```python
import torch

def _softmax(x, axis=-1):
    return torch.softmax(x, dim=axis)
def _gelu(x):
    return torch.nn.functional.gelu(x, approximate="tanh")
def _silu(x):
    return torch.nn.functional.silu(x)
def _sigmoid(x):
    return torch.sigmoid(x)
def _layernorm(x, axis=-1, eps=1e-5):
    m = x.mean(dim=axis, keepdim=True)
    v = x.var(dim=axis, keepdim=True, unbiased=False)
    return (x - m) / torch.sqrt(v + eps)
def _scatter_add(tgt, idx, src, axis=0):
    return tgt.clone().index_add_(axis, idx, src)
def _segment_sum(src, seg, n):
    out = torch.zeros((n,) + src.shape[1:], dtype=src.dtype)
    return out.index_add_(0, seg, src)
def _pad(x, pw):
    flat = tuple(v for pair in reversed(pw) for v in pair)
    return torch.nn.functional.pad(x, flat)

kernel_name = 'gated_mix__compressed_kv_cla__ssm_conv_h3__prompt'

def setup_inputs():

    _w = (lambda a: (lambda t: t.to(torch.bfloat16) if t.is_floating_point() else t)(torch.as_tensor(a)))
    def _A_setup():
        B, H, Sq, Sk, D, M = 1, 32, 2048, 2048, 128, 1024
        Dc = 4 * D
        return {
            "x": _w((lambda *s: torch.randn(*s, dtype=torch.bfloat16) * 0.05)(B, Sq, M)),
            "c_kv": _w((lambda *s: torch.randn(*s, dtype=torch.bfloat16) * 0.8)(B, Sk, Dc)),
            "w_q": _w((lambda *s: torch.randn(*s, dtype=torch.bfloat16) * 6.4)(M, H, D) * (M ** -0.5)),
            "w_uk": _w((lambda *s: torch.randn(*s, dtype=torch.bfloat16) * 6.4)(Dc, H, D) * (Dc ** -0.5)),
            "w_uv": _w((lambda *s: torch.randn(*s, dtype=torch.bfloat16) * 0.8)(Dc, H, D) * (Dc ** -0.5)),
            "w_o": _w((lambda *s: torch.randn(*s, dtype=torch.bfloat16) * 0.8)(H, D, M) * ((H * D) ** -0.5)),
        }
    _A_in = _A_setup()

    def _B_setup():
        B, S, D = 1, 2048, 1024
        ks = 4
        return {
            "q": _w((lambda *s: torch.randn(*s, dtype=torch.bfloat16) * 0.05)(B, S, D)),
            "k": _w((lambda *s: torch.randn(*s, dtype=torch.bfloat16) * 0.8)(B, S, D)),
            "v": _w((lambda *s: torch.randn(*s, dtype=torch.bfloat16) * 0.8)(B, S, D)),
            "shift_k": _w((lambda *s: torch.randn(*s, dtype=torch.bfloat16) * 0.8)(D, ks) * 0.5),
            "ssm_k": _w((lambda *s: torch.randn(*s, dtype=torch.bfloat16) * 1.6)(D, S) * (1.0 / S ** 0.5)),
            "ssm_D": _w((lambda *s: torch.randn(*s, dtype=torch.bfloat16) * 0.8)(D)),
        }
    _B_in = _B_setup()

    return {
        "A_x": _A_in["x"],
        "A_c_kv": _A_in["c_kv"],
        "A_w_q": _A_in["w_q"],
        "A_w_uk": _A_in["w_uk"],
        "A_w_uv": _A_in["w_uv"],
        "A_w_o": _A_in["w_o"],
        "B_q": _B_in["q"],
        "B_k": _B_in["k"],
        "B_v": _B_in["v"],
        "B_shift_k": _B_in["shift_k"],
        "B_ssm_k": _B_in["ssm_k"],
        "B_ssm_D": _B_in["ssm_D"],
        "gate_w": _w((lambda *s: torch.randn(*s, dtype=torch.bfloat16) * 0.05)(1024) * 16.0),
    }

def reference(A_x, A_c_kv, A_w_q, A_w_uk, A_w_uv, A_w_o, B_q, B_k, B_v, B_shift_k, B_ssm_k, B_ssm_D, gate_w):
    def _A_ref(x, c_kv, w_q, w_uk, w_uv, w_o):
        B, Sq, M = x.shape[0], x.shape[1], x.shape[2]
        Sk = c_kv.shape[1]
        H, D = w_q.shape[1], w_q.shape[2]
        q = torch.einsum("bqm,mhd->bhqd", x, w_q)
        k = torch.einsum("bkc,chd->bhkd", c_kv, w_uk)
        v = torch.einsum("bkc,chd->bhkd", c_kv, w_uv)
        scores = torch.einsum("bhqd,bhkd->bhqk", q, k) * (D ** -0.5)
        off = Sk - Sq
        qi = torch.arange(Sq)[:, None]
        kj = torch.arange(Sk)[None, :]
        cmask = kj <= (qi + off)
        scores = torch.where(cmask[None, None], scores, -1e9)
        p = _softmax(scores, axis=-1)
        ctx = torch.einsum("bhqk,bhkd->bhqd", p, v)
        return torch.einsum("bhqd,hdm->bqm", ctx, w_o)

    def _B_ref(q, k, v, shift_k, ssm_k, ssm_D):
        B, S, D = q.shape
        ks = shift_k.shape[-1]
        k_pad = _pad(k, ((0, 0), (ks - 1, 0), (0, 0)))
        k_shift = torch.zeros_like(k)
        for t in range(ks):
            k_shift = k_shift + k_pad[:, t:t + S, :] * shift_k[:, ks - 1 - t][None, None, :]
        kv = k_shift * v
        L = 2 * S
        kv_pad = _pad(kv, ((0, 0), (0, S), (0, 0)))
        kf_pad = _pad(ssm_k, ((0, 0), (0, S)))
        kv_f = (lambda x, axes=(-2,-1): torch.fft.rfft2(x.float(), dim=axes))(kv_pad[:, None, :, :], axes=(1, 2))
        kf_f = (lambda x, axes=(-2,-1): torch.fft.rfft2(x.float(), dim=axes))(kf_pad[:, None, :], axes=(1, 2))
        kf_f = (lambda x, *d: x.permute(*d))(kf_f, 1, 2, 0)
        y_f = kv_f * kf_f[None, :, :, :]
        y = (lambda x, s, axes=(-2,-1): torch.fft.irfft2(x, s=s, dim=axes).to(torch.bfloat16))(y_f, (1, L), axes=(1, 2))[:, 0, :S, :]
        y = y + kv * ssm_D[None, None, :]
        return q * y

    x = A_x
    g = _sigmoid((x * gate_w).sum(-1, keepdims=True))
    a = _A_ref(x, A_c_kv, A_w_q, A_w_uk, A_w_uv, A_w_o)
    b = _B_ref(x, B_k, B_v, B_shift_k, B_ssm_k, B_ssm_D)
    return g * a + (1 - g) * b
```

```asm
; @launch grid=(256,1,1) block=(256,1,1) lds=163840
.amdgcn_target "amdgcn-amd-amdhsa--gfx950"
.text
.globl gated_mix__compressed_kv_cla__ssm_conv_h3__prompt_kernel
.p2align 8
.type gated_mix__compressed_kv_cla__ssm_conv_h3__prompt_kernel,@function
gated_mix__compressed_kv_cla__ssm_conv_h3__prompt_kernel:
  s_cmp_ge_u32 s2, 256
  s_cbranch_scc1 L_end
  s_load_dwordx16 s[64:79], s[0:1], 0
  s_load_dwordx16 s[80:95], s[0:1], 64
  s_lshr_b32 s54, s2, 3
  s_mul_i32 s54, s54, 20
  v_lshrrev_b32 v20, 3, v0
  v_min_u32 v20, 19, v20
  v_add_u32 v20, s54, v20
  v_min_u32 v20, 629, v20
  v_lshlrev_b32 v20, 7, v20
  s_getpc_b64 s[52:53]
L_pc0:
  s_add_u32 s52, s52, L_pg0-L_pc0
  s_addc_u32 s53, s53, 0
  v_add_co_u32 v20, vcc, s52, v20
  v_mov_b32 v21, s53
  s_nop 0
  v_addc_co_u32 v21, vcc, 0, v21, vcc
  global_load_dword v127, v[20:21], off
L_code0:
  v_lshrrev_b32 v14, 6, v0
  v_and_b32 v1, 63, v0
  v_readfirstlane_b32 s28, v14
  s_and_b32 s3, s2, 7
  s_lshr_b32 s31, s2, 6
  s_lshl_b32 s29, s3, 2
  s_add_u32 s29, s29, s31
  s_lshr_b32 s30, s2, 3
  s_and_b32 s30, s30, 7
  s_lshl_b32 s96, s28, 13
  s_lshl_b32 s97, s28, 12
  v_lshrrev_b32 v16, 4, v1
  v_and_b32 v17, 15, v1
  v_lshlrev_b32 v18, 1, v16
  v_xor_b32 v18, v17, v18
  v_lshlrev_b32 v18, 4, v18
  v_lshl_add_u32 v28, v16, 13, v18
  s_lshr_b32 s99, s2, 6
  s_lshr_b32 s31, s2, 3
  s_add_u32 s99, s99, s31
  s_and_b32 s55, s99, 1
  s_lshl_b32 s98, s55, 19
  v_xor_b32 v28, s98, v28
  v_xor_b32 v29, 0x80, v28
  s_lshl_b32 s3, s29, 8
  s_lshl_b32 s31, s28, 17
  s_add_u32 s3, s3, s31
  s_mov_b32 s48, 0x0
  s_mov_b32 s49, 0x7c00
  s_mov_b32 s50, 0xf800
  s_mov_b32 s51, 0x17400
  s_mov_b32 s10, 0x39e100
  s_mov_b32 s11, 0x20000
  s_add_u32 m0, s97, 0x10000
  s_waitcnt lgkmcnt(0)
  s_add_u32 s8, s70, s3
  s_addc_u32 s9, s71, 0
  buffer_load_dwordx4 v28, s[8:11], s48 offen offset:0  lds
  buffer_load_dwordx4 v28, s[8:11], s49 offen offset:1024  lds
  buffer_load_dwordx4 v29, s[8:11], s50 offen offset:2048  lds
  buffer_load_dwordx4 v29, s[8:11], s51 offen offset:3072  lds
  v_lshrrev_b32 v14, 3, v1
  v_and_b32 v15, 7, v1
  v_xor_b32 v18, v15, v16
  v_lshlrev_b32 v18, 4, v18
  v_lshl_add_u32 v24, v14, 10, v18
  s_lshl_b32 s98, s55, 7
  v_xor_b32 v24, s98, v24
  v_xor_b32 v25, 64, v24
  s_lshl_b32 s98, s30, 17
  s_lshr_b32 s31, s28, 1
  s_lshl_b32 s31, s31, 16
  s_add_u32 s98, s98, s31
  s_and_b32 s31, s28, 1
  s_lshl_b32 s31, s31, 20
  s_add_u32 s98, s98, s31
  s_add_u32 s4, s66, s98
  s_addc_u32 s5, s67, 0
  s_mov_b32 s6, 0x10000
  s_mov_b32 s7, 0x20000
  s_add_u32 m0, s96, 0x0
  s_mov_b32 s32, 0x0
  buffer_load_dwordx4 v24, s[4:7], s32 offen offset:0  lds
  s_mov_b32 s33, 0x1c00
  buffer_load_dwordx4 v25, s[4:7], s33 offen offset:1024  lds
  s_mov_b32 s34, 0x3800
  buffer_load_dwordx4 v24, s[4:7], s34 offen offset:2048  lds
  s_mov_b32 s35, 0x5400
  buffer_load_dwordx4 v25, s[4:7], s35 offen offset:3072  lds
  s_add_u32 m0, s96, 0x1000
  s_mov_b32 s36, 0x8000
  buffer_load_dwordx4 v24, s[4:7], s36 offen offset:0  lds
  s_mov_b32 s37, 0x9c00
  buffer_load_dwordx4 v25, s[4:7], s37 offen offset:1024  lds
  s_mov_b32 s38, 0xb800
  buffer_load_dwordx4 v24, s[4:7], s38 offen offset:2048  lds
  s_mov_b32 s39, 0xd400
  buffer_load_dwordx4 v25, s[4:7], s39 offen offset:3072  lds
  s_add_u32 s12, s72, s3
  s_addc_u32 s13, s73, 0
  s_mov_b32 s14, 0x39e100
  s_mov_b32 s15, 0x20000
  v_lshl_add_u32 v26, v14, 11, v18
  s_and_b32 s99, s99, 1
  s_lshl_b32 s98, s99, 7
  v_xor_b32 v26, s98, v26
  v_xor_b32 v27, 64, v26
  s_xor_b32 s99, s99, s55
  s_xor_b32 s99, s99, 7
  s_lshl_b32 s99, s99, 19
  v_lshlrev_b32 v3, 4, v1
  v_add_u32 v2, s97, v3
  v_lshrrev_b32 v18, 1, v17
  v_xor_b32 v18, v16, v18
  v_lshlrev_b32 v18, 4, v18
  v_lshl_add_u32 v18, v17, 7, v18
  s_and_b32 s31, s28, 1
  s_lshl_b32 s31, s31, 14
  v_add_u32 v30, s31, v18
  v_xor_b32 v31, 64, v30
  v_add_u32 v32, 0x20000, v30
  v_add_u32 v33, 0x20000, v31
  v_add_u32 v34, s96, v18
  v_xor_b32 v35, 64, v34
  v_add_u32 v36, 0x20000, v34
  v_add_u32 v37, 0x20000, v35
  v_bfe_u32 v18, v1, 2, 2
  v_and_b32 v19, 1, v16
  v_lshl_add_u32 v19, v19, 2, v18
  v_lshl_add_u32 v18, v16, 3, v18
  v_lshlrev_b32 v18, 8, v18
  v_lshl_add_u32 v18, v19, 5, v18
  v_and_b32 v19, 3, v1
  v_lshl_add_u32 v18, v19, 3, v18
  v_add_u32 v42, 0x10000, v18
  v_xor_b32 v43, 0x20, v42
  v_xor_b32 v44, 0x40, v42
  v_xor_b32 v45, 0x60, v42
  v_xor_b32 v46, 0x80, v42
  v_xor_b32 v47, 0xa0, v42
  v_xor_b32 v48, 0xc0, v42
  v_xor_b32 v49, 0xe0, v42
  s_lshr_b32 s31, s28, 1
  s_lshl_b32 s31, s31, 7
  v_xor_b32 v38, s31, v42
  v_xor_b32 v39, s31, v43
  v_xor_b32 v40, s31, v44
  v_xor_b32 v41, s31, v45
  s_mov_b64 exec, 0
  s_cmp_eq_u32 s28, 0
  s_cbranch_scc1 L_pad1
  s_cmp_eq_u32 s28, 1
  s_cbranch_scc1 L_pad2
  s_cmp_eq_u32 s28, 2
  s_cbranch_scc1 L_pad3
  s_branch L_pad4
.p2align 12
L_pg0:
L_hr0:
  s_mov_b64 exec, -1
  s_add_u32 m0, s97, 0x14000
  s_nop 0
  buffer_load_dwordx4 v28, s[12:15], s48 offen offset:0  lds
  buffer_load_dwordx4 v28, s[12:15], s49 offen offset:1024  lds
  buffer_load_dwordx4 v29, s[12:15], s50 offen offset:2048  lds
  buffer_load_dwordx4 v29, s[12:15], s51 offen offset:3072  lds
  v_xor_b32 v28, 0x80000, v28
  v_xor_b32 v29, 0x80000, v29
  s_add_u32 m0, s97, 0x18000
  s_nop 0
  buffer_load_dwordx4 v28, s[8:11], s48 offen offset:0  lds
  buffer_load_dwordx4 v28, s[8:11], s49 offen offset:1024  lds
  buffer_load_dwordx4 v29, s[8:11], s50 offen offset:2048  lds
  buffer_load_dwordx4 v29, s[8:11], s51 offen offset:3072  lds
  s_waitcnt vmcnt(8)
  s_barrier
  ds_read_b64_tr_b16 a[192:193], v38 offset:0
  ds_read_b64_tr_b16 a[194:195], v38 offset:1024
  ds_read_b64_tr_b16 a[196:197], v38 offset:8192
  ds_read_b64_tr_b16 a[198:199], v38 offset:9216
  ds_read_b128 a[128:131], v30 offset:0
  ds_read_b128 a[132:135], v31 offset:0
  ds_read_b128 a[140:143], v31 offset:2048
  ds_read_b128 a[136:139], v30 offset:2048
  ds_read_b128 a[144:147], v30 offset:4096
  ds_read_b128 a[148:151], v31 offset:4096
  ds_read_b128 a[156:159], v31 offset:6144
  ds_read_b128 a[152:155], v30 offset:6144
  s_waitcnt lgkmcnt(7)
  v_mfma_f32_16x16x32_bf16 v[128:131], a[192:195], a[128:131], 0
  s_waitcnt lgkmcnt(6)
  s_lshl_b32 s3, s29, 8
  s_lshl_b32 s31, s28, 17
  ds_read_b128 a[160:163], v30 offset:8192
  v_mfma_f32_16x16x32_bf16 v[128:131], a[196:199], a[132:135], v[128:131]
  s_waitcnt lgkmcnt(6)
  s_add_u32 s3, s3, s31
  ds_read_b128 a[164:167], v31 offset:8192
  v_mfma_f32_16x16x32_bf16 v[144:147], a[196:199], a[140:143], 0
  s_waitcnt lgkmcnt(6)
  s_add_u32 s60, s68, s3
  s_addc_u32 s61, s69, 0
  ds_read_b128 a[172:175], v31 offset:10240
  v_mfma_f32_16x16x32_bf16 v[144:147], a[192:195], a[136:139], v[144:147]
  s_waitcnt lgkmcnt(6)
  s_mov_b32 s62, 0x79e100
  s_mov_b32 s63, 0x20000
  ds_read_b128 a[168:171], v30 offset:10240
  v_mfma_f32_16x16x32_bf16 v[160:163], a[192:195], a[144:147], 0
  s_waitcnt lgkmcnt(6)
  s_mov_b32 s56, s64
  s_mov_b32 s57, s65
  ds_read_b128 a[176:179], v30 offset:12288
  v_mfma_f32_16x16x32_bf16 v[160:163], a[196:199], a[148:151], v[160:163]
  s_waitcnt lgkmcnt(6)
  s_mov_b32 s58, 0x400000
  s_mov_b32 s59, 0x20000
  ds_read_b128 a[180:183], v31 offset:12288
  v_mfma_f32_16x16x32_bf16 v[176:179], a[196:199], a[156:159], 0
  s_waitcnt lgkmcnt(6)
  s_lshl_b32 s3, s30, 18
  s_lshl_b32 s31, s28, 15
  ds_read_b128 a[188:191], v31 offset:14336
  v_mfma_f32_16x16x32_bf16 v[176:179], a[192:195], a[152:155], v[176:179]
  s_waitcnt lgkmcnt(6)
  s_add_u32 s40, s3, s31
  s_xor_b32 s3, s3, 0x3c0000
  ds_read_b128 a[184:187], v30 offset:14336
  v_mfma_f32_16x16x32_bf16 v[192:195], a[192:195], a[160:163], 0
  s_waitcnt lgkmcnt(6)
  s_add_u32 s44, s3, s31
  s_add_u32 s41, s40, 0x3c00
  ds_read_b64_tr_b16 a[200:201], v39 offset:0
  v_mfma_f32_16x16x32_bf16 v[192:195], a[196:199], a[164:167], v[192:195]
  s_waitcnt lgkmcnt(6)
  s_add_u32 s45, s44, 0x3c00
  s_add_u32 s42, s40, 0x1f800
  ds_read_b64_tr_b16 a[202:203], v39 offset:1024
  v_mfma_f32_16x16x32_bf16 v[208:211], a[196:199], a[172:175], 0
  s_waitcnt lgkmcnt(6)
  s_add_u32 s46, s44, 0x1f800
  s_add_u32 s43, s40, 0x23400
  ds_read_b64_tr_b16 a[204:205], v39 offset:8192
  v_mfma_f32_16x16x32_bf16 v[208:211], a[192:195], a[168:171], v[208:211]
  s_waitcnt lgkmcnt(6)
  s_add_u32 s47, s44, 0x23400
  s_lshl_b32 s3, s29, 20
  ds_read_b64_tr_b16 a[206:207], v39 offset:9216
  v_mfma_f32_16x16x32_bf16 v[224:227], a[192:195], a[176:179], 0
  s_waitcnt lgkmcnt(6)
  s_add_u32 s16, s94, s3
  s_addc_u32 s17, s95, 0
  ds_read_b64_tr_b16 a[208:209], v40 offset:0
  v_mfma_f32_16x16x32_bf16 v[224:227], a[196:199], a[180:183], v[224:227]
  s_waitcnt lgkmcnt(6)
  s_mov_b32 s18, 0x100000
  s_mov_b32 s19, 0x20000
  ds_read_b64_tr_b16 a[210:211], v40 offset:1024
  v_mfma_f32_16x16x32_bf16 v[240:243], a[196:199], a[188:191], 0
  s_waitcnt lgkmcnt(6)
  s_xor_b32 s31, s30, 15
  s_add_u32 s31, s31, 1
  ds_read_b64_tr_b16 a[212:213], v40 offset:8192
  v_mfma_f32_16x16x32_bf16 v[240:243], a[192:195], a[184:187], v[240:243]
  s_waitcnt lgkmcnt(5)
  s_lshl_b32 s31, s31, 16
  ds_read_b64_tr_b16 a[214:215], v40 offset:9216
  v_xor_b32 v24, 0x80, v24
  v_mfma_f32_16x16x32_bf16 v[244:247], a[200:203], a[184:187], 0
  s_waitcnt lgkmcnt(4)
  s_add_u32 s24, s94, s3
  s_addc_u32 s25, s95, 0
  v_xor_b32 v25, 0x80, v25
  v_mfma_f32_16x16x32_bf16 v[244:247], a[204:207], a[188:191], v[244:247]
  s_mov_b32 s26, s31
  s_mov_b32 s27, 0x20000
  v_mfma_f32_16x16x32_bf16 v[228:231], a[204:207], a[180:183], 0
  s_add_u32 s20, s94, 0x3d00000
  s_addc_u32 s21, s95, 0
  v_mfma_f32_16x16x32_bf16 v[228:231], a[200:203], a[176:179], v[228:231]
  s_mov_b32 s22, 0x100000
  s_mov_b32 s23, 0x20000
  v_mfma_f32_16x16x32_bf16 v[212:215], a[200:203], a[168:171], 0
  s_lshl_b32 s3, s30, 16
  s_and_b32 s31, s28, 1
  v_mfma_f32_16x16x32_bf16 v[212:215], a[204:207], a[172:175], v[212:215]
  s_lshl_b32 s31, s31, 15
  s_add_u32 s3, s3, s31
  v_mfma_f32_16x16x32_bf16 v[196:199], a[204:207], a[164:167], 0
  s_lshr_b32 s31, s28, 1
  s_lshl_b32 s98, s31, 11
  ds_read_b64_tr_b16 a[216:217], v41 offset:0
  v_mfma_f32_16x16x32_bf16 v[196:199], a[200:203], a[160:163], v[196:199]
  s_add_u32 s98, s98, s3
  v_add_u32 v11, s98, v3
  s_lshl_b32 s98, s31, 13
  v_mfma_f32_16x16x32_bf16 v[180:183], a[200:203], a[152:155], 0
  s_add_u32 s98, s98, s3
  s_add_u32 s98, s98, 0x4000
  v_add_u32 v12, s98, v3
  v_mfma_f32_16x16x32_bf16 v[180:183], a[204:207], a[156:159], v[180:183]
  v_lshlrev_b32 v8, 20, v0
  s_lshl_b32 s3, s29, 10
  s_add_u32 s3, s3, 524288
  v_mfma_f32_16x16x32_bf16 v[164:167], a[204:207], a[148:151], 0
  s_add_u32 m0, s96, 0x8000
  v_lshlrev_b32 v7, 7, v15
  v_add_u32 v7, s3, v7
  v_mfma_f32_16x16x32_bf16 v[164:167], a[200:203], a[144:147], v[164:167]
  v_mov_b32 v9, 1
  v_mov_b32 v13, 0xff800000
  v_mfma_f32_16x16x32_bf16 v[148:151], a[200:203], a[136:139], 0
  v_add_u32 v4, 0x10000, v3
  v_mov_b32 v5, v3
  s_mov_b32 s52, s64
  v_mfma_f32_16x16x32_bf16 v[148:151], a[204:207], a[140:143], v[148:151]
  s_mov_b32 s53, s65
  s_mov_b32 s54, 0x400000
  ds_read_b64_tr_b16 a[218:219], v41 offset:1024
  v_mfma_f32_16x16x32_bf16 v[132:135], a[204:207], a[132:135], 0
  s_mov_b32 s55, 0x20000
  s_lshr_b32 s3, s2, 4
  ds_read_b64_tr_b16 a[220:221], v41 offset:8192
  v_mfma_f32_16x16x32_bf16 v[132:135], a[200:203], a[128:131], v[132:135]
  s_waitcnt lgkmcnt(5)
  s_lshl_b32 s3, s3, 18
  s_and_b32 s31, s2, 15
  ds_read_b64_tr_b16 a[222:223], v41 offset:9216
  v_mfma_f32_16x16x32_bf16 v[136:139], a[208:211], a[128:131], 0
  s_waitcnt lgkmcnt(4)
  s_lshl_b32 s31, s31, 7
  buffer_load_dwordx4 v24, s[4:7], s32 offen offset:0  lds
  v_mfma_f32_16x16x32_bf16 v[136:139], a[212:215], a[132:135], v[136:139]
  s_add_u32 s3, s3, s31
  v_lshrrev_b32 v22, 4, v0
  v_lshlrev_b32 v18, 14, v22
  v_mfma_f32_16x16x32_bf16 v[152:155], a[212:215], a[140:143], 0
  v_lshl_add_u32 v18, v17, 3, v18
  v_add_u32 v18, s3, v18
  s_lshl_b32 s31, s31, 2
  v_mfma_f32_16x16x32_bf16 v[152:155], a[208:211], a[136:139], v[152:155]
  v_lshlrev_b32 v19, 5, v17
  v_add_u32 v19, s31, v19
  s_lshl_b32 s31, s31, 9
  v_mfma_f32_16x16x32_bf16 v[168:171], a[208:211], a[144:147], 0
  s_lshr_b32 s3, s2, 4
  s_lshl_b32 s3, s3, 9
  v_mfma_f32_16x16x32_bf16 v[168:171], a[212:215], a[148:151], v[168:171]
  s_add_u32 s3, s3, s31
  s_lshl_b32 s31, s28, 7
  v_mfma_f32_16x16x32_bf16 v[184:187], a[212:215], a[156:159], 0
  s_add_u32 s3, s3, s31
  v_lshlrev_b32 v20, 15, v14
  v_lshl_add_u32 v20, v15, 4, v20
  v_mfma_f32_16x16x32_bf16 v[184:187], a[208:211], a[152:155], v[184:187]
  s_waitcnt vmcnt(5)
  buffer_load_dwordx4 v25, s[4:7], s33 offen offset:1024  lds
  v_mfma_f32_16x16x32_bf16 v[200:203], a[208:211], a[160:163], 0
  s_barrier
  v_mfma_f32_16x16x32_bf16 v[200:203], a[212:215], a[164:167], v[200:203]
  v_add_u32 v20, s3, v20
  v_bfe_u32 v21, v17, 3, 1
  v_mfma_f32_16x16x32_bf16 v[216:219], a[212:215], a[172:175], 0
  v_lshl_add_u32 v21, v21, 2, v16
  v_xor_b32 v21, v21, v15
  v_mfma_f32_16x16x32_bf16 v[216:219], a[208:211], a[168:171], v[216:219]
  v_lshl_add_u32 v6, v15, 3, v21
  v_lshlrev_b32 v6, 4, v6
  v_mfma_f32_16x16x32_bf16 v[232:235], a[208:211], a[176:179], 0
  v_add_u32 v6, s96, v6
  s_lshr_b32 s3, s2, 3
  s_lshl_b32 s3, s3, 18
  v_mfma_f32_16x16x32_bf16 v[232:235], a[212:215], a[180:183], v[232:235]
  s_lshl_b32 s31, s28, 16
  s_add_u32 s3, s3, s31
  ds_read_b64_tr_b16 a[192:193], v38 offset:16384
  v_mfma_f32_16x16x32_bf16 v[248:251], a[212:215], a[188:191], 0
  s_and_b32 s31, s2, 7
  buffer_load_dwordx4 v24, s[4:7], s34 offen offset:2048  lds
  v_mfma_f32_16x16x32_bf16 v[248:251], a[208:211], a[184:187], v[248:251]
  s_waitcnt lgkmcnt(3)
  s_lshl_b32 s31, s31, 10
  s_add_u32 s3, s3, s31
  v_lshrrev_b32 v21, 5, v1
  v_mfma_f32_16x16x32_bf16 v[252:255], a[216:219], a[184:187], 0
  s_waitcnt lgkmcnt(1)
  v_lshlrev_b32 v21, 13, v21
  v_bfe_u32 v22, v1, 2, 3
  v_mfma_f32_16x16x32_bf16 v[252:255], a[220:223], a[188:191], v[252:255]
  v_lshl_add_u32 v21, v22, 7, v21
  v_add_u32 v21, s3, v21
  v_mfma_f32_16x16x32_bf16 v[236:239], a[220:223], a[180:183], 0
  v_xor_b32 v22, v14, v1
  v_lshlrev_b32 v22, 4, v22
  v_mfma_f32_16x16x32_bf16 v[236:239], a[216:219], a[176:179], v[236:239]
  v_add_u32 v22, s96, v22
  s_mov_b32 s101, 0xffff0000
  s_lshl_b32 s3, s28, 20
  v_mfma_f32_16x16x32_bf16 v[220:223], a[216:219], a[168:171], 0
  v_add_u32 v15, s3, v3
  v_mov_b32 v100, 0
  v_mfma_f32_16x16x32_bf16 v[220:223], a[220:223], a[172:175], v[220:223]
  buffer_load_dwordx4 v25, s[4:7], s35 offen offset:3072  lds
  v_mfma_f32_16x16x32_bf16 v[204:207], a[220:223], a[164:167], 0
  s_add_u32 m0, s96, 0x9000
  v_mov_b32 v101, 0
  v_mov_b32 v102, 0
  v_mfma_f32_16x16x32_bf16 v[204:207], a[216:219], a[160:163], v[204:207]
  ds_read_b64_tr_b16 a[194:195], v38 offset:17408
  v_mov_b32 v103, 0
  s_lshl_b32 s77, s2, 14
  v_mfma_f32_16x16x32_bf16 v[188:191], a[216:219], a[152:155], 0
  s_add_u32 s77, s77, s97
  ds_read_b64_tr_b16 a[196:197], v38 offset:24576
  v_subrev_u32 v96, 6144, v18
  v_mfma_f32_16x16x32_bf16 v[188:191], a[220:223], a[156:159], v[188:191]
  ds_read_b64_tr_b16 a[198:199], v38 offset:25600
  v_subrev_u32 v97, 4096, v18
  v_mfma_f32_16x16x32_bf16 v[172:175], a[220:223], a[148:151], 0
  ds_read_b64_tr_b16 a[200:201], v39 offset:16384
  v_subrev_u32 v98, 2048, v18
  v_mfma_f32_16x16x32_bf16 v[172:175], a[216:219], a[144:147], v[172:175]
  buffer_load_dwordx4 v24, s[4:7], s36 offen offset:0  lds
  v_mfma_f32_16x16x32_bf16 v[156:159], a[216:219], a[136:139], 0
  ds_read_b64_tr_b16 a[202:203], v39 offset:17408
  v_mfma_f32_16x16x32_bf16 v[156:159], a[220:223], a[140:143], v[156:159]
  ds_read_b64_tr_b16 a[204:205], v39 offset:24576
  v_mfma_f32_16x16x32_bf16 v[140:143], a[220:223], a[132:135], 0
  buffer_load_dwordx4 v25, s[4:7], s37 offen offset:1024  lds
  v_mfma_f32_16x16x32_bf16 v[140:143], a[216:219], a[128:131], v[140:143]
  s_waitcnt lgkmcnt(5)
  ds_read_b64_tr_b16 a[206:207], v39 offset:25600
  v_mfma_f32_16x16x32_bf16 a[0:3], a[128:131], a[192:195], 0
  s_waitcnt lgkmcnt(4)
  v_mfma_f32_16x16x32_bf16 a[0:3], a[132:135], a[196:199], a[0:3]
  buffer_load_dwordx4 v24, s[4:7], s38 offen offset:2048  lds
  v_mfma_f32_16x16x32_bf16 a[16:19], a[140:143], a[196:199], 0
  v_mfma_f32_16x16x32_bf16 a[16:19], a[136:139], a[192:195], a[16:19]
  v_mfma_f32_16x16x32_bf16 a[32:35], a[144:147], a[192:195], 0
  buffer_load_dwordx4 v25, s[4:7], s39 offen offset:3072  lds
  v_mfma_f32_16x16x32_bf16 a[32:35], a[148:151], a[196:199], a[32:35]
  v_mfma_f32_16x16x32_bf16 a[48:51], a[156:159], a[196:199], 0
  ds_read_b64_tr_b16 a[208:209], v40 offset:16384
  v_mfma_f32_16x16x32_bf16 a[48:51], a[152:155], a[192:195], a[48:51]
  ds_read_b64_tr_b16 a[210:211], v40 offset:17408
  v_mfma_f32_16x16x32_bf16 a[64:67], a[160:163], a[192:195], 0
  ds_read_b64_tr_b16 a[212:213], v40 offset:24576
  v_mfma_f32_16x16x32_bf16 a[64:67], a[164:167], a[196:199], a[64:67]
  ds_read_b64_tr_b16 a[214:215], v40 offset:25600
  v_mfma_f32_16x16x32_bf16 a[80:83], a[172:175], a[196:199], 0
  v_mfma_f32_16x16x32_bf16 a[80:83], a[168:171], a[192:195], a[80:83]
  s_lshl_b32 s76, s2, 11
  v_mfma_f32_16x16x32_bf16 a[96:99], a[176:179], a[192:195], 0
  buffer_store_dwordx4 v[100:103], v15, s[20:23], s76 offen offset:1024 sc1
  v_mfma_f32_16x16x32_bf16 a[96:99], a[180:183], a[196:199], a[96:99]
  v_mfma_f32_16x16x32_bf16 a[112:115], a[188:191], a[196:199], 0
  v_mfma_f32_16x16x32_bf16 a[112:115], a[184:187], a[192:195], a[112:115]
  s_waitcnt lgkmcnt(6)
  buffer_store_dwordx4 v[100:103], v15, s[20:23], s76 offen sc1
  v_mfma_f32_16x16x32_bf16 a[116:119], a[184:187], a[200:203], 0
  s_waitcnt lgkmcnt(4)
  s_lshl_b32 s76, s29, 10
  v_mfma_f32_16x16x32_bf16 a[116:119], a[188:191], a[204:207], a[116:119]
  s_add_u32 s76, s76, 524288
  v_mfma_f32_16x16x32_bf16 a[100:103], a[180:183], a[204:207], 0
  s_cmp_eq_u32 s30, 7
  s_cselect_b32 s76, s76, 0x100000
  v_mfma_f32_16x16x32_bf16 a[100:103], a[176:179], a[200:203], a[100:103]
  buffer_store_dwordx4 v[100:103], v15, s[20:23], s76 offen sc1
  v_mfma_f32_16x16x32_bf16 a[84:87], a[168:171], a[200:203], 0
  s_add_u32 m0, s97, 0x1c000
  v_mfma_f32_16x16x32_bf16 a[84:87], a[172:175], a[204:207], a[84:87]
  v_mfma_f32_16x16x32_bf16 a[68:71], a[164:167], a[204:207], 0
  buffer_load_dwordx4 v28, s[12:15], s48 offen offset:0  lds
  v_mfma_f32_16x16x32_bf16 a[68:71], a[160:163], a[200:203], a[68:71]
  ds_read_b64_tr_b16 a[216:217], v41 offset:16384
  v_mfma_f32_16x16x32_bf16 a[52:55], a[152:155], a[200:203], 0
  ds_read_b64_tr_b16 a[218:219], v41 offset:17408
  v_mfma_f32_16x16x32_bf16 a[52:55], a[156:159], a[204:207], a[52:55]
  buffer_load_dwordx4 v28, s[12:15], s49 offen offset:1024  lds
  v_mfma_f32_16x16x32_bf16 a[36:39], a[148:151], a[204:207], 0
  ds_read_b64_tr_b16 a[220:221], v41 offset:24576
  v_mfma_f32_16x16x32_bf16 a[36:39], a[144:147], a[200:203], a[36:39]
  ds_read_b64_tr_b16 a[222:223], v41 offset:25600
  v_mfma_f32_16x16x32_bf16 a[20:23], a[136:139], a[200:203], 0
  v_mfma_f32_16x16x32_bf16 a[20:23], a[140:143], a[204:207], a[20:23]
  v_mfma_f32_16x16x32_bf16 a[4:7], a[132:135], a[204:207], 0
  v_mfma_f32_16x16x32_bf16 a[4:7], a[128:131], a[200:203], a[4:7]
  s_waitcnt lgkmcnt(6)
  v_mfma_f32_16x16x32_bf16 a[8:11], a[128:131], a[208:211], 0
  s_waitcnt lgkmcnt(4)
  buffer_load_dwordx4 v29, s[12:15], s50 offen offset:2048  lds
  v_mfma_f32_16x16x32_bf16 a[8:11], a[132:135], a[212:215], a[8:11]
  v_mfma_f32_16x16x32_bf16 a[24:27], a[140:143], a[212:215], 0
  v_mfma_f32_16x16x32_bf16 a[24:27], a[136:139], a[208:211], a[24:27]
  v_mfma_f32_16x16x32_bf16 a[40:43], a[144:147], a[208:211], 0
  v_mfma_f32_16x16x32_bf16 a[40:43], a[148:151], a[212:215], a[40:43]
  v_mfma_f32_16x16x32_bf16 a[56:59], a[156:159], a[212:215], 0
  v_mfma_f32_16x16x32_bf16 a[56:59], a[152:155], a[208:211], a[56:59]
  s_waitcnt vmcnt(6)
  buffer_load_dwordx4 v29, s[12:15], s51 offen offset:3072  lds
  v_mfma_f32_16x16x32_bf16 a[72:75], a[160:163], a[208:211], 0
  s_barrier
  v_mfma_f32_16x16x32_bf16 a[72:75], a[164:167], a[212:215], a[72:75]
  s_mov_b32 s52, s78
  ds_read_b64_tr_b16 a[192:193], v38 offset:32768
  v_mfma_f32_16x16x32_bf16 a[88:91], a[172:175], a[212:215], 0
  s_mov_b32 s53, s79
  ds_read_b64_tr_b16 a[194:195], v38 offset:33792
  v_mfma_f32_16x16x32_bf16 a[88:91], a[168:171], a[208:211], a[88:91]
  s_mov_b32 s54, 0x400000
  ds_read_b64_tr_b16 a[196:197], v38 offset:40960
  v_mfma_f32_16x16x32_bf16 a[104:107], a[176:179], a[208:211], 0
  ds_read_b64_tr_b16 a[198:199], v38 offset:41984
  v_mfma_f32_16x16x32_bf16 a[104:107], a[180:183], a[212:215], a[104:107]
  v_mfma_f32_16x16x32_bf16 a[120:123], a[188:191], a[212:215], 0
  buffer_load_dwordx2 v[58:59], v96, s[52:55], 0 offen
  v_mfma_f32_16x16x32_bf16 a[120:123], a[184:187], a[208:211], a[120:123]
  s_waitcnt lgkmcnt(6)
  v_mfma_f32_16x16x32_bf16 a[124:127], a[184:187], a[216:219], 0
  s_waitcnt lgkmcnt(4)
  ds_read_b128 a[184:187], v30 offset:47104
  v_mfma_f32_16x16x32_bf16 a[124:127], a[188:191], a[220:223], a[124:127]
  buffer_load_dwordx2 v[60:61], v97, s[52:55], 0 offen
  v_mfma_f32_16x16x32_bf16 a[108:111], a[180:183], a[220:223], 0
  ds_read_b128 a[188:191], v31 offset:47104
  v_mfma_f32_16x16x32_bf16 a[108:111], a[176:179], a[216:219], a[108:111]
  ds_read_b128 a[180:183], v31 offset:45056
  v_mfma_f32_16x16x32_bf16 a[92:95], a[168:171], a[216:219], 0
  ds_read_b128 a[176:179], v30 offset:45056
  v_mfma_f32_16x16x32_bf16 a[92:95], a[172:175], a[220:223], a[92:95]
  buffer_load_dwordx2 v[62:63], v98, s[52:55], 0 offen
  v_mfma_f32_16x16x32_bf16 a[76:79], a[164:167], a[220:223], 0
  s_mov_b32 s76, 0
  ds_read_b128 a[168:171], v30 offset:43008
  v_mfma_f32_16x16x32_bf16 a[76:79], a[160:163], a[216:219], a[76:79]
  ds_read_b128 a[172:175], v31 offset:43008
  v_mfma_f32_16x16x32_bf16 a[60:63], a[152:155], a[216:219], 0
  buffer_load_dwordx2 v[64:65], v18, s[52:55], s76 offen offset:0
  v_mfma_f32_16x16x32_bf16 a[60:63], a[156:159], a[220:223], a[60:63]
  ds_read_b128 a[164:167], v31 offset:40960
  v_xor_b32 v28, 0x180000, v28
  v_mfma_f32_16x16x32_bf16 a[44:47], a[148:151], a[220:223], 0
  ds_read_b128 a[160:163], v30 offset:40960
  v_xor_b32 v29, 0x180000, v29
  v_mfma_f32_16x16x32_bf16 a[44:47], a[144:147], a[216:219], a[44:47]
  s_add_u32 m0, s97, 0x10000
  ds_read_b128 a[152:155], v30 offset:38912
  v_mfma_f32_16x16x32_bf16 a[28:31], a[136:139], a[216:219], 0
  buffer_load_dwordx4 v28, s[8:11], s48 offen offset:0  lds
  v_mfma_f32_16x16x32_bf16 a[28:31], a[140:143], a[220:223], a[28:31]
  ds_read_b128 a[156:159], v31 offset:38912
  v_mfma_f32_16x16x32_bf16 a[12:15], a[132:135], a[220:223], 0
  ds_read_b128 a[148:151], v31 offset:36864
  v_mfma_f32_16x16x32_bf16 a[12:15], a[128:131], a[216:219], a[12:15]
  s_waitcnt lgkmcnt(10)
  ds_read_b128 a[144:147], v30 offset:36864
  v_mfma_f32_16x16x32_bf16 v[240:243], a[192:195], a[184:187], v[240:243]
  s_waitcnt lgkmcnt(10)
  ds_read_b128 a[136:139], v30 offset:34816
  v_mfma_f32_16x16x32_bf16 v[240:243], a[196:199], a[188:191], v[240:243]
  s_waitcnt lgkmcnt(10)
  ds_read_b128 a[140:143], v31 offset:34816
  v_mfma_f32_16x16x32_bf16 v[224:227], a[196:199], a[180:183], v[224:227]
  s_waitcnt lgkmcnt(10)
  ds_read_b64_tr_b16 a[200:201], v39 offset:32768
  v_mfma_f32_16x16x32_bf16 v[224:227], a[192:195], a[176:179], v[224:227]
  s_waitcnt lgkmcnt(10)
  buffer_load_dwordx4 v28, s[8:11], s49 offen offset:1024  lds
  v_mfma_f32_16x16x32_bf16 v[208:211], a[192:195], a[168:171], v[208:211]
  s_waitcnt lgkmcnt(9)
  ds_read_b128 a[132:135], v31 offset:32768
  v_mfma_f32_16x16x32_bf16 v[208:211], a[196:199], a[172:175], v[208:211]
  s_waitcnt lgkmcnt(9)
  ds_read_b64_tr_b16 a[202:203], v39 offset:33792
  v_mfma_f32_16x16x32_bf16 v[192:195], a[196:199], a[164:167], v[192:195]
  s_waitcnt lgkmcnt(9)
  ds_read_b128 a[128:131], v30 offset:32768
  v_mfma_f32_16x16x32_bf16 v[192:195], a[192:195], a[160:163], v[192:195]
  s_waitcnt lgkmcnt(9)
  ds_read_b64_tr_b16 a[204:205], v39 offset:40960
  v_mfma_f32_16x16x32_bf16 v[176:179], a[192:195], a[152:155], v[176:179]
  s_waitcnt lgkmcnt(9)
  ds_read_b64_tr_b16 a[206:207], v39 offset:41984
  v_mfma_f32_16x16x32_bf16 v[176:179], a[196:199], a[156:159], v[176:179]
  s_waitcnt lgkmcnt(9)
  ds_read_b64_tr_b16 a[208:209], v40 offset:32768
  v_mfma_f32_16x16x32_bf16 v[160:163], a[196:199], a[148:151], v[160:163]
  s_waitcnt lgkmcnt(9)
  buffer_load_dwordx4 v29, s[8:11], s50 offen offset:2048  lds
  v_mfma_f32_16x16x32_bf16 v[160:163], a[192:195], a[144:147], v[160:163]
  s_waitcnt lgkmcnt(8)
  ds_read_b64_tr_b16 a[210:211], v40 offset:33792
  v_mfma_f32_16x16x32_bf16 v[144:147], a[192:195], a[136:139], v[144:147]
  s_waitcnt lgkmcnt(8)
  ds_read_b64_tr_b16 a[212:213], v40 offset:40960
  v_mfma_f32_16x16x32_bf16 v[144:147], a[196:199], a[140:143], v[144:147]
  s_waitcnt lgkmcnt(7)
  ds_read_b64_tr_b16 a[214:215], v40 offset:41984
  v_mfma_f32_16x16x32_bf16 v[128:131], a[196:199], a[132:135], v[128:131]
  s_waitcnt lgkmcnt(6)
  v_mfma_f32_16x16x32_bf16 v[128:131], a[192:195], a[128:131], v[128:131]
  v_mfma_f32_16x16x32_bf16 v[132:135], a[200:203], a[128:131], v[132:135]
  s_waitcnt lgkmcnt(4)
  v_mfma_f32_16x16x32_bf16 v[132:135], a[204:207], a[132:135], v[132:135]
  buffer_load_dwordx4 v29, s[8:11], s51 offen offset:3072  lds
  v_mfma_f32_16x16x32_bf16 v[148:151], a[204:207], a[140:143], v[148:151]
  v_mfma_f32_16x16x32_bf16 v[148:151], a[200:203], a[136:139], v[148:151]
  v_mfma_f32_16x16x32_bf16 v[164:167], a[200:203], a[144:147], v[164:167]
  v_mfma_f32_16x16x32_bf16 v[164:167], a[204:207], a[148:151], v[164:167]
  v_mfma_f32_16x16x32_bf16 v[180:183], a[204:207], a[156:159], v[180:183]
  ds_read_b64_tr_b16 a[216:217], v41 offset:32768
  v_mfma_f32_16x16x32_bf16 v[180:183], a[200:203], a[152:155], v[180:183]
  ds_read_b64_tr_b16 a[218:219], v41 offset:33792
  v_mfma_f32_16x16x32_bf16 v[196:199], a[200:203], a[160:163], v[196:199]
  buffer_load_dwordx2 v[66:67], v18, s[52:55], s76 offen offset:2048
  v_mfma_f32_16x16x32_bf16 v[196:199], a[204:207], a[164:167], v[196:199]
  ds_read_b64_tr_b16 a[220:221], v41 offset:40960
  v_xor_b32 v24, 0x180, v24
  v_mfma_f32_16x16x32_bf16 v[212:215], a[204:207], a[172:175], v[212:215]
  ds_read_b64_tr_b16 a[222:223], v41 offset:41984
  v_xor_b32 v25, 0x180, v25
  v_mfma_f32_16x16x32_bf16 v[212:215], a[200:203], a[168:171], v[212:215]
  s_add_u32 m0, s96, 0x20000
  v_mfma_f32_16x16x32_bf16 v[228:231], a[200:203], a[176:179], v[228:231]
  buffer_load_dwordx4 v24, s[4:7], s32 offen offset:0  lds
  v_mfma_f32_16x16x32_bf16 v[228:231], a[204:207], a[180:183], v[228:231]
  v_mfma_f32_16x16x32_bf16 v[244:247], a[204:207], a[188:191], v[244:247]
  v_mfma_f32_16x16x32_bf16 v[244:247], a[200:203], a[184:187], v[244:247]
  s_waitcnt lgkmcnt(6)
  v_mfma_f32_16x16x32_bf16 v[248:251], a[208:211], a[184:187], v[248:251]
  s_waitcnt lgkmcnt(4)
  buffer_load_dwordx4 v25, s[4:7], s33 offen offset:1024  lds
  v_mfma_f32_16x16x32_bf16 v[248:251], a[212:215], a[188:191], v[248:251]
  v_mfma_f32_16x16x32_bf16 v[232:235], a[212:215], a[180:183], v[232:235]
  v_mfma_f32_16x16x32_bf16 v[232:235], a[208:211], a[176:179], v[232:235]
  buffer_load_dwordx4 v24, s[4:7], s34 offen offset:2048  lds
  v_mfma_f32_16x16x32_bf16 v[216:219], a[208:211], a[168:171], v[216:219]
  v_mfma_f32_16x16x32_bf16 v[216:219], a[212:215], a[172:175], v[216:219]
  v_mfma_f32_16x16x32_bf16 v[200:203], a[212:215], a[164:167], v[200:203]
  buffer_load_dwordx4 v25, s[4:7], s35 offen offset:3072  lds
  v_mfma_f32_16x16x32_bf16 v[200:203], a[208:211], a[160:163], v[200:203]
  s_add_u32 m0, s96, 0x21000
  s_mov_b64 exec, 0
  s_cmp_eq_u32 s28, 0
  s_cbranch_scc1 L_pad9
  s_cmp_eq_u32 s28, 1
  s_cbranch_scc1 L_pad10
  s_cmp_eq_u32 s28, 2
  s_cbranch_scc1 L_pad11
  s_branch L_pad12
L_hr1:
  s_mov_b64 exec, -1
  v_mfma_f32_16x16x32_bf16 v[184:187], a[208:211], a[152:155], v[184:187]
  s_waitcnt vmcnt(13)
  s_barrier
  v_mfma_f32_16x16x32_bf16 v[184:187], a[212:215], a[156:159], v[184:187]
  buffer_load_dwordx4 v24, s[4:7], s36 offen offset:0  lds
  v_mfma_f32_16x16x32_bf16 v[168:171], a[212:215], a[148:151], v[168:171]
  ds_read_b64_tr_b16 a[192:193], v38 offset:49152
  v_mfma_f32_16x16x32_bf16 v[168:171], a[208:211], a[144:147], v[168:171]
  ds_read_b64_tr_b16 a[194:195], v38 offset:50176
  v_mfma_f32_16x16x32_bf16 v[152:155], a[208:211], a[136:139], v[152:155]
  buffer_load_dwordx4 v25, s[4:7], s37 offen offset:1024  lds
  v_mfma_f32_16x16x32_bf16 v[152:155], a[212:215], a[140:143], v[152:155]
  ds_read_b64_tr_b16 a[196:197], v38 offset:57344
  v_mfma_f32_16x16x32_bf16 v[136:139], a[212:215], a[132:135], v[136:139]
  ds_read_b64_tr_b16 a[198:199], v38 offset:58368
  v_mfma_f32_16x16x32_bf16 v[136:139], a[208:211], a[128:131], v[136:139]
  s_waitcnt lgkmcnt(6)
  buffer_load_dwordx4 v24, s[4:7], s38 offen offset:2048  lds
  v_mfma_f32_16x16x32_bf16 v[140:143], a[216:219], a[128:131], v[140:143]
  s_waitcnt lgkmcnt(4)
  v_mfma_f32_16x16x32_bf16 v[140:143], a[220:223], a[132:135], v[140:143]
  v_mfma_f32_16x16x32_bf16 v[156:159], a[220:223], a[140:143], v[156:159]
  buffer_load_dwordx4 v25, s[4:7], s39 offen offset:3072  lds
  v_mfma_f32_16x16x32_bf16 v[156:159], a[216:219], a[136:139], v[156:159]
  s_mov_b32 s76, 4096
  v_mfma_f32_16x16x32_bf16 v[172:175], a[216:219], a[144:147], v[172:175]
  v_mfma_f32_16x16x32_bf16 v[172:175], a[220:223], a[148:151], v[172:175]
  buffer_load_dwordx2 v[68:69], v18, s[52:55], s76 offen offset:0
  v_mfma_f32_16x16x32_bf16 v[188:191], a[220:223], a[156:159], v[188:191]
  ds_read_b64_tr_b16 a[200:201], v39 offset:49152
  v_mfma_f32_16x16x32_bf16 v[188:191], a[216:219], a[152:155], v[188:191]
  ds_read_b64_tr_b16 a[202:203], v39 offset:50176
  v_mfma_f32_16x16x32_bf16 v[204:207], a[216:219], a[160:163], v[204:207]
  buffer_load_dwordx2 v[70:71], v18, s[52:55], s76 offen offset:2048
  v_mfma_f32_16x16x32_bf16 v[204:207], a[220:223], a[164:167], v[204:207]
  s_mov_b32 s76, 8192
  ds_read_b64_tr_b16 a[204:205], v39 offset:57344
  v_mfma_f32_16x16x32_bf16 v[220:223], a[220:223], a[172:175], v[220:223]
  ds_read_b64_tr_b16 a[206:207], v39 offset:58368
  v_mfma_f32_16x16x32_bf16 v[220:223], a[216:219], a[168:171], v[220:223]
  buffer_load_dwordx2 v[72:73], v18, s[52:55], s76 offen offset:0
  v_mfma_f32_16x16x32_bf16 v[236:239], a[216:219], a[176:179], v[236:239]
  v_mfma_f32_16x16x32_bf16 v[236:239], a[220:223], a[180:183], v[236:239]
  v_mfma_f32_16x16x32_bf16 v[252:255], a[220:223], a[188:191], v[252:255]
  buffer_load_dwordx2 v[74:75], v18, s[52:55], s76 offen offset:2048
  v_mfma_f32_16x16x32_bf16 v[252:255], a[216:219], a[184:187], v[252:255]
  s_waitcnt lgkmcnt(6)
  s_mov_b32 s76, 12288
  v_mfma_f32_16x16x32_bf16 a[112:115], a[184:187], a[192:195], a[112:115]
  s_waitcnt lgkmcnt(4)
  v_mfma_f32_16x16x32_bf16 a[112:115], a[188:191], a[196:199], a[112:115]
  buffer_load_dwordx2 v[76:77], v18, s[52:55], s76 offen offset:0
  v_mfma_f32_16x16x32_bf16 a[96:99], a[180:183], a[196:199], a[96:99]
  s_add_u32 m0, s97, 0x14000
  v_mfma_f32_16x16x32_bf16 a[96:99], a[176:179], a[192:195], a[96:99]
  v_mfma_f32_16x16x32_bf16 a[80:83], a[168:171], a[192:195], a[80:83]
  buffer_load_dwordx4 v28, s[12:15], s48 offen offset:0  lds
  v_mfma_f32_16x16x32_bf16 a[80:83], a[172:175], a[196:199], a[80:83]
  v_mfma_f32_16x16x32_bf16 a[64:67], a[164:167], a[196:199], a[64:67]
  ds_read_b64_tr_b16 a[208:209], v40 offset:49152
  v_mfma_f32_16x16x32_bf16 a[64:67], a[160:163], a[192:195], a[64:67]
  ds_read_b64_tr_b16 a[210:211], v40 offset:50176
  v_mfma_f32_16x16x32_bf16 a[48:51], a[152:155], a[192:195], a[48:51]
  ds_read_b64_tr_b16 a[212:213], v40 offset:57344
  v_mfma_f32_16x16x32_bf16 a[48:51], a[156:159], a[196:199], a[48:51]
  ds_read_b64_tr_b16 a[214:215], v40 offset:58368
  v_mfma_f32_16x16x32_bf16 a[32:35], a[148:151], a[196:199], a[32:35]
  buffer_load_dwordx4 v28, s[12:15], s49 offen offset:1024  lds
  v_mfma_f32_16x16x32_bf16 a[32:35], a[144:147], a[192:195], a[32:35]
  v_mfma_f32_16x16x32_bf16 a[16:19], a[136:139], a[192:195], a[16:19]
  v_mfma_f32_16x16x32_bf16 a[16:19], a[140:143], a[196:199], a[16:19]
  v_mfma_f32_16x16x32_bf16 a[0:3], a[132:135], a[196:199], a[0:3]
  v_mfma_f32_16x16x32_bf16 a[0:3], a[128:131], a[192:195], a[0:3]
  s_waitcnt lgkmcnt(6)
  v_mfma_f32_16x16x32_bf16 a[4:7], a[128:131], a[200:203], a[4:7]
  s_waitcnt lgkmcnt(4)
  v_mfma_f32_16x16x32_bf16 a[4:7], a[132:135], a[204:207], a[4:7]
  buffer_load_dwordx4 v29, s[12:15], s50 offen offset:2048  lds
  v_mfma_f32_16x16x32_bf16 a[20:23], a[140:143], a[204:207], a[20:23]
  v_mfma_f32_16x16x32_bf16 a[20:23], a[136:139], a[200:203], a[20:23]
  v_mfma_f32_16x16x32_bf16 a[36:39], a[144:147], a[200:203], a[36:39]
  v_mfma_f32_16x16x32_bf16 a[36:39], a[148:151], a[204:207], a[36:39]
  v_mfma_f32_16x16x32_bf16 a[52:55], a[156:159], a[204:207], a[52:55]
  ds_read_b64_tr_b16 a[216:217], v41 offset:49152
  v_mfma_f32_16x16x32_bf16 a[52:55], a[152:155], a[200:203], a[52:55]
  ds_read_b64_tr_b16 a[218:219], v41 offset:50176
  v_mfma_f32_16x16x32_bf16 a[68:71], a[160:163], a[200:203], a[68:71]
  buffer_load_dwordx4 v29, s[12:15], s51 offen offset:3072  lds
  v_mfma_f32_16x16x32_bf16 a[68:71], a[164:167], a[204:207], a[68:71]
  ds_read_b64_tr_b16 a[220:221], v41 offset:57344
  v_mfma_f32_16x16x32_bf16 a[84:87], a[172:175], a[204:207], a[84:87]
  ds_read_b64_tr_b16 a[222:223], v41 offset:58368
  v_mfma_f32_16x16x32_bf16 a[84:87], a[168:171], a[200:203], a[84:87]
  v_mfma_f32_16x16x32_bf16 a[100:103], a[176:179], a[200:203], a[100:103]
  v_mfma_f32_16x16x32_bf16 a[100:103], a[180:183], a[204:207], a[100:103]
  v_mfma_f32_16x16x32_bf16 a[116:119], a[188:191], a[204:207], a[116:119]
  v_mfma_f32_16x16x32_bf16 a[116:119], a[184:187], a[200:203], a[116:119]
  s_waitcnt lgkmcnt(6)
  buffer_load_dwordx2 v[78:79], v18, s[52:55], s76 offen offset:2048
  v_mfma_f32_16x16x32_bf16 a[120:123], a[184:187], a[208:211], a[120:123]
  s_waitcnt lgkmcnt(4)
  s_mov_b32 s52, s80
  v_mfma_f32_16x16x32_bf16 a[120:123], a[188:191], a[212:215], a[120:123]
L_pad1:
  s_cbranch_execz L_pad5
  s_mov_b32 s53, s81
  v_mfma_f32_16x16x32_bf16 a[104:107], a[180:183], a[212:215], a[104:107]
  s_mov_b32 s54, 0x400000
  v_mfma_f32_16x16x32_bf16 a[104:107], a[176:179], a[208:211], a[104:107]
  s_mov_b32 s76, 0
  v_mfma_f32_16x16x32_bf16 a[88:91], a[168:171], a[208:211], a[88:91]
  buffer_load_dwordx2 v[80:81], v18, s[52:55], s76 offen offset:0
  v_mfma_f32_16x16x32_bf16 a[88:91], a[172:175], a[212:215], a[88:91]
  v_mfma_f32_16x16x32_bf16 a[72:75], a[164:167], a[212:215], a[72:75]
  v_mfma_f32_16x16x32_bf16 a[72:75], a[160:163], a[208:211], a[72:75]
  s_waitcnt vmcnt(11)
  buffer_load_dwordx2 v[82:83], v18, s[52:55], s76 offen offset:2048
  v_mfma_f32_16x16x32_bf16 a[56:59], a[152:155], a[208:211], a[56:59]
  s_barrier
  v_mfma_f32_16x16x32_bf16 a[56:59], a[156:159], a[212:215], a[56:59]
  ds_read_b64_tr_b16 a[192:193], v38 offset:0
  v_xor_b32 v28, 0x80000, v28
  v_mfma_f32_16x16x32_bf16 a[40:43], a[148:151], a[212:215], a[40:43]
  ds_read_b64_tr_b16 a[194:195], v38 offset:1024
  v_xor_b32 v29, 0x80000, v29
  v_mfma_f32_16x16x32_bf16 a[40:43], a[144:147], a[208:211], a[40:43]
  s_add_u32 m0, s97, 0x18000
  ds_read_b64_tr_b16 a[196:197], v38 offset:8192
  v_mfma_f32_16x16x32_bf16 a[24:27], a[136:139], a[208:211], a[24:27]
  buffer_load_dwordx4 v28, s[8:11], s48 offen offset:0  lds
  v_mfma_f32_16x16x32_bf16 a[24:27], a[140:143], a[212:215], a[24:27]
  ds_read_b64_tr_b16 a[198:199], v38 offset:9216
  v_mfma_f32_16x16x32_bf16 a[8:11], a[132:135], a[212:215], a[8:11]
  v_mfma_f32_16x16x32_bf16 a[8:11], a[128:131], a[208:211], a[8:11]
  s_waitcnt lgkmcnt(6)
  v_mfma_f32_16x16x32_bf16 a[12:15], a[128:131], a[216:219], a[12:15]
  s_waitcnt lgkmcnt(4)
  ds_read_b128 a[128:131], v32 offset:0
  v_mfma_f32_16x16x32_bf16 a[12:15], a[132:135], a[220:223], a[12:15]
  buffer_load_dwordx4 v28, s[8:11], s49 offen offset:1024  lds
  v_mfma_f32_16x16x32_bf16 a[28:31], a[140:143], a[220:223], a[28:31]
  ds_read_b128 a[132:135], v33 offset:0
  v_mfma_f32_16x16x32_bf16 a[28:31], a[136:139], a[216:219], a[28:31]
  ds_read_b128 a[140:143], v33 offset:2048
  v_mfma_f32_16x16x32_bf16 a[44:47], a[144:147], a[216:219], a[44:47]
  ds_read_b128 a[136:139], v32 offset:2048
  v_mfma_f32_16x16x32_bf16 a[44:47], a[148:151], a[220:223], a[44:47]
  ds_read_b128 a[144:147], v32 offset:4096
  v_mfma_f32_16x16x32_bf16 a[60:63], a[156:159], a[220:223], a[60:63]
  ds_read_b128 a[148:151], v33 offset:4096
  v_mfma_f32_16x16x32_bf16 a[60:63], a[152:155], a[216:219], a[60:63]
  ds_read_b128 a[156:159], v33 offset:6144
  v_mfma_f32_16x16x32_bf16 a[76:79], a[160:163], a[216:219], a[76:79]
  buffer_load_dwordx4 v29, s[8:11], s50 offen offset:2048  lds
  v_mfma_f32_16x16x32_bf16 a[76:79], a[164:167], a[220:223], a[76:79]
  ds_read_b128 a[152:155], v32 offset:6144
  v_mfma_f32_16x16x32_bf16 a[92:95], a[172:175], a[220:223], a[92:95]
  ds_read_b128 a[160:163], v32 offset:8192
  v_mfma_f32_16x16x32_bf16 a[92:95], a[168:171], a[216:219], a[92:95]
  ds_read_b128 a[164:167], v33 offset:8192
  v_mfma_f32_16x16x32_bf16 a[108:111], a[176:179], a[216:219], a[108:111]
  ds_read_b128 a[172:175], v33 offset:10240
  v_mfma_f32_16x16x32_bf16 a[108:111], a[180:183], a[220:223], a[108:111]
  ds_read_b128 a[168:171], v32 offset:10240
  v_mfma_f32_16x16x32_bf16 a[124:127], a[188:191], a[220:223], a[124:127]
  ds_read_b128 a[176:179], v32 offset:12288
  v_mfma_f32_16x16x32_bf16 a[124:127], a[184:187], a[216:219], a[124:127]
  s_waitcnt lgkmcnt(12)
  buffer_load_dwordx4 v29, s[8:11], s51 offen offset:3072  lds
  v_mfma_f32_16x16x32_bf16 v[128:131], a[192:195], a[128:131], v[128:131]
  s_waitcnt lgkmcnt(11)
  ds_read_b128 a[180:183], v33 offset:12288
  v_mfma_f32_16x16x32_bf16 v[128:131], a[196:199], a[132:135], v[128:131]
  s_waitcnt lgkmcnt(11)
  ds_read_b64_tr_b16 a[200:201], v39 offset:0
  v_mfma_f32_16x16x32_bf16 v[144:147], a[196:199], a[140:143], v[144:147]
  s_waitcnt lgkmcnt(11)
  ds_read_b128 a[188:191], v33 offset:14336
  v_mfma_f32_16x16x32_bf16 v[144:147], a[192:195], a[136:139], v[144:147]
  s_waitcnt lgkmcnt(11)
  s_mov_b32 s76, 4096
  ds_read_b64_tr_b16 a[202:203], v39 offset:1024
  v_mfma_f32_16x16x32_bf16 v[160:163], a[192:195], a[144:147], v[160:163]
  s_waitcnt lgkmcnt(11)
  ds_read_b128 a[184:187], v32 offset:14336
  v_mfma_f32_16x16x32_bf16 v[160:163], a[196:199], a[148:151], v[160:163]
  s_waitcnt lgkmcnt(11)
  ds_read_b64_tr_b16 a[204:205], v39 offset:8192
  v_mfma_f32_16x16x32_bf16 v[176:179], a[196:199], a[156:159], v[176:179]
  s_waitcnt lgkmcnt(11)
  buffer_load_dwordx2 v[84:85], v18, s[52:55], s76 offen offset:0
  v_mfma_f32_16x16x32_bf16 v[176:179], a[192:195], a[152:155], v[176:179]
  s_waitcnt lgkmcnt(10)
  ds_read_b64_tr_b16 a[206:207], v39 offset:9216
  v_mfma_f32_16x16x32_bf16 v[192:195], a[192:195], a[160:163], v[192:195]
  s_waitcnt lgkmcnt(10)
  ds_read_b64_tr_b16 a[208:209], v40 offset:0
  v_mfma_f32_16x16x32_bf16 v[192:195], a[196:199], a[164:167], v[192:195]
  s_waitcnt lgkmcnt(10)
  buffer_load_dwordx2 v[86:87], v18, s[52:55], s76 offen offset:2048
  v_mfma_f32_16x16x32_bf16 v[208:211], a[196:199], a[172:175], v[208:211]
  s_waitcnt lgkmcnt(9)
  ds_read_b64_tr_b16 a[210:211], v40 offset:1024
  v_xor_b32 v24, 0x80, v24
  v_mfma_f32_16x16x32_bf16 v[208:211], a[192:195], a[168:171], v[208:211]
  s_waitcnt lgkmcnt(9)
  ds_read_b64_tr_b16 a[212:213], v40 offset:8192
  v_xor_b32 v25, 0x80, v25
  v_mfma_f32_16x16x32_bf16 v[224:227], a[192:195], a[176:179], v[224:227]
  s_waitcnt lgkmcnt(9)
  s_add_u32 m0, s96, 0x0
  ds_read_b64_tr_b16 a[214:215], v40 offset:9216
  v_mfma_f32_16x16x32_bf16 v[224:227], a[196:199], a[180:183], v[224:227]
  s_waitcnt lgkmcnt(8)
  buffer_load_dwordx4 v24, s[4:7], s32 offen offset:0  lds
  v_mfma_f32_16x16x32_bf16 v[240:243], a[196:199], a[188:191], v[240:243]
  s_waitcnt lgkmcnt(6)
  v_mfma_f32_16x16x32_bf16 v[240:243], a[192:195], a[184:187], v[240:243]
  v_mfma_f32_16x16x32_bf16 v[244:247], a[200:203], a[184:187], v[244:247]
  s_waitcnt lgkmcnt(4)
  v_mfma_f32_16x16x32_bf16 v[244:247], a[204:207], a[188:191], v[244:247]
  v_mfma_f32_16x16x32_bf16 v[228:231], a[204:207], a[180:183], v[228:231]
  v_mfma_f32_16x16x32_bf16 v[228:231], a[200:203], a[176:179], v[228:231]
  v_mfma_f32_16x16x32_bf16 v[212:215], a[200:203], a[168:171], v[212:215]
  buffer_load_dwordx4 v25, s[4:7], s33 offen offset:1024  lds
  v_mfma_f32_16x16x32_bf16 v[212:215], a[204:207], a[172:175], v[212:215]
  v_mfma_f32_16x16x32_bf16 v[196:199], a[204:207], a[164:167], v[196:199]
  ds_read_b64_tr_b16 a[216:217], v41 offset:0
  v_mfma_f32_16x16x32_bf16 v[196:199], a[200:203], a[160:163], v[196:199]
  ds_read_b64_tr_b16 a[218:219], v41 offset:1024
  v_mfma_f32_16x16x32_bf16 v[180:183], a[200:203], a[152:155], v[180:183]
  ds_read_b64_tr_b16 a[220:221], v41 offset:8192
  v_mfma_f32_16x16x32_bf16 v[180:183], a[204:207], a[156:159], v[180:183]
  ds_read_b64_tr_b16 a[222:223], v41 offset:9216
  v_mfma_f32_16x16x32_bf16 v[164:167], a[204:207], a[148:151], v[164:167]
  v_mfma_f32_16x16x32_bf16 v[164:167], a[200:203], a[144:147], v[164:167]
  buffer_load_dwordx4 v24, s[4:7], s34 offen offset:2048  lds
  v_mfma_f32_16x16x32_bf16 v[148:151], a[200:203], a[136:139], v[148:151]
  v_mfma_f32_16x16x32_bf16 v[148:151], a[204:207], a[140:143], v[148:151]
  v_mfma_f32_16x16x32_bf16 v[132:135], a[204:207], a[132:135], v[132:135]
  v_mfma_f32_16x16x32_bf16 v[132:135], a[200:203], a[128:131], v[132:135]
  s_waitcnt lgkmcnt(6)
  v_mfma_f32_16x16x32_bf16 v[136:139], a[208:211], a[128:131], v[136:139]
  s_waitcnt lgkmcnt(4)
  v_mfma_f32_16x16x32_bf16 v[136:139], a[212:215], a[132:135], v[136:139]
  v_mfma_f32_16x16x32_bf16 v[152:155], a[212:215], a[140:143], v[152:155]
  buffer_load_dwordx4 v25, s[4:7], s35 offen offset:3072  lds
  v_mfma_f32_16x16x32_bf16 v[152:155], a[208:211], a[136:139], v[152:155]
  s_add_u32 m0, s96, 0x1000
  v_mfma_f32_16x16x32_bf16 v[168:171], a[208:211], a[144:147], v[168:171]
  v_mfma_f32_16x16x32_bf16 v[168:171], a[212:215], a[148:151], v[168:171]
  buffer_load_dwordx4 v24, s[4:7], s36 offen offset:0  lds
  v_mfma_f32_16x16x32_bf16 v[184:187], a[212:215], a[156:159], v[184:187]
  v_mfma_f32_16x16x32_bf16 v[184:187], a[208:211], a[152:155], v[184:187]
  s_waitcnt vmcnt(14)
  v_mfma_f32_16x16x32_bf16 v[200:203], a[208:211], a[160:163], v[200:203]
  s_barrier
  v_mfma_f32_16x16x32_bf16 v[200:203], a[212:215], a[164:167], v[200:203]
  buffer_load_dwordx4 v25, s[4:7], s37 offen offset:1024  lds
  v_mfma_f32_16x16x32_bf16 v[216:219], a[212:215], a[172:175], v[216:219]
  ds_read_b64_tr_b16 a[192:193], v38 offset:16384
  v_mfma_f32_16x16x32_bf16 v[216:219], a[208:211], a[168:171], v[216:219]
  ds_read_b64_tr_b16 a[194:195], v38 offset:17408
  v_mfma_f32_16x16x32_bf16 v[232:235], a[208:211], a[176:179], v[232:235]
  buffer_load_dwordx4 v24, s[4:7], s38 offen offset:2048  lds
  v_mfma_f32_16x16x32_bf16 v[232:235], a[212:215], a[180:183], v[232:235]
  ds_read_b64_tr_b16 a[196:197], v38 offset:24576
  v_mfma_f32_16x16x32_bf16 v[248:251], a[212:215], a[188:191], v[248:251]
  ds_read_b64_tr_b16 a[198:199], v38 offset:25600
  v_mfma_f32_16x16x32_bf16 v[248:251], a[208:211], a[184:187], v[248:251]
  s_waitcnt lgkmcnt(6)
  buffer_load_dwordx4 v25, s[4:7], s39 offen offset:3072  lds
  v_mfma_f32_16x16x32_bf16 v[252:255], a[216:219], a[184:187], v[252:255]
  s_waitcnt lgkmcnt(4)
  s_mov_b32 s76, 8192
  v_mfma_f32_16x16x32_bf16 v[252:255], a[220:223], a[188:191], v[252:255]
  v_mfma_f32_16x16x32_bf16 v[236:239], a[220:223], a[180:183], v[236:239]
  buffer_load_dwordx2 v[88:89], v18, s[52:55], s76 offen offset:0
  v_mfma_f32_16x16x32_bf16 v[236:239], a[216:219], a[176:179], v[236:239]
  v_mfma_f32_16x16x32_bf16 v[220:223], a[216:219], a[168:171], v[220:223]
  v_mfma_f32_16x16x32_bf16 v[220:223], a[220:223], a[172:175], v[220:223]
  buffer_load_dwordx2 v[90:91], v18, s[52:55], s76 offen offset:2048
  v_mfma_f32_16x16x32_bf16 v[204:207], a[220:223], a[164:167], v[204:207]
  s_mov_b32 s76, 12288
  ds_read_b64_tr_b16 a[200:201], v39 offset:16384
  v_mfma_f32_16x16x32_bf16 v[204:207], a[216:219], a[160:163], v[204:207]
  ds_read_b64_tr_b16 a[202:203], v39 offset:17408
  v_mfma_f32_16x16x32_bf16 v[188:191], a[216:219], a[152:155], v[188:191]
  buffer_load_dwordx2 v[92:93], v18, s[52:55], s76 offen offset:0
  v_mfma_f32_16x16x32_bf16 v[188:191], a[220:223], a[156:159], v[188:191]
  ds_read_b64_tr_b16 a[204:205], v39 offset:24576
  v_mfma_f32_16x16x32_bf16 v[172:175], a[220:223], a[148:151], v[172:175]
  ds_read_b64_tr_b16 a[206:207], v39 offset:25600
  v_mfma_f32_16x16x32_bf16 v[172:175], a[216:219], a[144:147], v[172:175]
  buffer_load_dwordx2 v[94:95], v18, s[52:55], s76 offen offset:2048
  v_mfma_f32_16x16x32_bf16 v[156:159], a[216:219], a[136:139], v[156:159]
  s_mov_b32 s52, s82
  v_mfma_f32_16x16x32_bf16 v[156:159], a[220:223], a[140:143], v[156:159]
  s_mov_b32 s53, s83
  v_mfma_f32_16x16x32_bf16 v[140:143], a[220:223], a[132:135], v[140:143]
  s_mov_b32 s54, 0x2000
  v_mfma_f32_16x16x32_bf16 v[140:143], a[216:219], a[128:131], v[140:143]
  s_waitcnt lgkmcnt(6)
  buffer_load_dwordx4 v[50:53], v19, s[52:55], 0 offen offset:0
  v_mfma_f32_16x16x32_bf16 a[0:3], a[128:131], a[192:195], a[0:3]
  s_waitcnt lgkmcnt(4)
  s_add_u32 m0, s97, 0x1c000
  v_mfma_f32_16x16x32_bf16 a[0:3], a[132:135], a[196:199], a[0:3]
  v_mfma_f32_16x16x32_bf16 a[16:19], a[140:143], a[196:199], a[16:19]
  buffer_load_dwordx4 v28, s[12:15], s48 offen offset:0  lds
  v_mfma_f32_16x16x32_bf16 a[16:19], a[136:139], a[192:195], a[16:19]
  v_mfma_f32_16x16x32_bf16 a[32:35], a[144:147], a[192:195], a[32:35]
  v_mfma_f32_16x16x32_bf16 a[32:35], a[148:151], a[196:199], a[32:35]
  buffer_load_dwordx4 v28, s[12:15], s49 offen offset:1024  lds
  v_mfma_f32_16x16x32_bf16 a[48:51], a[156:159], a[196:199], a[48:51]
  ds_read_b64_tr_b16 a[208:209], v40 offset:16384
  v_mfma_f32_16x16x32_bf16 a[48:51], a[152:155], a[192:195], a[48:51]
  ds_read_b64_tr_b16 a[210:211], v40 offset:17408
  v_mfma_f32_16x16x32_bf16 a[64:67], a[160:163], a[192:195], a[64:67]
  ds_read_b64_tr_b16 a[212:213], v40 offset:24576
  v_mfma_f32_16x16x32_bf16 a[64:67], a[164:167], a[196:199], a[64:67]
  ds_read_b64_tr_b16 a[214:215], v40 offset:25600
  v_mfma_f32_16x16x32_bf16 a[80:83], a[172:175], a[196:199], a[80:83]
  v_mfma_f32_16x16x32_bf16 a[80:83], a[168:171], a[192:195], a[80:83]
  v_mfma_f32_16x16x32_bf16 a[96:99], a[176:179], a[192:195], a[96:99]
  buffer_load_dwordx4 v29, s[12:15], s50 offen offset:2048  lds
  v_mfma_f32_16x16x32_bf16 a[96:99], a[180:183], a[196:199], a[96:99]
  v_mfma_f32_16x16x32_bf16 a[112:115], a[188:191], a[196:199], a[112:115]
  v_mfma_f32_16x16x32_bf16 a[112:115], a[184:187], a[192:195], a[112:115]
  s_waitcnt lgkmcnt(6)
  v_mfma_f32_16x16x32_bf16 a[116:119], a[184:187], a[200:203], a[116:119]
  s_waitcnt lgkmcnt(4)
  v_mfma_f32_16x16x32_bf16 a[116:119], a[188:191], a[204:207], a[116:119]
  v_mfma_f32_16x16x32_bf16 a[100:103], a[180:183], a[204:207], a[100:103]
  v_mfma_f32_16x16x32_bf16 a[100:103], a[176:179], a[200:203], a[100:103]
  buffer_load_dwordx4 v29, s[12:15], s51 offen offset:3072  lds
  v_mfma_f32_16x16x32_bf16 a[84:87], a[168:171], a[200:203], a[84:87]
  v_mfma_f32_16x16x32_bf16 a[84:87], a[172:175], a[204:207], a[84:87]
  v_mfma_f32_16x16x32_bf16 a[68:71], a[164:167], a[204:207], a[68:71]
  ds_read_b64_tr_b16 a[216:217], v41 offset:16384
  v_mfma_f32_16x16x32_bf16 a[68:71], a[160:163], a[200:203], a[68:71]
  ds_read_b64_tr_b16 a[218:219], v41 offset:17408
  v_mfma_f32_16x16x32_bf16 a[52:55], a[152:155], a[200:203], a[52:55]
  ds_read_b64_tr_b16 a[220:221], v41 offset:24576
  v_mfma_f32_16x16x32_bf16 a[52:55], a[156:159], a[204:207], a[52:55]
  ds_read_b64_tr_b16 a[222:223], v41 offset:25600
  v_mfma_f32_16x16x32_bf16 a[36:39], a[148:151], a[204:207], a[36:39]
  buffer_load_dwordx4 v[54:57], v19, s[52:55], 0 offen offset:16
  v_mfma_f32_16x16x32_bf16 a[36:39], a[144:147], a[200:203], a[36:39]
  s_mov_b32 s52, s92
  v_mfma_f32_16x16x32_bf16 a[20:23], a[136:139], a[200:203], a[20:23]
  s_mov_b32 s53, s93
  v_mfma_f32_16x16x32_bf16 a[20:23], a[140:143], a[204:207], a[20:23]
  s_mov_b32 s54, 0x100
  v_mfma_f32_16x16x32_bf16 a[4:7], a[132:135], a[204:207], a[4:7]
  s_lshl_b32 s76, s29, 2
  v_mfma_f32_16x16x32_bf16 a[4:7], a[128:131], a[200:203], a[4:7]
  s_waitcnt lgkmcnt(6)
  s_cmp_eq_u32 s30, 7
  s_cselect_b32 s76, s76, 0x1000
  v_mfma_f32_16x16x32_bf16 a[8:11], a[128:131], a[208:211], a[8:11]
  s_waitcnt lgkmcnt(4)
  buffer_store_dword v9, v8, s[52:55], s76 offen sc1
  v_mfma_f32_16x16x32_bf16 a[8:11], a[132:135], a[212:215], a[8:11]
  v_xor_b32 v24, 0x380, v24
  v_mfma_f32_16x16x32_bf16 a[24:27], a[140:143], a[212:215], a[24:27]
  v_xor_b32 v25, 0x380, v25
  v_mfma_f32_16x16x32_bf16 a[24:27], a[136:139], a[208:211], a[24:27]
  s_add_u32 m0, s96, 0x8000
  v_mfma_f32_16x16x32_bf16 a[40:43], a[144:147], a[208:211], a[40:43]
  buffer_load_dwordx4 v24, s[4:7], s32 offen offset:0  lds
  v_mfma_f32_16x16x32_bf16 a[40:43], a[148:151], a[212:215], a[40:43]
  v_mfma_f32_16x16x32_bf16 a[56:59], a[156:159], a[212:215], a[56:59]
  v_mfma_f32_16x16x32_bf16 a[56:59], a[152:155], a[208:211], a[56:59]
  s_waitcnt vmcnt(12)
  buffer_load_dwordx4 v25, s[4:7], s33 offen offset:1024  lds
  v_mfma_f32_16x16x32_bf16 a[72:75], a[160:163], a[208:211], a[72:75]
  s_barrier
  v_mfma_f32_16x16x32_bf16 a[72:75], a[164:167], a[212:215], a[72:75]
  ds_read_b64_tr_b16 a[192:193], v38 offset:32768
  v_mfma_f32_16x16x32_bf16 a[88:91], a[172:175], a[212:215], a[88:91]
  ds_read_b64_tr_b16 a[194:195], v38 offset:33792
  v_mfma_f32_16x16x32_bf16 a[88:91], a[168:171], a[208:211], a[88:91]
  buffer_load_dwordx4 v24, s[4:7], s34 offen offset:2048  lds
  v_mfma_f32_16x16x32_bf16 a[104:107], a[176:179], a[208:211], a[104:107]
  ds_read_b64_tr_b16 a[196:197], v38 offset:40960
  v_mfma_f32_16x16x32_bf16 a[104:107], a[180:183], a[212:215], a[104:107]
  ds_read_b64_tr_b16 a[198:199], v38 offset:41984
  v_mfma_f32_16x16x32_bf16 a[120:123], a[188:191], a[212:215], a[120:123]
  v_mfma_f32_16x16x32_bf16 a[120:123], a[184:187], a[208:211], a[120:123]
  s_waitcnt lgkmcnt(6)
  v_mfma_f32_16x16x32_bf16 a[124:127], a[184:187], a[216:219], a[124:127]
  s_waitcnt lgkmcnt(4)
  ds_read_b128 a[184:187], v30 offset:14336
  v_mfma_f32_16x16x32_bf16 a[124:127], a[188:191], a[220:223], a[124:127]
  ds_read_b128 a[188:191], v31 offset:14336
  v_mfma_f32_16x16x32_bf16 a[108:111], a[180:183], a[220:223], a[108:111]
  buffer_load_dwordx4 v25, s[4:7], s35 offen offset:3072  lds
  v_mfma_f32_16x16x32_bf16 a[108:111], a[176:179], a[216:219], a[108:111]
  ds_read_b128 a[180:183], v31 offset:12288
  v_mfma_f32_16x16x32_bf16 a[92:95], a[168:171], a[216:219], a[92:95]
  ds_read_b128 a[176:179], v30 offset:12288
  v_xor_b32 v28, 0x380000, v28
  v_mfma_f32_16x16x32_bf16 a[92:95], a[172:175], a[220:223], a[92:95]
  ds_read_b128 a[168:171], v30 offset:10240
  v_xor_b32 v29, 0x380000, v29
  v_mfma_f32_16x16x32_bf16 a[76:79], a[164:167], a[220:223], a[76:79]
  s_add_u32 m0, s97, 0x10000
  ds_read_b128 a[172:175], v31 offset:10240
  v_mfma_f32_16x16x32_bf16 a[76:79], a[160:163], a[216:219], a[76:79]
  ds_read_b128 a[164:167], v31 offset:8192
  v_mfma_f32_16x16x32_bf16 a[60:63], a[152:155], a[216:219], a[60:63]
  ds_read_b128 a[160:163], v30 offset:8192
  v_mfma_f32_16x16x32_bf16 a[60:63], a[156:159], a[220:223], a[60:63]
  buffer_load_dwordx4 v28, s[8:11], s48 offen offset:0  lds
  v_mfma_f32_16x16x32_bf16 a[44:47], a[148:151], a[220:223], a[44:47]
  ds_read_b128 a[152:155], v30 offset:6144
  v_mfma_f32_16x16x32_bf16 a[44:47], a[144:147], a[216:219], a[44:47]
  ds_read_b128 a[156:159], v31 offset:6144
  v_mfma_f32_16x16x32_bf16 a[28:31], a[136:139], a[216:219], a[28:31]
  ds_read_b128 a[148:151], v31 offset:4096
  v_mfma_f32_16x16x32_bf16 a[28:31], a[140:143], a[220:223], a[28:31]
  ds_read_b128 a[144:147], v30 offset:4096
  v_mfma_f32_16x16x32_bf16 a[12:15], a[132:135], a[220:223], a[12:15]
  ds_read_b128 a[136:139], v30 offset:2048
  v_mfma_f32_16x16x32_bf16 a[12:15], a[128:131], a[216:219], a[12:15]
  s_waitcnt lgkmcnt(12)
  ds_read_b128 a[140:143], v31 offset:2048
  v_mfma_f32_16x16x32_bf16 v[240:243], a[192:195], a[184:187], v[240:243]
  s_waitcnt lgkmcnt(12)
  buffer_load_dwordx4 v28, s[8:11], s49 offen offset:1024  lds
  v_mfma_f32_16x16x32_bf16 v[240:243], a[196:199], a[188:191], v[240:243]
  s_waitcnt lgkmcnt(11)
  ds_read_b64_tr_b16 a[200:201], v39 offset:32768
  v_mfma_f32_16x16x32_bf16 v[224:227], a[196:199], a[180:183], v[224:227]
  s_waitcnt lgkmcnt(11)
  ds_read_b128 a[132:135], v31 offset:0
  v_mfma_f32_16x16x32_bf16 v[224:227], a[192:195], a[176:179], v[224:227]
  s_waitcnt lgkmcnt(11)
  ds_read_b64_tr_b16 a[202:203], v39 offset:33792
  v_mfma_f32_16x16x32_bf16 v[208:211], a[192:195], a[168:171], v[208:211]
  s_waitcnt lgkmcnt(11)
  ds_read_b128 a[128:131], v30 offset:0
  v_mfma_f32_16x16x32_bf16 v[208:211], a[196:199], a[172:175], v[208:211]
  s_waitcnt lgkmcnt(11)
  ds_read_b64_tr_b16 a[204:205], v39 offset:40960
  v_mfma_f32_16x16x32_bf16 v[192:195], a[196:199], a[164:167], v[192:195]
  s_waitcnt lgkmcnt(11)
  ds_read_b64_tr_b16 a[206:207], v39 offset:41984
  v_mfma_f32_16x16x32_bf16 v[192:195], a[192:195], a[160:163], v[192:195]
  s_waitcnt lgkmcnt(11)
  buffer_load_dwordx4 v29, s[8:11], s50 offen offset:2048  lds
  v_mfma_f32_16x16x32_bf16 v[176:179], a[192:195], a[152:155], v[176:179]
  s_waitcnt lgkmcnt(10)
  ds_read_b64_tr_b16 a[208:209], v40 offset:32768
  v_mfma_f32_16x16x32_bf16 v[176:179], a[196:199], a[156:159], v[176:179]
  s_waitcnt lgkmcnt(10)
  ds_read_b64_tr_b16 a[210:211], v40 offset:33792
  v_mfma_f32_16x16x32_bf16 v[160:163], a[196:199], a[148:151], v[160:163]
  s_waitcnt lgkmcnt(10)
  ds_read_b64_tr_b16 a[212:213], v40 offset:40960
  v_mfma_f32_16x16x32_bf16 v[160:163], a[192:195], a[144:147], v[160:163]
  s_waitcnt lgkmcnt(10)
  ds_read_b64_tr_b16 a[214:215], v40 offset:41984
  v_mfma_f32_16x16x32_bf16 v[144:147], a[192:195], a[136:139], v[144:147]
  s_waitcnt lgkmcnt(10)
  v_mfma_f32_16x16x32_bf16 v[144:147], a[196:199], a[140:143], v[144:147]
  s_waitcnt lgkmcnt(8)
  v_mfma_f32_16x16x32_bf16 v[128:131], a[196:199], a[132:135], v[128:131]
  s_waitcnt lgkmcnt(6)
  buffer_load_dwordx4 v29, s[8:11], s51 offen offset:3072  lds
  v_mfma_f32_16x16x32_bf16 v[128:131], a[192:195], a[128:131], v[128:131]
  v_mfma_f32_16x16x32_bf16 v[132:135], a[200:203], a[128:131], v[132:135]
  s_waitcnt lgkmcnt(4)
  v_mfma_f32_16x16x32_bf16 v[132:135], a[204:207], a[132:135], v[132:135]
  v_mfma_f32_16x16x32_bf16 v[148:151], a[204:207], a[140:143], v[148:151]
  s_add_u32 m0, s96, 0x9000
  v_mfma_f32_16x16x32_bf16 v[148:151], a[200:203], a[136:139], v[148:151]
  v_mfma_f32_16x16x32_bf16 v[164:167], a[200:203], a[144:147], v[164:167]
  v_mfma_f32_16x16x32_bf16 v[164:167], a[204:207], a[148:151], v[164:167]
  buffer_load_dwordx4 v24, s[4:7], s36 offen offset:0  lds
  v_mfma_f32_16x16x32_bf16 v[180:183], a[204:207], a[156:159], v[180:183]
  s_waitcnt vmcnt(15)
  ds_read_b64_tr_b16 a[216:217], v41 offset:32768
  v_lshlrev_b32 v98, 16, v50
  v_mfma_f32_16x16x32_bf16 v[180:183], a[200:203], a[152:155], v[180:183]
  ds_read_b64_tr_b16 a[218:219], v41 offset:33792
  v_and_b32 v99, s101, v50
  v_mfma_f32_16x16x32_bf16 v[196:199], a[200:203], a[160:163], v[196:199]
  ds_read_b64_tr_b16 a[220:221], v41 offset:40960
  v_lshlrev_b32 v100, 16, v51
  v_mfma_f32_16x16x32_bf16 v[196:199], a[204:207], a[164:167], v[196:199]
  ds_read_b64_tr_b16 a[222:223], v41 offset:41984
  v_and_b32 v101, s101, v51
  v_mfma_f32_16x16x32_bf16 v[212:215], a[204:207], a[172:175], v[212:215]
  v_lshlrev_b32 v104, 16, v58
  v_lshlrev_b32 v105, 16, v60
  v_mfma_f32_16x16x32_bf16 v[212:215], a[200:203], a[168:171], v[212:215]
  v_lshlrev_b32 v106, 16, v62
  v_lshlrev_b32 v107, 16, v64
  v_mfma_f32_16x16x32_bf16 v[228:231], a[200:203], a[176:179], v[228:231]
  buffer_load_dwordx4 v25, s[4:7], s37 offen offset:1024  lds
  v_mfma_f32_16x16x32_bf16 v[228:231], a[204:207], a[180:183], v[228:231]
  v_lshlrev_b32 v108, 16, v66
  v_lshlrev_b32 v109, 16, v68
  v_mfma_f32_16x16x32_bf16 v[244:247], a[204:207], a[188:191], v[244:247]
  v_lshlrev_b32 v110, 16, v70
  v_lshlrev_b32 v111, 16, v72
  v_mfma_f32_16x16x32_bf16 v[244:247], a[200:203], a[184:187], v[244:247]
  s_waitcnt lgkmcnt(6)
  v_lshlrev_b32 v112, 16, v74
  v_lshlrev_b32 v113, 16, v76
  v_mfma_f32_16x16x32_bf16 v[248:251], a[208:211], a[184:187], v[248:251]
  s_waitcnt lgkmcnt(4)
  v_lshlrev_b32 v114, 16, v78
  v_mul_f32 v115, v101, v104
  v_mfma_f32_16x16x32_bf16 v[248:251], a[212:215], a[188:191], v[248:251]
  v_mul_f32 v116, v101, v105
  v_mul_f32 v117, v101, v106
  v_mfma_f32_16x16x32_bf16 v[232:235], a[212:215], a[180:183], v[232:235]
  v_mul_f32 v118, v101, v107
  v_mul_f32 v119, v101, v108
  v_mfma_f32_16x16x32_bf16 v[232:235], a[208:211], a[176:179], v[232:235]
  buffer_load_dwordx4 v24, s[4:7], s38 offen offset:2048  lds
  v_mfma_f32_16x16x32_bf16 v[216:219], a[208:211], a[168:171], v[216:219]
  v_mul_f32 v120, v101, v109
  v_mul_f32 v121, v101, v110
  v_mfma_f32_16x16x32_bf16 v[216:219], a[212:215], a[172:175], v[216:219]
  v_mul_f32 v122, v101, v111
  v_fmac_f32 v115, v100, v105
  v_mfma_f32_16x16x32_bf16 v[200:203], a[212:215], a[164:167], v[200:203]
  v_fmac_f32 v116, v100, v106
  v_fmac_f32 v117, v100, v107
  v_mfma_f32_16x16x32_bf16 v[200:203], a[208:211], a[160:163], v[200:203]
  s_waitcnt vmcnt(13)
  v_fmac_f32 v118, v100, v108
  v_fmac_f32 v119, v100, v109
  v_mfma_f32_16x16x32_bf16 v[184:187], a[208:211], a[152:155], v[184:187]
  s_barrier
  v_mfma_f32_16x16x32_bf16 v[184:187], a[212:215], a[156:159], v[184:187]
  ds_read_b64_tr_b16 a[192:193], v38 offset:49152
  v_fmac_f32 v120, v100, v110
  v_mfma_f32_16x16x32_bf16 v[168:171], a[212:215], a[148:151], v[168:171]
  buffer_load_dwordx4 v25, s[4:7], s39 offen offset:3072  lds
  v_mfma_f32_16x16x32_bf16 v[168:171], a[208:211], a[144:147], v[168:171]
  ds_read_b64_tr_b16 a[194:195], v38 offset:50176
  v_fmac_f32 v121, v100, v111
  v_mfma_f32_16x16x32_bf16 v[152:155], a[208:211], a[136:139], v[152:155]
  ds_read_b64_tr_b16 a[196:197], v38 offset:57344
  v_fmac_f32 v122, v100, v112
  v_mfma_f32_16x16x32_bf16 v[152:155], a[212:215], a[140:143], v[152:155]
  ds_read_b64_tr_b16 a[198:199], v38 offset:58368
  v_fmac_f32 v115, v99, v106
  v_mfma_f32_16x16x32_bf16 v[136:139], a[212:215], a[132:135], v[136:139]
  s_add_u32 m0, s97, 0x14000
  v_fmac_f32 v116, v99, v107
  v_fmac_f32 v117, v99, v108
  v_mfma_f32_16x16x32_bf16 v[136:139], a[208:211], a[128:131], v[136:139]
  s_waitcnt lgkmcnt(6)
  v_fmac_f32 v118, v99, v109
  v_fmac_f32 v119, v99, v110
  v_mfma_f32_16x16x32_bf16 v[140:143], a[216:219], a[128:131], v[140:143]
  s_waitcnt lgkmcnt(4)
  v_fmac_f32 v120, v99, v111
  v_fmac_f32 v121, v99, v112
  v_mfma_f32_16x16x32_bf16 v[140:143], a[220:223], a[132:135], v[140:143]
  buffer_load_dwordx4 v28, s[12:15], s48 offen offset:0  lds
  v_mfma_f32_16x16x32_bf16 v[156:159], a[220:223], a[140:143], v[156:159]
  v_fmac_f32 v122, v99, v113
  v_fmac_f32 v115, v98, v107
  v_mfma_f32_16x16x32_bf16 v[156:159], a[216:219], a[136:139], v[156:159]
  v_fmac_f32 v116, v98, v108
  v_fmac_f32 v117, v98, v109
  v_mfma_f32_16x16x32_bf16 v[172:175], a[216:219], a[144:147], v[172:175]
  v_fmac_f32 v118, v98, v110
  v_fmac_f32 v119, v98, v111
  v_mfma_f32_16x16x32_bf16 v[172:175], a[220:223], a[148:151], v[172:175]
  v_fmac_f32 v120, v98, v112
  v_fmac_f32 v121, v98, v113
  v_mfma_f32_16x16x32_bf16 v[188:191], a[220:223], a[156:159], v[188:191]
  ds_read_b64_tr_b16 a[200:201], v39 offset:49152
  v_fmac_f32 v122, v98, v114
  v_mfma_f32_16x16x32_bf16 v[188:191], a[216:219], a[152:155], v[188:191]
  ds_read_b64_tr_b16 a[202:203], v39 offset:50176
  v_lshlrev_b32 v104, 16, v80
  v_mfma_f32_16x16x32_bf16 v[204:207], a[216:219], a[160:163], v[204:207]
  buffer_load_dwordx4 v28, s[12:15], s49 offen offset:1024  lds
  v_mfma_f32_16x16x32_bf16 v[204:207], a[220:223], a[164:167], v[204:207]
  ds_read_b64_tr_b16 a[204:205], v39 offset:57344
  v_lshlrev_b32 v105, 16, v82
  v_mfma_f32_16x16x32_bf16 v[220:223], a[220:223], a[172:175], v[220:223]
  ds_read_b64_tr_b16 a[206:207], v39 offset:58368
  v_lshlrev_b32 v106, 16, v84
  v_mfma_f32_16x16x32_bf16 v[220:223], a[216:219], a[168:171], v[220:223]
  v_lshlrev_b32 v107, 16, v86
  v_lshlrev_b32 v108, 16, v88
  v_mfma_f32_16x16x32_bf16 v[236:239], a[216:219], a[176:179], v[236:239]
  v_lshlrev_b32 v109, 16, v90
  v_lshlrev_b32 v110, 16, v92
  v_mfma_f32_16x16x32_bf16 v[236:239], a[220:223], a[180:183], v[236:239]
  v_lshlrev_b32 v111, 16, v94
  v_mul_f32 v115, v115, v104
  v_mfma_f32_16x16x32_bf16 v[252:255], a[220:223], a[188:191], v[252:255]
  v_mul_f32 v116, v116, v105
  v_mul_f32 v117, v117, v106
  v_mfma_f32_16x16x32_bf16 v[252:255], a[216:219], a[184:187], v[252:255]
  s_waitcnt lgkmcnt(6)
  buffer_load_dwordx4 v29, s[12:15], s50 offen offset:2048  lds
  v_mfma_f32_16x16x32_bf16 a[112:115], a[184:187], a[192:195], a[112:115]
  s_waitcnt lgkmcnt(4)
  v_mul_f32 v118, v118, v107
  v_mul_f32 v119, v119, v108
  v_mfma_f32_16x16x32_bf16 a[112:115], a[188:191], a[196:199], a[112:115]
  v_mul_f32 v120, v120, v109
  v_mul_f32 v121, v121, v110
  v_mfma_f32_16x16x32_bf16 a[96:99], a[180:183], a[196:199], a[96:99]
  v_mul_f32 v122, v122, v111
  v_cvt_pk_bf16_f32 v124, v122, v121
  v_mfma_f32_16x16x32_bf16 a[96:99], a[176:179], a[192:195], a[96:99]
  v_cvt_pk_bf16_f32 v125, v120, v119
  v_cvt_pk_bf16_f32 v126, v118, v117
  v_mfma_f32_16x16x32_bf16 a[80:83], a[168:171], a[192:195], a[80:83]
  v_cvt_pk_bf16_f32 v127, v116, v115
  v_accvgpr_write_b32 a224, v124
  v_mfma_f32_16x16x32_bf16 a[80:83], a[172:175], a[196:199], a[80:83]
  v_accvgpr_write_b32 a225, v125
  v_accvgpr_write_b32 a226, v126
  v_mfma_f32_16x16x32_bf16 a[64:67], a[164:167], a[196:199], a[64:67]
  buffer_load_dwordx4 v29, s[12:15], s51 offen offset:3072  lds
  v_mfma_f32_16x16x32_bf16 a[64:67], a[160:163], a[192:195], a[64:67]
  ds_read_b64_tr_b16 a[208:209], v40 offset:49152
  v_accvgpr_write_b32 a227, v127
  v_mfma_f32_16x16x32_bf16 a[48:51], a[152:155], a[192:195], a[48:51]
  ds_read_b64_tr_b16 a[210:211], v40 offset:50176
  v_xor_b32 v24, 0x80, v24
  v_mfma_f32_16x16x32_bf16 a[48:51], a[156:159], a[196:199], a[48:51]
  ds_read_b64_tr_b16 a[212:213], v40 offset:57344
  v_xor_b32 v25, 0x80, v25
  v_mfma_f32_16x16x32_bf16 a[32:35], a[148:151], a[196:199], a[32:35]
  s_add_u32 m0, s96, 0x20000
  ds_read_b64_tr_b16 a[214:215], v40 offset:58368
  v_mfma_f32_16x16x32_bf16 a[32:35], a[144:147], a[192:195], a[32:35]
  v_lshlrev_b32 v98, 16, v52
  v_and_b32 v99, s101, v52
  v_mfma_f32_16x16x32_bf16 a[16:19], a[136:139], a[192:195], a[16:19]
  v_lshlrev_b32 v100, 16, v53
  v_and_b32 v101, s101, v53
  v_mfma_f32_16x16x32_bf16 a[16:19], a[140:143], a[196:199], a[16:19]
  buffer_load_dwordx4 v24, s[4:7], s32 offen offset:0  lds
  v_mfma_f32_16x16x32_bf16 a[0:3], a[132:135], a[196:199], a[0:3]
  v_and_b32 v104, s101, v58
  v_and_b32 v105, s101, v60
  v_mfma_f32_16x16x32_bf16 a[0:3], a[128:131], a[192:195], a[0:3]
  s_waitcnt lgkmcnt(6)
  v_and_b32 v106, s101, v62
  v_and_b32 v107, s101, v64
  v_mfma_f32_16x16x32_bf16 a[4:7], a[128:131], a[200:203], a[4:7]
  s_waitcnt lgkmcnt(4)
  v_and_b32 v108, s101, v66
  v_and_b32 v109, s101, v68
  v_mfma_f32_16x16x32_bf16 a[4:7], a[132:135], a[204:207], a[4:7]
  v_and_b32 v110, s101, v70
  v_and_b32 v111, s101, v72
  v_mfma_f32_16x16x32_bf16 a[20:23], a[140:143], a[204:207], a[20:23]
  v_and_b32 v112, s101, v74
  v_and_b32 v113, s101, v76
  v_mfma_f32_16x16x32_bf16 a[20:23], a[136:139], a[200:203], a[20:23]
  v_and_b32 v114, s101, v78
  v_mul_f32 v115, v101, v104
  v_mfma_f32_16x16x32_bf16 a[36:39], a[144:147], a[200:203], a[36:39]
  buffer_load_dwordx4 v25, s[4:7], s33 offen offset:1024  lds
  v_mfma_f32_16x16x32_bf16 a[36:39], a[148:151], a[204:207], a[36:39]
  v_mul_f32 v116, v101, v105
  v_mul_f32 v117, v101, v106
  v_mfma_f32_16x16x32_bf16 a[52:55], a[156:159], a[204:207], a[52:55]
  ds_read_b64_tr_b16 a[216:217], v41 offset:49152
  v_mul_f32 v118, v101, v107
  v_mfma_f32_16x16x32_bf16 a[52:55], a[152:155], a[200:203], a[52:55]
  ds_read_b64_tr_b16 a[218:219], v41 offset:50176
  v_mul_f32 v119, v101, v108
  v_mfma_f32_16x16x32_bf16 a[68:71], a[160:163], a[200:203], a[68:71]
  ds_read_b64_tr_b16 a[220:221], v41 offset:57344
  v_mul_f32 v120, v101, v109
  v_mfma_f32_16x16x32_bf16 a[68:71], a[164:167], a[204:207], a[68:71]
  ds_read_b64_tr_b16 a[222:223], v41 offset:58368
  v_mul_f32 v121, v101, v110
  v_mfma_f32_16x16x32_bf16 a[84:87], a[172:175], a[204:207], a[84:87]
  v_mul_f32 v122, v101, v111
  v_fmac_f32 v115, v100, v105
  v_mfma_f32_16x16x32_bf16 a[84:87], a[168:171], a[200:203], a[84:87]
  buffer_load_dwordx4 v24, s[4:7], s34 offen offset:2048  lds
  v_mfma_f32_16x16x32_bf16 a[100:103], a[176:179], a[200:203], a[100:103]
  v_fmac_f32 v116, v100, v106
  v_fmac_f32 v117, v100, v107
  v_mfma_f32_16x16x32_bf16 a[100:103], a[180:183], a[204:207], a[100:103]
  v_fmac_f32 v118, v100, v108
  v_fmac_f32 v119, v100, v109
  v_mfma_f32_16x16x32_bf16 a[116:119], a[188:191], a[204:207], a[116:119]
  v_fmac_f32 v120, v100, v110
  v_fmac_f32 v121, v100, v111
  v_mfma_f32_16x16x32_bf16 a[116:119], a[184:187], a[200:203], a[116:119]
L_pad2:
  s_cbranch_execz L_pad6
  s_waitcnt lgkmcnt(6)
  v_fmac_f32 v122, v100, v112
  v_fmac_f32 v115, v99, v106
  v_mfma_f32_16x16x32_bf16 a[120:123], a[184:187], a[208:211], a[120:123]
  s_waitcnt lgkmcnt(4)
  v_fmac_f32 v116, v99, v107
  v_fmac_f32 v117, v99, v108
  v_mfma_f32_16x16x32_bf16 a[120:123], a[188:191], a[212:215], a[120:123]
  v_fmac_f32 v118, v99, v109
  v_fmac_f32 v119, v99, v110
  v_mfma_f32_16x16x32_bf16 a[104:107], a[180:183], a[212:215], a[104:107]
  buffer_load_dwordx4 v25, s[4:7], s35 offen offset:3072  lds
  v_mfma_f32_16x16x32_bf16 a[104:107], a[176:179], a[208:211], a[104:107]
  v_fmac_f32 v120, v99, v111
  v_fmac_f32 v121, v99, v112
  v_mfma_f32_16x16x32_bf16 a[88:91], a[168:171], a[208:211], a[88:91]
  v_fmac_f32 v122, v99, v113
  v_fmac_f32 v115, v98, v107
  v_mfma_f32_16x16x32_bf16 a[88:91], a[172:175], a[212:215], a[88:91]
  v_fmac_f32 v116, v98, v108
  v_fmac_f32 v117, v98, v109
  v_mfma_f32_16x16x32_bf16 a[72:75], a[164:167], a[212:215], a[72:75]
  v_fmac_f32 v118, v98, v110
  v_fmac_f32 v119, v98, v111
  v_mfma_f32_16x16x32_bf16 a[72:75], a[160:163], a[208:211], a[72:75]
  s_waitcnt vmcnt(8)
  v_fmac_f32 v120, v98, v112
  v_fmac_f32 v121, v98, v113
  v_mfma_f32_16x16x32_bf16 a[56:59], a[152:155], a[208:211], a[56:59]
  s_barrier
  v_mfma_f32_16x16x32_bf16 a[56:59], a[156:159], a[212:215], a[56:59]
  ds_read_b64_tr_b16 a[192:193], v38 offset:0
  v_xor_b32 v28, 0x80000, v28
  v_mfma_f32_16x16x32_bf16 a[40:43], a[148:151], a[212:215], a[40:43]
  ds_read_b64_tr_b16 a[194:195], v38 offset:1024
  v_xor_b32 v29, 0x80000, v29
  v_mfma_f32_16x16x32_bf16 a[40:43], a[144:147], a[208:211], a[40:43]
  s_add_u32 m0, s97, 0x18000
  ds_read_b64_tr_b16 a[196:197], v38 offset:8192
  v_fmac_f32 v122, v98, v114
  v_mfma_f32_16x16x32_bf16 a[24:27], a[136:139], a[208:211], a[24:27]
  buffer_load_dwordx4 v28, s[8:11], s48 offen offset:0  lds
  v_mfma_f32_16x16x32_bf16 a[24:27], a[140:143], a[212:215], a[24:27]
  ds_read_b64_tr_b16 a[198:199], v38 offset:9216
  v_and_b32 v104, s101, v80
  v_mfma_f32_16x16x32_bf16 a[8:11], a[132:135], a[212:215], a[8:11]
  v_and_b32 v105, s101, v82
  v_and_b32 v106, s101, v84
  v_mfma_f32_16x16x32_bf16 a[8:11], a[128:131], a[208:211], a[8:11]
  s_waitcnt lgkmcnt(6)
  v_and_b32 v107, s101, v86
  v_and_b32 v108, s101, v88
  v_mfma_f32_16x16x32_bf16 a[12:15], a[128:131], a[216:219], a[12:15]
  s_waitcnt lgkmcnt(4)
  buffer_load_dwordx4 v28, s[8:11], s49 offen offset:1024  lds
  v_mfma_f32_16x16x32_bf16 a[12:15], a[132:135], a[220:223], a[12:15]
  ds_read_b128 a[128:131], v30 offset:32768
  v_and_b32 v109, s101, v90
  v_mfma_f32_16x16x32_bf16 a[28:31], a[140:143], a[220:223], a[28:31]
  ds_read_b128 a[132:135], v31 offset:32768
  v_and_b32 v110, s101, v92
  v_mfma_f32_16x16x32_bf16 a[28:31], a[136:139], a[216:219], a[28:31]
  ds_read_b128 a[140:143], v31 offset:34816
  v_and_b32 v111, s101, v94
  v_mfma_f32_16x16x32_bf16 a[44:47], a[144:147], a[216:219], a[44:47]
  ds_read_b128 a[136:139], v30 offset:34816
  v_mul_f32 v115, v115, v104
  v_mfma_f32_16x16x32_bf16 a[44:47], a[148:151], a[220:223], a[44:47]
  ds_read_b128 a[144:147], v30 offset:36864
  v_mul_f32 v116, v116, v105
  v_mfma_f32_16x16x32_bf16 a[60:63], a[156:159], a[220:223], a[60:63]
  ds_read_b128 a[148:151], v31 offset:36864
  v_mul_f32 v117, v117, v106
  v_mfma_f32_16x16x32_bf16 a[60:63], a[152:155], a[216:219], a[60:63]
  buffer_load_dwordx4 v29, s[8:11], s50 offen offset:2048  lds
  v_mfma_f32_16x16x32_bf16 a[76:79], a[160:163], a[216:219], a[76:79]
  ds_read_b128 a[156:159], v31 offset:38912
  v_mul_f32 v118, v118, v107
  v_mfma_f32_16x16x32_bf16 a[76:79], a[164:167], a[220:223], a[76:79]
  ds_read_b128 a[152:155], v30 offset:38912
  v_mul_f32 v119, v119, v108
  v_mfma_f32_16x16x32_bf16 a[92:95], a[172:175], a[220:223], a[92:95]
  ds_read_b128 a[160:163], v30 offset:40960
  v_mul_f32 v120, v120, v109
  v_mfma_f32_16x16x32_bf16 a[92:95], a[168:171], a[216:219], a[92:95]
  ds_read_b128 a[164:167], v31 offset:40960
  v_mul_f32 v121, v121, v110
  v_mfma_f32_16x16x32_bf16 a[108:111], a[176:179], a[216:219], a[108:111]
  ds_read_b128 a[172:175], v31 offset:43008
  v_mul_f32 v122, v122, v111
  v_mfma_f32_16x16x32_bf16 a[108:111], a[180:183], a[220:223], a[108:111]
  ds_read_b128 a[168:171], v30 offset:43008
  v_cvt_pk_bf16_f32 v124, v122, v121
  v_mfma_f32_16x16x32_bf16 a[124:127], a[188:191], a[220:223], a[124:127]
  buffer_load_dwordx4 v29, s[8:11], s51 offen offset:3072  lds
  v_mfma_f32_16x16x32_bf16 a[124:127], a[184:187], a[216:219], a[124:127]
  s_waitcnt lgkmcnt(11)
  ds_read_b128 a[176:179], v30 offset:45056
  v_mfma_f32_16x16x32_bf16 v[128:131], a[192:195], a[128:131], v[128:131]
  s_waitcnt lgkmcnt(11)
  ds_read_b128 a[180:183], v31 offset:45056
  v_cvt_pk_bf16_f32 v125, v120, v119
  v_mfma_f32_16x16x32_bf16 v[128:131], a[196:199], a[132:135], v[128:131]
  s_waitcnt lgkmcnt(11)
  ds_read_b64_tr_b16 a[200:201], v39 offset:0
  v_mfma_f32_16x16x32_bf16 v[144:147], a[196:199], a[140:143], v[144:147]
  s_waitcnt lgkmcnt(11)
  s_add_u32 m0, s96, 0x21000
  ds_read_b128 a[188:191], v31 offset:47104
  v_mfma_f32_16x16x32_bf16 v[144:147], a[192:195], a[136:139], v[144:147]
  s_waitcnt lgkmcnt(11)
  ds_read_b64_tr_b16 a[202:203], v39 offset:1024
  v_mfma_f32_16x16x32_bf16 v[160:163], a[192:195], a[144:147], v[160:163]
  s_waitcnt lgkmcnt(11)
  ds_read_b128 a[184:187], v30 offset:47104
  v_mfma_f32_16x16x32_bf16 v[160:163], a[196:199], a[148:151], v[160:163]
  s_waitcnt lgkmcnt(11)
  buffer_load_dwordx4 v24, s[4:7], s36 offen offset:0  lds
  v_mfma_f32_16x16x32_bf16 v[176:179], a[196:199], a[156:159], v[176:179]
  s_waitcnt lgkmcnt(10)
  ds_read_b64_tr_b16 a[204:205], v39 offset:8192
  v_mfma_f32_16x16x32_bf16 v[176:179], a[192:195], a[152:155], v[176:179]
  s_waitcnt lgkmcnt(10)
  ds_read_b64_tr_b16 a[206:207], v39 offset:9216
  v_mfma_f32_16x16x32_bf16 v[192:195], a[192:195], a[160:163], v[192:195]
  s_waitcnt lgkmcnt(10)
  ds_read_b64_tr_b16 a[208:209], v40 offset:0
  v_cvt_pk_bf16_f32 v126, v118, v117
  v_mfma_f32_16x16x32_bf16 v[192:195], a[196:199], a[164:167], v[192:195]
  s_waitcnt lgkmcnt(10)
  ds_read_b64_tr_b16 a[210:211], v40 offset:1024
  v_mfma_f32_16x16x32_bf16 v[208:211], a[196:199], a[172:175], v[208:211]
  s_waitcnt lgkmcnt(10)
  ds_read_b64_tr_b16 a[212:213], v40 offset:8192
  v_mfma_f32_16x16x32_bf16 v[208:211], a[192:195], a[168:171], v[208:211]
  s_waitcnt lgkmcnt(10)
  ds_read_b64_tr_b16 a[214:215], v40 offset:9216
  v_mfma_f32_16x16x32_bf16 v[224:227], a[192:195], a[176:179], v[224:227]
  s_waitcnt lgkmcnt(10)
  buffer_load_dwordx4 v25, s[4:7], s37 offen offset:1024  lds
  v_mfma_f32_16x16x32_bf16 v[224:227], a[196:199], a[180:183], v[224:227]
  s_waitcnt lgkmcnt(8)
  v_cvt_pk_bf16_f32 v127, v116, v115
  v_accvgpr_write_b32 a228, v124
  v_mfma_f32_16x16x32_bf16 v[240:243], a[196:199], a[188:191], v[240:243]
  s_waitcnt lgkmcnt(6)
  v_accvgpr_write_b32 a229, v125
  v_mfma_f32_16x16x32_bf16 v[240:243], a[192:195], a[184:187], v[240:243]
  v_accvgpr_write_b32 a230, v126
  v_mfma_f32_16x16x32_bf16 v[244:247], a[200:203], a[184:187], v[244:247]
  s_waitcnt lgkmcnt(4)
  v_accvgpr_write_b32 a231, v127
  v_lshlrev_b32 v98, 16, v54
  v_mfma_f32_16x16x32_bf16 v[244:247], a[204:207], a[188:191], v[244:247]
  v_and_b32 v99, s101, v54
  v_lshlrev_b32 v100, 16, v55
  v_mfma_f32_16x16x32_bf16 v[228:231], a[204:207], a[180:183], v[228:231]
  v_and_b32 v101, s101, v55
  v_lshlrev_b32 v104, 16, v59
  v_mfma_f32_16x16x32_bf16 v[228:231], a[200:203], a[176:179], v[228:231]
  buffer_load_dwordx4 v24, s[4:7], s38 offen offset:2048  lds
  v_mfma_f32_16x16x32_bf16 v[212:215], a[200:203], a[168:171], v[212:215]
  v_lshlrev_b32 v105, 16, v61
  v_lshlrev_b32 v106, 16, v63
  v_mfma_f32_16x16x32_bf16 v[212:215], a[204:207], a[172:175], v[212:215]
  v_lshlrev_b32 v107, 16, v65
  v_lshlrev_b32 v108, 16, v67
  v_mfma_f32_16x16x32_bf16 v[196:199], a[204:207], a[164:167], v[196:199]
  ds_read_b64_tr_b16 a[216:217], v41 offset:0
  v_lshlrev_b32 v109, 16, v69
  v_mfma_f32_16x16x32_bf16 v[196:199], a[200:203], a[160:163], v[196:199]
  ds_read_b64_tr_b16 a[218:219], v41 offset:1024
  v_lshlrev_b32 v110, 16, v71
  v_mfma_f32_16x16x32_bf16 v[180:183], a[200:203], a[152:155], v[180:183]
  ds_read_b64_tr_b16 a[220:221], v41 offset:8192
  v_lshlrev_b32 v111, 16, v73
  v_mfma_f32_16x16x32_bf16 v[180:183], a[204:207], a[156:159], v[180:183]
  ds_read_b64_tr_b16 a[222:223], v41 offset:9216
  v_lshlrev_b32 v112, 16, v75
  v_mfma_f32_16x16x32_bf16 v[164:167], a[204:207], a[148:151], v[164:167]
  buffer_load_dwordx4 v25, s[4:7], s39 offen offset:3072  lds
  v_mfma_f32_16x16x32_bf16 v[164:167], a[200:203], a[144:147], v[164:167]
  v_lshlrev_b32 v113, 16, v77
  v_lshlrev_b32 v114, 16, v79
  v_mfma_f32_16x16x32_bf16 v[148:151], a[200:203], a[136:139], v[148:151]
  v_xor_b32 v24, 0x180, v24
  v_mul_f32 v115, v101, v104
  v_mfma_f32_16x16x32_bf16 v[148:151], a[204:207], a[140:143], v[148:151]
  v_xor_b32 v25, 0x180, v25
  v_mul_f32 v116, v101, v105
  v_mfma_f32_16x16x32_bf16 v[132:135], a[204:207], a[132:135], v[132:135]
  s_add_u32 m0, s96, 0x0
  v_mul_f32 v117, v101, v106
  v_mul_f32 v118, v101, v107
  v_mfma_f32_16x16x32_bf16 v[132:135], a[200:203], a[128:131], v[132:135]
  s_waitcnt lgkmcnt(6)
  v_mul_f32 v119, v101, v108
  v_mul_f32 v120, v101, v109
  v_mfma_f32_16x16x32_bf16 v[136:139], a[208:211], a[128:131], v[136:139]
  s_waitcnt lgkmcnt(4)
  v_mul_f32 v121, v101, v110
  v_mul_f32 v122, v101, v111
  v_mfma_f32_16x16x32_bf16 v[136:139], a[212:215], a[132:135], v[136:139]
  buffer_load_dwordx4 v24, s[4:7], s32 offen offset:0  lds
  v_mfma_f32_16x16x32_bf16 v[152:155], a[212:215], a[140:143], v[152:155]
  v_fmac_f32 v115, v100, v105
  v_fmac_f32 v116, v100, v106
  v_mfma_f32_16x16x32_bf16 v[152:155], a[208:211], a[136:139], v[152:155]
  v_fmac_f32 v117, v100, v107
  v_fmac_f32 v118, v100, v108
  v_mfma_f32_16x16x32_bf16 v[168:171], a[208:211], a[144:147], v[168:171]
  v_fmac_f32 v119, v100, v109
  v_fmac_f32 v120, v100, v110
  v_mfma_f32_16x16x32_bf16 v[168:171], a[212:215], a[148:151], v[168:171]
  v_fmac_f32 v121, v100, v111
  v_fmac_f32 v122, v100, v112
  v_mfma_f32_16x16x32_bf16 v[184:187], a[212:215], a[156:159], v[184:187]
  v_fmac_f32 v115, v99, v106
  v_fmac_f32 v116, v99, v107
  v_mfma_f32_16x16x32_bf16 v[184:187], a[208:211], a[152:155], v[184:187]
  s_waitcnt vmcnt(13)
  v_fmac_f32 v117, v99, v108
  v_fmac_f32 v118, v99, v109
  v_mfma_f32_16x16x32_bf16 v[200:203], a[208:211], a[160:163], v[200:203]
  s_barrier
  v_mfma_f32_16x16x32_bf16 v[200:203], a[212:215], a[164:167], v[200:203]
  buffer_load_dwordx4 v25, s[4:7], s33 offen offset:1024  lds
  v_mfma_f32_16x16x32_bf16 v[216:219], a[212:215], a[172:175], v[216:219]
  ds_read_b64_tr_b16 a[192:193], v38 offset:16384
  v_fmac_f32 v119, v99, v110
  v_mfma_f32_16x16x32_bf16 v[216:219], a[208:211], a[168:171], v[216:219]
  ds_read_b64_tr_b16 a[194:195], v38 offset:17408
  v_fmac_f32 v120, v99, v111
  v_mfma_f32_16x16x32_bf16 v[232:235], a[208:211], a[176:179], v[232:235]
  ds_read_b64_tr_b16 a[196:197], v38 offset:24576
  v_fmac_f32 v121, v99, v112
  v_mfma_f32_16x16x32_bf16 v[232:235], a[212:215], a[180:183], v[232:235]
  ds_read_b64_tr_b16 a[198:199], v38 offset:25600
  v_fmac_f32 v122, v99, v113
  v_mfma_f32_16x16x32_bf16 v[248:251], a[212:215], a[188:191], v[248:251]
  v_fmac_f32 v115, v98, v107
  v_fmac_f32 v116, v98, v108
  v_mfma_f32_16x16x32_bf16 v[248:251], a[208:211], a[184:187], v[248:251]
  s_waitcnt lgkmcnt(6)
  buffer_load_dwordx4 v24, s[4:7], s34 offen offset:2048  lds
  v_mfma_f32_16x16x32_bf16 v[252:255], a[216:219], a[184:187], v[252:255]
  s_waitcnt lgkmcnt(4)
  v_fmac_f32 v117, v98, v109
  v_fmac_f32 v118, v98, v110
  v_mfma_f32_16x16x32_bf16 v[252:255], a[220:223], a[188:191], v[252:255]
  v_fmac_f32 v119, v98, v111
  v_fmac_f32 v120, v98, v112
  v_mfma_f32_16x16x32_bf16 v[236:239], a[220:223], a[180:183], v[236:239]
  v_fmac_f32 v121, v98, v113
  v_fmac_f32 v122, v98, v114
  v_mfma_f32_16x16x32_bf16 v[236:239], a[216:219], a[176:179], v[236:239]
  v_lshlrev_b32 v104, 16, v81
  v_lshlrev_b32 v105, 16, v83
  v_mfma_f32_16x16x32_bf16 v[220:223], a[216:219], a[168:171], v[220:223]
  v_lshlrev_b32 v106, 16, v85
  v_lshlrev_b32 v107, 16, v87
  v_mfma_f32_16x16x32_bf16 v[220:223], a[220:223], a[172:175], v[220:223]
  v_lshlrev_b32 v108, 16, v89
  v_lshlrev_b32 v109, 16, v91
  v_mfma_f32_16x16x32_bf16 v[204:207], a[220:223], a[164:167], v[204:207]
  buffer_load_dwordx4 v25, s[4:7], s35 offen offset:3072  lds
  v_mfma_f32_16x16x32_bf16 v[204:207], a[216:219], a[160:163], v[204:207]
  ds_read_b64_tr_b16 a[200:201], v39 offset:16384
  v_lshlrev_b32 v110, 16, v93
  v_mfma_f32_16x16x32_bf16 v[188:191], a[216:219], a[152:155], v[188:191]
  ds_read_b64_tr_b16 a[202:203], v39 offset:17408
  v_lshlrev_b32 v111, 16, v95
  v_mfma_f32_16x16x32_bf16 v[188:191], a[220:223], a[156:159], v[188:191]
  ds_read_b64_tr_b16 a[204:205], v39 offset:24576
  v_mul_f32 v115, v115, v104
  v_mfma_f32_16x16x32_bf16 v[172:175], a[220:223], a[148:151], v[172:175]
  s_add_u32 m0, s97, 0x1c000
  ds_read_b64_tr_b16 a[206:207], v39 offset:25600
  v_mul_f32 v116, v116, v105
  v_mfma_f32_16x16x32_bf16 v[172:175], a[216:219], a[144:147], v[172:175]
  v_mul_f32 v117, v117, v106
  v_mul_f32 v118, v118, v107
  v_mfma_f32_16x16x32_bf16 v[156:159], a[216:219], a[136:139], v[156:159]
  v_mul_f32 v119, v119, v108
  v_mul_f32 v120, v120, v109
  v_mfma_f32_16x16x32_bf16 v[156:159], a[220:223], a[140:143], v[156:159]
  buffer_load_dwordx4 v28, s[12:15], s48 offen offset:0  lds
  v_mfma_f32_16x16x32_bf16 v[140:143], a[220:223], a[132:135], v[140:143]
  v_mul_f32 v121, v121, v110
  v_mul_f32 v122, v122, v111
  v_mfma_f32_16x16x32_bf16 v[140:143], a[216:219], a[128:131], v[140:143]
  s_waitcnt lgkmcnt(6)
  v_cvt_pk_bf16_f32 v124, v122, v121
  v_cvt_pk_bf16_f32 v125, v120, v119
  v_mfma_f32_16x16x32_bf16 a[0:3], a[128:131], a[192:195], a[0:3]
  s_waitcnt lgkmcnt(4)
  v_cvt_pk_bf16_f32 v126, v118, v117
  v_cvt_pk_bf16_f32 v127, v116, v115
  v_mfma_f32_16x16x32_bf16 a[0:3], a[132:135], a[196:199], a[0:3]
  v_accvgpr_write_b32 a232, v124
  v_accvgpr_write_b32 a233, v125
  v_mfma_f32_16x16x32_bf16 a[16:19], a[140:143], a[196:199], a[16:19]
  v_accvgpr_write_b32 a234, v126
  v_accvgpr_write_b32 a235, v127
  v_mfma_f32_16x16x32_bf16 a[16:19], a[136:139], a[192:195], a[16:19]
  v_lshlrev_b32 v98, 16, v56
  v_and_b32 v99, s101, v56
  v_mfma_f32_16x16x32_bf16 a[32:35], a[144:147], a[192:195], a[32:35]
  buffer_load_dwordx4 v28, s[12:15], s49 offen offset:1024  lds
  v_mfma_f32_16x16x32_bf16 a[32:35], a[148:151], a[196:199], a[32:35]
  v_lshlrev_b32 v100, 16, v57
  v_and_b32 v101, s101, v57
  v_mfma_f32_16x16x32_bf16 a[48:51], a[156:159], a[196:199], a[48:51]
  ds_read_b64_tr_b16 a[208:209], v40 offset:16384
  v_and_b32 v104, s101, v59
  v_mfma_f32_16x16x32_bf16 a[48:51], a[152:155], a[192:195], a[48:51]
  ds_read_b64_tr_b16 a[210:211], v40 offset:17408
  v_and_b32 v105, s101, v61
  v_mfma_f32_16x16x32_bf16 a[64:67], a[160:163], a[192:195], a[64:67]
  ds_read_b64_tr_b16 a[212:213], v40 offset:24576
  v_and_b32 v106, s101, v63
  v_mfma_f32_16x16x32_bf16 a[64:67], a[164:167], a[196:199], a[64:67]
  ds_read_b64_tr_b16 a[214:215], v40 offset:25600
  v_and_b32 v107, s101, v65
  v_mfma_f32_16x16x32_bf16 a[80:83], a[172:175], a[196:199], a[80:83]
  v_and_b32 v108, s101, v67
  v_and_b32 v109, s101, v69
  v_mfma_f32_16x16x32_bf16 a[80:83], a[168:171], a[192:195], a[80:83]
  buffer_load_dwordx4 v29, s[12:15], s50 offen offset:2048  lds
  v_mfma_f32_16x16x32_bf16 a[96:99], a[176:179], a[192:195], a[96:99]
  v_and_b32 v110, s101, v71
  v_and_b32 v111, s101, v73
  v_mfma_f32_16x16x32_bf16 a[96:99], a[180:183], a[196:199], a[96:99]
  v_and_b32 v112, s101, v75
  v_and_b32 v113, s101, v77
  v_mfma_f32_16x16x32_bf16 a[112:115], a[188:191], a[196:199], a[112:115]
  v_and_b32 v114, s101, v79
  v_mul_f32 v115, v101, v104
  v_mfma_f32_16x16x32_bf16 a[112:115], a[184:187], a[192:195], a[112:115]
  s_waitcnt lgkmcnt(6)
  v_mul_f32 v116, v101, v105
  v_mul_f32 v117, v101, v106
  v_mfma_f32_16x16x32_bf16 a[116:119], a[184:187], a[200:203], a[116:119]
  s_waitcnt lgkmcnt(4)
  v_mul_f32 v118, v101, v107
  v_mul_f32 v119, v101, v108
  v_mfma_f32_16x16x32_bf16 a[116:119], a[188:191], a[204:207], a[116:119]
  v_mul_f32 v120, v101, v109
  v_mul_f32 v121, v101, v110
  v_mfma_f32_16x16x32_bf16 a[100:103], a[180:183], a[204:207], a[100:103]
  buffer_load_dwordx4 v29, s[12:15], s51 offen offset:3072  lds
  v_mfma_f32_16x16x32_bf16 a[100:103], a[176:179], a[200:203], a[100:103]
  v_mul_f32 v122, v101, v111
  v_fmac_f32 v115, v100, v105
  v_mfma_f32_16x16x32_bf16 a[84:87], a[168:171], a[200:203], a[84:87]
  v_fmac_f32 v116, v100, v106
  v_fmac_f32 v117, v100, v107
  v_mfma_f32_16x16x32_bf16 a[84:87], a[172:175], a[204:207], a[84:87]
  v_fmac_f32 v118, v100, v108
  v_fmac_f32 v119, v100, v109
  v_mfma_f32_16x16x32_bf16 a[68:71], a[164:167], a[204:207], a[68:71]
  s_add_u32 m0, s96, 0x1000
  ds_read_b64_tr_b16 a[216:217], v41 offset:16384
  v_fmac_f32 v120, v100, v110
  v_mfma_f32_16x16x32_bf16 a[68:71], a[160:163], a[200:203], a[68:71]
  ds_read_b64_tr_b16 a[218:219], v41 offset:17408
  v_fmac_f32 v121, v100, v111
  v_mfma_f32_16x16x32_bf16 a[52:55], a[152:155], a[200:203], a[52:55]
  ds_read_b64_tr_b16 a[220:221], v41 offset:24576
  v_fmac_f32 v122, v100, v112
  v_mfma_f32_16x16x32_bf16 a[52:55], a[156:159], a[204:207], a[52:55]
  buffer_load_dwordx4 v24, s[4:7], s36 offen offset:0  lds
  v_mfma_f32_16x16x32_bf16 a[36:39], a[148:151], a[204:207], a[36:39]
  ds_read_b64_tr_b16 a[222:223], v41 offset:25600
  v_fmac_f32 v115, v99, v106
  v_mfma_f32_16x16x32_bf16 a[36:39], a[144:147], a[200:203], a[36:39]
  v_fmac_f32 v116, v99, v107
  v_fmac_f32 v117, v99, v108
  v_mfma_f32_16x16x32_bf16 a[20:23], a[136:139], a[200:203], a[20:23]
  v_fmac_f32 v118, v99, v109
  v_fmac_f32 v119, v99, v110
  v_mfma_f32_16x16x32_bf16 a[20:23], a[140:143], a[204:207], a[20:23]
  v_fmac_f32 v120, v99, v111
  v_fmac_f32 v121, v99, v112
  v_mfma_f32_16x16x32_bf16 a[4:7], a[132:135], a[204:207], a[4:7]
  v_fmac_f32 v122, v99, v113
  v_fmac_f32 v115, v98, v107
  v_mfma_f32_16x16x32_bf16 a[4:7], a[128:131], a[200:203], a[4:7]
  s_waitcnt lgkmcnt(6)
  v_fmac_f32 v116, v98, v108
  v_fmac_f32 v117, v98, v109
  v_mfma_f32_16x16x32_bf16 a[8:11], a[128:131], a[208:211], a[8:11]
  s_waitcnt lgkmcnt(4)
  buffer_load_dwordx4 v25, s[4:7], s37 offen offset:1024  lds
  v_mfma_f32_16x16x32_bf16 a[8:11], a[132:135], a[212:215], a[8:11]
  v_fmac_f32 v118, v98, v110
  v_fmac_f32 v119, v98, v111
  v_mfma_f32_16x16x32_bf16 a[24:27], a[140:143], a[212:215], a[24:27]
  v_fmac_f32 v120, v98, v112
  v_fmac_f32 v121, v98, v113
  v_mfma_f32_16x16x32_bf16 a[24:27], a[136:139], a[208:211], a[24:27]
  v_fmac_f32 v122, v98, v114
  v_and_b32 v104, s101, v81
  v_mfma_f32_16x16x32_bf16 a[40:43], a[144:147], a[208:211], a[40:43]
  v_and_b32 v105, s101, v83
  v_and_b32 v106, s101, v85
  v_mfma_f32_16x16x32_bf16 a[40:43], a[148:151], a[212:215], a[40:43]
  v_and_b32 v107, s101, v87
  v_and_b32 v108, s101, v89
  v_mfma_f32_16x16x32_bf16 a[56:59], a[156:159], a[212:215], a[56:59]
  v_and_b32 v109, s101, v91
  v_and_b32 v110, s101, v93
  v_mfma_f32_16x16x32_bf16 a[56:59], a[152:155], a[208:211], a[56:59]
  s_waitcnt vmcnt(10)
  buffer_load_dwordx4 v24, s[4:7], s38 offen offset:2048  lds
  v_mfma_f32_16x16x32_bf16 a[72:75], a[160:163], a[208:211], a[72:75]
  s_barrier
  v_mfma_f32_16x16x32_bf16 a[72:75], a[164:167], a[212:215], a[72:75]
  ds_read_b64_tr_b16 a[192:193], v38 offset:32768
  v_and_b32 v111, s101, v95
  v_mfma_f32_16x16x32_bf16 a[88:91], a[172:175], a[212:215], a[88:91]
  ds_read_b64_tr_b16 a[194:195], v38 offset:33792
  v_mul_f32 v115, v115, v104
  v_mfma_f32_16x16x32_bf16 a[88:91], a[168:171], a[208:211], a[88:91]
  ds_read_b64_tr_b16 a[196:197], v38 offset:40960
  v_mul_f32 v116, v116, v105
  v_mfma_f32_16x16x32_bf16 a[104:107], a[176:179], a[208:211], a[104:107]
  ds_read_b64_tr_b16 a[198:199], v38 offset:41984
  v_mul_f32 v117, v117, v106
  v_mfma_f32_16x16x32_bf16 a[104:107], a[180:183], a[212:215], a[104:107]
  v_mul_f32 v118, v118, v107
  v_mul_f32 v119, v119, v108
  v_mfma_f32_16x16x32_bf16 a[120:123], a[188:191], a[212:215], a[120:123]
  buffer_load_dwordx4 v25, s[4:7], s39 offen offset:3072  lds
  v_mfma_f32_16x16x32_bf16 a[120:123], a[184:187], a[208:211], a[120:123]
  s_waitcnt lgkmcnt(6)
  v_mul_f32 v120, v120, v109
  v_mul_f32 v121, v121, v110
  v_mfma_f32_16x16x32_bf16 a[124:127], a[184:187], a[216:219], a[124:127]
  s_waitcnt lgkmcnt(4)
  ds_read_b128 a[184:187], v32 offset:14336
  v_xor_b32 v28, 0x180000, v28
  v_mfma_f32_16x16x32_bf16 a[124:127], a[188:191], a[220:223], a[124:127]
  ds_read_b128 a[188:191], v33 offset:14336
  v_xor_b32 v29, 0x180000, v29
  v_mfma_f32_16x16x32_bf16 a[108:111], a[180:183], a[220:223], a[108:111]
  s_add_u32 m0, s97, 0x10000
  ds_read_b128 a[180:183], v33 offset:12288
  v_mul_f32 v122, v122, v111
  v_mfma_f32_16x16x32_bf16 a[108:111], a[176:179], a[216:219], a[108:111]
  ds_read_b128 a[176:179], v32 offset:12288
  v_cvt_pk_bf16_f32 v124, v122, v121
  v_mfma_f32_16x16x32_bf16 a[92:95], a[168:171], a[216:219], a[92:95]
  ds_read_b128 a[168:171], v32 offset:10240
  v_cvt_pk_bf16_f32 v125, v120, v119
  v_mfma_f32_16x16x32_bf16 a[92:95], a[172:175], a[220:223], a[92:95]
  buffer_load_dwordx4 v28, s[8:11], s48 offen offset:0  lds
  v_mfma_f32_16x16x32_bf16 a[76:79], a[164:167], a[220:223], a[76:79]
  ds_read_b128 a[172:175], v33 offset:10240
  v_cvt_pk_bf16_f32 v126, v118, v117
  v_mfma_f32_16x16x32_bf16 a[76:79], a[160:163], a[216:219], a[76:79]
  ds_read_b128 a[164:167], v33 offset:8192
  v_mfma_f32_16x16x32_bf16 a[60:63], a[152:155], a[216:219], a[60:63]
  ds_read_b128 a[160:163], v32 offset:8192
  v_cvt_pk_bf16_f32 v127, v116, v115
  v_mfma_f32_16x16x32_bf16 a[60:63], a[156:159], a[220:223], a[60:63]
  ds_read_b128 a[152:155], v32 offset:6144
  v_mfma_f32_16x16x32_bf16 a[44:47], a[148:151], a[220:223], a[44:47]
  ds_read_b128 a[156:159], v33 offset:6144
  v_mfma_f32_16x16x32_bf16 a[44:47], a[144:147], a[216:219], a[44:47]
  ds_read_b128 a[148:151], v33 offset:4096
  v_mfma_f32_16x16x32_bf16 a[28:31], a[136:139], a[216:219], a[28:31]
  buffer_load_dwordx4 v28, s[8:11], s49 offen offset:1024  lds
  v_mfma_f32_16x16x32_bf16 a[28:31], a[140:143], a[220:223], a[28:31]
  ds_read_b128 a[144:147], v32 offset:4096
  v_accvgpr_write_b32 a236, v124
  v_mfma_f32_16x16x32_bf16 a[12:15], a[132:135], a[220:223], a[12:15]
  ds_read_b128 a[136:139], v32 offset:2048
  v_mfma_f32_16x16x32_bf16 a[12:15], a[128:131], a[216:219], a[12:15]
  s_waitcnt lgkmcnt(12)
  ds_read_b128 a[140:143], v33 offset:2048
  v_mfma_f32_16x16x32_bf16 v[240:243], a[192:195], a[184:187], v[240:243]
  s_waitcnt lgkmcnt(12)
  ds_read_b64_tr_b16 a[200:201], v39 offset:32768
  v_accvgpr_write_b32 a237, v125
  v_mfma_f32_16x16x32_bf16 v[240:243], a[196:199], a[188:191], v[240:243]
  s_waitcnt lgkmcnt(12)
  ds_read_b128 a[132:135], v33 offset:0
  v_mfma_f32_16x16x32_bf16 v[224:227], a[196:199], a[180:183], v[224:227]
  s_waitcnt lgkmcnt(12)
  ds_read_b64_tr_b16 a[202:203], v39 offset:33792
  v_mfma_f32_16x16x32_bf16 v[224:227], a[192:195], a[176:179], v[224:227]
  s_waitcnt lgkmcnt(12)
  buffer_load_dwordx4 v29, s[8:11], s50 offen offset:2048  lds
  v_mfma_f32_16x16x32_bf16 v[208:211], a[192:195], a[168:171], v[208:211]
  s_waitcnt lgkmcnt(11)
  ds_read_b128 a[128:131], v32 offset:0
  v_accvgpr_write_b32 a238, v126
  v_mfma_f32_16x16x32_bf16 v[208:211], a[196:199], a[172:175], v[208:211]
  s_waitcnt lgkmcnt(11)
  ds_read_b64_tr_b16 a[204:205], v39 offset:40960
  v_mfma_f32_16x16x32_bf16 v[192:195], a[196:199], a[164:167], v[192:195]
  s_waitcnt lgkmcnt(11)
  ds_read_b64_tr_b16 a[206:207], v39 offset:41984
  v_mfma_f32_16x16x32_bf16 v[192:195], a[192:195], a[160:163], v[192:195]
  s_waitcnt lgkmcnt(11)
  ds_read_b64_tr_b16 a[208:209], v40 offset:32768
  v_mfma_f32_16x16x32_bf16 v[176:179], a[192:195], a[152:155], v[176:179]
  s_waitcnt lgkmcnt(11)
  ds_read_b64_tr_b16 a[210:211], v40 offset:33792
  v_accvgpr_write_b32 a239, v127
  v_mfma_f32_16x16x32_bf16 v[176:179], a[196:199], a[156:159], v[176:179]
  s_waitcnt lgkmcnt(11)
  ds_read_b64_tr_b16 a[212:213], v40 offset:40960
  v_mfma_f32_16x16x32_bf16 v[160:163], a[196:199], a[148:151], v[160:163]
  s_waitcnt lgkmcnt(11)
  buffer_load_dwordx4 v29, s[8:11], s51 offen offset:3072  lds
  v_mfma_f32_16x16x32_bf16 v[160:163], a[192:195], a[144:147], v[160:163]
  s_waitcnt lgkmcnt(10)
  ds_read_b64_tr_b16 a[214:215], v40 offset:41984
  v_mfma_f32_16x16x32_bf16 v[144:147], a[192:195], a[136:139], v[144:147]
  s_waitcnt lgkmcnt(10)
  v_mfma_f32_16x16x32_bf16 v[144:147], a[196:199], a[140:143], v[144:147]
  s_waitcnt lgkmcnt(8)
  v_mfma_f32_16x16x32_bf16 v[128:131], a[196:199], a[132:135], v[128:131]
  s_waitcnt lgkmcnt(6)
  v_mfma_f32_16x16x32_bf16 v[128:131], a[192:195], a[128:131], v[128:131]
  v_mfma_f32_16x16x32_bf16 v[132:135], a[200:203], a[128:131], v[132:135]
  s_waitcnt lgkmcnt(4)
  v_mfma_f32_16x16x32_bf16 v[132:135], a[204:207], a[132:135], v[132:135]
  global_load_dword v17, v21, s[68:69]
  v_mfma_f32_16x16x32_bf16 v[148:151], a[204:207], a[140:143], v[148:151]
  v_add_u32 v21, 0x4000, v21
  v_mfma_f32_16x16x32_bf16 v[148:151], a[200:203], a[136:139], v[148:151]
  v_mfma_f32_16x16x32_bf16 v[164:167], a[200:203], a[144:147], v[164:167]
  v_mfma_f32_16x16x32_bf16 v[164:167], a[204:207], a[148:151], v[164:167]
  v_mfma_f32_16x16x32_bf16 v[180:183], a[204:207], a[156:159], v[180:183]
  ds_read_b64_tr_b16 a[216:217], v41 offset:32768
  v_mfma_f32_16x16x32_bf16 v[180:183], a[200:203], a[152:155], v[180:183]
  ds_read_b64_tr_b16 a[218:219], v41 offset:33792
  v_mfma_f32_16x16x32_bf16 v[196:199], a[200:203], a[160:163], v[196:199]
  ds_read_b64_tr_b16 a[220:221], v41 offset:40960
  v_mfma_f32_16x16x32_bf16 v[196:199], a[204:207], a[164:167], v[196:199]
  ds_read_b64_tr_b16 a[222:223], v41 offset:41984
  v_mfma_f32_16x16x32_bf16 v[212:215], a[204:207], a[172:175], v[212:215]
  v_xor_b32 v24, 0x80, v24
  v_mfma_f32_16x16x32_bf16 v[212:215], a[200:203], a[168:171], v[212:215]
  v_xor_b32 v25, 0x80, v25
  v_mfma_f32_16x16x32_bf16 v[228:231], a[200:203], a[176:179], v[228:231]
  s_add_u32 m0, s96, 0x8000
  v_mfma_f32_16x16x32_bf16 v[228:231], a[204:207], a[180:183], v[228:231]
  v_mfma_f32_16x16x32_bf16 v[244:247], a[204:207], a[188:191], v[244:247]
  v_mfma_f32_16x16x32_bf16 v[244:247], a[200:203], a[184:187], v[244:247]
  s_waitcnt lgkmcnt(6)
  buffer_load_dwordx4 v24, s[4:7], s32 offen offset:0  lds
  v_mfma_f32_16x16x32_bf16 v[248:251], a[208:211], a[184:187], v[248:251]
  s_waitcnt lgkmcnt(4)
  v_mfma_f32_16x16x32_bf16 v[248:251], a[212:215], a[188:191], v[248:251]
  v_mfma_f32_16x16x32_bf16 v[232:235], a[212:215], a[180:183], v[232:235]
  v_mfma_f32_16x16x32_bf16 v[232:235], a[208:211], a[176:179], v[232:235]
  v_mfma_f32_16x16x32_bf16 v[216:219], a[208:211], a[168:171], v[216:219]
  v_mfma_f32_16x16x32_bf16 v[216:219], a[212:215], a[172:175], v[216:219]
  v_mfma_f32_16x16x32_bf16 v[200:203], a[212:215], a[164:167], v[200:203]
  buffer_load_dwordx4 v25, s[4:7], s33 offen offset:1024  lds
  v_mfma_f32_16x16x32_bf16 v[200:203], a[208:211], a[160:163], v[200:203]
  s_waitcnt vmcnt(11)
  v_mfma_f32_16x16x32_bf16 v[184:187], a[208:211], a[152:155], v[184:187]
  s_barrier
  v_mfma_f32_16x16x32_bf16 v[184:187], a[212:215], a[156:159], v[184:187]
  ds_read_b64_tr_b16 a[192:193], v38 offset:49152
  v_mfma_f32_16x16x32_bf16 v[168:171], a[212:215], a[148:151], v[168:171]
  ds_read_b64_tr_b16 a[194:195], v38 offset:50176
  v_mfma_f32_16x16x32_bf16 v[168:171], a[208:211], a[144:147], v[168:171]
  ds_read_b64_tr_b16 a[196:197], v38 offset:57344
  v_mfma_f32_16x16x32_bf16 v[152:155], a[208:211], a[136:139], v[152:155]
  ds_read_b64_tr_b16 a[198:199], v38 offset:58368
  v_mfma_f32_16x16x32_bf16 v[152:155], a[212:215], a[140:143], v[152:155]
  buffer_load_dwordx4 v24, s[4:7], s34 offen offset:2048  lds
  v_mfma_f32_16x16x32_bf16 v[136:139], a[212:215], a[132:135], v[136:139]
  v_mfma_f32_16x16x32_bf16 v[136:139], a[208:211], a[128:131], v[136:139]
  s_waitcnt lgkmcnt(6)
  v_mfma_f32_16x16x32_bf16 v[140:143], a[216:219], a[128:131], v[140:143]
  s_waitcnt lgkmcnt(4)
  v_mfma_f32_16x16x32_bf16 v[140:143], a[220:223], a[132:135], v[140:143]
  v_mfma_f32_16x16x32_bf16 v[156:159], a[220:223], a[140:143], v[156:159]
  v_mfma_f32_16x16x32_bf16 v[156:159], a[216:219], a[136:139], v[156:159]
  v_mfma_f32_16x16x32_bf16 v[172:175], a[216:219], a[144:147], v[172:175]
  buffer_load_dwordx4 v25, s[4:7], s35 offen offset:3072  lds
  v_mfma_f32_16x16x32_bf16 v[172:175], a[220:223], a[148:151], v[172:175]
  v_mfma_f32_16x16x32_bf16 v[188:191], a[220:223], a[156:159], v[188:191]
  s_mov_b32 s52, s64
  ds_read_b64_tr_b16 a[200:201], v39 offset:49152
  v_mfma_f32_16x16x32_bf16 v[188:191], a[216:219], a[152:155], v[188:191]
  s_mov_b32 s53, s65
  ds_read_b64_tr_b16 a[202:203], v39 offset:50176
  v_mfma_f32_16x16x32_bf16 v[204:207], a[216:219], a[160:163], v[204:207]
  s_mov_b32 s54, 0x400000
  ds_read_b64_tr_b16 a[204:205], v39 offset:57344
  v_mfma_f32_16x16x32_bf16 v[204:207], a[220:223], a[164:167], v[204:207]
  ds_read_b64_tr_b16 a[206:207], v39 offset:58368
  v_mfma_f32_16x16x32_bf16 v[220:223], a[220:223], a[172:175], v[220:223]
  v_mfma_f32_16x16x32_bf16 v[220:223], a[216:219], a[168:171], v[220:223]
  buffer_load_dwordx4 v[112:115], v3, s[52:55], s77 offen offset:0
  v_mfma_f32_16x16x32_bf16 v[236:239], a[216:219], a[176:179], v[236:239]
  v_mfma_f32_16x16x32_bf16 v[236:239], a[220:223], a[180:183], v[236:239]
  v_mfma_f32_16x16x32_bf16 v[252:255], a[220:223], a[188:191], v[252:255]
  v_mfma_f32_16x16x32_bf16 v[252:255], a[216:219], a[184:187], v[252:255]
  s_waitcnt lgkmcnt(6)
  v_mfma_f32_16x16x32_bf16 a[112:115], a[184:187], a[192:195], a[112:115]
  s_waitcnt lgkmcnt(4)
  v_mfma_f32_16x16x32_bf16 a[112:115], a[188:191], a[196:199], a[112:115]
  v_mfma_f32_16x16x32_bf16 a[96:99], a[180:183], a[196:199], a[96:99]
  buffer_load_dwordx4 v[116:119], v3, s[52:55], s77 offen offset:1024
  v_mfma_f32_16x16x32_bf16 a[96:99], a[176:179], a[192:195], a[96:99]
  v_mfma_f32_16x16x32_bf16 a[80:83], a[168:171], a[192:195], a[80:83]
  v_mfma_f32_16x16x32_bf16 a[80:83], a[172:175], a[196:199], a[80:83]
  v_mfma_f32_16x16x32_bf16 a[64:67], a[164:167], a[196:199], a[64:67]
  ds_read_b64_tr_b16 a[208:209], v40 offset:49152
  v_mfma_f32_16x16x32_bf16 a[64:67], a[160:163], a[192:195], a[64:67]
  ds_read_b64_tr_b16 a[210:211], v40 offset:50176
  v_mfma_f32_16x16x32_bf16 a[48:51], a[152:155], a[192:195], a[48:51]
  ds_read_b64_tr_b16 a[212:213], v40 offset:57344
  v_mfma_f32_16x16x32_bf16 a[48:51], a[156:159], a[196:199], a[48:51]
L_pad3:
  s_cbranch_execz L_pad7
  global_load_dword v17, v21, s[68:69]
  v_mfma_f32_16x16x32_bf16 a[32:35], a[148:151], a[196:199], a[32:35]
  ds_read_b64_tr_b16 a[214:215], v40 offset:58368
  v_add_u32 v21, 0x4000, v21
  v_mfma_f32_16x16x32_bf16 a[32:35], a[144:147], a[192:195], a[32:35]
  v_mfma_f32_16x16x32_bf16 a[16:19], a[136:139], a[192:195], a[16:19]
  v_mfma_f32_16x16x32_bf16 a[16:19], a[140:143], a[196:199], a[16:19]
  v_mfma_f32_16x16x32_bf16 a[0:3], a[132:135], a[196:199], a[0:3]
  v_mfma_f32_16x16x32_bf16 a[0:3], a[128:131], a[192:195], a[0:3]
  s_waitcnt lgkmcnt(6)
  v_mfma_f32_16x16x32_bf16 a[4:7], a[128:131], a[200:203], a[4:7]
  s_waitcnt lgkmcnt(4)
  v_mfma_f32_16x16x32_bf16 a[4:7], a[132:135], a[204:207], a[4:7]
  v_mfma_f32_16x16x32_bf16 a[20:23], a[140:143], a[204:207], a[20:23]
  v_mfma_f32_16x16x32_bf16 a[20:23], a[136:139], a[200:203], a[20:23]
  v_mfma_f32_16x16x32_bf16 a[36:39], a[144:147], a[200:203], a[36:39]
  s_add_u32 m0, s97, 0x14000
  v_mfma_f32_16x16x32_bf16 a[36:39], a[148:151], a[204:207], a[36:39]
  v_mfma_f32_16x16x32_bf16 a[52:55], a[156:159], a[204:207], a[52:55]
  ds_read_b64_tr_b16 a[216:217], v41 offset:49152
  v_mfma_f32_16x16x32_bf16 a[52:55], a[152:155], a[200:203], a[52:55]
  buffer_load_dwordx4 v28, s[12:15], s48 offen offset:0  lds
  v_mfma_f32_16x16x32_bf16 a[68:71], a[160:163], a[200:203], a[68:71]
  ds_read_b64_tr_b16 a[218:219], v41 offset:50176
  v_mfma_f32_16x16x32_bf16 a[68:71], a[164:167], a[204:207], a[68:71]
  ds_read_b64_tr_b16 a[220:221], v41 offset:57344
  v_mfma_f32_16x16x32_bf16 a[84:87], a[172:175], a[204:207], a[84:87]
  ds_read_b64_tr_b16 a[222:223], v41 offset:58368
  v_mfma_f32_16x16x32_bf16 a[84:87], a[168:171], a[200:203], a[84:87]
  v_mfma_f32_16x16x32_bf16 a[100:103], a[176:179], a[200:203], a[100:103]
  v_mfma_f32_16x16x32_bf16 a[100:103], a[180:183], a[204:207], a[100:103]
  v_mfma_f32_16x16x32_bf16 a[116:119], a[188:191], a[204:207], a[116:119]
  buffer_load_dwordx4 v28, s[12:15], s49 offen offset:1024  lds
  v_mfma_f32_16x16x32_bf16 a[116:119], a[184:187], a[200:203], a[116:119]
  s_waitcnt lgkmcnt(6)
  v_mfma_f32_16x16x32_bf16 a[120:123], a[184:187], a[208:211], a[120:123]
  s_waitcnt lgkmcnt(4)
  v_mfma_f32_16x16x32_bf16 a[120:123], a[188:191], a[212:215], a[120:123]
  v_mfma_f32_16x16x32_bf16 a[104:107], a[180:183], a[212:215], a[104:107]
  v_mfma_f32_16x16x32_bf16 a[104:107], a[176:179], a[208:211], a[104:107]
  v_mfma_f32_16x16x32_bf16 a[88:91], a[168:171], a[208:211], a[88:91]
  v_mfma_f32_16x16x32_bf16 a[88:91], a[172:175], a[212:215], a[88:91]
  buffer_load_dwordx4 v29, s[12:15], s50 offen offset:2048  lds
  v_mfma_f32_16x16x32_bf16 a[72:75], a[164:167], a[212:215], a[72:75]
  v_mfma_f32_16x16x32_bf16 a[72:75], a[160:163], a[208:211], a[72:75]
  s_waitcnt vmcnt(11)
  v_mfma_f32_16x16x32_bf16 a[56:59], a[152:155], a[208:211], a[56:59]
  s_barrier
  v_mfma_f32_16x16x32_bf16 a[56:59], a[156:159], a[212:215], a[56:59]
  ds_read_b64_tr_b16 a[192:193], v38 offset:0
  v_mfma_f32_16x16x32_bf16 a[40:43], a[148:151], a[212:215], a[40:43]
  ds_read_b64_tr_b16 a[194:195], v38 offset:1024
  v_mfma_f32_16x16x32_bf16 a[40:43], a[144:147], a[208:211], a[40:43]
  buffer_load_dwordx4 v29, s[12:15], s51 offen offset:3072  lds
  v_mfma_f32_16x16x32_bf16 a[24:27], a[136:139], a[208:211], a[24:27]
  ds_read_b64_tr_b16 a[196:197], v38 offset:8192
  v_mfma_f32_16x16x32_bf16 a[24:27], a[140:143], a[212:215], a[24:27]
  ds_read_b64_tr_b16 a[198:199], v38 offset:9216
  v_mfma_f32_16x16x32_bf16 a[8:11], a[132:135], a[212:215], a[8:11]
  buffer_load_dwordx4 v[120:123], v3, s[52:55], s77 offen offset:2048
  v_mfma_f32_16x16x32_bf16 a[8:11], a[128:131], a[208:211], a[8:11]
  s_waitcnt lgkmcnt(6)
  v_mfma_f32_16x16x32_bf16 a[12:15], a[128:131], a[216:219], a[12:15]
  s_waitcnt lgkmcnt(4)
  ds_read_b128 a[128:131], v30 offset:0
  v_mfma_f32_16x16x32_bf16 a[12:15], a[132:135], a[220:223], a[12:15]
  ds_read_b128 a[132:135], v31 offset:0
  v_mfma_f32_16x16x32_bf16 a[28:31], a[140:143], a[220:223], a[28:31]
  buffer_load_dwordx4 v[124:127], v3, s[52:55], s77 offen offset:3072
  v_mfma_f32_16x16x32_bf16 a[28:31], a[136:139], a[216:219], a[28:31]
  ds_read_b128 a[140:143], v31 offset:2048
  v_mfma_f32_16x16x32_bf16 a[44:47], a[144:147], a[216:219], a[44:47]
  s_mov_b32 s52, s88
  ds_read_b128 a[136:139], v30 offset:2048
  v_mfma_f32_16x16x32_bf16 a[44:47], a[148:151], a[220:223], a[44:47]
  s_mov_b32 s53, s89
  ds_read_b128 a[144:147], v30 offset:4096
  v_mfma_f32_16x16x32_bf16 a[60:63], a[156:159], a[220:223], a[60:63]
  s_mov_b32 s54, 0x800
  ds_read_b128 a[148:151], v31 offset:4096
  v_mfma_f32_16x16x32_bf16 a[60:63], a[152:155], a[216:219], a[60:63]
  ds_read_b128 a[156:159], v31 offset:6144
  v_mfma_f32_16x16x32_bf16 a[76:79], a[160:163], a[216:219], a[76:79]
  ds_read_b128 a[152:155], v30 offset:6144
  v_mfma_f32_16x16x32_bf16 a[76:79], a[164:167], a[220:223], a[76:79]
  buffer_load_dwordx4 v[104:107], v3, s[52:55], 0 offen offset:0
  v_mfma_f32_16x16x32_bf16 a[92:95], a[172:175], a[220:223], a[92:95]
  ds_read_b128 a[160:163], v30 offset:8192
  v_mfma_f32_16x16x32_bf16 a[92:95], a[168:171], a[216:219], a[92:95]
  ds_read_b128 a[164:167], v31 offset:8192
  v_mfma_f32_16x16x32_bf16 a[108:111], a[176:179], a[216:219], a[108:111]
  buffer_load_dwordx4 v[108:111], v3, s[52:55], 0 offen offset:1024
  v_mfma_f32_16x16x32_bf16 a[108:111], a[180:183], a[220:223], a[108:111]
  ds_read_b128 a[172:175], v31 offset:10240
  v_mfma_f32_16x16x32_bf16 a[124:127], a[188:191], a[220:223], a[124:127]
  ds_read_b128 a[168:171], v30 offset:10240
  v_mfma_f32_16x16x32_bf16 a[124:127], a[184:187], a[216:219], a[124:127]
  s_waitcnt lgkmcnt(11)
  global_load_dword v17, v21, s[68:69]
  v_mfma_f32_16x16x32_bf16 v[128:131], a[192:195], a[128:131], v[128:131]
  s_waitcnt lgkmcnt(10)
  s_mov_b32 s83, 0x3e0293ee
  ds_read_b128 a[176:179], v30 offset:12288
  v_add_u32 v21, 0x4000, v21
  v_mfma_f32_16x16x32_bf16 v[128:131], a[196:199], a[132:135], v[128:131]
  s_waitcnt lgkmcnt(10)
  ds_read_b128 a[180:183], v31 offset:12288
  v_mfma_f32_16x16x32_bf16 v[144:147], a[196:199], a[140:143], v[144:147]
  s_waitcnt lgkmcnt(10)
  ds_read_b64_tr_b16 a[200:201], v39 offset:0
  v_mfma_f32_16x16x32_bf16 v[144:147], a[192:195], a[136:139], v[144:147]
  s_waitcnt lgkmcnt(10)
  ds_read_b128 a[188:191], v31 offset:14336
  v_mfma_f32_16x16x32_bf16 v[160:163], a[192:195], a[144:147], v[160:163]
  s_waitcnt lgkmcnt(10)
  ds_read_b64_tr_b16 a[202:203], v39 offset:1024
  v_mfma_f32_16x16x32_bf16 v[160:163], a[196:199], a[148:151], v[160:163]
  s_waitcnt lgkmcnt(10)
  ds_read_b128 a[184:187], v30 offset:14336
  v_mfma_f32_16x16x32_bf16 v[176:179], a[196:199], a[156:159], v[176:179]
  s_waitcnt lgkmcnt(10)
  ds_read_b64_tr_b16 a[204:205], v39 offset:8192
  v_xor_b32 v28, 0x80000, v28
  v_mfma_f32_16x16x32_bf16 v[176:179], a[192:195], a[152:155], v[176:179]
  s_waitcnt lgkmcnt(10)
  ds_read_b64_tr_b16 a[206:207], v39 offset:9216
  v_xor_b32 v29, 0x80000, v29
  v_mfma_f32_16x16x32_bf16 v[192:195], a[192:195], a[160:163], v[192:195]
  s_waitcnt lgkmcnt(10)
  s_add_u32 m0, s97, 0x18000
  ds_read_b64_tr_b16 a[208:209], v40 offset:0
  v_mfma_f32_16x16x32_bf16 v[192:195], a[196:199], a[164:167], v[192:195]
  s_waitcnt lgkmcnt(10)
  ds_read_b64_tr_b16 a[210:211], v40 offset:1024
  v_mfma_f32_16x16x32_bf16 v[208:211], a[196:199], a[172:175], v[208:211]
  s_waitcnt lgkmcnt(10)
  ds_read_b64_tr_b16 a[212:213], v40 offset:8192
  v_mfma_f32_16x16x32_bf16 v[208:211], a[192:195], a[168:171], v[208:211]
  s_waitcnt lgkmcnt(10)
  buffer_load_dwordx4 v28, s[8:11], s48 offen offset:0  lds
  v_mfma_f32_16x16x32_bf16 v[224:227], a[192:195], a[176:179], v[224:227]
  s_waitcnt lgkmcnt(9)
  ds_read_b64_tr_b16 a[214:215], v40 offset:9216
  v_mfma_f32_16x16x32_bf16 v[224:227], a[196:199], a[180:183], v[224:227]
  s_waitcnt lgkmcnt(8)
  v_mfma_f32_16x16x32_bf16 v[240:243], a[196:199], a[188:191], v[240:243]
  s_waitcnt lgkmcnt(6)
  v_mfma_f32_16x16x32_bf16 v[240:243], a[192:195], a[184:187], v[240:243]
  v_mfma_f32_16x16x32_bf16 v[244:247], a[200:203], a[184:187], v[244:247]
  s_waitcnt lgkmcnt(4)
  v_mfma_f32_16x16x32_bf16 v[244:247], a[204:207], a[188:191], v[244:247]
  v_mfma_f32_16x16x32_bf16 v[228:231], a[204:207], a[180:183], v[228:231]
  buffer_load_dwordx4 v28, s[8:11], s49 offen offset:1024  lds
  v_mfma_f32_16x16x32_bf16 v[228:231], a[200:203], a[176:179], v[228:231]
  v_mfma_f32_16x16x32_bf16 v[212:215], a[200:203], a[168:171], v[212:215]
  v_mfma_f32_16x16x32_bf16 v[212:215], a[204:207], a[172:175], v[212:215]
  v_mfma_f32_16x16x32_bf16 v[196:199], a[204:207], a[164:167], v[196:199]
  ds_read_b64_tr_b16 a[216:217], v41 offset:0
  v_mfma_f32_16x16x32_bf16 v[196:199], a[200:203], a[160:163], v[196:199]
  ds_read_b64_tr_b16 a[218:219], v41 offset:1024
  v_mfma_f32_16x16x32_bf16 v[180:183], a[200:203], a[152:155], v[180:183]
  ds_read_b64_tr_b16 a[220:221], v41 offset:8192
  v_mfma_f32_16x16x32_bf16 v[180:183], a[204:207], a[156:159], v[180:183]
  buffer_load_dwordx4 v29, s[8:11], s50 offen offset:2048  lds
  v_mfma_f32_16x16x32_bf16 v[164:167], a[204:207], a[148:151], v[164:167]
  ds_read_b64_tr_b16 a[222:223], v41 offset:9216
  v_mfma_f32_16x16x32_bf16 v[164:167], a[200:203], a[144:147], v[164:167]
  v_mfma_f32_16x16x32_bf16 v[148:151], a[200:203], a[136:139], v[148:151]
  v_mfma_f32_16x16x32_bf16 v[148:151], a[204:207], a[140:143], v[148:151]
  v_mfma_f32_16x16x32_bf16 v[132:135], a[204:207], a[132:135], v[132:135]
  v_mfma_f32_16x16x32_bf16 v[132:135], a[200:203], a[128:131], v[132:135]
  s_waitcnt lgkmcnt(6)
  v_mfma_f32_16x16x32_bf16 v[136:139], a[208:211], a[128:131], v[136:139]
  s_waitcnt lgkmcnt(4)
  buffer_load_dwordx4 v29, s[8:11], s51 offen offset:3072  lds
  v_mfma_f32_16x16x32_bf16 v[136:139], a[212:215], a[132:135], v[136:139]
  v_mfma_f32_16x16x32_bf16 v[152:155], a[212:215], a[140:143], v[152:155]
  v_mfma_f32_16x16x32_bf16 v[152:155], a[208:211], a[136:139], v[152:155]
  v_mfma_f32_16x16x32_bf16 v[168:171], a[208:211], a[144:147], v[168:171]
  s_add_u32 m0, s96, 0x9000
  v_mfma_f32_16x16x32_bf16 v[168:171], a[212:215], a[148:151], v[168:171]
  v_mfma_f32_16x16x32_bf16 v[184:187], a[212:215], a[156:159], v[184:187]
  v_mfma_f32_16x16x32_bf16 v[184:187], a[208:211], a[152:155], v[184:187]
  s_waitcnt vmcnt(9)
  buffer_load_dwordx4 v24, s[4:7], s36 offen offset:0  lds
  v_mfma_f32_16x16x32_bf16 v[200:203], a[208:211], a[160:163], v[200:203]
  s_barrier
  v_mfma_f32_16x16x32_bf16 v[200:203], a[212:215], a[164:167], v[200:203]
  ds_read_b64_tr_b16 a[192:193], v38 offset:16384
  v_mfma_f32_16x16x32_bf16 v[216:219], a[212:215], a[172:175], v[216:219]
  ds_write_b128 v6, a[224:227] offset:0
  v_mfma_f32_16x16x32_bf16 v[216:219], a[208:211], a[168:171], v[216:219]
  ds_read_b64_tr_b16 a[194:195], v38 offset:17408
  v_mfma_f32_16x16x32_bf16 v[232:235], a[208:211], a[176:179], v[232:235]
  ds_write_b128 v6, a[228:231] offset:1024
  v_mfma_f32_16x16x32_bf16 v[232:235], a[212:215], a[180:183], v[232:235]
  ds_read_b64_tr_b16 a[196:197], v38 offset:24576
  v_mfma_f32_16x16x32_bf16 v[248:251], a[212:215], a[188:191], v[248:251]
  s_waitcnt vmcnt(7)
  ds_write_b128 v6, a[232:235] offset:2048
  v_lshlrev_b32 v96, 16, v104
  v_mfma_f32_16x16x32_bf16 v[248:251], a[208:211], a[184:187], v[248:251]
  s_waitcnt lgkmcnt(8)
  buffer_load_dwordx4 v25, s[4:7], s37 offen offset:1024  lds
  v_mfma_f32_16x16x32_bf16 v[252:255], a[216:219], a[184:187], v[252:255]
  s_waitcnt lgkmcnt(6)
  ds_write_b128 v6, a[236:239] offset:3072
  v_and_b32 v97, s101, v104
  v_mfma_f32_16x16x32_bf16 v[252:255], a[220:223], a[188:191], v[252:255]
  ds_read_b128 a[224:227], v22 offset:0
  v_lshlrev_b32 v98, 16, v112
  v_mfma_f32_16x16x32_bf16 v[236:239], a[220:223], a[180:183], v[236:239]
  ds_read_b128 a[228:231], v22 offset:1024
  v_and_b32 v99, s101, v112
  v_mfma_f32_16x16x32_bf16 v[236:239], a[216:219], a[176:179], v[236:239]
  ds_read_b128 a[232:235], v22 offset:2048
  v_lshlrev_b32 v100, 16, v120
  v_mfma_f32_16x16x32_bf16 v[220:223], a[216:219], a[168:171], v[220:223]
  ds_read_b128 a[236:239], v22 offset:3072
  v_and_b32 v101, s101, v120
  v_mfma_f32_16x16x32_bf16 v[220:223], a[220:223], a[172:175], v[220:223]
  buffer_load_dwordx4 v24, s[4:7], s38 offen offset:2048  lds
  v_mfma_f32_16x16x32_bf16 v[204:207], a[220:223], a[164:167], v[204:207]
  ds_read_b64_tr_b16 a[198:199], v38 offset:25600
  v_mul_f32 v102, v96, v98
  v_mfma_f32_16x16x32_bf16 v[204:207], a[216:219], a[160:163], v[204:207]
  ds_read_b64_tr_b16 a[200:201], v39 offset:16384
  v_mul_f32 v103, v96, v100
  v_mfma_f32_16x16x32_bf16 v[188:191], a[216:219], a[152:155], v[188:191]
  ds_read_b64_tr_b16 a[202:203], v39 offset:17408
  v_fmac_f32 v102, v97, v99
  v_mfma_f32_16x16x32_bf16 v[188:191], a[220:223], a[156:159], v[188:191]
  ds_read_b64_tr_b16 a[204:205], v39 offset:24576
  v_fmac_f32 v103, v97, v101
  v_mfma_f32_16x16x32_bf16 v[172:175], a[220:223], a[148:151], v[172:175]
  ds_read_b64_tr_b16 a[206:207], v39 offset:25600
  v_lshlrev_b32 v96, 16, v105
  v_mfma_f32_16x16x32_bf16 v[172:175], a[216:219], a[144:147], v[172:175]
  v_and_b32 v97, s101, v105
  v_lshlrev_b32 v98, 16, v113
  v_mfma_f32_16x16x32_bf16 v[156:159], a[216:219], a[136:139], v[156:159]
  buffer_load_dwordx4 v25, s[4:7], s39 offen offset:3072  lds
  v_mfma_f32_16x16x32_bf16 v[156:159], a[220:223], a[140:143], v[156:159]
  v_and_b32 v99, s101, v113
  v_lshlrev_b32 v100, 16, v121
  v_mfma_f32_16x16x32_bf16 v[140:143], a[220:223], a[132:135], v[140:143]
  v_and_b32 v101, s101, v121
  v_fmac_f32 v102, v96, v98
  v_mfma_f32_16x16x32_bf16 v[140:143], a[216:219], a[128:131], v[140:143]
  s_waitcnt lgkmcnt(13)
  v_fmac_f32 v103, v96, v100
  v_fmac_f32 v102, v97, v99
  v_mfma_f32_16x16x32_bf16 a[0:3], a[128:131], a[192:195], a[0:3]
  s_waitcnt lgkmcnt(4)
  v_fmac_f32 v103, v97, v101
  v_lshlrev_b32 v96, 16, v106
  v_mfma_f32_16x16x32_bf16 a[0:3], a[132:135], a[196:199], a[0:3]
  v_and_b32 v97, s101, v106
  v_lshlrev_b32 v98, 16, v114
  v_mfma_f32_16x16x32_bf16 a[16:19], a[140:143], a[196:199], a[16:19]
  v_and_b32 v99, s101, v114
  v_lshlrev_b32 v100, 16, v122
  v_mfma_f32_16x16x32_bf16 a[16:19], a[136:139], a[192:195], a[16:19]
  global_load_dword v17, v21, s[68:69]
  v_mfma_f32_16x16x32_bf16 a[32:35], a[144:147], a[192:195], a[32:35]
  v_add_u32 v21, 0x4000, v21
  v_and_b32 v101, s101, v122
  v_mfma_f32_16x16x32_bf16 a[32:35], a[148:151], a[196:199], a[32:35]
  v_fmac_f32 v102, v96, v98
  v_fmac_f32 v103, v96, v100
  v_mfma_f32_16x16x32_bf16 a[48:51], a[156:159], a[196:199], a[48:51]
  ds_read_b64_tr_b16 a[208:209], v40 offset:16384
  v_fmac_f32 v102, v97, v99
  v_mfma_f32_16x16x32_bf16 a[48:51], a[152:155], a[192:195], a[48:51]
  ds_read_b64_tr_b16 a[210:211], v40 offset:17408
  v_fmac_f32 v103, v97, v101
  v_mfma_f32_16x16x32_bf16 a[64:67], a[160:163], a[192:195], a[64:67]
  ds_read_b64_tr_b16 a[212:213], v40 offset:24576
  v_lshlrev_b32 v96, 16, v107
  v_mfma_f32_16x16x32_bf16 a[64:67], a[164:167], a[196:199], a[64:67]
  ds_read_b64_tr_b16 a[214:215], v40 offset:25600
  v_and_b32 v97, s101, v107
  v_mfma_f32_16x16x32_bf16 a[80:83], a[172:175], a[196:199], a[80:83]
  v_lshlrev_b32 v98, 16, v115
  v_and_b32 v99, s101, v115
  v_mfma_f32_16x16x32_bf16 a[80:83], a[168:171], a[192:195], a[80:83]
  v_lshlrev_b32 v100, 16, v123
  v_and_b32 v101, s101, v123
  v_mfma_f32_16x16x32_bf16 a[96:99], a[176:179], a[192:195], a[96:99]
  v_fmac_f32 v102, v96, v98
  v_fmac_f32 v103, v96, v100
  v_mfma_f32_16x16x32_bf16 a[96:99], a[180:183], a[196:199], a[96:99]
  v_fmac_f32 v102, v97, v99
  v_fmac_f32 v103, v97, v101
  v_mfma_f32_16x16x32_bf16 a[112:115], a[188:191], a[196:199], a[112:115]
  s_waitcnt vmcnt(10)
  s_add_u32 m0, s97, 0x1c000
  v_lshlrev_b32 v96, 16, v108
  v_and_b32 v97, s101, v108
  v_mfma_f32_16x16x32_bf16 a[112:115], a[184:187], a[192:195], a[112:115]
  s_waitcnt lgkmcnt(6)
  v_lshlrev_b32 v98, 16, v116
  v_and_b32 v99, s101, v116
  v_mfma_f32_16x16x32_bf16 a[116:119], a[184:187], a[200:203], a[116:119]
  s_waitcnt lgkmcnt(4)
  v_lshlrev_b32 v100, 16, v124
  v_and_b32 v101, s101, v124
  v_mfma_f32_16x16x32_bf16 a[116:119], a[188:191], a[204:207], a[116:119]
  buffer_load_dwordx4 v28, s[12:15], s48 offen offset:0  lds
  v_mfma_f32_16x16x32_bf16 a[100:103], a[180:183], a[204:207], a[100:103]
  v_fmac_f32 v102, v96, v98
  v_fmac_f32 v103, v96, v100
  v_mfma_f32_16x16x32_bf16 a[100:103], a[176:179], a[200:203], a[100:103]
  v_fmac_f32 v102, v97, v99
  v_fmac_f32 v103, v97, v101
  v_mfma_f32_16x16x32_bf16 a[84:87], a[168:171], a[200:203], a[84:87]
  v_lshlrev_b32 v96, 16, v109
  v_and_b32 v97, s101, v109
  v_mfma_f32_16x16x32_bf16 a[84:87], a[172:175], a[204:207], a[84:87]
  v_lshlrev_b32 v98, 16, v117
  v_and_b32 v99, s101, v117
  v_mfma_f32_16x16x32_bf16 a[68:71], a[164:167], a[204:207], a[68:71]
  ds_read_b64_tr_b16 a[216:217], v41 offset:16384
  v_lshlrev_b32 v100, 16, v125
  v_mfma_f32_16x16x32_bf16 a[68:71], a[160:163], a[200:203], a[68:71]
  ds_read_b64_tr_b16 a[218:219], v41 offset:17408
  v_and_b32 v101, s101, v125
  v_mfma_f32_16x16x32_bf16 a[52:55], a[152:155], a[200:203], a[52:55]
  buffer_load_dwordx4 v28, s[12:15], s49 offen offset:1024  lds
  v_mfma_f32_16x16x32_bf16 a[52:55], a[156:159], a[204:207], a[52:55]
  ds_read_b64_tr_b16 a[220:221], v41 offset:24576
  v_fmac_f32 v102, v96, v98
  v_mfma_f32_16x16x32_bf16 a[36:39], a[148:151], a[204:207], a[36:39]
  ds_read_b64_tr_b16 a[222:223], v41 offset:25600
  v_fmac_f32 v103, v96, v100
  v_mfma_f32_16x16x32_bf16 a[36:39], a[144:147], a[200:203], a[36:39]
  v_fmac_f32 v102, v97, v99
  v_fmac_f32 v103, v97, v101
  v_mfma_f32_16x16x32_bf16 a[20:23], a[136:139], a[200:203], a[20:23]
  v_lshlrev_b32 v96, 16, v110
  v_and_b32 v97, s101, v110
  v_mfma_f32_16x16x32_bf16 a[20:23], a[140:143], a[204:207], a[20:23]
  v_lshlrev_b32 v98, 16, v118
  v_and_b32 v99, s101, v118
  v_mfma_f32_16x16x32_bf16 a[4:7], a[132:135], a[204:207], a[4:7]
  v_lshlrev_b32 v100, 16, v126
  v_and_b32 v101, s101, v126
  v_mfma_f32_16x16x32_bf16 a[4:7], a[128:131], a[200:203], a[4:7]
  s_waitcnt lgkmcnt(6)
  buffer_load_dwordx4 v29, s[12:15], s50 offen offset:2048  lds
  v_mfma_f32_16x16x32_bf16 a[8:11], a[128:131], a[208:211], a[8:11]
  s_waitcnt lgkmcnt(4)
  v_fmac_f32 v102, v96, v98
  v_fmac_f32 v103, v96, v100
  v_mfma_f32_16x16x32_bf16 a[8:11], a[132:135], a[212:215], a[8:11]
  v_fmac_f32 v102, v97, v99
  v_fmac_f32 v103, v97, v101
  v_mfma_f32_16x16x32_bf16 a[24:27], a[140:143], a[212:215], a[24:27]
  v_lshlrev_b32 v96, 16, v111
  v_and_b32 v97, s101, v111
  v_mfma_f32_16x16x32_bf16 a[24:27], a[136:139], a[208:211], a[24:27]
  v_lshlrev_b32 v98, 16, v119
  v_and_b32 v99, s101, v119
  v_mfma_f32_16x16x32_bf16 a[40:43], a[144:147], a[208:211], a[40:43]
  v_lshlrev_b32 v100, 16, v127
  v_and_b32 v101, s101, v127
  v_mfma_f32_16x16x32_bf16 a[40:43], a[148:151], a[212:215], a[40:43]
  v_fmac_f32 v102, v96, v98
  v_fmac_f32 v103, v96, v100
  v_mfma_f32_16x16x32_bf16 a[56:59], a[156:159], a[212:215], a[56:59]
  buffer_load_dwordx4 v29, s[12:15], s51 offen offset:3072  lds
  v_mfma_f32_16x16x32_bf16 a[56:59], a[152:155], a[208:211], a[56:59]
  s_mov_b32 s4, s92
  v_fmac_f32 v102, v97, v99
  v_fmac_f32 v103, v97, v101
  v_mfma_f32_16x16x32_bf16 a[72:75], a[160:163], a[208:211], a[72:75]
  s_waitcnt vmcnt(5)
  s_mov_b32 s5, s93
  s_barrier
  v_mfma_f32_16x16x32_bf16 a[72:75], a[164:167], a[212:215], a[72:75]
  s_mov_b32 s6, 256
  ds_read_b64_tr_b16 a[192:193], v38 offset:32768
  v_add_f32_dpp v102, v102, v102 row_ror:8 row_mask:0xf bank_mask:0xf
  v_mfma_f32_16x16x32_bf16 a[88:91], a[172:175], a[212:215], a[88:91]
  s_lshl_b32 s100, s29, 2
  ds_read_b64_tr_b16 a[194:195], v38 offset:33792
  v_add_f32_dpp v103, v103, v103 row_ror:8 row_mask:0xf bank_mask:0xf
  v_mfma_f32_16x16x32_bf16 a[88:91], a[168:171], a[208:211], a[88:91]
  ds_read_b64_tr_b16 a[196:197], v38 offset:40960
  v_mfma_f32_16x16x32_bf16 a[104:107], a[176:179], a[208:211], a[104:107]
  ds_read_b64_tr_b16 a[198:199], v38 offset:41984
  v_add_f32_dpp v102, v102, v102 row_ror:4 row_mask:0xf bank_mask:0xf
  v_mfma_f32_16x16x32_bf16 a[104:107], a[180:183], a[212:215], a[104:107]
  buffer_load_dword v10, off, s[4:7], s100 offset:0 sc1
  v_mfma_f32_16x16x32_bf16 a[120:123], a[188:191], a[212:215], a[120:123]
  s_add_u32 m0, s96, 0x20000
  v_add_f32_dpp v103, v103, v103 row_ror:4 row_mask:0xf bank_mask:0xf
  v_mfma_f32_16x16x32_bf16 a[120:123], a[184:187], a[208:211], a[120:123]
  s_waitcnt lgkmcnt(6)
  v_mfma_f32_16x16x32_bf16 a[124:127], a[184:187], a[216:219], a[124:127]
  s_waitcnt lgkmcnt(4)
  buffer_load_dwordx4 v26, s[56:59], s40 offen offset:0  lds
  v_mfma_f32_16x16x32_bf16 a[124:127], a[188:191], a[220:223], a[124:127]
  ds_read_b128 a[184:187], v30 offset:47104
  v_add_f32_dpp v102, v102, v102 row_ror:2 row_mask:0xf bank_mask:0xf
  v_mfma_f32_16x16x32_bf16 a[108:111], a[180:183], a[220:223], a[108:111]
  ds_read_b128 a[188:191], v31 offset:47104
  v_add_f32_dpp v103, v103, v103 row_ror:2 row_mask:0xf bank_mask:0xf
  v_mfma_f32_16x16x32_bf16 a[108:111], a[176:179], a[216:219], a[108:111]
  buffer_load_dwordx4 v27, s[56:59], s41 offen offset:1024  lds
  v_mfma_f32_16x16x32_bf16 a[92:95], a[168:171], a[216:219], a[92:95]
  ds_read_b128 a[180:183], v31 offset:45056
  v_add_f32_dpp v102, v102, v102 row_ror:1 row_mask:0xf bank_mask:0xf
  v_mfma_f32_16x16x32_bf16 a[92:95], a[172:175], a[220:223], a[92:95]
  ds_read_b128 a[176:179], v30 offset:45056
  v_add_f32_dpp v103, v103, v103 row_ror:1 row_mask:0xf bank_mask:0xf
  v_mfma_f32_16x16x32_bf16 a[76:79], a[164:167], a[220:223], a[76:79]
  ds_read_b128 a[168:171], v30 offset:43008
  v_mfma_f32_16x16x32_bf16 a[76:79], a[160:163], a[216:219], a[76:79]
  buffer_load_dwordx4 v26, s[56:59], s42 offen offset:2048  lds
  v_mfma_f32_16x16x32_bf16 a[60:63], a[152:155], a[216:219], a[60:63]
  ds_read_b128 a[172:175], v31 offset:43008
  v_mov_b32 v96, v102
  v_mfma_f32_16x16x32_bf16 a[60:63], a[156:159], a[220:223], a[60:63]
  ds_read_b128 a[164:167], v31 offset:40960
  v_mfma_f32_16x16x32_bf16 a[44:47], a[148:151], a[220:223], a[44:47]
  ds_read_b128 a[160:163], v30 offset:40960
  v_mov_b32 v97, v103
  v_mfma_f32_16x16x32_bf16 a[44:47], a[144:147], a[216:219], a[44:47]
  ds_read_b128 a[152:155], v30 offset:38912
  v_mfma_f32_16x16x32_bf16 a[28:31], a[136:139], a[216:219], a[28:31]
  buffer_load_dwordx4 v27, s[56:59], s43 offen offset:3072  lds
  v_mfma_f32_16x16x32_bf16 a[28:31], a[140:143], a[220:223], a[28:31]
  ds_read_b128 a[156:159], v31 offset:38912
  v_permlane32_swap_b32 v96, v102
  v_mfma_f32_16x16x32_bf16 a[12:15], a[132:135], a[220:223], a[12:15]
  s_add_u32 m0, s96, 0x21000
  ds_read_b128 a[148:151], v31 offset:36864
  v_mfma_f32_16x16x32_bf16 a[12:15], a[128:131], a[216:219], a[12:15]
  s_waitcnt lgkmcnt(10)
  ds_read_b128 a[144:147], v30 offset:36864
  v_mfma_f32_16x16x32_bf16 v[240:243], a[192:195], a[184:187], v[240:243]
L_gq0:
  ds_read_b128 a[136:139], v30 offset:34816
  s_waitcnt lgkmcnt(11)
  v_mfma_f32_16x16x32_bf16 v[240:243], a[196:199], a[188:191], v[240:243]
  s_waitcnt lgkmcnt(10)
  buffer_load_dwordx4 v26, s[56:59], s44 offen offset:0  lds
  v_mfma_f32_16x16x32_bf16 v[224:227], a[196:199], a[180:183], v[224:227]
  s_waitcnt lgkmcnt(9)
  ds_read_b128 a[140:143], v31 offset:34816
  v_permlane32_swap_b32 v97, v103
  v_mfma_f32_16x16x32_bf16 v[224:227], a[192:195], a[176:179], v[224:227]
  s_waitcnt lgkmcnt(9)
  ds_read_b64_tr_b16 a[200:201], v39 offset:32768
  v_mfma_f32_16x16x32_bf16 v[208:211], a[192:195], a[168:171], v[208:211]
  s_waitcnt lgkmcnt(9)
  ds_read_b128 a[132:135], v31 offset:32768
  v_add_f32 v102, v102, v96
  v_mfma_f32_16x16x32_bf16 v[208:211], a[196:199], a[172:175], v[208:211]
  s_waitcnt lgkmcnt(9)
  buffer_load_dwordx4 v27, s[56:59], s45 offen offset:1024  lds
  v_mfma_f32_16x16x32_bf16 v[192:195], a[196:199], a[164:167], v[192:195]
  s_waitcnt lgkmcnt(8)
  ds_read_b64_tr_b16 a[202:203], v39 offset:33792
  v_add_f32 v103, v103, v97
  v_mfma_f32_16x16x32_bf16 v[192:195], a[192:195], a[160:163], v[192:195]
  s_waitcnt lgkmcnt(8)
  ds_read_b128 a[128:131], v30 offset:32768
  v_mfma_f32_16x16x32_bf16 v[176:179], a[192:195], a[152:155], v[176:179]
  s_waitcnt lgkmcnt(8)
  ds_read_b64_tr_b16 a[204:205], v39 offset:40960
  v_mov_b32 v96, v102
  v_mfma_f32_16x16x32_bf16 v[176:179], a[196:199], a[156:159], v[176:179]
  s_waitcnt lgkmcnt(8)
  ds_read_b64_tr_b16 a[206:207], v39 offset:41984
  v_mfma_f32_16x16x32_bf16 v[160:163], a[196:199], a[148:151], v[160:163]
  s_waitcnt lgkmcnt(8)
  buffer_load_dwordx4 v26, s[56:59], s46 offen offset:2048  lds
  v_mfma_f32_16x16x32_bf16 v[160:163], a[192:195], a[144:147], v[160:163]
  s_waitcnt lgkmcnt(7)
  ds_read_b64_tr_b16 a[208:209], v40 offset:32768
  v_mov_b32 v97, v103
  v_mfma_f32_16x16x32_bf16 v[144:147], a[192:195], a[136:139], v[144:147]
  s_waitcnt lgkmcnt(7)
  ds_read_b64_tr_b16 a[210:211], v40 offset:33792
  v_mfma_f32_16x16x32_bf16 v[144:147], a[196:199], a[140:143], v[144:147]
  s_waitcnt lgkmcnt(6)
  ds_read_b64_tr_b16 a[212:213], v40 offset:40960
  v_permlane16_swap_b32 v96, v102
  v_mfma_f32_16x16x32_bf16 v[128:131], a[196:199], a[132:135], v[128:131]
  s_waitcnt lgkmcnt(5)
  ds_read_b64_tr_b16 a[214:215], v40 offset:41984
  v_permlane16_swap_b32 v97, v103
  v_mfma_f32_16x16x32_bf16 v[128:131], a[192:195], a[128:131], v[128:131]
  buffer_load_dwordx4 v27, s[56:59], s47 offen offset:3072  lds
  v_mfma_f32_16x16x32_bf16 v[132:135], a[200:203], a[128:131], v[132:135]
  s_waitcnt lgkmcnt(4)
  v_xor_b32 v28, s99, v28
  v_add_f32 v102, v102, v96
  v_mfma_f32_16x16x32_bf16 v[132:135], a[204:207], a[132:135], v[132:135]
  v_xor_b32 v29, s99, v29
  v_add_f32 v103, v103, v97
  v_mfma_f32_16x16x32_bf16 v[148:151], a[204:207], a[140:143], v[148:151]
  s_add_u32 m0, s97, 0x10000
  v_mul_f32 v102, 0xbfb8aa3b, v102
  v_mul_f32 v103, 0xbfb8aa3b, v103
  v_mfma_f32_16x16x32_bf16 v[148:151], a[200:203], a[136:139], v[148:151]
  buffer_load_dwordx4 v28, s[60:63], s48 offen offset:0  lds
  v_mfma_f32_16x16x32_bf16 v[164:167], a[200:203], a[144:147], v[164:167]
  v_exp_f32 v102, v102
  v_mfma_f32_16x16x32_bf16 v[164:167], a[204:207], a[148:151], v[164:167]
  v_exp_f32 v103, v103
  v_mfma_f32_16x16x32_bf16 v[180:183], a[204:207], a[156:159], v[180:183]
  v_add_f32 v102, 1.0, v102
  v_add_f32 v103, 1.0, v103
  v_mfma_f32_16x16x32_bf16 v[180:183], a[200:203], a[152:155], v[180:183]
  v_rcp_f32 v102, v102
  v_mfma_f32_16x16x32_bf16 v[196:199], a[200:203], a[160:163], v[196:199]
  buffer_load_dwordx4 v28, s[60:63], s49 offen offset:1024  lds
  v_mfma_f32_16x16x32_bf16 v[196:199], a[204:207], a[164:167], v[196:199]
  v_rcp_f32 v103, v103
  v_mfma_f32_16x16x32_bf16 v[212:215], a[204:207], a[172:175], v[212:215]
  v_lshlrev_b32 v16, 24, v1
  v_accvgpr_write_b32 a240, v102
  v_mfma_f32_16x16x32_bf16 v[212:215], a[200:203], a[168:171], v[212:215]
  ds_read_b64_tr_b16 a[216:217], v41 offset:32768
  v_accvgpr_write_b32 a241, v103
  v_mfma_f32_16x16x32_bf16 v[228:231], a[200:203], a[176:179], v[228:231]
  ds_read_b64_tr_b16 a[218:219], v41 offset:33792
  v_cvt_pk_bf16_f32 v64, v128, v129
  v_mfma_f32_16x16x32_bf16 v[228:231], a[204:207], a[180:183], v[228:231]
  buffer_load_dwordx4 v29, s[60:63], s50 offen offset:2048  lds
  v_mfma_f32_16x16x32_bf16 v[244:247], a[204:207], a[188:191], v[244:247]
  ds_read_b64_tr_b16 a[220:221], v41 offset:40960
  v_cvt_pk_bf16_f32 v65, v130, v131
  v_mfma_f32_16x16x32_bf16 v[244:247], a[200:203], a[184:187], v[244:247]
  s_waitcnt lgkmcnt(5)
  ds_read_b64_tr_b16 a[222:223], v41 offset:41984
  v_cvt_pk_bf16_f32 v80, v160, v161
  v_mfma_f32_16x16x32_bf16 v[248:251], a[208:211], a[184:187], v[248:251]
  s_waitcnt lgkmcnt(4)
  v_cvt_pk_bf16_f32 v81, v162, v163
  v_mfma_f32_16x16x32_bf16 v[248:251], a[212:215], a[188:191], v[248:251]
  buffer_load_dwordx4 v29, s[60:63], s51 offen offset:3072  lds
  v_mfma_f32_16x16x32_bf16 v[232:235], a[212:215], a[180:183], v[232:235]
  s_add_u32 s52, s94, 0x3000000
  s_addc_u32 s53, s95, 0
  v_mfma_f32_16x16x32_bf16 v[232:235], a[208:211], a[176:179], v[232:235]
  s_mov_b32 s54, 0xc02000
  v_mfma_f32_16x16x32_bf16 v[216:219], a[208:211], a[168:171], v[216:219]
  s_lshl_b32 s76, s2, 5
  v_cvt_pk_bf16_f32 v96, v192, v193
  v_mfma_f32_16x16x32_bf16 v[216:219], a[212:215], a[172:175], v[216:219]
  s_lshl_b32 s77, s28, 3
  v_cvt_pk_bf16_f32 v97, v194, v195
  v_mfma_f32_16x16x32_bf16 v[200:203], a[212:215], a[164:167], v[200:203]
  s_add_u32 s76, s76, s77
  v_cvt_pk_bf16_f32 v112, v224, v225
  v_mfma_f32_16x16x32_bf16 v[200:203], a[208:211], a[160:163], v[200:203]
  s_add_u32 s76, s76, 0xc00000
  v_mfma_f32_16x16x32_bf16 v[184:187], a[208:211], a[152:155], v[184:187]
  s_waitcnt vmcnt(13)
  s_barrier
  v_mfma_f32_16x16x32_bf16 v[184:187], a[212:215], a[156:159], v[184:187]
  buffer_store_dwordx2 a[240:241], v16, s[52:55], s76 offen sc1
  v_mfma_f32_16x16x32_bf16 v[168:171], a[212:215], a[148:151], v[168:171]
  s_mov_b32 s76, 0
  ds_read_b64_tr_b16 a[192:193], v38 offset:49152
  v_cvt_pk_bf16_f32 v113, v226, v227
  v_mfma_f32_16x16x32_bf16 v[168:171], a[208:211], a[144:147], v[168:171]
  ds_read_b64_tr_b16 a[194:195], v38 offset:50176
  v_mfma_f32_16x16x32_bf16 v[152:155], a[208:211], a[136:139], v[152:155]
  buffer_store_dwordx4 a[224:227], v20, s[52:55], s76 offen sc1
  v_mfma_f32_16x16x32_bf16 v[152:155], a[212:215], a[140:143], v[152:155]
  s_mov_b32 s76, 8192
  ds_read_b64_tr_b16 a[196:197], v38 offset:57344
  v_mfma_f32_16x16x32_bf16 v[136:139], a[212:215], a[132:135], v[136:139]
  ds_read_b64_tr_b16 a[198:199], v38 offset:58368
  v_mfma_f32_16x16x32_bf16 v[136:139], a[208:211], a[128:131], v[136:139]
  s_waitcnt lgkmcnt(6)
  v_cvt_pk_bf16_f32 v114, v228, v229
  v_mfma_f32_16x16x32_bf16 v[140:143], a[216:219], a[128:131], v[140:143]
  s_waitcnt lgkmcnt(4)
  buffer_store_dwordx4 a[228:231], v20, s[52:55], s76 offen sc1
  v_mfma_f32_16x16x32_bf16 v[140:143], a[220:223], a[132:135], v[140:143]
  v_cvt_pk_bf16_f32 v115, v230, v231
  v_mfma_f32_16x16x32_bf16 v[156:159], a[220:223], a[140:143], v[156:159]
  s_mov_b32 s76, 16384
  v_cvt_pk_bf16_f32 v98, v196, v197
  v_mfma_f32_16x16x32_bf16 v[156:159], a[216:219], a[136:139], v[156:159]
  v_cvt_pk_bf16_f32 v99, v198, v199
  v_mfma_f32_16x16x32_bf16 v[172:175], a[216:219], a[144:147], v[172:175]
  v_cvt_pk_bf16_f32 v82, v164, v165
  v_mfma_f32_16x16x32_bf16 v[172:175], a[220:223], a[148:151], v[172:175]
  buffer_store_dwordx4 a[232:235], v20, s[52:55], s76 offen sc1
  v_mfma_f32_16x16x32_bf16 v[188:191], a[220:223], a[156:159], v[188:191]
  ds_read_b64_tr_b16 a[200:201], v39 offset:49152
  v_cvt_pk_bf16_f32 v83, v166, v167
  v_mfma_f32_16x16x32_bf16 v[188:191], a[216:219], a[152:155], v[188:191]
  s_mov_b32 s76, 24576
  ds_read_b64_tr_b16 a[202:203], v39 offset:50176
  v_mfma_f32_16x16x32_bf16 v[204:207], a[216:219], a[160:163], v[204:207]
L_pad4:
  s_cbranch_execz L_pad8
  ds_read_b64_tr_b16 a[204:205], v39 offset:57344
  v_mfma_f32_16x16x32_bf16 v[204:207], a[220:223], a[164:167], v[204:207]
  ds_read_b64_tr_b16 a[206:207], v39 offset:58368
  v_mfma_f32_16x16x32_bf16 v[220:223], a[220:223], a[172:175], v[220:223]
  buffer_store_dwordx4 a[236:239], v20, s[52:55], s76 offen sc1
  v_mfma_f32_16x16x32_bf16 v[220:223], a[216:219], a[168:171], v[220:223]
  v_xor_b32 v26, 0x80, v26
  v_mfma_f32_16x16x32_bf16 v[236:239], a[216:219], a[176:179], v[236:239]
  v_xor_b32 v27, 0x80, v27
  v_mfma_f32_16x16x32_bf16 v[236:239], a[220:223], a[180:183], v[236:239]
  s_add_u32 m0, s96, 0x0
  v_cvt_pk_bf16_f32 v66, v132, v133
  v_mfma_f32_16x16x32_bf16 v[252:255], a[220:223], a[188:191], v[252:255]
  v_cvt_pk_bf16_f32 v67, v134, v135
  v_mfma_f32_16x16x32_bf16 v[252:255], a[216:219], a[184:187], v[252:255]
  s_waitcnt lgkmcnt(6)
  buffer_load_dwordx4 v26, s[56:59], s40 offen offset:0  lds
  v_mfma_f32_16x16x32_bf16 a[112:115], a[184:187], a[192:195], a[112:115]
  s_waitcnt lgkmcnt(4)
  v_mul_f32 v136, s83, v136
  v_mul_f32 v137, s83, v137
  v_mfma_f32_16x16x32_bf16 a[112:115], a[188:191], a[196:199], a[112:115]
  s_waitcnt vmcnt(18)
  v_cmp_eq_u32 vcc, 0, v10
  s_nop 2
  s_cbranch_vccnz L_clr_wait
L_clr_ok:
  v_mfma_f32_16x16x32_bf16 a[96:99], a[180:183], a[196:199], a[96:99]
  s_waitcnt vmcnt(10)
  ds_read_b128 a[224:227], v36 offset:0
  v_mul_f32 v138, s83, v138
  v_mfma_f32_16x16x32_bf16 a[96:99], a[176:179], a[192:195], a[96:99]
  v_mul_f32 v139, s83, v139
  v_cvt_pk_bf16_f32 v68, v136, v137
  v_mfma_f32_16x16x32_bf16 a[80:83], a[168:171], a[192:195], a[80:83]
  buffer_load_dwordx4 v27, s[56:59], s41 offen offset:1024  lds
  v_mfma_f32_16x16x32_bf16 a[80:83], a[172:175], a[196:199], a[80:83]
  v_cvt_pk_bf16_f32 v69, v138, v139
  v_mul_f32 v168, s83, v168
  v_mfma_f32_16x16x32_bf16 a[64:67], a[164:167], a[196:199], a[64:67]
  ds_read_b64_tr_b16 a[208:209], v40 offset:49152
  v_mul_f32 v169, s83, v169
  v_mfma_f32_16x16x32_bf16 a[64:67], a[160:163], a[192:195], a[64:67]
  ds_read_b64_tr_b16 a[210:211], v40 offset:50176
  v_mfma_f32_16x16x32_bf16 a[48:51], a[152:155], a[192:195], a[48:51]
  ds_read_b64_tr_b16 a[212:213], v40 offset:57344
  v_mul_f32 v170, s83, v170
  v_mfma_f32_16x16x32_bf16 a[48:51], a[156:159], a[196:199], a[48:51]
  buffer_load_dwordx4 v26, s[56:59], s42 offen offset:2048  lds
  v_mfma_f32_16x16x32_bf16 a[32:35], a[148:151], a[196:199], a[32:35]
  ds_read_b64_tr_b16 a[214:215], v40 offset:58368
  v_mul_f32 v171, s83, v171
  v_mfma_f32_16x16x32_bf16 a[32:35], a[144:147], a[192:195], a[32:35]
  ds_read_b128 a[228:231], v37 offset:0
  v_mfma_f32_16x16x32_bf16 a[16:19], a[136:139], a[192:195], a[16:19]
  ds_read_b128 a[232:235], v36 offset:2048
  v_cvt_pk_bf16_f32 v84, v168, v169
  v_mfma_f32_16x16x32_bf16 a[16:19], a[140:143], a[196:199], a[16:19]
  buffer_load_dwordx4 v27, s[56:59], s43 offen offset:3072  lds
  v_mfma_f32_16x16x32_bf16 a[0:3], a[132:135], a[196:199], a[0:3]
  s_add_u32 m0, s96, 0x1000
  ds_read_b128 a[236:239], v37 offset:2048
  v_mfma_f32_16x16x32_bf16 a[0:3], a[128:131], a[192:195], a[0:3]
  s_waitcnt lgkmcnt(10)
  v_mfma_f32_16x16x32_bf16 a[4:7], a[128:131], a[200:203], a[4:7]
  s_waitcnt lgkmcnt(8)
  buffer_load_dwordx4 v26, s[56:59], s44 offen offset:0  lds
  v_mfma_f32_16x16x32_bf16 a[4:7], a[132:135], a[204:207], a[4:7]
  v_cvt_pk_bf16_f32 v85, v170, v171
  v_mul_f32 v200, s83, v200
  v_mfma_f32_16x16x32_bf16 a[20:23], a[140:143], a[204:207], a[20:23]
  ds_read_b128 a[240:243], v36 offset:4096
  v_mul_f32 v201, s83, v201
  v_mfma_f32_16x16x32_bf16 a[20:23], a[136:139], a[200:203], a[20:23]
  buffer_load_dwordx4 v27, s[56:59], s45 offen offset:1024  lds
  v_mfma_f32_16x16x32_bf16 a[36:39], a[144:147], a[200:203], a[36:39]
  v_mul_f32 v202, s83, v202
  v_mul_f32 v203, s83, v203
  v_mfma_f32_16x16x32_bf16 a[36:39], a[148:151], a[204:207], a[36:39]
  v_cvt_pk_bf16_f32 v100, v200, v201
  v_cvt_pk_bf16_f32 v101, v202, v203
  v_mfma_f32_16x16x32_bf16 a[52:55], a[156:159], a[204:207], a[52:55]
  ds_read_b64_tr_b16 a[216:217], v41 offset:49152
  v_mfma_f32_16x16x32_bf16 a[52:55], a[152:155], a[200:203], a[52:55]
  buffer_load_dwordx4 v26, s[56:59], s46 offen offset:2048  lds
  v_mfma_f32_16x16x32_bf16 a[68:71], a[160:163], a[200:203], a[68:71]
  ds_read_b64_tr_b16 a[218:219], v41 offset:50176
  v_mul_f32 v232, s83, v232
  v_mfma_f32_16x16x32_bf16 a[68:71], a[164:167], a[204:207], a[68:71]
  ds_read_b64_tr_b16 a[220:221], v41 offset:57344
  v_mfma_f32_16x16x32_bf16 a[84:87], a[172:175], a[204:207], a[84:87]
  buffer_load_dwordx4 v27, s[56:59], s47 offen offset:3072  lds
  v_mfma_f32_16x16x32_bf16 a[84:87], a[168:171], a[200:203], a[84:87]
  ds_read_b64_tr_b16 a[222:223], v41 offset:58368
  v_xor_b32 v28, 0x80000, v28
  v_mfma_f32_16x16x32_bf16 a[100:103], a[176:179], a[200:203], a[100:103]
  ds_read_b128 a[244:247], v37 offset:4096
  v_xor_b32 v29, 0x80000, v29
  v_mfma_f32_16x16x32_bf16 a[100:103], a[180:183], a[204:207], a[100:103]
  s_add_u32 m0, s97, 0x14000
  ds_read_b128 a[248:251], v36 offset:6144
  v_mfma_f32_16x16x32_bf16 a[116:119], a[188:191], a[204:207], a[116:119]
  ds_read_b128 a[252:255], v37 offset:6144
  v_mfma_f32_16x16x32_bf16 a[116:119], a[184:187], a[200:203], a[116:119]
  s_waitcnt lgkmcnt(13)
  v_mfma_f32_16x16x32_bf16 a[120:123], a[184:187], a[208:211], a[120:123]
  s_waitcnt lgkmcnt(11)
  buffer_load_dwordx4 v28, s[60:63], s48 offen offset:0  lds
  v_mfma_f32_16x16x32_bf16 a[120:123], a[188:191], a[212:215], a[120:123]
  v_mul_f32 v233, s83, v233
  v_mul_f32 v234, s83, v234
  v_mfma_f32_16x16x32_bf16 a[104:107], a[180:183], a[212:215], a[104:107]
  v_mul_f32 v235, s83, v235
  v_cvt_pk_bf16_f32 v116, v232, v233
  v_mfma_f32_16x16x32_bf16 a[104:107], a[176:179], a[208:211], a[104:107]
  v_cvt_pk_bf16_f32 v117, v234, v235
  v_mfma_f32_16x16x32_bf16 a[88:91], a[168:171], a[208:211], a[88:91]
  v_mul_f32 v236, s83, v236
  v_mul_f32 v237, s83, v237
  v_mfma_f32_16x16x32_bf16 a[88:91], a[172:175], a[212:215], a[88:91]
  buffer_load_dwordx4 v28, s[60:63], s49 offen offset:1024  lds
  v_mfma_f32_16x16x32_bf16 a[72:75], a[164:167], a[212:215], a[72:75]
  v_mul_f32 v238, s83, v238
  v_mul_f32 v239, s83, v239
  v_mfma_f32_16x16x32_bf16 a[72:75], a[160:163], a[208:211], a[72:75]
  s_waitcnt vmcnt(15)
  v_mul_f32 v204, s83, v204
  v_mul_f32 v205, s83, v205
  v_mfma_f32_16x16x32_bf16 a[56:59], a[152:155], a[208:211], a[56:59]
  s_barrier
  v_mfma_f32_16x16x32_bf16 a[56:59], a[156:159], a[212:215], a[56:59]
  ds_read_b64_tr_b16 a[192:193], v42 offset:0
  v_mul_f32 v206, s83, v206
  v_mfma_f32_16x16x32_bf16 a[40:43], a[148:151], a[212:215], a[40:43]
  buffer_load_dwordx4 v29, s[60:63], s50 offen offset:2048  lds
  v_mfma_f32_16x16x32_bf16 a[40:43], a[144:147], a[208:211], a[40:43]
  ds_read_b64_tr_b16 a[194:195], v42 offset:1024
  v_mul_f32 v207, s83, v207
  v_mfma_f32_16x16x32_bf16 a[24:27], a[136:139], a[208:211], a[24:27]
  ds_read_b64_tr_b16 a[196:197], v42 offset:8192
  v_cvt_pk_bf16_f32 v118, v236, v237
  v_mfma_f32_16x16x32_bf16 a[24:27], a[140:143], a[212:215], a[24:27]
  ds_read_b64_tr_b16 a[198:199], v42 offset:9216
  v_cvt_pk_bf16_f32 v119, v238, v239
  v_mfma_f32_16x16x32_bf16 a[8:11], a[132:135], a[212:215], a[8:11]
  buffer_load_dwordx4 v29, s[60:63], s51 offen offset:3072  lds
  v_mfma_f32_16x16x32_bf16 a[8:11], a[128:131], a[208:211], a[8:11]
  s_waitcnt lgkmcnt(9)
  ds_read_b64_tr_b16 a[200:201], v43 offset:0
  v_xor_b32 v26, 0x180, v26
  v_mfma_f32_16x16x32_bf16 a[12:15], a[128:131], a[216:219], a[12:15]
  s_waitcnt lgkmcnt(8)
  ds_read_b64_tr_b16 a[202:203], v43 offset:1024
  v_xor_b32 v27, 0x180, v27
  v_mfma_f32_16x16x32_bf16 a[12:15], a[132:135], a[220:223], a[12:15]
  s_add_u32 m0, s96, 0x8000
  ds_read_b64_tr_b16 a[204:205], v43 offset:8192
  v_mul_f32 v172, s83, v172
  v_mfma_f32_16x16x32_bf16 a[28:31], a[140:143], a[220:223], a[28:31]
  ds_read_b64_tr_b16 a[206:207], v43 offset:9216
  v_mul_f32 v173, s83, v173
  v_mfma_f32_16x16x32_bf16 a[28:31], a[136:139], a[216:219], a[28:31]
  buffer_load_dwordx4 v26, s[56:59], s40 offen offset:0  lds
  v_mfma_f32_16x16x32_bf16 a[44:47], a[144:147], a[216:219], a[44:47]
  v_mul_f32 v174, s83, v174
  v_mul_f32 v175, s83, v175
  v_mfma_f32_16x16x32_bf16 a[44:47], a[148:151], a[220:223], a[44:47]
  v_cvt_pk_bf16_f32 v102, v204, v205
  v_cvt_pk_bf16_f32 v103, v206, v207
  v_mfma_f32_16x16x32_bf16 a[60:63], a[156:159], a[220:223], a[60:63]
  ds_read_b64_tr_b16 a[208:209], v44 offset:0
  v_mul_f32 v140, s83, v140
  v_mfma_f32_16x16x32_bf16 a[60:63], a[152:155], a[216:219], a[60:63]
  ds_read_b64_tr_b16 a[210:211], v44 offset:1024
  v_mul_f32 v141, s83, v141
  v_mfma_f32_16x16x32_bf16 a[76:79], a[160:163], a[216:219], a[76:79]
  buffer_load_dwordx4 v27, s[56:59], s41 offen offset:1024  lds
  v_mfma_f32_16x16x32_bf16 a[76:79], a[164:167], a[220:223], a[76:79]
  ds_read_b64_tr_b16 a[212:213], v44 offset:8192
  v_mul_f32 v142, s83, v142
  v_mfma_f32_16x16x32_bf16 a[92:95], a[172:175], a[220:223], a[92:95]
  ds_read_b64_tr_b16 a[214:215], v44 offset:9216
  v_mul_f32 v143, s83, v143
  v_mfma_f32_16x16x32_bf16 a[92:95], a[168:171], a[216:219], a[92:95]
  v_cvt_pk_bf16_f32 v86, v172, v173
  v_cvt_pk_bf16_f32 v87, v174, v175
  v_mfma_f32_16x16x32_bf16 a[108:111], a[176:179], a[216:219], a[108:111]
  v_cvt_pk_bf16_f32 v70, v140, v141
  v_cvt_pk_bf16_f32 v71, v142, v143
  v_mfma_f32_16x16x32_bf16 a[108:111], a[180:183], a[220:223], a[108:111]
  buffer_load_dwordx4 v26, s[56:59], s42 offen offset:2048  lds
  v_mfma_f32_16x16x32_bf16 a[124:127], a[188:191], a[220:223], a[124:127]
  v_cvt_pk_bf16_f32 v72, v144, v145
  v_cvt_pk_bf16_f32 v73, v146, v147
  v_mfma_f32_16x16x32_bf16 a[124:127], a[184:187], a[216:219], a[124:127]
  s_waitcnt lgkmcnt(10)
  v_cvt_pk_bf16_f32 v88, v176, v177
  v_cvt_pk_bf16_f32 v89, v178, v179
  v_mfma_f32_16x16x32_bf16 v[128:131], a[192:195], a[224:227], 0
  s_waitcnt lgkmcnt(8)
  ds_read_b64_tr_b16 a[216:217], v45 offset:0
  v_cvt_pk_bf16_f32 v104, v208, v209
  v_mfma_f32_16x16x32_bf16 v[128:131], a[196:199], a[228:231], v[128:131]
  buffer_load_dwordx4 v27, s[56:59], s43 offen offset:3072  lds
  v_mfma_f32_16x16x32_bf16 v[160:163], a[196:199], a[236:239], 0
  ds_read_b64_tr_b16 a[218:219], v45 offset:1024
  v_cvt_pk_bf16_f32 v105, v210, v211
  v_mfma_f32_16x16x32_bf16 v[160:163], a[192:195], a[232:235], v[160:163]
  s_add_u32 m0, s96, 0x9000
  ds_read_b64_tr_b16 a[220:221], v45 offset:8192
  v_cvt_pk_bf16_f32 v120, v240, v241
  v_mfma_f32_16x16x32_bf16 v[192:195], a[192:195], a[240:243], 0
  ds_read_b64_tr_b16 a[222:223], v45 offset:9216
  v_cvt_pk_bf16_f32 v121, v242, v243
  v_mfma_f32_16x16x32_bf16 v[192:195], a[196:199], a[244:247], v[192:195]
  s_waitcnt vmcnt(8)
  ds_read_b128 a[160:163], v34 offset:0
  v_cvt_pk_bf16_f32 v122, v244, v245
  v_mfma_f32_16x16x32_bf16 v[224:227], a[196:199], a[252:255], 0
  buffer_load_dwordx4 v26, s[56:59], s44 offen offset:0  lds
  v_mfma_f32_16x16x32_bf16 v[224:227], a[192:195], a[248:251], v[224:227]
  s_waitcnt lgkmcnt(11)
  ds_read_b128 a[164:167], v35 offset:0
  v_cvt_pk_bf16_f32 v123, v246, v247
  v_mfma_f32_16x16x32_bf16 v[228:231], a[200:203], a[248:251], 0
  s_waitcnt lgkmcnt(10)
  ds_read_b64_tr_b16 a[192:193], v46 offset:0
  v_cvt_pk_bf16_f32 v106, v212, v213
  v_mfma_f32_16x16x32_bf16 v[228:231], a[204:207], a[252:255], v[228:231]
  ds_read_b64_tr_b16 a[194:195], v46 offset:1024
  v_cvt_pk_bf16_f32 v107, v214, v215
  v_mfma_f32_16x16x32_bf16 v[196:199], a[204:207], a[244:247], 0
  ds_read_b64_tr_b16 a[196:197], v46 offset:8192
  v_cvt_pk_bf16_f32 v90, v180, v181
  v_mfma_f32_16x16x32_bf16 v[196:199], a[200:203], a[240:243], v[196:199]
  buffer_load_dwordx4 v27, s[56:59], s45 offen offset:1024  lds
  v_mfma_f32_16x16x32_bf16 v[164:167], a[200:203], a[232:235], 0
  ds_read_b64_tr_b16 a[198:199], v46 offset:9216
  v_cvt_pk_bf16_f32 v91, v182, v183
  v_mfma_f32_16x16x32_bf16 v[164:167], a[204:207], a[236:239], v[164:167]
  ds_read_b128 a[168:171], v34 offset:2048
  v_cvt_pk_bf16_f32 v74, v148, v149
  v_mfma_f32_16x16x32_bf16 v[132:135], a[204:207], a[228:231], 0
  ds_read_b128 a[172:175], v35 offset:2048
  v_cvt_pk_bf16_f32 v75, v150, v151
  v_mfma_f32_16x16x32_bf16 v[132:135], a[200:203], a[224:227], v[132:135]
  s_waitcnt lgkmcnt(14)
  buffer_load_dwordx4 v26, s[56:59], s46 offen offset:2048  lds
  v_mfma_f32_16x16x32_bf16 v[136:139], a[208:211], a[224:227], 0
  s_waitcnt lgkmcnt(12)
  ds_read_b64_tr_b16 a[200:201], v47 offset:0
  v_mul_f32 v152, s83, v152
  v_mfma_f32_16x16x32_bf16 v[136:139], a[212:215], a[228:231], v[136:139]
  ds_read_b64_tr_b16 a[202:203], v47 offset:1024
  v_mul_f32 v153, s83, v153
  v_mfma_f32_16x16x32_bf16 v[168:171], a[212:215], a[236:239], 0
  ds_read_b64_tr_b16 a[204:205], v47 offset:8192
  v_mul_f32 v154, s83, v154
  v_mfma_f32_16x16x32_bf16 v[168:171], a[208:211], a[232:235], v[168:171]
  ds_read_b64_tr_b16 a[206:207], v47 offset:9216
  v_mul_f32 v155, s83, v155
  v_mfma_f32_16x16x32_bf16 v[200:203], a[208:211], a[240:243], 0
  buffer_load_dwordx4 v27, s[56:59], s47 offen offset:3072  lds
  v_mfma_f32_16x16x32_bf16 v[200:203], a[212:215], a[244:247], v[200:203]
  ds_read_b128 a[176:179], v34 offset:4096
  v_cvt_pk_bf16_f32 v76, v152, v153
  v_mfma_f32_16x16x32_bf16 v[232:235], a[212:215], a[252:255], 0
  s_mov_b32 s3, 0x0
  ds_read_b128 a[180:183], v35 offset:4096
  v_cvt_pk_bf16_f32 v77, v154, v155
  v_mfma_f32_16x16x32_bf16 v[232:235], a[208:211], a[248:251], v[232:235]
  s_waitcnt lgkmcnt(15)
  v_mul_f32 v184, s83, v184
  v_mul_f32 v185, s83, v185
  v_mfma_f32_16x16x32_bf16 v[236:239], a[216:219], a[248:251], 0
  ds_read_b64_tr_b16 a[208:209], v48 offset:0
  v_mul_f32 v186, s83, v186
  s_waitcnt lgkmcnt(15)
  v_mfma_f32_16x16x32_bf16 v[236:239], a[220:223], a[252:255], v[236:239]
  buffer_store_dwordx4 v[64:67], v11, s[16:19], s3 offen offset:0 sc1
  v_mfma_f32_16x16x32_bf16 v[204:207], a[220:223], a[244:247], 0
  ds_read_b64_tr_b16 a[210:211], v48 offset:1024
  v_xor_b32 v28, 0x180000, v28
  v_mfma_f32_16x16x32_bf16 v[204:207], a[216:219], a[240:243], v[204:207]
  ds_read_b64_tr_b16 a[212:213], v48 offset:8192
  v_xor_b32 v29, 0x180000, v29
  v_mfma_f32_16x16x32_bf16 v[172:175], a[216:219], a[232:235], 0
  s_add_u32 m0, s97, 0x18000
  ds_read_b64_tr_b16 a[214:215], v48 offset:9216
  v_mul_f32 v187, s83, v187
  v_mfma_f32_16x16x32_bf16 v[172:175], a[220:223], a[236:239], v[172:175]
  ds_read_b128 a[184:187], v34 offset:6144
  v_cvt_pk_bf16_f32 v92, v184, v185
  v_mfma_f32_16x16x32_bf16 v[140:143], a[220:223], a[228:231], 0
  v_cvt_pk_bf16_f32 v93, v186, v187
  v_mul_f32 v216, s83, v216
  v_mfma_f32_16x16x32_bf16 v[140:143], a[216:219], a[224:227], v[140:143]
  s_waitcnt lgkmcnt(15)
  buffer_load_dwordx4 v28, s[60:63], s48 offen offset:0  lds
  v_mfma_f32_16x16x32_bf16 v[144:147], a[192:195], a[224:227], 0
  s_waitcnt lgkmcnt(13)
  ds_read_b64_tr_b16 a[216:217], v49 offset:0
  v_mul_f32 v217, s83, v217
  v_mfma_f32_16x16x32_bf16 v[144:147], a[196:199], a[228:231], v[144:147]
  ds_read_b64_tr_b16 a[218:219], v49 offset:1024
  v_mul_f32 v218, s83, v218
  v_mfma_f32_16x16x32_bf16 v[176:179], a[196:199], a[236:239], 0
  ds_read_b64_tr_b16 a[220:221], v49 offset:8192
  v_mul_f32 v219, s83, v219
  v_mfma_f32_16x16x32_bf16 v[176:179], a[192:195], a[232:235], v[176:179]
  buffer_load_dwordx4 v28, s[60:63], s49 offen offset:1024  lds
  v_mfma_f32_16x16x32_bf16 v[208:211], a[192:195], a[240:243], 0
  ds_read_b64_tr_b16 a[222:223], v49 offset:9216
  v_cvt_pk_bf16_f32 v108, v216, v217
  v_mfma_f32_16x16x32_bf16 v[208:211], a[196:199], a[244:247], v[208:211]
  v_cvt_pk_bf16_f32 v109, v218, v219
  v_mul_f32 v248, s83, v248
  v_mfma_f32_16x16x32_bf16 v[240:243], a[196:199], a[252:255], 0
  v_mul_f32 v249, s83, v249
  v_mul_f32 v250, s83, v250
  v_mfma_f32_16x16x32_bf16 v[240:243], a[192:195], a[248:251], v[240:243]
  s_waitcnt vmcnt(11) lgkmcnt(13)
  ds_read_b128 a[188:191], v35 offset:6144
  v_mul_f32 v251, s83, v251
  v_mfma_f32_16x16x32_bf16 v[244:247], a[200:203], a[248:251], 0
  s_barrier
  s_waitcnt lgkmcnt(12)
  v_mfma_f32_16x16x32_bf16 v[244:247], a[204:207], a[252:255], v[244:247]
  buffer_load_dwordx4 v29, s[60:63], s50 offen offset:2048  lds
  v_mfma_f32_16x16x32_bf16 v[212:215], a[204:207], a[244:247], 0
  v_cvt_pk_bf16_f32 v124, v248, v249
  v_cvt_pk_bf16_f32 v125, v250, v251
  v_mfma_f32_16x16x32_bf16 v[212:215], a[200:203], a[240:243], v[212:215]
  v_mul_f32 v252, s83, v252
  v_mul_f32 v253, s83, v253
  v_mfma_f32_16x16x32_bf16 v[180:183], a[200:203], a[232:235], 0
  v_mul_f32 v254, s83, v254
  v_mul_f32 v255, s83, v255
  v_mfma_f32_16x16x32_bf16 v[180:183], a[204:207], a[236:239], v[180:183]
  buffer_load_dwordx4 v29, s[60:63], s51 offen offset:3072  lds
  v_mfma_f32_16x16x32_bf16 v[148:151], a[204:207], a[228:231], 0
  ds_read_b64_tr_b16 a[192:193], v42 offset:16384
  v_mul_f32 v220, s83, v220
  v_mfma_f32_16x16x32_bf16 v[148:151], a[200:203], a[224:227], v[148:151]
  s_waitcnt lgkmcnt(9)
  s_mov_b32 s3, 0x0
  ds_read_b64_tr_b16 a[194:195], v42 offset:17408
  v_mul_f32 v221, s83, v221
  v_mfma_f32_16x16x32_bf16 v[152:155], a[208:211], a[224:227], 0
  s_waitcnt lgkmcnt(8)
  v_mul_f32 v222, s83, v222
  v_mul_f32 v223, s83, v223
  v_mfma_f32_16x16x32_bf16 v[152:155], a[212:215], a[228:231], v[152:155]
  v_cvt_pk_bf16_f32 v126, v252, v253
  v_cvt_pk_bf16_f32 v127, v254, v255
  v_mfma_f32_16x16x32_bf16 v[184:187], a[212:215], a[236:239], 0
  buffer_store_dwordx4 v[68:71], v11, s[16:19], s3 offen offset:1024 sc1
  v_mfma_f32_16x16x32_bf16 v[184:187], a[208:211], a[232:235], v[184:187]
  ds_read_b64_tr_b16 a[196:197], v42 offset:24576
  v_xor_b32 v26, 0x80, v26
  v_mfma_f32_16x16x32_bf16 v[216:219], a[208:211], a[240:243], 0
  ds_read_b64_tr_b16 a[198:199], v42 offset:25600
  v_xor_b32 v27, 0x80, v27
  v_mfma_f32_16x16x32_bf16 v[216:219], a[212:215], a[244:247], v[216:219]
  s_add_u32 m0, s96, 0x20000
  v_mul_f32 v188, s83, v188
  v_mul_f32 v189, s83, v189
  v_mfma_f32_16x16x32_bf16 v[248:251], a[212:215], a[252:255], 0
  v_mul_f32 v190, s83, v190
  v_mul_f32 v191, s83, v191
  v_mfma_f32_16x16x32_bf16 v[248:251], a[208:211], a[248:251], v[248:251]
  s_waitcnt lgkmcnt(7)
  v_cvt_pk_bf16_f32 v110, v220, v221
  v_cvt_pk_bf16_f32 v111, v222, v223
  v_mfma_f32_16x16x32_bf16 v[252:255], a[216:219], a[248:251], 0
  s_waitcnt lgkmcnt(5)
  buffer_load_dwordx4 v26, s[56:59], s40 offen offset:0  lds
  v_mfma_f32_16x16x32_bf16 v[252:255], a[220:223], a[252:255], v[252:255]
  v_mul_f32 v156, s83, v156
  v_mul_f32 v157, s83, v157
  v_mfma_f32_16x16x32_bf16 v[220:223], a[220:223], a[244:247], 0
  v_mul_f32 v158, s83, v158
  v_mul_f32 v159, s83, v159
  v_mfma_f32_16x16x32_bf16 v[220:223], a[216:219], a[240:243], v[220:223]
  v_cvt_pk_bf16_f32 v94, v188, v189
  v_cvt_pk_bf16_f32 v95, v190, v191
  v_mfma_f32_16x16x32_bf16 v[188:191], a[216:219], a[232:235], 0
  buffer_load_dwordx4 v27, s[56:59], s41 offen offset:1024  lds
  v_mfma_f32_16x16x32_bf16 v[188:191], a[220:223], a[236:239], v[188:191]
  v_cvt_pk_bf16_f32 v78, v156, v157
  v_cvt_pk_bf16_f32 v79, v158, v159
  v_mfma_f32_16x16x32_bf16 v[156:159], a[220:223], a[228:231], 0
  ds_read_b64_tr_b16 a[200:201], v43 offset:16384
  v_mfma_f32_16x16x32_bf16 v[156:159], a[216:219], a[224:227], v[156:159]
  s_waitcnt lgkmcnt(3)
  ds_read_b64_tr_b16 a[202:203], v43 offset:17408
  v_mfma_f32_16x16x32_bf16 v[128:131], a[192:195], a[160:163], v[128:131]
  s_waitcnt lgkmcnt(2)
  ds_read_b64_tr_b16 a[204:205], v43 offset:24576
  v_mfma_f32_16x16x32_bf16 v[128:131], a[196:199], a[164:167], v[128:131]
  ds_read_b64_tr_b16 a[206:207], v43 offset:25600
  v_mfma_f32_16x16x32_bf16 v[160:163], a[196:199], a[172:175], v[160:163]
  buffer_load_dwordx4 v26, s[56:59], s42 offen offset:2048  lds
  v_mfma_f32_16x16x32_bf16 v[160:163], a[192:195], a[168:171], v[160:163]
  ds_read_b64_tr_b16 a[208:209], v44 offset:16384
  v_mfma_f32_16x16x32_bf16 v[192:195], a[192:195], a[176:179], v[192:195]
  ds_read_b64_tr_b16 a[210:211], v44 offset:17408
  v_mfma_f32_16x16x32_bf16 v[192:195], a[196:199], a[180:183], v[192:195]
  ds_read_b64_tr_b16 a[212:213], v44 offset:24576
  v_mfma_f32_16x16x32_bf16 v[224:227], a[196:199], a[188:191], v[224:227]
  buffer_load_dwordx4 v27, s[56:59], s43 offen offset:3072  lds
  v_mfma_f32_16x16x32_bf16 v[224:227], a[192:195], a[184:187], v[224:227]
  s_waitcnt lgkmcnt(5)
  s_add_u32 m0, s96, 0x21000
  ds_read_b64_tr_b16 a[214:215], v44 offset:25600
  v_mfma_f32_16x16x32_bf16 v[228:231], a[200:203], a[184:187], v[228:231]
  s_waitcnt lgkmcnt(4)
  ds_read_b64_tr_b16 a[216:217], v45 offset:16384
  v_mfma_f32_16x16x32_bf16 v[228:231], a[204:207], a[188:191], v[228:231]
  ds_read_b64_tr_b16 a[218:219], v45 offset:17408
  v_mfma_f32_16x16x32_bf16 v[196:199], a[204:207], a[180:183], v[196:199]
  buffer_load_dwordx4 v26, s[56:59], s44 offen offset:0  lds
  v_mfma_f32_16x16x32_bf16 v[196:199], a[200:203], a[176:179], v[196:199]
  ds_read_b64_tr_b16 a[220:221], v45 offset:24576
  v_mfma_f32_16x16x32_bf16 v[164:167], a[200:203], a[168:171], v[164:167]
  ds_read_b64_tr_b16 a[222:223], v45 offset:25600
  v_mfma_f32_16x16x32_bf16 v[164:167], a[204:207], a[172:175], v[164:167]
  ds_read_b64_tr_b16 a[192:193], v46 offset:16384
  v_mfma_f32_16x16x32_bf16 v[132:135], a[204:207], a[164:167], v[132:135]
  ds_read_b64_tr_b16 a[194:195], v46 offset:17408
  v_mfma_f32_16x16x32_bf16 v[132:135], a[200:203], a[160:163], v[132:135]
  s_waitcnt lgkmcnt(8)
  buffer_load_dwordx4 v27, s[56:59], s45 offen offset:1024  lds
  v_mfma_f32_16x16x32_bf16 v[136:139], a[208:211], a[160:163], v[136:139]
  s_waitcnt lgkmcnt(6)
  ds_read_b64_tr_b16 a[196:197], v46 offset:24576
  v_mfma_f32_16x16x32_bf16 v[136:139], a[212:215], a[164:167], v[136:139]
  s_waitcnt vmcnt(12)
  ds_read_b128 a[224:227], v34 offset:32768
  v_mfma_f32_16x16x32_bf16 v[168:171], a[212:215], a[172:175], v[168:171]
  ds_read_b64_tr_b16 a[198:199], v46 offset:25600
  v_mfma_f32_16x16x32_bf16 v[168:171], a[208:211], a[168:171], v[168:171]
  ds_read_b128 a[228:231], v35 offset:32768
  v_mfma_f32_16x16x32_bf16 v[200:203], a[208:211], a[176:179], v[200:203]
  buffer_load_dwordx4 v26, s[56:59], s46 offen offset:2048  lds
  v_mfma_f32_16x16x32_bf16 v[200:203], a[212:215], a[180:183], v[200:203]
  ds_read_b64_tr_b16 a[200:201], v47 offset:16384
  v_mfma_f32_16x16x32_bf16 v[232:235], a[212:215], a[188:191], v[232:235]
  ds_read_b64_tr_b16 a[202:203], v47 offset:17408
  v_mfma_f32_16x16x32_bf16 v[232:235], a[208:211], a[184:187], v[232:235]
  s_waitcnt lgkmcnt(10)
  ds_read_b64_tr_b16 a[204:205], v47 offset:24576
  v_mfma_f32_16x16x32_bf16 v[236:239], a[216:219], a[184:187], v[236:239]
  s_waitcnt lgkmcnt(9)
  buffer_load_dwordx4 v27, s[56:59], s47 offen offset:3072  lds
  v_mfma_f32_16x16x32_bf16 v[236:239], a[220:223], a[188:191], v[236:239]
  ds_read_b128 a[232:235], v34 offset:34816
  v_mfma_f32_16x16x32_bf16 v[204:207], a[220:223], a[180:183], v[204:207]
  s_mov_b32 s3, 0x1000
  ds_read_b64_tr_b16 a[206:207], v47 offset:25600
  v_mfma_f32_16x16x32_bf16 v[204:207], a[216:219], a[176:179], v[204:207]
  ds_read_b128 a[236:239], v35 offset:34816
  v_mfma_f32_16x16x32_bf16 v[172:175], a[216:219], a[168:171], v[172:175]
  ds_read_b64_tr_b16 a[208:209], v48 offset:16384
  v_mfma_f32_16x16x32_bf16 v[172:175], a[220:223], a[172:175], v[172:175]
  buffer_store_dwordx4 v[72:75], v11, s[16:19], s3 offen offset:0 sc1
  v_mfma_f32_16x16x32_bf16 v[140:143], a[220:223], a[164:167], v[140:143]
  ds_read_b64_tr_b16 a[210:211], v48 offset:17408
  v_xor_b32 v28, 0x80000, v28
  v_mfma_f32_16x16x32_bf16 v[140:143], a[216:219], a[160:163], v[140:143]
  s_waitcnt lgkmcnt(12)
  ds_read_b64_tr_b16 a[212:213], v48 offset:24576
  v_xor_b32 v29, 0x80000, v29
  v_mfma_f32_16x16x32_bf16 v[144:147], a[192:195], a[160:163], v[144:147]
  s_waitcnt lgkmcnt(10)
  s_add_u32 m0, s97, 0x1c000
  ds_read_b128 a[240:243], v34 offset:36864
  v_mfma_f32_16x16x32_bf16 v[144:147], a[196:199], a[164:167], v[144:147]
  ds_read_b64_tr_b16 a[214:215], v48 offset:25600
  v_mfma_f32_16x16x32_bf16 v[176:179], a[196:199], a[172:175], v[176:179]
  ds_read_b128 a[244:247], v35 offset:36864
  v_mfma_f32_16x16x32_bf16 v[176:179], a[192:195], a[168:171], v[176:179]
  buffer_load_dwordx4 v28, s[60:63], s48 offen offset:0  lds
  v_mfma_f32_16x16x32_bf16 v[208:211], a[192:195], a[176:179], v[208:211]
  ds_read_b64_tr_b16 a[216:217], v49 offset:16384
  v_mfma_f32_16x16x32_bf16 v[208:211], a[196:199], a[180:183], v[208:211]
  ds_read_b64_tr_b16 a[218:219], v49 offset:17408
  v_mfma_f32_16x16x32_bf16 v[240:243], a[196:199], a[188:191], v[240:243]
  ds_read_b64_tr_b16 a[220:221], v49 offset:24576
  v_mfma_f32_16x16x32_bf16 v[240:243], a[192:195], a[184:187], v[240:243]
  s_waitcnt vmcnt(11) lgkmcnt(13)
  ds_read_b128 a[248:251], v34 offset:38912
  v_mfma_f32_16x16x32_bf16 v[244:247], a[200:203], a[184:187], v[244:247]
  s_barrier
  s_waitcnt lgkmcnt(11)
  v_mfma_f32_16x16x32_bf16 v[244:247], a[204:207], a[188:191], v[244:247]
  buffer_load_dwordx4 v28, s[60:63], s49 offen offset:1024  lds
  v_mfma_f32_16x16x32_bf16 v[212:215], a[204:207], a[180:183], v[212:215]
  ds_read_b64_tr_b16 a[222:223], v49 offset:25600
  v_mov_b32 v19, 0x30000
  v_mfma_f32_16x16x32_bf16 v[212:215], a[200:203], a[176:179], v[212:215]
  ds_read_b128 a[252:255], v35 offset:38912
  v_mfma_f32_16x16x32_bf16 v[180:183], a[200:203], a[168:171], v[180:183]
  ds_read_b64_tr_b16 a[192:193], v42 offset:32768
  v_mfma_f32_16x16x32_bf16 v[180:183], a[204:207], a[172:175], v[180:183]
  buffer_load_dwordx4 v29, s[60:63], s50 offen offset:2048  lds
  v_mfma_f32_16x16x32_bf16 v[148:151], a[204:207], a[164:167], v[148:151]
  ds_read_b64_tr_b16 a[194:195], v42 offset:33792
  v_mfma_f32_16x16x32_bf16 v[148:151], a[200:203], a[160:163], v[148:151]
  s_waitcnt lgkmcnt(12)
  ds_read_b64_tr_b16 a[196:197], v42 offset:40960
  v_mfma_f32_16x16x32_bf16 v[152:155], a[208:211], a[160:163], v[152:155]
  s_waitcnt lgkmcnt(10)
  ds_read_b64_tr_b16 a[198:199], v42 offset:41984
  v_mfma_f32_16x16x32_bf16 v[152:155], a[212:215], a[164:167], v[152:155]
  buffer_load_dwordx4 v29, s[60:63], s51 offen offset:3072  lds
  v_mfma_f32_16x16x32_bf16 v[184:187], a[212:215], a[172:175], v[184:187]
  ds_read_b64_tr_b16 a[200:201], v43 offset:32768
  v_xor_b32 v26, 0x380, v26
  v_mfma_f32_16x16x32_bf16 v[184:187], a[208:211], a[168:171], v[184:187]
  ds_read_b64_tr_b16 a[202:203], v43 offset:33792
  v_xor_b32 v27, 0x380, v27
  v_mfma_f32_16x16x32_bf16 v[216:219], a[208:211], a[176:179], v[216:219]
  s_add_u32 m0, s96, 0x0
  ds_read_b64_tr_b16 a[204:205], v43 offset:40960
  v_mfma_f32_16x16x32_bf16 v[216:219], a[212:215], a[180:183], v[216:219]
  ds_read_b64_tr_b16 a[206:207], v43 offset:41984
  v_mfma_f32_16x16x32_bf16 v[248:251], a[212:215], a[188:191], v[248:251]
  buffer_load_dwordx4 v26, s[56:59], s40 offen offset:0  lds
  v_mfma_f32_16x16x32_bf16 v[248:251], a[208:211], a[184:187], v[248:251]
  s_waitcnt lgkmcnt(12)
  v_mfma_f32_16x16x32_bf16 v[252:255], a[216:219], a[184:187], v[252:255]
  s_waitcnt lgkmcnt(9)
  ds_read_b64_tr_b16 a[208:209], v44 offset:32768
  v_mfma_f32_16x16x32_bf16 v[252:255], a[220:223], a[188:191], v[252:255]
  ds_read_b64_tr_b16 a[210:211], v44 offset:33792
  v_mfma_f32_16x16x32_bf16 v[220:223], a[220:223], a[180:183], v[220:223]
  ds_read_b64_tr_b16 a[212:213], v44 offset:40960
  v_mfma_f32_16x16x32_bf16 v[220:223], a[216:219], a[176:179], v[220:223]
  buffer_load_dwordx4 v27, s[56:59], s41 offen offset:1024  lds
  v_mfma_f32_16x16x32_bf16 v[188:191], a[216:219], a[168:171], v[188:191]
  ds_read_b64_tr_b16 a[214:215], v44 offset:41984
  v_mfma_f32_16x16x32_bf16 v[188:191], a[220:223], a[172:175], v[188:191]
  v_mfma_f32_16x16x32_bf16 v[156:159], a[220:223], a[164:167], v[156:159]
  v_mfma_f32_16x16x32_bf16 v[156:159], a[216:219], a[160:163], v[156:159]
  s_waitcnt lgkmcnt(10)
  buffer_load_dwordx4 v26, s[56:59], s42 offen offset:2048  lds
  v_mfma_f32_16x16x32_bf16 v[128:131], a[192:195], a[224:227], v[128:131]
  s_waitcnt lgkmcnt(8)
  ds_read_b64_tr_b16 a[216:217], v45 offset:32768
  v_mfma_f32_16x16x32_bf16 v[128:131], a[196:199], a[228:231], v[128:131]
  ds_read_b64_tr_b16 a[218:219], v45 offset:33792
  v_mfma_f32_16x16x32_bf16 v[160:163], a[196:199], a[236:239], v[160:163]
  ds_read_b64_tr_b16 a[220:221], v45 offset:40960
  v_mfma_f32_16x16x32_bf16 v[160:163], a[192:195], a[232:235], v[160:163]
  buffer_load_dwordx4 v27, s[56:59], s43 offen offset:3072  lds
  v_mfma_f32_16x16x32_bf16 v[192:195], a[192:195], a[240:243], v[192:195]
  s_add_u32 m0, s96, 0x1000
  ds_read_b64_tr_b16 a[222:223], v45 offset:41984
  v_mfma_f32_16x16x32_bf16 v[192:195], a[196:199], a[244:247], v[192:195]
  s_waitcnt vmcnt(9)
  ds_read_b128 a[160:163], v36 offset:0
  v_mfma_f32_16x16x32_bf16 v[224:227], a[196:199], a[252:255], v[224:227]
  buffer_load_dwordx4 v26, s[56:59], s44 offen offset:0  lds
  v_mfma_f32_16x16x32_bf16 v[224:227], a[192:195], a[248:251], v[224:227]
  s_waitcnt lgkmcnt(11)
  ds_read_b128 a[164:167], v37 offset:0
  v_mfma_f32_16x16x32_bf16 v[228:231], a[200:203], a[248:251], v[228:231]
  s_waitcnt lgkmcnt(10)
  ds_read_b64_tr_b16 a[192:193], v46 offset:32768
  v_mfma_f32_16x16x32_bf16 v[228:231], a[204:207], a[252:255], v[228:231]
  buffer_load_dwordx4 v27, s[56:59], s45 offen offset:1024  lds
  v_mfma_f32_16x16x32_bf16 v[196:199], a[204:207], a[244:247], v[196:199]
L_pad5:
  s_cbranch_execz L_hr0
  ds_read_b64_tr_b16 a[194:195], v46 offset:33792
  v_mfma_f32_16x16x32_bf16 v[196:199], a[200:203], a[240:243], v[196:199]
  ds_read_b64_tr_b16 a[196:197], v46 offset:40960
  v_mfma_f32_16x16x32_bf16 v[164:167], a[200:203], a[232:235], v[164:167]
  buffer_load_dwordx4 v26, s[56:59], s46 offen offset:2048  lds
  v_mfma_f32_16x16x32_bf16 v[164:167], a[204:207], a[236:239], v[164:167]
  ds_read_b64_tr_b16 a[198:199], v46 offset:41984
  v_mfma_f32_16x16x32_bf16 v[132:135], a[204:207], a[228:231], v[132:135]
  ds_read_b128 a[168:171], v36 offset:2048
  v_mfma_f32_16x16x32_bf16 v[132:135], a[200:203], a[224:227], v[132:135]
  s_waitcnt lgkmcnt(13)
  buffer_load_dwordx4 v27, s[56:59], s47 offen offset:3072  lds
  v_mfma_f32_16x16x32_bf16 v[136:139], a[208:211], a[224:227], v[136:139]
  s_waitcnt lgkmcnt(11)
  s_mov_b32 s3, 0x1000
  ds_read_b64_tr_b16 a[200:201], v47 offset:32768
  v_mfma_f32_16x16x32_bf16 v[136:139], a[212:215], a[228:231], v[136:139]
  ds_read_b64_tr_b16 a[202:203], v47 offset:33792
  v_mfma_f32_16x16x32_bf16 v[168:171], a[212:215], a[236:239], v[168:171]
  buffer_store_dwordx4 v[76:79], v11, s[16:19], s3 offen offset:1024 sc1
  v_mfma_f32_16x16x32_bf16 v[168:171], a[208:211], a[232:235], v[168:171]
  ds_read_b64_tr_b16 a[204:205], v47 offset:40960
  v_xor_b32 v28, 0x380000, v28
  v_mfma_f32_16x16x32_bf16 v[200:203], a[208:211], a[240:243], v[200:203]
  ds_read_b64_tr_b16 a[206:207], v47 offset:41984
  v_xor_b32 v29, 0x380000, v29
  v_mfma_f32_16x16x32_bf16 v[200:203], a[212:215], a[244:247], v[200:203]
  s_add_u32 m0, s97, 0x10000
  ds_read_b128 a[172:175], v37 offset:2048
  v_mfma_f32_16x16x32_bf16 v[232:235], a[212:215], a[252:255], v[232:235]
  buffer_load_dwordx4 v28, s[60:63], s48 offen offset:0  lds
  v_mfma_f32_16x16x32_bf16 v[232:235], a[208:211], a[248:251], v[232:235]
  ds_read_b128 a[176:179], v36 offset:4096
  s_waitcnt lgkmcnt(15)
  v_mfma_f32_16x16x32_bf16 v[236:239], a[216:219], a[248:251], v[236:239]
  s_waitcnt lgkmcnt(13)
  ds_read_b64_tr_b16 a[208:209], v48 offset:32768
  v_mfma_f32_16x16x32_bf16 v[236:239], a[220:223], a[252:255], v[236:239]
  buffer_load_dwordx4 v28, s[60:63], s49 offen offset:1024  lds
  v_mfma_f32_16x16x32_bf16 v[204:207], a[220:223], a[244:247], v[204:207]
  ds_read_b64_tr_b16 a[210:211], v48 offset:33792
  v_mfma_f32_16x16x32_bf16 v[204:207], a[216:219], a[240:243], v[204:207]
  ds_read_b64_tr_b16 a[212:213], v48 offset:40960
  v_mfma_f32_16x16x32_bf16 v[172:175], a[216:219], a[232:235], v[172:175]
  ds_read_b64_tr_b16 a[214:215], v48 offset:41984
  v_mfma_f32_16x16x32_bf16 v[172:175], a[220:223], a[236:239], v[172:175]
  ds_read_b128 a[180:183], v37 offset:4096
  v_mfma_f32_16x16x32_bf16 v[140:143], a[220:223], a[228:231], v[140:143]
  buffer_load_dwordx4 v29, s[60:63], s50 offen offset:2048  lds
  v_mfma_f32_16x16x32_bf16 v[140:143], a[216:219], a[224:227], v[140:143]
  ds_read_b128 a[184:187], v36 offset:6144
  s_waitcnt lgkmcnt(15)
  v_mfma_f32_16x16x32_bf16 v[144:147], a[192:195], a[224:227], v[144:147]
  s_waitcnt lgkmcnt(13)
  ds_read_b64_tr_b16 a[216:217], v49 offset:32768
  v_mfma_f32_16x16x32_bf16 v[144:147], a[196:199], a[228:231], v[144:147]
  ds_read_b64_tr_b16 a[218:219], v49 offset:33792
  v_mfma_f32_16x16x32_bf16 v[176:179], a[196:199], a[236:239], v[176:179]
  ds_read_b64_tr_b16 a[220:221], v49 offset:40960
  v_mfma_f32_16x16x32_bf16 v[176:179], a[192:195], a[232:235], v[176:179]
  buffer_load_dwordx4 v29, s[60:63], s51 offen offset:3072  lds
  v_mfma_f32_16x16x32_bf16 v[208:211], a[192:195], a[240:243], v[208:211]
  s_mov_b32 s3, 0x2000
  ds_read_b64_tr_b16 a[222:223], v49 offset:41984
  v_mfma_f32_16x16x32_bf16 v[208:211], a[196:199], a[244:247], v[208:211]
  ds_read_b128 a[188:191], v37 offset:6144
  v_mfma_f32_16x16x32_bf16 v[240:243], a[196:199], a[252:255], v[240:243]
  ds_read_b128 a[128:131], v19
  v_mfma_f32_16x16x32_bf16 v[240:243], a[192:195], a[248:251], v[240:243]
  s_waitcnt vmcnt(13) lgkmcnt(15)
  buffer_store_dwordx4 v[80:83], v11, s[16:19], s3 offen offset:0 sc1
  v_mfma_f32_16x16x32_bf16 v[244:247], a[200:203], a[248:251], v[244:247]
  s_barrier
  s_waitcnt lgkmcnt(14)
  v_mfma_f32_16x16x32_bf16 v[244:247], a[204:207], a[252:255], v[244:247]
  ds_read_b64_tr_b16 a[192:193], v42 offset:49152
  v_xor_b32 v26, 0x80, v26
  v_mfma_f32_16x16x32_bf16 v[212:215], a[204:207], a[244:247], v[212:215]
  ds_read_b64_tr_b16 a[194:195], v42 offset:50176
  v_xor_b32 v27, 0x80, v27
  v_mfma_f32_16x16x32_bf16 v[212:215], a[200:203], a[240:243], v[212:215]
  s_add_u32 m0, s96, 0x8000
  ds_read_b64_tr_b16 a[196:197], v42 offset:57344
  v_mfma_f32_16x16x32_bf16 v[180:183], a[200:203], a[232:235], v[180:183]
  ds_read_b64_tr_b16 a[198:199], v42 offset:58368
  v_mfma_f32_16x16x32_bf16 v[180:183], a[204:207], a[236:239], v[180:183]
  buffer_load_dwordx4 v26, s[56:59], s40 offen offset:0  lds
  v_mfma_f32_16x16x32_bf16 v[148:151], a[204:207], a[228:231], v[148:151]
  ds_read_b128 a[132:135], v19
  v_mfma_f32_16x16x32_bf16 v[148:151], a[200:203], a[224:227], v[148:151]
  ds_read_b128 a[136:139], v19
  s_waitcnt lgkmcnt(15)
  v_mfma_f32_16x16x32_bf16 v[152:155], a[208:211], a[224:227], v[152:155]
  ds_read_b64_tr_b16 a[200:201], v43 offset:49152
  s_waitcnt lgkmcnt(15)
  v_mfma_f32_16x16x32_bf16 v[152:155], a[212:215], a[228:231], v[152:155]
  ds_read_b64_tr_b16 a[202:203], v43 offset:50176
  v_mfma_f32_16x16x32_bf16 v[184:187], a[212:215], a[236:239], v[184:187]
  buffer_load_dwordx4 v27, s[56:59], s41 offen offset:1024  lds
  v_mfma_f32_16x16x32_bf16 v[184:187], a[208:211], a[232:235], v[184:187]
  ds_read_b64_tr_b16 a[204:205], v43 offset:57344
  v_mfma_f32_16x16x32_bf16 v[216:219], a[208:211], a[240:243], v[216:219]
  ds_read_b64_tr_b16 a[206:207], v43 offset:58368
  v_mfma_f32_16x16x32_bf16 v[216:219], a[212:215], a[244:247], v[216:219]
  ds_read_b128 a[140:143], v19
  v_mfma_f32_16x16x32_bf16 v[248:251], a[212:215], a[252:255], v[248:251]
  v_mfma_f32_16x16x32_bf16 v[248:251], a[208:211], a[248:251], v[248:251]
  s_waitcnt lgkmcnt(15)
  buffer_load_dwordx4 v26, s[56:59], s42 offen offset:2048  lds
  v_mfma_f32_16x16x32_bf16 v[252:255], a[216:219], a[248:251], v[252:255]
  s_waitcnt lgkmcnt(13)
  ds_read_b64_tr_b16 a[208:209], v44 offset:49152
  v_mfma_f32_16x16x32_bf16 v[252:255], a[220:223], a[252:255], v[252:255]
  ds_read_b64_tr_b16 a[210:211], v44 offset:50176
  v_mfma_f32_16x16x32_bf16 v[220:223], a[220:223], a[244:247], v[220:223]
  ds_read_b64_tr_b16 a[212:213], v44 offset:57344
  v_mfma_f32_16x16x32_bf16 v[220:223], a[216:219], a[240:243], v[220:223]
  buffer_load_dwordx4 v27, s[56:59], s43 offen offset:3072  lds
  v_mfma_f32_16x16x32_bf16 v[188:191], a[216:219], a[232:235], v[188:191]
  ds_read_b64_tr_b16 a[214:215], v44 offset:58368
  v_mfma_f32_16x16x32_bf16 v[188:191], a[220:223], a[236:239], v[188:191]
  s_add_u32 m0, s96, 0x9000
  v_mfma_f32_16x16x32_bf16 v[156:159], a[220:223], a[228:231], v[156:159]
  v_mfma_f32_16x16x32_bf16 v[156:159], a[216:219], a[224:227], v[156:159]
  s_waitcnt lgkmcnt(13)
  v_mfma_f32_16x16x32_bf16 v[128:131], a[192:195], a[160:163], v[128:131]
  s_waitcnt lgkmcnt(11)
  buffer_load_dwordx4 v26, s[56:59], s44 offen offset:0  lds
  v_mfma_f32_16x16x32_bf16 v[128:131], a[196:199], a[164:167], v[128:131]
  ds_read_b64_tr_b16 a[216:217], v45 offset:49152
  v_mfma_f32_16x16x32_bf16 v[160:163], a[196:199], a[172:175], v[160:163]
  ds_read_b64_tr_b16 a[218:219], v45 offset:50176
  v_mfma_f32_16x16x32_bf16 v[160:163], a[192:195], a[168:171], v[160:163]
  ds_read_b64_tr_b16 a[220:221], v45 offset:57344
  v_mfma_f32_16x16x32_bf16 v[192:195], a[192:195], a[176:179], v[192:195]
  ds_read_b64_tr_b16 a[222:223], v45 offset:58368
  v_mfma_f32_16x16x32_bf16 v[192:195], a[196:199], a[180:183], v[192:195]
  buffer_load_dwordx4 v27, s[56:59], s45 offen offset:1024  lds
  v_mfma_f32_16x16x32_bf16 v[224:227], a[196:199], a[188:191], v[224:227]
  s_waitcnt vmcnt(12)
  ds_read_b128 a[224:227], v34 offset:0
  v_mfma_f32_16x16x32_bf16 v[224:227], a[192:195], a[184:187], v[224:227]
  s_waitcnt lgkmcnt(12)
  ds_read_b128 a[228:231], v35 offset:0
  v_mfma_f32_16x16x32_bf16 v[228:231], a[200:203], a[184:187], v[228:231]
  s_waitcnt lgkmcnt(11)
  ds_read_b64_tr_b16 a[192:193], v46 offset:49152
  v_mfma_f32_16x16x32_bf16 v[228:231], a[204:207], a[188:191], v[228:231]
  ds_read_b64_tr_b16 a[194:195], v46 offset:50176
  v_mfma_f32_16x16x32_bf16 v[196:199], a[204:207], a[180:183], v[196:199]
  buffer_load_dwordx4 v26, s[56:59], s46 offen offset:2048  lds
  v_mfma_f32_16x16x32_bf16 v[196:199], a[200:203], a[176:179], v[196:199]
  ds_read_b64_tr_b16 a[196:197], v46 offset:57344
  v_mfma_f32_16x16x32_bf16 v[164:167], a[200:203], a[168:171], v[164:167]
  ds_read_b64_tr_b16 a[198:199], v46 offset:58368
  v_mfma_f32_16x16x32_bf16 v[164:167], a[204:207], a[172:175], v[164:167]
  ds_read_b128 a[232:235], v34 offset:2048
  v_mfma_f32_16x16x32_bf16 v[132:135], a[204:207], a[164:167], v[132:135]
  buffer_load_dwordx4 v27, s[56:59], s47 offen offset:3072  lds
  v_mfma_f32_16x16x32_bf16 v[132:135], a[200:203], a[160:163], v[132:135]
  s_waitcnt lgkmcnt(13)
  ds_read_b128 a[236:239], v35 offset:2048
  v_mfma_f32_16x16x32_bf16 v[136:139], a[208:211], a[160:163], v[136:139]
  s_waitcnt lgkmcnt(12)
  s_mov_b32 s3, 0x2000
  ds_read_b64_tr_b16 a[200:201], v47 offset:49152
  v_mfma_f32_16x16x32_bf16 v[136:139], a[212:215], a[164:167], v[136:139]
  ds_read_b64_tr_b16 a[202:203], v47 offset:50176
  v_mfma_f32_16x16x32_bf16 v[168:171], a[212:215], a[172:175], v[168:171]
  ds_read_b64_tr_b16 a[204:205], v47 offset:57344
  v_mfma_f32_16x16x32_bf16 v[168:171], a[208:211], a[168:171], v[168:171]
  buffer_store_dwordx4 v[84:87], v11, s[16:19], s3 offen offset:1024 sc1
  v_mfma_f32_16x16x32_bf16 v[200:203], a[208:211], a[176:179], v[200:203]
  ds_read_b64_tr_b16 a[206:207], v47 offset:58368
  v_xor_b32 v28, 0x80000, v28
  v_mfma_f32_16x16x32_bf16 v[200:203], a[212:215], a[180:183], v[200:203]
  ds_read_b128 a[240:243], v34 offset:4096
  v_xor_b32 v29, 0x80000, v29
  v_mfma_f32_16x16x32_bf16 v[232:235], a[212:215], a[188:191], v[232:235]
  s_add_u32 m0, s97, 0x14000
  ds_read_b128 a[244:247], v35 offset:4096
  v_mfma_f32_16x16x32_bf16 v[232:235], a[208:211], a[184:187], v[232:235]
  s_waitcnt lgkmcnt(15)
  v_mfma_f32_16x16x32_bf16 v[236:239], a[216:219], a[184:187], v[236:239]
  ds_read_b64_tr_b16 a[208:209], v48 offset:49152
  s_waitcnt lgkmcnt(15)
  v_mfma_f32_16x16x32_bf16 v[236:239], a[220:223], a[188:191], v[236:239]
  buffer_load_dwordx4 v28, s[60:63], s48 offen offset:0  lds
  v_mfma_f32_16x16x32_bf16 v[204:207], a[220:223], a[180:183], v[204:207]
  ds_read_b64_tr_b16 a[210:211], v48 offset:50176
  v_mfma_f32_16x16x32_bf16 v[204:207], a[216:219], a[176:179], v[204:207]
  ds_read_b64_tr_b16 a[212:213], v48 offset:57344
  v_mfma_f32_16x16x32_bf16 v[172:175], a[216:219], a[168:171], v[172:175]
  ds_read_b64_tr_b16 a[214:215], v48 offset:58368
  v_mfma_f32_16x16x32_bf16 v[172:175], a[220:223], a[172:175], v[172:175]
  ds_read_b128 a[248:251], v34 offset:6144
  v_mfma_f32_16x16x32_bf16 v[140:143], a[220:223], a[164:167], v[140:143]
  buffer_load_dwordx4 v28, s[60:63], s49 offen offset:1024  lds
  v_mfma_f32_16x16x32_bf16 v[140:143], a[216:219], a[160:163], v[140:143]
  ds_read_b128 a[252:255], v35 offset:6144
  v_accvgpr_read_b32 v50, a0
  s_waitcnt lgkmcnt(15)
  v_mfma_f32_16x16x32_bf16 v[144:147], a[192:195], a[160:163], v[144:147]
  ds_read_b64_tr_b16 a[216:217], v49 offset:49152
  s_waitcnt lgkmcnt(15)
  v_mfma_f32_16x16x32_bf16 v[144:147], a[196:199], a[164:167], v[144:147]
  ds_read_b64_tr_b16 a[218:219], v49 offset:50176
  v_mfma_f32_16x16x32_bf16 v[176:179], a[196:199], a[172:175], v[176:179]
  buffer_load_dwordx4 v29, s[60:63], s50 offen offset:2048  lds
  v_mfma_f32_16x16x32_bf16 v[176:179], a[192:195], a[168:171], v[176:179]
  ds_read_b64_tr_b16 a[220:221], v49 offset:57344
  v_accvgpr_read_b32 v51, a1
  v_mfma_f32_16x16x32_bf16 v[208:211], a[192:195], a[176:179], v[208:211]
  ds_read_b64_tr_b16 a[222:223], v49 offset:58368
  v_mfma_f32_16x16x32_bf16 v[208:211], a[196:199], a[180:183], v[208:211]
  v_accvgpr_read_b32 v52, a2
  v_mfma_f32_16x16x32_bf16 v[240:243], a[196:199], a[188:191], v[240:243]
  v_accvgpr_read_b32 v53, a3
  v_accvgpr_read_b32 v54, a16
  v_mfma_f32_16x16x32_bf16 v[240:243], a[192:195], a[184:187], v[240:243]
  s_waitcnt vmcnt(13) lgkmcnt(14)
  buffer_load_dwordx4 v29, s[60:63], s51 offen offset:3072  lds
  v_mfma_f32_16x16x32_bf16 v[244:247], a[200:203], a[184:187], v[244:247]
  s_barrier
  s_waitcnt lgkmcnt(12)
  v_mfma_f32_16x16x32_bf16 v[244:247], a[204:207], a[188:191], v[244:247]
  s_mov_b32 s3, 0x3000
  ds_read_b64_tr_b16 a[192:193], v42 offset:0
  v_mfma_f32_16x16x32_bf16 v[212:215], a[204:207], a[180:183], v[212:215]
  ds_read_b64_tr_b16 a[194:195], v42 offset:1024
  v_mfma_f32_16x16x32_bf16 v[212:215], a[200:203], a[176:179], v[212:215]
  ds_read_b64_tr_b16 a[196:197], v42 offset:8192
  v_mfma_f32_16x16x32_bf16 v[180:183], a[200:203], a[168:171], v[180:183]
  buffer_store_dwordx4 v[88:91], v11, s[16:19], s3 offen offset:0 sc1
  v_mfma_f32_16x16x32_bf16 v[180:183], a[204:207], a[172:175], v[180:183]
  ds_read_b64_tr_b16 a[198:199], v42 offset:9216
  v_xor_b32 v26, 0x180, v26
  v_mfma_f32_16x16x32_bf16 v[148:151], a[204:207], a[164:167], v[148:151]
  ds_read_b128 a[0:3], v19
  v_xor_b32 v27, 0x180, v27
  v_mfma_f32_16x16x32_bf16 v[148:151], a[200:203], a[160:163], v[148:151]
  s_waitcnt lgkmcnt(13)
  s_add_u32 m0, s96, 0x20000
  v_mfma_f32_16x16x32_bf16 v[152:155], a[208:211], a[160:163], v[152:155]
  s_waitcnt lgkmcnt(11)
  ds_read_b64_tr_b16 a[200:201], v43 offset:0
  v_mfma_f32_16x16x32_bf16 v[152:155], a[212:215], a[164:167], v[152:155]
  ds_read_b64_tr_b16 a[202:203], v43 offset:1024
  v_mfma_f32_16x16x32_bf16 v[184:187], a[212:215], a[172:175], v[184:187]
  buffer_load_dwordx4 v26, s[56:59], s40 offen offset:0  lds
  v_mfma_f32_16x16x32_bf16 v[184:187], a[208:211], a[168:171], v[184:187]
  ds_read_b64_tr_b16 a[204:205], v43 offset:8192
  v_mfma_f32_16x16x32_bf16 v[216:219], a[208:211], a[176:179], v[216:219]
  ds_read_b64_tr_b16 a[206:207], v43 offset:9216
  v_accvgpr_read_b32 v55, a17
  v_mfma_f32_16x16x32_bf16 v[216:219], a[212:215], a[180:183], v[216:219]
  v_accvgpr_read_b32 v56, a18
  v_mfma_f32_16x16x32_bf16 v[248:251], a[212:215], a[188:191], v[248:251]
  buffer_load_dwordx4 v27, s[56:59], s41 offen offset:1024  lds
  v_mfma_f32_16x16x32_bf16 v[248:251], a[208:211], a[184:187], v[248:251]
  s_waitcnt lgkmcnt(11)
  v_accvgpr_read_b32 v57, a19
  v_mfma_f32_16x16x32_bf16 v[252:255], a[216:219], a[184:187], v[252:255]
  s_waitcnt lgkmcnt(9)
  ds_read_b64_tr_b16 a[208:209], v44 offset:0
  v_cvt_pk_bf16_f32 v64, v50, v51
  v_mfma_f32_16x16x32_bf16 v[252:255], a[220:223], a[188:191], v[252:255]
  ds_read_b64_tr_b16 a[210:211], v44 offset:1024
  v_mfma_f32_16x16x32_bf16 v[220:223], a[220:223], a[180:183], v[220:223]
  ds_read_b64_tr_b16 a[212:213], v44 offset:8192
  v_mfma_f32_16x16x32_bf16 v[220:223], a[216:219], a[176:179], v[220:223]
  buffer_load_dwordx4 v26, s[56:59], s42 offen offset:2048  lds
  v_mfma_f32_16x16x32_bf16 v[188:191], a[216:219], a[168:171], v[188:191]
  ds_read_b64_tr_b16 a[214:215], v44 offset:9216
  v_cvt_pk_bf16_f32 v65, v52, v53
  v_mfma_f32_16x16x32_bf16 v[188:191], a[220:223], a[172:175], v[188:191]
  ds_read_b128 a[16:19], v19
  v_cvt_pk_bf16_f32 v66, v54, v55
  v_mfma_f32_16x16x32_bf16 v[156:159], a[220:223], a[164:167], v[156:159]
  v_mfma_f32_16x16x32_bf16 v[156:159], a[216:219], a[160:163], v[156:159]
  s_waitcnt lgkmcnt(12)
  v_cvt_pk_bf16_f32 v67, v56, v57
  v_mfma_f32_16x16x32_bf16 v[128:131], a[192:195], a[224:227], v[128:131]
  s_waitcnt lgkmcnt(10)
  buffer_load_dwordx4 v27, s[56:59], s43 offen offset:3072  lds
  v_mfma_f32_16x16x32_bf16 v[128:131], a[196:199], a[228:231], v[128:131]
  ds_read_b64_tr_b16 a[216:217], v45 offset:0
  v_and_b32 v14, 2, v1
  v_mfma_f32_16x16x32_bf16 v[160:163], a[196:199], a[236:239], v[160:163]
  s_add_u32 m0, s96, 0x21000
  ds_read_b64_tr_b16 a[218:219], v45 offset:1024
  v_mfma_f32_16x16x32_bf16 v[160:163], a[192:195], a[232:235], v[160:163]
  ds_read_b64_tr_b16 a[220:221], v45 offset:8192
  v_mfma_f32_16x16x32_bf16 v[192:195], a[192:195], a[240:243], v[192:195]
  ds_read_b64_tr_b16 a[222:223], v45 offset:9216
  v_mfma_f32_16x16x32_bf16 v[192:195], a[196:199], a[244:247], v[192:195]
  buffer_load_dwordx4 v26, s[56:59], s44 offen offset:0  lds
  v_mfma_f32_16x16x32_bf16 v[224:227], a[196:199], a[252:255], v[224:227]
  s_waitcnt vmcnt(11)
  ds_read_b128 a[160:163], v34 offset:32768
  v_min_u32 v14, 1, v14
  v_mfma_f32_16x16x32_bf16 v[224:227], a[192:195], a[248:251], v[224:227]
  s_waitcnt lgkmcnt(12)
  ds_read_b128 a[164:167], v35 offset:32768
  v_mfma_f32_16x16x32_bf16 v[228:231], a[200:203], a[248:251], v[228:231]
  s_waitcnt lgkmcnt(11)
  ds_read_b64_tr_b16 a[192:193], v46 offset:0
  v_subrev_u32 v14, 1, v14
  v_mfma_f32_16x16x32_bf16 v[228:231], a[204:207], a[252:255], v[228:231]
  buffer_load_dwordx4 v27, s[56:59], s45 offen offset:1024  lds
  v_mfma_f32_16x16x32_bf16 v[196:199], a[204:207], a[244:247], v[196:199]
  ds_read_b64_tr_b16 a[194:195], v46 offset:1024
  v_and_b32 v14, 0x3f803f80, v14
  v_mfma_f32_16x16x32_bf16 v[196:199], a[200:203], a[240:243], v[196:199]
  ds_read_b64_tr_b16 a[196:197], v46 offset:8192
  v_mfma_f32_16x16x32_bf16 v[164:167], a[200:203], a[232:235], v[164:167]
  ds_read_b64_tr_b16 a[198:199], v46 offset:9216
  v_mfma_f32_16x16x32_bf16 v[164:167], a[204:207], a[236:239], v[164:167]
  ds_read_b128 a[168:171], v34 offset:34816
  v_mfma_f32_16x16x32_bf16 v[132:135], a[204:207], a[228:231], v[132:135]
  buffer_load_dwordx4 v26, s[56:59], s46 offen offset:2048  lds
  v_mfma_f32_16x16x32_bf16 v[132:135], a[200:203], a[224:227], v[132:135]
  ds_read_b128 a[172:175], v35 offset:34816
  v_accvgpr_read_b32 v58, a32
  s_waitcnt lgkmcnt(15)
  v_mfma_f32_16x16x32_bf16 v[136:139], a[208:211], a[224:227], v[136:139]
  s_waitcnt lgkmcnt(13)
  ds_read_b64_tr_b16 a[200:201], v47 offset:0
  v_mfma_f32_16x16x32_bf16 v[136:139], a[212:215], a[228:231], v[136:139]
  ds_read_b64_tr_b16 a[202:203], v47 offset:1024
  v_mfma_f32_16x16x32_bf16 v[168:171], a[212:215], a[236:239], v[168:171]
  ds_read_b64_tr_b16 a[204:205], v47 offset:8192
  v_accvgpr_read_b32 v59, a33
  v_mfma_f32_16x16x32_bf16 v[168:171], a[208:211], a[232:235], v[168:171]
  buffer_load_dwordx4 v27, s[56:59], s47 offen offset:3072  lds
  v_mfma_f32_16x16x32_bf16 v[200:203], a[208:211], a[240:243], v[200:203]
  s_mov_b32 s3, 0x3000
  ds_read_b64_tr_b16 a[206:207], v47 offset:9216
  v_mfma_f32_16x16x32_bf16 v[200:203], a[212:215], a[244:247], v[200:203]
  ds_read_b128 a[176:179], v34 offset:36864
  v_mfma_f32_16x16x32_bf16 v[232:235], a[212:215], a[252:255], v[232:235]
  ds_read_b128 a[180:183], v35 offset:36864
  v_mfma_f32_16x16x32_bf16 v[232:235], a[208:211], a[248:251], v[232:235]
  s_waitcnt lgkmcnt(15)
  buffer_store_dwordx4 v[92:95], v11, s[16:19], s3 offen offset:1024 sc1
  v_mfma_f32_16x16x32_bf16 v[236:239], a[216:219], a[248:251], v[236:239]
  ds_read_b64_tr_b16 a[208:209], v48 offset:0
  v_xor_b32 v28, 0x180000, v28
  s_waitcnt lgkmcnt(15)
  v_mfma_f32_16x16x32_bf16 v[236:239], a[220:223], a[252:255], v[236:239]
  ds_read_b64_tr_b16 a[210:211], v48 offset:1024
  v_xor_b32 v29, 0x180000, v29
  v_mfma_f32_16x16x32_bf16 v[204:207], a[220:223], a[244:247], v[204:207]
  s_add_u32 m0, s97, 0x18000
  ds_read_b64_tr_b16 a[212:213], v48 offset:8192
  v_mfma_f32_16x16x32_bf16 v[204:207], a[216:219], a[240:243], v[204:207]
  ds_read_b64_tr_b16 a[214:215], v48 offset:9216
  v_mfma_f32_16x16x32_bf16 v[172:175], a[216:219], a[232:235], v[172:175]
  ds_read_b128 a[184:187], v34 offset:38912
  v_mfma_f32_16x16x32_bf16 v[172:175], a[220:223], a[236:239], v[172:175]
  buffer_load_dwordx4 v28, s[60:63], s48 offen offset:0  lds
  v_mfma_f32_16x16x32_bf16 v[140:143], a[220:223], a[228:231], v[140:143]
  ds_read_b128 a[188:191], v35 offset:38912
  v_mfma_f32_16x16x32_bf16 v[140:143], a[216:219], a[224:227], v[140:143]
  s_waitcnt lgkmcnt(15)
  v_mfma_f32_16x16x32_bf16 v[144:147], a[192:195], a[224:227], v[144:147]
  ds_read_b64_tr_b16 a[216:217], v49 offset:0
  s_waitcnt lgkmcnt(15)
  v_mfma_f32_16x16x32_bf16 v[144:147], a[196:199], a[228:231], v[144:147]
  ds_read_b64_tr_b16 a[218:219], v49 offset:1024
  v_mfma_f32_16x16x32_bf16 v[176:179], a[196:199], a[236:239], v[176:179]
  buffer_load_dwordx4 v28, s[60:63], s49 offen offset:1024  lds
  v_mfma_f32_16x16x32_bf16 v[176:179], a[192:195], a[232:235], v[176:179]
  ds_read_b64_tr_b16 a[220:221], v49 offset:8192
  v_accvgpr_read_b32 v60, a34
  v_mfma_f32_16x16x32_bf16 v[208:211], a[192:195], a[240:243], v[208:211]
  ds_read_b64_tr_b16 a[222:223], v49 offset:9216
  v_mfma_f32_16x16x32_bf16 v[208:211], a[196:199], a[244:247], v[208:211]
  v_accvgpr_read_b32 v61, a35
  v_mfma_f32_16x16x32_bf16 v[240:243], a[196:199], a[252:255], v[240:243]
  v_accvgpr_read_b32 v62, a48
  v_accvgpr_read_b32 v63, a49
  v_mfma_f32_16x16x32_bf16 v[240:243], a[192:195], a[248:251], v[240:243]
  s_waitcnt vmcnt(12) lgkmcnt(14)
  buffer_load_dwordx4 v29, s[60:63], s50 offen offset:2048  lds
  v_mfma_f32_16x16x32_bf16 v[244:247], a[200:203], a[248:251], v[244:247]
  s_barrier
  s_waitcnt lgkmcnt(12)
  v_mfma_f32_16x16x32_bf16 v[244:247], a[204:207], a[252:255], v[244:247]
  ds_read_b64_tr_b16 a[192:193], v42 offset:16384
  v_accvgpr_read_b32 v50, a50
  v_mfma_f32_16x16x32_bf16 v[212:215], a[204:207], a[244:247], v[212:215]
  ds_read_b64_tr_b16 a[194:195], v42 offset:17408
  v_accvgpr_read_b32 v51, a51
  v_mfma_f32_16x16x32_bf16 v[212:215], a[200:203], a[240:243], v[212:215]
  buffer_load_dwordx4 v29, s[60:63], s51 offen offset:3072  lds
  v_mfma_f32_16x16x32_bf16 v[180:183], a[200:203], a[232:235], v[180:183]
  ds_read_b64_tr_b16 a[196:197], v42 offset:24576
  v_cvt_pk_bf16_f32 v68, v58, v59
  v_mfma_f32_16x16x32_bf16 v[180:183], a[204:207], a[236:239], v[180:183]
  s_mov_b32 s3, 0x0
  ds_read_b64_tr_b16 a[198:199], v42 offset:25600
  v_cvt_pk_bf16_f32 v69, v60, v61
  v_mfma_f32_16x16x32_bf16 v[148:151], a[204:207], a[228:231], v[148:151]
  v_cvt_pk_bf16_f32 v70, v62, v63
  v_cvt_pk_bf16_f32 v71, v50, v51
  v_mfma_f32_16x16x32_bf16 v[148:151], a[200:203], a[224:227], v[148:151]
  s_waitcnt lgkmcnt(12)
  ds_read_b128 a[32:35], v19
  v_mfma_f32_16x16x32_bf16 v[152:155], a[208:211], a[224:227], v[152:155]
  s_waitcnt lgkmcnt(11)
  buffer_store_dwordx4 v[64:67], v12, s[16:19], s3 offen offset:0 sc1
  v_mfma_f32_16x16x32_bf16 v[152:155], a[212:215], a[228:231], v[152:155]
  ds_read_b64_tr_b16 a[200:201], v43 offset:16384
  v_xor_b32 v26, 0x80, v26
  v_mfma_f32_16x16x32_bf16 v[184:187], a[212:215], a[236:239], v[184:187]
  ds_read_b64_tr_b16 a[202:203], v43 offset:17408
  v_xor_b32 v27, 0x80, v27
  v_mfma_f32_16x16x32_bf16 v[184:187], a[208:211], a[232:235], v[184:187]
  s_add_u32 m0, s96, 0x0
  ds_read_b64_tr_b16 a[204:205], v43 offset:24576
  v_mfma_f32_16x16x32_bf16 v[216:219], a[208:211], a[240:243], v[216:219]
  ds_read_b64_tr_b16 a[206:207], v43 offset:25600
  v_mfma_f32_16x16x32_bf16 v[216:219], a[212:215], a[244:247], v[216:219]
  ds_read_b128 a[48:51], v19
  v_mfma_f32_16x16x32_bf16 v[248:251], a[212:215], a[252:255], v[248:251]
  buffer_load_dwordx4 v26, s[56:59], s40 offen offset:0  lds
  v_mfma_f32_16x16x32_bf16 v[248:251], a[208:211], a[248:251], v[248:251]
  s_waitcnt lgkmcnt(12)
  v_mfma_f32_16x16x32_bf16 v[252:255], a[216:219], a[248:251], v[252:255]
  s_waitcnt lgkmcnt(10)
  ds_read_b64_tr_b16 a[208:209], v44 offset:16384
  v_mfma_f32_16x16x32_bf16 v[252:255], a[220:223], a[252:255], v[252:255]
  ds_read_b64_tr_b16 a[210:211], v44 offset:17408
  v_mfma_f32_16x16x32_bf16 v[220:223], a[220:223], a[244:247], v[220:223]
  ds_read_b64_tr_b16 a[212:213], v44 offset:24576
  v_mfma_f32_16x16x32_bf16 v[220:223], a[216:219], a[240:243], v[220:223]
  buffer_load_dwordx4 v27, s[56:59], s41 offen offset:1024  lds
  v_mfma_f32_16x16x32_bf16 v[188:191], a[216:219], a[232:235], v[188:191]
  ds_read_b64_tr_b16 a[214:215], v44 offset:25600
  v_mfma_f32_16x16x32_bf16 v[188:191], a[220:223], a[236:239], v[188:191]
  v_mfma_f32_16x16x32_bf16 v[156:159], a[220:223], a[228:231], v[156:159]
  v_accvgpr_read_b32 v52, a4
  v_mfma_f32_16x16x32_bf16 v[156:159], a[216:219], a[224:227], v[156:159]
  s_waitcnt lgkmcnt(12)
  v_accvgpr_read_b32 v53, a5
  v_mfma_f32_16x16x32_bf16 v[128:131], a[192:195], a[160:163], v[128:131]
  s_waitcnt lgkmcnt(10)
  buffer_load_dwordx4 v26, s[56:59], s42 offen offset:2048  lds
  v_mfma_f32_16x16x32_bf16 v[128:131], a[196:199], a[164:167], v[128:131]
  ds_read_b64_tr_b16 a[216:217], v45 offset:16384
  v_accvgpr_read_b32 v54, a6
  v_mfma_f32_16x16x32_bf16 v[160:163], a[196:199], a[172:175], v[160:163]
  ds_read_b64_tr_b16 a[218:219], v45 offset:17408
  v_mfma_f32_16x16x32_bf16 v[160:163], a[192:195], a[168:171], v[160:163]
  ds_read_b64_tr_b16 a[220:221], v45 offset:24576
  v_mfma_f32_16x16x32_bf16 v[192:195], a[192:195], a[176:179], v[192:195]
  buffer_load_dwordx4 v27, s[56:59], s43 offen offset:3072  lds
  v_mfma_f32_16x16x32_bf16 v[192:195], a[196:199], a[180:183], v[192:195]
  ds_read_b64_tr_b16 a[222:223], v45 offset:25600
  v_accvgpr_read_b32 v55, a7
  v_mfma_f32_16x16x32_bf16 v[224:227], a[196:199], a[188:191], v[224:227]
  s_waitcnt vmcnt(10)
  s_add_u32 m0, s96, 0x1000
  ds_read_b128 a[224:227], v36 offset:0
  v_mfma_f32_16x16x32_bf16 v[224:227], a[192:195], a[184:187], v[224:227]
  s_waitcnt lgkmcnt(12)
  ds_read_b128 a[228:231], v37 offset:0
  v_mfma_f32_16x16x32_bf16 v[228:231], a[200:203], a[184:187], v[228:231]
  s_waitcnt lgkmcnt(11)
  ds_read_b64_tr_b16 a[192:193], v46 offset:16384
  v_mfma_f32_16x16x32_bf16 v[228:231], a[204:207], a[188:191], v[228:231]
  buffer_load_dwordx4 v26, s[56:59], s44 offen offset:0  lds
  v_mfma_f32_16x16x32_bf16 v[196:199], a[204:207], a[180:183], v[196:199]
  ds_read_b64_tr_b16 a[194:195], v46 offset:17408
  v_accvgpr_read_b32 v56, a20
  v_mfma_f32_16x16x32_bf16 v[196:199], a[200:203], a[176:179], v[196:199]
  ds_read_b64_tr_b16 a[196:197], v46 offset:24576
  v_accvgpr_read_b32 v57, a21
  v_mfma_f32_16x16x32_bf16 v[164:167], a[200:203], a[168:171], v[164:167]
  ds_read_b64_tr_b16 a[198:199], v46 offset:25600
  v_accvgpr_read_b32 v58, a22
  v_mfma_f32_16x16x32_bf16 v[164:167], a[204:207], a[172:175], v[164:167]
  ds_read_b128 a[232:235], v36 offset:2048
  v_accvgpr_read_b32 v59, a23
  v_mfma_f32_16x16x32_bf16 v[132:135], a[204:207], a[164:167], v[132:135]
  buffer_load_dwordx4 v27, s[56:59], s45 offen offset:1024  lds
  v_mfma_f32_16x16x32_bf16 v[132:135], a[200:203], a[160:163], v[132:135]
  s_waitcnt lgkmcnt(13)
  ds_read_b128 a[236:239], v37 offset:2048
  v_cvt_pk_bf16_f32 v72, v52, v53
  v_mfma_f32_16x16x32_bf16 v[136:139], a[208:211], a[160:163], v[136:139]
  s_waitcnt lgkmcnt(12)
  ds_read_b64_tr_b16 a[200:201], v47 offset:16384
  v_cvt_pk_bf16_f32 v73, v54, v55
  v_mfma_f32_16x16x32_bf16 v[136:139], a[212:215], a[164:167], v[136:139]
  ds_read_b64_tr_b16 a[202:203], v47 offset:17408
  v_cvt_pk_bf16_f32 v74, v56, v57
  v_mfma_f32_16x16x32_bf16 v[168:171], a[212:215], a[172:175], v[168:171]
  buffer_load_dwordx4 v26, s[56:59], s46 offen offset:2048  lds
  v_mfma_f32_16x16x32_bf16 v[168:171], a[208:211], a[168:171], v[168:171]
  ds_read_b64_tr_b16 a[204:205], v47 offset:24576
  v_cvt_pk_bf16_f32 v75, v58, v59
  v_mfma_f32_16x16x32_bf16 v[200:203], a[208:211], a[176:179], v[200:203]
  ds_read_b64_tr_b16 a[206:207], v47 offset:25600
  v_mfma_f32_16x16x32_bf16 v[200:203], a[212:215], a[180:183], v[200:203]
  ds_read_b128 a[240:243], v36 offset:4096
  v_mfma_f32_16x16x32_bf16 v[232:235], a[212:215], a[188:191], v[232:235]
  ds_read_b128 a[244:247], v37 offset:4096
  v_mfma_f32_16x16x32_bf16 v[232:235], a[208:211], a[184:187], v[232:235]
  s_waitcnt lgkmcnt(15)
  buffer_load_dwordx4 v27, s[56:59], s47 offen offset:3072  lds
  v_mfma_f32_16x16x32_bf16 v[236:239], a[216:219], a[184:187], v[236:239]
  ds_read_b64_tr_b16 a[208:209], v48 offset:16384
  s_waitcnt lgkmcnt(15)
  v_mfma_f32_16x16x32_bf16 v[236:239], a[220:223], a[188:191], v[236:239]
  s_mov_b32 s3, 0x0
  ds_read_b64_tr_b16 a[210:211], v48 offset:17408
  v_mfma_f32_16x16x32_bf16 v[204:207], a[220:223], a[180:183], v[204:207]
  ds_read_b64_tr_b16 a[212:213], v48 offset:24576
  v_mfma_f32_16x16x32_bf16 v[204:207], a[216:219], a[176:179], v[204:207]
  ds_read_b64_tr_b16 a[214:215], v48 offset:25600
  v_mfma_f32_16x16x32_bf16 v[172:175], a[216:219], a[168:171], v[172:175]
  buffer_store_dwordx4 v[68:71], v12, s[16:19], s3 offen offset:1024 sc1
  v_mfma_f32_16x16x32_bf16 v[172:175], a[220:223], a[172:175], v[172:175]
  ds_read_b128 a[248:251], v36 offset:6144
  v_xor_b32 v28, 0x80000, v28
  v_mfma_f32_16x16x32_bf16 v[140:143], a[220:223], a[164:167], v[140:143]
  ds_read_b128 a[252:255], v37 offset:6144
  v_xor_b32 v29, 0x80000, v29
  v_mfma_f32_16x16x32_bf16 v[140:143], a[216:219], a[160:163], v[140:143]
  s_add_u32 m0, s97, 0x1c000
  ds_read_b128 a[4:7], v19
  s_waitcnt lgkmcnt(15)
  v_mfma_f32_16x16x32_bf16 v[144:147], a[192:195], a[160:163], v[144:147]
  ds_read_b64_tr_b16 a[216:217], v49 offset:16384
  v_mfma_f32_16x16x32_bf16 v[144:147], a[196:199], a[164:167], v[144:147]
  ds_read_b64_tr_b16 a[218:219], v49 offset:17408
  v_mfma_f32_16x16x32_bf16 v[176:179], a[196:199], a[172:175], v[176:179]
  buffer_load_dwordx4 v28, s[60:63], s48 offen offset:0  lds
  v_mfma_f32_16x16x32_bf16 v[176:179], a[192:195], a[168:171], v[176:179]
  ds_read_b64_tr_b16 a[220:221], v49 offset:24576
  v_mfma_f32_16x16x32_bf16 v[208:211], a[192:195], a[176:179], v[208:211]
  ds_read_b64_tr_b16 a[222:223], v49 offset:25600
  v_mfma_f32_16x16x32_bf16 v[208:211], a[196:199], a[180:183], v[208:211]
L_pad6:
  s_cbranch_execz L_hr0
  ds_read_b128 a[20:23], v19
  v_mfma_f32_16x16x32_bf16 v[240:243], a[196:199], a[188:191], v[240:243]
  buffer_load_dwordx4 v28, s[60:63], s49 offen offset:1024  lds
  v_mfma_f32_16x16x32_bf16 v[240:243], a[192:195], a[184:187], v[240:243]
  s_waitcnt vmcnt(12) lgkmcnt(15)
  v_mfma_f32_16x16x32_bf16 v[244:247], a[200:203], a[184:187], v[244:247]
  s_barrier
  s_waitcnt lgkmcnt(14)
  v_mfma_f32_16x16x32_bf16 v[244:247], a[204:207], a[188:191], v[244:247]
  ds_read_b64_tr_b16 a[192:193], v42 offset:32768
  v_mfma_f32_16x16x32_bf16 v[212:215], a[204:207], a[180:183], v[212:215]
  ds_read_b64_tr_b16 a[194:195], v42 offset:33792
  v_mfma_f32_16x16x32_bf16 v[212:215], a[200:203], a[176:179], v[212:215]
  buffer_load_dwordx4 v29, s[60:63], s50 offen offset:2048  lds
  v_mfma_f32_16x16x32_bf16 v[180:183], a[200:203], a[168:171], v[180:183]
  ds_read_b64_tr_b16 a[196:197], v42 offset:40960
  v_mfma_f32_16x16x32_bf16 v[180:183], a[204:207], a[172:175], v[180:183]
  ds_read_b64_tr_b16 a[198:199], v42 offset:41984
  v_mfma_f32_16x16x32_bf16 v[148:151], a[204:207], a[164:167], v[148:151]
  v_mfma_f32_16x16x32_bf16 v[148:151], a[200:203], a[160:163], v[148:151]
  s_waitcnt lgkmcnt(14)
  v_accvgpr_read_b32 v60, a36
  v_accvgpr_read_b32 v61, a37
  v_mfma_f32_16x16x32_bf16 v[152:155], a[208:211], a[160:163], v[152:155]
  s_waitcnt lgkmcnt(12)
  buffer_load_dwordx4 v29, s[60:63], s51 offen offset:3072  lds
  v_mfma_f32_16x16x32_bf16 v[152:155], a[212:215], a[164:167], v[152:155]
  ds_read_b64_tr_b16 a[200:201], v43 offset:32768
  v_xor_b32 v26, 0x780, v26
  v_mfma_f32_16x16x32_bf16 v[184:187], a[212:215], a[172:175], v[184:187]
  ds_read_b64_tr_b16 a[202:203], v43 offset:33792
  v_xor_b32 v27, 0x780, v27
  v_mfma_f32_16x16x32_bf16 v[184:187], a[208:211], a[168:171], v[184:187]
  s_add_u32 m0, s96, 0x8000
  ds_read_b64_tr_b16 a[204:205], v43 offset:40960
  v_accvgpr_read_b32 v62, a38
  v_mfma_f32_16x16x32_bf16 v[216:219], a[208:211], a[176:179], v[216:219]
  ds_read_b64_tr_b16 a[206:207], v43 offset:41984
  v_accvgpr_read_b32 v63, a39
  v_mfma_f32_16x16x32_bf16 v[216:219], a[212:215], a[180:183], v[216:219]
  buffer_load_dwordx4 v26, s[56:59], s40 offen offset:0  lds
  v_mfma_f32_16x16x32_bf16 v[248:251], a[212:215], a[188:191], v[248:251]
  v_accvgpr_read_b32 v50, a52
  v_accvgpr_read_b32 v51, a53
  v_mfma_f32_16x16x32_bf16 v[248:251], a[208:211], a[184:187], v[248:251]
  s_waitcnt lgkmcnt(11)
  v_accvgpr_read_b32 v52, a54
  v_accvgpr_read_b32 v53, a55
  v_mfma_f32_16x16x32_bf16 v[252:255], a[216:219], a[184:187], v[252:255]
  s_waitcnt lgkmcnt(9)
  ds_read_b64_tr_b16 a[208:209], v44 offset:32768
  v_cvt_pk_bf16_f32 v76, v60, v61
  v_mfma_f32_16x16x32_bf16 v[252:255], a[220:223], a[188:191], v[252:255]
  buffer_load_dwordx4 v27, s[56:59], s41 offen offset:1024  lds
  v_mfma_f32_16x16x32_bf16 v[220:223], a[220:223], a[180:183], v[220:223]
  ds_read_b64_tr_b16 a[210:211], v44 offset:33792
  v_cvt_pk_bf16_f32 v77, v62, v63
  v_mfma_f32_16x16x32_bf16 v[220:223], a[216:219], a[176:179], v[220:223]
  ds_read_b64_tr_b16 a[212:213], v44 offset:40960
  v_cvt_pk_bf16_f32 v78, v50, v51
  v_mfma_f32_16x16x32_bf16 v[188:191], a[216:219], a[168:171], v[188:191]
  ds_read_b64_tr_b16 a[214:215], v44 offset:41984
  v_cvt_pk_bf16_f32 v79, v52, v53
  v_mfma_f32_16x16x32_bf16 v[188:191], a[220:223], a[172:175], v[188:191]
  ds_read_b128 a[36:39], v19
  v_mfma_f32_16x16x32_bf16 v[156:159], a[220:223], a[164:167], v[156:159]
  buffer_load_dwordx4 v26, s[56:59], s42 offen offset:2048  lds
  v_mfma_f32_16x16x32_bf16 v[156:159], a[216:219], a[160:163], v[156:159]
  s_waitcnt lgkmcnt(11)
  ds_read_b128 a[52:55], v19
  v_mfma_f32_16x16x32_bf16 v[128:131], a[192:195], a[224:227], v[128:131]
  s_waitcnt lgkmcnt(10)
  ds_read_b64_tr_b16 a[216:217], v45 offset:32768
  v_mfma_f32_16x16x32_bf16 v[128:131], a[196:199], a[228:231], v[128:131]
  ds_read_b64_tr_b16 a[218:219], v45 offset:33792
  v_mfma_f32_16x16x32_bf16 v[160:163], a[196:199], a[236:239], v[160:163]
  ds_read_b64_tr_b16 a[220:221], v45 offset:40960
  v_mfma_f32_16x16x32_bf16 v[160:163], a[192:195], a[232:235], v[160:163]
  buffer_load_dwordx4 v27, s[56:59], s43 offen offset:3072  lds
  v_mfma_f32_16x16x32_bf16 v[192:195], a[192:195], a[240:243], v[192:195]
  s_add_u32 m0, s96, 0x9000
  ds_read_b64_tr_b16 a[222:223], v45 offset:41984
  v_accvgpr_read_b32 v54, a64
  v_mfma_f32_16x16x32_bf16 v[192:195], a[196:199], a[244:247], v[192:195]
  s_waitcnt vmcnt(9)
  ds_read_b128 a[160:163], v34 offset:0
  v_accvgpr_read_b32 v55, a65
  v_mfma_f32_16x16x32_bf16 v[224:227], a[196:199], a[252:255], v[224:227]
  buffer_load_dwordx4 v26, s[56:59], s44 offen offset:0  lds
  v_mfma_f32_16x16x32_bf16 v[224:227], a[192:195], a[248:251], v[224:227]
  s_waitcnt lgkmcnt(13)
  ds_read_b128 a[164:167], v35 offset:0
  v_accvgpr_read_b32 v56, a66
  v_mfma_f32_16x16x32_bf16 v[228:231], a[200:203], a[248:251], v[228:231]
  s_waitcnt lgkmcnt(12)
  ds_read_b64_tr_b16 a[192:193], v46 offset:32768
  v_accvgpr_read_b32 v57, a67
  v_mfma_f32_16x16x32_bf16 v[228:231], a[204:207], a[252:255], v[228:231]
  buffer_load_dwordx4 v27, s[56:59], s45 offen offset:1024  lds
  v_mfma_f32_16x16x32_bf16 v[196:199], a[204:207], a[244:247], v[196:199]
  ds_read_b64_tr_b16 a[194:195], v46 offset:33792
  v_accvgpr_read_b32 v58, a80
  v_mfma_f32_16x16x32_bf16 v[196:199], a[200:203], a[240:243], v[196:199]
  ds_read_b64_tr_b16 a[196:197], v46 offset:40960
  v_accvgpr_read_b32 v59, a81
  v_mfma_f32_16x16x32_bf16 v[164:167], a[200:203], a[232:235], v[164:167]
  buffer_load_dwordx4 v26, s[56:59], s46 offen offset:2048  lds
  v_mfma_f32_16x16x32_bf16 v[164:167], a[204:207], a[236:239], v[164:167]
  ds_read_b64_tr_b16 a[198:199], v46 offset:41984
  v_accvgpr_read_b32 v60, a82
  v_mfma_f32_16x16x32_bf16 v[132:135], a[204:207], a[228:231], v[132:135]
  v_accvgpr_read_b32 v61, a83
  v_cvt_pk_bf16_f32 v64, v54, v55
  v_mfma_f32_16x16x32_bf16 v[132:135], a[200:203], a[224:227], v[132:135]
  s_waitcnt lgkmcnt(14)
  buffer_load_dwordx4 v27, s[56:59], s47 offen offset:3072  lds
  v_mfma_f32_16x16x32_bf16 v[136:139], a[208:211], a[224:227], v[136:139]
  s_waitcnt lgkmcnt(12)
  s_mov_b32 s3, 0x0
  ds_read_b64_tr_b16 a[200:201], v47 offset:32768
  v_cvt_pk_bf16_f32 v65, v56, v57
  v_mfma_f32_16x16x32_bf16 v[136:139], a[212:215], a[228:231], v[136:139]
  v_cvt_pk_bf16_f32 v66, v58, v59
  v_cvt_pk_bf16_f32 v67, v60, v61
  v_mfma_f32_16x16x32_bf16 v[168:171], a[212:215], a[236:239], v[168:171]
  buffer_store_dwordx4 v[72:75], v12, s[16:19], s3 offen offset:2048 sc1
  v_mfma_f32_16x16x32_bf16 v[168:171], a[208:211], a[232:235], v[168:171]
  ds_read_b64_tr_b16 a[202:203], v47 offset:33792
  v_xor_b32 v28, 0x780000, v28
  v_mfma_f32_16x16x32_bf16 v[200:203], a[208:211], a[240:243], v[200:203]
  ds_read_b64_tr_b16 a[204:205], v47 offset:40960
  v_xor_b32 v29, 0x780000, v29
  v_mfma_f32_16x16x32_bf16 v[200:203], a[212:215], a[244:247], v[200:203]
  s_add_u32 m0, s97, 0x10000
  ds_read_b128 a[168:171], v34 offset:2048
  v_accvgpr_read_b32 v62, a8
  v_mfma_f32_16x16x32_bf16 v[232:235], a[212:215], a[252:255], v[232:235]
  buffer_load_dwordx4 v28, s[60:63], s48 offen offset:0  lds
  v_mfma_f32_16x16x32_bf16 v[232:235], a[208:211], a[248:251], v[232:235]
  s_waitcnt lgkmcnt(12)
  ds_read_b64_tr_b16 a[206:207], v47 offset:41984
  v_accvgpr_read_b32 v63, a9
  v_mfma_f32_16x16x32_bf16 v[236:239], a[216:219], a[248:251], v[236:239]
  s_waitcnt lgkmcnt(11)
  ds_read_b128 a[172:175], v35 offset:2048
  v_accvgpr_read_b32 v50, a10
  v_mfma_f32_16x16x32_bf16 v[236:239], a[220:223], a[252:255], v[236:239]
  buffer_load_dwordx4 v28, s[60:63], s49 offen offset:1024  lds
  v_mfma_f32_16x16x32_bf16 v[204:207], a[220:223], a[244:247], v[204:207]
  ds_read_b64_tr_b16 a[208:209], v48 offset:32768
  v_accvgpr_read_b32 v51, a11
  v_mfma_f32_16x16x32_bf16 v[204:207], a[216:219], a[240:243], v[204:207]
  ds_read_b64_tr_b16 a[210:211], v48 offset:33792
  v_accvgpr_read_b32 v52, a24
  v_mfma_f32_16x16x32_bf16 v[172:175], a[216:219], a[232:235], v[172:175]
  ds_read_b64_tr_b16 a[212:213], v48 offset:40960
  v_accvgpr_read_b32 v53, a25
  v_mfma_f32_16x16x32_bf16 v[172:175], a[220:223], a[236:239], v[172:175]
  ds_read_b128 a[176:179], v34 offset:4096
  v_accvgpr_read_b32 v54, a26
  v_mfma_f32_16x16x32_bf16 v[140:143], a[220:223], a[228:231], v[140:143]
  buffer_load_dwordx4 v29, s[60:63], s50 offen offset:2048  lds
  v_mfma_f32_16x16x32_bf16 v[140:143], a[216:219], a[224:227], v[140:143]
  s_waitcnt lgkmcnt(12)
  ds_read_b64_tr_b16 a[214:215], v48 offset:41984
  v_accvgpr_read_b32 v55, a27
  v_mfma_f32_16x16x32_bf16 v[144:147], a[192:195], a[224:227], v[144:147]
  s_waitcnt lgkmcnt(11)
  ds_read_b128 a[180:183], v35 offset:4096
  v_cvt_pk_bf16_f32 v80, v62, v63
  v_mfma_f32_16x16x32_bf16 v[144:147], a[196:199], a[228:231], v[144:147]
  ds_read_b64_tr_b16 a[216:217], v49 offset:32768
  v_cvt_pk_bf16_f32 v81, v50, v51
  v_mfma_f32_16x16x32_bf16 v[176:179], a[196:199], a[236:239], v[176:179]
  v_cvt_pk_bf16_f32 v82, v52, v53
  v_cvt_pk_bf16_f32 v83, v54, v55
  v_mfma_f32_16x16x32_bf16 v[176:179], a[192:195], a[232:235], v[176:179]
  buffer_load_dwordx4 v29, s[60:63], s51 offen offset:3072  lds
  v_mfma_f32_16x16x32_bf16 v[208:211], a[192:195], a[240:243], v[208:211]
  s_mov_b32 s3, 0x0
  ds_read_b64_tr_b16 a[218:219], v49 offset:33792
  v_mfma_f32_16x16x32_bf16 v[208:211], a[196:199], a[244:247], v[208:211]
  ds_read_b64_tr_b16 a[220:221], v49 offset:40960
  v_mfma_f32_16x16x32_bf16 v[240:243], a[196:199], a[252:255], v[240:243]
  ds_read_b128 a[184:187], v34 offset:6144
  v_mfma_f32_16x16x32_bf16 v[240:243], a[192:195], a[248:251], v[240:243]
  s_waitcnt vmcnt(13) lgkmcnt(14)
  buffer_store_dwordx4 v[76:79], v12, s[16:19], s3 offen offset:3072 sc1
  v_mfma_f32_16x16x32_bf16 v[244:247], a[200:203], a[248:251], v[244:247]
  s_barrier
  s_waitcnt lgkmcnt(11)
  v_mfma_f32_16x16x32_bf16 v[244:247], a[204:207], a[252:255], v[244:247]
  ds_read_b64_tr_b16 a[222:223], v49 offset:41984
  v_xor_b32 v26, 0x80, v26
  v_mfma_f32_16x16x32_bf16 v[212:215], a[204:207], a[244:247], v[212:215]
  ds_read_b128 a[188:191], v35 offset:6144
  v_xor_b32 v27, 0x80, v27
  v_mfma_f32_16x16x32_bf16 v[212:215], a[200:203], a[240:243], v[212:215]
  s_add_u32 m0, s96, 0x20000
  ds_read_b64_tr_b16 a[192:193], v42 offset:49152
  v_accvgpr_read_b32 v56, a96
  v_mfma_f32_16x16x32_bf16 v[180:183], a[200:203], a[232:235], v[180:183]
  ds_read_b64_tr_b16 a[194:195], v42 offset:50176
  v_accvgpr_read_b32 v57, a97
  v_mfma_f32_16x16x32_bf16 v[180:183], a[204:207], a[236:239], v[180:183]
  buffer_load_dwordx4 v26, s[56:59], s40 offen offset:0  lds
  v_mfma_f32_16x16x32_bf16 v[148:151], a[204:207], a[228:231], v[148:151]
  ds_read_b64_tr_b16 a[196:197], v42 offset:57344
  v_accvgpr_read_b32 v58, a98
  v_mfma_f32_16x16x32_bf16 v[148:151], a[200:203], a[224:227], v[148:151]
  s_waitcnt lgkmcnt(13)
  ds_read_b64_tr_b16 a[198:199], v42 offset:58368
  v_accvgpr_read_b32 v59, a99
  v_mfma_f32_16x16x32_bf16 v[152:155], a[208:211], a[224:227], v[152:155]
  s_waitcnt lgkmcnt(11)
  ds_read_b64_tr_b16 a[200:201], v43 offset:49152
  v_accvgpr_read_b32 v60, a112
  v_mfma_f32_16x16x32_bf16 v[152:155], a[212:215], a[228:231], v[152:155]
  ds_read_b64_tr_b16 a[202:203], v43 offset:50176
  v_accvgpr_read_b32 v61, a113
  v_mfma_f32_16x16x32_bf16 v[184:187], a[212:215], a[236:239], v[184:187]
  buffer_load_dwordx4 v27, s[56:59], s41 offen offset:1024  lds
  v_mfma_f32_16x16x32_bf16 v[184:187], a[208:211], a[232:235], v[184:187]
  ds_read_b64_tr_b16 a[204:205], v43 offset:57344
  v_accvgpr_read_b32 v62, a114
  v_mfma_f32_16x16x32_bf16 v[216:219], a[208:211], a[240:243], v[216:219]
  ds_read_b64_tr_b16 a[206:207], v43 offset:58368
  v_accvgpr_read_b32 v63, a115
  v_mfma_f32_16x16x32_bf16 v[216:219], a[212:215], a[244:247], v[216:219]
  v_cvt_pk_bf16_f32 v68, v56, v57
  v_cvt_pk_bf16_f32 v69, v58, v59
  v_mfma_f32_16x16x32_bf16 v[248:251], a[212:215], a[252:255], v[248:251]
  v_cvt_pk_bf16_f32 v70, v60, v61
  v_cvt_pk_bf16_f32 v71, v62, v63
  v_mfma_f32_16x16x32_bf16 v[248:251], a[208:211], a[248:251], v[248:251]
  s_waitcnt lgkmcnt(12)
  buffer_load_dwordx4 v26, s[56:59], s42 offen offset:2048  lds
  v_mfma_f32_16x16x32_bf16 v[252:255], a[216:219], a[248:251], v[252:255]
  s_waitcnt lgkmcnt(9)
  ds_read_b64_tr_b16 a[208:209], v44 offset:49152
  v_accvgpr_read_b32 v50, a40
  v_mfma_f32_16x16x32_bf16 v[252:255], a[220:223], a[252:255], v[252:255]
  ds_read_b64_tr_b16 a[210:211], v44 offset:50176
  v_accvgpr_read_b32 v51, a41
  v_mfma_f32_16x16x32_bf16 v[220:223], a[220:223], a[244:247], v[220:223]
  ds_read_b64_tr_b16 a[212:213], v44 offset:57344
  v_accvgpr_read_b32 v52, a42
  v_mfma_f32_16x16x32_bf16 v[220:223], a[216:219], a[240:243], v[220:223]
  buffer_load_dwordx4 v27, s[56:59], s43 offen offset:3072  lds
  v_mfma_f32_16x16x32_bf16 v[188:191], a[216:219], a[232:235], v[188:191]
  ds_read_b64_tr_b16 a[214:215], v44 offset:58368
  v_accvgpr_read_b32 v53, a43
  v_mfma_f32_16x16x32_bf16 v[188:191], a[220:223], a[236:239], v[188:191]
  s_add_u32 m0, s96, 0x21000
  v_accvgpr_read_b32 v54, a56
  v_accvgpr_read_b32 v55, a57
  v_mfma_f32_16x16x32_bf16 v[156:159], a[220:223], a[228:231], v[156:159]
  v_accvgpr_read_b32 v56, a58
  v_accvgpr_read_b32 v57, a59
  v_mfma_f32_16x16x32_bf16 v[156:159], a[216:219], a[224:227], v[156:159]
  s_waitcnt lgkmcnt(10)
  v_cvt_pk_bf16_f32 v84, v50, v51
  v_cvt_pk_bf16_f32 v85, v52, v53
  v_mfma_f32_16x16x32_bf16 v[128:131], a[192:195], a[160:163], v[128:131]
L_gq1:
  buffer_load_dwordx4 v26, s[56:59], s44 offen offset:0  lds
  s_waitcnt lgkmcnt(8)
  v_mfma_f32_16x16x32_bf16 v[128:131], a[196:199], a[164:167], v[128:131]
  ds_read_b64_tr_b16 a[216:217], v45 offset:49152
  v_cvt_pk_bf16_f32 v86, v54, v55
  v_mfma_f32_16x16x32_bf16 v[160:163], a[196:199], a[172:175], v[160:163]
  ds_read_b64_tr_b16 a[218:219], v45 offset:50176
  v_cvt_pk_bf16_f32 v87, v56, v57
  v_mfma_f32_16x16x32_bf16 v[160:163], a[192:195], a[168:171], v[160:163]
  ds_read_b64_tr_b16 a[220:221], v45 offset:57344
  v_mfma_f32_16x16x32_bf16 v[192:195], a[192:195], a[176:179], v[192:195]
  ds_read_b64_tr_b16 a[222:223], v45 offset:58368
  v_mfma_f32_16x16x32_bf16 v[192:195], a[196:199], a[180:183], v[192:195]
  buffer_load_dwordx4 v27, s[56:59], s45 offen offset:1024  lds
  v_mfma_f32_16x16x32_bf16 v[224:227], a[196:199], a[188:191], v[224:227]
  s_waitcnt vmcnt(12)
  ds_read_b128 a[224:227], v34 offset:32768
  v_mfma_f32_16x16x32_bf16 v[224:227], a[192:195], a[184:187], v[224:227]
  s_waitcnt lgkmcnt(11)
  ds_read_b128 a[228:231], v35 offset:32768
  v_mfma_f32_16x16x32_bf16 v[228:231], a[200:203], a[184:187], v[228:231]
  s_waitcnt lgkmcnt(10)
  ds_read_b64_tr_b16 a[192:193], v46 offset:49152
  v_mfma_f32_16x16x32_bf16 v[228:231], a[204:207], a[188:191], v[228:231]
  ds_read_b64_tr_b16 a[194:195], v46 offset:50176
  v_mfma_f32_16x16x32_bf16 v[196:199], a[204:207], a[180:183], v[196:199]
  buffer_load_dwordx4 v26, s[56:59], s46 offen offset:2048  lds
  v_mfma_f32_16x16x32_bf16 v[196:199], a[200:203], a[176:179], v[196:199]
  ds_read_b64_tr_b16 a[196:197], v46 offset:57344
  v_mfma_f32_16x16x32_bf16 v[164:167], a[200:203], a[168:171], v[164:167]
  ds_read_b64_tr_b16 a[198:199], v46 offset:58368
  v_mfma_f32_16x16x32_bf16 v[164:167], a[204:207], a[172:175], v[164:167]
  ds_read_b128 a[232:235], v34 offset:34816
  v_accvgpr_read_b32 v58, a68
  v_mfma_f32_16x16x32_bf16 v[132:135], a[204:207], a[164:167], v[132:135]
  buffer_load_dwordx4 v27, s[56:59], s47 offen offset:3072  lds
  v_mfma_f32_16x16x32_bf16 v[132:135], a[200:203], a[160:163], v[132:135]
  s_waitcnt lgkmcnt(13)
  ds_read_b128 a[236:239], v35 offset:34816
  v_accvgpr_read_b32 v59, a69
  v_mfma_f32_16x16x32_bf16 v[136:139], a[208:211], a[160:163], v[136:139]
  s_waitcnt lgkmcnt(12)
  s_mov_b32 s3, 0x1000
  ds_read_b64_tr_b16 a[200:201], v47 offset:49152
  v_accvgpr_read_b32 v60, a70
  v_mfma_f32_16x16x32_bf16 v[136:139], a[212:215], a[164:167], v[136:139]
  ds_read_b64_tr_b16 a[202:203], v47 offset:50176
  v_accvgpr_read_b32 v61, a71
  v_mfma_f32_16x16x32_bf16 v[168:171], a[212:215], a[172:175], v[168:171]
  ds_read_b64_tr_b16 a[204:205], v47 offset:57344
  v_accvgpr_read_b32 v62, a84
  v_mfma_f32_16x16x32_bf16 v[168:171], a[208:211], a[168:171], v[168:171]
  buffer_store_dwordx4 v[80:83], v12, s[16:19], s3 offen offset:0 sc1
  v_mfma_f32_16x16x32_bf16 v[200:203], a[208:211], a[176:179], v[200:203]
  ds_read_b64_tr_b16 a[206:207], v47 offset:58368
  v_xor_b32 v28, 0x80000, v28
  v_mfma_f32_16x16x32_bf16 v[200:203], a[212:215], a[180:183], v[200:203]
  v_xor_b32 v29, 0x80000, v29
  v_accvgpr_read_b32 v63, a85
  v_mfma_f32_16x16x32_bf16 v[232:235], a[212:215], a[188:191], v[232:235]
  s_add_u32 m0, s97, 0x14000
  v_accvgpr_read_b32 v50, a86
  v_accvgpr_read_b32 v51, a87
  v_mfma_f32_16x16x32_bf16 v[232:235], a[208:211], a[184:187], v[232:235]
  s_waitcnt lgkmcnt(14)
  v_cvt_pk_bf16_f32 v72, v58, v59
  v_cvt_pk_bf16_f32 v73, v60, v61
  v_mfma_f32_16x16x32_bf16 v[236:239], a[216:219], a[184:187], v[236:239]
  s_waitcnt lgkmcnt(12)
  ds_read_b64_tr_b16 a[208:209], v48 offset:49152
  v_cvt_pk_bf16_f32 v74, v62, v63
  v_mfma_f32_16x16x32_bf16 v[236:239], a[220:223], a[188:191], v[236:239]
  buffer_load_dwordx4 v28, s[60:63], s48 offen offset:0  lds
  v_mfma_f32_16x16x32_bf16 v[204:207], a[220:223], a[180:183], v[204:207]
  ds_read_b64_tr_b16 a[210:211], v48 offset:50176
  v_cvt_pk_bf16_f32 v75, v50, v51
  v_mfma_f32_16x16x32_bf16 v[204:207], a[216:219], a[176:179], v[204:207]
  ds_read_b64_tr_b16 a[212:213], v48 offset:57344
  v_mfma_f32_16x16x32_bf16 v[172:175], a[216:219], a[168:171], v[172:175]
  ds_read_b128 a[240:243], v34 offset:36864
  v_mfma_f32_16x16x32_bf16 v[172:175], a[220:223], a[172:175], v[172:175]
  ds_read_b64_tr_b16 a[214:215], v48 offset:58368
  v_accvgpr_read_b32 v52, a12
  v_mfma_f32_16x16x32_bf16 v[140:143], a[220:223], a[164:167], v[140:143]
  buffer_load_dwordx4 v28, s[60:63], s49 offen offset:1024  lds
  v_mfma_f32_16x16x32_bf16 v[140:143], a[216:219], a[160:163], v[140:143]
  s_waitcnt lgkmcnt(13)
  ds_read_b128 a[244:247], v35 offset:36864
  v_accvgpr_read_b32 v53, a13
  v_mfma_f32_16x16x32_bf16 v[144:147], a[192:195], a[160:163], v[144:147]
  s_waitcnt lgkmcnt(12)
  ds_read_b64_tr_b16 a[216:217], v49 offset:49152
  v_accvgpr_read_b32 v54, a14
  v_mfma_f32_16x16x32_bf16 v[144:147], a[196:199], a[164:167], v[144:147]
  ds_read_b64_tr_b16 a[218:219], v49 offset:50176
  v_accvgpr_read_b32 v55, a15
  v_mfma_f32_16x16x32_bf16 v[176:179], a[196:199], a[172:175], v[176:179]
  buffer_load_dwordx4 v29, s[60:63], s50 offen offset:2048  lds
  v_mfma_f32_16x16x32_bf16 v[176:179], a[192:195], a[168:171], v[176:179]
  ds_read_b64_tr_b16 a[220:221], v49 offset:57344
  v_accvgpr_read_b32 v56, a28
  v_mfma_f32_16x16x32_bf16 v[208:211], a[192:195], a[176:179], v[208:211]
  ds_read_b128 a[248:251], v34 offset:38912
  v_accvgpr_read_b32 v57, a29
  v_mfma_f32_16x16x32_bf16 v[208:211], a[196:199], a[180:183], v[208:211]
  ds_read_b64_tr_b16 a[222:223], v49 offset:58368
  v_accvgpr_read_b32 v58, a30
  v_mfma_f32_16x16x32_bf16 v[240:243], a[196:199], a[188:191], v[240:243]
  ds_read_b128 a[252:255], v35 offset:38912
  v_accvgpr_read_b32 v59, a31
  v_mfma_f32_16x16x32_bf16 v[240:243], a[192:195], a[184:187], v[240:243]
  s_waitcnt vmcnt(13) lgkmcnt(14)
  buffer_load_dwordx4 v29, s[60:63], s51 offen offset:3072  lds
  v_mfma_f32_16x16x32_bf16 v[244:247], a[200:203], a[184:187], v[244:247]
  s_barrier
  s_waitcnt lgkmcnt(12)
  v_mfma_f32_16x16x32_bf16 v[244:247], a[204:207], a[188:191], v[244:247]
  s_mov_b32 s3, 0x1000
  ds_read_b64_tr_b16 a[192:193], v42 offset:0
  v_cvt_pk_bf16_f32 v88, v52, v53
  v_mfma_f32_16x16x32_bf16 v[212:215], a[204:207], a[180:183], v[212:215]
  ds_read_b64_tr_b16 a[194:195], v42 offset:1024
  v_cvt_pk_bf16_f32 v89, v54, v55
  v_mfma_f32_16x16x32_bf16 v[212:215], a[200:203], a[176:179], v[212:215]
  v_cvt_pk_bf16_f32 v90, v56, v57
  v_cvt_pk_bf16_f32 v91, v58, v59
  v_mfma_f32_16x16x32_bf16 v[180:183], a[200:203], a[168:171], v[180:183]
  buffer_store_dwordx4 v[84:87], v12, s[16:19], s3 offen offset:1024 sc1
  v_mfma_f32_16x16x32_bf16 v[180:183], a[204:207], a[172:175], v[180:183]
  ds_read_b64_tr_b16 a[196:197], v42 offset:8192
  v_xor_b32 v26, 0x180, v26
  v_mfma_f32_16x16x32_bf16 v[148:151], a[204:207], a[164:167], v[148:151]
  ds_read_b64_tr_b16 a[198:199], v42 offset:9216
  v_xor_b32 v27, 0x180, v27
  v_mfma_f32_16x16x32_bf16 v[148:151], a[200:203], a[160:163], v[148:151]
  s_add_u32 m0, s96, 0x0
  ds_read_b128 a[8:11], v19
  s_waitcnt lgkmcnt(15)
  v_mfma_f32_16x16x32_bf16 v[152:155], a[208:211], a[160:163], v[152:155]
  s_waitcnt lgkmcnt(12)
  ds_read_b64_tr_b16 a[200:201], v43 offset:0
  v_mfma_f32_16x16x32_bf16 v[152:155], a[212:215], a[164:167], v[152:155]
  ds_read_b64_tr_b16 a[202:203], v43 offset:1024
  v_mfma_f32_16x16x32_bf16 v[184:187], a[212:215], a[172:175], v[184:187]
  buffer_load_dwordx4 v26, s[56:59], s40 offen offset:0  lds
  v_mfma_f32_16x16x32_bf16 v[184:187], a[208:211], a[168:171], v[184:187]
  ds_read_b64_tr_b16 a[204:205], v43 offset:8192
  v_accvgpr_read_b32 v60, a100
  v_mfma_f32_16x16x32_bf16 v[216:219], a[208:211], a[176:179], v[216:219]
  ds_read_b64_tr_b16 a[206:207], v43 offset:9216
  v_accvgpr_read_b32 v61, a101
  v_mfma_f32_16x16x32_bf16 v[216:219], a[212:215], a[180:183], v[216:219]
  v_accvgpr_read_b32 v62, a102
  v_accvgpr_read_b32 v63, a103
  v_mfma_f32_16x16x32_bf16 v[248:251], a[212:215], a[188:191], v[248:251]
  buffer_load_dwordx4 v27, s[56:59], s41 offen offset:1024  lds
  v_mfma_f32_16x16x32_bf16 v[248:251], a[208:211], a[184:187], v[248:251]
  s_waitcnt lgkmcnt(13)
  v_accvgpr_read_b32 v50, a116
  v_accvgpr_read_b32 v51, a117
  v_mfma_f32_16x16x32_bf16 v[252:255], a[216:219], a[184:187], v[252:255]
  s_waitcnt lgkmcnt(10)
  ds_read_b64_tr_b16 a[208:209], v44 offset:0
  v_accvgpr_read_b32 v52, a118
  v_mfma_f32_16x16x32_bf16 v[252:255], a[220:223], a[188:191], v[252:255]
  ds_read_b64_tr_b16 a[210:211], v44 offset:1024
  v_accvgpr_read_b32 v53, a119
  v_mfma_f32_16x16x32_bf16 v[220:223], a[220:223], a[180:183], v[220:223]
  ds_read_b64_tr_b16 a[212:213], v44 offset:8192
  v_cvt_pk_bf16_f32 v76, v60, v61
  v_mfma_f32_16x16x32_bf16 v[220:223], a[216:219], a[176:179], v[220:223]
  buffer_load_dwordx4 v26, s[56:59], s42 offen offset:2048  lds
  v_mfma_f32_16x16x32_bf16 v[188:191], a[216:219], a[168:171], v[188:191]
  ds_read_b64_tr_b16 a[214:215], v44 offset:9216
  v_cvt_pk_bf16_f32 v77, v62, v63
  v_mfma_f32_16x16x32_bf16 v[188:191], a[220:223], a[172:175], v[188:191]
  v_cvt_pk_bf16_f32 v78, v50, v51
  v_cvt_pk_bf16_f32 v79, v52, v53
  v_mfma_f32_16x16x32_bf16 v[156:159], a[220:223], a[164:167], v[156:159]
  ds_read_b128 a[12:15], v19
  v_mfma_f32_16x16x32_bf16 v[156:159], a[216:219], a[160:163], v[156:159]
  s_waitcnt lgkmcnt(12)
  ds_read_b128 a[24:27], v19
  v_mfma_f32_16x16x32_bf16 v[128:131], a[192:195], a[224:227], v[128:131]
  s_waitcnt lgkmcnt(11)
  buffer_load_dwordx4 v27, s[56:59], s43 offen offset:3072  lds
  v_mfma_f32_16x16x32_bf16 v[128:131], a[196:199], a[228:231], v[128:131]
  ds_read_b64_tr_b16 a[216:217], v45 offset:0
  v_mfma_f32_16x16x32_bf16 v[160:163], a[196:199], a[236:239], v[160:163]
  s_add_u32 m0, s96, 0x1000
  ds_read_b64_tr_b16 a[218:219], v45 offset:1024
  v_accvgpr_read_b32 v54, a44
  v_mfma_f32_16x16x32_bf16 v[160:163], a[192:195], a[232:235], v[160:163]
  ds_read_b64_tr_b16 a[220:221], v45 offset:8192
  v_accvgpr_read_b32 v55, a45
  v_mfma_f32_16x16x32_bf16 v[192:195], a[192:195], a[240:243], v[192:195]
  ds_read_b64_tr_b16 a[222:223], v45 offset:9216
  v_accvgpr_read_b32 v56, a46
  v_mfma_f32_16x16x32_bf16 v[192:195], a[196:199], a[244:247], v[192:195]
  buffer_load_dwordx4 v26, s[56:59], s44 offen offset:0  lds
  v_mfma_f32_16x16x32_bf16 v[224:227], a[196:199], a[252:255], v[224:227]
  s_waitcnt vmcnt(11)
  ds_read_b128 a[160:163], v36 offset:0
  v_accvgpr_read_b32 v57, a47
  v_mfma_f32_16x16x32_bf16 v[224:227], a[192:195], a[248:251], v[224:227]
  s_waitcnt lgkmcnt(13)
  v_accvgpr_read_b32 v58, a60
  v_accvgpr_read_b32 v59, a61
  v_mfma_f32_16x16x32_bf16 v[228:231], a[200:203], a[248:251], v[228:231]
  s_waitcnt lgkmcnt(11)
  ds_read_b64_tr_b16 a[192:193], v46 offset:0
  v_accvgpr_read_b32 v60, a62
  v_mfma_f32_16x16x32_bf16 v[228:231], a[204:207], a[252:255], v[228:231]
  buffer_load_dwordx4 v27, s[56:59], s45 offen offset:1024  lds
  v_mfma_f32_16x16x32_bf16 v[196:199], a[204:207], a[244:247], v[196:199]
  ds_read_b64_tr_b16 a[194:195], v46 offset:1024
  v_accvgpr_read_b32 v61, a63
  v_mfma_f32_16x16x32_bf16 v[196:199], a[200:203], a[240:243], v[196:199]
  ds_read_b64_tr_b16 a[196:197], v46 offset:8192
  v_cvt_pk_bf16_f32 v92, v54, v55
  v_mfma_f32_16x16x32_bf16 v[164:167], a[200:203], a[232:235], v[164:167]
  ds_read_b64_tr_b16 a[198:199], v46 offset:9216
  v_cvt_pk_bf16_f32 v93, v56, v57
  v_mfma_f32_16x16x32_bf16 v[164:167], a[204:207], a[236:239], v[164:167]
  ds_read_b128 a[164:167], v37 offset:0
  v_cvt_pk_bf16_f32 v94, v58, v59
  v_mfma_f32_16x16x32_bf16 v[132:135], a[204:207], a[228:231], v[132:135]
  buffer_load_dwordx4 v26, s[56:59], s46 offen offset:2048  lds
  v_mfma_f32_16x16x32_bf16 v[132:135], a[200:203], a[224:227], v[132:135]
  ds_read_b128 a[168:171], v36 offset:2048
  v_cvt_pk_bf16_f32 v95, v60, v61
  s_waitcnt lgkmcnt(15)
  v_mfma_f32_16x16x32_bf16 v[136:139], a[208:211], a[224:227], v[136:139]
  s_waitcnt lgkmcnt(13)
  ds_read_b64_tr_b16 a[200:201], v47 offset:0
  v_mfma_f32_16x16x32_bf16 v[136:139], a[212:215], a[228:231], v[136:139]
  ds_read_b64_tr_b16 a[202:203], v47 offset:1024
  v_mfma_f32_16x16x32_bf16 v[168:171], a[212:215], a[236:239], v[168:171]
  ds_read_b64_tr_b16 a[204:205], v47 offset:8192
  v_mfma_f32_16x16x32_bf16 v[168:171], a[208:211], a[232:235], v[168:171]
  buffer_load_dwordx4 v27, s[56:59], s47 offen offset:3072  lds
  v_mfma_f32_16x16x32_bf16 v[200:203], a[208:211], a[240:243], v[200:203]
  s_mov_b32 s3, 0x1000
  ds_read_b64_tr_b16 a[206:207], v47 offset:9216
  v_mfma_f32_16x16x32_bf16 v[200:203], a[212:215], a[244:247], v[200:203]
  ds_read_b128 a[172:175], v37 offset:2048
  v_mfma_f32_16x16x32_bf16 v[232:235], a[212:215], a[252:255], v[232:235]
  ds_read_b128 a[176:179], v36 offset:4096
  v_mfma_f32_16x16x32_bf16 v[232:235], a[208:211], a[248:251], v[232:235]
  s_waitcnt lgkmcnt(15)
  buffer_store_dwordx4 v[88:91], v12, s[16:19], s3 offen offset:2048 sc1
  v_mfma_f32_16x16x32_bf16 v[236:239], a[216:219], a[248:251], v[236:239]
  s_waitcnt lgkmcnt(13)
  ds_read_b64_tr_b16 a[208:209], v48 offset:0
  v_xor_b32 v28, 0x180000, v28
  v_mfma_f32_16x16x32_bf16 v[236:239], a[220:223], a[252:255], v[236:239]
  ds_read_b64_tr_b16 a[210:211], v48 offset:1024
  v_xor_b32 v29, 0x180000, v29
  v_mfma_f32_16x16x32_bf16 v[204:207], a[220:223], a[244:247], v[204:207]
  s_add_u32 m0, s97, 0x18000
  ds_read_b64_tr_b16 a[212:213], v48 offset:8192
  v_mfma_f32_16x16x32_bf16 v[204:207], a[216:219], a[240:243], v[204:207]
  ds_read_b64_tr_b16 a[214:215], v48 offset:9216
  v_mfma_f32_16x16x32_bf16 v[172:175], a[216:219], a[232:235], v[172:175]
  ds_read_b128 a[180:183], v37 offset:4096
  v_mfma_f32_16x16x32_bf16 v[172:175], a[220:223], a[236:239], v[172:175]
  buffer_load_dwordx4 v28, s[60:63], s48 offen offset:0  lds
  v_mfma_f32_16x16x32_bf16 v[140:143], a[220:223], a[228:231], v[140:143]
  ds_read_b128 a[184:187], v36 offset:6144
  v_mfma_f32_16x16x32_bf16 v[140:143], a[216:219], a[224:227], v[140:143]
  ds_read_b128 a[188:191], v37 offset:6144
  s_waitcnt lgkmcnt(15)
  v_mfma_f32_16x16x32_bf16 v[144:147], a[192:195], a[224:227], v[144:147]
  ds_read_b64_tr_b16 a[216:217], v49 offset:0
  v_mfma_f32_16x16x32_bf16 v[144:147], a[196:199], a[228:231], v[144:147]
L_pad7:
  s_cbranch_execz L_hr0
  ds_read_b64_tr_b16 a[218:219], v49 offset:1024
  v_mfma_f32_16x16x32_bf16 v[176:179], a[196:199], a[236:239], v[176:179]
  buffer_load_dwordx4 v28, s[60:63], s49 offen offset:1024  lds
  v_mfma_f32_16x16x32_bf16 v[176:179], a[192:195], a[232:235], v[176:179]
  ds_read_b64_tr_b16 a[220:221], v49 offset:8192
  v_mfma_f32_16x16x32_bf16 v[208:211], a[192:195], a[240:243], v[208:211]
  ds_read_b64_tr_b16 a[222:223], v49 offset:9216
  v_mfma_f32_16x16x32_bf16 v[208:211], a[196:199], a[244:247], v[208:211]
  ds_read_b128 a[28:31], v19
  v_mfma_f32_16x16x32_bf16 v[240:243], a[196:199], a[252:255], v[240:243]
  ds_read_b128 a[40:43], v19
  v_mfma_f32_16x16x32_bf16 v[240:243], a[192:195], a[248:251], v[240:243]
  s_waitcnt vmcnt(12) lgkmcnt(15)
  buffer_load_dwordx4 v29, s[60:63], s50 offen offset:2048  lds
  v_mfma_f32_16x16x32_bf16 v[244:247], a[200:203], a[248:251], v[244:247]
  s_barrier
  v_mfma_f32_16x16x32_bf16 v[244:247], a[204:207], a[252:255], v[244:247]
  ds_read_b64_tr_b16 a[192:193], v42 offset:16384
  v_mfma_f32_16x16x32_bf16 v[212:215], a[204:207], a[244:247], v[212:215]
  ds_read_b64_tr_b16 a[194:195], v42 offset:17408
  v_mfma_f32_16x16x32_bf16 v[212:215], a[200:203], a[240:243], v[212:215]
  buffer_load_dwordx4 v29, s[60:63], s51 offen offset:3072  lds
  v_mfma_f32_16x16x32_bf16 v[180:183], a[200:203], a[232:235], v[180:183]
  ds_read_b64_tr_b16 a[196:197], v42 offset:24576
  v_mfma_f32_16x16x32_bf16 v[180:183], a[204:207], a[236:239], v[180:183]
  s_mov_b32 s3, 0x1000
  ds_read_b64_tr_b16 a[198:199], v42 offset:25600
  v_mfma_f32_16x16x32_bf16 v[148:151], a[204:207], a[228:231], v[148:151]
  ds_read_b128 a[44:47], v19
  v_mfma_f32_16x16x32_bf16 v[148:151], a[200:203], a[224:227], v[148:151]
  ds_read_b128 a[56:59], v19
  s_waitcnt lgkmcnt(15)
  v_mfma_f32_16x16x32_bf16 v[152:155], a[208:211], a[224:227], v[152:155]
  buffer_store_dwordx4 v[92:95], v12, s[16:19], s3 offen offset:3072 sc1
  v_mfma_f32_16x16x32_bf16 v[152:155], a[212:215], a[228:231], v[152:155]
  ds_read_b64_tr_b16 a[200:201], v43 offset:16384
  v_xor_b32 v26, 0x80, v26
  v_mfma_f32_16x16x32_bf16 v[184:187], a[212:215], a[236:239], v[184:187]
  ds_read_b64_tr_b16 a[202:203], v43 offset:17408
  v_xor_b32 v27, 0x80, v27
  v_mfma_f32_16x16x32_bf16 v[184:187], a[208:211], a[232:235], v[184:187]
  s_add_u32 m0, s96, 0x8000
  ds_read_b64_tr_b16 a[204:205], v43 offset:24576
  v_mfma_f32_16x16x32_bf16 v[216:219], a[208:211], a[240:243], v[216:219]
  ds_read_b64_tr_b16 a[206:207], v43 offset:25600
  v_mfma_f32_16x16x32_bf16 v[216:219], a[212:215], a[244:247], v[216:219]
  ds_read_b128 a[60:63], v19
  v_mfma_f32_16x16x32_bf16 v[248:251], a[212:215], a[252:255], v[248:251]
  buffer_load_dwordx4 v26, s[56:59], s40 offen offset:0  lds
  v_mfma_f32_16x16x32_bf16 v[248:251], a[208:211], a[248:251], v[248:251]
  ds_read_b128 a[64:67], v19
  s_waitcnt lgkmcnt(15)
  v_mfma_f32_16x16x32_bf16 v[252:255], a[216:219], a[248:251], v[252:255]
  ds_read_b64_tr_b16 a[208:209], v44 offset:16384
  s_waitcnt lgkmcnt(15)
  v_mfma_f32_16x16x32_bf16 v[252:255], a[220:223], a[252:255], v[252:255]
  ds_read_b64_tr_b16 a[210:211], v44 offset:17408
  v_mfma_f32_16x16x32_bf16 v[220:223], a[220:223], a[244:247], v[220:223]
  ds_read_b64_tr_b16 a[212:213], v44 offset:24576
  v_mfma_f32_16x16x32_bf16 v[220:223], a[216:219], a[240:243], v[220:223]
  buffer_load_dwordx4 v27, s[56:59], s41 offen offset:1024  lds
  v_mfma_f32_16x16x32_bf16 v[188:191], a[216:219], a[232:235], v[188:191]
  ds_read_b64_tr_b16 a[214:215], v44 offset:25600
  v_mfma_f32_16x16x32_bf16 v[188:191], a[220:223], a[236:239], v[188:191]
  ds_read_b128 a[68:71], v19
  v_mfma_f32_16x16x32_bf16 v[156:159], a[220:223], a[228:231], v[156:159]
  ds_read_b128 a[80:83], v19
  v_mfma_f32_16x16x32_bf16 v[156:159], a[216:219], a[224:227], v[156:159]
  ds_read_b128 a[84:87], v19
  s_waitcnt lgkmcnt(15)
  v_mfma_f32_16x16x32_bf16 v[128:131], a[192:195], a[160:163], v[128:131]
  buffer_load_dwordx4 v26, s[56:59], s42 offen offset:2048  lds
  v_mfma_f32_16x16x32_bf16 v[128:131], a[196:199], a[164:167], v[128:131]
  ds_read_b64_tr_b16 a[216:217], v45 offset:16384
  v_mfma_f32_16x16x32_bf16 v[160:163], a[196:199], a[172:175], v[160:163]
  ds_read_b64_tr_b16 a[218:219], v45 offset:17408
  v_mfma_f32_16x16x32_bf16 v[160:163], a[192:195], a[168:171], v[160:163]
  ds_read_b64_tr_b16 a[220:221], v45 offset:24576
  v_mfma_f32_16x16x32_bf16 v[192:195], a[192:195], a[176:179], v[192:195]
  buffer_load_dwordx4 v27, s[56:59], s43 offen offset:3072  lds
  v_mfma_f32_16x16x32_bf16 v[192:195], a[196:199], a[180:183], v[192:195]
  ds_read_b64_tr_b16 a[222:223], v45 offset:25600
  v_mfma_f32_16x16x32_bf16 v[224:227], a[196:199], a[188:191], v[224:227]
  s_waitcnt vmcnt(10)
  s_add_u32 m0, s96, 0x9000
  ds_read_b128 a[224:227], v34 offset:0
  v_mfma_f32_16x16x32_bf16 v[224:227], a[192:195], a[184:187], v[224:227]
  ds_read_b128 a[228:231], v35 offset:0
  s_waitcnt lgkmcnt(15)
  v_mfma_f32_16x16x32_bf16 v[228:231], a[200:203], a[184:187], v[228:231]
  ds_read_b64_tr_b16 a[192:193], v46 offset:16384
  v_mfma_f32_16x16x32_bf16 v[228:231], a[204:207], a[188:191], v[228:231]
  buffer_load_dwordx4 v26, s[56:59], s44 offen offset:0  lds
  v_mfma_f32_16x16x32_bf16 v[196:199], a[204:207], a[180:183], v[196:199]
  ds_read_b64_tr_b16 a[194:195], v46 offset:17408
  v_mfma_f32_16x16x32_bf16 v[196:199], a[200:203], a[176:179], v[196:199]
  ds_read_b64_tr_b16 a[196:197], v46 offset:24576
  v_mfma_f32_16x16x32_bf16 v[164:167], a[200:203], a[168:171], v[164:167]
  ds_read_b64_tr_b16 a[198:199], v46 offset:25600
  v_mfma_f32_16x16x32_bf16 v[164:167], a[204:207], a[172:175], v[164:167]
  ds_read_b128 a[232:235], v34 offset:2048
  v_mfma_f32_16x16x32_bf16 v[132:135], a[204:207], a[164:167], v[132:135]
  buffer_load_dwordx4 v27, s[56:59], s45 offen offset:1024  lds
  v_mfma_f32_16x16x32_bf16 v[132:135], a[200:203], a[160:163], v[132:135]
  ds_read_b128 a[236:239], v35 offset:2048
  s_waitcnt lgkmcnt(15)
  v_mfma_f32_16x16x32_bf16 v[136:139], a[208:211], a[160:163], v[136:139]
  ds_read_b64_tr_b16 a[200:201], v47 offset:16384
  v_mfma_f32_16x16x32_bf16 v[136:139], a[212:215], a[164:167], v[136:139]
  ds_read_b64_tr_b16 a[202:203], v47 offset:17408
  v_mfma_f32_16x16x32_bf16 v[168:171], a[212:215], a[172:175], v[168:171]
  buffer_load_dwordx4 v26, s[56:59], s46 offen offset:2048  lds
  v_mfma_f32_16x16x32_bf16 v[168:171], a[208:211], a[168:171], v[168:171]
  ds_read_b64_tr_b16 a[204:205], v47 offset:24576
  v_mfma_f32_16x16x32_bf16 v[200:203], a[208:211], a[176:179], v[200:203]
  ds_read_b64_tr_b16 a[206:207], v47 offset:25600
  v_mfma_f32_16x16x32_bf16 v[200:203], a[212:215], a[180:183], v[200:203]
  ds_read_b128 a[240:243], v34 offset:4096
  v_mfma_f32_16x16x32_bf16 v[232:235], a[212:215], a[188:191], v[232:235]
  ds_read_b128 a[244:247], v35 offset:4096
  v_mfma_f32_16x16x32_bf16 v[232:235], a[208:211], a[184:187], v[232:235]
  s_waitcnt lgkmcnt(15)
  buffer_load_dwordx4 v27, s[56:59], s47 offen offset:3072  lds
  v_mfma_f32_16x16x32_bf16 v[236:239], a[216:219], a[184:187], v[236:239]
  ds_read_b64_tr_b16 a[208:209], v48 offset:16384
  v_xor_b32 v28, 0x80000, v28
  s_waitcnt lgkmcnt(15)
  v_mfma_f32_16x16x32_bf16 v[236:239], a[220:223], a[188:191], v[236:239]
  ds_read_b64_tr_b16 a[210:211], v48 offset:17408
  v_xor_b32 v29, 0x80000, v29
  v_mfma_f32_16x16x32_bf16 v[204:207], a[220:223], a[180:183], v[204:207]
  s_add_u32 m0, s97, 0x1c000
  ds_read_b64_tr_b16 a[212:213], v48 offset:24576
  v_mfma_f32_16x16x32_bf16 v[204:207], a[216:219], a[176:179], v[204:207]
  ds_read_b64_tr_b16 a[214:215], v48 offset:25600
  v_mfma_f32_16x16x32_bf16 v[172:175], a[216:219], a[168:171], v[172:175]
  buffer_load_dwordx4 v28, s[60:63], s48 offen offset:0  lds
  v_mfma_f32_16x16x32_bf16 v[172:175], a[220:223], a[172:175], v[172:175]
  ds_read_b128 a[248:251], v34 offset:6144
  v_mfma_f32_16x16x32_bf16 v[140:143], a[220:223], a[164:167], v[140:143]
  ds_read_b128 a[252:255], v35 offset:6144
  v_mfma_f32_16x16x32_bf16 v[140:143], a[216:219], a[160:163], v[140:143]
  ds_read_b128 a[96:99], v19
  s_waitcnt lgkmcnt(15)
  v_mfma_f32_16x16x32_bf16 v[144:147], a[192:195], a[160:163], v[144:147]
  buffer_load_dwordx4 v28, s[60:63], s49 offen offset:1024  lds
  v_mfma_f32_16x16x32_bf16 v[144:147], a[196:199], a[164:167], v[144:147]
  ds_read_b64_tr_b16 a[216:217], v49 offset:16384
  v_accvgpr_read_b32 v62, a72
  v_mfma_f32_16x16x32_bf16 v[176:179], a[196:199], a[172:175], v[176:179]
  ds_read_b64_tr_b16 a[218:219], v49 offset:17408
  v_accvgpr_read_b32 v63, a73
  v_mfma_f32_16x16x32_bf16 v[176:179], a[192:195], a[168:171], v[176:179]
  ds_read_b64_tr_b16 a[220:221], v49 offset:24576
  v_accvgpr_read_b32 v50, a74
  v_mfma_f32_16x16x32_bf16 v[208:211], a[192:195], a[176:179], v[208:211]
  ds_read_b64_tr_b16 a[222:223], v49 offset:25600
  v_accvgpr_read_b32 v51, a75
  v_mfma_f32_16x16x32_bf16 v[208:211], a[196:199], a[180:183], v[208:211]
  buffer_load_dwordx4 v29, s[60:63], s50 offen offset:2048  lds
  v_mfma_f32_16x16x32_bf16 v[240:243], a[196:199], a[188:191], v[240:243]
  v_accvgpr_read_b32 v52, a88
  v_accvgpr_read_b32 v53, a89
  v_mfma_f32_16x16x32_bf16 v[240:243], a[192:195], a[184:187], v[240:243]
  s_waitcnt vmcnt(11) lgkmcnt(15)
  v_accvgpr_read_b32 v54, a90
  v_accvgpr_read_b32 v55, a91
  v_mfma_f32_16x16x32_bf16 v[244:247], a[200:203], a[184:187], v[244:247]
  s_barrier
  s_waitcnt lgkmcnt(13)
  v_mfma_f32_16x16x32_bf16 v[244:247], a[204:207], a[188:191], v[244:247]
  ds_read_b64_tr_b16 a[192:193], v42 offset:32768
  v_cvt_pk_bf16_f32 v80, v62, v63
  v_mfma_f32_16x16x32_bf16 v[212:215], a[204:207], a[180:183], v[212:215]
  buffer_load_dwordx4 v29, s[60:63], s51 offen offset:3072  lds
  v_mfma_f32_16x16x32_bf16 v[212:215], a[200:203], a[176:179], v[212:215]
  s_lshl_b32 s3, s29, 3
  ds_read_b64_tr_b16 a[194:195], v42 offset:33792
  v_cvt_pk_bf16_f32 v81, v50, v51
  v_mfma_f32_16x16x32_bf16 v[180:183], a[200:203], a[168:171], v[180:183]
  s_add_u32 s3, s3, s30
  ds_read_b64_tr_b16 a[196:197], v42 offset:40960
  v_cvt_pk_bf16_f32 v82, v52, v53
  v_mfma_f32_16x16x32_bf16 v[180:183], a[204:207], a[172:175], v[180:183]
  s_lshl_b32 s3, s3, 7
  ds_read_b64_tr_b16 a[198:199], v42 offset:41984
  v_cvt_pk_bf16_f32 v83, v54, v55
  v_mfma_f32_16x16x32_bf16 v[148:151], a[204:207], a[164:167], v[148:151]
  s_add_u32 s3, s3, 524288
  ds_read_b128 a[72:75], v19
  v_mfma_f32_16x16x32_bf16 v[148:151], a[200:203], a[160:163], v[148:151]
  s_waitcnt lgkmcnt(14)
  buffer_store_dword v9, v8, s[20:23], s3 offen sc1
  v_mfma_f32_16x16x32_bf16 v[152:155], a[208:211], a[160:163], v[152:155]
  s_waitcnt lgkmcnt(12)
  ds_read_b64_tr_b16 a[200:201], v43 offset:32768
  v_xor_b32 v26, 0x380, v26
  v_mfma_f32_16x16x32_bf16 v[152:155], a[212:215], a[164:167], v[152:155]
  ds_read_b64_tr_b16 a[202:203], v43 offset:33792
  v_xor_b32 v27, 0x380, v27
  v_mfma_f32_16x16x32_bf16 v[184:187], a[212:215], a[172:175], v[184:187]
  s_add_u32 m0, s96, 0x20000
  ds_read_b64_tr_b16 a[204:205], v43 offset:40960
  v_mfma_f32_16x16x32_bf16 v[184:187], a[208:211], a[168:171], v[184:187]
  buffer_load_dwordx4 v26, s[56:59], s40 offen offset:0  lds
  v_mfma_f32_16x16x32_bf16 v[216:219], a[208:211], a[176:179], v[216:219]
  ds_read_b64_tr_b16 a[206:207], v43 offset:41984
  v_mfma_f32_16x16x32_bf16 v[216:219], a[212:215], a[180:183], v[216:219]
  ds_read_b128 a[88:91], v19
  v_mfma_f32_16x16x32_bf16 v[248:251], a[212:215], a[188:191], v[248:251]
  buffer_load_dwordx4 v27, s[56:59], s41 offen offset:1024  lds
  v_mfma_f32_16x16x32_bf16 v[248:251], a[208:211], a[184:187], v[248:251]
  s_waitcnt lgkmcnt(12)
  ds_read_b128 a[100:103], v19
  v_mfma_f32_16x16x32_bf16 v[252:255], a[216:219], a[184:187], v[252:255]
  s_waitcnt lgkmcnt(11)
  ds_read_b64_tr_b16 a[208:209], v44 offset:32768
  v_mfma_f32_16x16x32_bf16 v[252:255], a[220:223], a[188:191], v[252:255]
  buffer_load_dwordx4 v26, s[56:59], s42 offen offset:2048  lds
  v_mfma_f32_16x16x32_bf16 v[220:223], a[220:223], a[180:183], v[220:223]
  ds_read_b64_tr_b16 a[210:211], v44 offset:33792
  v_mfma_f32_16x16x32_bf16 v[220:223], a[216:219], a[176:179], v[220:223]
  ds_read_b64_tr_b16 a[212:213], v44 offset:40960
  v_mfma_f32_16x16x32_bf16 v[188:191], a[216:219], a[168:171], v[188:191]
  ds_read_b64_tr_b16 a[214:215], v44 offset:41984
  v_mfma_f32_16x16x32_bf16 v[188:191], a[220:223], a[172:175], v[188:191]
  ds_read_b128 a[112:115], v19
  v_mfma_f32_16x16x32_bf16 v[156:159], a[220:223], a[164:167], v[156:159]
  buffer_load_dwordx4 v27, s[56:59], s43 offen offset:3072  lds
  v_mfma_f32_16x16x32_bf16 v[156:159], a[216:219], a[160:163], v[156:159]
  s_waitcnt lgkmcnt(14)
  s_add_u32 m0, s96, 0x21000
  v_accvgpr_read_b32 v56, a104
  v_accvgpr_read_b32 v57, a105
  v_mfma_f32_16x16x32_bf16 v[128:131], a[192:195], a[224:227], v[128:131]
  s_waitcnt lgkmcnt(12)
  ds_read_b64_tr_b16 a[216:217], v45 offset:32768
  v_accvgpr_read_b32 v58, a106
  v_mfma_f32_16x16x32_bf16 v[128:131], a[196:199], a[228:231], v[128:131]
  ds_read_b64_tr_b16 a[218:219], v45 offset:33792
  v_accvgpr_read_b32 v59, a107
  v_mfma_f32_16x16x32_bf16 v[160:163], a[196:199], a[236:239], v[160:163]
  buffer_load_dwordx4 v26, s[56:59], s44 offen offset:0  lds
  v_mfma_f32_16x16x32_bf16 v[160:163], a[192:195], a[232:235], v[160:163]
  ds_read_b64_tr_b16 a[220:221], v45 offset:40960
  v_accvgpr_read_b32 v60, a120
  v_mfma_f32_16x16x32_bf16 v[192:195], a[192:195], a[240:243], v[192:195]
  ds_read_b64_tr_b16 a[222:223], v45 offset:41984
  v_accvgpr_read_b32 v61, a121
  v_mfma_f32_16x16x32_bf16 v[192:195], a[196:199], a[244:247], v[192:195]
  v_accvgpr_read_b32 v62, a122
  v_accvgpr_read_b32 v63, a123
  v_mfma_f32_16x16x32_bf16 v[224:227], a[196:199], a[252:255], v[224:227]
  s_waitcnt vmcnt(10)
  ds_read_b128 a[160:163], v34 offset:32768
  v_cvt_pk_bf16_f32 v84, v56, v57
  v_mfma_f32_16x16x32_bf16 v[224:227], a[192:195], a[248:251], v[224:227]
  s_waitcnt lgkmcnt(14)
  buffer_load_dwordx4 v27, s[56:59], s45 offen offset:1024  lds
  v_mfma_f32_16x16x32_bf16 v[228:231], a[200:203], a[248:251], v[228:231]
  s_waitcnt lgkmcnt(12)
  ds_read_b64_tr_b16 a[192:193], v46 offset:32768
  v_cvt_pk_bf16_f32 v85, v58, v59
  v_mfma_f32_16x16x32_bf16 v[228:231], a[204:207], a[252:255], v[228:231]
  ds_read_b64_tr_b16 a[194:195], v46 offset:33792
  v_cvt_pk_bf16_f32 v86, v60, v61
  v_mfma_f32_16x16x32_bf16 v[196:199], a[204:207], a[244:247], v[196:199]
  ds_read_b64_tr_b16 a[196:197], v46 offset:40960
  v_cvt_pk_bf16_f32 v87, v62, v63
  v_mfma_f32_16x16x32_bf16 v[196:199], a[200:203], a[240:243], v[196:199]
  ds_read_b64_tr_b16 a[198:199], v46 offset:41984
  v_mfma_f32_16x16x32_bf16 v[164:167], a[200:203], a[232:235], v[164:167]
  buffer_load_dwordx4 v26, s[56:59], s46 offen offset:2048  lds
  v_mfma_f32_16x16x32_bf16 v[164:167], a[204:207], a[236:239], v[164:167]
  ds_read_b128 a[164:167], v35 offset:32768
  v_mfma_f32_16x16x32_bf16 v[132:135], a[204:207], a[228:231], v[132:135]
  ds_read_b128 a[168:171], v34 offset:34816
  v_mfma_f32_16x16x32_bf16 v[132:135], a[200:203], a[224:227], v[132:135]
  ds_read_b128 a[172:175], v35 offset:34816
  s_waitcnt lgkmcnt(15)
  v_mfma_f32_16x16x32_bf16 v[136:139], a[208:211], a[224:227], v[136:139]
  s_waitcnt lgkmcnt(13)
  buffer_load_dwordx4 v27, s[56:59], s47 offen offset:3072  lds
  v_mfma_f32_16x16x32_bf16 v[136:139], a[212:215], a[228:231], v[136:139]
  ds_read_b64_tr_b16 a[200:201], v47 offset:32768
  v_xor_b32 v28, 0x380000, v28
  v_mfma_f32_16x16x32_bf16 v[168:171], a[212:215], a[236:239], v[168:171]
  ds_read_b64_tr_b16 a[202:203], v47 offset:33792
  v_xor_b32 v29, 0x380000, v29
  v_mfma_f32_16x16x32_bf16 v[168:171], a[208:211], a[232:235], v[168:171]
  s_add_u32 m0, s97, 0x10000
  ds_read_b64_tr_b16 a[204:205], v47 offset:40960
  v_mfma_f32_16x16x32_bf16 v[200:203], a[208:211], a[240:243], v[200:203]
  ds_read_b64_tr_b16 a[206:207], v47 offset:41984
  v_mfma_f32_16x16x32_bf16 v[200:203], a[212:215], a[244:247], v[200:203]
  buffer_load_dwordx4 v28, s[60:63], s48 offen offset:0  lds
  v_mfma_f32_16x16x32_bf16 v[232:235], a[212:215], a[252:255], v[232:235]
  ds_read_b128 a[176:179], v34 offset:36864
  v_mfma_f32_16x16x32_bf16 v[232:235], a[208:211], a[248:251], v[232:235]
  ds_read_b128 a[180:183], v35 offset:36864
  s_waitcnt lgkmcnt(15)
  v_mfma_f32_16x16x32_bf16 v[236:239], a[216:219], a[248:251], v[236:239]
  ds_read_b64_tr_b16 a[208:209], v48 offset:32768
  s_waitcnt lgkmcnt(15)
  v_mfma_f32_16x16x32_bf16 v[236:239], a[220:223], a[252:255], v[236:239]
  ds_read_b64_tr_b16 a[210:211], v48 offset:33792
  v_mfma_f32_16x16x32_bf16 v[204:207], a[220:223], a[244:247], v[204:207]
  buffer_load_dwordx4 v28, s[60:63], s49 offen offset:1024  lds
  v_mfma_f32_16x16x32_bf16 v[204:207], a[216:219], a[240:243], v[204:207]
  ds_read_b64_tr_b16 a[212:213], v48 offset:40960
  v_mfma_f32_16x16x32_bf16 v[172:175], a[216:219], a[232:235], v[172:175]
  ds_read_b64_tr_b16 a[214:215], v48 offset:41984
  v_accvgpr_read_b32 v50, a76
  v_mfma_f32_16x16x32_bf16 v[172:175], a[220:223], a[236:239], v[172:175]
  ds_read_b128 a[184:187], v34 offset:38912
  v_accvgpr_read_b32 v51, a77
  v_mfma_f32_16x16x32_bf16 v[140:143], a[220:223], a[228:231], v[140:143]
  ds_read_b128 a[188:191], v35 offset:38912
  v_accvgpr_read_b32 v52, a78
  v_mfma_f32_16x16x32_bf16 v[140:143], a[216:219], a[224:227], v[140:143]
  s_waitcnt lgkmcnt(15)
  buffer_load_dwordx4 v29, s[60:63], s50 offen offset:2048  lds
  v_mfma_f32_16x16x32_bf16 v[144:147], a[192:195], a[224:227], v[144:147]
  ds_read_b64_tr_b16 a[216:217], v49 offset:32768
  v_accvgpr_read_b32 v53, a79
  v_mfma_f32_16x16x32_bf16 v[144:147], a[196:199], a[228:231], v[144:147]
  ds_read_b64_tr_b16 a[218:219], v49 offset:33792
  v_accvgpr_read_b32 v54, a92
  v_mfma_f32_16x16x32_bf16 v[176:179], a[196:199], a[236:239], v[176:179]
  ds_read_b64_tr_b16 a[220:221], v49 offset:40960
  v_accvgpr_read_b32 v55, a93
  v_mfma_f32_16x16x32_bf16 v[176:179], a[192:195], a[232:235], v[176:179]
  buffer_load_dwordx4 v29, s[60:63], s51 offen offset:3072  lds
  v_mfma_f32_16x16x32_bf16 v[208:211], a[192:195], a[240:243], v[208:211]
  ds_read_b64_tr_b16 a[222:223], v49 offset:41984
  v_xor_b32 v26, 0x80, v26
  v_mfma_f32_16x16x32_bf16 v[208:211], a[196:199], a[244:247], v[208:211]
  v_xor_b32 v27, 0x80, v27
  v_accvgpr_read_b32 v56, a94
  v_mfma_f32_16x16x32_bf16 v[240:243], a[196:199], a[252:255], v[240:243]
  s_add_u32 m0, s96, 0x0
  v_accvgpr_read_b32 v57, a95
  v_cvt_pk_bf16_f32 v88, v50, v51
  v_mfma_f32_16x16x32_bf16 v[240:243], a[192:195], a[248:251], v[240:243]
  s_waitcnt vmcnt(13) lgkmcnt(14)
  v_cvt_pk_bf16_f32 v89, v52, v53
  v_cvt_pk_bf16_f32 v90, v54, v55
  v_mfma_f32_16x16x32_bf16 v[244:247], a[200:203], a[248:251], v[244:247]
  s_barrier
  s_waitcnt lgkmcnt(12)
  v_mfma_f32_16x16x32_bf16 v[244:247], a[204:207], a[252:255], v[244:247]
  buffer_load_dwordx4 v26, s[56:59], s40 offen offset:0  lds
  v_mfma_f32_16x16x32_bf16 v[212:215], a[204:207], a[244:247], v[212:215]
  ds_read_b64_tr_b16 a[192:193], v42 offset:49152
  v_cvt_pk_bf16_f32 v91, v56, v57
  v_mfma_f32_16x16x32_bf16 v[212:215], a[200:203], a[240:243], v[212:215]
  ds_read_b64_tr_b16 a[194:195], v42 offset:50176
  v_mfma_f32_16x16x32_bf16 v[180:183], a[200:203], a[232:235], v[180:183]
  ds_read_b64_tr_b16 a[196:197], v42 offset:57344
  v_mfma_f32_16x16x32_bf16 v[180:183], a[204:207], a[236:239], v[180:183]
  buffer_load_dwordx4 v27, s[56:59], s41 offen offset:1024  lds
  v_mfma_f32_16x16x32_bf16 v[148:151], a[204:207], a[228:231], v[148:151]
  ds_read_b64_tr_b16 a[198:199], v42 offset:58368
  v_mfma_f32_16x16x32_bf16 v[148:151], a[200:203], a[224:227], v[148:151]
  s_waitcnt lgkmcnt(12)
  ds_read_b128 a[76:79], v19
  v_mfma_f32_16x16x32_bf16 v[152:155], a[208:211], a[224:227], v[152:155]
  s_waitcnt lgkmcnt(11)
  ds_read_b64_tr_b16 a[200:201], v43 offset:49152
  v_mfma_f32_16x16x32_bf16 v[152:155], a[212:215], a[228:231], v[152:155]
  buffer_load_dwordx4 v26, s[56:59], s42 offen offset:2048  lds
  v_mfma_f32_16x16x32_bf16 v[184:187], a[212:215], a[236:239], v[184:187]
  ds_read_b64_tr_b16 a[202:203], v43 offset:50176
  v_mfma_f32_16x16x32_bf16 v[184:187], a[208:211], a[232:235], v[184:187]
  ds_read_b64_tr_b16 a[204:205], v43 offset:57344
  v_mfma_f32_16x16x32_bf16 v[216:219], a[208:211], a[240:243], v[216:219]
  ds_read_b64_tr_b16 a[206:207], v43 offset:58368
  v_mfma_f32_16x16x32_bf16 v[216:219], a[212:215], a[244:247], v[216:219]
  ds_read_b128 a[92:95], v19
  v_mfma_f32_16x16x32_bf16 v[248:251], a[212:215], a[252:255], v[248:251]
  buffer_load_dwordx4 v27, s[56:59], s43 offen offset:3072  lds
  v_mfma_f32_16x16x32_bf16 v[248:251], a[208:211], a[248:251], v[248:251]
  s_waitcnt lgkmcnt(12)
  ds_read_b128 a[104:107], v19
  v_mfma_f32_16x16x32_bf16 v[252:255], a[216:219], a[248:251], v[252:255]
  s_waitcnt lgkmcnt(11)
  s_add_u32 m0, s96, 0x1000
  ds_read_b64_tr_b16 a[208:209], v44 offset:49152
  v_mfma_f32_16x16x32_bf16 v[252:255], a[220:223], a[252:255], v[252:255]
  ds_read_b64_tr_b16 a[210:211], v44 offset:50176
  v_mfma_f32_16x16x32_bf16 v[220:223], a[220:223], a[244:247], v[220:223]
  ds_read_b64_tr_b16 a[212:213], v44 offset:57344
  v_accvgpr_read_b32 v58, a108
  v_mfma_f32_16x16x32_bf16 v[220:223], a[216:219], a[240:243], v[220:223]
  buffer_load_dwordx4 v26, s[56:59], s44 offen offset:0  lds
  v_mfma_f32_16x16x32_bf16 v[188:191], a[216:219], a[232:235], v[188:191]
  ds_read_b64_tr_b16 a[214:215], v44 offset:58368
  v_accvgpr_read_b32 v59, a109
  v_mfma_f32_16x16x32_bf16 v[188:191], a[220:223], a[236:239], v[188:191]
  v_accvgpr_read_b32 v60, a110
  v_accvgpr_read_b32 v61, a111
  v_mfma_f32_16x16x32_bf16 v[156:159], a[220:223], a[228:231], v[156:159]
  v_accvgpr_read_b32 v62, a124
  v_accvgpr_read_b32 v63, a125
  v_mfma_f32_16x16x32_bf16 v[156:159], a[216:219], a[224:227], v[156:159]
  s_waitcnt lgkmcnt(13)
  buffer_load_dwordx4 v27, s[56:59], s45 offen offset:1024  lds
  v_mfma_f32_16x16x32_bf16 v[128:131], a[192:195], a[160:163], v[128:131]
  s_waitcnt lgkmcnt(11)
  s_lshl_b32 s12, s29, 18
  ds_read_b64_tr_b16 a[216:217], v45 offset:49152
  v_accvgpr_read_b32 v50, a126
  v_mfma_f32_16x16x32_bf16 v[128:131], a[196:199], a[164:167], v[128:131]
  ds_read_b64_tr_b16 a[218:219], v45 offset:50176
  v_accvgpr_read_b32 v51, a127
  v_mfma_f32_16x16x32_bf16 v[160:163], a[196:199], a[172:175], v[160:163]
  ds_read_b64_tr_b16 a[220:221], v45 offset:57344
  v_cvt_pk_bf16_f32 v92, v58, v59
  v_mfma_f32_16x16x32_bf16 v[160:163], a[192:195], a[168:171], v[160:163]
  ds_read_b64_tr_b16 a[222:223], v45 offset:58368
  v_cvt_pk_bf16_f32 v93, v60, v61
  v_mfma_f32_16x16x32_bf16 v[192:195], a[192:195], a[176:179], v[192:195]
  buffer_load_dwordx4 v26, s[56:59], s46 offen offset:2048  lds
  v_mfma_f32_16x16x32_bf16 v[192:195], a[196:199], a[180:183], v[192:195]
  v_cvt_pk_bf16_f32 v94, v62, v63
  v_cvt_pk_bf16_f32 v95, v50, v51
  v_mfma_f32_16x16x32_bf16 v[224:227], a[196:199], a[188:191], v[224:227]
  s_waitcnt vmcnt(11)
  s_add_u32 s8, s74, s12
  s_addc_u32 s9, s75, 0
  ds_read_b128 a[224:227], v36 offset:0
  v_mfma_f32_16x16x32_bf16 v[224:227], a[192:195], a[184:187], v[224:227]
  s_waitcnt lgkmcnt(13)
  s_mov_b32 s10, 0x40000
  ds_read_b128 a[228:231], v37 offset:0
  v_mfma_f32_16x16x32_bf16 v[228:231], a[200:203], a[184:187], v[228:231]
  s_waitcnt lgkmcnt(12)
  s_mov_b32 s11, 0x20000
  ds_read_b64_tr_b16 a[192:193], v46 offset:49152
  v_mfma_f32_16x16x32_bf16 v[228:231], a[204:207], a[188:191], v[228:231]
  s_sub_u32 s12, s30, 1
  buffer_load_dwordx4 v27, s[56:59], s47 offen offset:3072  lds
  v_mfma_f32_16x16x32_bf16 v[196:199], a[204:207], a[180:183], v[196:199]
  s_lshl_b32 s12, s12, 14
  ds_read_b64_tr_b16 a[194:195], v46 offset:50176
  v_xor_b32 v28, 0x80000, v28
  v_mfma_f32_16x16x32_bf16 v[196:199], a[200:203], a[176:179], v[196:199]
  s_mov_b32 s13, 0x18000
  ds_read_b64_tr_b16 a[196:197], v46 offset:57344
  v_xor_b32 v29, 0x80000, v29
  v_mfma_f32_16x16x32_bf16 v[164:167], a[200:203], a[168:171], v[164:167]
  s_add_u32 m0, s97, 0x14000
  ds_read_b64_tr_b16 a[198:199], v46 offset:58368
  v_mfma_f32_16x16x32_bf16 v[164:167], a[204:207], a[172:175], v[164:167]
  ds_read_b128 a[232:235], v36 offset:2048
  v_mfma_f32_16x16x32_bf16 v[132:135], a[204:207], a[164:167], v[132:135]
  buffer_load_dwordx4 v28, s[60:63], s48 offen offset:0  lds
  v_mfma_f32_16x16x32_bf16 v[132:135], a[200:203], a[160:163], v[132:135]
  s_waitcnt lgkmcnt(13)
  ds_read_b128 a[236:239], v37 offset:2048
  v_mfma_f32_16x16x32_bf16 v[136:139], a[208:211], a[160:163], v[136:139]
  s_waitcnt lgkmcnt(12)
  ds_read_b64_tr_b16 a[200:201], v47 offset:49152
  v_mfma_f32_16x16x32_bf16 v[136:139], a[212:215], a[164:167], v[136:139]
  ds_read_b64_tr_b16 a[202:203], v47 offset:50176
  v_mfma_f32_16x16x32_bf16 v[168:171], a[212:215], a[172:175], v[168:171]
  buffer_load_dwordx4 v28, s[60:63], s49 offen offset:1024  lds
  v_mfma_f32_16x16x32_bf16 v[168:171], a[208:211], a[168:171], v[168:171]
  ds_read_b64_tr_b16 a[204:205], v47 offset:57344
  v_mfma_f32_16x16x32_bf16 v[200:203], a[208:211], a[176:179], v[200:203]
  ds_read_b64_tr_b16 a[206:207], v47 offset:58368
  v_mfma_f32_16x16x32_bf16 v[200:203], a[212:215], a[180:183], v[200:203]
  ds_read_b128 a[240:243], v36 offset:4096
  v_mfma_f32_16x16x32_bf16 v[232:235], a[212:215], a[188:191], v[232:235]
  ds_read_b128 a[244:247], v37 offset:4096
  v_mfma_f32_16x16x32_bf16 v[232:235], a[208:211], a[184:187], v[232:235]
  s_waitcnt lgkmcnt(15)
  buffer_load_dwordx4 v29, s[60:63], s50 offen offset:2048  lds
  v_mfma_f32_16x16x32_bf16 v[236:239], a[216:219], a[184:187], v[236:239]
  ds_read_b64_tr_b16 a[208:209], v48 offset:49152
  s_waitcnt lgkmcnt(15)
  v_mfma_f32_16x16x32_bf16 v[236:239], a[220:223], a[188:191], v[236:239]
  ds_read_b64_tr_b16 a[210:211], v48 offset:50176
  v_mfma_f32_16x16x32_bf16 v[204:207], a[220:223], a[180:183], v[204:207]
  ds_read_b64_tr_b16 a[212:213], v48 offset:57344
  v_mfma_f32_16x16x32_bf16 v[204:207], a[216:219], a[176:179], v[204:207]
  ds_read_b64_tr_b16 a[214:215], v48 offset:58368
  v_mfma_f32_16x16x32_bf16 v[172:175], a[216:219], a[168:171], v[172:175]
  buffer_load_dwordx4 v29, s[60:63], s51 offen offset:3072  lds
  v_mfma_f32_16x16x32_bf16 v[172:175], a[220:223], a[172:175], v[172:175]
  ds_read_b128 a[248:251], v36 offset:6144
  v_xor_b32 v26, 0x180, v26
  v_mfma_f32_16x16x32_bf16 v[140:143], a[220:223], a[164:167], v[140:143]
  ds_read_b128 a[252:255], v37 offset:6144
  v_xor_b32 v27, 0x180, v27
  v_mfma_f32_16x16x32_bf16 v[140:143], a[216:219], a[160:163], v[140:143]
  s_add_u32 m0, s96, 0x8000
  ds_read_b128 a[108:111], v19
  s_waitcnt lgkmcnt(15)
  v_mfma_f32_16x16x32_bf16 v[144:147], a[192:195], a[160:163], v[144:147]
  buffer_load_dwordx4 v26, s[56:59], s40 offen offset:0  lds
  v_mfma_f32_16x16x32_bf16 v[144:147], a[196:199], a[164:167], v[144:147]
  ds_read_b64_tr_b16 a[216:217], v49 offset:49152
  v_mfma_f32_16x16x32_bf16 v[176:179], a[196:199], a[172:175], v[176:179]
  ds_read_b64_tr_b16 a[218:219], v49 offset:50176
  v_mfma_f32_16x16x32_bf16 v[176:179], a[192:195], a[168:171], v[176:179]
  ds_read_b64_tr_b16 a[220:221], v49 offset:57344
  v_mfma_f32_16x16x32_bf16 v[208:211], a[192:195], a[176:179], v[208:211]
  ds_read_b64_tr_b16 a[222:223], v49 offset:58368
  v_mfma_f32_16x16x32_bf16 v[208:211], a[196:199], a[180:183], v[208:211]
  buffer_load_dwordx4 v27, s[56:59], s41 offen offset:1024  lds
  v_mfma_f32_16x16x32_bf16 v[240:243], a[196:199], a[188:191], v[240:243]
  ds_read_b128 a[116:119], v19
  v_mfma_f32_16x16x32_bf16 v[240:243], a[192:195], a[184:187], v[240:243]
  s_waitcnt vmcnt(14)
  ds_read_b128 a[120:123], v19
  s_waitcnt lgkmcnt(15)
  v_mfma_f32_16x16x32_bf16 v[244:247], a[200:203], a[184:187], v[244:247]
  s_barrier
  v_mfma_f32_16x16x32_bf16 v[244:247], a[204:207], a[188:191], v[244:247]
  ds_read_b64_tr_b16 a[192:193], v42 offset:0
  v_mfma_f32_16x16x32_bf16 v[212:215], a[204:207], a[180:183], v[212:215]
  buffer_load_dwordx4 v26, s[56:59], s42 offen offset:2048  lds
  v_mfma_f32_16x16x32_bf16 v[212:215], a[200:203], a[176:179], v[212:215]
  ds_read_b64_tr_b16 a[194:195], v42 offset:1024
  v_mfma_f32_16x16x32_bf16 v[180:183], a[200:203], a[168:171], v[180:183]
  ds_read_b64_tr_b16 a[196:197], v42 offset:8192
  v_mfma_f32_16x16x32_bf16 v[180:183], a[204:207], a[172:175], v[180:183]
  ds_read_b64_tr_b16 a[198:199], v42 offset:9216
  v_mfma_f32_16x16x32_bf16 v[148:151], a[204:207], a[164:167], v[148:151]
  buffer_load_dwordx4 v27, s[56:59], s43 offen offset:3072  lds
  v_mfma_f32_16x16x32_bf16 v[148:151], a[200:203], a[160:163], v[148:151]
  ds_read_b128 a[124:127], v19
  s_waitcnt lgkmcnt(15)
  v_mfma_f32_16x16x32_bf16 v[152:155], a[208:211], a[160:163], v[152:155]
  s_add_u32 m0, s96, 0x9000
  ds_read_b64_tr_b16 a[200:201], v43 offset:0
  s_waitcnt lgkmcnt(15)
  v_mfma_f32_16x16x32_bf16 v[152:155], a[212:215], a[164:167], v[152:155]
  ds_read_b64_tr_b16 a[202:203], v43 offset:1024
  v_mfma_f32_16x16x32_bf16 v[184:187], a[212:215], a[172:175], v[184:187]
L_pad8:
  s_cbranch_execz L_hr0
  ds_read_b64_tr_b16 a[204:205], v43 offset:8192
  v_mfma_f32_16x16x32_bf16 v[184:187], a[208:211], a[168:171], v[184:187]
  buffer_load_dwordx4 v26, s[56:59], s44 offen offset:0  lds
  v_mfma_f32_16x16x32_bf16 v[216:219], a[208:211], a[176:179], v[216:219]
  ds_read_b64_tr_b16 a[206:207], v43 offset:9216
  v_mfma_f32_16x16x32_bf16 v[216:219], a[212:215], a[180:183], v[216:219]
  v_mfma_f32_16x16x32_bf16 v[248:251], a[212:215], a[188:191], v[248:251]
  v_mfma_f32_16x16x32_bf16 v[248:251], a[208:211], a[184:187], v[248:251]
  s_waitcnt lgkmcnt(13)
  v_mfma_f32_16x16x32_bf16 v[252:255], a[216:219], a[184:187], v[252:255]
  s_waitcnt lgkmcnt(11)
  buffer_load_dwordx4 v27, s[56:59], s45 offen offset:1024  lds
  v_mfma_f32_16x16x32_bf16 v[252:255], a[220:223], a[188:191], v[252:255]
  ds_read_b64_tr_b16 a[208:209], v44 offset:0
  v_mfma_f32_16x16x32_bf16 v[220:223], a[220:223], a[180:183], v[220:223]
  ds_read_b64_tr_b16 a[210:211], v44 offset:1024
  v_mfma_f32_16x16x32_bf16 v[220:223], a[216:219], a[176:179], v[220:223]
  ds_read_b64_tr_b16 a[212:213], v44 offset:8192
  v_mfma_f32_16x16x32_bf16 v[188:191], a[216:219], a[168:171], v[188:191]
  ds_read_b64_tr_b16 a[214:215], v44 offset:9216
  v_mfma_f32_16x16x32_bf16 v[188:191], a[220:223], a[172:175], v[188:191]
  buffer_load_dwordx4 v26, s[56:59], s46 offen offset:2048  lds
  v_mfma_f32_16x16x32_bf16 v[156:159], a[220:223], a[164:167], v[156:159]
  v_mfma_f32_16x16x32_bf16 v[156:159], a[216:219], a[160:163], v[156:159]
  s_waitcnt lgkmcnt(11)
  v_mfma_f32_16x16x32_bf16 v[128:131], a[192:195], a[224:227], v[128:131]
  s_waitcnt lgkmcnt(9)
  ds_read_b64_tr_b16 a[216:217], v45 offset:0
  v_mfma_f32_16x16x32_bf16 v[128:131], a[196:199], a[228:231], v[128:131]
  buffer_load_dwordx4 v27, s[56:59], s47 offen offset:3072  lds
  v_mfma_f32_16x16x32_bf16 v[160:163], a[196:199], a[236:239], v[160:163]
  ds_read_b64_tr_b16 a[218:219], v45 offset:1024
  v_xor_b32 v28, 0x180000, v28
  v_mfma_f32_16x16x32_bf16 v[160:163], a[192:195], a[232:235], v[160:163]
  ds_read_b64_tr_b16 a[220:221], v45 offset:8192
  v_xor_b32 v29, 0x180000, v29
  v_mfma_f32_16x16x32_bf16 v[192:195], a[192:195], a[240:243], v[192:195]
  s_add_u32 m0, s97, 0x18000
  ds_read_b64_tr_b16 a[222:223], v45 offset:9216
  v_mfma_f32_16x16x32_bf16 v[192:195], a[196:199], a[244:247], v[192:195]
  s_waitcnt vmcnt(12)
  ds_read_b128 a[160:163], v34 offset:0
  v_mfma_f32_16x16x32_bf16 v[224:227], a[196:199], a[252:255], v[224:227]
  buffer_load_dwordx4 v28, s[60:63], s48 offen offset:0  lds
  v_mfma_f32_16x16x32_bf16 v[224:227], a[192:195], a[248:251], v[224:227]
  s_waitcnt lgkmcnt(11)
  ds_read_b128 a[164:167], v35 offset:0
  v_mfma_f32_16x16x32_bf16 v[228:231], a[200:203], a[248:251], v[228:231]
  s_waitcnt lgkmcnt(10)
  ds_read_b64_tr_b16 a[192:193], v46 offset:0
  v_mfma_f32_16x16x32_bf16 v[228:231], a[204:207], a[252:255], v[228:231]
  ds_read_b64_tr_b16 a[194:195], v46 offset:1024
  v_mfma_f32_16x16x32_bf16 v[196:199], a[204:207], a[244:247], v[196:199]
  ds_read_b64_tr_b16 a[196:197], v46 offset:8192
  v_mfma_f32_16x16x32_bf16 v[196:199], a[200:203], a[240:243], v[196:199]
  buffer_load_dwordx4 v28, s[60:63], s49 offen offset:1024  lds
  v_mfma_f32_16x16x32_bf16 v[164:167], a[200:203], a[232:235], v[164:167]
  ds_read_b64_tr_b16 a[198:199], v46 offset:9216
  v_mfma_f32_16x16x32_bf16 v[164:167], a[204:207], a[236:239], v[164:167]
  ds_read_b128 a[168:171], v34 offset:2048
  v_mfma_f32_16x16x32_bf16 v[132:135], a[204:207], a[228:231], v[132:135]
  ds_read_b128 a[172:175], v35 offset:2048
  v_mfma_f32_16x16x32_bf16 v[132:135], a[200:203], a[224:227], v[132:135]
  s_waitcnt lgkmcnt(14)
  buffer_load_dwordx4 v29, s[60:63], s50 offen offset:2048  lds
  v_mfma_f32_16x16x32_bf16 v[136:139], a[208:211], a[224:227], v[136:139]
  s_waitcnt lgkmcnt(12)
  ds_read_b64_tr_b16 a[200:201], v47 offset:0
  v_mfma_f32_16x16x32_bf16 v[136:139], a[212:215], a[228:231], v[136:139]
  ds_read_b64_tr_b16 a[202:203], v47 offset:1024
  v_mfma_f32_16x16x32_bf16 v[168:171], a[212:215], a[236:239], v[168:171]
  ds_read_b64_tr_b16 a[204:205], v47 offset:8192
  v_mfma_f32_16x16x32_bf16 v[168:171], a[208:211], a[232:235], v[168:171]
  ds_read_b64_tr_b16 a[206:207], v47 offset:9216
  v_mfma_f32_16x16x32_bf16 v[200:203], a[208:211], a[240:243], v[200:203]
  buffer_load_dwordx4 v29, s[60:63], s51 offen offset:3072  lds
  v_mfma_f32_16x16x32_bf16 v[200:203], a[212:215], a[244:247], v[200:203]
  ds_read_b128 a[176:179], v34 offset:4096
  v_xor_b32 v26, 0x80, v26
  v_mfma_f32_16x16x32_bf16 v[232:235], a[212:215], a[252:255], v[232:235]
  ds_read_b128 a[180:183], v35 offset:4096
  v_xor_b32 v27, 0x80, v27
  v_mfma_f32_16x16x32_bf16 v[232:235], a[208:211], a[248:251], v[232:235]
  s_waitcnt lgkmcnt(15)
  s_add_u32 m0, s96, 0x20000
  v_mfma_f32_16x16x32_bf16 v[236:239], a[216:219], a[248:251], v[236:239]
  ds_read_b64_tr_b16 a[208:209], v48 offset:0
  s_waitcnt lgkmcnt(15)
  v_mfma_f32_16x16x32_bf16 v[236:239], a[220:223], a[252:255], v[236:239]
  buffer_load_dwordx4 v26, s[56:59], s40 offen offset:0  lds
  v_mfma_f32_16x16x32_bf16 v[204:207], a[220:223], a[244:247], v[204:207]
  ds_read_b64_tr_b16 a[210:211], v48 offset:1024
  v_mfma_f32_16x16x32_bf16 v[204:207], a[216:219], a[240:243], v[204:207]
  ds_read_b64_tr_b16 a[212:213], v48 offset:8192
  v_mfma_f32_16x16x32_bf16 v[172:175], a[216:219], a[232:235], v[172:175]
  ds_read_b64_tr_b16 a[214:215], v48 offset:9216
  v_mfma_f32_16x16x32_bf16 v[172:175], a[220:223], a[236:239], v[172:175]
  buffer_load_dwordx4 v27, s[56:59], s41 offen offset:1024  lds
  v_mfma_f32_16x16x32_bf16 v[140:143], a[220:223], a[228:231], v[140:143]
  ds_read_b128 a[184:187], v34 offset:6144
  v_mfma_f32_16x16x32_bf16 v[140:143], a[216:219], a[224:227], v[140:143]
  ds_read_b128 a[188:191], v35 offset:6144
  s_waitcnt lgkmcnt(15)
  v_mfma_f32_16x16x32_bf16 v[144:147], a[192:195], a[224:227], v[144:147]
  ds_read_b64_tr_b16 a[216:217], v49 offset:0
  s_waitcnt lgkmcnt(15)
  v_mfma_f32_16x16x32_bf16 v[144:147], a[196:199], a[228:231], v[144:147]
  ds_read_b64_tr_b16 a[218:219], v49 offset:1024
  v_mfma_f32_16x16x32_bf16 v[176:179], a[196:199], a[236:239], v[176:179]
  buffer_load_dwordx4 v26, s[56:59], s42 offen offset:2048  lds
  v_mfma_f32_16x16x32_bf16 v[176:179], a[192:195], a[232:235], v[176:179]
  ds_read_b64_tr_b16 a[220:221], v49 offset:8192
  v_mfma_f32_16x16x32_bf16 v[208:211], a[192:195], a[240:243], v[208:211]
  ds_read_b64_tr_b16 a[222:223], v49 offset:9216
  v_mfma_f32_16x16x32_bf16 v[208:211], a[196:199], a[244:247], v[208:211]
  v_mfma_f32_16x16x32_bf16 v[240:243], a[196:199], a[252:255], v[240:243]
  v_mfma_f32_16x16x32_bf16 v[240:243], a[192:195], a[248:251], v[240:243]
  s_waitcnt vmcnt(15) lgkmcnt(14)
  buffer_load_dwordx4 v27, s[56:59], s43 offen offset:3072  lds
  v_mfma_f32_16x16x32_bf16 v[244:247], a[200:203], a[248:251], v[244:247]
  s_barrier
  s_waitcnt lgkmcnt(12)
  v_mfma_f32_16x16x32_bf16 v[244:247], a[204:207], a[252:255], v[244:247]
  ds_read_b64_tr_b16 a[192:193], v42 offset:16384
  v_accvgpr_write_b32 a144, v14
  v_mfma_f32_16x16x32_bf16 v[212:215], a[204:207], a[244:247], v[212:215]
  ds_read_b64_tr_b16 a[194:195], v42 offset:17408
  v_accvgpr_write_b32 a145, v14
  v_mfma_f32_16x16x32_bf16 v[212:215], a[200:203], a[240:243], v[212:215]
  ds_read_b64_tr_b16 a[196:197], v42 offset:24576
  v_accvgpr_write_b32 a146, v14
  v_mfma_f32_16x16x32_bf16 v[180:183], a[200:203], a[232:235], v[180:183]
  buffer_load_dword v10, v7, s[20:23], 0 offen offset:0 sc1
  v_mfma_f32_16x16x32_bf16 v[180:183], a[204:207], a[236:239], v[180:183]
  s_add_u32 m0, s96, 0x21000
  ds_read_b64_tr_b16 a[198:199], v42 offset:25600
  v_accvgpr_write_b32 a147, v14
  v_mfma_f32_16x16x32_bf16 v[148:151], a[204:207], a[228:231], v[148:151]
  v_mfma_f32_16x16x32_bf16 v[148:151], a[200:203], a[224:227], v[148:151]
  s_waitcnt lgkmcnt(12)
  buffer_load_dwordx4 v26, s[56:59], s44 offen offset:0  lds
  v_mfma_f32_16x16x32_bf16 v[152:155], a[208:211], a[224:227], v[152:155]
  s_waitcnt lgkmcnt(10)
  ds_read_b64_tr_b16 a[200:201], v43 offset:16384
  v_mfma_f32_16x16x32_bf16 v[152:155], a[212:215], a[228:231], v[152:155]
  ds_read_b64_tr_b16 a[202:203], v43 offset:17408
  v_mfma_f32_16x16x32_bf16 v[184:187], a[212:215], a[236:239], v[184:187]
  buffer_load_dwordx4 v27, s[56:59], s45 offen offset:1024  lds
  v_mfma_f32_16x16x32_bf16 v[184:187], a[208:211], a[232:235], v[184:187]
  ds_read_b64_tr_b16 a[204:205], v43 offset:24576
  v_mfma_f32_16x16x32_bf16 v[216:219], a[208:211], a[240:243], v[216:219]
  ds_read_b64_tr_b16 a[206:207], v43 offset:25600
  v_mfma_f32_16x16x32_bf16 v[216:219], a[212:215], a[244:247], v[216:219]
  v_mfma_f32_16x16x32_bf16 v[248:251], a[212:215], a[252:255], v[248:251]
  buffer_load_dwordx4 v26, s[56:59], s46 offen offset:2048  lds
  v_mfma_f32_16x16x32_bf16 v[248:251], a[208:211], a[248:251], v[248:251]
  s_waitcnt lgkmcnt(10)
  v_mfma_f32_16x16x32_bf16 v[252:255], a[216:219], a[248:251], v[252:255]
  s_waitcnt lgkmcnt(8)
  ds_read_b64_tr_b16 a[208:209], v44 offset:16384
  v_lshlrev_b32 v22, 6, v0
  v_mfma_f32_16x16x32_bf16 v[252:255], a[220:223], a[252:255], v[252:255]
  ds_read_b64_tr_b16 a[210:211], v44 offset:17408
  v_mfma_f32_16x16x32_bf16 v[220:223], a[220:223], a[244:247], v[220:223]
  ds_read_b64_tr_b16 a[212:213], v44 offset:24576
  v_mfma_f32_16x16x32_bf16 v[220:223], a[216:219], a[240:243], v[220:223]
  buffer_load_dwordx4 v27, s[56:59], s47 offen offset:3072  lds
  v_mfma_f32_16x16x32_bf16 v[188:191], a[216:219], a[232:235], v[188:191]
  ds_read_b64_tr_b16 a[214:215], v44 offset:25600
  v_xor_b32 v28, 0x80000, v28
  v_mfma_f32_16x16x32_bf16 v[188:191], a[220:223], a[236:239], v[188:191]
  v_xor_b32 v29, 0x80000, v29
  v_mfma_f32_16x16x32_bf16 v[156:159], a[220:223], a[228:231], v[156:159]
  s_add_u32 m0, s97, 0x1c000
  v_mfma_f32_16x16x32_bf16 v[156:159], a[216:219], a[224:227], v[156:159]
  s_waitcnt lgkmcnt(10)
  buffer_load_dwordx4 v28, s[60:63], s48 offen offset:0  lds
  v_mfma_f32_16x16x32_bf16 v[128:131], a[192:195], a[160:163], v[128:131]
  s_waitcnt lgkmcnt(8)
  ds_read_b64_tr_b16 a[216:217], v45 offset:16384
  v_mfma_f32_16x16x32_bf16 v[128:131], a[196:199], a[164:167], v[128:131]
  ds_read_b64_tr_b16 a[218:219], v45 offset:17408
  v_mfma_f32_16x16x32_bf16 v[160:163], a[196:199], a[172:175], v[160:163]
  ds_read_b64_tr_b16 a[220:221], v45 offset:24576
  v_mfma_f32_16x16x32_bf16 v[160:163], a[192:195], a[168:171], v[160:163]
  ds_read_b64_tr_b16 a[222:223], v45 offset:25600
  v_mfma_f32_16x16x32_bf16 v[192:195], a[192:195], a[176:179], v[192:195]
  buffer_load_dwordx4 v28, s[60:63], s49 offen offset:1024  lds
  v_mfma_f32_16x16x32_bf16 v[192:195], a[196:199], a[180:183], v[192:195]
  s_waitcnt vmcnt(15)
  ds_read_b128 a[224:227], v34 offset:32768
  v_mfma_f32_16x16x32_bf16 v[224:227], a[196:199], a[188:191], v[224:227]
  ds_read_b128 a[228:231], v35 offset:32768
  v_mfma_f32_16x16x32_bf16 v[224:227], a[192:195], a[184:187], v[224:227]
  s_waitcnt lgkmcnt(12)
  v_mfma_f32_16x16x32_bf16 v[228:231], a[200:203], a[184:187], v[228:231]
  s_waitcnt lgkmcnt(10)
  ds_read_b64_tr_b16 a[192:193], v46 offset:16384
  v_mfma_f32_16x16x32_bf16 v[228:231], a[204:207], a[188:191], v[228:231]
  buffer_load_dwordx4 v29, s[60:63], s50 offen offset:2048  lds
  v_mfma_f32_16x16x32_bf16 v[196:199], a[204:207], a[180:183], v[196:199]
  ds_read_b64_tr_b16 a[194:195], v46 offset:17408
  v_mfma_f32_16x16x32_bf16 v[196:199], a[200:203], a[176:179], v[196:199]
  ds_read_b64_tr_b16 a[196:197], v46 offset:24576
  v_mfma_f32_16x16x32_bf16 v[164:167], a[200:203], a[168:171], v[164:167]
  ds_read_b64_tr_b16 a[198:199], v46 offset:25600
  v_mfma_f32_16x16x32_bf16 v[164:167], a[204:207], a[172:175], v[164:167]
  buffer_load_dwordx4 v29, s[60:63], s51 offen offset:3072  lds
  v_mfma_f32_16x16x32_bf16 v[132:135], a[204:207], a[164:167], v[132:135]
  ds_read_b128 a[232:235], v34 offset:34816
  v_mfma_f32_16x16x32_bf16 v[132:135], a[200:203], a[160:163], v[132:135]
  s_waitcnt lgkmcnt(13)
  s_mov_b32 s3, 0x80000
  ds_read_b128 a[236:239], v35 offset:34816
  v_mfma_f32_16x16x32_bf16 v[136:139], a[208:211], a[160:163], v[136:139]
  s_waitcnt lgkmcnt(12)
  ds_read_b64_tr_b16 a[200:201], v47 offset:16384
  v_mfma_f32_16x16x32_bf16 v[136:139], a[212:215], a[164:167], v[136:139]
  ds_read_b64_tr_b16 a[202:203], v47 offset:17408
  v_mfma_f32_16x16x32_bf16 v[168:171], a[212:215], a[172:175], v[168:171]
  buffer_store_dwordx4 v[64:67], v12, s[16:19], s3 offen offset:0 sc1
  v_mfma_f32_16x16x32_bf16 v[168:171], a[208:211], a[168:171], v[168:171]
  s_mov_b32 s3, 0x81000
  ds_read_b64_tr_b16 a[204:205], v47 offset:24576
  v_mfma_f32_16x16x32_bf16 v[200:203], a[208:211], a[176:179], v[200:203]
  ds_read_b64_tr_b16 a[206:207], v47 offset:25600
  v_mfma_f32_16x16x32_bf16 v[200:203], a[212:215], a[180:183], v[200:203]
  buffer_store_dwordx4 v[80:83], v12, s[16:19], s3 offen offset:0 sc1
  v_mfma_f32_16x16x32_bf16 v[232:235], a[212:215], a[188:191], v[232:235]
  ds_read_b128 a[240:243], v34 offset:36864
  v_mfma_f32_16x16x32_bf16 v[232:235], a[208:211], a[184:187], v[232:235]
  ds_read_b128 a[244:247], v35 offset:36864
  s_waitcnt lgkmcnt(15)
  v_mfma_f32_16x16x32_bf16 v[236:239], a[216:219], a[184:187], v[236:239]
  ds_read_b64_tr_b16 a[208:209], v48 offset:16384
  s_waitcnt lgkmcnt(15)
  v_mfma_f32_16x16x32_bf16 v[236:239], a[220:223], a[188:191], v[236:239]
  ds_read_b64_tr_b16 a[210:211], v48 offset:17408
  v_mfma_f32_16x16x32_bf16 v[204:207], a[220:223], a[180:183], v[204:207]
  ds_read_b64_tr_b16 a[212:213], v48 offset:24576
  v_mfma_f32_16x16x32_bf16 v[204:207], a[216:219], a[176:179], v[204:207]
  ds_read_b64_tr_b16 a[214:215], v48 offset:25600
  v_mfma_f32_16x16x32_bf16 v[172:175], a[216:219], a[168:171], v[172:175]
  ds_read_b128 a[248:251], v34 offset:38912
  v_mfma_f32_16x16x32_bf16 v[172:175], a[220:223], a[172:175], v[172:175]
  v_mfma_f32_16x16x32_bf16 v[140:143], a[220:223], a[164:167], v[140:143]
  ds_read_b128 a[252:255], v35 offset:38912
  v_mfma_f32_16x16x32_bf16 v[140:143], a[216:219], a[160:163], v[140:143]
  s_waitcnt lgkmcnt(15)
  v_mfma_f32_16x16x32_bf16 v[144:147], a[192:195], a[160:163], v[144:147]
  ds_read_b64_tr_b16 a[216:217], v49 offset:16384
  s_waitcnt lgkmcnt(15)
  v_mfma_f32_16x16x32_bf16 v[144:147], a[196:199], a[164:167], v[144:147]
  ds_read_b64_tr_b16 a[218:219], v49 offset:17408
  v_mfma_f32_16x16x32_bf16 v[176:179], a[196:199], a[172:175], v[176:179]
  ds_read_b64_tr_b16 a[220:221], v49 offset:24576
  v_mfma_f32_16x16x32_bf16 v[176:179], a[192:195], a[168:171], v[176:179]
  ds_read_b64_tr_b16 a[222:223], v49 offset:25600
  v_mfma_f32_16x16x32_bf16 v[208:211], a[192:195], a[176:179], v[208:211]
  v_mfma_f32_16x16x32_bf16 v[208:211], a[196:199], a[180:183], v[208:211]
  v_mfma_f32_16x16x32_bf16 v[240:243], a[196:199], a[188:191], v[240:243]
  s_waitcnt vmcnt(10)
  v_cmp_ne_u32 vcc, 1, v10
  s_nop 2
  s_cbranch_vccnz L_kv_wait
L_kv_ok:
  v_mfma_f32_16x16x32_bf16 v[240:243], a[192:195], a[184:187], v[240:243]
  s_waitcnt lgkmcnt(14)
  v_mfma_f32_16x16x32_bf16 v[244:247], a[200:203], a[184:187], v[244:247]
  s_barrier
  s_waitcnt lgkmcnt(12)
  v_mfma_f32_16x16x32_bf16 v[244:247], a[204:207], a[188:191], v[244:247]
  s_mov_b32 s3, 0x80000
  ds_read_b64_tr_b16 a[192:193], v42 offset:32768
  v_mfma_f32_16x16x32_bf16 v[212:215], a[204:207], a[180:183], v[212:215]
  buffer_store_dwordx4 v[96:99], v11, s[16:19], s3 offen offset:0 sc1
  v_mfma_f32_16x16x32_bf16 v[212:215], a[200:203], a[176:179], v[212:215]
  s_add_u32 s3, s100, 128
  ds_read_b64_tr_b16 a[194:195], v42 offset:33792
  v_mfma_f32_16x16x32_bf16 v[180:183], a[200:203], a[168:171], v[180:183]
  s_cmp_eq_u32 s30, 7
  s_cselect_b32 s3, s3, 0x1000
  ds_read_b64_tr_b16 a[196:197], v42 offset:40960
  v_mfma_f32_16x16x32_bf16 v[180:183], a[204:207], a[172:175], v[180:183]
  buffer_store_dword v9, v8, s[4:7], s3 offen sc1
  v_mfma_f32_16x16x32_bf16 v[148:151], a[204:207], a[164:167], v[148:151]
  s_mov_b32 s98, 0x0
  ds_read_b64_tr_b16 a[198:199], v42 offset:41984
  v_mfma_f32_16x16x32_bf16 v[148:151], a[200:203], a[160:163], v[148:151]
  s_waitcnt lgkmcnt(12)
  s_add_u32 m0, s97, 0x10000
  v_mfma_f32_16x16x32_bf16 v[152:155], a[208:211], a[160:163], v[152:155]
  s_waitcnt lgkmcnt(10)
  buffer_load_dwordx4 v2, s[24:27], s98 offen offset:0 sc1 lds
  v_mfma_f32_16x16x32_bf16 v[152:155], a[212:215], a[164:167], v[152:155]
  ds_read_b64_tr_b16 a[200:201], v43 offset:32768
  v_mfma_f32_16x16x32_bf16 v[184:187], a[212:215], a[172:175], v[184:187]
  ds_read_b64_tr_b16 a[202:203], v43 offset:33792
  v_mfma_f32_16x16x32_bf16 v[184:187], a[208:211], a[168:171], v[184:187]
  buffer_load_dwordx4 v2, s[24:27], s98 offen offset:1024 sc1 lds
  v_mfma_f32_16x16x32_bf16 v[216:219], a[208:211], a[176:179], v[216:219]
  ds_read_b64_tr_b16 a[204:205], v43 offset:40960
  v_mfma_f32_16x16x32_bf16 v[216:219], a[212:215], a[180:183], v[216:219]
  ds_read_b64_tr_b16 a[206:207], v43 offset:41984
  v_mfma_f32_16x16x32_bf16 v[248:251], a[212:215], a[188:191], v[248:251]
  buffer_load_dwordx4 v2, s[24:27], s98 offen offset:2048 sc1 lds
  v_mfma_f32_16x16x32_bf16 v[248:251], a[208:211], a[184:187], v[248:251]
  s_waitcnt lgkmcnt(10)
  v_mfma_f32_16x16x32_bf16 v[252:255], a[216:219], a[184:187], v[252:255]
  s_waitcnt lgkmcnt(8)
  ds_read_b64_tr_b16 a[208:209], v44 offset:32768
  v_mfma_f32_16x16x32_bf16 v[252:255], a[220:223], a[188:191], v[252:255]
  ds_read_b64_tr_b16 a[210:211], v44 offset:33792
  v_mfma_f32_16x16x32_bf16 v[220:223], a[220:223], a[180:183], v[220:223]
  ds_read_b64_tr_b16 a[212:213], v44 offset:40960
  v_mfma_f32_16x16x32_bf16 v[220:223], a[216:219], a[176:179], v[220:223]
  buffer_load_dwordx4 v2, s[24:27], s98 offen offset:3072 sc1 lds
  v_mfma_f32_16x16x32_bf16 v[188:191], a[216:219], a[168:171], v[188:191]
  s_mov_b32 s98, 0x4000
  ds_read_b64_tr_b16 a[214:215], v44 offset:41984
  v_mfma_f32_16x16x32_bf16 v[188:191], a[220:223], a[172:175], v[188:191]
  s_add_u32 m0, s97, 0x0
  v_mfma_f32_16x16x32_bf16 v[156:159], a[220:223], a[164:167], v[156:159]
  v_mfma_f32_16x16x32_bf16 v[156:159], a[216:219], a[160:163], v[156:159]
  s_waitcnt lgkmcnt(10)
  buffer_load_dwordx4 v2, s[24:27], s98 offen offset:0 sc1 lds
  v_mfma_f32_16x16x32_bf16 v[128:131], a[192:195], a[224:227], v[128:131]
  s_waitcnt lgkmcnt(8)
  s_mov_b32 s82, 26
  ds_read_b64_tr_b16 a[216:217], v45 offset:32768
  v_mfma_f32_16x16x32_bf16 v[128:131], a[196:199], a[228:231], v[128:131]
  s_mov_b32 s99, 0x14000
  ds_read_b64_tr_b16 a[218:219], v45 offset:33792
  v_mfma_f32_16x16x32_bf16 v[160:163], a[196:199], a[236:239], v[160:163]
  s_add_u32 s100, s97, 0x10000
  ds_read_b64_tr_b16 a[220:221], v45 offset:40960
  v_mfma_f32_16x16x32_bf16 v[160:163], a[192:195], a[232:235], v[160:163]
  s_add_u32 s101, s97, 0x8000
  ds_read_b64_tr_b16 a[222:223], v45 offset:41984
  v_mfma_f32_16x16x32_bf16 v[192:195], a[192:195], a[240:243], v[192:195]
  s_lshl_b32 s88, s29, 3
  buffer_load_dwordx4 v2, s[24:27], s98 offen offset:1024 sc1 lds
  v_mfma_f32_16x16x32_bf16 v[192:195], a[196:199], a[244:247], v[192:195]
  s_waitcnt vmcnt(14)
  s_add_u32 s88, s88, s30
  ds_read_b128 a[160:163], v36 offset:0
  v_mfma_f32_16x16x32_bf16 v[224:227], a[196:199], a[252:255], v[224:227]
  s_lshl_b32 s88, s88, 7
  ds_read_b128 a[164:167], v37 offset:0
  v_mfma_f32_16x16x32_bf16 v[224:227], a[192:195], a[248:251], v[224:227]
  s_waitcnt lgkmcnt(12)
  s_add_u32 s88, s88, 524288
  v_mfma_f32_16x16x32_bf16 v[228:231], a[200:203], a[248:251], v[228:231]
  s_waitcnt lgkmcnt(10)
  ds_read_b64_tr_b16 a[192:193], v46 offset:32768
  v_mfma_f32_16x16x32_bf16 v[228:231], a[204:207], a[252:255], v[228:231]
  buffer_load_dwordx4 v2, s[24:27], s98 offen offset:2048 sc1 lds
  v_mfma_f32_16x16x32_bf16 v[196:199], a[204:207], a[244:247], v[196:199]
  ds_read_b64_tr_b16 a[194:195], v46 offset:33792
  v_mfma_f32_16x16x32_bf16 v[196:199], a[200:203], a[240:243], v[196:199]
  ds_read_b64_tr_b16 a[196:197], v46 offset:40960
  v_mfma_f32_16x16x32_bf16 v[164:167], a[200:203], a[232:235], v[164:167]
  ds_read_b64_tr_b16 a[198:199], v46 offset:41984
  v_and_b32 v14, 15, v1
  v_mfma_f32_16x16x32_bf16 v[164:167], a[204:207], a[236:239], v[164:167]
  buffer_load_dwordx4 v2, s[24:27], s98 offen offset:3072 sc1 lds
  v_mfma_f32_16x16x32_bf16 v[132:135], a[204:207], a[228:231], v[132:135]
  ds_read_b128 a[168:171], v36 offset:2048
  v_lshrrev_b32 v15, 4, v1
  v_mfma_f32_16x16x32_bf16 v[132:135], a[200:203], a[224:227], v[132:135]
  s_waitcnt lgkmcnt(13)
  s_mov_b32 s3, 0x82000
  ds_read_b128 a[172:175], v37 offset:2048
  v_lshlrev_b32 v15, 2, v15
  v_mfma_f32_16x16x32_bf16 v[136:139], a[208:211], a[224:227], v[136:139]
  s_waitcnt lgkmcnt(12)
  ds_read_b64_tr_b16 a[200:201], v47 offset:32768
  v_sub_u32 v14, v14, v15
  v_mfma_f32_16x16x32_bf16 v[136:139], a[212:215], a[228:231], v[136:139]
  ds_read_b64_tr_b16 a[202:203], v47 offset:33792
  v_mfma_f32_16x16x32_bf16 v[168:171], a[212:215], a[236:239], v[168:171]
  buffer_store_dwordx4 v[112:115], v11, s[16:19], s3 offen offset:0 sc1
  v_mfma_f32_16x16x32_bf16 v[168:171], a[208:211], a[232:235], v[168:171]
  ds_read_b64_tr_b16 a[204:205], v47 offset:40960
  v_lshrrev_b32 v15, 6, v0
  v_mfma_f32_16x16x32_bf16 v[200:203], a[208:211], a[240:243], v[200:203]
  ds_read_b64_tr_b16 a[206:207], v47 offset:41984
  v_lshl_add_u32 v14, v15, 4, v14
  v_mfma_f32_16x16x32_bf16 v[200:203], a[212:215], a[244:247], v[200:203]
  ds_read_b128 a[176:179], v36 offset:4096
  v_mov_b32 v15, 0
  v_mfma_f32_16x16x32_bf16 v[232:235], a[212:215], a[252:255], v[232:235]
  ds_read_b128 a[180:183], v37 offset:4096
  v_cmp_le_i32 s[32:33], 0, v14
  v_mfma_f32_16x16x32_bf16 v[232:235], a[208:211], a[248:251], v[232:235]
  s_waitcnt lgkmcnt(15)
  v_mfma_f32_16x16x32_bf16 v[236:239], a[216:219], a[248:251], v[236:239]
  ds_read_b64_tr_b16 a[208:209], v48 offset:32768
  v_cmp_le_i32 s[34:35], 1, v14
  s_waitcnt lgkmcnt(15)
  v_mfma_f32_16x16x32_bf16 v[236:239], a[220:223], a[252:255], v[236:239]
  s_mov_b32 s3, 0x80000
  ds_read_b64_tr_b16 a[210:211], v48 offset:33792
  v_cmp_le_i32 s[36:37], 2, v14
  v_mfma_f32_16x16x32_bf16 v[204:207], a[220:223], a[244:247], v[204:207]
  buffer_store_dwordx4 v[68:71], v12, s[16:19], s3 offen offset:1024 sc1
  v_mfma_f32_16x16x32_bf16 v[204:207], a[216:219], a[240:243], v[204:207]
  ds_read_b64_tr_b16 a[212:213], v48 offset:40960
  v_cmp_le_i32 s[38:39], 3, v14
  v_mfma_f32_16x16x32_bf16 v[172:175], a[216:219], a[232:235], v[172:175]
  ds_read_b64_tr_b16 a[214:215], v48 offset:41984
  v_cmp_le_i32 s[40:41], 16, v14
  v_mfma_f32_16x16x32_bf16 v[172:175], a[220:223], a[236:239], v[172:175]
  ds_read_b128 a[184:187], v36 offset:6144
  v_mfma_f32_16x16x32_bf16 v[140:143], a[220:223], a[228:231], v[140:143]
  ds_read_b128 a[188:191], v37 offset:6144
  v_cmp_le_i32 s[42:43], 17, v14
  v_mfma_f32_16x16x32_bf16 v[140:143], a[216:219], a[224:227], v[140:143]
  s_waitcnt lgkmcnt(15)
  v_cmp_le_i32 s[44:45], 18, v14
  v_mfma_f32_16x16x32_bf16 v[144:147], a[192:195], a[224:227], v[144:147]
  ds_read_b64_tr_b16 a[216:217], v49 offset:32768
  s_waitcnt lgkmcnt(15)
  v_mfma_f32_16x16x32_bf16 v[144:147], a[196:199], a[228:231], v[144:147]
  ds_read_b64_tr_b16 a[218:219], v49 offset:33792
  v_cmp_le_i32 s[46:47], 19, v14
  v_mfma_f32_16x16x32_bf16 v[176:179], a[196:199], a[236:239], v[176:179]
  ds_read_b64_tr_b16 a[220:221], v49 offset:40960
  v_cmp_le_i32 s[48:49], 32, v14
  v_mfma_f32_16x16x32_bf16 v[176:179], a[192:195], a[232:235], v[176:179]
  ds_read_b64_tr_b16 a[222:223], v49 offset:41984
  v_mfma_f32_16x16x32_bf16 v[208:211], a[192:195], a[240:243], v[208:211]
  v_cmp_le_i32 s[50:51], 33, v14
  v_mfma_f32_16x16x32_bf16 v[208:211], a[196:199], a[244:247], v[208:211]
  v_cmp_le_i32 s[52:53], 34, v14
  v_mfma_f32_16x16x32_bf16 v[240:243], a[196:199], a[252:255], v[240:243]
  v_mfma_f32_16x16x32_bf16 v[240:243], a[192:195], a[248:251], v[240:243]
  s_waitcnt vmcnt(14) lgkmcnt(14)
  v_cmp_le_i32 s[54:55], 35, v14
  v_mfma_f32_16x16x32_bf16 v[244:247], a[200:203], a[248:251], v[244:247]
  s_barrier
  s_waitcnt lgkmcnt(12)
  v_mfma_f32_16x16x32_bf16 v[244:247], a[204:207], a[252:255], v[244:247]
  s_mov_b32 s98, 0x8000
  ds_read_b64_tr_b16 a[192:193], v42 offset:49152
  v_cmp_le_i32 s[56:57], 48, v14
  v_mfma_f32_16x16x32_bf16 v[212:215], a[204:207], a[244:247], v[212:215]
  s_add_u32 m0, s97, 0x14000
  ds_read_b64_tr_b16 a[194:195], v42 offset:50176
  v_cmp_le_i32 s[58:59], 49, v14
  v_mfma_f32_16x16x32_bf16 v[212:215], a[200:203], a[240:243], v[212:215]
  buffer_load_dwordx4 v2, s[24:27], s98 offen offset:0 sc1 lds
  v_mfma_f32_16x16x32_bf16 v[180:183], a[200:203], a[232:235], v[180:183]
  ds_read_b64_tr_b16 a[196:197], v42 offset:57344
  v_cmp_le_i32 s[60:61], 50, v14
  v_mfma_f32_16x16x32_bf16 v[180:183], a[204:207], a[236:239], v[180:183]
  ds_read_b64_tr_b16 a[198:199], v42 offset:58368
  v_cmp_le_i32 s[62:63], 51, v14
  v_mfma_f32_16x16x32_bf16 v[148:151], a[204:207], a[228:231], v[148:151]
  buffer_load_dwordx4 v2, s[24:27], s98 offen offset:1024 sc1 lds
  v_mfma_f32_16x16x32_bf16 v[148:151], a[200:203], a[224:227], v[148:151]
  s_waitcnt lgkmcnt(12)
  s_cmp_eq_u32 s30, 0
  s_cselect_b64 s[0:1], s[32:33], -1
  v_mfma_f32_16x16x32_bf16 v[152:155], a[208:211], a[224:227], v[152:155]
  s_waitcnt lgkmcnt(10)
  ds_read_b64_tr_b16 a[200:201], v43 offset:49152
  v_mfma_f32_16x16x32_bf16 v[152:155], a[212:215], a[228:231], v[152:155]
  ds_read_b64_tr_b16 a[202:203], v43 offset:50176
  v_mfma_f32_16x16x32_bf16 v[184:187], a[212:215], a[236:239], v[184:187]
  buffer_load_dwordx4 v2, s[24:27], s98 offen offset:2048 sc1 lds
  v_mfma_f32_16x16x32_bf16 v[184:187], a[208:211], a[232:235], v[184:187]
  ds_read_b64_tr_b16 a[204:205], v43 offset:57344
  v_cndmask_b32 v24, v13, v15, s[0:1]
  v_mfma_f32_16x16x32_bf16 v[216:219], a[208:211], a[240:243], v[216:219]
  ds_read_b64_tr_b16 a[206:207], v43 offset:58368
  v_mfma_f32_16x16x32_bf16 v[216:219], a[212:215], a[244:247], v[216:219]
  s_cmp_eq_u32 s30, 0
  s_cselect_b64 s[0:1], s[34:35], -1
  v_mfma_f32_16x16x32_bf16 v[248:251], a[212:215], a[252:255], v[248:251]
  v_cndmask_b32 v25, v13, v15, s[0:1]
  v_mfma_f32_16x16x32_bf16 v[248:251], a[208:211], a[248:251], v[248:251]
  s_waitcnt lgkmcnt(10)
  buffer_load_dwordx4 v2, s[24:27], s98 offen offset:3072 sc1 lds
  v_mfma_f32_16x16x32_bf16 v[252:255], a[216:219], a[248:251], v[252:255]
  s_waitcnt lgkmcnt(8)
  s_mov_b32 s3, 0x81000
  ds_read_b64_tr_b16 a[208:209], v44 offset:49152
  v_mfma_f32_16x16x32_bf16 v[252:255], a[220:223], a[252:255], v[252:255]
  s_cmp_eq_u32 s30, 0
  s_cselect_b64 s[0:1], s[36:37], -1
  ds_read_b64_tr_b16 a[210:211], v44 offset:50176
  v_mfma_f32_16x16x32_bf16 v[220:223], a[220:223], a[244:247], v[220:223]
  ds_read_b64_tr_b16 a[212:213], v44 offset:57344
  v_cndmask_b32 v26, v13, v15, s[0:1]
  v_mfma_f32_16x16x32_bf16 v[220:223], a[216:219], a[240:243], v[220:223]
  buffer_store_dwordx4 v[84:87], v12, s[16:19], s3 offen offset:1024 sc1
  v_mfma_f32_16x16x32_bf16 v[188:191], a[216:219], a[232:235], v[188:191]
  s_cmp_eq_u32 s30, 0
  s_cselect_b64 s[0:1], s[38:39], -1
  ds_read_b64_tr_b16 a[214:215], v44 offset:58368
  v_mfma_f32_16x16x32_bf16 v[188:191], a[220:223], a[236:239], v[188:191]
  v_cndmask_b32 v27, v13, v15, s[0:1]
  v_mfma_f32_16x16x32_bf16 v[156:159], a[220:223], a[228:231], v[156:159]
  v_mfma_f32_16x16x32_bf16 v[156:159], a[216:219], a[224:227], v[156:159]
  s_waitcnt lgkmcnt(10)
  v_mfma_f32_16x16x32_bf16 v[128:131], a[192:195], a[160:163], v[128:131]
  s_waitcnt lgkmcnt(8)
  ds_read_b64_tr_b16 a[216:217], v45 offset:49152
  v_mfma_f32_16x16x32_bf16 v[128:131], a[196:199], a[164:167], v[128:131]
  ds_read_b64_tr_b16 a[218:219], v45 offset:50176
  v_mfma_f32_16x16x32_bf16 v[160:163], a[196:199], a[172:175], v[160:163]
  ds_read_b64_tr_b16 a[220:221], v45 offset:57344
  v_mfma_f32_16x16x32_bf16 v[160:163], a[192:195], a[168:171], v[160:163]
  ds_read_b64_tr_b16 a[222:223], v45 offset:58368
  v_mfma_f32_16x16x32_bf16 v[192:195], a[192:195], a[176:179], v[192:195]
  v_mfma_f32_16x16x32_bf16 v[192:195], a[196:199], a[180:183], v[192:195]
  v_mfma_f32_16x16x32_bf16 v[224:227], a[196:199], a[188:191], v[224:227]
  v_mul_f32 v128, s83, v128
  v_mul_f32 v129, s83, v129
  v_mfma_f32_16x16x32_bf16 v[224:227], a[192:195], a[184:187], v[224:227]
  s_waitcnt lgkmcnt(10)
  v_mul_f32 v130, s83, v130
  v_mul_f32 v131, s83, v131
  v_mfma_f32_16x16x32_bf16 v[228:231], a[200:203], a[184:187], v[228:231]
  s_waitcnt lgkmcnt(8)
  s_mov_b32 s3, 0x80000
  ds_read_b64_tr_b16 a[192:193], v46 offset:49152
  v_mul_f32 v160, s83, v160
  v_mfma_f32_16x16x32_bf16 v[228:231], a[204:207], a[188:191], v[228:231]
  buffer_store_dwordx4 v[100:103], v11, s[16:19], s3 offen offset:1024 sc1
  v_mfma_f32_16x16x32_bf16 v[196:199], a[204:207], a[180:183], v[196:199]
  ds_read_b64_tr_b16 a[194:195], v46 offset:50176
  v_mul_f32 v161, s83, v161
  v_mfma_f32_16x16x32_bf16 v[196:199], a[200:203], a[176:179], v[196:199]
  ds_read_b64_tr_b16 a[196:197], v46 offset:57344
  v_mul_f32 v162, s83, v162
  v_mfma_f32_16x16x32_bf16 v[164:167], a[200:203], a[168:171], v[164:167]
  ds_read_b64_tr_b16 a[198:199], v46 offset:58368
  v_mul_f32 v163, s83, v163
  v_mfma_f32_16x16x32_bf16 v[164:167], a[204:207], a[172:175], v[164:167]
  v_mul_f32 v192, s83, v192
  v_mul_f32 v193, s83, v193
  v_mfma_f32_16x16x32_bf16 v[132:135], a[204:207], a[164:167], v[132:135]
  v_mul_f32 v194, s83, v194
  v_mul_f32 v195, s83, v195
  v_mfma_f32_16x16x32_bf16 v[132:135], a[200:203], a[160:163], v[132:135]
  s_waitcnt lgkmcnt(10)
  v_mul_f32 v224, s83, v224
  v_mul_f32 v225, s83, v225
  v_mfma_f32_16x16x32_bf16 v[136:139], a[208:211], a[160:163], v[136:139]
  s_waitcnt lgkmcnt(8)
  ds_read_b64_tr_b16 a[200:201], v47 offset:49152
  v_mul_f32 v196, s83, v196
  v_mfma_f32_16x16x32_bf16 v[136:139], a[212:215], a[164:167], v[136:139]
  ds_read_b64_tr_b16 a[202:203], v47 offset:50176
  v_mul_f32 v197, s83, v197
  v_mfma_f32_16x16x32_bf16 v[168:171], a[212:215], a[172:175], v[168:171]
  ds_read_b64_tr_b16 a[204:205], v47 offset:57344
  v_mul_f32 v164, s83, v164
  v_mfma_f32_16x16x32_bf16 v[168:171], a[208:211], a[168:171], v[168:171]
  ds_read_b64_tr_b16 a[206:207], v47 offset:58368
  v_mul_f32 v165, s83, v165
  v_mfma_f32_16x16x32_bf16 v[200:203], a[208:211], a[176:179], v[200:203]
  v_mul_f32 v132, s83, v132
  v_mul_f32 v133, s83, v133
  v_mfma_f32_16x16x32_bf16 v[200:203], a[212:215], a[180:183], v[200:203]
L_pad9:
  s_cbranch_execz L_pad13
  v_mul_f32 v134, s83, v134
  v_mul_f32 v135, s83, v135
  v_mfma_f32_16x16x32_bf16 v[232:235], a[212:215], a[188:191], v[232:235]
  v_mul_f32 v166, s83, v166
  v_mul_f32 v167, s83, v167
  v_mfma_f32_16x16x32_bf16 v[232:235], a[208:211], a[184:187], v[232:235]
  s_waitcnt lgkmcnt(10)
  v_mul_f32 v198, s83, v198
  v_mul_f32 v199, s83, v199
  v_mfma_f32_16x16x32_bf16 v[236:239], a[216:219], a[184:187], v[236:239]
  s_waitcnt lgkmcnt(8)
  ds_read_b64_tr_b16 a[208:209], v48 offset:49152
  v_mul_f32 v226, s83, v226
  v_mfma_f32_16x16x32_bf16 v[236:239], a[220:223], a[188:191], v[236:239]
  ds_read_b64_tr_b16 a[210:211], v48 offset:50176
  v_mul_f32 v227, s83, v227
  v_mfma_f32_16x16x32_bf16 v[204:207], a[220:223], a[180:183], v[204:207]
  ds_read_b64_tr_b16 a[212:213], v48 offset:57344
  v_mul_f32 v228, s83, v228
  v_mfma_f32_16x16x32_bf16 v[204:207], a[216:219], a[176:179], v[204:207]
  ds_read_b64_tr_b16 a[214:215], v48 offset:58368
  v_mul_f32 v229, s83, v229
  v_mfma_f32_16x16x32_bf16 v[172:175], a[216:219], a[168:171], v[172:175]
  v_mul_f32 v230, s83, v230
  v_mul_f32 v231, s83, v231
  v_mfma_f32_16x16x32_bf16 v[172:175], a[220:223], a[172:175], v[172:175]
  v_mfma_f32_16x16x32_bf16 v[140:143], a[220:223], a[164:167], v[140:143]
  v_mfma_f32_16x16x32_bf16 v[140:143], a[216:219], a[160:163], v[140:143]
  s_waitcnt lgkmcnt(10)
  v_mfma_f32_16x16x32_bf16 v[144:147], a[192:195], a[160:163], v[144:147]
  s_waitcnt lgkmcnt(8)
  s_mov_b32 s3, 0x82000
  ds_read_b64_tr_b16 a[216:217], v49 offset:49152
  v_mfma_f32_16x16x32_bf16 v[144:147], a[196:199], a[164:167], v[144:147]
  buffer_store_dwordx4 v[116:119], v11, s[16:19], s3 offen offset:1024 sc1
  v_mfma_f32_16x16x32_bf16 v[176:179], a[196:199], a[172:175], v[176:179]
  ds_read_b64_tr_b16 a[218:219], v49 offset:50176
  v_mfma_f32_16x16x32_bf16 v[176:179], a[192:195], a[168:171], v[176:179]
  ds_read_b64_tr_b16 a[220:221], v49 offset:57344
  v_mfma_f32_16x16x32_bf16 v[208:211], a[192:195], a[176:179], v[208:211]
  ds_read_b64_tr_b16 a[222:223], v49 offset:58368
  v_mfma_f32_16x16x32_bf16 v[208:211], a[196:199], a[180:183], v[208:211]
  v_mfma_f32_16x16x32_bf16 v[240:243], a[196:199], a[188:191], v[240:243]
  v_mul_f32 v144, s83, v144
  v_mul_f32 v145, s83, v145
  v_mfma_f32_16x16x32_bf16 v[240:243], a[192:195], a[184:187], v[240:243]
  s_waitcnt vmcnt(13) lgkmcnt(10)
  v_mul_f32 v146, s83, v146
  v_mul_f32 v147, s83, v147
  v_mfma_f32_16x16x32_bf16 v[244:247], a[200:203], a[184:187], v[244:247]
  s_barrier
  s_waitcnt lgkmcnt(8)
  v_mfma_f32_16x16x32_bf16 v[244:247], a[204:207], a[188:191], v[244:247]
  s_mov_b32 s98, 0x10000
  ds_read_b128 a[224:227], v4 offset:0
  v_mul_f32 v176, s83, v176
  v_mfma_f32_16x16x32_bf16 v[212:215], a[204:207], a[180:183], v[212:215]
  s_add_u32 m0, s97, 0x18000
  ds_read_b128 a[228:231], v4 offset:1024
  v_mul_f32 v177, s83, v177
  v_mfma_f32_16x16x32_bf16 v[212:215], a[200:203], a[176:179], v[212:215]
  buffer_load_dwordx4 v2, s[24:27], s98 offen offset:0 sc1 lds
  v_mfma_f32_16x16x32_bf16 v[180:183], a[200:203], a[168:171], v[180:183]
  ds_read_b128 a[232:235], v4 offset:2048
  v_mul_f32 v178, s83, v178
  v_mfma_f32_16x16x32_bf16 v[180:183], a[204:207], a[172:175], v[180:183]
  ds_read_b128 a[236:239], v4 offset:3072
  v_mul_f32 v179, s83, v179
  v_mfma_f32_16x16x32_bf16 v[148:151], a[204:207], a[164:167], v[148:151]
  buffer_load_dwordx4 v2, s[24:27], s98 offen offset:1024 sc1 lds
  v_mfma_f32_16x16x32_bf16 v[148:151], a[200:203], a[160:163], v[148:151]
  s_waitcnt lgkmcnt(10)
  v_mul_f32 v208, s83, v208
  v_mul_f32 v209, s83, v209
  v_mfma_f32_16x16x32_bf16 v[152:155], a[208:211], a[160:163], v[152:155]
  s_waitcnt lgkmcnt(8)
  v_mul_f32 v210, s83, v210
  v_mul_f32 v211, s83, v211
  v_mfma_f32_16x16x32_bf16 v[152:155], a[212:215], a[164:167], v[152:155]
  buffer_load_dwordx4 v2, s[24:27], s98 offen offset:2048 sc1 lds
  v_mfma_f32_16x16x32_bf16 v[184:187], a[212:215], a[172:175], v[184:187]
  v_mul_f32 v180, s83, v180
  v_mul_f32 v181, s83, v181
  v_mfma_f32_16x16x32_bf16 v[184:187], a[208:211], a[168:171], v[184:187]
  v_mul_f32 v182, s83, v182
  v_mul_f32 v183, s83, v183
  v_mfma_f32_16x16x32_bf16 v[216:219], a[208:211], a[176:179], v[216:219]
  buffer_load_dwordx4 v2, s[24:27], s98 offen offset:3072 sc1 lds
  v_mfma_f32_16x16x32_bf16 v[216:219], a[212:215], a[180:183], v[216:219]
  s_mov_b32 s98, 0xc000
  v_mul_f32 v148, s83, v148
  v_mul_f32 v149, s83, v149
  v_mfma_f32_16x16x32_bf16 v[248:251], a[212:215], a[188:191], v[248:251]
  s_add_u32 m0, s97, 0x4000
  v_mul_f32 v150, s83, v150
  v_mul_f32 v151, s83, v151
  v_mfma_f32_16x16x32_bf16 v[248:251], a[208:211], a[184:187], v[248:251]
  s_waitcnt lgkmcnt(6)
  buffer_load_dwordx4 v2, s[24:27], s98 offen offset:0 sc1 lds
  v_mfma_f32_16x16x32_bf16 v[252:255], a[216:219], a[184:187], v[252:255]
  s_waitcnt lgkmcnt(4)
  v_mul_f32 v212, s83, v212
  v_mul_f32 v213, s83, v213
  v_mfma_f32_16x16x32_bf16 v[252:255], a[220:223], a[188:191], v[252:255]
  v_mul_f32 v214, s83, v214
  v_mul_f32 v215, s83, v215
  v_mfma_f32_16x16x32_bf16 v[220:223], a[220:223], a[180:183], v[220:223]
  buffer_load_dwordx4 v2, s[24:27], s98 offen offset:1024 sc1 lds
  v_mfma_f32_16x16x32_bf16 v[220:223], a[216:219], a[176:179], v[220:223]
  v_mul_f32 v240, s83, v240
  v_mul_f32 v241, s83, v241
  v_mfma_f32_16x16x32_bf16 v[188:191], a[216:219], a[168:171], v[188:191]
  v_mul_f32 v242, s83, v242
  v_mul_f32 v243, s83, v243
  v_mfma_f32_16x16x32_bf16 v[188:191], a[220:223], a[172:175], v[188:191]
  buffer_load_dwordx4 v2, s[24:27], s98 offen offset:2048 sc1 lds
  v_mfma_f32_16x16x32_bf16 v[156:159], a[220:223], a[164:167], v[156:159]
  v_mul_f32 v244, s83, v244
  v_mul_f32 v245, s83, v245
  v_mfma_f32_16x16x32_bf16 v[156:159], a[216:219], a[160:163], v[156:159]
  v_mul_f32 v246, s83, v246
  v_mul_f32 v247, s83, v247
  buffer_load_dwordx4 v2, s[24:27], s98 offen offset:3072 sc1 lds
L_attn:
  ds_read_b128 a[176:179], v4 offset:4096
  ds_read_b128 a[180:183], v4 offset:5120
  ds_read_b128 a[184:187], v4 offset:6144
  ds_read_b128 a[188:191], v4 offset:7168
  ds_read_b128 a[192:195], v4 offset:8192
  ds_read_b128 a[196:199], v4 offset:9216
  ds_read_b128 a[200:203], v4 offset:10240
  ds_read_b128 a[204:207], v4 offset:11264
  ds_read_b128 a[208:211], v4 offset:12288
  ds_read_b128 a[212:215], v4 offset:13312
  ds_read_b128 a[216:219], v4 offset:14336
  ds_read_b128 a[220:223], v4 offset:15360
  s_mov_b32 s3, 0x80000
  buffer_store_dwordx4 v[72:75], v12, s[16:19], s3 offen offset:2048 sc1
  v_cvt_pk_bf16_f32 v128, v128, v129
  s_mov_b32 s3, 0x81000
  v_cvt_pk_bf16_f32 v129, v130, v131
  v_cvt_pk_bf16_f32 v130, v132, v133
  v_cvt_pk_bf16_f32 v131, v134, v135
  v_cvt_pk_bf16_f32 v132, v136, v137
  v_cvt_pk_bf16_f32 v133, v138, v139
  s_waitcnt lgkmcnt(15)
  v_mfma_f32_16x16x32_bf16 v[64:67], a[224:227], v[128:131], v[24:27]
  s_cmp_eq_u32 s30, 0
  v_cvt_pk_bf16_f32 v134, v140, v141
  v_cvt_pk_bf16_f32 v135, v142, v143
  v_cvt_pk_bf16_f32 v136, v144, v145
  v_cvt_pk_bf16_f32 v137, v146, v147
  s_waitcnt lgkmcnt(14)
  v_mfma_f32_16x16x32_bf16 v[64:67], a[228:231], v[132:135], v[64:67]
  s_cselect_b64 s[0:1], s[40:41], -1
  v_cvt_pk_bf16_f32 v138, v148, v149
  v_cvt_pk_bf16_f32 v139, v150, v151
  v_cvt_pk_bf16_f32 v140, v152, v153
  v_cvt_pk_bf16_f32 v141, v154, v155
  s_waitcnt lgkmcnt(13)
  v_mfma_f32_16x16x32_bf16 v[64:67], a[232:235], v[136:139], v[64:67]
  s_cmp_eq_u32 s30, 0
  v_cvt_pk_bf16_f32 v142, v156, v157
  v_cvt_pk_bf16_f32 v143, v158, v159
  v_cvt_pk_bf16_f32 v144, v160, v161
  v_cvt_pk_bf16_f32 v145, v162, v163
  s_waitcnt lgkmcnt(12)
  v_mfma_f32_16x16x32_bf16 v[64:67], a[236:239], v[140:143], v[64:67]
  s_cselect_b64 s[66:67], s[42:43], -1
  v_cvt_pk_bf16_f32 v146, v164, v165
  v_cvt_pk_bf16_f32 v147, v166, v167
  v_cvt_pk_bf16_f32 v148, v168, v169
  v_cvt_pk_bf16_f32 v149, v170, v171
  v_mfma_f32_16x16x32_bf16 v[80:83], a[224:227], v[144:147], 0
  s_cmp_eq_u32 s30, 0
  v_cvt_pk_bf16_f32 v150, v172, v173
  v_cvt_pk_bf16_f32 v151, v174, v175
  v_cvt_pk_bf16_f32 v152, v176, v177
  v_cvt_pk_bf16_f32 v153, v178, v179
  v_mfma_f32_16x16x32_bf16 v[80:83], a[228:231], v[148:151], v[80:83]
  buffer_store_dwordx4 v[88:91], v12, s[16:19], s3 offen offset:2048 sc1
  v_cvt_pk_bf16_f32 v154, v180, v181
  s_mov_b32 s3, 0x81000
  v_cvt_pk_bf16_f32 v155, v182, v183
  v_cvt_pk_bf16_f32 v156, v184, v185
  v_cvt_pk_bf16_f32 v157, v186, v187
  v_mfma_f32_16x16x32_bf16 v[80:83], a[232:235], v[152:155], v[80:83]
  s_mov_b32 s98, 0x18000
  v_cvt_pk_bf16_f32 v158, v188, v189
  v_cvt_pk_bf16_f32 v159, v190, v191
  v_cvt_pk_bf16_f32 v160, v192, v193
  v_cvt_pk_bf16_f32 v161, v194, v195
  v_mfma_f32_16x16x32_bf16 v[80:83], a[236:239], v[156:159], v[80:83]
  v_cvt_pk_bf16_f32 v162, v196, v197
  v_cvt_pk_bf16_f32 v163, v198, v199
  v_cvt_pk_bf16_f32 v164, v200, v201
  v_cvt_pk_bf16_f32 v165, v202, v203
  v_mfma_f32_16x16x32_bf16 v[96:99], a[224:227], v[160:163], 0
  v_cvt_pk_bf16_f32 v166, v204, v205
  v_cvt_pk_bf16_f32 v167, v206, v207
  v_cvt_pk_bf16_f32 v168, v208, v209
  v_cvt_pk_bf16_f32 v169, v210, v211
  v_mfma_f32_16x16x32_bf16 v[96:99], a[228:231], v[164:167], v[96:99]
  v_cvt_pk_bf16_f32 v170, v212, v213
  v_cvt_pk_bf16_f32 v171, v214, v215
  v_cvt_pk_bf16_f32 v172, v216, v217
  v_cvt_pk_bf16_f32 v173, v218, v219
  v_mfma_f32_16x16x32_bf16 v[96:99], a[232:235], v[168:171], v[96:99]
  v_cvt_pk_bf16_f32 v174, v220, v221
  v_cvt_pk_bf16_f32 v175, v222, v223
  v_cvt_pk_bf16_f32 v176, v224, v225
  v_cvt_pk_bf16_f32 v177, v226, v227
  v_mfma_f32_16x16x32_bf16 v[96:99], a[236:239], v[172:175], v[96:99]
  v_cvt_pk_bf16_f32 v178, v228, v229
  buffer_store_dwordx4 v[104:107], v11, s[16:19], s3 offen offset:0 sc1
  v_cvt_pk_bf16_f32 v179, v230, v231
  s_mov_b32 s3, 0x83000
  v_cvt_pk_bf16_f32 v180, v232, v233
  v_mfma_f32_16x16x32_bf16 v[112:115], a[224:227], v[176:179], 0
  v_cvt_pk_bf16_f32 v181, v234, v235
  v_cvt_pk_bf16_f32 v182, v236, v237
  v_cvt_pk_bf16_f32 v183, v238, v239
  v_cvt_pk_bf16_f32 v184, v240, v241
  v_cvt_pk_bf16_f32 v185, v242, v243
  v_mfma_f32_16x16x32_bf16 v[112:115], a[228:231], v[180:183], v[112:115]
  v_cvt_pk_bf16_f32 v186, v244, v245
  v_cvt_pk_bf16_f32 v187, v246, v247
  v_cvt_pk_bf16_f32 v188, v248, v249
  v_cvt_pk_bf16_f32 v189, v250, v251
  v_mfma_f32_16x16x32_bf16 v[112:115], a[232:235], v[184:187], v[112:115]
  v_cvt_pk_bf16_f32 v190, v252, v253
  v_cvt_pk_bf16_f32 v191, v254, v255
  v_max3_f32 v14, v64, v65, v66
  v_max_f32 v14, v14, v67
  v_mfma_f32_16x16x32_bf16 v[112:115], a[236:239], v[188:191], v[112:115]
  v_mov_b32 v18, v14
  v_max3_f32 v15, v80, v81, v82
  v_max_f32 v15, v15, v83
  v_permlane32_swap_b32 v18, v14
  v_max_f32 v14, v14, v18
  v_mov_b32 v18, v14
  v_mov_b32 v19, v15
  v_max3_f32 v16, v96, v97, v98
  v_permlane16_swap_b32 v18, v14
  v_max_f32 v14, v14, v18
  v_sub_f32 v18, 0, v14
  v_mov_b32 v24, v18
  v_mov_b32 v25, v18
  v_mov_b32 v26, v18
  buffer_store_dwordx4 v[120:123], v11, s[16:19], s3 offen offset:0 sc1
  v_mov_b32 v27, v18
  s_mov_b32 s3, 0x80000
  v_cndmask_b32 v28, v13, v18, s[0:1]
  v_cndmask_b32 v29, v13, v18, s[66:67]
  s_cselect_b64 s[0:1], s[44:45], -1
  v_cndmask_b32 v30, v13, v18, s[0:1]
  s_cmp_eq_u32 s30, 0
  s_cselect_b64 s[66:67], s[46:47], -1
  v_cndmask_b32 v31, v13, v18, s[66:67]
  s_cmp_eq_u32 s30, 0
  s_cselect_b64 s[0:1], s[48:49], -1
  s_waitcnt lgkmcnt(11)
  v_mfma_f32_16x16x32_bf16 v[68:71], a[176:179], v[128:131], v[28:31]
  s_waitcnt lgkmcnt(10)
  s_cmp_eq_u32 s30, 0
  v_cndmask_b32 v32, v13, v18, s[0:1]
  s_cselect_b64 s[66:67], s[50:51], -1
  v_mfma_f32_16x16x32_bf16 v[68:71], a[180:183], v[132:135], v[68:71]
  s_waitcnt lgkmcnt(9)
  s_cmp_eq_u32 s30, 0
  v_cndmask_b32 v33, v13, v18, s[66:67]
  s_cselect_b64 s[0:1], s[52:53], -1
  v_mfma_f32_16x16x32_bf16 v[68:71], a[184:187], v[136:139], v[68:71]
  s_waitcnt lgkmcnt(8)
  s_cmp_eq_u32 s30, 0
  v_cndmask_b32 v34, v13, v18, s[0:1]
  s_cselect_b64 s[66:67], s[54:55], -1
  v_mfma_f32_16x16x32_bf16 v[68:71], a[188:191], v[140:143], v[68:71]
  s_cmp_eq_u32 s30, 0
  v_cndmask_b32 v35, v13, v18, s[66:67]
  s_cselect_b64 s[0:1], s[56:57], -1
  v_cndmask_b32 v36, v13, v18, s[0:1]
  s_waitcnt lgkmcnt(7)
  v_mfma_f32_16x16x32_bf16 v[72:75], a[192:195], v[128:131], v[32:35]
  s_waitcnt lgkmcnt(6)
  s_cmp_eq_u32 s30, 0
  s_cselect_b64 s[66:67], s[58:59], -1
  v_cndmask_b32 v37, v13, v18, s[66:67]
  v_mfma_f32_16x16x32_bf16 v[72:75], a[196:199], v[132:135], v[72:75]
  s_waitcnt lgkmcnt(5)
  s_cmp_eq_u32 s30, 0
  s_cselect_b64 s[0:1], s[60:61], -1
  v_cndmask_b32 v38, v13, v18, s[0:1]
  v_mfma_f32_16x16x32_bf16 v[72:75], a[200:203], v[136:139], v[72:75]
  s_waitcnt lgkmcnt(4)
  buffer_store_dwordx4 v[76:79], v12, s[16:19], s3 offen offset:3072 sc1
  v_mfma_f32_16x16x32_bf16 v[72:75], a[204:207], v[140:143], v[72:75]
  s_mov_b32 s3, 0x81000
  s_cmp_eq_u32 s30, 0
  s_cselect_b64 s[66:67], s[62:63], -1
  v_cndmask_b32 v39, v13, v18, s[66:67]
  v_permlane32_swap_b32 v19, v15
  v_max_f32 v15, v15, v19
  s_waitcnt lgkmcnt(3)
  v_mfma_f32_16x16x32_bf16 v[76:79], a[208:211], v[128:131], v[36:39]
  s_waitcnt lgkmcnt(2)
  s_add_u32 m0, s97, 0x1c000
  v_mov_b32 v19, v15
  v_max_f32 v16, v16, v99
  v_mfma_f32_16x16x32_bf16 v[76:79], a[212:215], v[132:135], v[76:79]
  s_waitcnt lgkmcnt(1)
  v_permlane16_swap_b32 v19, v15
  v_max_f32 v15, v15, v19
  v_mfma_f32_16x16x32_bf16 v[76:79], a[216:219], v[136:139], v[76:79]
  s_waitcnt lgkmcnt(0)
  v_sub_f32 v56, 0, v15
  v_sub_f32 v57, 0, v15
  v_mfma_f32_16x16x32_bf16 v[76:79], a[220:223], v[140:143], v[76:79]
  v_sub_f32 v58, 0, v15
  v_sub_f32 v59, 0, v15
  v_mov_b32 v20, v16
  v_max3_f32 v17, v112, v113, v114
  v_mfma_f32_16x16x32_bf16 v[84:87], a[176:179], v[144:147], v[56:59]
  v_permlane32_swap_b32 v20, v16
  v_max_f32 v16, v16, v20
  v_mfma_f32_16x16x32_bf16 v[84:87], a[180:183], v[148:151], v[84:87]
  v_mov_b32 v20, v16
  v_max_f32 v17, v17, v115
  v_mfma_f32_16x16x32_bf16 v[84:87], a[184:187], v[152:155], v[84:87]
  v_permlane16_swap_b32 v20, v16
  v_max_f32 v16, v16, v20
  v_mfma_f32_16x16x32_bf16 v[84:87], a[188:191], v[156:159], v[84:87]
  buffer_store_dwordx4 v[92:95], v12, s[16:19], s3 offen offset:3072 sc1
  v_mfma_f32_16x16x32_bf16 v[88:91], a[192:195], v[144:147], v[56:59]
  s_mov_b32 s3, 0x81000
  v_sub_f32 v40, 0, v16
  v_sub_f32 v41, 0, v16
  v_mfma_f32_16x16x32_bf16 v[88:91], a[196:199], v[148:151], v[88:91]
  v_sub_f32 v42, 0, v16
  v_sub_f32 v43, 0, v16
  v_mfma_f32_16x16x32_bf16 v[88:91], a[200:203], v[152:155], v[88:91]
  v_sub_f32 v44, 0, v16
  v_sub_f32 v45, 0, v16
  v_mfma_f32_16x16x32_bf16 v[88:91], a[204:207], v[156:159], v[88:91]
  v_sub_f32 v46, 0, v16
  v_sub_f32 v47, 0, v16
  v_mfma_f32_16x16x32_bf16 v[92:95], a[208:211], v[144:147], v[56:59]
  v_sub_f32 v48, 0, v16
  v_sub_f32 v49, 0, v16
  v_mfma_f32_16x16x32_bf16 v[92:95], a[212:215], v[148:151], v[92:95]
  v_sub_f32 v50, 0, v16
  v_sub_f32 v51, 0, v16
  v_mfma_f32_16x16x32_bf16 v[92:95], a[216:219], v[152:155], v[92:95]
  v_sub_f32 v52, 0, v16
  v_sub_f32 v53, 0, v16
  v_mfma_f32_16x16x32_bf16 v[92:95], a[220:223], v[156:159], v[92:95]
  v_sub_f32 v54, 0, v16
  v_sub_f32 v55, 0, v16
  v_mfma_f32_16x16x32_bf16 v[100:103], a[176:179], v[160:163], v[44:47]
  v_mov_b32 v21, v17
  v_sub_f32 v64, v64, v14
  v_mfma_f32_16x16x32_bf16 v[100:103], a[180:183], v[164:167], v[100:103]
  buffer_store_dwordx4 v[108:111], v11, s[16:19], s3 offen offset:1024 sc1
  v_mfma_f32_16x16x32_bf16 v[100:103], a[184:187], v[168:171], v[100:103]
  s_mov_b32 s3, 0x83000
  v_permlane32_swap_b32 v21, v17
  v_max_f32 v17, v17, v21
  v_mfma_f32_16x16x32_bf16 v[100:103], a[188:191], v[172:175], v[100:103]
  v_mov_b32 v21, v17
  v_sub_f32 v65, v65, v14
  v_mfma_f32_16x16x32_bf16 v[104:107], a[192:195], v[160:163], v[48:51]
  v_permlane16_swap_b32 v21, v17
  v_max_f32 v17, v17, v21
  v_mfma_f32_16x16x32_bf16 v[104:107], a[196:199], v[164:167], v[104:107]
  v_sub_f32 v60, 0, v17
  v_sub_f32 v61, 0, v17
  v_mfma_f32_16x16x32_bf16 v[104:107], a[200:203], v[168:171], v[104:107]
  v_sub_f32 v62, 0, v17
  v_sub_f32 v63, 0, v17
  v_mfma_f32_16x16x32_bf16 v[104:107], a[204:207], v[172:175], v[104:107]
  v_sub_f32 v66, v66, v14
  v_sub_f32 v67, v67, v14
  v_mfma_f32_16x16x32_bf16 v[108:111], a[208:211], v[160:163], v[52:55]
  v_exp_f32 v64, v64
  v_mfma_f32_16x16x32_bf16 v[108:111], a[212:215], v[164:167], v[108:111]
  v_exp_f32 v65, v65
  v_mfma_f32_16x16x32_bf16 v[108:111], a[216:219], v[168:171], v[108:111]
  v_exp_f32 v66, v66
  v_mfma_f32_16x16x32_bf16 v[108:111], a[220:223], v[172:175], v[108:111]
  buffer_store_dwordx4 v[124:127], v11, s[16:19], s3 offen offset:1024 sc1
  v_mfma_f32_16x16x32_bf16 v[116:119], a[176:179], v[176:179], v[60:63]
  s_waitcnt vmcnt(19) lgkmcnt(0)
  s_barrier
  ds_read_b128 a[160:163], v4 offset:16384
  v_mfma_f32_16x16x32_bf16 v[116:119], a[180:183], v[180:183], v[116:119]
  ds_read_b128 a[164:167], v4 offset:17408
  ds_read_b128 a[168:171], v4 offset:18432
  v_mfma_f32_16x16x32_bf16 v[116:119], a[184:187], v[184:187], v[116:119]
  ds_read_b128 a[172:175], v4 offset:19456
  v_exp_f32 v67, v67
  v_mfma_f32_16x16x32_bf16 v[116:119], a[188:191], v[188:191], v[116:119]
  ds_read_b128 a[176:179], v4 offset:20480
  v_cvt_pk_bf16_f32 v192, v64, v65
  v_mfma_f32_16x16x32_bf16 v[120:123], a[192:195], v[176:179], v[60:63]
  ds_read_b128 a[180:183], v4 offset:21504
  v_cvt_pk_bf16_f32 v193, v66, v67
  v_mfma_f32_16x16x32_bf16 v[120:123], a[196:199], v[180:183], v[120:123]
  ds_read_b128 a[184:187], v4 offset:22528
  v_exp_f32 v68, v68
  v_mfma_f32_16x16x32_bf16 v[120:123], a[200:203], v[184:187], v[120:123]
  ds_read_b128 a[188:191], v4 offset:23552
  v_exp_f32 v69, v69
  v_mfma_f32_16x16x32_bf16 v[120:123], a[204:207], v[188:191], v[120:123]
  v_exp_f32 v70, v70
  v_mfma_f32_16x16x32_bf16 v[124:127], a[208:211], v[176:179], v[60:63]
  v_exp_f32 v71, v71
  v_mfma_f32_16x16x32_bf16 v[124:127], a[212:215], v[180:183], v[124:127]
  buffer_load_dwordx4 v2, s[24:27], s98 offen offset:0 sc1 lds
  v_mfma_f32_16x16x32_bf16 v[124:127], a[216:219], v[184:187], v[124:127]
  v_cvt_pk_bf16_f32 v194, v68, v69
  v_cvt_pk_bf16_f32 v195, v70, v71
  v_mfma_f32_16x16x32_bf16 v[124:127], a[220:223], v[188:191], v[124:127]
  v_exp_f32 v72, v72
  v_exp_f32 v73, v73
  v_exp_f32 v74, v74
  v_exp_f32 v75, v75
  v_cvt_pk_bf16_f32 v196, v72, v73
  v_cvt_pk_bf16_f32 v197, v74, v75
  v_exp_f32 v76, v76
  v_exp_f32 v77, v77
  v_exp_f32 v78, v78
  v_exp_f32 v79, v79
  v_cvt_pk_bf16_f32 v198, v76, v77
  v_cvt_pk_bf16_f32 v199, v78, v79
  v_sub_f32 v80, v80, v15
  v_sub_f32 v81, v81, v15
  v_sub_f32 v82, v82, v15
  v_sub_f32 v83, v83, v15
  v_exp_f32 v80, v80
  v_exp_f32 v81, v81
  v_exp_f32 v82, v82
  v_exp_f32 v83, v83
  buffer_load_dwordx4 v2, s[24:27], s98 offen offset:1024 sc1 lds
  v_cvt_pk_bf16_f32 v200, v80, v81
  v_cvt_pk_bf16_f32 v201, v82, v83
  v_exp_f32 v84, v84
  v_exp_f32 v85, v85
  v_exp_f32 v86, v86
  v_exp_f32 v87, v87
  v_cvt_pk_bf16_f32 v202, v84, v85
  v_cvt_pk_bf16_f32 v203, v86, v87
  v_exp_f32 v88, v88
  v_exp_f32 v89, v89
  v_exp_f32 v90, v90
  v_exp_f32 v91, v91
  v_cvt_pk_bf16_f32 v204, v88, v89
  v_cvt_pk_bf16_f32 v205, v90, v91
  v_exp_f32 v92, v92
  v_exp_f32 v93, v93
  v_exp_f32 v94, v94
  v_exp_f32 v95, v95
  v_cvt_pk_bf16_f32 v206, v92, v93
  v_cvt_pk_bf16_f32 v207, v94, v95
  v_sub_f32 v96, v96, v16
  v_sub_f32 v97, v97, v16
  v_sub_f32 v98, v98, v16
  v_sub_f32 v99, v99, v16
  v_exp_f32 v96, v96
  buffer_load_dwordx4 v2, s[24:27], s98 offen offset:2048 sc1 lds
  v_exp_f32 v97, v97
  v_exp_f32 v98, v98
  v_exp_f32 v99, v99
  v_cvt_pk_bf16_f32 v208, v96, v97
  v_cvt_pk_bf16_f32 v209, v98, v99
  v_exp_f32 v100, v100
  v_exp_f32 v101, v101
  v_exp_f32 v102, v102
  v_exp_f32 v103, v103
  v_cvt_pk_bf16_f32 v210, v100, v101
  v_cvt_pk_bf16_f32 v211, v102, v103
  v_exp_f32 v104, v104
  v_exp_f32 v105, v105
  v_exp_f32 v106, v106
  v_exp_f32 v107, v107
  v_cvt_pk_bf16_f32 v212, v104, v105
  v_cvt_pk_bf16_f32 v213, v106, v107
  v_exp_f32 v108, v108
  v_exp_f32 v109, v109
  v_exp_f32 v110, v110
  v_exp_f32 v111, v111
  v_cvt_pk_bf16_f32 v214, v108, v109
  v_cvt_pk_bf16_f32 v215, v110, v111
  buffer_load_dwordx4 v2, s[24:27], s98 offen offset:3072 sc1 lds
  s_mov_b32 s98, 0x14000
  s_add_u32 m0, s97, 0x8000
  v_sub_f32 v112, v112, v17
  v_sub_f32 v113, v113, v17
  v_sub_f32 v114, v114, v17
  v_sub_f32 v115, v115, v17
  v_exp_f32 v112, v112
  v_exp_f32 v113, v113
  v_exp_f32 v114, v114
  v_exp_f32 v115, v115
  v_cvt_pk_bf16_f32 v216, v112, v113
  v_cvt_pk_bf16_f32 v217, v114, v115
  v_exp_f32 v116, v116
  v_exp_f32 v117, v117
  v_exp_f32 v118, v118
  v_exp_f32 v119, v119
  v_cvt_pk_bf16_f32 v218, v116, v117
  v_cvt_pk_bf16_f32 v219, v118, v119
  v_exp_f32 v120, v120
  v_exp_f32 v121, v121
  v_exp_f32 v122, v122
  v_exp_f32 v123, v123
  v_cvt_pk_bf16_f32 v220, v120, v121
  v_cvt_pk_bf16_f32 v221, v122, v123
  v_mov_b32 v16, v24
  v_mov_b32 v17, v24
  buffer_load_dwordx4 v2, s[24:27], s98 offen offset:0 sc1 lds
  v_mov_b32 v18, v24
  v_mov_b32 v19, v24
  v_and_b32 v20, 1, v1
  v_sub_u32 v20, 0, v20
  v_and_b32 v20, 0xaaaaaaaa, v20
  v_or_b32 v20, 0x44444444, v20
  buffer_load_dwordx4 v2, s[24:27], s98 offen offset:1024 sc1 lds
  buffer_load_dwordx4 v2, s[24:27], s98 offen offset:2048 sc1 lds
  buffer_load_dwordx4 v2, s[24:27], s98 offen offset:3072 sc1 lds
  s_mov_b32 s98, 0x18000
  s_waitcnt lgkmcnt(7)
  s_mov_b32 s31, s30
  s_cmp_lt_u32 s31, 2
  s_cbranch_scc1 L_last4
.p2align 6
L_loop4:
  v_mfma_f32_16x16x32_bf16 v[112:115], a[160:163], v[176:179], v[60:63]
  s_waitcnt lgkmcnt(6)
  v_exp_f32 v124, v124
  v_mfma_f32_16x16x32_bf16 v[112:115], a[164:167], v[180:183], v[112:115]
  s_waitcnt lgkmcnt(5)
  v_exp_f32 v125, v125
  v_mfma_f32_16x16x32_bf16 v[112:115], a[168:171], v[184:187], v[112:115]
  s_waitcnt lgkmcnt(4)
  ds_read_b128 a[192:195], v4 offset:24576
  v_cvt_pk_bf16_f32 v222, v124, v125
  v_mfma_f32_16x16x32_bf16 v[112:115], a[172:175], v[188:191], v[112:115]
  s_add_u32 m0, s100, 0
  v_exp_f32 v126, v126
  v_mfma_f32_16x16x32_bf16 v[96:99], a[172:175], v[172:175], v[40:43]
  s_add_u32 s98, s98, 0x8000
  v_exp_f32 v127, v127
  v_mfma_f32_16x16x32_bf16 v[96:99], a[168:171], v[168:171], v[96:99]
  buffer_load_dwordx4 v2, s[24:27], s98 offen offset:0 sc1 lds
  v_mfma_f32_16x16x32_bf16 v[96:99], a[164:167], v[164:167], v[96:99]
  ds_read_b128 a[196:199], v4 offset:25600
  v_cvt_pk_bf16_f32 v223, v126, v127
  v_mfma_f32_16x16x32_bf16 v[96:99], a[160:163], v[160:163], v[96:99]
  v_exp_f32 v112, v112
  v_mfma_f32_16x16x32_bf16 v[80:83], a[160:163], v[144:147], v[56:59]
  v_exp_f32 v113, v113
  v_mfma_f32_16x16x32_bf16 v[80:83], a[164:167], v[148:151], v[80:83]
  ds_read_b128 a[200:203], v4 offset:26624
  v_cvt_pk_bf16_f32 v248, v112, v113
  v_mfma_f32_16x16x32_bf16 v[80:83], a[168:171], v[152:155], v[80:83]
  buffer_load_dwordx4 v2, s[24:27], s98 offen offset:1024 sc1 lds
  v_mfma_f32_16x16x32_bf16 v[80:83], a[172:175], v[156:159], v[80:83]
  v_exp_f32 v114, v114
  v_mfma_f32_16x16x32_bf16 v[64:67], a[172:175], v[140:143], v[16:19]
  v_exp_f32 v115, v115
  v_mfma_f32_16x16x32_bf16 v[64:67], a[168:171], v[136:139], v[64:67]
  ds_read_b128 a[204:207], v4 offset:27648
  v_cvt_pk_bf16_f32 v249, v114, v115
  v_mfma_f32_16x16x32_bf16 v[64:67], a[164:167], v[132:135], v[64:67]
  v_exp_f32 v96, v96
  v_mfma_f32_16x16x32_bf16 v[64:67], a[160:163], v[128:131], v[64:67]
  s_waitcnt lgkmcnt(7)
  buffer_load_dwordx4 v2, s[24:27], s98 offen offset:2048 sc1 lds
  v_mfma_f32_16x16x32_bf16 v[68:71], a[176:179], v[128:131], v[16:19]
  s_waitcnt lgkmcnt(6)
  v_exp_f32 v97, v97
  v_mfma_f32_16x16x32_bf16 v[68:71], a[180:183], v[132:135], v[68:71]
  s_waitcnt lgkmcnt(5)
  ds_read_b128 a[208:211], v4 offset:28672
  v_cvt_pk_bf16_f32 v240, v96, v97
  v_mfma_f32_16x16x32_bf16 v[68:71], a[184:187], v[136:139], v[68:71]
  s_waitcnt lgkmcnt(5)
  v_exp_f32 v98, v98
  v_mfma_f32_16x16x32_bf16 v[68:71], a[188:191], v[140:143], v[68:71]
  v_exp_f32 v99, v99
  v_mfma_f32_16x16x32_bf16 v[84:87], a[188:191], v[156:159], v[56:59]
  buffer_load_dwordx4 v2, s[24:27], s98 offen offset:3072 sc1 lds
  v_mfma_f32_16x16x32_bf16 v[84:87], a[184:187], v[152:155], v[84:87]
  ds_read_b128 a[212:215], v4 offset:29696
  v_cvt_pk_bf16_f32 v241, v98, v99
  v_mfma_f32_16x16x32_bf16 v[84:87], a[180:183], v[148:151], v[84:87]
  v_exp_f32 v80, v80
  v_mfma_f32_16x16x32_bf16 v[84:87], a[176:179], v[144:147], v[84:87]
  v_exp_f32 v81, v81
  v_mfma_f32_16x16x32_bf16 v[100:103], a[176:179], v[160:163], v[44:47]
  ds_read_b128 a[216:219], v4 offset:30720
  v_cvt_pk_bf16_f32 v232, v80, v81
  v_mfma_f32_16x16x32_bf16 v[100:103], a[180:183], v[164:167], v[100:103]
  buffer_load_dword v12, v22, s[8:11], s12 offen
  v_mfma_f32_16x16x32_bf16 v[100:103], a[184:187], v[168:171], v[100:103]
  s_add_u32 m0, s101, 16384
  v_exp_f32 v82, v82
  v_mfma_f32_16x16x32_bf16 v[100:103], a[188:191], v[172:175], v[100:103]
  s_add_u32 s99, s99, 0x8000
  v_exp_f32 v83, v83
  v_mfma_f32_16x16x32_bf16 v[116:119], a[188:191], v[188:191], v[60:63]
  s_add_u32 s12, s12, s13
  ds_read_b128 a[220:223], v4 offset:31744
  v_cvt_pk_bf16_f32 v233, v82, v83
  v_mfma_f32_16x16x32_bf16 v[116:119], a[184:187], v[184:187], v[116:119]
  s_sub_u32 s13, s13, 0x4000
  v_exp_f32 v64, v64
  v_mfma_f32_16x16x32_bf16 v[116:119], a[180:183], v[180:183], v[116:119]
  v_exp_f32 v65, v65
  v_mfma_f32_16x16x32_bf16 v[116:119], a[176:179], v[176:179], v[116:119]
  s_waitcnt lgkmcnt(7)
  ds_read_b128 a[224:227], v5 offset:0
  v_cvt_pk_bf16_f32 v224, v64, v65
  v_mfma_f32_16x16x32_bf16 v[120:123], a[192:195], v[176:179], v[60:63]
  s_waitcnt lgkmcnt(7)
  v_exp_f32 v66, v66
  v_mfma_f32_16x16x32_bf16 v[120:123], a[196:199], v[180:183], v[120:123]
  s_waitcnt lgkmcnt(6)
  v_exp_f32 v67, v67
  v_mfma_f32_16x16x32_bf16 v[120:123], a[200:203], v[184:187], v[120:123]
  s_waitcnt lgkmcnt(5)
  ds_read_b128 a[228:231], v5 offset:1024
  v_cvt_pk_bf16_f32 v225, v66, v67
  v_mfma_f32_16x16x32_bf16 v[120:123], a[204:207], v[188:191], v[120:123]
  v_exp_f32 v68, v68
  v_mfma_f32_16x16x32_bf16 v[104:107], a[204:207], v[172:175], v[48:51]
  v_exp_f32 v69, v69
  v_mfma_f32_16x16x32_bf16 v[104:107], a[200:203], v[168:171], v[104:107]
  ds_read_b128 a[232:235], v5 offset:2048
  v_cvt_pk_bf16_f32 v226, v68, v69
  v_mfma_f32_16x16x32_bf16 v[104:107], a[196:199], v[164:167], v[104:107]
  v_exp_f32 v70, v70
  v_mfma_f32_16x16x32_bf16 v[104:107], a[192:195], v[160:163], v[104:107]
  v_exp_f32 v71, v71
  v_mfma_f32_16x16x32_bf16 v[88:91], a[192:195], v[144:147], v[56:59]
  ds_read_b128 a[236:239], v5 offset:3072
  v_cvt_pk_bf16_f32 v227, v70, v71
  v_mfma_f32_16x16x32_bf16 v[88:91], a[196:199], v[148:151], v[88:91]
  v_exp_f32 v84, v84
  v_mfma_f32_16x16x32_bf16 v[88:91], a[200:203], v[152:155], v[88:91]
  v_exp_f32 v85, v85
  v_mfma_f32_16x16x32_bf16 v[88:91], a[204:207], v[156:159], v[88:91]
L_pad10:
  s_cbranch_execz L_pad14
  ds_read_b128 a[240:243], v5 offset:4096
  v_cvt_pk_bf16_f32 v234, v84, v85
  v_mfma_f32_16x16x32_bf16 v[72:75], a[204:207], v[140:143], v[16:19]
  v_exp_f32 v86, v86
  v_mfma_f32_16x16x32_bf16 v[72:75], a[200:203], v[136:139], v[72:75]
  v_exp_f32 v87, v87
  v_mfma_f32_16x16x32_bf16 v[72:75], a[196:199], v[132:135], v[72:75]
  ds_read_b128 a[244:247], v5 offset:5120
  v_cvt_pk_bf16_f32 v235, v86, v87
  v_mfma_f32_16x16x32_bf16 v[72:75], a[192:195], v[128:131], v[72:75]
  s_waitcnt lgkmcnt(9)
  v_exp_f32 v100, v100
  v_mfma_f32_16x16x32_bf16 v[76:79], a[208:211], v[128:131], v[16:19]
  s_waitcnt lgkmcnt(8)
  v_exp_f32 v101, v101
  v_mfma_f32_16x16x32_bf16 v[76:79], a[212:215], v[132:135], v[76:79]
  s_waitcnt lgkmcnt(7)
  ds_read_b128 a[248:251], v5 offset:6144
  v_cvt_pk_bf16_f32 v242, v100, v101
  v_mfma_f32_16x16x32_bf16 v[76:79], a[216:219], v[136:139], v[76:79]
  s_waitcnt lgkmcnt(7)
  v_exp_f32 v102, v102
  v_mfma_f32_16x16x32_bf16 v[76:79], a[220:223], v[140:143], v[76:79]
  v_exp_f32 v103, v103
  v_mfma_f32_16x16x32_bf16 v[92:95], a[220:223], v[156:159], v[56:59]
  ds_read_b128 a[252:255], v5 offset:7168
  v_cvt_pk_bf16_f32 v243, v102, v103
  v_mfma_f32_16x16x32_bf16 v[92:95], a[216:219], v[152:155], v[92:95]
  v_exp_f32 v116, v116
  v_mfma_f32_16x16x32_bf16 v[92:95], a[212:215], v[148:151], v[92:95]
  v_exp_f32 v117, v117
  v_mfma_f32_16x16x32_bf16 v[92:95], a[208:211], v[144:147], v[92:95]
  v_cvt_pk_bf16_f32 v250, v116, v117
  v_xor_b32 v4, 0x8000, v4
  v_mfma_f32_16x16x32_bf16 v[108:111], a[208:211], v[160:163], v[52:55]
  v_exp_f32 v118, v118
  v_mfma_f32_16x16x32_bf16 v[108:111], a[212:215], v[164:167], v[108:111]
  v_exp_f32 v119, v119
  v_mfma_f32_16x16x32_bf16 v[108:111], a[216:219], v[168:171], v[108:111]
  v_cvt_pk_bf16_f32 v251, v118, v119
  v_mfma_f32_16x16x32_bf16 v[108:111], a[220:223], v[172:175], v[108:111]
  v_exp_f32 v120, v120
  v_mfma_f32_16x16x32_bf16 v[124:127], a[220:223], v[188:191], v[60:63]
  v_exp_f32 v121, v121
  v_mfma_f32_16x16x32_bf16 v[124:127], a[216:219], v[184:187], v[124:127]
  v_cvt_pk_bf16_f32 v252, v120, v121
  v_mfma_f32_16x16x32_bf16 v[124:127], a[212:215], v[180:183], v[124:127]
  v_exp_f32 v122, v122
  v_mfma_f32_16x16x32_bf16 v[124:127], a[208:211], v[176:179], v[124:127]
  v_exp_f32 v123, v123
  v_smfmac_f32_16x16x64_bf16 a[128:131], a[144:147], v[192:199], v20
  v_cvt_pk_bf16_f32 v253, v122, v123
  v_smfmac_f32_16x16x64_bf16 a[132:135], a[144:147], v[200:207], v20
  v_smfmac_f32_16x16x64_bf16 a[136:139], a[144:147], v[208:215], v20
  v_smfmac_f32_16x16x64_bf16 a[140:143], a[144:147], v[216:223], v20
  s_waitcnt lgkmcnt(7)
  v_mfma_f32_16x16x32_bf16 a[96:99], a[224:227], v[216:219], a[96:99]
  s_waitcnt lgkmcnt(6)
  v_exp_f32 v104, v104
  v_mfma_f32_16x16x32_bf16 a[96:99], a[228:231], v[220:223], a[96:99]
  v_exp_f32 v105, v105
  v_mfma_f32_16x16x32_bf16 a[64:67], a[228:231], v[212:215], a[64:67]
  v_cvt_pk_bf16_f32 v244, v104, v105
  v_mfma_f32_16x16x32_bf16 a[64:67], a[224:227], v[208:211], a[64:67]
  v_exp_f32 v106, v106
  v_mfma_f32_16x16x32_bf16 a[32:35], a[224:227], v[200:203], a[32:35]
  v_exp_f32 v107, v107
  v_mfma_f32_16x16x32_bf16 a[32:35], a[228:231], v[204:207], a[32:35]
  v_cvt_pk_bf16_f32 v245, v106, v107
  v_mfma_f32_16x16x32_bf16 a[0:3], a[228:231], v[196:199], a[0:3]
  v_exp_f32 v88, v88
  v_mfma_f32_16x16x32_bf16 a[0:3], a[224:227], v[192:195], a[0:3]
  s_waitcnt lgkmcnt(5)
  v_exp_f32 v89, v89
  v_mfma_f32_16x16x32_bf16 a[4:7], a[232:235], v[192:195], a[4:7]
  s_waitcnt lgkmcnt(4)
  ds_read_b128 a[224:227], v5 offset:8192
  v_cvt_pk_bf16_f32 v236, v88, v89
  v_mfma_f32_16x16x32_bf16 a[4:7], a[236:239], v[196:199], a[4:7]
  v_exp_f32 v90, v90
  v_mfma_f32_16x16x32_bf16 a[36:39], a[236:239], v[204:207], a[36:39]
  ds_read_b128 a[228:231], v5 offset:9216
  v_mfma_f32_16x16x32_bf16 a[36:39], a[232:235], v[200:203], a[36:39]
  v_exp_f32 v91, v91
  v_mfma_f32_16x16x32_bf16 a[68:71], a[232:235], v[208:211], a[68:71]
  v_cvt_pk_bf16_f32 v237, v90, v91
  v_mfma_f32_16x16x32_bf16 a[68:71], a[236:239], v[212:215], a[68:71]
  v_exp_f32 v72, v72
  v_mfma_f32_16x16x32_bf16 a[100:103], a[236:239], v[220:223], a[100:103]
  v_exp_f32 v73, v73
  v_mfma_f32_16x16x32_bf16 a[100:103], a[232:235], v[216:219], a[100:103]
  s_waitcnt lgkmcnt(5)
  ds_read_b128 a[232:235], v5 offset:10240
  v_cvt_pk_bf16_f32 v228, v72, v73
  v_mfma_f32_16x16x32_bf16 a[104:107], a[240:243], v[216:219], a[104:107]
  s_waitcnt lgkmcnt(5)
  v_exp_f32 v74, v74
  v_mfma_f32_16x16x32_bf16 a[104:107], a[244:247], v[220:223], a[104:107]
  ds_read_b128 a[236:239], v5 offset:11264
  v_mfma_f32_16x16x32_bf16 a[72:75], a[244:247], v[212:215], a[72:75]
  v_exp_f32 v75, v75
  v_mfma_f32_16x16x32_bf16 a[72:75], a[240:243], v[208:211], a[72:75]
  v_cvt_pk_bf16_f32 v229, v74, v75
  v_mfma_f32_16x16x32_bf16 a[40:43], a[240:243], v[200:203], a[40:43]
  v_exp_f32 v76, v76
  v_mfma_f32_16x16x32_bf16 a[40:43], a[244:247], v[204:207], a[40:43]
  v_exp_f32 v77, v77
  v_mfma_f32_16x16x32_bf16 a[8:11], a[244:247], v[196:199], a[8:11]
  ds_read_b128 a[244:247], v5 offset:13312
  v_cvt_pk_bf16_f32 v230, v76, v77
  v_mfma_f32_16x16x32_bf16 a[8:11], a[240:243], v[192:195], a[8:11]
  s_waitcnt vmcnt(13) lgkmcnt(6)
  v_exp_f32 v78, v78
  v_mfma_f32_16x16x32_bf16 a[12:15], a[248:251], v[192:195], a[12:15]
  s_barrier
  s_waitcnt lgkmcnt(5)
  v_mfma_f32_16x16x32_bf16 a[12:15], a[252:255], v[196:199], a[12:15]
  buffer_load_dwordx4 v2, s[24:27], s99 offen offset:0 sc1 lds
  v_mfma_f32_16x16x32_bf16 a[44:47], a[252:255], v[204:207], a[44:47]
  s_xor_b32 s101, s101, 0x8000
  ds_read_b128 a[240:243], v5 offset:12288
  v_mfma_f32_16x16x32_bf16 a[44:47], a[248:251], v[200:203], a[44:47]
  v_exp_f32 v79, v79
  v_mfma_f32_16x16x32_bf16 a[76:79], a[248:251], v[208:211], a[76:79]
  ds_read_b128 a[160:163], v4 offset:0
  v_cvt_pk_bf16_f32 v231, v78, v79
  v_mfma_f32_16x16x32_bf16 a[76:79], a[252:255], v[212:215], a[76:79]
  v_exp_f32 v92, v92
  v_mfma_f32_16x16x32_bf16 a[108:111], a[252:255], v[220:223], a[108:111]
  v_exp_f32 v93, v93
  v_mfma_f32_16x16x32_bf16 a[108:111], a[248:251], v[216:219], a[108:111]
  s_waitcnt lgkmcnt(6)
  ds_read_b128 a[248:251], v5 offset:14336
  v_cvt_pk_bf16_f32 v238, v92, v93
  v_mfma_f32_16x16x32_bf16 a[112:115], a[224:227], v[216:219], a[112:115]
  s_waitcnt lgkmcnt(6)
  v_exp_f32 v94, v94
  v_mfma_f32_16x16x32_bf16 a[112:115], a[228:231], v[220:223], a[112:115]
  buffer_load_dwordx4 v2, s[24:27], s99 offen offset:1024 sc1 lds
  v_mfma_f32_16x16x32_bf16 a[80:83], a[228:231], v[212:215], a[80:83]
  ds_read_b128 a[252:255], v5 offset:15360
  v_mfma_f32_16x16x32_bf16 a[80:83], a[224:227], v[208:211], a[80:83]
  v_exp_f32 v95, v95
  v_mfma_f32_16x16x32_bf16 a[48:51], a[224:227], v[200:203], a[48:51]
  ds_read_b128 a[164:167], v4 offset:1024
  v_cvt_pk_bf16_f32 v239, v94, v95
  v_mfma_f32_16x16x32_bf16 a[48:51], a[228:231], v[204:207], a[48:51]
  v_exp_f32 v108, v108
  v_mfma_f32_16x16x32_bf16 a[16:19], a[228:231], v[196:199], a[16:19]
  v_exp_f32 v109, v109
  v_mfma_f32_16x16x32_bf16 a[16:19], a[224:227], v[192:195], a[16:19]
  s_waitcnt lgkmcnt(7)
  ds_read_b128 a[168:171], v4 offset:2048
  v_cvt_pk_bf16_f32 v246, v108, v109
  v_mfma_f32_16x16x32_bf16 a[20:23], a[232:235], v[192:195], a[20:23]
  s_waitcnt lgkmcnt(7)
  v_exp_f32 v110, v110
  v_mfma_f32_16x16x32_bf16 a[20:23], a[236:239], v[196:199], a[20:23]
  buffer_load_dwordx4 v2, s[24:27], s99 offen offset:2048 sc1 lds
  v_mfma_f32_16x16x32_bf16 a[52:55], a[236:239], v[204:207], a[52:55]
  ds_read_b128 a[172:175], v4 offset:3072
  v_mfma_f32_16x16x32_bf16 a[52:55], a[232:235], v[200:203], a[52:55]
  ds_read_b128 a[176:179], v4 offset:4096
  v_mfma_f32_16x16x32_bf16 a[84:87], a[232:235], v[208:211], a[84:87]
  v_exp_f32 v111, v111
  v_mfma_f32_16x16x32_bf16 a[84:87], a[236:239], v[212:215], a[84:87]
  ds_read_b128 a[180:183], v4 offset:5120
  v_cvt_pk_bf16_f32 v247, v110, v111
  v_mfma_f32_16x16x32_bf16 a[116:119], a[236:239], v[220:223], a[116:119]
  ds_read_b128 a[184:187], v4 offset:6144
  v_mfma_f32_16x16x32_bf16 a[116:119], a[232:235], v[216:219], a[116:119]
  s_waitcnt lgkmcnt(9)
  ds_read_b128 a[188:191], v4 offset:7168
  v_mfma_f32_16x16x32_bf16 a[120:123], a[240:243], v[216:219], a[120:123]
  v_mfma_f32_16x16x32_bf16 a[120:123], a[244:247], v[220:223], a[120:123]
  buffer_load_dwordx4 v2, s[24:27], s99 offen offset:3072 sc1 lds
  v_mfma_f32_16x16x32_bf16 a[88:91], a[244:247], v[212:215], a[88:91]
  v_mfma_f32_16x16x32_bf16 a[88:91], a[240:243], v[208:211], a[88:91]
  v_mfma_f32_16x16x32_bf16 a[56:59], a[240:243], v[200:203], a[56:59]
  v_mfma_f32_16x16x32_bf16 a[56:59], a[244:247], v[204:207], a[56:59]
  v_mfma_f32_16x16x32_bf16 a[24:27], a[244:247], v[196:199], a[24:27]
  v_mfma_f32_16x16x32_bf16 a[24:27], a[240:243], v[192:195], a[24:27]
  s_waitcnt lgkmcnt(8)
  v_mfma_f32_16x16x32_bf16 a[28:31], a[248:251], v[192:195], a[28:31]
  s_waitcnt lgkmcnt(7)
  v_mfma_f32_16x16x32_bf16 a[28:31], a[252:255], v[196:199], a[28:31]
  v_mfma_f32_16x16x32_bf16 a[60:63], a[252:255], v[204:207], a[60:63]
  v_mfma_f32_16x16x32_bf16 a[60:63], a[248:251], v[200:203], a[60:63]
  v_mfma_f32_16x16x32_bf16 a[92:95], a[248:251], v[208:211], a[92:95]
  v_mfma_f32_16x16x32_bf16 a[92:95], a[252:255], v[212:215], a[92:95]
  v_mfma_f32_16x16x32_bf16 a[124:127], a[252:255], v[220:223], a[124:127]
  v_mfma_f32_16x16x32_bf16 a[124:127], a[248:251], v[216:219], a[124:127]
  v_mfma_f32_16x16x32_bf16 v[112:115], a[160:163], v[176:179], v[60:63]
  s_waitcnt lgkmcnt(6)
  v_exp_f32 v124, v124
  v_mfma_f32_16x16x32_bf16 v[112:115], a[164:167], v[180:183], v[112:115]
  s_waitcnt lgkmcnt(5)
  v_exp_f32 v125, v125
  v_mfma_f32_16x16x32_bf16 v[112:115], a[168:171], v[184:187], v[112:115]
  s_waitcnt lgkmcnt(4)
  ds_read_b128 a[192:195], v4 offset:8192
  v_cvt_pk_bf16_f32 v254, v124, v125
  v_mfma_f32_16x16x32_bf16 v[112:115], a[172:175], v[188:191], v[112:115]
  s_add_u32 m0, s100, 16384
  v_exp_f32 v126, v126
  v_mfma_f32_16x16x32_bf16 v[96:99], a[172:175], v[172:175], v[40:43]
  s_add_u32 s98, s98, 0x8000
  v_exp_f32 v127, v127
  v_mfma_f32_16x16x32_bf16 v[96:99], a[168:171], v[168:171], v[96:99]
  buffer_load_dwordx4 v2, s[24:27], s98 offen offset:0 sc1 lds
  v_mfma_f32_16x16x32_bf16 v[96:99], a[164:167], v[164:167], v[96:99]
  s_xor_b32 s100, s100, 0x8000
  ds_read_b128 a[196:199], v4 offset:9216
  v_cvt_pk_bf16_f32 v255, v126, v127
  v_mfma_f32_16x16x32_bf16 v[96:99], a[160:163], v[160:163], v[96:99]
  v_exp_f32 v112, v112
  v_mfma_f32_16x16x32_bf16 v[80:83], a[160:163], v[144:147], v[56:59]
  v_exp_f32 v113, v113
  v_mfma_f32_16x16x32_bf16 v[80:83], a[164:167], v[148:151], v[80:83]
  ds_read_b128 a[200:203], v4 offset:10240
  v_cvt_pk_bf16_f32 v216, v112, v113
  v_mfma_f32_16x16x32_bf16 v[80:83], a[168:171], v[152:155], v[80:83]
  v_exp_f32 v114, v114
  v_mfma_f32_16x16x32_bf16 v[80:83], a[172:175], v[156:159], v[80:83]
  v_exp_f32 v115, v115
  v_mfma_f32_16x16x32_bf16 v[64:67], a[172:175], v[140:143], v[24:27]
  ds_read_b128 a[204:207], v4 offset:11264
  v_cvt_pk_bf16_f32 v217, v114, v115
  v_mfma_f32_16x16x32_bf16 v[64:67], a[168:171], v[136:139], v[64:67]
  buffer_load_dwordx4 v2, s[24:27], s98 offen offset:1024 sc1 lds
  v_mfma_f32_16x16x32_bf16 v[64:67], a[164:167], v[132:135], v[64:67]
  v_exp_f32 v96, v96
  v_mfma_f32_16x16x32_bf16 v[64:67], a[160:163], v[128:131], v[64:67]
  s_waitcnt lgkmcnt(7)
  v_exp_f32 v97, v97
  v_mfma_f32_16x16x32_bf16 v[68:71], a[176:179], v[128:131], v[28:31]
  s_waitcnt lgkmcnt(6)
  ds_read_b128 a[208:211], v4 offset:12288
  v_cvt_pk_bf16_f32 v208, v96, v97
  v_mfma_f32_16x16x32_bf16 v[68:71], a[180:183], v[132:135], v[68:71]
  s_waitcnt lgkmcnt(6)
  v_exp_f32 v98, v98
  v_mfma_f32_16x16x32_bf16 v[68:71], a[184:187], v[136:139], v[68:71]
  s_waitcnt lgkmcnt(5)
  v_exp_f32 v99, v99
  v_mfma_f32_16x16x32_bf16 v[68:71], a[188:191], v[140:143], v[68:71]
  ds_read_b128 a[212:215], v4 offset:13312
  v_cvt_pk_bf16_f32 v209, v98, v99
  v_mfma_f32_16x16x32_bf16 v[84:87], a[188:191], v[156:159], v[56:59]
  v_exp_f32 v80, v80
  v_mfma_f32_16x16x32_bf16 v[84:87], a[184:187], v[152:155], v[84:87]
  buffer_load_dwordx4 v2, s[24:27], s98 offen offset:2048 sc1 lds
  v_mfma_f32_16x16x32_bf16 v[84:87], a[180:183], v[148:151], v[84:87]
  v_exp_f32 v81, v81
  v_mfma_f32_16x16x32_bf16 v[84:87], a[176:179], v[144:147], v[84:87]
  ds_read_b128 a[216:219], v4 offset:14336
  v_cvt_pk_bf16_f32 v200, v80, v81
  v_mfma_f32_16x16x32_bf16 v[100:103], a[176:179], v[160:163], v[44:47]
  v_exp_f32 v82, v82
  v_mfma_f32_16x16x32_bf16 v[100:103], a[180:183], v[164:167], v[100:103]
  v_exp_f32 v83, v83
  v_mfma_f32_16x16x32_bf16 v[100:103], a[184:187], v[168:171], v[100:103]
  ds_read_b128 a[220:223], v4 offset:15360
  v_cvt_pk_bf16_f32 v201, v82, v83
  v_mfma_f32_16x16x32_bf16 v[100:103], a[188:191], v[172:175], v[100:103]
  v_exp_f32 v64, v64
  v_mfma_f32_16x16x32_bf16 v[116:119], a[188:191], v[188:191], v[60:63]
  v_exp_f32 v65, v65
  v_mfma_f32_16x16x32_bf16 v[116:119], a[184:187], v[184:187], v[116:119]
  buffer_load_dwordx4 v2, s[24:27], s98 offen offset:3072 sc1 lds
  v_mfma_f32_16x16x32_bf16 v[116:119], a[180:183], v[180:183], v[116:119]
  s_add_u32 m0, s101, 0
  ds_read_b128 a[224:227], v5 offset:16384
  v_cvt_pk_bf16_f32 v192, v64, v65
  v_mfma_f32_16x16x32_bf16 v[116:119], a[176:179], v[176:179], v[116:119]
  s_waitcnt lgkmcnt(8)
  v_exp_f32 v66, v66
  v_mfma_f32_16x16x32_bf16 v[120:123], a[192:195], v[176:179], v[60:63]
  s_waitcnt lgkmcnt(7)
  v_exp_f32 v67, v67
  v_mfma_f32_16x16x32_bf16 v[120:123], a[196:199], v[180:183], v[120:123]
  s_waitcnt lgkmcnt(6)
  ds_read_b128 a[228:231], v5 offset:17408
  v_cvt_pk_bf16_f32 v193, v66, v67
  v_mfma_f32_16x16x32_bf16 v[120:123], a[200:203], v[184:187], v[120:123]
  s_waitcnt lgkmcnt(6)
  v_exp_f32 v68, v68
  v_mfma_f32_16x16x32_bf16 v[120:123], a[204:207], v[188:191], v[120:123]
  s_add_u32 s99, s99, 0x8000
  v_exp_f32 v69, v69
  v_mfma_f32_16x16x32_bf16 v[104:107], a[204:207], v[172:175], v[48:51]
  ds_read_b128 a[232:235], v5 offset:18432
  v_cvt_pk_bf16_f32 v194, v68, v69
  v_mfma_f32_16x16x32_bf16 v[104:107], a[200:203], v[168:171], v[104:107]
  v_exp_f32 v70, v70
  v_mfma_f32_16x16x32_bf16 v[104:107], a[196:199], v[164:167], v[104:107]
  v_exp_f32 v71, v71
  v_mfma_f32_16x16x32_bf16 v[104:107], a[192:195], v[160:163], v[104:107]
  ds_read_b128 a[236:239], v5 offset:19456
  v_cvt_pk_bf16_f32 v195, v70, v71
  v_mfma_f32_16x16x32_bf16 v[88:91], a[192:195], v[144:147], v[56:59]
  v_exp_f32 v84, v84
  v_mfma_f32_16x16x32_bf16 v[88:91], a[196:199], v[148:151], v[88:91]
  v_exp_f32 v85, v85
  v_mfma_f32_16x16x32_bf16 v[88:91], a[200:203], v[152:155], v[88:91]
  ds_read_b128 a[240:243], v5 offset:20480
  v_cvt_pk_bf16_f32 v202, v84, v85
  v_mfma_f32_16x16x32_bf16 v[88:91], a[204:207], v[156:159], v[88:91]
  v_exp_f32 v86, v86
  v_mfma_f32_16x16x32_bf16 v[72:75], a[204:207], v[140:143], v[32:35]
  v_exp_f32 v87, v87
  v_mfma_f32_16x16x32_bf16 v[72:75], a[200:203], v[136:139], v[72:75]
  ds_read_b128 a[244:247], v5 offset:21504
  v_cvt_pk_bf16_f32 v203, v86, v87
  v_mfma_f32_16x16x32_bf16 v[72:75], a[196:199], v[132:135], v[72:75]
  v_exp_f32 v100, v100
  v_mfma_f32_16x16x32_bf16 v[72:75], a[192:195], v[128:131], v[72:75]
  s_waitcnt lgkmcnt(9)
  v_exp_f32 v101, v101
  v_mfma_f32_16x16x32_bf16 v[76:79], a[208:211], v[128:131], v[36:39]
  s_waitcnt lgkmcnt(8)
  ds_read_b128 a[248:251], v5 offset:22528
  v_cvt_pk_bf16_f32 v210, v100, v101
  v_mfma_f32_16x16x32_bf16 v[76:79], a[212:215], v[132:135], v[76:79]
  s_waitcnt lgkmcnt(8)
  v_exp_f32 v102, v102
  v_mfma_f32_16x16x32_bf16 v[76:79], a[216:219], v[136:139], v[76:79]
  s_waitcnt lgkmcnt(7)
  v_exp_f32 v103, v103
  v_mfma_f32_16x16x32_bf16 v[76:79], a[220:223], v[140:143], v[76:79]
  ds_read_b128 a[252:255], v5 offset:23552
  v_cvt_pk_bf16_f32 v211, v102, v103
  v_mfma_f32_16x16x32_bf16 v[92:95], a[220:223], v[156:159], v[56:59]
  v_exp_f32 v116, v116
  v_mfma_f32_16x16x32_bf16 v[92:95], a[216:219], v[152:155], v[92:95]
  v_exp_f32 v117, v117
  v_mfma_f32_16x16x32_bf16 v[92:95], a[212:215], v[148:151], v[92:95]
  v_cvt_pk_bf16_f32 v218, v116, v117
  v_mfma_f32_16x16x32_bf16 v[92:95], a[208:211], v[144:147], v[92:95]
  v_exp_f32 v118, v118
  v_mfma_f32_16x16x32_bf16 v[108:111], a[208:211], v[160:163], v[52:55]
  v_exp_f32 v119, v119
  v_mfma_f32_16x16x32_bf16 v[108:111], a[212:215], v[164:167], v[108:111]
  v_cvt_pk_bf16_f32 v219, v118, v119
  v_mfma_f32_16x16x32_bf16 v[108:111], a[216:219], v[168:171], v[108:111]
  v_exp_f32 v120, v120
  v_mfma_f32_16x16x32_bf16 v[108:111], a[220:223], v[172:175], v[108:111]
  v_exp_f32 v121, v121
  v_mfma_f32_16x16x32_bf16 v[124:127], a[220:223], v[188:191], v[60:63]
  v_cvt_pk_bf16_f32 v220, v120, v121
  v_mfma_f32_16x16x32_bf16 v[124:127], a[216:219], v[184:187], v[124:127]
  v_exp_f32 v122, v122
  v_mfma_f32_16x16x32_bf16 v[124:127], a[212:215], v[180:183], v[124:127]
  v_exp_f32 v123, v123
  v_mfma_f32_16x16x32_bf16 v[124:127], a[208:211], v[176:179], v[124:127]
  v_cvt_pk_bf16_f32 v221, v122, v123
  v_smfmac_f32_16x16x64_bf16 a[128:131], a[144:147], v[224:231], v20
  v_smfmac_f32_16x16x64_bf16 a[132:135], a[144:147], v[232:239], v20
  v_smfmac_f32_16x16x64_bf16 a[136:139], a[144:147], v[240:247], v20
  v_smfmac_f32_16x16x64_bf16 a[140:143], a[144:147], v[248:255], v20
  s_waitcnt lgkmcnt(7)
  v_mfma_f32_16x16x32_bf16 a[96:99], a[224:227], v[248:251], a[96:99]
  s_waitcnt lgkmcnt(6)
  v_exp_f32 v104, v104
  v_mfma_f32_16x16x32_bf16 a[96:99], a[228:231], v[252:255], a[96:99]
  v_exp_f32 v105, v105
  v_mfma_f32_16x16x32_bf16 a[64:67], a[228:231], v[244:247], a[64:67]
  v_cvt_pk_bf16_f32 v212, v104, v105
  v_mfma_f32_16x16x32_bf16 a[64:67], a[224:227], v[240:243], a[64:67]
  v_exp_f32 v106, v106
  v_mfma_f32_16x16x32_bf16 a[32:35], a[224:227], v[232:235], a[32:35]
  v_exp_f32 v107, v107
  v_mfma_f32_16x16x32_bf16 a[32:35], a[228:231], v[236:239], a[32:35]
  v_cvt_pk_bf16_f32 v213, v106, v107
  v_mfma_f32_16x16x32_bf16 a[0:3], a[228:231], v[228:231], a[0:3]
  v_exp_f32 v88, v88
  v_mfma_f32_16x16x32_bf16 a[0:3], a[224:227], v[224:227], a[0:3]
  s_waitcnt lgkmcnt(5)
  v_exp_f32 v89, v89
  v_mfma_f32_16x16x32_bf16 a[4:7], a[232:235], v[224:227], a[4:7]
  s_waitcnt lgkmcnt(4)
  ds_read_b128 a[224:227], v5 offset:24576
  v_cvt_pk_bf16_f32 v204, v88, v89
  v_mfma_f32_16x16x32_bf16 a[4:7], a[236:239], v[228:231], a[4:7]
  v_exp_f32 v90, v90
  v_mfma_f32_16x16x32_bf16 a[36:39], a[236:239], v[236:239], a[36:39]
  ds_read_b128 a[228:231], v5 offset:25600
  v_mfma_f32_16x16x32_bf16 a[36:39], a[232:235], v[232:235], a[36:39]
  v_exp_f32 v91, v91
  v_mfma_f32_16x16x32_bf16 a[68:71], a[232:235], v[240:243], a[68:71]
  v_cvt_pk_bf16_f32 v205, v90, v91
  v_mfma_f32_16x16x32_bf16 a[68:71], a[236:239], v[244:247], a[68:71]
  v_exp_f32 v72, v72
  v_mfma_f32_16x16x32_bf16 a[100:103], a[236:239], v[252:255], a[100:103]
  v_exp_f32 v73, v73
  v_mfma_f32_16x16x32_bf16 a[100:103], a[232:235], v[248:251], a[100:103]
  s_waitcnt lgkmcnt(5)
  ds_read_b128 a[232:235], v5 offset:26624
  v_cvt_pk_bf16_f32 v196, v72, v73
  v_mfma_f32_16x16x32_bf16 a[104:107], a[240:243], v[248:251], a[104:107]
  s_waitcnt lgkmcnt(5)
  v_exp_f32 v74, v74
  v_mfma_f32_16x16x32_bf16 a[104:107], a[244:247], v[252:255], a[104:107]
  ds_read_b128 a[236:239], v5 offset:27648
  v_mfma_f32_16x16x32_bf16 a[72:75], a[244:247], v[244:247], a[72:75]
  v_exp_f32 v75, v75
  v_mfma_f32_16x16x32_bf16 a[72:75], a[240:243], v[240:243], a[72:75]
  v_cvt_pk_bf16_f32 v197, v74, v75
  v_mfma_f32_16x16x32_bf16 a[40:43], a[240:243], v[232:235], a[40:43]
  v_exp_f32 v76, v76
  v_mfma_f32_16x16x32_bf16 a[40:43], a[244:247], v[236:239], a[40:43]
  v_exp_f32 v77, v77
  v_mfma_f32_16x16x32_bf16 a[8:11], a[244:247], v[228:231], a[8:11]
  ds_read_b128 a[244:247], v5 offset:29696
  v_cvt_pk_bf16_f32 v198, v76, v77
  v_mfma_f32_16x16x32_bf16 a[8:11], a[240:243], v[224:227], a[8:11]
  s_waitcnt vmcnt(13) lgkmcnt(6)
  v_exp_f32 v78, v78
  v_mfma_f32_16x16x32_bf16 a[12:15], a[248:251], v[224:227], a[12:15]
  s_barrier
  s_waitcnt lgkmcnt(5)
  v_mfma_f32_16x16x32_bf16 a[12:15], a[252:255], v[228:231], a[12:15]
  buffer_load_dwordx4 v2, s[24:27], s99 offen offset:0 sc1 lds
  v_mfma_f32_16x16x32_bf16 a[44:47], a[252:255], v[236:239], a[44:47]
  ds_read_b128 a[240:243], v5 offset:28672
  v_mfma_f32_16x16x32_bf16 a[44:47], a[248:251], v[232:235], a[44:47]
  v_exp_f32 v79, v79
  v_mfma_f32_16x16x32_bf16 a[76:79], a[248:251], v[240:243], a[76:79]
  ds_read_b128 a[160:163], v4 offset:16384
  v_cvt_pk_bf16_f32 v199, v78, v79
  v_mfma_f32_16x16x32_bf16 a[76:79], a[252:255], v[244:247], a[76:79]
  v_exp_f32 v92, v92
  v_mfma_f32_16x16x32_bf16 a[108:111], a[252:255], v[252:255], a[108:111]
  v_exp_f32 v93, v93
  v_mfma_f32_16x16x32_bf16 a[108:111], a[248:251], v[248:251], a[108:111]
  s_waitcnt lgkmcnt(6)
  ds_read_b128 a[248:251], v5 offset:30720
  v_cvt_pk_bf16_f32 v206, v92, v93
  v_mfma_f32_16x16x32_bf16 a[112:115], a[224:227], v[248:251], a[112:115]
  s_waitcnt lgkmcnt(6)
  v_exp_f32 v94, v94
  v_mfma_f32_16x16x32_bf16 a[112:115], a[228:231], v[252:255], a[112:115]
  buffer_load_dwordx4 v2, s[24:27], s99 offen offset:1024 sc1 lds
  v_mfma_f32_16x16x32_bf16 a[80:83], a[228:231], v[244:247], a[80:83]
  ds_read_b128 a[252:255], v5 offset:31744
  v_mfma_f32_16x16x32_bf16 a[80:83], a[224:227], v[240:243], a[80:83]
  v_exp_f32 v95, v95
  v_mfma_f32_16x16x32_bf16 a[48:51], a[224:227], v[232:235], a[48:51]
  ds_read_b128 a[164:167], v4 offset:17408
  v_cvt_pk_bf16_f32 v207, v94, v95
  v_mfma_f32_16x16x32_bf16 a[48:51], a[228:231], v[236:239], a[48:51]
  v_exp_f32 v108, v108
  v_mfma_f32_16x16x32_bf16 a[16:19], a[228:231], v[228:231], a[16:19]
  v_exp_f32 v109, v109
  v_mfma_f32_16x16x32_bf16 a[16:19], a[224:227], v[224:227], a[16:19]
  s_waitcnt lgkmcnt(7)
  ds_read_b128 a[168:171], v4 offset:18432
  v_cvt_pk_bf16_f32 v214, v108, v109
  v_mfma_f32_16x16x32_bf16 a[20:23], a[232:235], v[224:227], a[20:23]
  s_waitcnt lgkmcnt(7)
  v_exp_f32 v110, v110
  v_mfma_f32_16x16x32_bf16 a[20:23], a[236:239], v[228:231], a[20:23]
  buffer_load_dwordx4 v2, s[24:27], s99 offen offset:2048 sc1 lds
  v_mfma_f32_16x16x32_bf16 a[52:55], a[236:239], v[236:239], a[52:55]
  s_sub_u32 s31, s31, 1
  ds_read_b128 a[172:175], v4 offset:19456
  v_xor_b32 v5, 0x8000, v5
  v_mfma_f32_16x16x32_bf16 a[52:55], a[232:235], v[232:235], a[52:55]
  s_lshr_b32 s82, s82, 1
  ds_read_b128 a[176:179], v4 offset:20480
  v_mfma_f32_16x16x32_bf16 a[84:87], a[232:235], v[240:243], a[84:87]
  s_bitcmp1_b32 s82, 0
  v_exp_f32 v111, v111
  v_mfma_f32_16x16x32_bf16 a[84:87], a[236:239], v[244:247], a[84:87]
  s_cselect_b32 s3, 0, s31
  ds_read_b128 a[180:183], v4 offset:21504
  v_cvt_pk_bf16_f32 v215, v110, v111
  v_mfma_f32_16x16x32_bf16 a[116:119], a[236:239], v[252:255], a[116:119]
  s_cmp_gt_u32 s3, 1
  ds_read_b128 a[184:187], v4 offset:22528
  v_mfma_f32_16x16x32_bf16 a[116:119], a[232:235], v[248:251], a[116:119]
  s_waitcnt lgkmcnt(9)
  ds_read_b128 a[188:191], v4 offset:23552
  v_mfma_f32_16x16x32_bf16 a[120:123], a[240:243], v[248:251], a[120:123]
  v_mfma_f32_16x16x32_bf16 a[120:123], a[244:247], v[252:255], a[120:123]
  buffer_load_dwordx4 v2, s[24:27], s99 offen offset:3072 sc1 lds
  v_mfma_f32_16x16x32_bf16 a[88:91], a[244:247], v[244:247], a[88:91]
  v_mfma_f32_16x16x32_bf16 a[88:91], a[240:243], v[240:243], a[88:91]
  v_mfma_f32_16x16x32_bf16 a[56:59], a[240:243], v[232:235], a[56:59]
  v_mfma_f32_16x16x32_bf16 a[56:59], a[244:247], v[236:239], a[56:59]
  v_mfma_f32_16x16x32_bf16 a[24:27], a[244:247], v[228:231], a[24:27]
  v_mfma_f32_16x16x32_bf16 a[24:27], a[240:243], v[224:227], a[24:27]
  s_waitcnt lgkmcnt(8)
  v_mfma_f32_16x16x32_bf16 a[28:31], a[248:251], v[224:227], a[28:31]
  s_waitcnt lgkmcnt(7)
  v_mfma_f32_16x16x32_bf16 a[28:31], a[252:255], v[228:231], a[28:31]
  v_mfma_f32_16x16x32_bf16 a[60:63], a[252:255], v[236:239], a[60:63]
  v_mfma_f32_16x16x32_bf16 a[60:63], a[248:251], v[232:235], a[60:63]
  v_mfma_f32_16x16x32_bf16 a[92:95], a[248:251], v[240:243], a[92:95]
  v_mfma_f32_16x16x32_bf16 a[92:95], a[252:255], v[244:247], a[92:95]
  v_mfma_f32_16x16x32_bf16 a[124:127], a[252:255], v[252:255], a[124:127]
  v_mfma_f32_16x16x32_bf16 a[124:127], a[248:251], v[248:251], a[124:127]
  s_cbranch_scc1 L_loop4
L_ev4:
  s_bitcmp1_b32 s82, 0
  s_cbranch_scc1 L_hook4
L_last4:
  s_cmp_eq_u32 s31, 0
  s_cbranch_scc1 L_after4
  v_cndmask_b32 v24, v13, v24, s[32:33]
  v_cndmask_b32 v25, v13, v25, s[34:35]
  v_cndmask_b32 v26, v13, v26, s[36:37]
  v_cndmask_b32 v27, v13, v27, s[38:39]
  v_cndmask_b32 v28, v13, v28, s[40:41]
  v_cndmask_b32 v29, v13, v29, s[42:43]
  v_cndmask_b32 v30, v13, v30, s[44:45]
  v_cndmask_b32 v31, v13, v31, s[46:47]
  v_cndmask_b32 v32, v13, v32, s[48:49]
  v_cndmask_b32 v33, v13, v33, s[50:51]
  v_cndmask_b32 v34, v13, v34, s[52:53]
  v_cndmask_b32 v35, v13, v35, s[54:55]
  v_cndmask_b32 v36, v13, v36, s[56:57]
  v_cndmask_b32 v37, v13, v37, s[58:59]
  v_cndmask_b32 v38, v13, v38, s[60:61]
  v_cndmask_b32 v39, v13, v39, s[62:63]
  s_branch L_loop4
L_hook4:
  s_cmp_lt_u32 s82, 4
  s_cbranch_scc1 L_hook4_b
  s_cmp_gt_u32 s31, 1
  buffer_store_dword v9, v8, s[20:23], s88 offen offset:4 sc1
  s_cbranch_scc1 L_loop4
  s_branch L_last4
L_hook4_b:
  s_cmp_eq_u32 s82, 1
  s_cbranch_scc1 L_hook4_chk
  s_cmp_gt_u32 s31, 1
  buffer_load_dword v21, v7, s[20:23], 0 offen offset:4 sc1
  s_cbranch_scc1 L_loop4
  s_branch L_last4
L_hook4_chk:
  s_waitcnt vmcnt(8)
  s_mov_b32 s0, 0
L_hook4_loop:
  v_cmp_ne_u32 vcc, 1, v21
  s_nop 2
  s_cbranch_vccz L_hook4_ok
  buffer_load_dword v21, v7, s[20:23], 0 offen offset:4 sc1
  s_add_u32 s0, s0, 1
  s_cmp_lt_u32 s0, 0x200000
  s_waitcnt vmcnt(0)
  s_cbranch_scc1 L_hook4_loop
L_hook4_ok:
  s_cmp_gt_u32 s31, 1
  s_cbranch_scc1 L_loop4
  s_branch L_last4
L_after4:
  v_cndmask_b32 v24, v13, v56, s[32:33]
  v_cndmask_b32 v25, v13, v56, s[34:35]
  v_cndmask_b32 v26, v13, v56, s[36:37]
  v_cndmask_b32 v27, v13, v56, s[38:39]
  v_cndmask_b32 v28, v13, v56, s[40:41]
  v_cndmask_b32 v29, v13, v56, s[42:43]
  v_cndmask_b32 v30, v13, v56, s[44:45]
  v_cndmask_b32 v31, v13, v56, s[46:47]
  v_cndmask_b32 v32, v13, v56, s[48:49]
  v_cndmask_b32 v33, v13, v56, s[50:51]
  v_cndmask_b32 v34, v13, v56, s[52:53]
  v_cndmask_b32 v35, v13, v56, s[54:55]
  v_cndmask_b32 v36, v13, v56, s[56:57]
  v_cndmask_b32 v37, v13, v56, s[58:59]
  v_cndmask_b32 v38, v13, v56, s[60:61]
  v_cndmask_b32 v39, v13, v56, s[62:63]
  v_mfma_f32_16x16x32_bf16 v[112:115], a[160:163], v[176:179], v[60:63]
  s_waitcnt lgkmcnt(6)
  v_exp_f32 v124, v124
  v_mfma_f32_16x16x32_bf16 v[112:115], a[164:167], v[180:183], v[112:115]
  s_waitcnt lgkmcnt(5)
  v_exp_f32 v125, v125
  v_mfma_f32_16x16x32_bf16 v[112:115], a[168:171], v[184:187], v[112:115]
  s_waitcnt lgkmcnt(4)
  ds_read_b128 a[192:195], v4 offset:24576
  v_cvt_pk_bf16_f32 v222, v124, v125
  v_mfma_f32_16x16x32_bf16 v[112:115], a[172:175], v[188:191], v[112:115]
  v_exp_f32 v126, v126
  v_mfma_f32_16x16x32_bf16 v[96:99], a[172:175], v[172:175], v[40:43]
  v_exp_f32 v127, v127
  v_mfma_f32_16x16x32_bf16 v[96:99], a[168:171], v[168:171], v[96:99]
  ds_read_b128 a[196:199], v4 offset:25600
  v_cvt_pk_bf16_f32 v223, v126, v127
  v_mfma_f32_16x16x32_bf16 v[96:99], a[164:167], v[164:167], v[96:99]
  ds_read_b128 a[200:203], v4 offset:26624
  v_and_b32 v6, 31, v1
  v_mfma_f32_16x16x32_bf16 v[96:99], a[160:163], v[160:163], v[96:99]
  v_exp_f32 v112, v112
  v_mfma_f32_16x16x32_bf16 v[80:83], a[160:163], v[144:147], v[24:27]
  v_exp_f32 v113, v113
  v_mfma_f32_16x16x32_bf16 v[80:83], a[164:167], v[148:151], v[80:83]
  ds_read_b128 a[204:207], v4 offset:27648
  v_cvt_pk_bf16_f32 v248, v112, v113
  v_mfma_f32_16x16x32_bf16 v[80:83], a[168:171], v[152:155], v[80:83]
  v_exp_f32 v114, v114
  v_mfma_f32_16x16x32_bf16 v[80:83], a[172:175], v[156:159], v[80:83]
  s_waitcnt lgkmcnt(7)
  v_exp_f32 v115, v115
  v_mfma_f32_16x16x32_bf16 v[84:87], a[176:179], v[144:147], v[28:31]
  s_waitcnt lgkmcnt(6)
  v_cvt_pk_bf16_f32 v249, v114, v115
  v_lshlrev_b32 v6, 2, v6
  v_mfma_f32_16x16x32_bf16 v[84:87], a[180:183], v[148:151], v[84:87]
  s_waitcnt lgkmcnt(5)
  v_and_b32 v14, 60, v1
  v_lshl_add_u32 v71, v14, 4, v3
  v_mfma_f32_16x16x32_bf16 v[84:87], a[184:187], v[152:155], v[84:87]
  s_waitcnt lgkmcnt(4)
  ds_read_b128 a[208:211], v4 offset:28672
  v_subrev_u32 v73, 32, v3
  v_mfma_f32_16x16x32_bf16 v[84:87], a[188:191], v[156:159], v[84:87]
  s_lshl_b32 s3, s2, 2
  buffer_load_dword v10, v6, s[4:7], 0 offen offset:128 sc1
  v_mfma_f32_16x16x32_bf16 v[100:103], a[188:191], v[172:175], v[44:47]
  s_add_u32 m0, s100, 0
  v_exp_f32 v96, v96
  v_mfma_f32_16x16x32_bf16 v[100:103], a[184:187], v[168:171], v[100:103]
L_pad11:
  s_cbranch_execz L_pad15
  s_add_u32 s98, s98, 0x8000
  v_exp_f32 v97, v97
  v_mfma_f32_16x16x32_bf16 v[100:103], a[180:183], v[164:167], v[100:103]
  s_add_u32 s3, s3, s28
  ds_read_b128 a[212:215], v4 offset:29696
  v_cvt_pk_bf16_f32 v240, v96, v97
  v_mfma_f32_16x16x32_bf16 v[100:103], a[176:179], v[160:163], v[100:103]
  s_lshl_b32 s79, s3, 1
  v_exp_f32 v98, v98
  v_mfma_f32_16x16x32_bf16 v[116:119], a[176:179], v[176:179], v[60:63]
  s_lshl_b32 s3, s3, 12
  v_exp_f32 v99, v99
  v_mfma_f32_16x16x32_bf16 v[116:119], a[180:183], v[180:183], v[116:119]
  s_sub_u32 s78, 0x400000, s3
  ds_read_b128 a[216:219], v4 offset:30720
  v_cvt_pk_bf16_f32 v241, v98, v99
  v_mfma_f32_16x16x32_bf16 v[116:119], a[184:187], v[184:187], v[116:119]
  s_add_u32 s8, s84, s3
  s_addc_u32 s9, s85, 0
  ds_read_b128 a[220:223], v4 offset:31744
  v_mfma_f32_16x16x32_bf16 v[116:119], a[188:191], v[188:191], v[116:119]
  s_waitcnt lgkmcnt(7)
  buffer_load_dwordx4 v2, s[24:27], s98 offen offset:0 sc1 lds
  v_mfma_f32_16x16x32_bf16 v[120:123], a[192:195], v[176:179], v[60:63]
  s_waitcnt lgkmcnt(6)
  v_exp_f32 v80, v80
  v_mfma_f32_16x16x32_bf16 v[120:123], a[196:199], v[180:183], v[120:123]
  s_waitcnt lgkmcnt(5)
  v_exp_f32 v81, v81
  v_mfma_f32_16x16x32_bf16 v[120:123], a[200:203], v[184:187], v[120:123]
  s_waitcnt lgkmcnt(4)
  ds_read_b128 a[224:227], v5 offset:0
  v_cvt_pk_bf16_f32 v232, v80, v81
  v_mfma_f32_16x16x32_bf16 v[120:123], a[204:207], v[188:191], v[120:123]
  s_mov_b32 s10, s78
  v_exp_f32 v82, v82
  v_mfma_f32_16x16x32_bf16 v[104:107], a[204:207], v[172:175], v[48:51]
  s_mov_b32 s11, 0x20000
  v_exp_f32 v83, v83
  v_mfma_f32_16x16x32_bf16 v[104:107], a[200:203], v[168:171], v[104:107]
  s_lshr_b32 s3, s2, 4
  ds_read_b128 a[228:231], v5 offset:1024
  v_cvt_pk_bf16_f32 v233, v82, v83
  v_mfma_f32_16x16x32_bf16 v[104:107], a[196:199], v[164:167], v[104:107]
  s_lshl_b32 s3, s3, 3
  v_exp_f32 v84, v84
  v_mfma_f32_16x16x32_bf16 v[104:107], a[192:195], v[160:163], v[104:107]
  s_and_b32 s78, s2, 7
  buffer_load_dwordx4 v2, s[24:27], s98 offen offset:1024 sc1 lds
  v_mfma_f32_16x16x32_bf16 v[88:91], a[192:195], v[144:147], v[32:35]
  s_add_u32 s3, s3, s78
  v_exp_f32 v85, v85
  v_mfma_f32_16x16x32_bf16 v[88:91], a[196:199], v[148:151], v[88:91]
  s_bfe_u32 s78, s2, 0x10003
  ds_read_b128 a[232:235], v5 offset:2048
  v_cvt_pk_bf16_f32 v234, v84, v85
  v_mfma_f32_16x16x32_bf16 v[88:91], a[200:203], v[152:155], v[88:91]
  s_lshl_b32 s3, s3, 2
  v_exp_f32 v86, v86
  v_mfma_f32_16x16x32_bf16 v[88:91], a[204:207], v[156:159], v[88:91]
  s_waitcnt lgkmcnt(6)
  v_exp_f32 v87, v87
  v_mfma_f32_16x16x32_bf16 v[92:95], a[208:211], v[144:147], v[36:39]
  s_waitcnt lgkmcnt(5)
  ds_read_b128 a[236:239], v5 offset:3072
  v_cvt_pk_bf16_f32 v235, v86, v87
  v_mfma_f32_16x16x32_bf16 v[92:95], a[212:215], v[148:151], v[92:95]
  s_waitcnt lgkmcnt(5)
  v_exp_f32 v100, v100
  v_mfma_f32_16x16x32_bf16 v[92:95], a[216:219], v[152:155], v[92:95]
  s_waitcnt lgkmcnt(4)
  v_exp_f32 v101, v101
  v_mfma_f32_16x16x32_bf16 v[92:95], a[220:223], v[156:159], v[92:95]
  s_add_u32 s3, s3, s28
  buffer_load_dwordx4 v2, s[24:27], s98 offen offset:2048 sc1 lds
  v_mfma_f32_16x16x32_bf16 v[108:111], a[220:223], v[172:175], v[52:55]
  s_lshl_b32 s3, s3, 7
  ds_read_b128 a[240:243], v5 offset:4096
  v_cvt_pk_bf16_f32 v242, v100, v101
  v_mfma_f32_16x16x32_bf16 v[108:111], a[216:219], v[168:171], v[108:111]
  s_add_u32 s3, s3, s78
  v_exp_f32 v102, v102
  v_mfma_f32_16x16x32_bf16 v[108:111], a[212:215], v[164:167], v[108:111]
  s_lshl_b32 s3, s3, 6
  v_exp_f32 v103, v103
  v_mfma_f32_16x16x32_bf16 v[108:111], a[208:211], v[160:163], v[108:111]
  ds_read_b128 a[244:247], v5 offset:5120
  v_cvt_pk_bf16_f32 v243, v102, v103
  v_mfma_f32_16x16x32_bf16 v[124:127], a[208:211], v[176:179], v[60:63]
  v_exp_f32 v116, v116
  v_mfma_f32_16x16x32_bf16 v[124:127], a[212:215], v[180:183], v[124:127]
  v_exp_f32 v117, v117
  v_mfma_f32_16x16x32_bf16 v[124:127], a[216:219], v[184:187], v[124:127]
  ds_read_b128 a[248:251], v5 offset:6144
  v_cvt_pk_bf16_f32 v250, v116, v117
  v_mfma_f32_16x16x32_bf16 v[124:127], a[220:223], v[188:191], v[124:127]
  buffer_load_dwordx4 v2, s[24:27], s98 offen offset:3072 sc1 lds
  v_smfmac_f32_16x16x64_bf16 a[128:131], a[144:147], v[192:199], v20
  s_add_u32 m0, s101, 16384
  v_xor_b32 v4, 0x8000, v4
  v_smfmac_f32_16x16x64_bf16 a[132:135], a[144:147], v[200:207], v20
  s_add_u32 s99, s99, 0x8000
  v_smfmac_f32_16x16x64_bf16 a[136:139], a[144:147], v[208:215], v20
  s_add_u32 s12, s94, s3
  s_addc_u32 s13, s95, 0
  v_smfmac_f32_16x16x64_bf16 a[140:143], a[144:147], v[216:223], v20
  s_waitcnt lgkmcnt(6)
  v_mfma_f32_16x16x32_bf16 a[96:99], a[224:227], v[216:219], a[96:99]
  s_waitcnt lgkmcnt(5)
  v_exp_f32 v118, v118
  v_mfma_f32_16x16x32_bf16 a[96:99], a[228:231], v[220:223], a[96:99]
  v_exp_f32 v119, v119
  v_mfma_f32_16x16x32_bf16 a[64:67], a[228:231], v[212:215], a[64:67]
  ds_read_b128 a[252:255], v5 offset:7168
  v_cvt_pk_bf16_f32 v251, v118, v119
  v_mfma_f32_16x16x32_bf16 a[64:67], a[224:227], v[208:211], a[64:67]
  v_exp_f32 v120, v120
  v_mfma_f32_16x16x32_bf16 a[32:35], a[224:227], v[200:203], a[32:35]
  v_exp_f32 v121, v121
  v_mfma_f32_16x16x32_bf16 a[32:35], a[228:231], v[204:207], a[32:35]
  s_add_u32 s12, s12, 0x3000000
  s_addc_u32 s13, s13, 0
  v_cvt_pk_bf16_f32 v252, v120, v121
  v_mfma_f32_16x16x32_bf16 a[0:3], a[228:231], v[196:199], a[0:3]
  s_mov_b32 s14, 0x1fc0
  v_exp_f32 v122, v122
  v_mfma_f32_16x16x32_bf16 a[0:3], a[224:227], v[192:195], a[0:3]
  s_waitcnt lgkmcnt(5)
  v_exp_f32 v123, v123
  v_mfma_f32_16x16x32_bf16 a[4:7], a[232:235], v[192:195], a[4:7]
  s_waitcnt lgkmcnt(4)
  ds_read_b128 a[224:227], v5 offset:8192
  v_cvt_pk_bf16_f32 v253, v122, v123
  v_mfma_f32_16x16x32_bf16 a[4:7], a[236:239], v[196:199], a[4:7]
  s_mov_b32 s15, 0x20000
  v_exp_f32 v104, v104
  v_mfma_f32_16x16x32_bf16 a[36:39], a[236:239], v[204:207], a[36:39]
  s_mul_i32 s78, s28, 5120
  v_exp_f32 v105, v105
  v_mfma_f32_16x16x32_bf16 a[36:39], a[232:235], v[200:203], a[36:39]
  s_add_u32 s78, s78, 66560
  ds_read_b128 a[228:231], v5 offset:9216
  v_cvt_pk_bf16_f32 v244, v104, v105
  v_mfma_f32_16x16x32_bf16 a[68:71], a[232:235], v[208:211], a[68:71]
  s_mul_i32 s80, s28, 8192
  v_exp_f32 v106, v106
  v_mfma_f32_16x16x32_bf16 a[68:71], a[236:239], v[212:215], a[68:71]
  s_add_u32 s80, s80, 131072
  v_exp_f32 v107, v107
  v_mfma_f32_16x16x32_bf16 a[100:103], a[236:239], v[220:223], a[100:103]
  ds_read_b128 a[236:239], v5 offset:11264
  v_cvt_pk_bf16_f32 v245, v106, v107
  v_mfma_f32_16x16x32_bf16 a[100:103], a[232:235], v[216:219], a[100:103]
  s_waitcnt lgkmcnt(6)
  v_exp_f32 v88, v88
  v_mfma_f32_16x16x32_bf16 a[104:107], a[240:243], v[216:219], a[104:107]
  s_waitcnt lgkmcnt(5)
  ds_read_b128 a[232:235], v5 offset:10240
  v_and_b32 v16, 15, v1
  v_mfma_f32_16x16x32_bf16 a[104:107], a[244:247], v[220:223], a[104:107]
  v_exp_f32 v89, v89
  v_mfma_f32_16x16x32_bf16 a[72:75], a[244:247], v[212:215], a[72:75]
  v_cvt_pk_bf16_f32 v236, v88, v89
  v_lshrrev_b32 v17, 4, v1
  v_mfma_f32_16x16x32_bf16 a[72:75], a[240:243], v[208:211], a[72:75]
  v_exp_f32 v90, v90
  v_mfma_f32_16x16x32_bf16 a[40:43], a[240:243], v[200:203], a[40:43]
  v_exp_f32 v91, v91
  v_mfma_f32_16x16x32_bf16 a[40:43], a[244:247], v[204:207], a[40:43]
  v_cvt_pk_bf16_f32 v237, v90, v91
  v_lshl_add_u32 v18, v17, 3, v16
  v_mfma_f32_16x16x32_bf16 a[8:11], a[244:247], v[196:199], a[8:11]
  v_exp_f32 v92, v92
  v_mfma_f32_16x16x32_bf16 a[8:11], a[240:243], v[192:195], a[8:11]
  s_waitcnt vmcnt(13) lgkmcnt(5)
  ds_read_b128 a[240:243], v5 offset:12288
  v_add_u32 v18, 1, v18
  v_mfma_f32_16x16x32_bf16 a[12:15], a[248:251], v[192:195], a[12:15]
  s_barrier
  s_waitcnt lgkmcnt(5)
  v_mfma_f32_16x16x32_bf16 a[12:15], a[252:255], v[196:199], a[12:15]
  s_waitcnt vmcnt(4)
  v_cmp_eq_u32 vcc, 0, v10
  s_nop 2
  s_cbranch_vccnz L_prep_wait
L_prep_ok:
  v_mfma_f32_16x16x32_bf16 a[44:47], a[252:255], v[204:207], a[44:47]
  buffer_load_dwordx4 v2, s[24:27], s99 offen offset:0 sc1 lds
  v_mfma_f32_16x16x32_bf16 a[44:47], a[248:251], v[200:203], a[44:47]
  s_xor_b32 s101, s101, 0x8000
  ds_read_b128 a[244:247], v5 offset:13312
  v_lshlrev_b32 v74, 1, v18
  v_mfma_f32_16x16x32_bf16 a[76:79], a[248:251], v[208:211], a[76:79]
  v_exp_f32 v93, v93
  v_mfma_f32_16x16x32_bf16 a[76:79], a[252:255], v[212:215], a[76:79]
  v_cvt_pk_bf16_f32 v238, v92, v93
  v_add_u32 v72, s80, v74
  v_mfma_f32_16x16x32_bf16 a[108:111], a[252:255], v[220:223], a[108:111]
  buffer_load_dwordx4 v2, s[24:27], s99 offen offset:1024 sc1 lds
  v_mfma_f32_16x16x32_bf16 a[108:111], a[248:251], v[216:219], a[108:111]
  s_waitcnt lgkmcnt(5)
  v_exp_f32 v94, v94
  v_mfma_f32_16x16x32_bf16 a[112:115], a[224:227], v[216:219], a[112:115]
  s_waitcnt lgkmcnt(4)
  v_exp_f32 v95, v95
  v_mfma_f32_16x16x32_bf16 a[112:115], a[228:231], v[220:223], a[112:115]
  ds_read_b128 a[248:251], v5 offset:14336
  v_cvt_pk_bf16_f32 v239, v94, v95
  v_mfma_f32_16x16x32_bf16 a[80:83], a[228:231], v[212:215], a[80:83]
  buffer_load_dwordx4 v2, s[24:27], s99 offen offset:2048 sc1 lds
  v_mfma_f32_16x16x32_bf16 a[80:83], a[224:227], v[208:211], a[80:83]
  ds_read_b128 a[252:255], v5 offset:15360
  v_and_b32 v18, 1, v18
  v_mfma_f32_16x16x32_bf16 a[48:51], a[224:227], v[200:203], a[48:51]
  v_exp_f32 v108, v108
  v_mfma_f32_16x16x32_bf16 a[48:51], a[228:231], v[204:207], a[48:51]
  v_exp_f32 v109, v109
  v_mfma_f32_16x16x32_bf16 a[16:19], a[228:231], v[196:199], a[16:19]
  buffer_load_dwordx4 v2, s[24:27], s99 offen offset:3072 sc1 lds
  v_mfma_f32_16x16x32_bf16 a[16:19], a[224:227], v[192:195], a[16:19]
  s_waitcnt lgkmcnt(4)
  v_mul_u32_u24 v18, 4030, v18
  v_add_u32 v64, v72, v18
  v_mfma_f32_16x16x32_bf16 a[20:23], a[232:235], v[192:195], a[20:23]
  v_add_u32 v65, 0x400, v64
  v_add_u32 v66, 0x800, v64
  v_mfma_f32_16x16x32_bf16 a[20:23], a[236:239], v[196:199], a[20:23]
  s_mov_b32 m0, s80
  v_add_u32 v67, 0xc00, v64
  v_add_u32 v75, s80, v3
  v_mfma_f32_16x16x32_bf16 a[52:55], a[236:239], v[204:207], a[52:55]
  buffer_load_dwordx4 v73, s[8:11], 0 offen lds
  v_mfma_f32_16x16x32_bf16 a[52:55], a[232:235], v[200:203], a[52:55]
  s_add_u32 m0, s80, 1024
  v_lshlrev_b32 v68, 5, v16
  v_lshlrev_b32 v18, 4, v17
  v_mfma_f32_16x16x32_bf16 a[84:87], a[232:235], v[208:211], a[84:87]
  s_mov_b32 s76, 992
  v_sub_u32 v68, v68, v18
  v_add_u32 v68, s78, v68
  v_mfma_f32_16x16x32_bf16 a[84:87], a[236:239], v[212:215], a[84:87]
  v_subrev_u32 v68, 432, v68
  v_cvt_pk_bf16_f32 v246, v108, v109
  v_mfma_f32_16x16x32_bf16 a[116:119], a[236:239], v[220:223], a[116:119]
  buffer_load_dwordx4 v3, s[8:11], s76 offen offset:0 lds
  v_mfma_f32_16x16x32_bf16 a[116:119], a[232:235], v[216:219], a[116:119]
  s_waitcnt lgkmcnt(3)
  ds_read_b128 a[160:163], v4 offset:0
  v_mfma_f32_16x16x32_bf16 a[120:123], a[240:243], v[216:219], a[120:123]
  s_waitcnt lgkmcnt(3)
  v_exp_f32 v110, v110
  v_mfma_f32_16x16x32_bf16 a[120:123], a[244:247], v[220:223], a[120:123]
  ds_read_b128 a[164:167], v4 offset:1024
  v_mfma_f32_16x16x32_bf16 a[88:91], a[244:247], v[212:215], a[88:91]
  buffer_load_dwordx4 v3, s[8:11], s76 offen offset:1024 lds
  v_mfma_f32_16x16x32_bf16 a[88:91], a[240:243], v[208:211], a[88:91]
  ds_read_b128 a[168:171], v4 offset:2048
  v_mfma_f32_16x16x32_bf16 a[56:59], a[240:243], v[200:203], a[56:59]
  v_exp_f32 v111, v111
  v_mfma_f32_16x16x32_bf16 a[56:59], a[244:247], v[204:207], a[56:59]
  ds_read_b128 a[172:175], v4 offset:3072
  v_cvt_pk_bf16_f32 v247, v110, v111
  v_mfma_f32_16x16x32_bf16 a[24:27], a[244:247], v[196:199], a[24:27]
  buffer_load_dwordx4 v3, s[8:11], s76 offen offset:2048 lds
  v_mfma_f32_16x16x32_bf16 a[24:27], a[240:243], v[192:195], a[24:27]
  s_waitcnt lgkmcnt(5)
  ds_read_b128 a[176:179], v4 offset:4096
  v_mfma_f32_16x16x32_bf16 a[28:31], a[248:251], v[192:195], a[28:31]
  s_waitcnt lgkmcnt(5)
  ds_read_b128 a[180:183], v4 offset:5120
  v_mfma_f32_16x16x32_bf16 a[28:31], a[252:255], v[196:199], a[28:31]
  s_mov_b32 s16, s86
  ds_read_b128 a[184:187], v4 offset:6144
  v_mfma_f32_16x16x32_bf16 a[60:63], a[252:255], v[204:207], a[60:63]
  s_mov_b32 s17, s87
  ds_read_b128 a[188:191], v4 offset:7168
  v_mfma_f32_16x16x32_bf16 a[60:63], a[248:251], v[200:203], a[60:63]
  s_mov_b32 s18, 2048
  v_mfma_f32_16x16x32_bf16 a[92:95], a[248:251], v[208:211], a[92:95]
  s_cmp_lg_u32 s30, 7
  buffer_load_ushort v11, off, s[16:19], s79
  v_mfma_f32_16x16x32_bf16 a[92:95], a[252:255], v[212:215], a[92:95]
  v_mfma_f32_16x16x32_bf16 a[124:127], a[252:255], v[220:223], a[124:127]
  v_mfma_f32_16x16x32_bf16 a[124:127], a[248:251], v[216:219], a[124:127]
  s_waitcnt lgkmcnt(7)
  s_cbranch_scc1 L_nomask2
  v_cndmask_b32 v40, v13, v40, s[32:33]
  v_cndmask_b32 v41, v13, v41, s[34:35]
  v_cndmask_b32 v42, v13, v42, s[36:37]
  v_cndmask_b32 v43, v13, v43, s[38:39]
  v_cndmask_b32 v44, v13, v44, s[40:41]
  v_cndmask_b32 v45, v13, v45, s[42:43]
  v_cndmask_b32 v46, v13, v46, s[44:45]
  v_cndmask_b32 v47, v13, v47, s[46:47]
  v_cndmask_b32 v48, v13, v48, s[48:49]
  v_cndmask_b32 v49, v13, v49, s[50:51]
  v_cndmask_b32 v50, v13, v50, s[52:53]
  v_cndmask_b32 v51, v13, v51, s[54:55]
  v_cndmask_b32 v52, v13, v52, s[56:57]
  v_cndmask_b32 v53, v13, v53, s[58:59]
  v_cndmask_b32 v54, v13, v54, s[60:61]
  v_cndmask_b32 v55, v13, v55, s[62:63]
L_nomask2:
  v_mfma_f32_16x16x32_bf16 v[112:115], a[160:163], v[176:179], v[60:63]
  s_waitcnt lgkmcnt(6)
  v_exp_f32 v124, v124
  v_mfma_f32_16x16x32_bf16 v[112:115], a[164:167], v[180:183], v[112:115]
  s_waitcnt lgkmcnt(5)
  v_exp_f32 v125, v125
  v_mfma_f32_16x16x32_bf16 v[112:115], a[168:171], v[184:187], v[112:115]
  s_waitcnt lgkmcnt(4)
  ds_read_b128 a[192:195], v4 offset:8192
  v_cvt_pk_bf16_f32 v254, v124, v125
  v_mfma_f32_16x16x32_bf16 v[112:115], a[172:175], v[188:191], v[112:115]
  s_add_u32 m0, s100, 16384
  ds_read_b128 a[196:199], v4 offset:9216
  v_mov_b32 v24, v40
  v_mfma_f32_16x16x32_bf16 v[96:99], a[172:175], v[172:175], v[40:43]
  s_add_u32 s98, s98, 0x8000
  v_exp_f32 v126, v126
  v_mfma_f32_16x16x32_bf16 v[96:99], a[168:171], v[168:171], v[96:99]
  buffer_load_dwordx4 v2, s[24:27], s98 offen offset:0 sc1 lds
  v_mfma_f32_16x16x32_bf16 v[96:99], a[164:167], v[164:167], v[96:99]
  s_xor_b32 s100, s100, 0x8000
  ds_read_b128 a[200:203], v4 offset:10240
  v_mov_b32 v25, v40
  v_mfma_f32_16x16x32_bf16 v[96:99], a[160:163], v[160:163], v[96:99]
  s_waitcnt lgkmcnt(6)
  ds_read_b128 a[204:207], v4 offset:11264
  v_mov_b32 v26, v40
  v_mfma_f32_16x16x32_bf16 v[100:103], a[176:179], v[160:163], v[44:47]
  s_waitcnt lgkmcnt(6)
  v_exp_f32 v127, v127
  v_mfma_f32_16x16x32_bf16 v[100:103], a[180:183], v[164:167], v[100:103]
  s_waitcnt lgkmcnt(5)
  ds_read_b128 a[208:211], v4 offset:12288
  v_cvt_pk_bf16_f32 v255, v126, v127
  v_mfma_f32_16x16x32_bf16 v[100:103], a[184:187], v[168:171], v[100:103]
  s_waitcnt lgkmcnt(5)
  v_exp_f32 v112, v112
  v_mfma_f32_16x16x32_bf16 v[100:103], a[188:191], v[172:175], v[100:103]
  v_exp_f32 v113, v113
  v_mfma_f32_16x16x32_bf16 v[116:119], a[188:191], v[188:191], v[60:63]
  ds_read_b128 a[212:215], v4 offset:13312
  v_cvt_pk_bf16_f32 v216, v112, v113
  v_mfma_f32_16x16x32_bf16 v[116:119], a[184:187], v[184:187], v[116:119]
  buffer_load_dwordx4 v2, s[24:27], s98 offen offset:1024 sc1 lds
  v_mfma_f32_16x16x32_bf16 v[116:119], a[180:183], v[180:183], v[116:119]
  v_exp_f32 v114, v114
  v_mfma_f32_16x16x32_bf16 v[116:119], a[176:179], v[176:179], v[116:119]
  s_waitcnt lgkmcnt(5)
  ds_read_b128 a[216:219], v4 offset:14336
  v_mov_b32 v27, v40
  v_mfma_f32_16x16x32_bf16 v[120:123], a[192:195], v[176:179], v[60:63]
  s_waitcnt lgkmcnt(5)
  ds_read_b128 a[220:223], v4 offset:15360
  v_mfma_f32_16x16x32_bf16 v[120:123], a[196:199], v[180:183], v[120:123]
  s_waitcnt lgkmcnt(5)
  v_exp_f32 v115, v115
  v_mfma_f32_16x16x32_bf16 v[120:123], a[200:203], v[184:187], v[120:123]
  s_waitcnt lgkmcnt(4)
  ds_read_b128 a[224:227], v5 offset:16384
  v_cvt_pk_bf16_f32 v217, v114, v115
  v_mfma_f32_16x16x32_bf16 v[120:123], a[204:207], v[188:191], v[120:123]
  v_exp_f32 v96, v96
  v_mfma_f32_16x16x32_bf16 v[104:107], a[204:207], v[172:175], v[48:51]
  v_exp_f32 v97, v97
  v_mfma_f32_16x16x32_bf16 v[104:107], a[200:203], v[168:171], v[104:107]
  buffer_load_dwordx4 v2, s[24:27], s98 offen offset:2048 sc1 lds
  v_mfma_f32_16x16x32_bf16 v[104:107], a[196:199], v[164:167], v[104:107]
  ds_read_b128 a[228:231], v5 offset:17408
  v_cvt_pk_bf16_f32 v208, v96, v97
  v_mfma_f32_16x16x32_bf16 v[104:107], a[192:195], v[160:163], v[104:107]
  s_waitcnt lgkmcnt(5)
  v_exp_f32 v98, v98
  v_mfma_f32_16x16x32_bf16 v[108:111], a[208:211], v[160:163], v[52:55]
  s_waitcnt lgkmcnt(4)
  v_exp_f32 v99, v99
  v_mfma_f32_16x16x32_bf16 v[108:111], a[212:215], v[164:167], v[108:111]
  s_waitcnt lgkmcnt(3)
  ds_read_b128 a[232:235], v5 offset:18432
  v_cvt_pk_bf16_f32 v209, v98, v99
  v_mfma_f32_16x16x32_bf16 v[108:111], a[216:219], v[168:171], v[108:111]
  s_waitcnt lgkmcnt(3)
  ds_read_b128 a[236:239], v5 offset:19456
  v_mfma_f32_16x16x32_bf16 v[108:111], a[220:223], v[172:175], v[108:111]
  v_exp_f32 v100, v100
  v_mfma_f32_16x16x32_bf16 v[124:127], a[220:223], v[188:191], v[60:63]
  v_exp_f32 v101, v101
  v_mfma_f32_16x16x32_bf16 v[124:127], a[216:219], v[184:187], v[124:127]
  buffer_load_dwordx4 v2, s[24:27], s98 offen offset:3072 sc1 lds
  v_mfma_f32_16x16x32_bf16 v[124:127], a[212:215], v[180:183], v[124:127]
  s_add_u32 m0, s101, 0
  ds_read_b128 a[240:243], v5 offset:20480
  v_cvt_pk_bf16_f32 v210, v100, v101
  v_mfma_f32_16x16x32_bf16 v[124:127], a[208:211], v[176:179], v[124:127]
  s_add_u32 s99, s99, 0x8000
  v_exp_f32 v102, v102
  v_smfmac_f32_16x16x64_bf16 a[132:135], a[144:147], v[232:239], v20
  v_smfmac_f32_16x16x64_bf16 a[136:139], a[144:147], v[240:247], v20
  v_smfmac_f32_16x16x64_bf16 a[140:143], a[144:147], v[248:255], v20
  s_waitcnt lgkmcnt(4)
  v_mfma_f32_16x16x32_bf16 a[96:99], a[224:227], v[248:251], a[96:99]
  s_waitcnt lgkmcnt(3)
  ds_read_b128 a[244:247], v5 offset:21504
  v_mfma_f32_16x16x32_bf16 a[96:99], a[228:231], v[252:255], a[96:99]
  v_exp_f32 v103, v103
  v_mfma_f32_16x16x32_bf16 a[64:67], a[228:231], v[244:247], a[64:67]
  ds_read_b128 a[248:251], v5 offset:22528
  v_cvt_pk_bf16_f32 v211, v102, v103
  v_mfma_f32_16x16x32_bf16 a[64:67], a[224:227], v[240:243], a[64:67]
  v_exp_f32 v116, v116
  v_mfma_f32_16x16x32_bf16 a[32:35], a[224:227], v[232:235], a[32:35]
  ds_read_b128 a[252:255], v5 offset:23552
  v_mfma_f32_16x16x32_bf16 a[32:35], a[228:231], v[236:239], a[32:35]
  s_waitcnt lgkmcnt(5)
  v_exp_f32 v117, v117
  v_mfma_f32_16x16x32_bf16 a[36:39], a[232:235], v[232:235], a[36:39]
  s_waitcnt lgkmcnt(4)
  ds_read_b128 a[224:227], v5 offset:24576
  v_cvt_pk_bf16_f32 v218, v116, v117
  v_mfma_f32_16x16x32_bf16 a[36:39], a[236:239], v[236:239], a[36:39]
  v_exp_f32 v118, v118
  v_mfma_f32_16x16x32_bf16 a[68:71], a[236:239], v[244:247], a[68:71]
  v_exp_f32 v119, v119
  v_mfma_f32_16x16x32_bf16 a[68:71], a[232:235], v[240:243], a[68:71]
  ds_read_b128 a[228:231], v5 offset:25600
  v_cvt_pk_bf16_f32 v219, v118, v119
  v_mfma_f32_16x16x32_bf16 a[100:103], a[232:235], v[248:251], a[100:103]
  v_exp_f32 v120, v120
  v_mfma_f32_16x16x32_bf16 a[100:103], a[236:239], v[252:255], a[100:103]
  s_waitcnt lgkmcnt(5)
  v_exp_f32 v121, v121
  v_mfma_f32_16x16x32_bf16 a[104:107], a[240:243], v[248:251], a[104:107]
  s_waitcnt lgkmcnt(4)
  ds_read_b128 a[232:235], v5 offset:26624
  v_cvt_pk_bf16_f32 v220, v120, v121
  v_mfma_f32_16x16x32_bf16 a[104:107], a[244:247], v[252:255], a[104:107]
  v_exp_f32 v122, v122
  v_mfma_f32_16x16x32_bf16 a[72:75], a[244:247], v[244:247], a[72:75]
  v_exp_f32 v123, v123
  v_mfma_f32_16x16x32_bf16 a[72:75], a[240:243], v[240:243], a[72:75]
  ds_read_b128 a[236:239], v5 offset:27648
  v_cvt_pk_bf16_f32 v221, v122, v123
  v_mfma_f32_16x16x32_bf16 a[40:43], a[240:243], v[232:235], a[40:43]
  v_exp_f32 v104, v104
  v_mfma_f32_16x16x32_bf16 a[40:43], a[244:247], v[236:239], a[40:43]
  s_waitcnt vmcnt(18) lgkmcnt(5)
  v_exp_f32 v105, v105
  v_mfma_f32_16x16x32_bf16 a[44:47], a[248:251], v[232:235], a[44:47]
  s_barrier
  s_waitcnt lgkmcnt(4)
  v_mfma_f32_16x16x32_bf16 a[44:47], a[252:255], v[236:239], a[44:47]
  buffer_load_dwordx4 v2, s[24:27], s99 offen offset:0 sc1 lds
  v_mfma_f32_16x16x32_bf16 a[76:79], a[252:255], v[244:247], a[76:79]
  ds_read_b128 a[240:243], v5 offset:28672
  v_cvt_pk_bf16_f32 v212, v104, v105
  v_mfma_f32_16x16x32_bf16 a[76:79], a[248:251], v[240:243], a[76:79]
  v_exp_f32 v106, v106
  v_mfma_f32_16x16x32_bf16 a[108:111], a[248:251], v[248:251], a[108:111]
  ds_read_b128 a[244:247], v5 offset:29696
  v_and_b32 v16, 15, v1
  v_mfma_f32_16x16x32_bf16 a[108:111], a[252:255], v[252:255], a[108:111]
  s_waitcnt lgkmcnt(5)
  v_exp_f32 v107, v107
  v_mfma_f32_16x16x32_bf16 a[112:115], a[224:227], v[248:251], a[112:115]
  s_waitcnt lgkmcnt(4)
  buffer_load_dwordx4 v2, s[24:27], s99 offen offset:1024 sc1 lds
  v_mfma_f32_16x16x32_bf16 a[112:115], a[228:231], v[252:255], a[112:115]
  ds_read_b128 a[248:251], v5 offset:30720
  v_cvt_pk_bf16_f32 v213, v106, v107
  v_mfma_f32_16x16x32_bf16 a[80:83], a[228:231], v[244:247], a[80:83]
  v_exp_f32 v108, v108
  v_mfma_f32_16x16x32_bf16 a[80:83], a[224:227], v[240:243], a[80:83]
  ds_read_b128 a[252:255], v5 offset:31744
  v_lshrrev_b32 v17, 4, v1
  v_mfma_f32_16x16x32_bf16 a[48:51], a[224:227], v[232:235], a[48:51]
  v_exp_f32 v109, v109
  v_mfma_f32_16x16x32_bf16 a[48:51], a[228:231], v[236:239], a[48:51]
  s_waitcnt lgkmcnt(5)
  buffer_load_dwordx4 v2, s[24:27], s99 offen offset:2048 sc1 lds
  v_mfma_f32_16x16x32_bf16 a[52:55], a[232:235], v[232:235], a[52:55]
  s_waitcnt lgkmcnt(4)
  ds_read_b128 a[160:163], v4 offset:16384
  v_cvt_pk_bf16_f32 v214, v108, v109
  v_mfma_f32_16x16x32_bf16 a[52:55], a[236:239], v[236:239], a[52:55]
  v_exp_f32 v110, v110
  v_mfma_f32_16x16x32_bf16 a[84:87], a[236:239], v[244:247], a[84:87]
  ds_read_b128 a[164:167], v4 offset:17408
  v_xor_b32 v5, 0x8000, v5
  v_mfma_f32_16x16x32_bf16 a[84:87], a[232:235], v[240:243], a[84:87]
  ds_read_b128 a[168:171], v4 offset:18432
  v_lshl_add_u32 v16, v17, 3, v16
  v_mfma_f32_16x16x32_bf16 a[116:119], a[232:235], v[248:251], a[116:119]
  buffer_load_dwordx4 v2, s[24:27], s99 offen offset:3072 sc1 lds
  v_mfma_f32_16x16x32_bf16 a[116:119], a[236:239], v[252:255], a[116:119]
  s_waitcnt lgkmcnt(6)
  v_exp_f32 v111, v111
  v_mfma_f32_16x16x32_bf16 a[120:123], a[240:243], v[248:251], a[120:123]
  s_waitcnt lgkmcnt(5)
  ds_read_b128 a[172:175], v4 offset:19456
  v_cvt_pk_bf16_f32 v215, v110, v111
  v_mfma_f32_16x16x32_bf16 a[120:123], a[244:247], v[252:255], a[120:123]
  ds_read_b128 a[176:179], v4 offset:20480
  v_sub_u32 v16, 15, v16
  v_mfma_f32_16x16x32_bf16 a[88:91], a[244:247], v[244:247], a[88:91]
  ds_read_b128 a[180:183], v4 offset:21504
  v_and_b32 v17, 1, v16
  v_mfma_f32_16x16x32_bf16 a[88:91], a[240:243], v[240:243], a[88:91]
  buffer_load_dwordx4 v[76:79], v74, s[8:11], 0 offen offset:4000
  v_mfma_f32_16x16x32_bf16 a[56:59], a[240:243], v[232:235], a[56:59]
  ds_read_b128 a[184:187], v4 offset:22528
  v_lshlrev_b32 v17, 4, v17
  v_mfma_f32_16x16x32_bf16 a[56:59], a[244:247], v[236:239], a[56:59]
  s_waitcnt vmcnt(9) lgkmcnt(8)
  ds_read_b128 a[188:191], v4 offset:23552
  v_lshlrev_b32 v17, v17, v11
  v_mfma_f32_16x16x32_bf16 a[60:63], a[248:251], v[232:235], a[60:63]
  s_waitcnt lgkmcnt(8)
  v_ashrrev_i32 v16, 1, v16
  v_cmp_eq_u32 vcc, 0, v16
  v_mfma_f32_16x16x32_bf16 a[60:63], a[252:255], v[236:239], a[60:63]
  v_mfma_f32_16x16x32_bf16 a[92:95], a[252:255], v[244:247], a[92:95]
  v_cndmask_b32 v56, 0, v17, vcc
  v_cmp_eq_u32 vcc, 1, v16
  v_mfma_f32_16x16x32_bf16 a[92:95], a[248:251], v[240:243], a[92:95]
  v_mfma_f32_16x16x32_bf16 a[124:127], a[248:251], v[248:251], a[124:127]
  v_cndmask_b32 v57, 0, v17, vcc
  v_cmp_eq_u32 vcc, 2, v16
  v_mfma_f32_16x16x32_bf16 a[124:127], a[252:255], v[252:255], a[124:127]
  s_waitcnt lgkmcnt(7)
  v_cndmask_b32 v58, 0, v17, vcc
  v_cmp_eq_u32 vcc, 3, v16
  s_nop 1
  v_cndmask_b32 v59, 0, v17, vcc
  s_lshl_b32 s3, s29, 15
  s_lshl_b32 s31, s28, 10
  s_add_u32 s3, s3, s31
  s_add_u32 s4, s94, s3
  s_addc_u32 s5, s95, 0
  s_add_u32 s4, s4, 0x2000000
  s_addc_u32 s5, s5, 0
  s_mov_b32 s6, 0xf07400
  s_mov_b32 s7, 0x20000
  s_lshl_b32 s87, s30, 20
  v_accvgpr_read_b32 v14, a128
  v_accvgpr_read_b32 v22, a129
  v_add_f32 v14, v14, v22
  v_rcp_f32 v22, v14
  v_accvgpr_read_b32 v192, a0
  v_accvgpr_read_b32 v193, a1
  v_accvgpr_read_b32 v194, a2
  v_accvgpr_read_b32 v195, a3
  v_accvgpr_read_b32 v196, a4
  v_accvgpr_read_b32 v197, a5
  v_accvgpr_read_b32 v198, a6
  v_accvgpr_read_b32 v199, a7
  v_mul_f32 v192, v192, v22
  v_mul_f32 v193, v193, v22
  v_mul_f32 v194, v194, v22
  v_mul_f32 v195, v195, v22
  v_mul_f32 v196, v196, v22
  v_mul_f32 v197, v197, v22
  v_mul_f32 v198, v198, v22
  v_mul_f32 v199, v199, v22
  v_cvt_pk_bf16_f32 v200, v192, v193
  v_cvt_pk_bf16_f32 v201, v194, v195
  v_cvt_pk_bf16_f32 v202, v196, v197
  v_cvt_pk_bf16_f32 v203, v198, v199
  s_add_u32 s86, s87, 0x0
  buffer_store_dwordx4 v[200:203], v3, s[4:7], s86 offen sc1
  v_accvgpr_read_b32 v224, a8
  v_accvgpr_read_b32 v225, a9
  v_accvgpr_read_b32 v226, a10
  v_accvgpr_read_b32 v227, a11
  v_accvgpr_read_b32 v228, a12
  v_accvgpr_read_b32 v229, a13
  v_accvgpr_read_b32 v230, a14
  v_accvgpr_read_b32 v231, a15
  v_mul_f32 v224, v224, v22
  v_mul_f32 v225, v225, v22
  v_mul_f32 v226, v226, v22
  v_mul_f32 v227, v227, v22
  v_mul_f32 v228, v228, v22
  v_mul_f32 v229, v229, v22
  v_mul_f32 v230, v230, v22
  v_mul_f32 v231, v231, v22
  v_cvt_pk_bf16_f32 v232, v224, v225
  v_cvt_pk_bf16_f32 v233, v226, v227
  v_cvt_pk_bf16_f32 v234, v228, v229
  v_cvt_pk_bf16_f32 v235, v230, v231
  s_add_u32 s86, s87, 0x2000
  buffer_store_dwordx4 v[232:235], v3, s[4:7], s86 offen sc1
  v_accvgpr_read_b32 v192, a16
  v_accvgpr_read_b32 v193, a17
  v_accvgpr_read_b32 v194, a18
  v_accvgpr_read_b32 v195, a19
  v_accvgpr_read_b32 v196, a20
  v_accvgpr_read_b32 v197, a21
  v_accvgpr_read_b32 v198, a22
  v_accvgpr_read_b32 v199, a23
  v_mul_f32 v192, v192, v22
  v_mul_f32 v193, v193, v22
  v_mul_f32 v194, v194, v22
  v_mul_f32 v195, v195, v22
  v_mul_f32 v196, v196, v22
  v_mul_f32 v197, v197, v22
  v_mul_f32 v198, v198, v22
  v_mul_f32 v199, v199, v22
  v_cvt_pk_bf16_f32 v200, v192, v193
  v_cvt_pk_bf16_f32 v201, v194, v195
  v_cvt_pk_bf16_f32 v202, v196, v197
  v_cvt_pk_bf16_f32 v203, v198, v199
  s_add_u32 s86, s87, 0x4000
  buffer_store_dwordx4 v[200:203], v3, s[4:7], s86 offen sc1
  v_accvgpr_read_b32 v224, a24
  v_accvgpr_read_b32 v225, a25
  v_accvgpr_read_b32 v226, a26
  v_accvgpr_read_b32 v227, a27
  v_accvgpr_read_b32 v228, a28
  v_accvgpr_read_b32 v229, a29
  v_accvgpr_read_b32 v230, a30
  v_accvgpr_read_b32 v231, a31
  v_mul_f32 v224, v224, v22
  v_mul_f32 v225, v225, v22
  v_mul_f32 v226, v226, v22
  v_mul_f32 v227, v227, v22
  v_mul_f32 v228, v228, v22
  v_mul_f32 v229, v229, v22
  v_mul_f32 v230, v230, v22
  v_mul_f32 v231, v231, v22
  v_cvt_pk_bf16_f32 v232, v224, v225
  v_cvt_pk_bf16_f32 v233, v226, v227
  v_cvt_pk_bf16_f32 v234, v228, v229
L_pad12:
  s_cbranch_execz L_hr1
  v_cvt_pk_bf16_f32 v235, v230, v231
  s_add_u32 s86, s87, 0x6000
  buffer_store_dwordx4 v[232:235], v3, s[4:7], s86 offen sc1
  v_accvgpr_read_b32 v15, a132
  v_accvgpr_read_b32 v12, a133
  v_add_f32 v15, v15, v12
  v_rcp_f32 v12, v15
  v_accvgpr_read_b32 v192, a32
  v_accvgpr_read_b32 v193, a33
  v_accvgpr_read_b32 v194, a34
  v_accvgpr_read_b32 v195, a35
  v_accvgpr_read_b32 v196, a36
  v_accvgpr_read_b32 v197, a37
  v_accvgpr_read_b32 v198, a38
  v_accvgpr_read_b32 v199, a39
  v_mul_f32 v192, v192, v12
  v_mul_f32 v193, v193, v12
  v_mul_f32 v194, v194, v12
  v_mul_f32 v195, v195, v12
  v_mul_f32 v196, v196, v12
  v_mul_f32 v197, v197, v12
  v_mul_f32 v198, v198, v12
  v_mul_f32 v199, v199, v12
  v_cvt_pk_bf16_f32 v200, v192, v193
  v_cvt_pk_bf16_f32 v201, v194, v195
  v_cvt_pk_bf16_f32 v202, v196, v197
  v_cvt_pk_bf16_f32 v203, v198, v199
  s_add_u32 s86, s87, 0x1000
  buffer_store_dwordx4 v[200:203], v3, s[4:7], s86 offen sc1
  v_accvgpr_read_b32 v224, a40
  v_accvgpr_read_b32 v225, a41
  v_accvgpr_read_b32 v226, a42
  v_accvgpr_read_b32 v227, a43
  v_accvgpr_read_b32 v228, a44
  v_accvgpr_read_b32 v229, a45
  v_accvgpr_read_b32 v230, a46
  v_accvgpr_read_b32 v231, a47
  v_mul_f32 v224, v224, v12
  v_mul_f32 v225, v225, v12
  v_mul_f32 v226, v226, v12
  v_mul_f32 v227, v227, v12
  v_mul_f32 v228, v228, v12
  v_mul_f32 v229, v229, v12
  v_mul_f32 v230, v230, v12
  v_mul_f32 v231, v231, v12
  v_cvt_pk_bf16_f32 v232, v224, v225
  v_cvt_pk_bf16_f32 v233, v226, v227
  v_cvt_pk_bf16_f32 v234, v228, v229
  v_cvt_pk_bf16_f32 v235, v230, v231
  s_add_u32 s86, s87, 0x3000
  buffer_store_dwordx4 v[232:235], v3, s[4:7], s86 offen sc1
  v_accvgpr_read_b32 v192, a48
  v_accvgpr_read_b32 v193, a49
  v_accvgpr_read_b32 v194, a50
  v_accvgpr_read_b32 v195, a51
  v_accvgpr_read_b32 v196, a52
  v_accvgpr_read_b32 v197, a53
  v_accvgpr_read_b32 v198, a54
  v_accvgpr_read_b32 v199, a55
  v_mul_f32 v192, v192, v12
  v_mul_f32 v193, v193, v12
  v_mul_f32 v194, v194, v12
  v_mul_f32 v195, v195, v12
  v_mul_f32 v196, v196, v12
  v_mul_f32 v197, v197, v12
  v_mul_f32 v198, v198, v12
  v_mul_f32 v199, v199, v12
  v_cvt_pk_bf16_f32 v200, v192, v193
  v_cvt_pk_bf16_f32 v201, v194, v195
  v_cvt_pk_bf16_f32 v202, v196, v197
  v_cvt_pk_bf16_f32 v203, v198, v199
  s_add_u32 s86, s87, 0x5000
  buffer_store_dwordx4 v[200:203], v3, s[4:7], s86 offen sc1
  v_accvgpr_read_b32 v224, a56
  v_accvgpr_read_b32 v225, a57
  v_accvgpr_read_b32 v226, a58
  v_accvgpr_read_b32 v227, a59
  v_accvgpr_read_b32 v228, a60
  v_accvgpr_read_b32 v229, a61
  v_accvgpr_read_b32 v230, a62
  v_accvgpr_read_b32 v231, a63
  v_mul_f32 v224, v224, v12
  v_mul_f32 v225, v225, v12
  v_mul_f32 v226, v226, v12
  v_mul_f32 v227, v227, v12
  v_mul_f32 v228, v228, v12
  v_mul_f32 v229, v229, v12
  v_mul_f32 v230, v230, v12
  v_mul_f32 v231, v231, v12
  v_cvt_pk_bf16_f32 v232, v224, v225
  v_cvt_pk_bf16_f32 v233, v226, v227
  v_cvt_pk_bf16_f32 v234, v228, v229
  v_cvt_pk_bf16_f32 v235, v230, v231
  s_add_u32 s86, s87, 0x7000
  buffer_store_dwordx4 v[232:235], v3, s[4:7], s86 offen sc1
  v_add_f32 v22, v14, v15
  v_cmp_ngt_f32 vcc, 0x5d800000, v22
  s_nop 2
  s_mov_b64 s[70:71], vcc
  s_xor_b32 s31, s30, 15
  s_sub_u32 s31, s31, s30
  s_sub_u32 s31, s31, 1
  s_lshr_b32 s82, s82, 1
  s_bitcmp1_b32 s82, 0
  s_cselect_b32 s3, 0, s31
  s_cmp_lt_u32 s3, 2
  s_cbranch_scc1 L_ev2
.p2align 6
L_loop2:
  v_mfma_f32_16x16x32_bf16 v[112:115], a[160:163], v[176:179], v[60:63]
  s_waitcnt lgkmcnt(5)
  v_exp_f32 v124, v124
  v_mfma_f32_16x16x32_bf16 v[112:115], a[164:167], v[180:183], v[112:115]
  s_waitcnt lgkmcnt(4)
  v_exp_f32 v125, v125
  v_mfma_f32_16x16x32_bf16 v[112:115], a[168:171], v[184:187], v[112:115]
  s_waitcnt lgkmcnt(3)
  ds_read_b128 a[204:207], v4 offset:27648
  v_cvt_pk_bf16_f32 v222, v124, v125
  v_mfma_f32_16x16x32_bf16 v[112:115], a[172:175], v[188:191], v[112:115]
  s_add_u32 m0, s100, 0
  ds_read_b128 a[196:199], v4 offset:25600
  v_mfma_f32_16x16x32_bf16 v[96:99], a[172:175], v[172:175], v[24:27]
  s_add_u32 s98, s98, 0x8000
  v_exp_f32 v126, v126
  v_mfma_f32_16x16x32_bf16 v[96:99], a[168:171], v[168:171], v[96:99]
  ds_read_b128 a[192:195], v4 offset:24576
  buffer_load_dwordx4 v2, s[24:27], s98 offen offset:0 sc1 lds
  v_mfma_f32_16x16x32_bf16 v[96:99], a[164:167], v[164:167], v[96:99]
  v_exp_f32 v127, v127
  v_mfma_f32_16x16x32_bf16 v[96:99], a[160:163], v[160:163], v[96:99]
  s_waitcnt lgkmcnt(5)
  ds_read_b128 a[208:211], v4 offset:28672
  v_cvt_pk_bf16_f32 v223, v126, v127
  v_mfma_f32_16x16x32_bf16 v[100:103], a[176:179], v[160:163], v[24:27]
  s_waitcnt lgkmcnt(6)
  v_exp_f32 v112, v112
  v_mfma_f32_16x16x32_bf16 v[100:103], a[180:183], v[164:167], v[100:103]
  s_waitcnt lgkmcnt(5)
  v_exp_f32 v113, v113
  v_mfma_f32_16x16x32_bf16 v[100:103], a[184:187], v[168:171], v[100:103]
  s_waitcnt lgkmcnt(4)
  ds_read_b128 a[200:203], v4 offset:26624
  v_cvt_pk_bf16_f32 v248, v112, v113
  v_mfma_f32_16x16x32_bf16 v[100:103], a[188:191], v[172:175], v[100:103]
  ds_read_b128 a[212:215], v4 offset:29696
  v_mfma_f32_16x16x32_bf16 v[116:119], a[188:191], v[188:191], v[60:63]
  ds_read_b128 a[228:231], v5 offset:1024
  buffer_load_dwordx4 v2, s[24:27], s98 offen offset:1024 sc1 lds
  v_mfma_f32_16x16x32_bf16 v[116:119], a[184:187], v[184:187], v[116:119]
  v_exp_f32 v115, v115
  v_mfma_f32_16x16x32_bf16 v[116:119], a[180:183], v[180:183], v[116:119]
  ds_read_b128 a[216:219], v4 offset:30720
  v_exp_f32 v97, v97
  v_mfma_f32_16x16x32_bf16 v[116:119], a[176:179], v[176:179], v[116:119]
  s_waitcnt lgkmcnt(5)
  v_exp_f32 v98, v98
  v_mfma_f32_16x16x32_bf16 v[120:123], a[192:195], v[176:179], v[60:63]
  v_exp_f32 v96, v96
  v_mfma_f32_16x16x32_bf16 v[120:123], a[196:199], v[180:183], v[120:123]
  s_waitcnt lgkmcnt(3)
  ds_read_b128 a[224:227], v5 offset:0
  v_cvt_pk_bf16_f32 v240, v96, v97
  v_mfma_f32_16x16x32_bf16 v[120:123], a[200:203], v[184:187], v[120:123]
  v_exp_f32 v114, v114
  v_mfma_f32_16x16x32_bf16 v[120:123], a[204:207], v[188:191], v[120:123]
  buffer_load_dwordx4 v2, s[24:27], s98 offen offset:2048 sc1 lds
  v_mfma_f32_16x16x32_bf16 v[104:107], a[204:207], v[172:175], v[24:27]
  ds_read_b128 a[220:223], v4 offset:31744
  v_cvt_pk_bf16_f32 v249, v114, v115
  v_mfma_f32_16x16x32_bf16 v[104:107], a[200:203], v[168:171], v[104:107]
  v_exp_f32 v99, v99
  v_mfma_f32_16x16x32_bf16 v[104:107], a[196:199], v[164:167], v[104:107]
  ds_read_b128 a[236:239], v5 offset:3072
  v_cvt_pk_bf16_f32 v241, v98, v99
  v_mfma_f32_16x16x32_bf16 v[104:107], a[192:195], v[160:163], v[104:107]
  v_exp_f32 v100, v100
  v_mfma_f32_16x16x32_bf16 v[108:111], a[208:211], v[160:163], v[24:27]
  s_waitcnt lgkmcnt(5)
  v_exp_f32 v102, v102
  v_mfma_f32_16x16x32_bf16 v[108:111], a[212:215], v[164:167], v[108:111]
  s_waitcnt lgkmcnt(3)
  v_exp_f32 v103, v103
  v_mfma_f32_16x16x32_bf16 v[108:111], a[216:219], v[168:171], v[108:111]
  s_waitcnt lgkmcnt(1)
  buffer_load_dwordx4 v2, s[24:27], s98 offen offset:3072 sc1 lds
  v_mfma_f32_16x16x32_bf16 v[108:111], a[220:223], v[172:175], v[108:111]
  s_add_u32 m0, s101, 16384
  ds_read_b128 a[244:247], v5 offset:5120
  v_cvt_pk_bf16_f32 v243, v102, v103
  v_mfma_f32_16x16x32_bf16 v[124:127], a[220:223], v[188:191], v[60:63]
  s_add_u32 s99, s99, 0x8000
  ds_read_b128 a[240:243], v5 offset:4096
  v_xor_b32 v4, 0x8000, v4
  v_mfma_f32_16x16x32_bf16 v[124:127], a[216:219], v[184:187], v[124:127]
  v_exp_f32 v101, v101
  v_mfma_f32_16x16x32_bf16 v[124:127], a[212:215], v[180:183], v[124:127]
  ds_read_b128 a[232:235], v5 offset:2048
  v_cvt_pk_bf16_f32 v242, v100, v101
  v_mfma_f32_16x16x32_bf16 v[124:127], a[208:211], v[176:179], v[124:127]
  v_exp_f32 v116, v116
  v_smfmac_f32_16x16x64_bf16 a[136:139], a[144:147], v[208:215], v20
  v_smfmac_f32_16x16x64_bf16 a[140:143], a[144:147], v[216:223], v20
  s_waitcnt vmcnt(12)
  v_mfma_f32_16x16x32_bf16 a[96:99], a[224:227], v[216:219], a[96:99]
  s_barrier
  v_mfma_f32_16x16x32_bf16 a[96:99], a[228:231], v[220:223], a[96:99]
  buffer_load_dwordx4 v2, s[24:27], s99 offen offset:0 sc1 lds
  v_mfma_f32_16x16x32_bf16 a[64:67], a[228:231], v[212:215], a[64:67]
  s_xor_b32 s101, s101, 0x8000
  v_exp_f32 v117, v117
  v_mfma_f32_16x16x32_bf16 a[64:67], a[224:227], v[208:211], a[64:67]
  s_waitcnt lgkmcnt(0)
  ds_read_b128 a[248:251], v5 offset:6144
  v_cvt_pk_bf16_f32 v250, v116, v117
  v_mfma_f32_16x16x32_bf16 a[68:71], a[232:235], v[208:211], a[68:71]
  ds_read_b128 a[252:255], v5 offset:7168
  v_mfma_f32_16x16x32_bf16 a[68:71], a[236:239], v[212:215], a[68:71]
  v_exp_f32 v118, v118
  v_mfma_f32_16x16x32_bf16 a[100:103], a[236:239], v[220:223], a[100:103]
  v_exp_f32 v119, v119
  v_mfma_f32_16x16x32_bf16 a[100:103], a[232:235], v[216:219], a[100:103]
  ds_read_b128 a[224:227], v5 offset:8192
  v_exp_f32 v120, v120
  v_mfma_f32_16x16x32_bf16 a[104:107], a[240:243], v[216:219], a[104:107]
  buffer_load_dwordx4 v2, s[24:27], s99 offen offset:1024 sc1 lds
  v_mfma_f32_16x16x32_bf16 a[104:107], a[244:247], v[220:223], a[104:107]
  ds_read_b128 a[228:231], v5 offset:9216
  v_cvt_pk_bf16_f32 v251, v118, v119
  v_mfma_f32_16x16x32_bf16 a[72:75], a[244:247], v[212:215], a[72:75]
  v_exp_f32 v121, v121
  v_mfma_f32_16x16x32_bf16 a[72:75], a[240:243], v[208:211], a[72:75]
  s_waitcnt lgkmcnt(3)
  v_exp_f32 v122, v122
  v_mfma_f32_16x16x32_bf16 a[76:79], a[248:251], v[208:211], a[76:79]
  s_waitcnt lgkmcnt(2)
  ds_read_b128 a[240:243], v5 offset:12288
  v_cvt_pk_bf16_f32 v252, v120, v121
  v_mfma_f32_16x16x32_bf16 a[76:79], a[252:255], v[212:215], a[76:79]
  v_exp_f32 v106, v106
  v_mfma_f32_16x16x32_bf16 a[108:111], a[252:255], v[220:223], a[108:111]
  ds_read_b128 a[232:235], v5 offset:10240
  v_mfma_f32_16x16x32_bf16 a[108:111], a[248:251], v[216:219], a[108:111]
  s_waitcnt lgkmcnt(3)
  ds_read_b128 a[236:239], v5 offset:11264
  v_mfma_f32_16x16x32_bf16 a[112:115], a[224:227], v[216:219], a[112:115]
  s_waitcnt lgkmcnt(3)
  ds_read_b128 a[244:247], v5 offset:13312
  buffer_load_dwordx4 v2, s[24:27], s99 offen offset:2048 sc1 lds
  v_mfma_f32_16x16x32_bf16 a[112:115], a[228:231], v[220:223], a[112:115]
  ds_read_b128 a[248:251], v5 offset:14336
  v_exp_f32 v105, v105
  v_mfma_f32_16x16x32_bf16 a[80:83], a[228:231], v[212:215], a[80:83]
  v_exp_f32 v123, v123
  v_mfma_f32_16x16x32_bf16 a[80:83], a[224:227], v[208:211], a[80:83]
  s_waitcnt lgkmcnt(3)
  ds_read_b128 a[172:175], v4 offset:3072
  v_cvt_pk_bf16_f32 v253, v122, v123
  v_mfma_f32_16x16x32_bf16 a[84:87], a[232:235], v[208:211], a[84:87]
  s_waitcnt lgkmcnt(3)
  v_exp_f32 v104, v104
  v_mfma_f32_16x16x32_bf16 a[84:87], a[236:239], v[212:215], a[84:87]
  v_exp_f32 v108, v108
  v_mfma_f32_16x16x32_bf16 a[116:119], a[236:239], v[220:223], a[116:119]
  ds_read_b128 a[252:255], v5 offset:15360
  v_exp_f32 v107, v107
  v_mfma_f32_16x16x32_bf16 a[116:119], a[232:235], v[216:219], a[116:119]
  ds_read_b128 a[160:163], v4 offset:0
  v_cvt_pk_bf16_f32 v245, v106, v107
  v_mfma_f32_16x16x32_bf16 a[120:123], a[240:243], v[216:219], a[120:123]
  s_waitcnt lgkmcnt(4)
  ds_read_b128 a[164:167], v4 offset:1024
  buffer_load_dwordx4 v2, s[24:27], s99 offen offset:3072 sc1 lds
  v_mfma_f32_16x16x32_bf16 a[120:123], a[244:247], v[220:223], a[120:123]
  ds_read_b128 a[168:171], v4 offset:2048
  v_exp_f32 v109, v109
  v_mfma_f32_16x16x32_bf16 a[88:91], a[244:247], v[212:215], a[88:91]
  v_exp_f32 v110, v110
  v_mfma_f32_16x16x32_bf16 a[88:91], a[240:243], v[208:211], a[88:91]
  s_waitcnt lgkmcnt(5)
  ds_read_b128 a[176:179], v4 offset:4096
  v_cvt_pk_bf16_f32 v244, v104, v105
  v_mfma_f32_16x16x32_bf16 a[92:95], a[248:251], v[208:211], a[92:95]
  s_waitcnt lgkmcnt(4)
  v_exp_f32 v111, v111
  v_mfma_f32_16x16x32_bf16 a[92:95], a[252:255], v[212:215], a[92:95]
  ds_read_b128 a[180:183], v4 offset:5120
  v_cvt_pk_bf16_f32 v246, v108, v109
  v_mfma_f32_16x16x32_bf16 a[124:127], a[252:255], v[220:223], a[124:127]
  ds_read_b128 a[184:187], v4 offset:6144
  v_cvt_pk_bf16_f32 v247, v110, v111
  v_mfma_f32_16x16x32_bf16 a[124:127], a[248:251], v[216:219], a[124:127]
  s_waitcnt lgkmcnt(5)
  ds_read_b128 a[188:191], v4 offset:7168
  v_mfma_f32_16x16x32_bf16 v[112:115], a[160:163], v[176:179], v[60:63]
  s_waitcnt lgkmcnt(5)
  ds_read_b128 a[192:195], v4 offset:8192
  v_mfma_f32_16x16x32_bf16 v[112:115], a[164:167], v[180:183], v[112:115]
  s_waitcnt lgkmcnt(5)
  ds_read_b128 a[196:199], v4 offset:9216
  v_exp_f32 v125, v125
  v_mfma_f32_16x16x32_bf16 v[112:115], a[168:171], v[184:187], v[112:115]
  ds_read_b128 a[200:203], v4 offset:10240
  v_mfma_f32_16x16x32_bf16 v[112:115], a[172:175], v[188:191], v[112:115]
  s_add_u32 m0, s100, 16384
  ds_read_b128 a[204:207], v4 offset:11264
  v_exp_f32 v124, v124
  v_mfma_f32_16x16x32_bf16 v[96:99], a[172:175], v[172:175], v[40:43]
  s_add_u32 s98, s98, 0x8000
  v_exp_f32 v127, v127
  v_mfma_f32_16x16x32_bf16 v[96:99], a[168:171], v[168:171], v[96:99]
  buffer_load_dwordx4 v2, s[24:27], s98 offen offset:0 sc1 lds
  v_mfma_f32_16x16x32_bf16 v[96:99], a[164:167], v[164:167], v[96:99]
  s_xor_b32 s100, s100, 0x8000
  ds_read_b128 a[208:211], v4 offset:12288
  v_cvt_pk_bf16_f32 v254, v124, v125
  v_mfma_f32_16x16x32_bf16 v[96:99], a[160:163], v[160:163], v[96:99]
  s_waitcnt lgkmcnt(8)
  v_exp_f32 v115, v115
  v_mfma_f32_16x16x32_bf16 v[100:103], a[176:179], v[160:163], v[44:47]
  s_waitcnt lgkmcnt(7)
  v_exp_f32 v126, v126
  v_mfma_f32_16x16x32_bf16 v[100:103], a[180:183], v[164:167], v[100:103]
  s_waitcnt lgkmcnt(6)
  ds_read_b128 a[212:215], v4 offset:13312
  v_cvt_pk_bf16_f32 v255, v126, v127
  v_mfma_f32_16x16x32_bf16 v[100:103], a[184:187], v[168:171], v[100:103]
  s_waitcnt lgkmcnt(6)
  v_exp_f32 v112, v112
  v_mfma_f32_16x16x32_bf16 v[100:103], a[188:191], v[172:175], v[100:103]
  v_exp_f32 v96, v96
  v_mfma_f32_16x16x32_bf16 v[116:119], a[188:191], v[188:191], v[60:63]
  buffer_load_dwordx4 v2, s[24:27], s98 offen offset:1024 sc1 lds
  v_mfma_f32_16x16x32_bf16 v[116:119], a[184:187], v[184:187], v[116:119]
  v_exp_f32 v98, v98
  v_mfma_f32_16x16x32_bf16 v[116:119], a[180:183], v[180:183], v[116:119]
  v_exp_f32 v113, v113
  v_mfma_f32_16x16x32_bf16 v[116:119], a[176:179], v[176:179], v[116:119]
  s_waitcnt lgkmcnt(5)
  ds_read_b128 a[224:227], v5 offset:16384
  v_cvt_pk_bf16_f32 v216, v112, v113
  v_mfma_f32_16x16x32_bf16 v[120:123], a[192:195], v[176:179], v[60:63]
  s_waitcnt lgkmcnt(5)
  ds_read_b128 a[228:231], v5 offset:17408
  v_exp_f32 v114, v114
  v_mfma_f32_16x16x32_bf16 v[120:123], a[196:199], v[180:183], v[120:123]
  s_waitcnt lgkmcnt(5)
  ds_read_b128 a[216:219], v4 offset:14336
  v_cvt_pk_bf16_f32 v217, v114, v115
  v_mfma_f32_16x16x32_bf16 v[120:123], a[200:203], v[184:187], v[120:123]
  s_waitcnt lgkmcnt(5)
  v_exp_f32 v99, v99
  v_mfma_f32_16x16x32_bf16 v[120:123], a[204:207], v[188:191], v[120:123]
  buffer_load_dwordx4 v2, s[24:27], s98 offen offset:2048 sc1 lds
  v_mfma_f32_16x16x32_bf16 v[104:107], a[204:207], v[172:175], v[48:51]
  ds_read_b128 a[220:223], v4 offset:15360
  v_cvt_pk_bf16_f32 v209, v98, v99
  v_mfma_f32_16x16x32_bf16 v[104:107], a[200:203], v[168:171], v[104:107]
  ds_read_b128 a[236:239], v5 offset:19456
  v_mfma_f32_16x16x32_bf16 v[104:107], a[196:199], v[164:167], v[104:107]
  ds_read_b128 a[248:251], v5 offset:22528
  v_exp_f32 v97, v97
  v_mfma_f32_16x16x32_bf16 v[104:107], a[192:195], v[160:163], v[104:107]
  s_waitcnt lgkmcnt(7)
  ds_read_b128 a[244:247], v5 offset:21504
  v_cvt_pk_bf16_f32 v208, v96, v97
  v_mfma_f32_16x16x32_bf16 v[108:111], a[208:211], v[160:163], v[52:55]
  s_waitcnt lgkmcnt(7)
  v_exp_f32 v101, v101
  v_mfma_f32_16x16x32_bf16 v[108:111], a[212:215], v[164:167], v[108:111]
  s_waitcnt lgkmcnt(4)
  ds_read_b128 a[240:243], v5 offset:20480
  v_exp_f32 v100, v100
  v_mfma_f32_16x16x32_bf16 v[108:111], a[216:219], v[168:171], v[108:111]
  s_waitcnt lgkmcnt(4)
  buffer_load_dwordx4 v2, s[24:27], s98 offen offset:3072 sc1 lds
  v_mfma_f32_16x16x32_bf16 v[108:111], a[220:223], v[172:175], v[108:111]
  s_add_u32 m0, s101, 0
  ds_read_b128 a[232:235], v5 offset:18432
  v_cvt_pk_bf16_f32 v210, v100, v101
  v_mfma_f32_16x16x32_bf16 v[124:127], a[220:223], v[188:191], v[60:63]
  s_add_u32 s99, s99, 0x8000
  v_exp_f32 v102, v102
  v_mfma_f32_16x16x32_bf16 v[124:127], a[216:219], v[184:187], v[124:127]
  v_exp_f32 v117, v117
  v_mfma_f32_16x16x32_bf16 v[124:127], a[212:215], v[180:183], v[124:127]
  v_exp_f32 v116, v116
  v_mfma_f32_16x16x32_bf16 v[124:127], a[208:211], v[176:179], v[124:127]
  v_exp_f32 v103, v103
  v_smfmac_f32_16x16x64_bf16 a[136:139], a[144:147], v[240:247], v20
  v_cvt_pk_bf16_f32 v211, v102, v103
  v_smfmac_f32_16x16x64_bf16 a[140:143], a[144:147], v[248:255], v20
  s_waitcnt vmcnt(12)
  v_cvt_pk_bf16_f32 v218, v116, v117
  v_mfma_f32_16x16x32_bf16 a[96:99], a[224:227], v[248:251], a[96:99]
  s_barrier
  v_mfma_f32_16x16x32_bf16 a[96:99], a[228:231], v[252:255], a[96:99]
  buffer_load_dwordx4 v2, s[24:27], s99 offen offset:0 sc1 lds
  v_mfma_f32_16x16x32_bf16 a[64:67], a[228:231], v[244:247], a[64:67]
  ds_read_b128 a[252:255], v5 offset:23552
  v_exp_f32 v119, v119
  v_mfma_f32_16x16x32_bf16 a[64:67], a[224:227], v[240:243], a[64:67]
  s_waitcnt lgkmcnt(1)
  v_exp_f32 v120, v120
  v_mfma_f32_16x16x32_bf16 a[68:71], a[232:235], v[240:243], a[68:71]
  ds_read_b128 a[228:231], v5 offset:25600
  v_mfma_f32_16x16x32_bf16 a[68:71], a[236:239], v[244:247], a[68:71]
  v_exp_f32 v118, v118
  v_mfma_f32_16x16x32_bf16 a[100:103], a[236:239], v[252:255], a[100:103]
  ds_read_b128 a[224:227], v5 offset:24576
  v_cvt_pk_bf16_f32 v219, v118, v119
  v_mfma_f32_16x16x32_bf16 a[100:103], a[232:235], v[248:251], a[100:103]
  v_exp_f32 v123, v123
  v_mfma_f32_16x16x32_bf16 a[104:107], a[240:243], v[248:251], a[104:107]
  buffer_load_dwordx4 v2, s[24:27], s99 offen offset:1024 sc1 lds
  v_mfma_f32_16x16x32_bf16 a[104:107], a[244:247], v[252:255], a[104:107]
  v_exp_f32 v104, v104
  v_mfma_f32_16x16x32_bf16 a[72:75], a[244:247], v[244:247], a[72:75]
  s_sub_u32 s31, s31, 1
  ds_read_b128 a[232:235], v5 offset:26624
  v_mfma_f32_16x16x32_bf16 a[72:75], a[240:243], v[240:243], a[72:75]
  v_exp_f32 v122, v122
  v_mfma_f32_16x16x32_bf16 a[76:79], a[248:251], v[240:243], a[76:79]
  s_waitcnt lgkmcnt(3)
  v_exp_f32 v105, v105
  v_mfma_f32_16x16x32_bf16 a[76:79], a[252:255], v[244:247], a[76:79]
  s_lshr_b32 s82, s82, 1
  ds_read_b128 a[236:239], v5 offset:27648
  v_cvt_pk_bf16_f32 v221, v122, v123
  v_mfma_f32_16x16x32_bf16 a[108:111], a[252:255], v[252:255], a[108:111]
  s_bitcmp1_b32 s82, 0
  ds_read_b128 a[240:243], v5 offset:28672
  v_exp_f32 v121, v121
  v_mfma_f32_16x16x32_bf16 a[108:111], a[248:251], v[248:251], a[108:111]
  s_waitcnt lgkmcnt(3)
  buffer_load_dwordx4 v2, s[24:27], s99 offen offset:2048 sc1 lds
  v_mfma_f32_16x16x32_bf16 a[112:115], a[224:227], v[248:251], a[112:115]
  ds_read_b128 a[160:163], v4 offset:16384
  v_cvt_pk_bf16_f32 v220, v120, v121
  v_mfma_f32_16x16x32_bf16 a[112:115], a[228:231], v[252:255], a[112:115]
  s_cselect_b32 s3, 0, s31
  ds_read_b128 a[244:247], v5 offset:29696
  v_exp_f32 v108, v108
  v_mfma_f32_16x16x32_bf16 a[80:83], a[228:231], v[244:247], a[80:83]
  s_cmp_gt_u32 s3, 1
  v_exp_f32 v109, v109
  v_mfma_f32_16x16x32_bf16 a[80:83], a[224:227], v[240:243], a[80:83]
  s_waitcnt lgkmcnt(4)
  ds_read_b128 a[248:251], v5 offset:30720
  v_cvt_pk_bf16_f32 v212, v104, v105
  v_mfma_f32_16x16x32_bf16 a[84:87], a[232:235], v[240:243], a[84:87]
  s_waitcnt lgkmcnt(4)
  v_exp_f32 v110, v110
  v_mfma_f32_16x16x32_bf16 a[84:87], a[236:239], v[244:247], a[84:87]
  ds_read_b128 a[180:183], v4 offset:21504
  v_exp_f32 v106, v106
  v_mfma_f32_16x16x32_bf16 a[116:119], a[236:239], v[252:255], a[116:119]
  buffer_load_dwordx4 v2, s[24:27], s99 offen offset:3072 sc1 lds
  v_mfma_f32_16x16x32_bf16 a[116:119], a[232:235], v[248:251], a[116:119]
  s_waitcnt lgkmcnt(4)
  ds_read_b128 a[252:255], v5 offset:31744
  v_cvt_pk_bf16_f32 v214, v108, v109
  v_mfma_f32_16x16x32_bf16 a[120:123], a[240:243], v[248:251], a[120:123]
  s_waitcnt lgkmcnt(3)
  ds_read_b128 a[164:167], v4 offset:17408
  v_xor_b32 v5, 0x8000, v5
  v_mfma_f32_16x16x32_bf16 a[120:123], a[244:247], v[252:255], a[120:123]
  ds_read_b128 a[168:171], v4 offset:18432
  v_mfma_f32_16x16x32_bf16 a[88:91], a[244:247], v[244:247], a[88:91]
  ds_read_b128 a[172:175], v4 offset:19456
  v_exp_f32 v107, v107
  v_mfma_f32_16x16x32_bf16 a[88:91], a[240:243], v[240:243], a[88:91]
  s_waitcnt lgkmcnt(5)
  ds_read_b128 a[176:179], v4 offset:20480
  v_cvt_pk_bf16_f32 v213, v106, v107
  v_mfma_f32_16x16x32_bf16 a[92:95], a[248:251], v[240:243], a[92:95]
  s_waitcnt lgkmcnt(4)
  v_exp_f32 v111, v111
  v_mfma_f32_16x16x32_bf16 a[92:95], a[252:255], v[244:247], a[92:95]
  ds_read_b128 a[184:187], v4 offset:22528
  v_cvt_pk_bf16_f32 v215, v110, v111
  v_mfma_f32_16x16x32_bf16 a[124:127], a[252:255], v[252:255], a[124:127]
  ds_read_b128 a[188:191], v4 offset:23552
  v_mfma_f32_16x16x32_bf16 a[124:127], a[248:251], v[248:251], a[124:127]
  s_cbranch_scc1 L_loop2
L_ev2:
  s_bitcmp1_b32 s82, 0
  s_cbranch_scc1 L_hook2
L_last2:
  s_cmp_eq_u32 s31, 0
  s_cbranch_scc1 L_after2
  v_cndmask_b32 v40, v13, v40, s[32:33]
  v_cndmask_b32 v41, v13, v41, s[34:35]
  v_cndmask_b32 v42, v13, v42, s[36:37]
  v_cndmask_b32 v43, v13, v43, s[38:39]
  v_cndmask_b32 v44, v13, v44, s[40:41]
  v_cndmask_b32 v45, v13, v45, s[42:43]
  v_cndmask_b32 v46, v13, v46, s[44:45]
  v_cndmask_b32 v47, v13, v47, s[46:47]
  v_cndmask_b32 v48, v13, v48, s[48:49]
  v_cndmask_b32 v49, v13, v49, s[50:51]
  v_cndmask_b32 v50, v13, v50, s[52:53]
  v_cndmask_b32 v51, v13, v51, s[54:55]
  v_cndmask_b32 v52, v13, v52, s[56:57]
  v_cndmask_b32 v53, v13, v53, s[58:59]
  v_cndmask_b32 v54, v13, v54, s[60:61]
  v_cndmask_b32 v55, v13, v55, s[62:63]
  s_branch L_loop2
L_hook2:
  s_cmp_lt_u32 s82, 4
  s_cbranch_scc1 L_hook2_b
  s_cmp_gt_u32 s31, 1
  buffer_store_dword v9, v8, s[20:23], s88 offen offset:4 sc1
  s_cbranch_scc1 L_loop2
  s_branch L_last2
L_hook2_b:
  s_cmp_eq_u32 s82, 1
  s_cbranch_scc1 L_hook2_chk
  s_cmp_gt_u32 s31, 1
  buffer_load_dword v21, v7, s[20:23], 0 offen offset:4 sc1
  s_cbranch_scc1 L_loop2
  s_branch L_last2
L_hook2_chk:
  s_waitcnt vmcnt(8)
  s_mov_b32 s0, 0
L_hook2_loop:
  v_cmp_ne_u32 vcc, 1, v21
  s_nop 2
  s_cbranch_vccz L_hook2_ok
  buffer_load_dword v21, v7, s[20:23], 0 offen offset:4 sc1
  s_add_u32 s0, s0, 1
  s_cmp_lt_u32 s0, 0x200000
  s_waitcnt vmcnt(0)
  s_cbranch_scc1 L_hook2_loop
L_hook2_ok:
  s_cmp_gt_u32 s31, 1
  s_cbranch_scc1 L_loop2
  s_branch L_last2
L_after2:
  v_smfmac_f32_16x16x64_bf16 a[136:139], a[144:147], v[208:215], v20
  ds_read_b128 a[192:195], v4 offset:24576
  ds_read_b128 a[196:199], v4 offset:25600
  ds_read_b128 a[200:203], v4 offset:26624
  ds_read_b128 a[204:207], v4 offset:27648
  ds_read_b128 a[208:211], v4 offset:28672
  ds_read_b128 a[212:215], v4 offset:29696
  ds_read_b128 a[216:219], v4 offset:30720
  ds_read_b128 a[220:223], v4 offset:31744
  v_cndmask_b32 v24, v13, v60, s[32:33]
  v_cndmask_b32 v25, v13, v60, s[34:35]
  v_cndmask_b32 v26, v13, v60, s[36:37]
  v_cndmask_b32 v27, v13, v60, s[38:39]
  v_cndmask_b32 v28, v13, v60, s[40:41]
  v_cndmask_b32 v29, v13, v60, s[42:43]
  v_mfma_f32_16x16x32_bf16 v[112:115], a[160:163], v[176:179], v[24:27]
  s_waitcnt lgkmcnt(13)
  ds_read_b128 a[224:227], v5 offset:0
  v_cndmask_b32 v30, v13, v60, s[44:45]
  v_mfma_f32_16x16x32_bf16 v[112:115], a[164:167], v[180:183], v[112:115]
  s_waitcnt lgkmcnt(13)
  ds_read_b128 a[228:231], v5 offset:1024
  v_cndmask_b32 v31, v13, v60, s[46:47]
  v_mfma_f32_16x16x32_bf16 v[112:115], a[168:171], v[184:187], v[112:115]
  s_waitcnt lgkmcnt(13)
  ds_read_b128 a[232:235], v5 offset:2048
  v_exp_f32 v124, v124
  v_mfma_f32_16x16x32_bf16 v[112:115], a[172:175], v[188:191], v[112:115]
  s_waitcnt lgkmcnt(13)
  ds_read_b128 a[236:239], v5 offset:3072
  v_exp_f32 v125, v125
  v_mfma_f32_16x16x32_bf16 v[116:119], a[176:179], v[176:179], v[28:31]
  ds_read_b128 a[240:243], v5 offset:4096
  v_exp_f32 v126, v126
  v_mfma_f32_16x16x32_bf16 v[116:119], a[180:183], v[180:183], v[116:119]
  ds_read_b128 a[244:247], v5 offset:5120
  v_exp_f32 v127, v127
  s_waitcnt lgkmcnt(15)
  v_mfma_f32_16x16x32_bf16 v[116:119], a[184:187], v[184:187], v[116:119]
  ds_read_b128 a[248:251], v5 offset:6144
  v_cvt_pk_bf16_f32 v222, v124, v125
  s_waitcnt lgkmcnt(15)
  v_mfma_f32_16x16x32_bf16 v[116:119], a[188:191], v[188:191], v[116:119]
  s_waitcnt lgkmcnt(6)
  ds_read_b128 a[252:255], v5 offset:7168
  v_cvt_pk_bf16_f32 v223, v126, v127
  v_mfma_f32_16x16x32_bf16 a[64:67], a[224:227], v[208:211], a[64:67]
  s_mov_b32 m0, s78
  v_cndmask_b32 v32, v13, v60, s[48:49]
  v_cndmask_b32 v33, v13, v60, s[50:51]
  v_smfmac_f32_16x16x64_bf16 a[140:143], a[144:147], v[216:223], v20
  s_waitcnt lgkmcnt(6)
  s_mov_b32 s76, 0
  v_cndmask_b32 v34, v13, v60, s[52:53]
  v_mfma_f32_16x16x32_bf16 a[64:67], a[228:231], v[212:215], a[64:67]
  v_cndmask_b32 v35, v13, v60, s[54:55]
  v_cndmask_b32 v36, v13, v60, s[56:57]
  v_mfma_f32_16x16x32_bf16 a[96:99], a[224:227], v[216:219], a[96:99]
  v_cndmask_b32 v37, v13, v60, s[58:59]
  v_cndmask_b32 v38, v13, v60, s[60:61]
  v_mfma_f32_16x16x32_bf16 v[120:123], a[192:195], v[176:179], v[32:35]
  v_cndmask_b32 v39, v13, v60, s[62:63]
  s_waitcnt vmcnt(0)
  v_mfma_f32_16x16x32_bf16 v[120:123], a[196:199], v[180:183], v[120:123]
  s_barrier
  buffer_load_dwordx4 v71, s[12:15], s76 offen offset:0 sc1 lds
  v_mfma_f32_16x16x32_bf16 v[120:123], a[200:203], v[184:187], v[120:123]
  s_mov_b32 s76, 1024
  ds_read_b128 a[224:227], v5 offset:8192
  v_exp_f32 v112, v112
  v_mfma_f32_16x16x32_bf16 v[120:123], a[204:207], v[188:191], v[120:123]
  ds_read_b128 a[160:163], v5 offset:16384
  v_exp_f32 v113, v113
  v_mfma_f32_16x16x32_bf16 v[124:127], a[208:211], v[176:179], v[36:39]
  ds_read_b128 a[164:167], v5 offset:17408
  v_exp_f32 v114, v114
  v_mfma_f32_16x16x32_bf16 v[124:127], a[212:215], v[180:183], v[124:127]
  buffer_load_dwordx4 v71, s[12:15], s76 offen offset:1024 sc1 lds
  v_mfma_f32_16x16x32_bf16 v[124:127], a[216:219], v[184:187], v[124:127]
L_pad13:
  s_cbranch_execz L_hr1
  s_mov_b32 s76, 2048
  v_exp_f32 v115, v115
  v_mfma_f32_16x16x32_bf16 v[124:127], a[220:223], v[188:191], v[124:127]
  ds_read_b128 a[168:171], v5 offset:18432
  v_cvt_pk_bf16_f32 v248, v112, v113
  v_mfma_f32_16x16x32_bf16 a[96:99], a[228:231], v[220:223], a[96:99]
  s_waitcnt lgkmcnt(9)
  ds_read_b128 a[228:231], v5 offset:9216
  v_cvt_pk_bf16_f32 v249, v114, v115
  v_mfma_f32_16x16x32_bf16 a[68:71], a[232:235], v[208:211], a[68:71]
  s_waitcnt lgkmcnt(9)
  ds_read_b128 a[172:175], v5 offset:19456
  v_exp_f32 v116, v116
  v_mfma_f32_16x16x32_bf16 a[68:71], a[236:239], v[212:215], a[68:71]
  buffer_load_dwordx4 v71, s[12:15], s76 offen offset:2048 sc1 lds
  v_mfma_f32_16x16x32_bf16 a[100:103], a[232:235], v[216:219], a[100:103]
  s_mov_b32 s76, 3072
  ds_read_b128 a[232:235], v5 offset:10240
  v_exp_f32 v117, v117
  v_mfma_f32_16x16x32_bf16 a[100:103], a[236:239], v[220:223], a[100:103]
  s_waitcnt lgkmcnt(10)
  ds_read_b128 a[236:239], v5 offset:11264
  v_exp_f32 v118, v118
  v_mfma_f32_16x16x32_bf16 a[72:75], a[240:243], v[208:211], a[72:75]
  s_waitcnt lgkmcnt(10)
  ds_read_b128 a[176:179], v5 offset:20480
  v_exp_f32 v119, v119
  v_mfma_f32_16x16x32_bf16 a[72:75], a[244:247], v[212:215], a[72:75]
  buffer_load_dwordx4 v71, s[12:15], s76 offen offset:3072 sc1 lds
  v_mfma_f32_16x16x32_bf16 a[104:107], a[240:243], v[216:219], a[104:107]
  s_sub_u32 m0, s78, 1024
  s_mov_b32 s76, 0x100000
  v_cvt_pk_bf16_f32 v250, v116, v117
  v_mfma_f32_16x16x32_bf16 a[104:107], a[244:247], v[220:223], a[104:107]
  s_waitcnt lgkmcnt(10)
  ds_read_b128 a[240:243], v5 offset:12288
  v_cvt_pk_bf16_f32 v251, v118, v119
  v_mfma_f32_16x16x32_bf16 a[76:79], a[248:251], v[208:211], a[76:79]
  s_waitcnt lgkmcnt(10)
  ds_read_b128 a[244:247], v5 offset:13312
  v_exp_f32 v120, v120
  v_mfma_f32_16x16x32_bf16 a[76:79], a[252:255], v[212:215], a[76:79]
  ds_read_b128 a[180:183], v5 offset:21504
  buffer_load_dwordx4 v3, s[12:15], s76 offen lds
  v_mfma_f32_16x16x32_bf16 a[108:111], a[248:251], v[216:219], a[108:111]
  ds_read_b128 a[248:251], v5 offset:14336
  v_exp_f32 v121, v121
  v_mfma_f32_16x16x32_bf16 a[108:111], a[252:255], v[220:223], a[108:111]
  s_waitcnt lgkmcnt(12)
  ds_read_b128 a[252:255], v5 offset:15360
  v_exp_f32 v122, v122
  v_mfma_f32_16x16x32_bf16 a[80:83], a[224:227], v[208:211], a[80:83]
  s_waitcnt lgkmcnt(9)
  ds_read_b128 a[184:187], v5 offset:22528
  v_exp_f32 v123, v123
  v_mfma_f32_16x16x32_bf16 a[80:83], a[228:231], v[212:215], a[80:83]
  ds_read_b128 a[188:191], v5 offset:23552
  v_cvt_pk_bf16_f32 v252, v120, v121
  v_mfma_f32_16x16x32_bf16 a[112:115], a[224:227], v[216:219], a[112:115]
  ds_read_b128 a[192:195], v5 offset:24576
  v_cvt_pk_bf16_f32 v253, v122, v123
  v_mfma_f32_16x16x32_bf16 a[112:115], a[228:231], v[220:223], a[112:115]
  s_waitcnt lgkmcnt(10)
  ds_read_b128 a[196:199], v5 offset:25600
  v_exp_f32 v124, v124
  v_mfma_f32_16x16x32_bf16 a[84:87], a[232:235], v[208:211], a[84:87]
  s_waitcnt lgkmcnt(10)
  ds_read_b128 a[200:203], v5 offset:26624
  v_exp_f32 v125, v125
  v_mfma_f32_16x16x32_bf16 a[84:87], a[236:239], v[212:215], a[84:87]
  ds_read_b128 a[204:207], v5 offset:27648
  v_exp_f32 v126, v126
  v_mfma_f32_16x16x32_bf16 a[116:119], a[232:235], v[216:219], a[116:119]
  ds_read_b128 a[208:211], v5 offset:28672
  v_exp_f32 v127, v127
  v_mfma_f32_16x16x32_bf16 a[116:119], a[236:239], v[220:223], a[116:119]
  s_waitcnt lgkmcnt(11)
  ds_read_b128 a[212:215], v5 offset:29696
  v_cvt_pk_bf16_f32 v254, v124, v125
  v_mfma_f32_16x16x32_bf16 a[88:91], a[240:243], v[208:211], a[88:91]
  s_waitcnt lgkmcnt(11)
  ds_read_b128 a[216:219], v5 offset:30720
  v_cvt_pk_bf16_f32 v255, v126, v127
  v_mfma_f32_16x16x32_bf16 a[88:91], a[244:247], v[212:215], a[88:91]
  ds_read_b128 a[220:223], v5 offset:31744
  ds_read_b128 v[192:195], v75 offset:64
  v_mfma_f32_16x16x32_bf16 a[120:123], a[240:243], v[216:219], a[120:123]
  ds_read_b32 v196, v75 offset:80
  ds_read_b128 v[200:203], v75 offset:1088
  v_mfma_f32_16x16x32_bf16 a[120:123], a[244:247], v[220:223], a[120:123]
  ds_read_b32 v204, v75 offset:1104
  ds_read_b128 v[224:227], v75 offset:2112
  s_waitcnt lgkmcnt(15)
  v_mfma_f32_16x16x32_bf16 a[92:95], a[248:251], v[208:211], a[92:95]
  ds_read_b32 v228, v75 offset:2128
  ds_read_b128 v[232:235], v75 offset:3136
  v_mfma_f32_16x16x32_bf16 a[92:95], a[252:255], v[212:215], a[92:95]
  ds_read_b32 v236, v75 offset:3152
  s_lshl_b32 s87, s30, 20
  v_mfma_f32_16x16x32_bf16 a[124:127], a[248:251], v[216:219], a[124:127]
  s_xor_b32 s87, s87, 0xf00000
  v_accvgpr_read_b32 v14, a136
  v_accvgpr_read_b32 v22, a137
  v_mfma_f32_16x16x32_bf16 a[124:127], a[252:255], v[220:223], a[124:127]
  s_add_u32 s86, s87, 0x0
  v_add_f32 v14, v14, v22
  v_rcp_f32 v22, v14
  v_smfmac_f32_16x16x64_bf16 a[140:143], a[144:147], v[248:255], v20
  s_waitcnt lgkmcnt(7)
  v_alignbit_b32 v96, v193, v192, 16
  v_mfma_f32_16x16x32_bf16 a[96:99], a[160:163], v[248:251], a[96:99]
  v_alignbit_b32 v97, v194, v193, 16
  v_alignbit_b32 v98, v195, v194, 16
  v_mfma_f32_16x16x32_bf16 a[96:99], a[164:167], v[252:255], a[96:99]
  s_waitcnt lgkmcnt(6)
  v_alignbit_b32 v99, v196, v195, 16
  ds_write_b128 v75, v[96:99] offset:4096
  v_mfma_f32_16x16x32_bf16 a[100:103], a[168:171], v[248:251], a[100:103]
  s_waitcnt lgkmcnt(6)
  v_alignbit_b32 v100, v201, v200, 16
  v_alignbit_b32 v101, v202, v201, 16
  v_mfma_f32_16x16x32_bf16 a[100:103], a[172:175], v[252:255], a[100:103]
  s_waitcnt lgkmcnt(5)
  v_alignbit_b32 v102, v203, v202, 16
  v_alignbit_b32 v103, v204, v203, 16
  v_mfma_f32_16x16x32_bf16 a[104:107], a[176:179], v[248:251], a[104:107]
  s_waitcnt lgkmcnt(4)
  v_alignbit_b32 v104, v225, v224, 16
  v_alignbit_b32 v105, v226, v225, 16
  v_mfma_f32_16x16x32_bf16 a[104:107], a[180:183], v[252:255], a[104:107]
  ds_write_b128 v75, v[100:103] offset:5120
  v_alignbit_b32 v106, v227, v226, 16
  v_mfma_f32_16x16x32_bf16 a[108:111], a[184:187], v[248:251], a[108:111]
  s_waitcnt lgkmcnt(4)
  s_waitcnt lgkmcnt(3)
  v_alignbit_b32 v107, v228, v227, 16
  v_alignbit_b32 v108, v233, v232, 16
  v_mfma_f32_16x16x32_bf16 a[108:111], a[188:191], v[252:255], a[108:111]
  v_alignbit_b32 v109, v234, v233, 16
  v_alignbit_b32 v110, v235, v234, 16
  v_mfma_f32_16x16x32_bf16 a[112:115], a[192:195], v[248:251], a[112:115]
  s_waitcnt lgkmcnt(2)
  v_alignbit_b32 v111, v236, v235, 16
  ds_write_b128 v75, v[104:107] offset:6144
  v_mfma_f32_16x16x32_bf16 a[112:115], a[196:199], v[252:255], a[112:115]
  v_accvgpr_read_b32 v40, a64
  v_accvgpr_read_b32 v41, a65
  v_mfma_f32_16x16x32_bf16 a[116:119], a[200:203], v[248:251], a[116:119]
  v_accvgpr_read_b32 v42, a66
  v_accvgpr_read_b32 v43, a67
  v_mfma_f32_16x16x32_bf16 a[116:119], a[204:207], v[252:255], a[116:119]
  v_accvgpr_read_b32 v44, a68
  v_accvgpr_read_b32 v45, a69
  v_mfma_f32_16x16x32_bf16 a[120:123], a[208:211], v[248:251], a[120:123]
  ds_write_b128 v75, v[108:111] offset:7168
  v_accvgpr_read_b32 v46, a70
  v_mfma_f32_16x16x32_bf16 a[120:123], a[212:215], v[252:255], a[120:123]
  ds_read_b128 a[0:3], v72
  v_accvgpr_read_b32 v47, a71
  v_mfma_f32_16x16x32_bf16 a[124:127], a[216:219], v[248:251], a[124:127]
  ds_read2_b32 a[4:5], v64 offset0:128 offset1:129
  v_mul_f32 v40, v40, v22
  v_mfma_f32_16x16x32_bf16 a[124:127], a[220:223], v[252:255], a[124:127]
  ds_read2_b32 a[6:7], v64 offset0:130 offset1:131
  v_mul_f32 v41, v41, v22
  v_mul_f32 v42, v42, v22
  v_mul_f32 v43, v43, v22
  v_mul_f32 v44, v44, v22
  v_mul_f32 v45, v45, v22
  v_mul_f32 v46, v46, v22
  v_mul_f32 v47, v47, v22
  v_cvt_pk_bf16_f32 v48, v40, v41
  v_cvt_pk_bf16_f32 v49, v42, v43
  v_cvt_pk_bf16_f32 v50, v44, v45
  v_cvt_pk_bf16_f32 v51, v46, v47
  buffer_store_dwordx4 v[48:51], v3, s[4:7], s86 offen sc1
  v_accvgpr_read_b32 v24, a72
  v_accvgpr_read_b32 v25, a73
  v_accvgpr_read_b32 v26, a74
  v_accvgpr_read_b32 v27, a75
  v_accvgpr_read_b32 v28, a76
  v_accvgpr_read_b32 v29, a77
  v_accvgpr_read_b32 v30, a78
  v_accvgpr_read_b32 v31, a79
  v_mul_f32 v24, v24, v22
  v_mul_f32 v25, v25, v22
  v_mul_f32 v26, v26, v22
  v_mul_f32 v27, v27, v22
  v_mul_f32 v28, v28, v22
  v_mul_f32 v29, v29, v22
  v_mul_f32 v30, v30, v22
  v_mul_f32 v31, v31, v22
  v_cvt_pk_bf16_f32 v32, v24, v25
  v_cvt_pk_bf16_f32 v33, v26, v27
  v_cvt_pk_bf16_f32 v34, v28, v29
  v_cvt_pk_bf16_f32 v35, v30, v31
  s_add_u32 s86, s87, 0x2000
  buffer_store_dwordx4 v[32:35], v3, s[4:7], s86 offen sc1
  v_accvgpr_read_b32 v40, a80
  v_accvgpr_read_b32 v41, a81
  v_accvgpr_read_b32 v42, a82
  v_accvgpr_read_b32 v43, a83
  v_accvgpr_read_b32 v44, a84
  v_accvgpr_read_b32 v45, a85
  v_accvgpr_read_b32 v46, a86
  v_accvgpr_read_b32 v47, a87
  v_mul_f32 v40, v40, v22
  v_mul_f32 v41, v41, v22
  v_mul_f32 v42, v42, v22
  v_mul_f32 v43, v43, v22
  v_mul_f32 v44, v44, v22
  v_mul_f32 v45, v45, v22
  v_mul_f32 v46, v46, v22
  v_mul_f32 v47, v47, v22
  v_cvt_pk_bf16_f32 v48, v40, v41
  v_cvt_pk_bf16_f32 v49, v42, v43
  v_cvt_pk_bf16_f32 v50, v44, v45
  v_cvt_pk_bf16_f32 v51, v46, v47
  s_add_u32 s86, s87, 0x4000
  buffer_store_dwordx4 v[48:51], v3, s[4:7], s86 offen sc1
  v_accvgpr_read_b32 v24, a88
  v_accvgpr_read_b32 v25, a89
  v_accvgpr_read_b32 v26, a90
  v_accvgpr_read_b32 v27, a91
  v_accvgpr_read_b32 v28, a92
  v_accvgpr_read_b32 v29, a93
  v_accvgpr_read_b32 v30, a94
  v_accvgpr_read_b32 v31, a95
  v_mul_f32 v24, v24, v22
  v_mul_f32 v25, v25, v22
  v_mul_f32 v26, v26, v22
  v_mul_f32 v27, v27, v22
  v_mul_f32 v28, v28, v22
  v_mul_f32 v29, v29, v22
  v_mul_f32 v30, v30, v22
  v_mul_f32 v31, v31, v22
  v_cvt_pk_bf16_f32 v32, v24, v25
  v_cvt_pk_bf16_f32 v33, v26, v27
  v_cvt_pk_bf16_f32 v34, v28, v29
  v_cvt_pk_bf16_f32 v35, v30, v31
  s_add_u32 s86, s87, 0x6000
  buffer_store_dwordx4 v[32:35], v3, s[4:7], s86 offen sc1
  v_accvgpr_read_b32 v15, a140
  v_accvgpr_read_b32 v12, a141
  v_add_f32 v15, v15, v12
  v_rcp_f32 v12, v15
  v_accvgpr_read_b32 v40, a96
  v_accvgpr_read_b32 v41, a97
  v_accvgpr_read_b32 v42, a98
  v_accvgpr_read_b32 v43, a99
  v_accvgpr_read_b32 v44, a100
  v_accvgpr_read_b32 v45, a101
  v_accvgpr_read_b32 v46, a102
  v_accvgpr_read_b32 v47, a103
  v_mul_f32 v40, v40, v12
  v_mul_f32 v41, v41, v12
  v_mul_f32 v42, v42, v12
  v_mul_f32 v43, v43, v12
  v_mul_f32 v44, v44, v12
  v_mul_f32 v45, v45, v12
  v_mul_f32 v46, v46, v12
  v_mul_f32 v47, v47, v12
  v_cvt_pk_bf16_f32 v48, v40, v41
  v_cvt_pk_bf16_f32 v49, v42, v43
  v_cvt_pk_bf16_f32 v50, v44, v45
  v_cvt_pk_bf16_f32 v51, v46, v47
  s_add_u32 s86, s87, 0x1000
  buffer_store_dwordx4 v[48:51], v3, s[4:7], s86 offen sc1
  v_accvgpr_read_b32 v24, a104
  v_accvgpr_read_b32 v25, a105
  v_accvgpr_read_b32 v26, a106
  v_accvgpr_read_b32 v27, a107
  v_accvgpr_read_b32 v28, a108
  v_accvgpr_read_b32 v29, a109
  v_accvgpr_read_b32 v30, a110
  v_accvgpr_read_b32 v31, a111
  v_mul_f32 v24, v24, v12
  v_mul_f32 v25, v25, v12
  v_mul_f32 v26, v26, v12
  v_mul_f32 v27, v27, v12
  v_mul_f32 v28, v28, v12
  v_mul_f32 v29, v29, v12
  v_mul_f32 v30, v30, v12
  v_mul_f32 v31, v31, v12
  v_cvt_pk_bf16_f32 v32, v24, v25
  v_cvt_pk_bf16_f32 v33, v26, v27
  v_cvt_pk_bf16_f32 v34, v28, v29
  v_cvt_pk_bf16_f32 v35, v30, v31
  s_add_u32 s86, s87, 0x3000
  buffer_store_dwordx4 v[32:35], v3, s[4:7], s86 offen sc1
  v_accvgpr_read_b32 v40, a112
  v_accvgpr_read_b32 v41, a113
  v_accvgpr_read_b32 v42, a114
  v_accvgpr_read_b32 v43, a115
  v_accvgpr_read_b32 v44, a116
  v_accvgpr_read_b32 v45, a117
  v_accvgpr_read_b32 v46, a118
  v_accvgpr_read_b32 v47, a119
  v_mul_f32 v40, v40, v12
  v_mul_f32 v41, v41, v12
  v_mul_f32 v42, v42, v12
  v_mul_f32 v43, v43, v12
  v_mul_f32 v44, v44, v12
  v_mul_f32 v45, v45, v12
  v_mul_f32 v46, v46, v12
  v_mul_f32 v47, v47, v12
  v_cvt_pk_bf16_f32 v48, v40, v41
  v_cvt_pk_bf16_f32 v49, v42, v43
  v_cvt_pk_bf16_f32 v50, v44, v45
  v_cvt_pk_bf16_f32 v51, v46, v47
  s_add_u32 s86, s87, 0x5000
  buffer_store_dwordx4 v[48:51], v3, s[4:7], s86 offen sc1
  v_accvgpr_read_b32 v24, a120
  v_accvgpr_read_b32 v25, a121
  v_accvgpr_read_b32 v26, a122
  v_accvgpr_read_b32 v27, a123
  v_accvgpr_read_b32 v28, a124
  v_accvgpr_read_b32 v29, a125
  v_accvgpr_read_b32 v30, a126
  v_accvgpr_read_b32 v31, a127
  v_mul_f32 v24, v24, v12
  v_mul_f32 v25, v25, v12
  v_mul_f32 v26, v26, v12
  v_mul_f32 v27, v27, v12
  v_mul_f32 v28, v28, v12
  v_mul_f32 v29, v29, v12
  v_mul_f32 v30, v30, v12
  v_mul_f32 v31, v31, v12
  v_cvt_pk_bf16_f32 v32, v24, v25
  v_cvt_pk_bf16_f32 v33, v26, v27
  v_cvt_pk_bf16_f32 v34, v28, v29
  v_cvt_pk_bf16_f32 v35, v30, v31
  s_add_u32 s86, s87, 0x7000
  buffer_store_dwordx4 v[32:35], v3, s[4:7], s86 offen sc1
  v_add_f32 v22, v14, v15
  v_cmp_ngt_f32 vcc, 0x5d800000, v22
  s_waitcnt vmcnt(8)
  ds_read_b128 a[32:35], v68 offset:448
  ds_read_b128 a[36:39], v68 offset:960
  ds_read_b128 a[40:43], v68 offset:1472
  ds_read2_b32 a[8:9], v65 offset0:0 offset1:1
  ds_read2_b32 a[10:11], v65 offset0:2 offset1:3
  ds_read_b128 a[44:47], v68 offset:1984
  ds_read2_b32 a[12:13], v65 offset0:128 offset1:129
  ds_read2_b32 a[14:15], v65 offset0:130 offset1:131
  ds_read_b128 a[48:51], v68 offset:2496
  ds_read2_b32 a[16:17], v66 offset0:0 offset1:1
  ds_read2_b32 a[18:19], v66 offset0:2 offset1:3
  ds_read_b128 a[52:55], v68 offset:3008
  ds_read2_b32 a[20:21], v66 offset0:128 offset1:129
  ds_read2_b32 a[22:23], v66 offset0:130 offset1:131
  ds_read_b128 a[56:59], v68 offset:3520
  ds_read2_b32 a[24:25], v67 offset0:0 offset1:1
  ds_read2_b32 a[26:27], v67 offset0:2 offset1:3
  ds_read_b128 a[60:63], v68 offset:4032
  ds_read2_b32 a[28:29], v67 offset0:128 offset1:129
  ds_read2_b32 a[30:31], v67 offset0:130 offset1:131
  s_or_b64 vcc, vcc, s[70:71]
  s_cbranch_scc1 L_slow
L_slow_ret:
  s_waitcnt lgkmcnt(15)
  v_mfma_f32_16x16x32_bf16 v[96:99], v[56:59], a[32:35], 0
  s_and_b32 s8, s2, 3
  s_and_b32 s3, s2, 4
  ds_read_b128 a[96:99], v68 offset:384
  v_mfma_f32_16x16x32_bf16 v[96:99], a[0:3], a[32:35], v[96:99]
  s_lshr_b32 s31, s2, 6
  s_add_u32 s3, s3, s31
  ds_read2_b32 a[64:65], v64 offset0:16 offset1:17
  v_mfma_f32_16x16x32_bf16 v[100:103], v[56:59], a[36:39], 0
  s_lshl_b32 s3, s3, 1
  s_lshr_b32 s77, s28, 1
  ds_read2_b32 a[66:67], v64 offset0:18 offset1:19
  v_mfma_f32_16x16x32_bf16 v[100:103], a[4:7], a[32:35], v[100:103]
  s_add_u32 s38, s3, s77
  s_xor_b32 s3, s30, 5
  v_mfma_f32_16x16x32_bf16 v[100:103], a[0:3], a[36:39], v[100:103]
  s_lshr_b32 s39, s3, 1
  s_and_b32 s3, s3, 1
  ds_read_b128 a[100:103], v68 offset:896
  v_mfma_f32_16x16x32_bf16 v[104:107], v[56:59], a[40:43], 0
  s_lshl_b32 s3, s3, 2
  s_or_b32 s39, s39, s3
  ds_read2_b32 a[68:69], v64 offset0:144 offset1:145
  v_mfma_f32_16x16x32_bf16 v[104:107], a[0:3], a[40:43], v[104:107]
  s_add_u32 s31, s31, s39
  s_and_b32 s31, s31, 1
  ds_read2_b32 a[70:71], v64 offset0:146 offset1:147
  v_mfma_f32_16x16x32_bf16 v[104:107], a[4:7], a[36:39], v[104:107]
  s_lshl_b32 s100, s31, 17
  s_lshl_b32 s101, s31, 14
  v_mfma_f32_16x16x32_bf16 v[104:107], a[8:11], a[32:35], v[104:107]
  s_and_b32 s3, s2, 1
  s_mul_i32 s3, s3, 0
  ds_read_b128 a[104:107], v68 offset:1408
  s_waitcnt lgkmcnt(15)
  v_mfma_f32_16x16x32_bf16 v[108:111], v[56:59], a[44:47], 0
  s_lshl_b32 s14, s8, 4
  s_add_u32 s14, s14, s3
  ds_read2_b32 a[72:73], v65 offset0:16 offset1:17
  v_mfma_f32_16x16x32_bf16 v[108:111], a[12:15], a[32:35], v[108:111]
  s_lshl_b32 s3, s14, 17
  s_lshl_b32 s31, s28, 15
  ds_read2_b32 a[74:75], v65 offset0:18 offset1:19
  v_mfma_f32_16x16x32_bf16 v[108:111], a[8:11], a[36:39], v[108:111]
  s_add_u32 s3, s3, s31
  s_lshl_b32 s31, s39, 8
  v_mfma_f32_16x16x32_bf16 v[108:111], a[4:7], a[40:43], v[108:111]
  s_add_u32 s3, s3, s31
  s_sub_u32 s31, 0x800000, s3
  ds_read_b128 a[108:111], v68 offset:1920
  v_mfma_f32_16x16x32_bf16 v[108:111], a[0:3], a[44:47], v[108:111]
  s_add_u32 s44, s74, s3
  s_addc_u32 s45, s75, 0
  ds_read2_b32 a[76:77], v65 offset0:144 offset1:145
  v_mfma_f32_16x16x32_bf16 v[112:115], v[56:59], a[48:51], 0
  s_mov_b32 s46, s31
  s_mov_b32 s47, 0x20000
  ds_read2_b32 a[78:79], v65 offset0:146 offset1:147
  v_mfma_f32_16x16x32_bf16 v[112:115], a[0:3], a[48:51], v[112:115]
  s_lshl_b32 s37, s28, 12
  v_lshrrev_b32 v16, 4, v1
  v_and_b32 v17, 15, v1
  v_mfma_f32_16x16x32_bf16 v[112:115], a[4:7], a[44:47], v[112:115]
  ds_read_b128 a[112:115], v68 offset:2432
  v_lshlrev_b32 v18, 1, v16
  v_mfma_f32_16x16x32_bf16 v[112:115], a[8:11], a[40:43], v[112:115]
  ds_read2_b32 a[80:81], v66 offset0:16 offset1:17
  v_xor_b32 v18, v17, v18
  v_mfma_f32_16x16x32_bf16 v[112:115], a[12:15], a[36:39], v[112:115]
  ds_read2_b32 a[82:83], v66 offset0:18 offset1:19
  v_lshlrev_b32 v18, 4, v18
  v_mfma_f32_16x16x32_bf16 v[112:115], a[16:19], a[32:35], v[112:115]
  v_lshl_add_u32 v24, v16, 11, v18
  v_xor_b32 v25, 0x80, v24
  v_mfma_f32_16x16x32_bf16 v[116:119], v[56:59], a[52:55], 0
  ds_read_b128 a[116:119], v68 offset:2944
  v_add_u32 v25, 0x1c00, v25
  s_waitcnt lgkmcnt(15)
  v_mfma_f32_16x16x32_bf16 v[116:119], a[20:23], a[32:35], v[116:119]
  ds_read2_b32 a[84:85], v66 offset0:144 offset1:145
  v_add_u32 v26, 0x3800, v24
  v_mfma_f32_16x16x32_bf16 v[116:119], a[16:19], a[36:39], v[116:119]
  ds_read2_b32 a[86:87], v66 offset0:146 offset1:147
  v_add_u32 v27, 0x3800, v25
  v_mfma_f32_16x16x32_bf16 v[116:119], a[12:15], a[40:43], v[116:119]
  v_mfma_f32_16x16x32_bf16 v[116:119], a[8:11], a[44:47], v[116:119]
  ds_read_b128 a[120:123], v68 offset:3456
  v_mfma_f32_16x16x32_bf16 v[116:119], a[4:7], a[48:51], v[116:119]
  ds_read2_b32 a[88:89], v67 offset0:16 offset1:17
  v_mfma_f32_16x16x32_bf16 v[116:119], a[0:3], a[52:55], v[116:119]
  ds_read2_b32 a[90:91], v67 offset0:18 offset1:19
  v_mfma_f32_16x16x32_bf16 v[120:123], v[56:59], a[56:59], 0
  v_mfma_f32_16x16x32_bf16 v[120:123], a[0:3], a[56:59], v[120:123]
  ds_read_b128 a[124:127], v68 offset:3968
  v_mfma_f32_16x16x32_bf16 v[120:123], a[4:7], a[52:55], v[120:123]
  ds_read2_b32 a[92:93], v67 offset0:144 offset1:145
  v_mfma_f32_16x16x32_bf16 v[120:123], a[8:11], a[48:51], v[120:123]
  ds_read2_b32 a[94:95], v67 offset0:146 offset1:147
  v_mfma_f32_16x16x32_bf16 v[120:123], a[12:15], a[44:47], v[120:123]
  v_mfma_f32_16x16x32_bf16 v[120:123], a[16:19], a[40:43], v[120:123]
  v_mfma_f32_16x16x32_bf16 v[120:123], a[20:23], a[36:39], v[120:123]
  v_mfma_f32_16x16x32_bf16 v[120:123], a[24:27], a[32:35], v[120:123]
  v_mfma_f32_16x16x32_bf16 v[124:127], v[56:59], a[60:63], 0
  v_mfma_f32_16x16x32_bf16 v[124:127], a[28:31], a[32:35], v[124:127]
  v_mfma_f32_16x16x32_bf16 v[124:127], a[24:27], a[36:39], v[124:127]
  v_mfma_f32_16x16x32_bf16 v[124:127], a[20:23], a[40:43], v[124:127]
  v_mfma_f32_16x16x32_bf16 v[124:127], a[16:19], a[44:47], v[124:127]
  v_mfma_f32_16x16x32_bf16 v[124:127], a[12:15], a[48:51], v[124:127]
  v_mfma_f32_16x16x32_bf16 v[124:127], a[8:11], a[52:55], v[124:127]
  v_mfma_f32_16x16x32_bf16 v[124:127], a[4:7], a[56:59], v[124:127]
  v_mfma_f32_16x16x32_bf16 v[124:127], a[0:3], a[60:63], v[124:127]
  s_waitcnt vmcnt(0) lgkmcnt(15)
  v_mfma_f32_16x16x32_bf16 v[96:99], a[64:67], a[96:99], v[96:99]
  s_barrier
  v_mfma_f32_16x16x32_bf16 v[100:103], a[68:71], a[96:99], v[100:103]
  buffer_store_dword v9, v8, s[20:23], s88 offen offset:8 sc1
  v_mfma_f32_16x16x32_bf16 v[100:103], a[64:67], a[100:103], v[100:103]
  s_xor_b32 s32, s100, 0x0
  s_and_b32 s97, s28, 1
  ds_read_b128 a[32:35], v68 offset:320
  v_mfma_f32_16x16x32_bf16 v[104:107], a[64:67], a[104:107], v[104:107]
  s_add_u32 m0, s37, 0
  s_lshl_b32 s3, s38, 20
  ds_read2_b32 a[0:1], v64 offset0:32 offset1:33
  v_mfma_f32_16x16x32_bf16 v[104:107], a[68:71], a[100:103], v[104:107]
  s_lshl_b32 s31, s14, 14
  buffer_load_dwordx4 v24, s[44:47], s32 offen offset:0  lds
  v_mfma_f32_16x16x32_bf16 v[104:107], a[72:75], a[96:99], v[104:107]
  s_add_u32 s3, s3, s31
  ds_read2_b32 a[2:3], v64 offset0:34 offset1:35
  s_waitcnt lgkmcnt(15)
  v_mfma_f32_16x16x32_bf16 v[108:111], a[76:79], a[96:99], v[108:111]
  s_lshl_b32 s31, s97, 12
  ds_read_b128 a[36:39], v68 offset:832
  v_mfma_f32_16x16x32_bf16 v[108:111], a[72:75], a[100:103], v[108:111]
  s_add_u32 s3, s3, s31
  buffer_load_dwordx4 v25, s[44:47], s32 offen offset:1024  lds
  v_mfma_f32_16x16x32_bf16 v[108:111], a[68:71], a[104:107], v[108:111]
  s_add_u32 s40, s94, s3
  s_addc_u32 s41, s95, 0
  ds_read2_b32 a[4:5], v64 offset0:160 offset1:161
  v_mfma_f32_16x16x32_bf16 v[108:111], a[64:67], a[108:111], v[108:111]
  s_add_u32 s40, s40, 0x2000000
  s_addc_u32 s41, s41, 0
  ds_read2_b32 a[6:7], v64 offset0:162 offset1:163
  s_waitcnt lgkmcnt(15)
  v_mfma_f32_16x16x32_bf16 v[112:115], a[64:67], a[112:115], v[112:115]
  s_mov_b32 s42, 0x3f000
  ds_read_b128 a[40:43], v68 offset:1344
  v_mfma_f32_16x16x32_bf16 v[112:115], a[68:71], a[108:111], v[112:115]
  s_mov_b32 s43, 0x20000
  ds_read2_b32 a[8:9], v65 offset0:32 offset1:33
  v_mfma_f32_16x16x32_bf16 v[112:115], a[72:75], a[104:107], v[112:115]
  s_xor_b32 s3, s38, 15
  buffer_load_dwordx4 v26, s[44:47], s32 offen offset:2048  lds
  v_mfma_f32_16x16x32_bf16 v[112:115], a[76:79], a[100:103], v[112:115]
  s_min_u32 s3, s3, s38
  ds_read2_b32 a[10:11], v65 offset0:34 offset1:35
  v_mfma_f32_16x16x32_bf16 v[112:115], a[80:83], a[96:99], v[112:115]
  s_lshl_b32 s3, s3, 7
  ds_read_b128 a[44:47], v68 offset:1856
  s_waitcnt lgkmcnt(15)
  v_mfma_f32_16x16x32_bf16 v[116:119], a[84:87], a[96:99], v[116:119]
  s_lshl_b32 s31, s8, 13
  ds_read2_b32 a[12:13], v65 offset0:160 offset1:161
  v_mfma_f32_16x16x32_bf16 v[116:119], a[80:83], a[100:103], v[116:119]
  s_add_u32 s3, s3, s31
  ds_read2_b32 a[14:15], v65 offset0:162 offset1:163
  v_mfma_f32_16x16x32_bf16 v[116:119], a[76:79], a[104:107], v[116:119]
  s_add_u32 s3, s3, 524288
  buffer_load_dwordx4 v27, s[44:47], s32 offen offset:3072  lds
  v_mfma_f32_16x16x32_bf16 v[116:119], a[72:75], a[108:111], v[116:119]
  s_xor_b32 s32, s100, 0x20000
  s_and_b32 s31, s2, 1
  ds_read_b128 a[48:51], v68 offset:2368
  v_mfma_f32_16x16x32_bf16 v[116:119], a[68:71], a[112:115], v[116:119]
  s_add_u32 m0, s37, 16384
  s_mul_i32 s31, s31, 0
  ds_read2_b32 a[16:17], v66 offset0:32 offset1:33
  v_mfma_f32_16x16x32_bf16 v[116:119], a[64:67], a[116:119], v[116:119]
  s_sub_u32 s31, 7, s31
  ds_read2_b32 a[18:19], v66 offset0:34 offset1:35
  v_mfma_f32_16x16x32_bf16 v[120:123], a[64:67], a[120:123], v[120:123]
  ds_read_b128 a[52:55], v68 offset:2880
  v_min_u32 v18, s31, v1
  v_mfma_f32_16x16x32_bf16 v[120:123], a[68:71], a[116:119], v[120:123]
  buffer_load_dwordx4 v24, s[44:47], s32 offen offset:0  lds
  v_mfma_f32_16x16x32_bf16 v[120:123], a[72:75], a[112:115], v[120:123]
  ds_read2_b32 a[20:21], v66 offset0:160 offset1:161
  v_lshlrev_b32 v6, 10, v18
  v_mfma_f32_16x16x32_bf16 v[120:123], a[76:79], a[108:111], v[120:123]
  ds_read2_b32 a[22:23], v66 offset0:162 offset1:163
  v_add_u32 v6, s3, v6
  v_mfma_f32_16x16x32_bf16 v[120:123], a[80:83], a[104:107], v[120:123]
  s_and_b32 s3, s8, 2
  ds_read_b128 a[56:59], v68 offset:3392
  v_mfma_f32_16x16x32_bf16 v[120:123], a[84:87], a[100:103], v[120:123]
  s_lshl_b32 s3, s3, 10
  ds_read2_b32 a[24:25], v67 offset0:32 offset1:33
  s_waitcnt lgkmcnt(15)
  v_mfma_f32_16x16x32_bf16 v[120:123], a[88:91], a[96:99], v[120:123]
  buffer_load_dwordx4 v25, s[44:47], s32 offen offset:1024  lds
  v_mfma_f32_16x16x32_bf16 v[124:127], a[92:95], a[96:99], v[124:127]
  ds_read2_b32 a[26:27], v67 offset0:34 offset1:35
  v_add_u32 v60, s3, v3
  v_mfma_f32_16x16x32_bf16 v[124:127], a[88:91], a[100:103], v[124:127]
  ds_read_b128 a[60:63], v68 offset:3904
  v_xor_b32 v61, 0x800, v60
  v_mfma_f32_16x16x32_bf16 v[124:127], a[84:87], a[104:107], v[124:127]
  ds_read2_b32 a[28:29], v67 offset0:160 offset1:161
  v_bfe_u32 v18, v1, 2, 2
  v_mfma_f32_16x16x32_bf16 v[124:127], a[80:83], a[108:111], v[124:127]
  ds_read2_b32 a[30:31], v67 offset0:162 offset1:163
  v_lshl_add_u32 v18, v16, 2, v18
  v_mfma_f32_16x16x32_bf16 v[124:127], a[76:79], a[112:115], v[124:127]
  buffer_load_dwordx4 v26, s[44:47], s32 offen offset:2048  lds
  v_mfma_f32_16x16x32_bf16 v[124:127], a[72:75], a[116:119], v[124:127]
  v_and_b32 v19, 7, v18
  v_mfma_f32_16x16x32_bf16 v[124:127], a[68:71], a[120:123], v[124:127]
  v_lshlrev_b32 v18, 8, v18
  v_mfma_f32_16x16x32_bf16 v[124:127], a[64:67], a[124:127], v[124:127]
  v_lshl_add_u32 v18, v19, 5, v18
  v_mfma_f32_16x16x32_bf16 v[96:99], a[0:3], a[32:35], v[96:99]
  ds_read_b128 a[96:99], v68 offset:256
  v_and_b32 v19, 3, v1
  s_waitcnt lgkmcnt(15)
  v_mfma_f32_16x16x32_bf16 v[100:103], a[4:7], a[32:35], v[100:103]
  buffer_load_dwordx4 v27, s[44:47], s32 offen offset:3072  lds
  v_mfma_f32_16x16x32_bf16 v[100:103], a[0:3], a[36:39], v[100:103]
  s_xor_b32 s32, s100, 0x40000
  ds_read2_b32 a[64:65], v64 offset0:48 offset1:49
  v_lshl_add_u32 v18, v19, 3, v18
  v_mfma_f32_16x16x32_bf16 v[104:107], a[0:3], a[40:43], v[104:107]
  s_add_u32 m0, s37, 32768
  s_and_b32 s3, s2, 1
  ds_read2_b32 a[66:67], v64 offset0:50 offset1:51
  v_mfma_f32_16x16x32_bf16 v[104:107], a[4:7], a[36:39], v[104:107]
  s_lshl_b32 s3, s3, 7
  ds_read_b128 a[100:103], v68 offset:768
  v_mfma_f32_16x16x32_bf16 v[104:107], a[8:11], a[32:35], v[104:107]
  ds_read2_b32 a[68:69], v64 offset0:176 offset1:177
  v_xor_b32 v28, s3, v18
  s_waitcnt lgkmcnt(15)
  v_mfma_f32_16x16x32_bf16 v[108:111], a[12:15], a[32:35], v[108:111]
L_pad14:
  s_cbranch_execz L_hr1
  buffer_load_dwordx4 v24, s[44:47], s32 offen offset:0  lds
  v_mfma_f32_16x16x32_bf16 v[108:111], a[8:11], a[36:39], v[108:111]
  ds_read2_b32 a[70:71], v64 offset0:178 offset1:179
  v_xor_b32 v29, 32, v28
  v_mfma_f32_16x16x32_bf16 v[108:111], a[4:7], a[40:43], v[108:111]
  ds_read_b128 a[104:107], v68 offset:1280
  v_xor_b32 v30, 64, v28
  v_mfma_f32_16x16x32_bf16 v[108:111], a[0:3], a[44:47], v[108:111]
  ds_read2_b32 a[72:73], v65 offset0:48 offset1:49
  v_xor_b32 v31, 96, v28
  v_mfma_f32_16x16x32_bf16 v[112:115], a[0:3], a[48:51], v[112:115]
  ds_read2_b32 a[74:75], v65 offset0:50 offset1:51
  v_xor_b32 v32, 128, v28
  v_mfma_f32_16x16x32_bf16 v[112:115], a[4:7], a[44:47], v[112:115]
  buffer_load_dwordx4 v25, s[44:47], s32 offen offset:1024  lds
  v_mfma_f32_16x16x32_bf16 v[112:115], a[8:11], a[40:43], v[112:115]
  ds_read_b128 a[108:111], v68 offset:1792
  v_xor_b32 v33, 160, v28
  v_mfma_f32_16x16x32_bf16 v[112:115], a[12:15], a[36:39], v[112:115]
  ds_read2_b32 a[76:77], v65 offset0:176 offset1:177
  v_xor_b32 v34, 192, v28
  s_waitcnt lgkmcnt(15)
  v_mfma_f32_16x16x32_bf16 v[112:115], a[16:19], a[32:35], v[112:115]
  ds_read2_b32 a[78:79], v65 offset0:178 offset1:179
  v_xor_b32 v35, 224, v28
  v_mfma_f32_16x16x32_bf16 v[116:119], a[20:23], a[32:35], v[116:119]
  v_add_u32 v36, 0x10000, v28
  v_mfma_f32_16x16x32_bf16 v[116:119], a[16:19], a[36:39], v[116:119]
  buffer_load_dwordx4 v26, s[44:47], s32 offen offset:2048  lds
  v_mfma_f32_16x16x32_bf16 v[116:119], a[12:15], a[40:43], v[116:119]
  ds_read_b128 a[112:115], v68 offset:2304
  v_add_u32 v37, 0x10000, v29
  v_mfma_f32_16x16x32_bf16 v[116:119], a[8:11], a[44:47], v[116:119]
  ds_read2_b32 a[80:81], v66 offset0:48 offset1:49
  v_add_u32 v38, 0x10000, v30
  v_mfma_f32_16x16x32_bf16 v[116:119], a[4:7], a[48:51], v[116:119]
  ds_read2_b32 a[82:83], v66 offset0:50 offset1:51
  v_add_u32 v39, 0x10000, v31
  v_mfma_f32_16x16x32_bf16 v[116:119], a[0:3], a[52:55], v[116:119]
  ds_read_b128 a[116:119], v68 offset:2816
  v_add_u32 v40, 0x10000, v32
  v_mfma_f32_16x16x32_bf16 v[120:123], a[0:3], a[56:59], v[120:123]
  buffer_load_dwordx4 v27, s[44:47], s32 offen offset:3072  lds
  v_mfma_f32_16x16x32_bf16 v[120:123], a[4:7], a[52:55], v[120:123]
  s_xor_b32 s32, s100, 0x60000
  ds_read2_b32 a[84:85], v66 offset0:176 offset1:177
  v_add_u32 v41, 0x10000, v33
  v_mfma_f32_16x16x32_bf16 v[120:123], a[8:11], a[48:51], v[120:123]
  s_add_u32 m0, s37, 49152
  ds_read2_b32 a[86:87], v66 offset0:178 offset1:179
  v_add_u32 v42, 0x10000, v34
  v_mfma_f32_16x16x32_bf16 v[120:123], a[12:15], a[44:47], v[120:123]
  ds_read_b128 a[120:123], v68 offset:3328
  v_add_u32 v43, 0x10000, v35
  v_mfma_f32_16x16x32_bf16 v[120:123], a[16:19], a[40:43], v[120:123]
  s_lshl_b32 s3, s38, 2
  ds_read2_b32 a[88:89], v67 offset0:48 offset1:49
  v_mfma_f32_16x16x32_bf16 v[120:123], a[20:23], a[36:39], v[120:123]
  s_waitcnt lgkmcnt(15)
  s_lshl_b32 s31, s97, 1
  buffer_load_dwordx4 v24, s[44:47], s32 offen offset:0  lds
  v_mfma_f32_16x16x32_bf16 v[120:123], a[24:27], a[32:35], v[120:123]
  s_add_u32 s3, s3, s31
  ds_read2_b32 a[90:91], v67 offset0:50 offset1:51
  v_mfma_f32_16x16x32_bf16 v[124:127], a[28:31], a[32:35], v[124:127]
  s_lshr_b32 s31, s8, 1
  ds_read_b128 a[124:127], v68 offset:3840
  v_mfma_f32_16x16x32_bf16 v[124:127], a[24:27], a[36:39], v[124:127]
  s_add_u32 s97, s3, s31
  ds_read2_b32 a[92:93], v67 offset0:176 offset1:177
  v_mfma_f32_16x16x32_bf16 v[124:127], a[20:23], a[40:43], v[124:127]
  s_lshl_b32 s3, s39, 1
  ds_read2_b32 a[94:95], v67 offset0:178 offset1:179
  v_mfma_f32_16x16x32_bf16 v[124:127], a[16:19], a[44:47], v[124:127]
  s_and_b32 s31, s2, 1
  buffer_load_dwordx4 v25, s[44:47], s32 offen offset:1024  lds
  v_mfma_f32_16x16x32_bf16 v[124:127], a[12:15], a[48:51], v[124:127]
  s_add_u32 s76, s3, s31
  v_mfma_f32_16x16x32_bf16 v[124:127], a[8:11], a[52:55], v[124:127]
  s_lshl_b32 s3, s97, 16
  v_mfma_f32_16x16x32_bf16 v[124:127], a[4:7], a[56:59], v[124:127]
  s_lshl_b32 s31, s76, 7
  v_mfma_f32_16x16x32_bf16 v[124:127], a[0:3], a[60:63], v[124:127]
  s_add_u32 s3, s3, s31
  v_mfma_f32_16x16x32_bf16 v[96:99], a[64:67], a[96:99], v[96:99]
  s_waitcnt lgkmcnt(15)
  buffer_load_dwordx4 v26, s[44:47], s32 offen offset:2048  lds
  v_mfma_f32_16x16x32_bf16 v[100:103], a[68:71], a[96:99], v[100:103]
  s_add_u32 s48, s64, s3
  s_addc_u32 s49, s65, 0
  ds_read_b128 a[32:35], v68 offset:192
  v_mfma_f32_16x16x32_bf16 v[100:103], a[64:67], a[100:103], v[100:103]
  s_mov_b32 s50, 0xf880
  ds_read2_b32 a[0:1], v64 offset0:64 offset1:65
  v_mfma_f32_16x16x32_bf16 v[104:107], a[64:67], a[104:107], v[104:107]
  s_mov_b32 s51, 0x20000
  ds_read2_b32 a[2:3], v64 offset0:66 offset1:67
  v_mfma_f32_16x16x32_bf16 v[104:107], a[68:71], a[100:103], v[104:107]
  s_add_u32 s60, s90, s3
  s_addc_u32 s61, s91, 0
  ds_read_b128 a[36:39], v68 offset:704
  v_mfma_f32_16x16x32_bf16 v[104:107], a[72:75], a[96:99], v[104:107]
  s_waitcnt lgkmcnt(15)
  s_mov_b32 s62, 0xf880
  buffer_load_dwordx4 v27, s[44:47], s32 offen offset:3072  lds
  v_mfma_f32_16x16x32_bf16 v[108:111], a[76:79], a[96:99], v[108:111]
  s_mov_b32 s63, 0x20000
  ds_read2_b32 a[4:5], v64 offset0:192 offset1:193
  v_mfma_f32_16x16x32_bf16 v[108:111], a[72:75], a[100:103], v[108:111]
  s_lshl_b32 s3, s76, 18
  ds_read2_b32 a[6:7], v64 offset0:194 offset1:195
  v_mfma_f32_16x16x32_bf16 v[108:111], a[68:71], a[104:107], v[108:111]
  s_lshl_b32 s31, s97, 8
  ds_read_b128 a[40:43], v68 offset:1216
  v_mfma_f32_16x16x32_bf16 v[108:111], a[64:67], a[108:111], v[108:111]
  s_add_u32 s3, s3, s31
  ds_read2_b32 a[8:9], v65 offset0:64 offset1:65
  v_mfma_f32_16x16x32_bf16 v[112:115], a[64:67], a[112:115], v[112:115]
  s_add_u32 s52, s94, s3
  s_addc_u32 s53, s95, 0
  ds_read2_b32 a[10:11], v65 offset0:66 offset1:67
  v_mfma_f32_16x16x32_bf16 v[112:115], a[68:71], a[108:111], v[112:115]
  s_add_u32 s52, s52, 0x3800000
  s_addc_u32 s53, s53, 0
  v_mfma_f32_16x16x32_bf16 v[112:115], a[72:75], a[104:107], v[112:115]
  s_mov_b32 s54, 0x3c100
  ds_read_b128 a[44:47], v68 offset:1728
  v_mfma_f32_16x16x32_bf16 v[112:115], a[76:79], a[100:103], v[112:115]
  s_mov_b32 s55, 0x20000
  ds_read2_b32 a[12:13], v65 offset0:192 offset1:193
  s_waitcnt lgkmcnt(15)
  v_mfma_f32_16x16x32_bf16 v[112:115], a[80:83], a[96:99], v[112:115]
  s_lshl_b32 s3, s97, 7
  ds_read2_b32 a[14:15], v65 offset0:194 offset1:195
  v_mfma_f32_16x16x32_bf16 v[116:119], a[84:87], a[96:99], v[116:119]
  s_add_u32 s56, s94, s3
  s_addc_u32 s57, s95, 0
  v_mfma_f32_16x16x32_bf16 v[116:119], a[80:83], a[100:103], v[116:119]
  s_add_u32 s56, s56, 0x3c00000
  s_addc_u32 s57, s57, 0
  ds_read_b128 a[48:51], v68 offset:2240
  v_mfma_f32_16x16x32_bf16 v[116:119], a[76:79], a[104:107], v[116:119]
  s_mov_b32 s58, 0x80
  ds_read2_b32 a[16:17], v66 offset0:64 offset1:65
  v_mfma_f32_16x16x32_bf16 v[116:119], a[72:75], a[108:111], v[116:119]
  s_mov_b32 s59, 0x20000
  ds_read2_b32 a[18:19], v66 offset0:66 offset1:67
  v_mfma_f32_16x16x32_bf16 v[116:119], a[68:71], a[112:115], v[116:119]
  s_lshr_b32 s3, s2, 2
  v_mfma_f32_16x16x32_bf16 v[116:119], a[64:67], a[116:119], v[116:119]
  s_lshl_b32 s3, s3, 18
  ds_read_b128 a[52:55], v68 offset:2752
  v_mfma_f32_16x16x32_bf16 v[120:123], a[64:67], a[120:123], v[120:123]
  s_lshl_b32 s31, s28, 14
  ds_read2_b32 a[20:21], v66 offset0:192 offset1:193
  v_mfma_f32_16x16x32_bf16 v[120:123], a[68:71], a[116:119], v[120:123]
  s_add_u32 s3, s3, s31
  ds_read2_b32 a[22:23], v66 offset0:194 offset1:195
  v_mfma_f32_16x16x32_bf16 v[120:123], a[72:75], a[112:115], v[120:123]
  s_add_u32 s4, s94, s3
  s_addc_u32 s5, s95, 0
  v_mfma_f32_16x16x32_bf16 v[120:123], a[76:79], a[108:111], v[120:123]
  buffer_load_dword v10, v6, s[20:23], 0 offen offset:8 sc1
  v_mfma_f32_16x16x32_bf16 v[120:123], a[80:83], a[104:107], v[120:123]
  s_add_u32 s4, s4, 0x4000000
  s_addc_u32 s5, s5, 0
  ds_read_b128 a[56:59], v68 offset:3264
  v_mfma_f32_16x16x32_bf16 v[120:123], a[84:87], a[100:103], v[120:123]
  s_mov_b32 s6, 0x34000
  ds_read2_b32 a[24:25], v67 offset0:64 offset1:65
  s_waitcnt lgkmcnt(15)
  v_mfma_f32_16x16x32_bf16 v[120:123], a[88:91], a[96:99], v[120:123]
  s_mov_b32 s7, 0x20000
  ds_read2_b32 a[26:27], v67 offset0:66 offset1:67
  v_mfma_f32_16x16x32_bf16 v[124:127], a[92:95], a[96:99], v[124:127]
  s_lshl_b32 s8, s8, 16
  ds_read_b128 a[60:63], v68 offset:3776
  v_mfma_f32_16x16x32_bf16 v[124:127], a[88:91], a[100:103], v[124:127]
  s_lshl_b32 s3, s2, 11
  ds_read2_b32 a[28:29], v67 offset0:192 offset1:193
  v_mfma_f32_16x16x32_bf16 v[124:127], a[84:87], a[104:107], v[124:127]
  s_lshl_b32 s31, s28, 9
  ds_read2_b32 a[30:31], v67 offset0:194 offset1:195
  v_mfma_f32_16x16x32_bf16 v[124:127], a[80:83], a[108:111], v[124:127]
  s_add_u32 s35, s3, s31
  v_mfma_f32_16x16x32_bf16 v[124:127], a[76:79], a[112:115], v[124:127]
  v_min_u32 v18, 2, v1
  v_mfma_f32_16x16x32_bf16 v[124:127], a[72:75], a[116:119], v[124:127]
  v_lshlrev_b32 v45, 7, v18
  v_mfma_f32_16x16x32_bf16 v[124:127], a[68:71], a[120:123], v[124:127]
  s_lshl_b32 s3, s76, 15
  v_lshrrev_b32 v80, 4, v1
  v_bfe_u32 v81, v1, 2, 2
  v_mfma_f32_16x16x32_bf16 v[124:127], a[64:67], a[124:127], v[124:127]
  v_lshlrev_b32 v7, 11, v17
  v_xor_b32 v69, v80, v81
  v_mfma_f32_16x16x32_bf16 v[96:99], a[0:3], a[32:35], v[96:99]
  ds_read_b128 a[96:99], v68 offset:128
  v_add_u32 v7, s3, v7
  s_waitcnt lgkmcnt(15)
  v_mfma_f32_16x16x32_bf16 v[100:103], a[4:7], a[32:35], v[100:103]
  s_add_u32 s3, s37, 0x20000
  ds_read2_b32 a[64:65], v64 offset0:80 offset1:81
  v_lshlrev_b32 v69, 3, v69
  v_mfma_f32_16x16x32_bf16 v[100:103], a[0:3], a[36:39], v[100:103]
  ds_read2_b32 a[66:67], v64 offset0:82 offset1:83
  v_lshrrev_b32 v18, 3, v1
  v_mfma_f32_16x16x32_bf16 v[104:107], a[0:3], a[40:43], v[104:107]
  v_and_b32 v19, 7, v1
  v_mul_u32_u24 v70, 4224, v81
  v_mfma_f32_16x16x32_bf16 v[104:107], a[4:7], a[36:39], v[104:107]
  ds_read_b128 a[100:103], v68 offset:640
  v_lshlrev_b32 v62, 11, v18
  v_mfma_f32_16x16x32_bf16 v[104:107], a[8:11], a[32:35], v[104:107]
  ds_read2_b32 a[68:69], v64 offset0:208 offset1:209
  v_lshl_add_u32 v62, v19, 4, v62
  s_waitcnt lgkmcnt(15)
  v_mfma_f32_16x16x32_bf16 v[108:111], a[12:15], a[32:35], v[108:111]
  ds_read2_b32 a[70:71], v64 offset0:210 offset1:211
  v_xor_b32 v19, v19, v18
  v_mfma_f32_16x16x32_bf16 v[108:111], a[8:11], a[36:39], v[108:111]
  v_lshlrev_b32 v19, 4, v19
  v_lshrrev_b32 v81, 1, v81
  v_mfma_f32_16x16x32_bf16 v[108:111], a[4:7], a[40:43], v[108:111]
  ds_read_b128 a[104:107], v68 offset:1152
  v_lshl_add_u32 v46, v18, 11, v19
  v_mfma_f32_16x16x32_bf16 v[108:111], a[0:3], a[44:47], v[108:111]
  ds_read2_b32 a[72:73], v65 offset0:80 offset1:81
  v_lshl_add_u32 v63, v18, 7, v19
  v_mfma_f32_16x16x32_bf16 v[112:115], a[0:3], a[48:51], v[112:115]
  ds_read2_b32 a[74:75], v65 offset0:82 offset1:83
  v_add_u32 v63, s3, v63
  v_mfma_f32_16x16x32_bf16 v[112:115], a[4:7], a[44:47], v[112:115]
  v_and_b32 v18, 7, v17
  v_lshl_add_u32 v70, v81, 5, v70
  v_mfma_f32_16x16x32_bf16 v[112:115], a[8:11], a[40:43], v[112:115]
  ds_read_b128 a[108:111], v68 offset:1664
  v_lshrrev_b32 v19, 1, v16
  v_mfma_f32_16x16x32_bf16 v[112:115], a[12:15], a[36:39], v[112:115]
  ds_read2_b32 a[76:77], v65 offset0:208 offset1:209
  v_xor_b32 v18, v18, v19
  s_waitcnt lgkmcnt(15)
  v_mfma_f32_16x16x32_bf16 v[112:115], a[16:19], a[32:35], v[112:115]
  ds_read2_b32 a[78:79], v65 offset0:210 offset1:211
  v_lshlrev_b32 v18, 4, v18
  v_mfma_f32_16x16x32_bf16 v[116:119], a[20:23], a[32:35], v[116:119]
  v_lshl_add_u32 v18, v17, 7, v18
  v_lshl_add_u32 v70, v80, 6, v70
  v_mfma_f32_16x16x32_bf16 v[116:119], a[16:19], a[36:39], v[116:119]
  ds_read_b128 a[112:115], v68 offset:2176
  v_and_b32 v19, 1, v16
  v_mfma_f32_16x16x32_bf16 v[116:119], a[12:15], a[40:43], v[116:119]
  s_waitcnt vmcnt(13)
  ds_read2_b32 a[80:81], v66 offset0:80 offset1:81
  v_lshl_add_u32 v18, v19, 3, v18
  v_mfma_f32_16x16x32_bf16 v[116:119], a[8:11], a[44:47], v[116:119]
  s_barrier
  v_mfma_f32_16x16x32_bf16 v[116:119], a[4:7], a[48:51], v[116:119]
  ds_read2_b32 a[82:83], v66 offset0:82 offset1:83
  v_add_u32 v44, s3, v18
  v_mfma_f32_16x16x32_bf16 v[116:119], a[0:3], a[52:55], v[116:119]
  ds_read_b128 a[116:119], v68 offset:2688
  v_lshlrev_b32 v47, 14, v16
  v_mfma_f32_16x16x32_bf16 v[120:123], a[0:3], a[56:59], v[120:123]
  ds_read2_b32 a[84:85], v66 offset0:208 offset1:209
  v_lshl_add_u32 v47, v17, 4, v47
  v_mfma_f32_16x16x32_bf16 v[120:123], a[4:7], a[52:55], v[120:123]
  ds_read2_b32 a[86:87], v66 offset0:210 offset1:211
  v_lshlrev_b32 v48, 2, v17
  v_mfma_f32_16x16x32_bf16 v[120:123], a[8:11], a[48:51], v[120:123]
  v_lshlrev_b32 v49, 20, v1
  v_lshrrev_b32 v80, 1, v80
  v_mfma_f32_16x16x32_bf16 v[120:123], a[12:15], a[44:47], v[120:123]
  ds_read_b128 a[120:123], v68 offset:3200
  v_xor_b32 v56, 0, v44
  v_mfma_f32_16x16x32_bf16 v[120:123], a[16:19], a[40:43], v[120:123]
  ds_read2_b32 a[88:89], v67 offset0:80 offset1:81
  v_xor_b32 v57, 32, v44
  v_mfma_f32_16x16x32_bf16 v[120:123], a[20:23], a[36:39], v[120:123]
  ds_read2_b32 a[90:91], v67 offset0:82 offset1:83
  v_xor_b32 v58, 64, v44
  s_waitcnt lgkmcnt(15)
  v_mfma_f32_16x16x32_bf16 v[120:123], a[24:27], a[32:35], v[120:123]
  v_xor_b32 v59, 96, v44
  v_and_b32 v81, 3, v1
  v_mfma_f32_16x16x32_bf16 v[124:127], a[28:31], a[32:35], v[124:127]
  ds_read_b128 a[124:127], v68 offset:3712
  v_xor_b32 v80, v80, v81
  v_mfma_f32_16x16x32_bf16 v[124:127], a[24:27], a[36:39], v[124:127]
  ds_read2_b32 a[92:93], v67 offset0:208 offset1:209
  v_lshl_add_u32 v70, v80, 3, v70
  v_mfma_f32_16x16x32_bf16 v[124:127], a[20:23], a[40:43], v[124:127]
  ds_read2_b32 a[94:95], v67 offset0:210 offset1:211
  v_lshrrev_b32 v81, 6, v0
  v_mfma_f32_16x16x32_bf16 v[124:127], a[16:19], a[44:47], v[124:127]
  v_lshl_add_u32 v70, v81, 10, v70
  v_add_u32 v70, 0x18000, v70
  v_mfma_f32_16x16x32_bf16 v[124:127], a[12:15], a[48:51], v[124:127]
  v_xor_b32 v71, 16, v70
  v_mul_u32_u24 v80, 4224, v81
  v_mfma_f32_16x16x32_bf16 v[124:127], a[8:11], a[52:55], v[124:127]
  v_add_u32 v69, v69, v80
  v_lshrrev_b32 v81, 1, v81
  v_mfma_f32_16x16x32_bf16 v[124:127], a[4:7], a[56:59], v[124:127]
  v_and_b32 v80, 15, v1
  v_add_u32 v80, v80, v81
  v_mfma_f32_16x16x32_bf16 v[124:127], a[0:3], a[60:63], v[124:127]
  v_lshl_add_u32 v69, v80, 5, v69
  v_add_u32 v69, 0x18000, v69
  v_mfma_f32_16x16x32_bf16 v[96:99], a[64:67], a[96:99], v[96:99]
  s_mov_b64 exec, 0
  s_cmp_eq_u32 s28, 0
  s_cbranch_scc1 L_pad16
  s_cmp_eq_u32 s28, 1
  s_cbranch_scc1 L_pad17
  s_cmp_eq_u32 s28, 2
  s_cbranch_scc1 L_pad18
  s_branch L_pad19
L_hr2:
  s_mov_b64 exec, -1
  v_mfma_f32_16x16x32_bf16 v[100:103], a[68:71], a[96:99], v[100:103]
  ds_read_b128 a[32:35], v68 offset:64
  v_mfma_f32_16x16x32_bf16 v[100:103], a[64:67], a[100:103], v[100:103]
  s_waitcnt vmcnt(0)
  s_mov_b32 s0, 0
L_ctx_loop:
  v_cmp_ne_u32 vcc, 1, v10
  s_nop 2
  s_cbranch_vccz L_ctx_ok
  buffer_load_dword v10, v6, s[20:23], 0 offen offset:8 sc1
  s_add_u32 s0, s0, 1
  s_cmp_lt_u32 s0, 0x200000
  s_waitcnt vmcnt(0)
  s_cbranch_scc1 L_ctx_loop
L_ctx_ok:
  s_waitcnt lgkmcnt(15)
  v_mfma_f32_16x16x32_bf16 v[104:107], a[64:67], a[104:107], v[104:107]
  s_xor_b32 s34, s101, 0x0
  ds_read2_b32 a[0:1], v64 offset0:96 offset1:97
  v_mfma_f32_16x16x32_bf16 v[104:107], a[68:71], a[100:103], v[104:107]
  buffer_load_dwordx4 v[192:195], v60, s[40:43], s34 offen offset:0 sc1
  v_mfma_f32_16x16x32_bf16 v[104:107], a[72:75], a[96:99], v[104:107]
  ds_read2_b32 a[2:3], v64 offset0:98 offset1:99
  s_waitcnt lgkmcnt(15)
  v_mfma_f32_16x16x32_bf16 v[108:111], a[76:79], a[96:99], v[108:111]
  ds_read_b128 a[36:39], v68 offset:576
  v_mfma_f32_16x16x32_bf16 v[108:111], a[72:75], a[100:103], v[108:111]
  buffer_load_dwordx4 v[200:203], v60, s[40:43], s34 offen offset:1024 sc1
  v_mfma_f32_16x16x32_bf16 v[108:111], a[68:71], a[104:107], v[108:111]
  ds_read2_b32 a[4:5], v64 offset0:224 offset1:225
  v_mfma_f32_16x16x32_bf16 v[108:111], a[64:67], a[108:111], v[108:111]
  ds_read2_b32 a[6:7], v64 offset0:226 offset1:227
  s_waitcnt lgkmcnt(15)
  v_mfma_f32_16x16x32_bf16 v[112:115], a[64:67], a[112:115], v[112:115]
  ds_read_b128 a[40:43], v68 offset:1088
  v_mfma_f32_16x16x32_bf16 v[112:115], a[68:71], a[108:111], v[112:115]
  buffer_load_dwordx4 v[208:211], v61, s[40:43], s34 offen offset:0 sc1
  v_mfma_f32_16x16x32_bf16 v[112:115], a[72:75], a[104:107], v[112:115]
  ds_read2_b32 a[8:9], v65 offset0:96 offset1:97
  v_mfma_f32_16x16x32_bf16 v[112:115], a[76:79], a[100:103], v[112:115]
  ds_read2_b32 a[10:11], v65 offset0:98 offset1:99
  v_mfma_f32_16x16x32_bf16 v[112:115], a[80:83], a[96:99], v[112:115]
  ds_read_b128 a[44:47], v68 offset:1600
  s_waitcnt lgkmcnt(15)
  v_mfma_f32_16x16x32_bf16 v[116:119], a[84:87], a[96:99], v[116:119]
  buffer_load_dwordx4 v[216:219], v61, s[40:43], s34 offen offset:1024 sc1
  v_mfma_f32_16x16x32_bf16 v[116:119], a[80:83], a[100:103], v[116:119]
  s_xor_b32 s34, s101, 0x2000
  ds_read2_b32 a[12:13], v65 offset0:224 offset1:225
  v_mfma_f32_16x16x32_bf16 v[116:119], a[76:79], a[104:107], v[116:119]
  ds_read2_b32 a[14:15], v65 offset0:226 offset1:227
  v_mfma_f32_16x16x32_bf16 v[116:119], a[72:75], a[108:111], v[116:119]
  ds_read_b128 a[48:51], v68 offset:2112
  v_mfma_f32_16x16x32_bf16 v[116:119], a[68:71], a[112:115], v[116:119]
  buffer_load_dwordx4 v[196:199], v60, s[40:43], s34 offen offset:0 sc1
  v_mfma_f32_16x16x32_bf16 v[116:119], a[64:67], a[116:119], v[116:119]
  ds_read2_b32 a[16:17], v66 offset0:96 offset1:97
  v_mfma_f32_16x16x32_bf16 v[120:123], a[64:67], a[120:123], v[120:123]
  ds_read2_b32 a[18:19], v66 offset0:98 offset1:99
  v_mfma_f32_16x16x32_bf16 v[120:123], a[68:71], a[116:119], v[120:123]
  ds_read_b128 a[52:55], v68 offset:2624
  v_mfma_f32_16x16x32_bf16 v[120:123], a[72:75], a[112:115], v[120:123]
  buffer_load_dwordx4 v[204:207], v60, s[40:43], s34 offen offset:1024 sc1
  v_mfma_f32_16x16x32_bf16 v[120:123], a[76:79], a[108:111], v[120:123]
  ds_read2_b32 a[20:21], v66 offset0:224 offset1:225
  v_mfma_f32_16x16x32_bf16 v[120:123], a[80:83], a[104:107], v[120:123]
  ds_read2_b32 a[22:23], v66 offset0:226 offset1:227
  v_mfma_f32_16x16x32_bf16 v[120:123], a[84:87], a[100:103], v[120:123]
  ds_read_b128 a[56:59], v68 offset:3136
  s_waitcnt lgkmcnt(15)
  v_mfma_f32_16x16x32_bf16 v[120:123], a[88:91], a[96:99], v[120:123]
  buffer_load_dwordx4 v[212:215], v61, s[40:43], s34 offen offset:0 sc1
  v_mfma_f32_16x16x32_bf16 v[124:127], a[92:95], a[96:99], v[124:127]
  ds_read2_b32 a[24:25], v67 offset0:96 offset1:97
  v_mfma_f32_16x16x32_bf16 v[124:127], a[88:91], a[100:103], v[124:127]
  ds_read2_b32 a[26:27], v67 offset0:98 offset1:99
  v_mfma_f32_16x16x32_bf16 v[124:127], a[84:87], a[104:107], v[124:127]
  ds_read_b128 a[60:63], v68 offset:3648
  v_mfma_f32_16x16x32_bf16 v[124:127], a[80:83], a[108:111], v[124:127]
  buffer_load_dwordx4 v[220:223], v61, s[40:43], s34 offen offset:1024 sc1
  v_mfma_f32_16x16x32_bf16 v[124:127], a[76:79], a[112:115], v[124:127]
  s_xor_b32 s34, s101, 0x4000
  ds_read2_b32 a[28:29], v67 offset0:224 offset1:225
  v_mfma_f32_16x16x32_bf16 v[124:127], a[72:75], a[116:119], v[124:127]
  ds_read2_b32 a[30:31], v67 offset0:226 offset1:227
  v_mfma_f32_16x16x32_bf16 v[124:127], a[68:71], a[120:123], v[124:127]
  ds_read_b64_tr_b16 a[128:129], v28 offset:0
  v_mfma_f32_16x16x32_bf16 v[124:127], a[64:67], a[124:127], v[124:127]
  buffer_load_dwordx4 v[224:227], v60, s[40:43], s34 offen offset:0 sc1
  v_mfma_f32_16x16x32_bf16 v[96:99], a[0:3], a[32:35], v[96:99]
  ds_read_b128 a[96:99], v68 offset:0
  s_waitcnt lgkmcnt(15)
  v_mfma_f32_16x16x32_bf16 v[100:103], a[4:7], a[32:35], v[100:103]
  ds_read2_b32 a[64:65], v64 offset0:112 offset1:113
  v_mfma_f32_16x16x32_bf16 v[100:103], a[0:3], a[36:39], v[100:103]
  ds_read2_b32 a[66:67], v64 offset0:114 offset1:115
  v_mfma_f32_16x16x32_bf16 v[104:107], a[0:3], a[40:43], v[104:107]
  buffer_load_dwordx4 v[232:235], v60, s[40:43], s34 offen offset:1024 sc1
  v_mfma_f32_16x16x32_bf16 v[104:107], a[4:7], a[36:39], v[104:107]
  ds_read_b128 a[100:103], v68 offset:512
  v_mfma_f32_16x16x32_bf16 v[104:107], a[8:11], a[32:35], v[104:107]
  ds_read2_b32 a[68:69], v64 offset0:240 offset1:241
  s_waitcnt lgkmcnt(15)
  v_mfma_f32_16x16x32_bf16 v[108:111], a[12:15], a[32:35], v[108:111]
  s_lshl_b32 s3, s2, 14
  ds_read2_b32 a[70:71], v64 offset0:242 offset1:243
  v_mfma_f32_16x16x32_bf16 v[108:111], a[8:11], a[36:39], v[108:111]
  s_lshl_b32 s31, s28, 12
  buffer_load_dwordx4 v[240:243], v61, s[40:43], s34 offen offset:0 sc1
  v_mfma_f32_16x16x32_bf16 v[108:111], a[4:7], a[40:43], v[108:111]
  s_add_u32 s3, s3, s31
  ds_read_b128 a[104:107], v68 offset:1024
  v_mfma_f32_16x16x32_bf16 v[108:111], a[0:3], a[44:47], v[108:111]
  s_add_u32 s24, s94, s3
  s_addc_u32 s25, s95, 0
  ds_read2_b32 a[72:73], v65 offset0:112 offset1:113
  v_mfma_f32_16x16x32_bf16 v[112:115], a[0:3], a[48:51], v[112:115]
  s_add_u32 s24, s24, 0x3800000
  s_addc_u32 s25, s25, 0
  ds_read2_b32 a[74:75], v65 offset0:114 offset1:115
  v_mfma_f32_16x16x32_bf16 v[112:115], a[4:7], a[44:47], v[112:115]
  s_mov_b32 s26, 0x1000
  buffer_load_dwordx4 v[248:251], v61, s[40:43], s34 offen offset:1024 sc1
  v_mfma_f32_16x16x32_bf16 v[112:115], a[8:11], a[40:43], v[112:115]
  s_xor_b32 s34, s101, 0x6000
  s_mov_b32 s27, 0x20000
  ds_read_b128 a[108:111], v68 offset:1536
  v_mfma_f32_16x16x32_bf16 v[112:115], a[12:15], a[36:39], v[112:115]
  ds_read2_b32 a[76:77], v65 offset0:240 offset1:241
  v_mfma_f32_16x16x32_bf16 v[112:115], a[16:19], a[32:35], v[112:115]
  ds_read2_b32 a[78:79], v65 offset0:242 offset1:243
  s_waitcnt lgkmcnt(15)
  v_mfma_f32_16x16x32_bf16 v[116:119], a[20:23], a[32:35], v[116:119]
  buffer_load_dwordx4 v[228:231], v60, s[40:43], s34 offen offset:0 sc1
  v_mfma_f32_16x16x32_bf16 v[116:119], a[16:19], a[36:39], v[116:119]
  ds_read_b128 a[112:115], v68 offset:2048
  v_mfma_f32_16x16x32_bf16 v[116:119], a[12:15], a[40:43], v[116:119]
  ds_read2_b32 a[80:81], v66 offset0:112 offset1:113
  v_mfma_f32_16x16x32_bf16 v[116:119], a[8:11], a[44:47], v[116:119]
  ds_read2_b32 a[82:83], v66 offset0:114 offset1:115
  v_mfma_f32_16x16x32_bf16 v[116:119], a[4:7], a[48:51], v[116:119]
  buffer_load_dwordx4 v[236:239], v60, s[40:43], s34 offen offset:1024 sc1
  v_mfma_f32_16x16x32_bf16 v[116:119], a[0:3], a[52:55], v[116:119]
  ds_read_b128 a[116:119], v68 offset:2560
  v_mfma_f32_16x16x32_bf16 v[120:123], a[0:3], a[56:59], v[120:123]
  ds_read2_b32 a[84:85], v66 offset0:240 offset1:241
  v_mfma_f32_16x16x32_bf16 v[120:123], a[4:7], a[52:55], v[120:123]
  ds_read2_b32 a[86:87], v66 offset0:242 offset1:243
  v_mfma_f32_16x16x32_bf16 v[120:123], a[8:11], a[48:51], v[120:123]
  buffer_load_dwordx4 v[244:247], v61, s[40:43], s34 offen offset:0 sc1
  v_mfma_f32_16x16x32_bf16 v[120:123], a[12:15], a[44:47], v[120:123]
  ds_read_b128 a[120:123], v68 offset:3072
  v_mfma_f32_16x16x32_bf16 v[120:123], a[16:19], a[40:43], v[120:123]
  ds_read2_b32 a[88:89], v67 offset0:112 offset1:113
  v_mfma_f32_16x16x32_bf16 v[120:123], a[20:23], a[36:39], v[120:123]
  ds_read2_b32 a[90:91], v67 offset0:114 offset1:115
  v_mfma_f32_16x16x32_bf16 v[120:123], a[24:27], a[32:35], v[120:123]
  s_waitcnt lgkmcnt(15)
  buffer_load_dwordx4 v[252:255], v61, s[40:43], s34 offen offset:1024 sc1
  v_mfma_f32_16x16x32_bf16 v[124:127], a[28:31], a[32:35], v[124:127]
  s_xor_b32 s34, s101, 0x8000
  ds_read_b128 a[124:127], v68 offset:3584
  v_mfma_f32_16x16x32_bf16 v[124:127], a[24:27], a[36:39], v[124:127]
  ds_read_b64_tr_b16 a[130:131], v28 offset:4096
  v_mfma_f32_16x16x32_bf16 v[124:127], a[20:23], a[40:43], v[124:127]
  ds_read_b64_tr_b16 a[132:133], v28 offset:8192
  v_mfma_f32_16x16x32_bf16 v[124:127], a[16:19], a[44:47], v[124:127]
  buffer_load_dwordx4 a[192:195], v60, s[40:43], s34 offen offset:0 sc1
  v_mfma_f32_16x16x32_bf16 v[124:127], a[12:15], a[48:51], v[124:127]
  ds_read_b64_tr_b16 a[134:135], v28 offset:12288
  v_mfma_f32_16x16x32_bf16 v[124:127], a[8:11], a[52:55], v[124:127]
  ds_read_b64_tr_b16 a[136:137], v29 offset:0
  v_mfma_f32_16x16x32_bf16 v[124:127], a[4:7], a[56:59], v[124:127]
  ds_read_b64_tr_b16 a[138:139], v29 offset:4096
  v_mfma_f32_16x16x32_bf16 v[124:127], a[0:3], a[60:63], v[124:127]
  buffer_load_dwordx4 a[200:203], v60, s[40:43], s34 offen offset:1024 sc1
  v_mfma_f32_16x16x32_bf16 v[96:99], a[64:67], a[96:99], v[96:99]
  ds_read_b64_tr_b16 a[140:141], v29 offset:8192
  v_mfma_f32_16x16x32_bf16 v[100:103], a[68:71], a[96:99], v[100:103]
  ds_read_b64_tr_b16 a[142:143], v29 offset:12288
  v_mfma_f32_16x16x32_bf16 v[100:103], a[64:67], a[100:103], v[100:103]
  ds_read_b64_tr_b16 a[144:145], v30 offset:0
  s_waitcnt lgkmcnt(15)
  v_mfma_f32_16x16x32_bf16 v[104:107], a[64:67], a[104:107], v[104:107]
  buffer_load_dwordx4 a[208:211], v61, s[40:43], s34 offen offset:0 sc1
  v_mfma_f32_16x16x32_bf16 v[104:107], a[68:71], a[100:103], v[104:107]
  ds_read_b64_tr_b16 a[146:147], v30 offset:4096
  v_mfma_f32_16x16x32_bf16 v[104:107], a[72:75], a[96:99], v[104:107]
  ds_read_b64_tr_b16 a[148:149], v30 offset:8192
  v_mfma_f32_16x16x32_bf16 v[108:111], a[76:79], a[96:99], v[108:111]
  ds_read_b64_tr_b16 a[150:151], v30 offset:12288
  v_mfma_f32_16x16x32_bf16 v[108:111], a[72:75], a[100:103], v[108:111]
  buffer_load_dwordx4 a[216:219], v61, s[40:43], s34 offen offset:1024 sc1
  v_mfma_f32_16x16x32_bf16 v[108:111], a[68:71], a[104:107], v[108:111]
  s_xor_b32 s34, s101, 0xa000
  ds_read_b64_tr_b16 a[152:153], v31 offset:0
  v_cvt_pk_bf16_f32 v96, v96, v97
  v_mfma_f32_16x16x32_bf16 v[108:111], a[64:67], a[108:111], v[108:111]
  ds_read_b64_tr_b16 a[154:155], v31 offset:4096
  v_cvt_pk_bf16_f32 v97, v98, v99
  v_mfma_f32_16x16x32_bf16 v[112:115], a[64:67], a[112:115], v[112:115]
  ds_read_b64_tr_b16 a[156:157], v31 offset:8192
  v_cvt_pk_bf16_f32 v100, v100, v101
  v_mfma_f32_16x16x32_bf16 v[112:115], a[68:71], a[108:111], v[112:115]
  buffer_load_dwordx4 a[196:199], v60, s[40:43], s34 offen offset:0 sc1
  v_mfma_f32_16x16x32_bf16 v[112:115], a[72:75], a[104:107], v[112:115]
  ds_read_b64_tr_b16 a[158:159], v31 offset:12288
  v_cvt_pk_bf16_f32 v101, v102, v103
  v_mfma_f32_16x16x32_bf16 v[112:115], a[76:79], a[100:103], v[112:115]
  ds_read_b64_tr_b16 a[160:161], v32 offset:0
  v_cvt_pk_bf16_f32 v104, v104, v105
  v_mfma_f32_16x16x32_bf16 v[112:115], a[80:83], a[96:99], v[112:115]
  ds_read_b64_tr_b16 a[162:163], v32 offset:4096
  v_cvt_pk_bf16_f32 v105, v106, v107
  s_waitcnt lgkmcnt(15)
  v_mfma_f32_16x16x32_bf16 v[116:119], a[84:87], a[96:99], v[116:119]
  buffer_load_dwordx4 a[204:207], v60, s[40:43], s34 offen offset:1024 sc1
  v_mfma_f32_16x16x32_bf16 v[116:119], a[80:83], a[100:103], v[116:119]
  ds_read_b64_tr_b16 a[164:165], v32 offset:8192
  v_cvt_pk_bf16_f32 v108, v108, v109
  v_mfma_f32_16x16x32_bf16 v[116:119], a[76:79], a[104:107], v[116:119]
  ds_read_b64_tr_b16 a[166:167], v32 offset:12288
  v_cvt_pk_bf16_f32 v109, v110, v111
  v_mfma_f32_16x16x32_bf16 v[116:119], a[72:75], a[108:111], v[116:119]
  ds_read_b64_tr_b16 a[168:169], v33 offset:0
  v_mfma_f32_16x16x32_bf16 v[116:119], a[68:71], a[112:115], v[116:119]
  buffer_load_dwordx4 a[212:215], v61, s[40:43], s34 offen offset:0 sc1
  v_mfma_f32_16x16x32_bf16 v[116:119], a[64:67], a[116:119], v[116:119]
  ds_read_b64_tr_b16 a[170:171], v33 offset:4096
  v_mfma_f32_16x16x32_bf16 v[120:123], a[64:67], a[120:123], v[120:123]
  ds_read_b64_tr_b16 a[172:173], v33 offset:8192
  v_cvt_pk_bf16_f32 v112, v112, v113
  v_mfma_f32_16x16x32_bf16 v[120:123], a[68:71], a[116:119], v[120:123]
  ds_read_b64_tr_b16 a[174:175], v33 offset:12288
  v_cvt_pk_bf16_f32 v113, v114, v115
  v_mfma_f32_16x16x32_bf16 v[120:123], a[72:75], a[112:115], v[120:123]
  buffer_load_dwordx4 a[220:223], v61, s[40:43], s34 offen offset:1024 sc1
  v_mfma_f32_16x16x32_bf16 v[120:123], a[76:79], a[108:111], v[120:123]
  ds_read_b64_tr_b16 a[176:177], v34 offset:0
  v_mfma_f32_16x16x32_bf16 v[120:123], a[80:83], a[104:107], v[120:123]
  ds_read_b64_tr_b16 a[178:179], v34 offset:4096
  v_mfma_f32_16x16x32_bf16 v[120:123], a[84:87], a[100:103], v[120:123]
  ds_read_b64_tr_b16 a[180:181], v34 offset:8192
  v_mfma_f32_16x16x32_bf16 v[120:123], a[88:91], a[96:99], v[120:123]
  ds_read_b64_tr_b16 a[182:183], v34 offset:12288
  v_cvt_pk_bf16_f32 v116, v116, v117
  v_mfma_f32_16x16x32_bf16 v[124:127], v[76:79], a[96:99], v[124:127]
  ds_read_b64_tr_b16 a[184:185], v35 offset:0
  v_cvt_pk_bf16_f32 v117, v118, v119
  v_mfma_f32_16x16x32_bf16 v[124:127], a[88:91], a[100:103], v[124:127]
  ds_read_b64_tr_b16 a[186:187], v35 offset:4096
  v_mfma_f32_16x16x32_bf16 v[124:127], a[84:87], a[104:107], v[124:127]
  ds_read_b64_tr_b16 a[188:189], v35 offset:8192
  v_mfma_f32_16x16x32_bf16 v[124:127], a[80:83], a[108:111], v[124:127]
L_pad15:
  s_cbranch_execz L_hr1
  ds_read_b64_tr_b16 a[190:191], v35 offset:12288
  v_mfma_f32_16x16x32_bf16 v[124:127], a[76:79], a[112:115], v[124:127]
  ds_write_b64 v69, v[96:97] offset:0
  v_mfma_f32_16x16x32_bf16 v[124:127], a[72:75], a[116:119], v[124:127]
  ds_write_b64 v69, v[100:101] offset:512
  v_mfma_f32_16x16x32_bf16 v[124:127], a[68:71], a[120:123], v[124:127]
  v_cvt_pk_bf16_f32 v120, v120, v121
  v_cvt_pk_bf16_f32 v121, v122, v123
  v_mfma_f32_16x16x32_bf16 v[124:127], a[64:67], a[124:127], v[124:127]
  ds_write_b64 v69, v[104:105] offset:1024
L_outmain:
  s_waitcnt vmcnt(21)
  v_mfma_f32_16x16x32_bf16 v[128:131], a[128:131], v[208:211], 0
  s_waitcnt vmcnt(17) lgkmcnt(15)
  s_xor_b32 s34, s101, 0xc000
  s_mov_b32 s96, 0xffff0000
  v_mfma_f32_16x16x32_bf16 v[128:131], a[132:135], v[212:215], v[128:131]
  s_waitcnt vmcnt(16)
  v_mfma_f32_16x16x32_bf16 v[132:135], a[132:135], v[220:223], 0
  buffer_load_dwordx4 a[224:227], v60, s[40:43], s34 offen offset:0 sc1
  v_mfma_f32_16x16x32_bf16 v[132:135], a[128:131], v[216:219], v[132:135]
  v_mfma_f32_16x16x32_bf16 v[140:143], a[136:139], v[216:219], 0
  v_mfma_f32_16x16x32_bf16 v[140:143], a[140:143], v[220:223], v[140:143]
  ds_write_b64 v69, v[108:109] offset:1536
  v_mfma_f32_16x16x32_bf16 v[136:139], a[140:143], v[212:215], 0
  ds_write_b64 v69, v[112:113] offset:2048
  v_mfma_f32_16x16x32_bf16 v[136:139], a[136:139], v[208:211], v[136:139]
  ds_write_b64 v69, v[116:117] offset:2560
  v_mfma_f32_16x16x32_bf16 v[144:147], a[144:147], v[208:211], 0
  ds_write_b64 v69, v[120:121] offset:3072
  v_cvt_pk_bf16_f32 v124, v124, v125
  v_mfma_f32_16x16x32_bf16 v[144:147], a[148:151], v[212:215], v[144:147]
  v_cvt_pk_bf16_f32 v125, v126, v127
  v_mfma_f32_16x16x32_bf16 v[148:151], a[148:151], v[220:223], 0
  s_mov_b32 s9, 7
  ds_write_b64 v69, v[124:125] offset:3584
  v_mfma_f32_16x16x32_bf16 v[148:151], a[144:147], v[216:219], v[148:151]
  buffer_load_dwordx4 a[232:235], v60, s[40:43], s34 offen offset:1024 sc1
  v_mfma_f32_16x16x32_bf16 v[156:159], a[152:155], v[216:219], 0
  v_mfma_f32_16x16x32_bf16 v[156:159], a[156:159], v[220:223], v[156:159]
  s_waitcnt lgkmcnt(0)
  s_barrier
  v_mfma_f32_16x16x32_bf16 v[152:155], a[156:159], v[212:215], 0
  ds_read_b64_tr_b16 a[64:65], v70 offset:0
  v_mfma_f32_16x16x32_bf16 v[152:155], a[152:155], v[208:211], v[152:155]
  ds_read_b64_tr_b16 a[66:67], v70 offset:32
  v_mfma_f32_16x16x32_bf16 v[160:163], a[160:163], v[208:211], 0
  ds_read_b64_tr_b16 a[68:69], v71 offset:256
  v_mfma_f32_16x16x32_bf16 v[160:163], a[164:167], v[212:215], v[160:163]
  ds_read_b64_tr_b16 a[70:71], v71 offset:288
  v_mfma_f32_16x16x32_bf16 v[164:167], a[164:167], v[220:223], 0
  ds_read_b64_tr_b16 a[72:73], v70 offset:512
  v_mfma_f32_16x16x32_bf16 v[164:167], a[160:163], v[216:219], v[164:167]
  ds_read_b64_tr_b16 a[74:75], v70 offset:544
  v_mfma_f32_16x16x32_bf16 v[172:175], a[168:171], v[216:219], 0
  ds_read_b64_tr_b16 a[76:77], v71 offset:768
  v_mfma_f32_16x16x32_bf16 v[172:175], a[172:175], v[220:223], v[172:175]
  ds_read_b64_tr_b16 a[78:79], v71 offset:800
  v_mfma_f32_16x16x32_bf16 v[168:171], a[172:175], v[212:215], 0
  buffer_load_dwordx4 a[240:243], v61, s[40:43], s34 offen offset:0 sc1
  v_mfma_f32_16x16x32_bf16 v[168:171], a[168:171], v[208:211], v[168:171]
  v_mfma_f32_16x16x32_bf16 v[176:179], a[176:179], v[208:211], 0
  buffer_load_dwordx4 a[248:251], v61, s[40:43], s34 offen offset:1024 sc1
  v_mfma_f32_16x16x32_bf16 v[176:179], a[180:183], v[212:215], v[176:179]
  s_xor_b32 s34, s101, 0xe000
  v_mfma_f32_16x16x32_bf16 v[180:183], a[180:183], v[220:223], 0
  buffer_load_dwordx4 a[228:231], v60, s[40:43], s34 offen offset:0 sc1
  v_mfma_f32_16x16x32_bf16 v[180:183], a[176:179], v[216:219], v[180:183]
  v_mfma_f32_16x16x32_bf16 v[188:191], a[184:187], v[216:219], 0
  buffer_load_dwordx4 a[236:239], v60, s[40:43], s34 offen offset:1024 sc1
  v_mfma_f32_16x16x32_bf16 v[188:191], a[188:191], v[220:223], v[188:191]
  v_mfma_f32_16x16x32_bf16 v[184:187], a[188:191], v[212:215], 0
  buffer_load_dwordx4 a[244:247], v61, s[40:43], s34 offen offset:0 sc1
  v_mfma_f32_16x16x32_bf16 v[184:187], a[184:187], v[208:211], v[184:187]
  v_mfma_f32_16x16x32_bf16 v[64:67], a[128:131], v[192:195], 0
  buffer_load_dwordx4 a[252:255], v61, s[40:43], s34 offen offset:1024 sc1
  v_mfma_f32_16x16x32_bf16 v[64:67], a[132:135], v[196:199], v[64:67]
  v_mfma_f32_16x16x32_bf16 v[68:71], a[132:135], v[204:207], 0
  v_mfma_f32_16x16x32_bf16 v[68:71], a[128:131], v[200:203], v[68:71]
  s_waitcnt lgkmcnt(0)
  s_barrier
  v_mfma_f32_16x16x32_bf16 v[76:79], a[136:139], v[200:203], 0
  buffer_store_dwordx4 a[64:67], v3, s[24:27], 0 offen offset:0 sc1
  v_mfma_f32_16x16x32_bf16 v[76:79], a[140:143], v[204:207], v[76:79]
  ds_read_b64_tr_b16 a[128:129], v28 offset:16384
  v_mfma_f32_16x16x32_bf16 v[72:75], a[140:143], v[196:199], 0
  ds_read_b64_tr_b16 a[130:131], v28 offset:20480
  v_mfma_f32_16x16x32_bf16 v[72:75], a[136:139], v[192:195], v[72:75]
  ds_read_b64_tr_b16 a[132:133], v28 offset:24576
  v_mfma_f32_16x16x32_bf16 v[80:83], a[144:147], v[192:195], 0
  ds_read_b64_tr_b16 a[134:135], v28 offset:28672
  v_mfma_f32_16x16x32_bf16 v[80:83], a[148:151], v[196:199], v[80:83]
  v_mfma_f32_16x16x32_bf16 v[84:87], a[148:151], v[204:207], 0
  s_xor_b32 s32, s100, 0x80000
  v_mfma_f32_16x16x32_bf16 v[84:87], a[144:147], v[200:203], v[84:87]
  s_add_u32 m0, s37, 65536
  v_mfma_f32_16x16x32_bf16 v[92:95], a[152:155], v[200:203], 0
  ds_read_b64_tr_b16 a[136:137], v29 offset:16384
  v_mfma_f32_16x16x32_bf16 v[92:95], a[156:159], v[204:207], v[92:95]
  ds_read_b64_tr_b16 a[138:139], v29 offset:20480
  v_mfma_f32_16x16x32_bf16 v[88:91], a[156:159], v[196:199], 0
  buffer_load_dwordx4 v24, s[44:47], s32 offen offset:0  lds
  v_mfma_f32_16x16x32_bf16 v[88:91], a[152:155], v[192:195], v[88:91]
  ds_read_b64_tr_b16 a[140:141], v29 offset:24576
  v_mfma_f32_16x16x32_bf16 v[96:99], a[160:163], v[192:195], 0
  ds_read_b64_tr_b16 a[142:143], v29 offset:28672
  v_mfma_f32_16x16x32_bf16 v[96:99], a[164:167], v[196:199], v[96:99]
  v_mfma_f32_16x16x32_bf16 v[100:103], a[164:167], v[204:207], 0
  buffer_load_dwordx4 v25, s[44:47], s32 offen offset:1024  lds
  v_mfma_f32_16x16x32_bf16 v[100:103], a[160:163], v[200:203], v[100:103]
  v_mfma_f32_16x16x32_bf16 v[108:111], a[168:171], v[200:203], 0
  ds_read_b64_tr_b16 a[144:145], v30 offset:16384
  v_mfma_f32_16x16x32_bf16 v[108:111], a[172:175], v[204:207], v[108:111]
  ds_read_b64_tr_b16 a[146:147], v30 offset:20480
  v_mfma_f32_16x16x32_bf16 v[104:107], a[172:175], v[196:199], 0
  buffer_load_dwordx4 v26, s[44:47], s32 offen offset:2048  lds
  v_mfma_f32_16x16x32_bf16 v[104:107], a[168:171], v[192:195], v[104:107]
  ds_read_b64_tr_b16 a[148:149], v30 offset:24576
  v_mfma_f32_16x16x32_bf16 v[112:115], a[176:179], v[192:195], 0
  ds_read_b64_tr_b16 a[150:151], v30 offset:28672
  v_mfma_f32_16x16x32_bf16 v[112:115], a[180:183], v[196:199], v[112:115]
  v_mfma_f32_16x16x32_bf16 v[116:119], a[180:183], v[204:207], 0
  v_mfma_f32_16x16x32_bf16 v[116:119], a[176:179], v[200:203], v[116:119]
  buffer_load_dwordx4 v27, s[44:47], s32 offen offset:3072  lds
  v_mfma_f32_16x16x32_bf16 v[124:127], a[184:187], v[200:203], 0
  ds_read_b64_tr_b16 a[152:153], v31 offset:16384
  v_mfma_f32_16x16x32_bf16 v[124:127], a[188:191], v[204:207], v[124:127]
  ds_read_b64_tr_b16 a[154:155], v31 offset:20480
  v_mfma_f32_16x16x32_bf16 v[120:123], a[188:191], v[196:199], 0
  ds_read_b64_tr_b16 a[156:157], v31 offset:24576
  v_mfma_f32_16x16x32_bf16 v[120:123], a[184:187], v[192:195], v[120:123]
  s_waitcnt vmcnt(28) lgkmcnt(13)
  buffer_store_dwordx4 a[68:71], v3, s[24:27], 0 offen offset:1024 sc1
  v_mfma_f32_16x16x32_bf16 v[64:67], a[128:131], v[224:227], v[64:67]
  s_waitcnt vmcnt(25) lgkmcnt(11)
  ds_read_b64_tr_b16 a[158:159], v31 offset:28672
  v_mfma_f32_16x16x32_bf16 v[64:67], a[132:135], v[228:231], v[64:67]
  s_waitcnt vmcnt(24)
  v_mfma_f32_16x16x32_bf16 v[68:71], a[132:135], v[236:239], v[68:71]
  v_mfma_f32_16x16x32_bf16 v[68:71], a[128:131], v[232:235], v[68:71]
  v_mfma_f32_16x16x32_bf16 v[128:131], a[128:131], v[240:243], v[128:131]
  s_waitcnt vmcnt(23)
  ds_read_b64_tr_b16 a[160:161], v32 offset:16384
  v_mfma_f32_16x16x32_bf16 v[128:131], a[132:135], v[244:247], v[128:131]
  s_waitcnt vmcnt(22)
  ds_read_b64_tr_b16 a[162:163], v32 offset:20480
  v_mfma_f32_16x16x32_bf16 v[132:135], a[132:135], v[252:255], v[132:135]
  ds_read_b64_tr_b16 a[164:165], v32 offset:24576
  v_mfma_f32_16x16x32_bf16 v[132:135], a[128:131], v[248:251], v[132:135]
  s_waitcnt lgkmcnt(13)
  ds_read_b64_tr_b16 a[166:167], v32 offset:28672
  v_mfma_f32_16x16x32_bf16 v[140:143], a[136:139], v[248:251], v[140:143]
  s_waitcnt lgkmcnt(12)
  v_mfma_f32_16x16x32_bf16 v[140:143], a[140:143], v[252:255], v[140:143]
  buffer_store_dwordx4 a[72:75], v3, s[24:27], 0 offen offset:2048 sc1
  v_mfma_f32_16x16x32_bf16 v[136:139], a[140:143], v[244:247], v[136:139]
  v_mfma_f32_16x16x32_bf16 v[136:139], a[136:139], v[240:243], v[136:139]
  v_mfma_f32_16x16x32_bf16 v[76:79], a[136:139], v[232:235], v[76:79]
  ds_read_b64_tr_b16 a[168:169], v33 offset:16384
  v_mfma_f32_16x16x32_bf16 v[76:79], a[140:143], v[236:239], v[76:79]
  ds_read_b64_tr_b16 a[170:171], v33 offset:20480
  v_mfma_f32_16x16x32_bf16 v[72:75], a[140:143], v[228:231], v[72:75]
  ds_read_b64_tr_b16 a[172:173], v33 offset:24576
  v_mfma_f32_16x16x32_bf16 v[72:75], a[136:139], v[224:227], v[72:75]
  s_waitcnt lgkmcnt(13)
  ds_read_b64_tr_b16 a[174:175], v33 offset:28672
  v_mfma_f32_16x16x32_bf16 v[80:83], a[144:147], v[224:227], v[80:83]
  s_waitcnt lgkmcnt(12)
  s_xor_b32 s34, s101, 0x10000
  v_mfma_f32_16x16x32_bf16 v[80:83], a[148:151], v[228:231], v[80:83]
  v_mfma_f32_16x16x32_bf16 v[84:87], a[148:151], v[236:239], v[84:87]
  v_mfma_f32_16x16x32_bf16 v[84:87], a[144:147], v[232:235], v[84:87]
  buffer_load_dwordx4 a[0:3], v60, s[40:43], s34 offen offset:0 sc1
  v_mfma_f32_16x16x32_bf16 v[144:147], a[144:147], v[240:243], v[144:147]
  ds_read_b64_tr_b16 a[176:177], v34 offset:16384
  v_mfma_f32_16x16x32_bf16 v[144:147], a[148:151], v[244:247], v[144:147]
  ds_read_b64_tr_b16 a[178:179], v34 offset:20480
  v_mfma_f32_16x16x32_bf16 v[148:151], a[148:151], v[252:255], v[148:151]
  ds_read_b64_tr_b16 a[180:181], v34 offset:24576
  v_mfma_f32_16x16x32_bf16 v[148:151], a[144:147], v[248:251], v[148:151]
  s_waitcnt lgkmcnt(13)
  buffer_load_dwordx4 a[8:11], v60, s[40:43], s34 offen offset:1024 sc1
  v_mfma_f32_16x16x32_bf16 v[156:159], a[152:155], v[248:251], v[156:159]
  s_waitcnt lgkmcnt(11)
  ds_read_b64_tr_b16 a[182:183], v34 offset:28672
  v_mfma_f32_16x16x32_bf16 v[156:159], a[156:159], v[252:255], v[156:159]
  v_mfma_f32_16x16x32_bf16 v[152:155], a[156:159], v[244:247], v[152:155]
  v_mfma_f32_16x16x32_bf16 v[152:155], a[152:155], v[240:243], v[152:155]
  v_mfma_f32_16x16x32_bf16 v[92:95], a[152:155], v[232:235], v[92:95]
  buffer_load_dwordx4 a[16:19], v61, s[40:43], s34 offen offset:0 sc1
  v_mfma_f32_16x16x32_bf16 v[92:95], a[156:159], v[236:239], v[92:95]
  ds_read_b64_tr_b16 a[184:185], v35 offset:16384
  v_mfma_f32_16x16x32_bf16 v[88:91], a[156:159], v[228:231], v[88:91]
  ds_read_b64_tr_b16 a[186:187], v35 offset:20480
  v_mfma_f32_16x16x32_bf16 v[88:91], a[152:155], v[224:227], v[88:91]
  s_waitcnt lgkmcnt(12)
  ds_read_b64_tr_b16 a[188:189], v35 offset:24576
  v_mfma_f32_16x16x32_bf16 v[96:99], a[160:163], v[224:227], v[96:99]
  s_waitcnt lgkmcnt(11)
  buffer_load_dwordx4 a[24:27], v61, s[40:43], s34 offen offset:1024 sc1
  v_mfma_f32_16x16x32_bf16 v[96:99], a[164:167], v[228:231], v[96:99]
  ds_read_b64_tr_b16 a[190:191], v35 offset:28672
  v_mfma_f32_16x16x32_bf16 v[100:103], a[164:167], v[236:239], v[100:103]
  v_mfma_f32_16x16x32_bf16 v[100:103], a[160:163], v[232:235], v[100:103]
  s_barrier
  v_mfma_f32_16x16x32_bf16 v[160:163], a[160:163], v[240:243], v[160:163]
  buffer_store_dwordx4 a[76:79], v3, s[24:27], 0 offen offset:3072 sc1
  v_mfma_f32_16x16x32_bf16 v[160:163], a[164:167], v[244:247], v[160:163]
  ds_read_b64_tr_b16 a[128:129], v28 offset:32768
  v_lshrrev_b32 v14, 4, v1
  v_mfma_f32_16x16x32_bf16 v[164:167], a[164:167], v[252:255], v[164:167]
  ds_read_b64_tr_b16 a[130:131], v28 offset:36864
  v_bfe_u32 v15, v1, 2, 2
  v_mfma_f32_16x16x32_bf16 v[164:167], a[160:163], v[248:251], v[164:167]
  s_waitcnt lgkmcnt(12)
  ds_read_b64_tr_b16 a[132:133], v28 offset:40960
  v_cmp_eq_u32 s[84:85], v14, v15
  v_mfma_f32_16x16x32_bf16 v[172:175], a[168:171], v[248:251], v[172:175]
  s_waitcnt lgkmcnt(11)
  ds_read_b64_tr_b16 a[134:135], v28 offset:45056
  v_and_b32 v14, 1, v1
  v_mfma_f32_16x16x32_bf16 v[172:175], a[172:175], v[252:255], v[172:175]
  v_lshlrev_b32 v14, 4, v14
  v_mov_b32 v15, 0x3f80
  v_mfma_f32_16x16x32_bf16 v[168:171], a[172:175], v[244:247], v[168:171]
  v_lshlrev_b32 v14, v14, v15
  v_cndmask_b32 v14, 0, v14, s[84:85]
  v_mfma_f32_16x16x32_bf16 v[168:171], a[168:171], v[240:243], v[168:171]
  s_xor_b32 s34, s101, 0x12000
  v_and_b32 v15, 2, v1
  v_cmp_eq_u32 s[84:85], 0, v15
  v_mfma_f32_16x16x32_bf16 v[108:111], a[168:171], v[232:235], v[108:111]
  ds_read_b64_tr_b16 a[136:137], v29 offset:32768
  v_mov_b32 v16, 0
  v_mfma_f32_16x16x32_bf16 v[108:111], a[172:175], v[236:239], v[108:111]
  ds_read_b64_tr_b16 a[138:139], v29 offset:36864
  v_mov_b32 v17, 0
  v_mfma_f32_16x16x32_bf16 v[104:107], a[172:175], v[228:231], v[104:107]
  buffer_load_dwordx4 a[4:7], v60, s[40:43], s34 offen offset:0 sc1
  v_mfma_f32_16x16x32_bf16 v[104:107], a[168:171], v[224:227], v[104:107]
  s_waitcnt lgkmcnt(12)
  ds_read_b64_tr_b16 a[140:141], v29 offset:40960
  v_mov_b32 v20, 0
  v_mfma_f32_16x16x32_bf16 v[112:115], a[176:179], v[224:227], v[112:115]
  s_waitcnt lgkmcnt(11)
  ds_read_b64_tr_b16 a[142:143], v29 offset:45056
  v_mov_b32 v21, 0
  v_mfma_f32_16x16x32_bf16 v[112:115], a[180:183], v[228:231], v[112:115]
  v_cndmask_b32 v18, 0, v14, s[84:85]
  v_cndmask_b32 v19, v14, 0, s[84:85]
  v_mfma_f32_16x16x32_bf16 v[116:119], a[180:183], v[236:239], v[116:119]
  v_mfma_f32_16x16x32_bf16 v[116:119], a[176:179], v[232:235], v[116:119]
  buffer_load_dwordx4 a[12:15], v60, s[40:43], s34 offen offset:1024 sc1
  v_mfma_f32_16x16x32_bf16 v[176:179], a[176:179], v[240:243], v[176:179]
  ds_read_b64_tr_b16 a[144:145], v30 offset:32768
  v_mfma_f32_16x16x32_bf16 v[176:179], a[180:183], v[244:247], v[176:179]
  ds_read_b64_tr_b16 a[146:147], v30 offset:36864
  v_mfma_f32_16x16x32_bf16 v[180:183], a[180:183], v[252:255], v[180:183]
  ds_read_b64_tr_b16 a[148:149], v30 offset:40960
  v_mfma_f32_16x16x32_bf16 v[180:183], a[176:179], v[248:251], v[180:183]
  s_waitcnt lgkmcnt(13)
  buffer_load_dwordx4 a[20:23], v61, s[40:43], s34 offen offset:0 sc1
  v_mfma_f32_16x16x32_bf16 v[188:191], a[184:187], v[248:251], v[188:191]
  s_waitcnt lgkmcnt(11)
  ds_read_b64_tr_b16 a[150:151], v30 offset:45056
  v_mfma_f32_16x16x32_bf16 v[188:191], a[188:191], v[252:255], v[188:191]
  v_mfma_f32_16x16x32_bf16 v[184:187], a[188:191], v[244:247], v[184:187]
  v_mfma_f32_16x16x32_bf16 v[184:187], a[184:187], v[240:243], v[184:187]
  buffer_load_dwordx4 a[28:31], v61, s[40:43], s34 offen offset:1024 sc1
  v_mfma_f32_16x16x32_bf16 v[124:127], a[184:187], v[232:235], v[124:127]
  s_xor_b32 s32, s100, 0xa0000
  ds_read_b64_tr_b16 a[152:153], v31 offset:32768
  v_mfma_f32_16x16x32_bf16 v[124:127], a[188:191], v[236:239], v[124:127]
  s_add_u32 m0, s37, 81920
  ds_read_b64_tr_b16 a[154:155], v31 offset:36864
  v_mfma_f32_16x16x32_bf16 v[120:123], a[188:191], v[228:231], v[120:123]
  ds_read_b64_tr_b16 a[156:157], v31 offset:40960
  v_mfma_f32_16x16x32_bf16 v[120:123], a[184:187], v[224:227], v[120:123]
  s_waitcnt vmcnt(31) lgkmcnt(13)
  buffer_load_dwordx4 v24, s[44:47], s32 offen offset:0  lds
  v_mfma_f32_16x16x32_bf16 v[64:67], a[128:131], a[192:195], v[64:67]
  s_waitcnt vmcnt(28) lgkmcnt(11)
  ds_read_b64_tr_b16 a[158:159], v31 offset:45056
  v_mfma_f32_16x16x32_bf16 v[64:67], a[132:135], a[196:199], v[64:67]
  s_waitcnt vmcnt(27)
  v_mfma_f32_16x16x32_bf16 v[68:71], a[132:135], a[204:207], v[68:71]
  v_mfma_f32_16x16x32_bf16 v[68:71], a[128:131], a[200:203], v[68:71]
  v_mfma_f32_16x16x32_bf16 v[128:131], a[128:131], a[208:211], v[128:131]
  s_waitcnt vmcnt(26)
  buffer_load_dwordx4 v25, s[44:47], s32 offen offset:1024  lds
  v_mfma_f32_16x16x32_bf16 v[128:131], a[132:135], a[212:215], v[128:131]
  s_waitcnt vmcnt(26)
  ds_read_b64_tr_b16 a[160:161], v32 offset:32768
  v_mfma_f32_16x16x32_bf16 v[132:135], a[132:135], a[220:223], v[132:135]
  ds_read_b64_tr_b16 a[162:163], v32 offset:36864
  v_mfma_f32_16x16x32_bf16 v[132:135], a[128:131], a[216:219], v[132:135]
  s_waitcnt lgkmcnt(12)
  ds_read_b64_tr_b16 a[164:165], v32 offset:40960
  v_mfma_f32_16x16x32_bf16 v[140:143], a[136:139], a[216:219], v[140:143]
  s_waitcnt lgkmcnt(11)
  buffer_load_dwordx4 v26, s[44:47], s32 offen offset:2048  lds
  v_mfma_f32_16x16x32_bf16 v[140:143], a[140:143], a[220:223], v[140:143]
  ds_read_b64_tr_b16 a[166:167], v32 offset:45056
  v_mfma_f32_16x16x32_bf16 v[136:139], a[140:143], a[212:215], v[136:139]
  v_mfma_f32_16x16x32_bf16 v[136:139], a[136:139], a[208:211], v[136:139]
  v_mfma_f32_16x16x32_bf16 v[76:79], a[136:139], a[200:203], v[76:79]
  buffer_load_dwordx4 v27, s[44:47], s32 offen offset:3072  lds
  v_mfma_f32_16x16x32_bf16 v[76:79], a[140:143], a[204:207], v[76:79]
  ds_read_b64_tr_b16 a[168:169], v33 offset:32768
  v_mfma_f32_16x16x32_bf16 v[72:75], a[140:143], a[196:199], v[72:75]
  s_xor_b32 s34, s101, 0x14000
  ds_read_b64_tr_b16 a[170:171], v33 offset:36864
  v_mfma_f32_16x16x32_bf16 v[72:75], a[136:139], a[192:195], v[72:75]
  s_waitcnt lgkmcnt(12)
  ds_read_b64_tr_b16 a[172:173], v33 offset:40960
  v_mfma_f32_16x16x32_bf16 v[80:83], a[144:147], a[192:195], v[80:83]
  s_waitcnt lgkmcnt(11)
  ds_read_b64_tr_b16 a[174:175], v33 offset:45056
  v_mfma_f32_16x16x32_bf16 v[80:83], a[148:151], a[196:199], v[80:83]
  buffer_load_dwordx4 a[32:35], v60, s[40:43], s34 offen offset:0 sc1
  v_mfma_f32_16x16x32_bf16 v[84:87], a[148:151], a[204:207], v[84:87]
  v_mfma_f32_16x16x32_bf16 v[84:87], a[144:147], a[200:203], v[84:87]
  v_mfma_f32_16x16x32_bf16 v[144:147], a[144:147], a[208:211], v[144:147]
  ds_read_b64_tr_b16 a[176:177], v34 offset:32768
  v_mfma_f32_16x16x32_bf16 v[144:147], a[148:151], a[212:215], v[144:147]
  buffer_load_dwordx4 a[40:43], v60, s[40:43], s34 offen offset:1024 sc1
  v_mfma_f32_16x16x32_bf16 v[148:151], a[148:151], a[220:223], v[148:151]
  ds_read_b64_tr_b16 a[178:179], v34 offset:36864
  v_mfma_f32_16x16x32_bf16 v[148:151], a[144:147], a[216:219], v[148:151]
  s_waitcnt lgkmcnt(12)
  ds_read_b64_tr_b16 a[180:181], v34 offset:40960
  v_mfma_f32_16x16x32_bf16 v[156:159], a[152:155], a[216:219], v[156:159]
  s_waitcnt lgkmcnt(11)
  ds_read_b64_tr_b16 a[182:183], v34 offset:45056
  v_mfma_f32_16x16x32_bf16 v[156:159], a[156:159], a[220:223], v[156:159]
  buffer_load_dwordx4 a[48:51], v61, s[40:43], s34 offen offset:0 sc1
  v_mfma_f32_16x16x32_bf16 v[152:155], a[156:159], a[212:215], v[152:155]
  v_mfma_f32_16x16x32_bf16 v[152:155], a[152:155], a[208:211], v[152:155]
  v_mfma_f32_16x16x32_bf16 v[92:95], a[152:155], a[200:203], v[92:95]
  ds_read_b64_tr_b16 a[184:185], v35 offset:32768
  v_mfma_f32_16x16x32_bf16 v[92:95], a[156:159], a[204:207], v[92:95]
  ds_read_b64_tr_b16 a[186:187], v35 offset:36864
  v_mfma_f32_16x16x32_bf16 v[88:91], a[156:159], a[196:199], v[88:91]
  buffer_load_dwordx4 a[56:59], v61, s[40:43], s34 offen offset:1024 sc1
  v_mfma_f32_16x16x32_bf16 v[88:91], a[152:155], a[192:195], v[88:91]
  s_waitcnt lgkmcnt(12)
  s_xor_b32 s34, s101, 0x16000
  ds_read_b64_tr_b16 a[188:189], v35 offset:40960
  v_mfma_f32_16x16x32_bf16 v[96:99], a[160:163], a[192:195], v[96:99]
  s_waitcnt lgkmcnt(11)
  ds_read_b64_tr_b16 a[190:191], v35 offset:45056
  v_mfma_f32_16x16x32_bf16 v[96:99], a[164:167], a[196:199], v[96:99]
  v_mfma_f32_16x16x32_bf16 v[100:103], a[164:167], a[204:207], v[100:103]
  buffer_load_dwordx4 a[36:39], v60, s[40:43], s34 offen offset:0 sc1
  v_mfma_f32_16x16x32_bf16 v[100:103], a[160:163], a[200:203], v[100:103]
  s_barrier
  v_mfma_f32_16x16x32_bf16 v[160:163], a[160:163], a[208:211], v[160:163]
  ds_read_b64_tr_b16 a[128:129], v28 offset:49152
  v_mfma_f32_16x16x32_bf16 v[160:163], a[164:167], a[212:215], v[160:163]
  ds_read_b64_tr_b16 a[130:131], v28 offset:53248
  v_mfma_f32_16x16x32_bf16 v[164:167], a[164:167], a[220:223], v[164:167]
  buffer_load_dwordx4 a[44:47], v60, s[40:43], s34 offen offset:1024 sc1
  v_mfma_f32_16x16x32_bf16 v[164:167], a[160:163], a[216:219], v[164:167]
  s_waitcnt lgkmcnt(12)
  ds_read_b64_tr_b16 a[132:133], v28 offset:57344
  v_mfma_f32_16x16x32_bf16 v[172:175], a[168:171], a[216:219], v[172:175]
  s_waitcnt lgkmcnt(11)
  ds_read_b64_tr_b16 a[134:135], v28 offset:61440
  v_mfma_f32_16x16x32_bf16 v[172:175], a[172:175], a[220:223], v[172:175]
  v_mfma_f32_16x16x32_bf16 v[168:171], a[172:175], a[212:215], v[168:171]
  v_mfma_f32_16x16x32_bf16 v[168:171], a[168:171], a[208:211], v[168:171]
  buffer_load_dwordx4 a[52:55], v61, s[40:43], s34 offen offset:0 sc1
  v_mfma_f32_16x16x32_bf16 v[108:111], a[168:171], a[200:203], v[108:111]
  ds_read_b64_tr_b16 a[136:137], v29 offset:49152
  v_mfma_f32_16x16x32_bf16 v[108:111], a[172:175], a[204:207], v[108:111]
  ds_read_b64_tr_b16 a[138:139], v29 offset:53248
  v_mfma_f32_16x16x32_bf16 v[104:107], a[172:175], a[196:199], v[104:107]
  ds_read_b64_tr_b16 a[140:141], v29 offset:57344
  v_mfma_f32_16x16x32_bf16 v[104:107], a[168:171], a[192:195], v[104:107]
  s_waitcnt lgkmcnt(13)
  buffer_load_dwordx4 a[60:63], v61, s[40:43], s34 offen offset:1024 sc1
  v_mfma_f32_16x16x32_bf16 v[112:115], a[176:179], a[192:195], v[112:115]
  s_waitcnt lgkmcnt(11)
  s_xor_b32 s32, s100, 0xc0000
  ds_read_b64_tr_b16 a[142:143], v29 offset:61440
  v_mfma_f32_16x16x32_bf16 v[112:115], a[180:183], a[196:199], v[112:115]
  s_add_u32 m0, s37, 98304
  v_mfma_f32_16x16x32_bf16 v[116:119], a[180:183], a[204:207], v[116:119]
  v_mfma_f32_16x16x32_bf16 v[116:119], a[176:179], a[200:203], v[116:119]
  buffer_load_dwordx4 v24, s[44:47], s32 offen offset:0  lds
  v_mfma_f32_16x16x32_bf16 v[176:179], a[176:179], a[208:211], v[176:179]
  ds_read_b64_tr_b16 a[144:145], v30 offset:49152
  v_mfma_f32_16x16x32_bf16 v[176:179], a[180:183], a[212:215], v[176:179]
  ds_read_b64_tr_b16 a[146:147], v30 offset:53248
  v_mfma_f32_16x16x32_bf16 v[180:183], a[180:183], a[220:223], v[180:183]
  ds_read_b64_tr_b16 a[148:149], v30 offset:57344
  v_mfma_f32_16x16x32_bf16 v[180:183], a[176:179], a[216:219], v[180:183]
  s_waitcnt lgkmcnt(13)
  buffer_load_dwordx4 v25, s[44:47], s32 offen offset:1024  lds
  v_mfma_f32_16x16x32_bf16 v[188:191], a[184:187], a[216:219], v[188:191]
  s_waitcnt lgkmcnt(11)
  ds_read_b64_tr_b16 a[150:151], v30 offset:61440
  v_mfma_f32_16x16x32_bf16 v[188:191], a[188:191], a[220:223], v[188:191]
  v_mfma_f32_16x16x32_bf16 v[184:187], a[188:191], a[212:215], v[184:187]
  v_mfma_f32_16x16x32_bf16 v[184:187], a[184:187], a[208:211], v[184:187]
  v_mfma_f32_16x16x32_bf16 v[124:127], a[184:187], a[200:203], v[124:127]
  buffer_load_dwordx4 v26, s[44:47], s32 offen offset:2048  lds
  v_mfma_f32_16x16x32_bf16 v[124:127], a[188:191], a[204:207], v[124:127]
  ds_read_b64_tr_b16 a[152:153], v31 offset:49152
  v_mfma_f32_16x16x32_bf16 v[120:123], a[188:191], a[196:199], v[120:123]
  ds_read_b64_tr_b16 a[154:155], v31 offset:53248
  v_mfma_f32_16x16x32_bf16 v[120:123], a[184:187], a[192:195], v[120:123]
  s_waitcnt vmcnt(38) lgkmcnt(12)
  ds_read_b64_tr_b16 a[156:157], v31 offset:57344
  v_mfma_f32_16x16x32_bf16 v[64:67], a[128:131], a[224:227], v[64:67]
  s_waitcnt vmcnt(34) lgkmcnt(11)
  buffer_load_dwordx4 v27, s[44:47], s32 offen offset:3072  lds
  v_mfma_f32_16x16x32_bf16 v[64:67], a[132:135], a[228:231], v[64:67]
  s_waitcnt vmcnt(34)
  s_xor_b32 s34, s101, 0x18000
  ds_read_b64_tr_b16 a[158:159], v31 offset:61440
  v_mfma_f32_16x16x32_bf16 v[68:71], a[132:135], a[236:239], v[68:71]
  v_mfma_f32_16x16x32_bf16 v[68:71], a[128:131], a[232:235], v[68:71]
  v_mfma_f32_16x16x32_bf16 v[128:131], a[128:131], a[240:243], v[128:131]
  s_waitcnt vmcnt(33)
  buffer_load_dwordx4 a[64:67], v60, s[40:43], s34 offen offset:0 sc1
  v_mfma_f32_16x16x32_bf16 v[128:131], a[132:135], a[244:247], v[128:131]
  s_waitcnt vmcnt(33)
  ds_read_b64_tr_b16 a[160:161], v32 offset:49152
  v_mfma_f32_16x16x32_bf16 v[132:135], a[132:135], a[252:255], v[132:135]
  ds_read_b64_tr_b16 a[162:163], v32 offset:53248
  v_mfma_f32_16x16x32_bf16 v[132:135], a[128:131], a[248:251], v[132:135]
  s_waitcnt vmcnt(21) lgkmcnt(12)
  ds_read_b64_tr_b16 a[164:165], v32 offset:57344
  v_mfma_f32_16x16x32_bf16 v[140:143], a[136:139], a[248:251], v[140:143]
  s_barrier
  s_waitcnt lgkmcnt(11)
  v_mfma_f32_16x16x32_bf16 v[140:143], a[140:143], a[252:255], v[140:143]
  buffer_load_dwordx4 a[72:75], v60, s[40:43], s34 offen offset:1024 sc1
  v_mfma_f32_16x16x32_bf16 v[136:139], a[140:143], a[244:247], v[136:139]
  ds_read_b64_tr_b16 a[166:167], v32 offset:61440
  v_mfma_f32_16x16x32_bf16 v[136:139], a[136:139], a[240:243], v[136:139]
  v_mfma_f32_16x16x32_bf16 v[76:79], a[136:139], a[232:235], v[76:79]
  ds_read_b64_tr_b16 a[168:169], v33 offset:49152
  v_mfma_f32_16x16x32_bf16 v[76:79], a[140:143], a[236:239], v[76:79]
  buffer_load_dwordx4 a[80:83], v61, s[40:43], s34 offen offset:0 sc1
  v_mfma_f32_16x16x32_bf16 v[72:75], a[140:143], a[228:231], v[72:75]
  ds_read_b64_tr_b16 a[170:171], v33 offset:53248
  v_mfma_f32_16x16x32_bf16 v[72:75], a[136:139], a[224:227], v[72:75]
  s_waitcnt lgkmcnt(12)
  ds_read_b64_tr_b16 a[172:173], v33 offset:57344
  v_mfma_f32_16x16x32_bf16 v[80:83], a[144:147], a[224:227], v[80:83]
  s_waitcnt lgkmcnt(11)
  ds_read_b64_tr_b16 a[174:175], v33 offset:61440
  v_mfma_f32_16x16x32_bf16 v[80:83], a[148:151], a[228:231], v[80:83]
  buffer_load_dwordx4 a[88:91], v61, s[40:43], s34 offen offset:1024 sc1
  v_mfma_f32_16x16x32_bf16 v[84:87], a[148:151], a[236:239], v[84:87]
  v_mfma_f32_16x16x32_bf16 v[84:87], a[144:147], a[232:235], v[84:87]
  s_lshl_b32 s98, s2, 11
  v_mfma_f32_16x16x32_bf16 v[144:147], a[144:147], a[240:243], v[144:147]
  ds_read_b64_tr_b16 a[176:177], v34 offset:49152
  v_mfma_f32_16x16x32_bf16 v[144:147], a[148:151], a[244:247], v[144:147]
  ds_read_b64_tr_b16 a[178:179], v34 offset:53248
  v_mfma_f32_16x16x32_bf16 v[148:151], a[148:151], a[252:255], v[148:151]
  buffer_store_dword v9, v8, s[20:23], s98 offen sc1
  v_mfma_f32_16x16x32_bf16 v[148:151], a[144:147], a[248:251], v[148:151]
  s_waitcnt lgkmcnt(12)
  s_xor_b32 s34, s101, 0x1a000
  ds_read_b64_tr_b16 a[180:181], v34 offset:57344
  v_mfma_f32_16x16x32_bf16 v[156:159], a[152:155], a[248:251], v[156:159]
  s_waitcnt lgkmcnt(11)
  buffer_load_dwordx4 a[68:71], v60, s[40:43], s34 offen offset:0 sc1
  v_mfma_f32_16x16x32_bf16 v[156:159], a[156:159], a[252:255], v[156:159]
  ds_read_b64_tr_b16 a[182:183], v34 offset:61440
  v_mfma_f32_16x16x32_bf16 v[152:155], a[156:159], a[244:247], v[152:155]
  v_mfma_f32_16x16x32_bf16 v[152:155], a[152:155], a[240:243], v[152:155]
  v_mfma_f32_16x16x32_bf16 v[92:95], a[152:155], a[232:235], v[92:95]
  buffer_load_dwordx4 a[76:79], v60, s[40:43], s34 offen offset:1024 sc1
  v_mfma_f32_16x16x32_bf16 v[92:95], a[156:159], a[236:239], v[92:95]
  ds_read_b64_tr_b16 a[184:185], v35 offset:49152
  v_mfma_f32_16x16x32_bf16 v[88:91], a[156:159], a[228:231], v[88:91]
  ds_read_b64_tr_b16 a[186:187], v35 offset:53248
  v_mfma_f32_16x16x32_bf16 v[88:91], a[152:155], a[224:227], v[88:91]
  s_waitcnt lgkmcnt(12)
  ds_read_b64_tr_b16 a[188:189], v35 offset:57344
  v_mfma_f32_16x16x32_bf16 v[96:99], a[160:163], a[224:227], v[96:99]
  s_waitcnt lgkmcnt(11)
  buffer_load_dwordx4 a[84:87], v61, s[40:43], s34 offen offset:0 sc1
  v_mfma_f32_16x16x32_bf16 v[96:99], a[164:167], a[228:231], v[96:99]
  ds_read_b64_tr_b16 a[190:191], v35 offset:61440
  v_mfma_f32_16x16x32_bf16 v[100:103], a[164:167], a[236:239], v[100:103]
  v_mfma_f32_16x16x32_bf16 v[100:103], a[160:163], a[232:235], v[100:103]
  s_barrier
  v_mfma_f32_16x16x32_bf16 v[160:163], a[160:163], a[240:243], v[160:163]
  buffer_load_dwordx4 a[92:95], v61, s[40:43], s34 offen offset:1024 sc1
  v_mfma_f32_16x16x32_bf16 v[160:163], a[164:167], a[244:247], v[160:163]
  s_xor_b32 s32, s100, 0xe0000
  ds_read_b64_tr_b16 a[128:129], v36 offset:0
  v_mfma_f32_16x16x32_bf16 v[164:167], a[164:167], a[252:255], v[164:167]
  s_add_u32 m0, s37, 114688
  ds_read_b64_tr_b16 a[130:131], v36 offset:4096
  v_mfma_f32_16x16x32_bf16 v[164:167], a[160:163], a[248:251], v[164:167]
  s_waitcnt lgkmcnt(12)
  ds_read_b64_tr_b16 a[132:133], v36 offset:8192
  v_mfma_f32_16x16x32_bf16 v[172:175], a[168:171], a[248:251], v[172:175]
  s_waitcnt lgkmcnt(11)
  ds_read_b64_tr_b16 a[134:135], v36 offset:12288
  v_mfma_f32_16x16x32_bf16 v[172:175], a[172:175], a[252:255], v[172:175]
  buffer_load_dwordx4 v24, s[44:47], s32 offen offset:0  lds
  v_mfma_f32_16x16x32_bf16 v[168:171], a[172:175], a[244:247], v[168:171]
  v_mfma_f32_16x16x32_bf16 v[168:171], a[168:171], a[240:243], v[168:171]
  v_mfma_f32_16x16x32_bf16 v[108:111], a[168:171], a[232:235], v[108:111]
  ds_read_b64_tr_b16 a[136:137], v37 offset:0
  v_mfma_f32_16x16x32_bf16 v[108:111], a[172:175], a[236:239], v[108:111]
  buffer_load_dwordx4 v25, s[44:47], s32 offen offset:1024  lds
  v_mfma_f32_16x16x32_bf16 v[104:107], a[172:175], a[228:231], v[104:107]
  ds_read_b64_tr_b16 a[138:139], v37 offset:4096
  v_mfma_f32_16x16x32_bf16 v[104:107], a[168:171], a[224:227], v[104:107]
  s_waitcnt lgkmcnt(12)
  ds_read_b64_tr_b16 a[140:141], v37 offset:8192
  v_mfma_f32_16x16x32_bf16 v[112:115], a[176:179], a[224:227], v[112:115]
  s_waitcnt lgkmcnt(11)
  ds_read_b64_tr_b16 a[142:143], v37 offset:12288
  v_mfma_f32_16x16x32_bf16 v[112:115], a[180:183], a[228:231], v[112:115]
  buffer_load_dwordx4 v26, s[44:47], s32 offen offset:2048  lds
  v_mfma_f32_16x16x32_bf16 v[116:119], a[180:183], a[236:239], v[116:119]
  v_mfma_f32_16x16x32_bf16 v[116:119], a[176:179], a[232:235], v[116:119]
  v_mfma_f32_16x16x32_bf16 v[176:179], a[176:179], a[240:243], v[176:179]
  ds_read_b64_tr_b16 a[144:145], v38 offset:0
  v_mfma_f32_16x16x32_bf16 v[176:179], a[180:183], a[244:247], v[176:179]
  ds_read_b64_tr_b16 a[146:147], v38 offset:4096
  v_mfma_f32_16x16x32_bf16 v[180:183], a[180:183], a[252:255], v[180:183]
  buffer_load_dwordx4 v27, s[44:47], s32 offen offset:3072  lds
  v_mfma_f32_16x16x32_bf16 v[180:183], a[176:179], a[248:251], v[180:183]
  s_waitcnt lgkmcnt(12)
  s_xor_b32 s34, s101, 0x1c000
  ds_read_b64_tr_b16 a[148:149], v38 offset:8192
  v_mfma_f32_16x16x32_bf16 v[188:191], a[184:187], a[248:251], v[188:191]
  s_waitcnt lgkmcnt(11)
  ds_read_b64_tr_b16 a[150:151], v38 offset:12288
  v_mfma_f32_16x16x32_bf16 v[188:191], a[188:191], a[252:255], v[188:191]
  v_mfma_f32_16x16x32_bf16 v[184:187], a[188:191], a[244:247], v[184:187]
  buffer_load_dwordx4 a[96:99], v60, s[40:43], s34 offen offset:0 sc1
  v_mfma_f32_16x16x32_bf16 v[184:187], a[184:187], a[240:243], v[184:187]
  v_mfma_f32_16x16x32_bf16 v[124:127], a[184:187], a[232:235], v[124:127]
  ds_read_b64_tr_b16 a[152:153], v39 offset:0
  v_mfma_f32_16x16x32_bf16 v[124:127], a[188:191], a[236:239], v[124:127]
  ds_read_b64_tr_b16 a[154:155], v39 offset:4096
  v_mfma_f32_16x16x32_bf16 v[120:123], a[188:191], a[228:231], v[120:123]
  buffer_load_dwordx4 a[104:107], v60, s[40:43], s34 offen offset:1024 sc1
  v_mfma_f32_16x16x32_bf16 v[120:123], a[184:187], a[224:227], v[120:123]
L_pad16:
  s_cbranch_execz L_hr2
  s_waitcnt lgkmcnt(12)
  ds_read_b64_tr_b16 a[156:157], v39 offset:8192
  v_mfma_f32_16x16x32_bf16 v[64:67], a[128:131], a[0:3], v[64:67]
  s_waitcnt vmcnt(34) lgkmcnt(11)
  ds_read_b64_tr_b16 a[158:159], v39 offset:12288
  v_mfma_f32_16x16x32_bf16 v[64:67], a[132:135], a[4:7], v[64:67]
  s_waitcnt vmcnt(33)
  v_mfma_f32_16x16x32_bf16 v[68:71], a[132:135], a[12:15], v[68:71]
  v_mfma_f32_16x16x32_bf16 v[68:71], a[128:131], a[8:11], v[68:71]
  buffer_load_dwordx4 a[112:115], v61, s[40:43], s34 offen offset:0 sc1
  v_mfma_f32_16x16x32_bf16 v[128:131], a[128:131], a[16:19], v[128:131]
  s_waitcnt vmcnt(33)
  ds_read_b64_tr_b16 a[160:161], v40 offset:0
  v_mfma_f32_16x16x32_bf16 v[128:131], a[132:135], a[20:23], v[128:131]
  s_waitcnt vmcnt(32)
  ds_read_b64_tr_b16 a[162:163], v40 offset:4096
  v_mfma_f32_16x16x32_bf16 v[132:135], a[132:135], a[28:31], v[132:135]
  ds_read_b64_tr_b16 a[164:165], v40 offset:8192
  v_mfma_f32_16x16x32_bf16 v[132:135], a[128:131], a[24:27], v[132:135]
  s_waitcnt lgkmcnt(13)
  buffer_load_dwordx4 a[120:123], v61, s[40:43], s34 offen offset:1024 sc1
  v_mfma_f32_16x16x32_bf16 v[140:143], a[136:139], a[24:27], v[140:143]
  s_waitcnt lgkmcnt(11)
  s_xor_b32 s34, s101, 0x1e000
  ds_read_b64_tr_b16 a[166:167], v40 offset:12288
  v_mfma_f32_16x16x32_bf16 v[140:143], a[140:143], a[28:31], v[140:143]
  v_mfma_f32_16x16x32_bf16 v[136:139], a[140:143], a[20:23], v[136:139]
  v_mfma_f32_16x16x32_bf16 v[136:139], a[136:139], a[16:19], v[136:139]
  buffer_load_dwordx4 a[100:103], v60, s[40:43], s34 offen offset:0 sc1
  v_mfma_f32_16x16x32_bf16 v[76:79], a[136:139], a[8:11], v[76:79]
  ds_read_b64_tr_b16 a[168:169], v41 offset:0
  v_mfma_f32_16x16x32_bf16 v[76:79], a[140:143], a[12:15], v[76:79]
  ds_read_b64_tr_b16 a[170:171], v41 offset:4096
  v_mfma_f32_16x16x32_bf16 v[72:75], a[140:143], a[4:7], v[72:75]
  ds_read_b64_tr_b16 a[172:173], v41 offset:8192
  v_mfma_f32_16x16x32_bf16 v[72:75], a[136:139], a[0:3], v[72:75]
  s_waitcnt lgkmcnt(13)
  buffer_load_dwordx4 a[108:111], v60, s[40:43], s34 offen offset:1024 sc1
  v_mfma_f32_16x16x32_bf16 v[80:83], a[144:147], a[0:3], v[80:83]
  s_waitcnt lgkmcnt(11)
  ds_read_b64_tr_b16 a[174:175], v41 offset:12288
  v_mfma_f32_16x16x32_bf16 v[80:83], a[148:151], a[4:7], v[80:83]
  v_mfma_f32_16x16x32_bf16 v[84:87], a[148:151], a[12:15], v[84:87]
  v_mfma_f32_16x16x32_bf16 v[84:87], a[144:147], a[8:11], v[84:87]
  v_mfma_f32_16x16x32_bf16 v[144:147], a[144:147], a[16:19], v[144:147]
  buffer_load_dwordx4 a[116:119], v61, s[40:43], s34 offen offset:0 sc1
  v_mfma_f32_16x16x32_bf16 v[144:147], a[148:151], a[20:23], v[144:147]
  ds_read_b64_tr_b16 a[176:177], v42 offset:0
  v_mfma_f32_16x16x32_bf16 v[148:151], a[148:151], a[28:31], v[148:151]
  ds_read_b64_tr_b16 a[178:179], v42 offset:4096
  v_mfma_f32_16x16x32_bf16 v[148:151], a[144:147], a[24:27], v[148:151]
  s_waitcnt lgkmcnt(12)
  ds_read_b64_tr_b16 a[180:181], v42 offset:8192
  v_mfma_f32_16x16x32_bf16 v[156:159], a[152:155], a[24:27], v[156:159]
  s_waitcnt lgkmcnt(11)
  buffer_load_dwordx4 a[124:127], v61, s[40:43], s34 offen offset:1024 sc1
  v_mfma_f32_16x16x32_bf16 v[156:159], a[156:159], a[28:31], v[156:159]
  s_xor_b32 s32, s100, 0x100000
  ds_read_b64_tr_b16 a[182:183], v42 offset:12288
  v_mfma_f32_16x16x32_bf16 v[152:155], a[156:159], a[20:23], v[152:155]
  s_add_u32 m0, s37, 0
  v_mfma_f32_16x16x32_bf16 v[152:155], a[152:155], a[16:19], v[152:155]
  v_mfma_f32_16x16x32_bf16 v[92:95], a[152:155], a[8:11], v[92:95]
  buffer_load_dwordx4 v24, s[44:47], s32 offen offset:0  lds
  v_mfma_f32_16x16x32_bf16 v[92:95], a[156:159], a[12:15], v[92:95]
  ds_read_b64_tr_b16 a[184:185], v43 offset:0
  v_mfma_f32_16x16x32_bf16 v[88:91], a[156:159], a[4:7], v[88:91]
  ds_read_b64_tr_b16 a[186:187], v43 offset:4096
  v_mfma_f32_16x16x32_bf16 v[88:91], a[152:155], a[0:3], v[88:91]
  s_waitcnt lgkmcnt(12)
  ds_read_b64_tr_b16 a[188:189], v43 offset:8192
  v_mfma_f32_16x16x32_bf16 v[96:99], a[160:163], a[0:3], v[96:99]
  s_waitcnt lgkmcnt(11)
  ds_read_b64_tr_b16 a[190:191], v43 offset:12288
  v_mfma_f32_16x16x32_bf16 v[96:99], a[164:167], a[4:7], v[96:99]
  buffer_load_dwordx4 v25, s[44:47], s32 offen offset:1024  lds
  v_mfma_f32_16x16x32_bf16 v[100:103], a[164:167], a[12:15], v[100:103]
  s_waitcnt vmcnt(35)
  v_mfma_f32_16x16x32_bf16 v[100:103], a[160:163], a[8:11], v[100:103]
  s_barrier
  v_mfma_f32_16x16x32_bf16 v[160:163], a[160:163], a[16:19], v[160:163]
  ds_read_b64_tr_b16 a[128:129], v36 offset:16384
  v_mfma_f32_16x16x32_bf16 v[160:163], a[164:167], a[20:23], v[160:163]
  buffer_load_dwordx4 v26, s[44:47], s32 offen offset:2048  lds
  v_mfma_f32_16x16x32_bf16 v[164:167], a[164:167], a[28:31], v[164:167]
  ds_read_b64_tr_b16 a[130:131], v36 offset:20480
  v_mfma_f32_16x16x32_bf16 v[164:167], a[160:163], a[24:27], v[164:167]
  s_waitcnt lgkmcnt(12)
  ds_read_b64_tr_b16 a[132:133], v36 offset:24576
  v_mfma_f32_16x16x32_bf16 v[172:175], a[168:171], a[24:27], v[172:175]
  s_waitcnt lgkmcnt(11)
  ds_read_b64_tr_b16 a[134:135], v36 offset:28672
  v_mfma_f32_16x16x32_bf16 v[172:175], a[172:175], a[28:31], v[172:175]
  buffer_load_dwordx4 v27, s[44:47], s32 offen offset:3072  lds
  v_mfma_f32_16x16x32_bf16 v[168:171], a[172:175], a[20:23], v[168:171]
  v_mfma_f32_16x16x32_bf16 v[168:171], a[168:171], a[16:19], v[168:171]
  s_xor_b32 s34, s101, 0x20000
  v_mfma_f32_16x16x32_bf16 v[108:111], a[168:171], a[8:11], v[108:111]
  ds_read_b64_tr_b16 a[136:137], v37 offset:16384
  v_mfma_f32_16x16x32_bf16 v[108:111], a[172:175], a[12:15], v[108:111]
  ds_read_b64_tr_b16 a[138:139], v37 offset:20480
  v_mfma_f32_16x16x32_bf16 v[104:107], a[172:175], a[4:7], v[104:107]
  buffer_load_dwordx4 v[192:195], v60, s[40:43], s34 offen offset:0 sc1
  v_mfma_f32_16x16x32_bf16 v[104:107], a[168:171], a[0:3], v[104:107]
  s_waitcnt lgkmcnt(12)
  ds_read_b64_tr_b16 a[140:141], v37 offset:24576
  v_mfma_f32_16x16x32_bf16 v[112:115], a[176:179], a[0:3], v[112:115]
  s_waitcnt lgkmcnt(11)
  ds_read_b64_tr_b16 a[142:143], v37 offset:28672
  v_mfma_f32_16x16x32_bf16 v[112:115], a[180:183], a[4:7], v[112:115]
  v_mfma_f32_16x16x32_bf16 v[116:119], a[180:183], a[12:15], v[116:119]
  buffer_load_dwordx4 v[200:203], v60, s[40:43], s34 offen offset:1024 sc1
  v_mfma_f32_16x16x32_bf16 v[116:119], a[176:179], a[8:11], v[116:119]
  v_mfma_f32_16x16x32_bf16 v[176:179], a[176:179], a[16:19], v[176:179]
  ds_read_b64_tr_b16 a[144:145], v38 offset:16384
  v_mfma_f32_16x16x32_bf16 v[176:179], a[180:183], a[20:23], v[176:179]
  ds_read_b64_tr_b16 a[146:147], v38 offset:20480
  v_mfma_f32_16x16x32_bf16 v[180:183], a[180:183], a[28:31], v[180:183]
  buffer_load_dwordx4 v[208:211], v61, s[40:43], s34 offen offset:0 sc1
  v_mfma_f32_16x16x32_bf16 v[180:183], a[176:179], a[24:27], v[180:183]
  s_waitcnt lgkmcnt(12)
  ds_read_b64_tr_b16 a[148:149], v38 offset:24576
  v_mfma_f32_16x16x32_bf16 v[188:191], a[184:187], a[24:27], v[188:191]
  s_waitcnt lgkmcnt(11)
  ds_read_b64_tr_b16 a[150:151], v38 offset:28672
  v_mfma_f32_16x16x32_bf16 v[188:191], a[188:191], a[28:31], v[188:191]
  v_mfma_f32_16x16x32_bf16 v[184:187], a[188:191], a[20:23], v[184:187]
  buffer_load_dwordx4 v[216:219], v61, s[40:43], s34 offen offset:1024 sc1
  v_mfma_f32_16x16x32_bf16 v[184:187], a[184:187], a[16:19], v[184:187]
  v_mfma_f32_16x16x32_bf16 v[124:127], a[184:187], a[8:11], v[124:127]
  s_xor_b32 s34, s101, 0x22000
  ds_read_b64_tr_b16 a[152:153], v39 offset:16384
  v_mfma_f32_16x16x32_bf16 v[124:127], a[188:191], a[12:15], v[124:127]
  ds_read_b64_tr_b16 a[154:155], v39 offset:20480
  v_mfma_f32_16x16x32_bf16 v[120:123], a[188:191], a[4:7], v[120:123]
  ds_read_b64_tr_b16 a[156:157], v39 offset:24576
  v_mfma_f32_16x16x32_bf16 v[120:123], a[184:187], a[0:3], v[120:123]
  s_waitcnt vmcnt(40) lgkmcnt(13)
  buffer_load_dwordx4 v[196:199], v60, s[40:43], s34 offen offset:0 sc1
  v_mfma_f32_16x16x32_bf16 v[64:67], a[128:131], a[32:35], v[64:67]
  s_waitcnt vmcnt(37) lgkmcnt(11)
  ds_read_b64_tr_b16 a[158:159], v39 offset:28672
  v_mfma_f32_16x16x32_bf16 v[64:67], a[132:135], a[36:39], v[64:67]
  s_waitcnt vmcnt(36)
  v_mfma_f32_16x16x32_bf16 v[68:71], a[132:135], a[44:47], v[68:71]
  v_mfma_f32_16x16x32_bf16 v[68:71], a[128:131], a[40:43], v[68:71]
  buffer_load_dwordx4 v[204:207], v60, s[40:43], s34 offen offset:1024 sc1
  v_mfma_f32_16x16x32_bf16 v[128:131], a[128:131], a[48:51], v[128:131]
  s_waitcnt vmcnt(36)
  ds_read_b64_tr_b16 a[160:161], v40 offset:16384
  v_mfma_f32_16x16x32_bf16 v[128:131], a[132:135], a[52:55], v[128:131]
  s_waitcnt vmcnt(35)
  ds_read_b64_tr_b16 a[162:163], v40 offset:20480
  v_mfma_f32_16x16x32_bf16 v[132:135], a[132:135], a[60:63], v[132:135]
  ds_read_b64_tr_b16 a[164:165], v40 offset:24576
  v_mfma_f32_16x16x32_bf16 v[132:135], a[128:131], a[56:59], v[132:135]
  s_waitcnt lgkmcnt(13)
  buffer_load_dwordx4 v[212:215], v61, s[40:43], s34 offen offset:0 sc1
  v_mfma_f32_16x16x32_bf16 v[140:143], a[136:139], a[56:59], v[140:143]
  s_waitcnt lgkmcnt(11)
  ds_read_b64_tr_b16 a[166:167], v40 offset:28672
  v_mfma_f32_16x16x32_bf16 v[140:143], a[140:143], a[60:63], v[140:143]
  v_mfma_f32_16x16x32_bf16 v[136:139], a[140:143], a[52:55], v[136:139]
  v_mfma_f32_16x16x32_bf16 v[136:139], a[136:139], a[48:51], v[136:139]
  v_mfma_f32_16x16x32_bf16 v[76:79], a[136:139], a[40:43], v[76:79]
  buffer_load_dwordx4 v[220:223], v61, s[40:43], s34 offen offset:1024 sc1
  v_mfma_f32_16x16x32_bf16 v[76:79], a[140:143], a[44:47], v[76:79]
  s_xor_b32 s32, s100, 0x120000
  ds_read_b64_tr_b16 a[168:169], v41 offset:16384
  v_mfma_f32_16x16x32_bf16 v[72:75], a[140:143], a[36:39], v[72:75]
  s_add_u32 m0, s37, 16384
  ds_read_b64_tr_b16 a[170:171], v41 offset:20480
  v_mfma_f32_16x16x32_bf16 v[72:75], a[136:139], a[32:35], v[72:75]
  s_waitcnt lgkmcnt(12)
  ds_read_b64_tr_b16 a[172:173], v41 offset:24576
  v_mfma_f32_16x16x32_bf16 v[80:83], a[144:147], a[32:35], v[80:83]
  s_waitcnt lgkmcnt(11)
  buffer_load_dwordx4 v24, s[44:47], s32 offen offset:0  lds
  v_mfma_f32_16x16x32_bf16 v[80:83], a[148:151], a[36:39], v[80:83]
  ds_read_b64_tr_b16 a[174:175], v41 offset:28672
  v_mfma_f32_16x16x32_bf16 v[84:87], a[148:151], a[44:47], v[84:87]
  v_mfma_f32_16x16x32_bf16 v[84:87], a[144:147], a[40:43], v[84:87]
  v_mfma_f32_16x16x32_bf16 v[144:147], a[144:147], a[48:51], v[144:147]
  buffer_load_dwordx4 v25, s[44:47], s32 offen offset:1024  lds
  v_mfma_f32_16x16x32_bf16 v[144:147], a[148:151], a[52:55], v[144:147]
  ds_read_b64_tr_b16 a[176:177], v42 offset:16384
  v_mfma_f32_16x16x32_bf16 v[148:151], a[148:151], a[60:63], v[148:151]
  ds_read_b64_tr_b16 a[178:179], v42 offset:20480
  v_mfma_f32_16x16x32_bf16 v[148:151], a[144:147], a[56:59], v[148:151]
  s_waitcnt lgkmcnt(12)
  ds_read_b64_tr_b16 a[180:181], v42 offset:24576
  v_mfma_f32_16x16x32_bf16 v[156:159], a[152:155], a[56:59], v[156:159]
  s_waitcnt lgkmcnt(11)
  ds_read_b64_tr_b16 a[182:183], v42 offset:28672
  v_mfma_f32_16x16x32_bf16 v[156:159], a[156:159], a[60:63], v[156:159]
  buffer_load_dwordx4 v26, s[44:47], s32 offen offset:2048  lds
  v_mfma_f32_16x16x32_bf16 v[152:155], a[156:159], a[52:55], v[152:155]
  v_mfma_f32_16x16x32_bf16 v[152:155], a[152:155], a[48:51], v[152:155]
  v_mfma_f32_16x16x32_bf16 v[92:95], a[152:155], a[40:43], v[92:95]
  ds_read_b64_tr_b16 a[184:185], v43 offset:16384
  v_mfma_f32_16x16x32_bf16 v[92:95], a[156:159], a[44:47], v[92:95]
  buffer_load_dwordx4 v27, s[44:47], s32 offen offset:3072  lds
  v_mfma_f32_16x16x32_bf16 v[88:91], a[156:159], a[36:39], v[88:91]
  s_xor_b32 s34, s101, 0x24000
  ds_read_b64_tr_b16 a[186:187], v43 offset:20480
  v_mfma_f32_16x16x32_bf16 v[88:91], a[152:155], a[32:35], v[88:91]
  s_waitcnt lgkmcnt(12)
  ds_read_b64_tr_b16 a[188:189], v43 offset:24576
  v_mfma_f32_16x16x32_bf16 v[96:99], a[160:163], a[32:35], v[96:99]
  s_waitcnt lgkmcnt(11)
  ds_read_b64_tr_b16 a[190:191], v43 offset:28672
  v_mfma_f32_16x16x32_bf16 v[96:99], a[164:167], a[36:39], v[96:99]
  buffer_load_dwordx4 v[224:227], v60, s[40:43], s34 offen offset:0 sc1
  v_mfma_f32_16x16x32_bf16 v[100:103], a[164:167], a[44:47], v[100:103]
  s_waitcnt vmcnt(38)
  v_mfma_f32_16x16x32_bf16 v[100:103], a[160:163], a[40:43], v[100:103]
  s_barrier
  v_mfma_f32_16x16x32_bf16 v[160:163], a[160:163], a[48:51], v[160:163]
  ds_read_b64_tr_b16 a[128:129], v36 offset:32768
  v_mfma_f32_16x16x32_bf16 v[160:163], a[164:167], a[52:55], v[160:163]
  buffer_load_dwordx4 v[232:235], v60, s[40:43], s34 offen offset:1024 sc1
  v_mfma_f32_16x16x32_bf16 v[164:167], a[164:167], a[60:63], v[164:167]
  ds_read_b64_tr_b16 a[130:131], v36 offset:36864
  v_mfma_f32_16x16x32_bf16 v[164:167], a[160:163], a[56:59], v[164:167]
  s_waitcnt lgkmcnt(12)
  ds_read_b64_tr_b16 a[132:133], v36 offset:40960
  v_mfma_f32_16x16x32_bf16 v[172:175], a[168:171], a[56:59], v[172:175]
  s_waitcnt lgkmcnt(11)
  ds_read_b64_tr_b16 a[134:135], v36 offset:45056
  v_mfma_f32_16x16x32_bf16 v[172:175], a[172:175], a[60:63], v[172:175]
  v_mfma_f32_16x16x32_bf16 v[168:171], a[172:175], a[52:55], v[168:171]
  buffer_load_dwordx4 v[240:243], v61, s[40:43], s34 offen offset:0 sc1
  v_mfma_f32_16x16x32_bf16 v[168:171], a[168:171], a[48:51], v[168:171]
  v_mfma_f32_16x16x32_bf16 v[108:111], a[168:171], a[40:43], v[108:111]
  ds_read_b64_tr_b16 a[136:137], v37 offset:32768
  v_mfma_f32_16x16x32_bf16 v[108:111], a[172:175], a[44:47], v[108:111]
  ds_read_b64_tr_b16 a[138:139], v37 offset:36864
  v_mfma_f32_16x16x32_bf16 v[104:107], a[172:175], a[36:39], v[104:107]
  buffer_load_dwordx4 v[248:251], v61, s[40:43], s34 offen offset:1024 sc1
  v_mfma_f32_16x16x32_bf16 v[104:107], a[168:171], a[32:35], v[104:107]
  s_waitcnt lgkmcnt(12)
  s_xor_b32 s34, s101, 0x26000
  ds_read_b64_tr_b16 a[140:141], v37 offset:40960
  v_mfma_f32_16x16x32_bf16 v[112:115], a[176:179], a[32:35], v[112:115]
  s_waitcnt lgkmcnt(11)
  ds_read_b64_tr_b16 a[142:143], v37 offset:45056
  v_mfma_f32_16x16x32_bf16 v[112:115], a[180:183], a[36:39], v[112:115]
  v_mfma_f32_16x16x32_bf16 v[116:119], a[180:183], a[44:47], v[116:119]
  buffer_load_dwordx4 v[228:231], v60, s[40:43], s34 offen offset:0 sc1
  v_mfma_f32_16x16x32_bf16 v[116:119], a[176:179], a[40:43], v[116:119]
  v_mfma_f32_16x16x32_bf16 v[176:179], a[176:179], a[48:51], v[176:179]
  ds_read_b64_tr_b16 a[144:145], v38 offset:32768
  v_mfma_f32_16x16x32_bf16 v[176:179], a[180:183], a[52:55], v[176:179]
  ds_read_b64_tr_b16 a[146:147], v38 offset:36864
  v_mfma_f32_16x16x32_bf16 v[180:183], a[180:183], a[60:63], v[180:183]
  ds_read_b64_tr_b16 a[148:149], v38 offset:40960
  v_mfma_f32_16x16x32_bf16 v[180:183], a[176:179], a[56:59], v[180:183]
  s_waitcnt lgkmcnt(13)
  buffer_load_dwordx4 v[236:239], v60, s[40:43], s34 offen offset:1024 sc1
  v_mfma_f32_16x16x32_bf16 v[188:191], a[184:187], a[56:59], v[188:191]
  s_waitcnt lgkmcnt(11)
  ds_read_b64_tr_b16 a[150:151], v38 offset:45056
  v_mfma_f32_16x16x32_bf16 v[188:191], a[188:191], a[60:63], v[188:191]
  v_mfma_f32_16x16x32_bf16 v[184:187], a[188:191], a[52:55], v[184:187]
  v_mfma_f32_16x16x32_bf16 v[184:187], a[184:187], a[48:51], v[184:187]
  buffer_load_dwordx4 v[244:247], v61, s[40:43], s34 offen offset:0 sc1
  v_mfma_f32_16x16x32_bf16 v[124:127], a[184:187], a[40:43], v[124:127]
  ds_read_b64_tr_b16 a[152:153], v39 offset:32768
  v_mfma_f32_16x16x32_bf16 v[124:127], a[188:191], a[44:47], v[124:127]
  ds_read_b64_tr_b16 a[154:155], v39 offset:36864
  v_mfma_f32_16x16x32_bf16 v[120:123], a[188:191], a[36:39], v[120:123]
  ds_read_b64_tr_b16 a[156:157], v39 offset:40960
  v_mfma_f32_16x16x32_bf16 v[120:123], a[184:187], a[32:35], v[120:123]
  s_waitcnt vmcnt(43) lgkmcnt(13)
  buffer_load_dwordx4 v[252:255], v61, s[40:43], s34 offen offset:1024 sc1
  v_mfma_f32_16x16x32_bf16 v[64:67], a[128:131], a[64:67], v[64:67]
  s_waitcnt vmcnt(39) lgkmcnt(11)
  s_xor_b32 s32, s100, 0x140000
  ds_read_b64_tr_b16 a[158:159], v39 offset:45056
  v_mfma_f32_16x16x32_bf16 v[64:67], a[132:135], a[68:71], v[64:67]
  s_waitcnt vmcnt(38)
  s_add_u32 m0, s37, 32768
  v_mfma_f32_16x16x32_bf16 v[68:71], a[132:135], a[76:79], v[68:71]
  v_mfma_f32_16x16x32_bf16 v[68:71], a[128:131], a[72:75], v[68:71]
  v_mfma_f32_16x16x32_bf16 v[128:131], a[128:131], a[80:83], v[128:131]
  s_waitcnt vmcnt(37)
  buffer_load_dwordx4 v24, s[44:47], s32 offen offset:0  lds
  v_mfma_f32_16x16x32_bf16 v[128:131], a[132:135], a[84:87], v[128:131]
  s_waitcnt vmcnt(37)
  ds_read_b64_tr_b16 a[160:161], v40 offset:32768
  v_mfma_f32_16x16x32_bf16 v[132:135], a[132:135], a[92:95], v[132:135]
  ds_read_b64_tr_b16 a[162:163], v40 offset:36864
  v_mfma_f32_16x16x32_bf16 v[132:135], a[128:131], a[88:91], v[132:135]
  s_waitcnt lgkmcnt(12)
  ds_read_b64_tr_b16 a[164:165], v40 offset:40960
  v_mfma_f32_16x16x32_bf16 v[140:143], a[136:139], a[88:91], v[140:143]
  s_waitcnt lgkmcnt(11)
  buffer_load_dwordx4 v25, s[44:47], s32 offen offset:1024  lds
  v_mfma_f32_16x16x32_bf16 v[140:143], a[140:143], a[92:95], v[140:143]
  ds_read_b64_tr_b16 a[166:167], v40 offset:45056
  v_mfma_f32_16x16x32_bf16 v[136:139], a[140:143], a[84:87], v[136:139]
  v_mfma_f32_16x16x32_bf16 v[136:139], a[136:139], a[80:83], v[136:139]
  v_mfma_f32_16x16x32_bf16 v[76:79], a[136:139], a[72:75], v[76:79]
  buffer_load_dwordx4 v26, s[44:47], s32 offen offset:2048  lds
  v_mfma_f32_16x16x32_bf16 v[76:79], a[140:143], a[76:79], v[76:79]
  ds_read_b64_tr_b16 a[168:169], v41 offset:32768
  v_mfma_f32_16x16x32_bf16 v[72:75], a[140:143], a[68:71], v[72:75]
  ds_read_b64_tr_b16 a[170:171], v41 offset:36864
  v_mfma_f32_16x16x32_bf16 v[72:75], a[136:139], a[64:67], v[72:75]
  s_waitcnt lgkmcnt(12)
  ds_read_b64_tr_b16 a[172:173], v41 offset:40960
  v_mfma_f32_16x16x32_bf16 v[80:83], a[144:147], a[64:67], v[80:83]
  s_waitcnt lgkmcnt(11)
  buffer_load_dwordx4 v27, s[44:47], s32 offen offset:3072  lds
  v_mfma_f32_16x16x32_bf16 v[80:83], a[148:151], a[68:71], v[80:83]
  ds_read_b64_tr_b16 a[174:175], v41 offset:45056
  v_mfma_f32_16x16x32_bf16 v[84:87], a[148:151], a[76:79], v[84:87]
  v_mfma_f32_16x16x32_bf16 v[84:87], a[144:147], a[72:75], v[84:87]
  v_mfma_f32_16x16x32_bf16 v[144:147], a[144:147], a[80:83], v[144:147]
  ds_read_b64_tr_b16 a[176:177], v42 offset:32768
  v_mfma_f32_16x16x32_bf16 v[144:147], a[148:151], a[84:87], v[144:147]
  buffer_load_dword v50, v48, s[56:59], 0 offen offset:0 sc1
  v_mfma_f32_16x16x32_bf16 v[148:151], a[148:151], a[92:95], v[148:151]
  ds_read_b64_tr_b16 a[178:179], v42 offset:36864
  v_mfma_f32_16x16x32_bf16 v[148:151], a[144:147], a[88:91], v[148:151]
  s_waitcnt lgkmcnt(12)
  ds_read_b64_tr_b16 a[180:181], v42 offset:40960
  v_mfma_f32_16x16x32_bf16 v[156:159], a[152:155], a[88:91], v[156:159]
  s_waitcnt lgkmcnt(11)
  ds_read_b64_tr_b16 a[182:183], v42 offset:45056
  v_mfma_f32_16x16x32_bf16 v[156:159], a[156:159], a[92:95], v[156:159]
  buffer_load_dword v51, v48, s[56:59], 0 offen offset:64 sc1
  v_mfma_f32_16x16x32_bf16 v[152:155], a[156:159], a[84:87], v[152:155]
  s_add_u32 m0, s37, 0x20000
  v_mfma_f32_16x16x32_bf16 v[152:155], a[152:155], a[80:83], v[152:155]
  s_mov_b32 s36, 0x0
  v_mfma_f32_16x16x32_bf16 v[92:95], a[152:155], a[72:75], v[92:95]
  ds_read_b64_tr_b16 a[184:185], v43 offset:32768
  v_mfma_f32_16x16x32_bf16 v[92:95], a[156:159], a[76:79], v[92:95]
  buffer_load_dwordx4 v46, s[48:51], s36 offen offset:0 lds
  v_mfma_f32_16x16x32_bf16 v[88:91], a[156:159], a[68:71], v[88:91]
  s_mov_b32 s36, 0x3c00
  ds_read_b64_tr_b16 a[186:187], v43 offset:36864
  v_mfma_f32_16x16x32_bf16 v[88:91], a[152:155], a[64:67], v[88:91]
  s_waitcnt lgkmcnt(12)
  ds_read_b64_tr_b16 a[188:189], v43 offset:40960
  v_mfma_f32_16x16x32_bf16 v[96:99], a[160:163], a[64:67], v[96:99]
  s_waitcnt lgkmcnt(11)
  ds_read_b64_tr_b16 a[190:191], v43 offset:45056
  v_mfma_f32_16x16x32_bf16 v[96:99], a[164:167], a[68:71], v[96:99]
  buffer_load_dwordx4 v46, s[48:51], s36 offen offset:1024 lds
  v_mfma_f32_16x16x32_bf16 v[100:103], a[164:167], a[76:79], v[100:103]
  s_mov_b32 s36, 0x7800
  v_mfma_f32_16x16x32_bf16 v[100:103], a[160:163], a[72:75], v[100:103]
  s_waitcnt vmcnt(40)
  s_barrier
  v_mfma_f32_16x16x32_bf16 v[160:163], a[160:163], a[80:83], v[160:163]
  ds_read_b64_tr_b16 a[128:129], v36 offset:49152
  v_mfma_f32_16x16x32_bf16 v[160:163], a[164:167], a[84:87], v[160:163]
  buffer_load_dwordx4 v46, s[48:51], s36 offen offset:2048 lds
  v_mfma_f32_16x16x32_bf16 v[164:167], a[164:167], a[92:95], v[164:167]
  s_mov_b32 s36, 0xb400
  ds_read_b64_tr_b16 a[130:131], v36 offset:53248
  v_mfma_f32_16x16x32_bf16 v[164:167], a[160:163], a[88:91], v[164:167]
  s_waitcnt lgkmcnt(12)
  ds_read_b64_tr_b16 a[132:133], v36 offset:57344
  v_mfma_f32_16x16x32_bf16 v[172:175], a[168:171], a[88:91], v[172:175]
  s_waitcnt lgkmcnt(11)
  ds_read_b64_tr_b16 a[134:135], v36 offset:61440
  v_mfma_f32_16x16x32_bf16 v[172:175], a[172:175], a[92:95], v[172:175]
  buffer_load_dwordx4 v46, s[48:51], s36 offen offset:3072 lds
  v_mfma_f32_16x16x32_bf16 v[168:171], a[172:175], a[84:87], v[168:171]
  s_xor_b32 s34, s101, 0x28000
  v_mfma_f32_16x16x32_bf16 v[168:171], a[168:171], a[80:83], v[168:171]
  v_mfma_f32_16x16x32_bf16 v[108:111], a[168:171], a[72:75], v[108:111]
  ds_read_b64_tr_b16 a[136:137], v37 offset:49152
  v_mfma_f32_16x16x32_bf16 v[108:111], a[172:175], a[76:79], v[108:111]
  buffer_load_dwordx4 a[192:195], v60, s[40:43], s34 offen offset:0 sc1
  v_mfma_f32_16x16x32_bf16 v[104:107], a[172:175], a[68:71], v[104:107]
  ds_read_b64_tr_b16 a[138:139], v37 offset:53248
  v_mfma_f32_16x16x32_bf16 v[104:107], a[168:171], a[64:67], v[104:107]
  s_waitcnt lgkmcnt(12)
  ds_read_b64_tr_b16 a[140:141], v37 offset:57344
  v_mfma_f32_16x16x32_bf16 v[112:115], a[176:179], a[64:67], v[112:115]
  s_waitcnt lgkmcnt(11)
  ds_read_b64_tr_b16 a[142:143], v37 offset:61440
  v_mfma_f32_16x16x32_bf16 v[112:115], a[180:183], a[68:71], v[112:115]
  buffer_load_dwordx4 a[200:203], v60, s[40:43], s34 offen offset:1024 sc1
  v_mfma_f32_16x16x32_bf16 v[116:119], a[180:183], a[76:79], v[116:119]
  v_mfma_f32_16x16x32_bf16 v[116:119], a[176:179], a[72:75], v[116:119]
  v_mfma_f32_16x16x32_bf16 v[176:179], a[176:179], a[80:83], v[176:179]
  ds_read_b64_tr_b16 a[144:145], v38 offset:49152
  v_mfma_f32_16x16x32_bf16 v[176:179], a[180:183], a[84:87], v[176:179]
  buffer_load_dwordx4 a[208:211], v61, s[40:43], s34 offen offset:0 sc1
  v_mfma_f32_16x16x32_bf16 v[180:183], a[180:183], a[92:95], v[180:183]
  ds_read_b64_tr_b16 a[146:147], v38 offset:53248
  v_mfma_f32_16x16x32_bf16 v[180:183], a[176:179], a[88:91], v[180:183]
  s_waitcnt lgkmcnt(12)
  ds_read_b64_tr_b16 a[148:149], v38 offset:57344
  v_mfma_f32_16x16x32_bf16 v[188:191], a[184:187], a[88:91], v[188:191]
  s_waitcnt lgkmcnt(11)
  ds_read_b64_tr_b16 a[150:151], v38 offset:61440
  v_mfma_f32_16x16x32_bf16 v[188:191], a[188:191], a[92:95], v[188:191]
  v_mfma_f32_16x16x32_bf16 v[184:187], a[188:191], a[84:87], v[184:187]
  buffer_load_dwordx4 a[216:219], v61, s[40:43], s34 offen offset:1024 sc1
  v_mfma_f32_16x16x32_bf16 v[184:187], a[184:187], a[80:83], v[184:187]
  s_xor_b32 s34, s101, 0x2a000
  v_mfma_f32_16x16x32_bf16 v[124:127], a[184:187], a[72:75], v[124:127]
  ds_read_b64_tr_b16 a[152:153], v39 offset:49152
  v_mfma_f32_16x16x32_bf16 v[124:127], a[188:191], a[76:79], v[124:127]
  ds_read_b64_tr_b16 a[154:155], v39 offset:53248
  v_mfma_f32_16x16x32_bf16 v[120:123], a[188:191], a[68:71], v[120:123]
  buffer_load_dwordx4 a[196:199], v60, s[40:43], s34 offen offset:0 sc1
  v_mfma_f32_16x16x32_bf16 v[120:123], a[184:187], a[64:67], v[120:123]
  s_waitcnt vmcnt(46) lgkmcnt(12)
  ds_read_b64_tr_b16 a[156:157], v39 offset:57344
  v_mfma_f32_16x16x32_bf16 v[64:67], a[128:131], a[96:99], v[64:67]
  s_waitcnt vmcnt(42) lgkmcnt(11)
  ds_read_b64_tr_b16 a[158:159], v39 offset:61440
  v_mfma_f32_16x16x32_bf16 v[64:67], a[132:135], a[100:103], v[64:67]
  s_waitcnt vmcnt(41)
  v_mfma_f32_16x16x32_bf16 v[68:71], a[132:135], a[108:111], v[68:71]
  buffer_load_dwordx4 a[204:207], v60, s[40:43], s34 offen offset:1024 sc1
  v_mfma_f32_16x16x32_bf16 v[68:71], a[128:131], a[104:107], v[68:71]
  v_mfma_f32_16x16x32_bf16 v[128:131], a[128:131], a[112:115], v[128:131]
  s_waitcnt vmcnt(41)
  ds_read_b64_tr_b16 a[160:161], v40 offset:49152
  v_mfma_f32_16x16x32_bf16 v[128:131], a[132:135], a[116:119], v[128:131]
  s_waitcnt vmcnt(40)
  ds_read_b64_tr_b16 a[162:163], v40 offset:53248
  v_mfma_f32_16x16x32_bf16 v[132:135], a[132:135], a[124:127], v[132:135]
  ds_read_b64_tr_b16 a[164:165], v40 offset:57344
  v_mfma_f32_16x16x32_bf16 v[132:135], a[128:131], a[120:123], v[132:135]
  s_waitcnt lgkmcnt(13)
  buffer_load_dwordx4 a[212:215], v61, s[40:43], s34 offen offset:0 sc1
  v_mfma_f32_16x16x32_bf16 v[140:143], a[136:139], a[120:123], v[140:143]
  s_waitcnt lgkmcnt(11)
  ds_read_b64_tr_b16 a[166:167], v40 offset:61440
  v_mfma_f32_16x16x32_bf16 v[140:143], a[140:143], a[124:127], v[140:143]
  v_mfma_f32_16x16x32_bf16 v[136:139], a[140:143], a[116:119], v[136:139]
  v_mfma_f32_16x16x32_bf16 v[136:139], a[136:139], a[112:115], v[136:139]
  buffer_load_dwordx4 a[220:223], v61, s[40:43], s34 offen offset:1024 sc1
  v_mfma_f32_16x16x32_bf16 v[76:79], a[136:139], a[104:107], v[76:79]
  s_xor_b32 s32, s100, 0x160000
  ds_read_b64_tr_b16 a[168:169], v41 offset:49152
  v_mfma_f32_16x16x32_bf16 v[76:79], a[140:143], a[108:111], v[76:79]
  s_add_u32 m0, s37, 49152
  ds_read_b64_tr_b16 a[170:171], v41 offset:53248
  v_mfma_f32_16x16x32_bf16 v[72:75], a[140:143], a[100:103], v[72:75]
  ds_read_b64_tr_b16 a[172:173], v41 offset:57344
  v_mfma_f32_16x16x32_bf16 v[72:75], a[136:139], a[96:99], v[72:75]
  s_waitcnt lgkmcnt(13)
  buffer_load_dwordx4 v24, s[44:47], s32 offen offset:0  lds
  v_mfma_f32_16x16x32_bf16 v[80:83], a[144:147], a[96:99], v[80:83]
  s_waitcnt lgkmcnt(11)
  ds_read_b64_tr_b16 a[174:175], v41 offset:61440
  v_mfma_f32_16x16x32_bf16 v[80:83], a[148:151], a[100:103], v[80:83]
  v_mfma_f32_16x16x32_bf16 v[84:87], a[148:151], a[108:111], v[84:87]
  v_mfma_f32_16x16x32_bf16 v[84:87], a[144:147], a[104:107], v[84:87]
  buffer_load_dwordx4 v25, s[44:47], s32 offen offset:1024  lds
  v_mfma_f32_16x16x32_bf16 v[144:147], a[144:147], a[112:115], v[144:147]
  ds_read_b64_tr_b16 a[176:177], v42 offset:49152
  v_mfma_f32_16x16x32_bf16 v[144:147], a[148:151], a[116:119], v[144:147]
  ds_read_b64_tr_b16 a[178:179], v42 offset:53248
  v_mfma_f32_16x16x32_bf16 v[148:151], a[148:151], a[124:127], v[148:151]
  ds_read_b64_tr_b16 a[180:181], v42 offset:57344
  v_mfma_f32_16x16x32_bf16 v[148:151], a[144:147], a[120:123], v[148:151]
  s_waitcnt lgkmcnt(13)
  ds_read_b64_tr_b16 a[182:183], v42 offset:61440
  v_mfma_f32_16x16x32_bf16 v[156:159], a[152:155], a[120:123], v[156:159]
  s_waitcnt lgkmcnt(12)
  buffer_load_dwordx4 v26, s[44:47], s32 offen offset:2048  lds
  v_mfma_f32_16x16x32_bf16 v[156:159], a[156:159], a[124:127], v[156:159]
  v_mfma_f32_16x16x32_bf16 v[152:155], a[156:159], a[116:119], v[152:155]
  v_mfma_f32_16x16x32_bf16 v[152:155], a[152:155], a[112:115], v[152:155]
  v_mfma_f32_16x16x32_bf16 v[92:95], a[152:155], a[104:107], v[92:95]
  buffer_load_dwordx4 v27, s[44:47], s32 offen offset:3072  lds
  v_mfma_f32_16x16x32_bf16 v[92:95], a[156:159], a[108:111], v[92:95]
  ds_read_b64_tr_b16 a[184:185], v43 offset:49152
  v_mfma_f32_16x16x32_bf16 v[88:91], a[156:159], a[100:103], v[88:91]
  ds_read_b64_tr_b16 a[186:187], v43 offset:53248
  v_mfma_f32_16x16x32_bf16 v[88:91], a[152:155], a[96:99], v[88:91]
  s_waitcnt lgkmcnt(12)
  ds_read_b64_tr_b16 a[188:189], v43 offset:57344
  v_mfma_f32_16x16x32_bf16 v[96:99], a[160:163], a[96:99], v[96:99]
  s_waitcnt lgkmcnt(11)
  buffer_load_dword v10, v7, s[20:23], 0 offen offset:0 sc1
  v_mfma_f32_16x16x32_bf16 v[96:99], a[164:167], a[100:103], v[96:99]
  s_xor_b32 s34, s101, 0x2c000
  ds_read_b64_tr_b16 a[190:191], v43 offset:61440
  v_mfma_f32_16x16x32_bf16 v[100:103], a[164:167], a[108:111], v[100:103]
  s_waitcnt vmcnt(43)
  buffer_load_dwordx4 a[224:227], v60, s[40:43], s34 offen offset:0 sc1
  v_mfma_f32_16x16x32_bf16 v[100:103], a[160:163], a[104:107], v[100:103]
  s_barrier
  v_mfma_f32_16x16x32_bf16 v[160:163], a[160:163], a[112:115], v[160:163]
  ds_read_b64_tr_b16 a[128:129], v32 offset:0
  v_mfma_f32_16x16x32_bf16 v[160:163], a[164:167], a[116:119], v[160:163]
  ds_read_b64_tr_b16 a[130:131], v32 offset:4096
  v_mfma_f32_16x16x32_bf16 v[164:167], a[164:167], a[124:127], v[164:167]
  ds_read_b64_tr_b16 a[132:133], v32 offset:8192
  v_mfma_f32_16x16x32_bf16 v[164:167], a[160:163], a[120:123], v[164:167]
  s_waitcnt lgkmcnt(13)
  buffer_load_dwordx4 a[232:235], v60, s[40:43], s34 offen offset:1024 sc1
  v_mfma_f32_16x16x32_bf16 v[172:175], a[168:171], a[120:123], v[172:175]
  s_waitcnt lgkmcnt(11)
  ds_read_b64_tr_b16 a[134:135], v32 offset:12288
  v_mfma_f32_16x16x32_bf16 v[172:175], a[172:175], a[124:127], v[172:175]
  v_mfma_f32_16x16x32_bf16 v[168:171], a[172:175], a[116:119], v[168:171]
  v_mfma_f32_16x16x32_bf16 v[168:171], a[168:171], a[112:115], v[168:171]
  buffer_load_dwordx4 a[240:243], v61, s[40:43], s34 offen offset:0 sc1
  v_mfma_f32_16x16x32_bf16 v[108:111], a[168:171], a[104:107], v[108:111]
  ds_read_b64_tr_b16 a[136:137], v33 offset:0
  v_mfma_f32_16x16x32_bf16 v[108:111], a[172:175], a[108:111], v[108:111]
  ds_read_b64_tr_b16 a[138:139], v33 offset:4096
  v_mfma_f32_16x16x32_bf16 v[104:107], a[172:175], a[100:103], v[104:107]
  ds_read_b64_tr_b16 a[140:141], v33 offset:8192
  v_mfma_f32_16x16x32_bf16 v[104:107], a[168:171], a[96:99], v[104:107]
  s_waitcnt lgkmcnt(13)
  buffer_load_dwordx4 a[248:251], v61, s[40:43], s34 offen offset:1024 sc1
  v_mfma_f32_16x16x32_bf16 v[112:115], a[176:179], a[96:99], v[112:115]
  s_waitcnt lgkmcnt(11)
  ds_read_b64_tr_b16 a[142:143], v33 offset:12288
  v_mfma_f32_16x16x32_bf16 v[112:115], a[180:183], a[100:103], v[112:115]
  s_xor_b32 s34, s101, 0x2e000
  v_mfma_f32_16x16x32_bf16 v[116:119], a[180:183], a[108:111], v[116:119]
  v_mfma_f32_16x16x32_bf16 v[116:119], a[176:179], a[104:107], v[116:119]
  v_mfma_f32_16x16x32_bf16 v[176:179], a[176:179], a[112:115], v[176:179]
  buffer_load_dwordx4 a[228:231], v60, s[40:43], s34 offen offset:0 sc1
  v_mfma_f32_16x16x32_bf16 v[176:179], a[180:183], a[116:119], v[176:179]
  ds_read_b64_tr_b16 a[144:145], v34 offset:0
  v_mfma_f32_16x16x32_bf16 v[180:183], a[180:183], a[124:127], v[180:183]
  ds_read_b64_tr_b16 a[146:147], v34 offset:4096
  v_mfma_f32_16x16x32_bf16 v[180:183], a[176:179], a[120:123], v[180:183]
  s_waitcnt lgkmcnt(12)
  ds_read_b64_tr_b16 a[148:149], v34 offset:8192
  v_mfma_f32_16x16x32_bf16 v[188:191], a[184:187], a[120:123], v[188:191]
  s_waitcnt lgkmcnt(11)
  buffer_load_dwordx4 a[236:239], v60, s[40:43], s34 offen offset:1024 sc1
  v_mfma_f32_16x16x32_bf16 v[188:191], a[188:191], a[124:127], v[188:191]
  ds_read_b64_tr_b16 a[150:151], v34 offset:12288
  v_mfma_f32_16x16x32_bf16 v[184:187], a[188:191], a[116:119], v[184:187]
  v_mfma_f32_16x16x32_bf16 v[184:187], a[184:187], a[112:115], v[184:187]
  v_mfma_f32_16x16x32_bf16 v[124:127], a[184:187], a[104:107], v[124:127]
  buffer_load_dwordx4 a[244:247], v61, s[40:43], s34 offen offset:0 sc1
  v_mfma_f32_16x16x32_bf16 v[124:127], a[188:191], a[108:111], v[124:127]
  ds_read_b64_tr_b16 a[152:153], v35 offset:0
  v_mfma_f32_16x16x32_bf16 v[120:123], a[188:191], a[100:103], v[120:123]
  ds_read_b64_tr_b16 a[154:155], v35 offset:4096
  v_mfma_f32_16x16x32_bf16 v[120:123], a[184:187], a[96:99], v[120:123]
  s_waitcnt vmcnt(49) lgkmcnt(12)
  ds_read_b64_tr_b16 a[156:157], v35 offset:8192
  v_mfma_f32_16x16x32_bf16 v[96:99], a[128:131], v[192:195], v[96:99]
  s_waitcnt vmcnt(45) lgkmcnt(11)
  ds_read_b64_tr_b16 a[158:159], v35 offset:12288
  buffer_load_dwordx4 a[252:255], v61, s[40:43], s34 offen offset:1024 sc1
  v_mfma_f32_16x16x32_bf16 v[96:99], a[132:135], v[196:199], v[96:99]
L_pad17:
  s_cbranch_execz L_hr2
  s_waitcnt vmcnt(45)
  s_xor_b32 s32, s100, 0x180000
  v_mfma_f32_16x16x32_bf16 v[100:103], a[132:135], v[204:207], v[100:103]
  s_add_u32 m0, s37, 65536
  v_mfma_f32_16x16x32_bf16 v[100:103], a[128:131], v[200:203], v[100:103]
  v_mfma_f32_16x16x32_bf16 v[160:163], a[128:131], v[208:211], v[160:163]
  s_waitcnt vmcnt(44)
  ds_read_b64_tr_b16 a[160:161], v28 offset:0
  v_mfma_f32_16x16x32_bf16 v[160:163], a[132:135], v[212:215], v[160:163]
  s_waitcnt vmcnt(43)
  ds_read_b64_tr_b16 a[162:163], v28 offset:4096
  buffer_load_dwordx4 v24, s[44:47], s32 offen offset:0  lds
  v_mfma_f32_16x16x32_bf16 v[164:167], a[132:135], v[220:223], v[164:167]
  ds_read_b64_tr_b16 a[164:165], v28 offset:8192
  v_mfma_f32_16x16x32_bf16 v[164:167], a[128:131], v[216:219], v[164:167]
  s_waitcnt lgkmcnt(13)
  ds_read_b64_tr_b16 a[166:167], v28 offset:12288
  v_mfma_f32_16x16x32_bf16 v[172:175], a[136:139], v[216:219], v[172:175]
  s_waitcnt lgkmcnt(12)
  ds_read_b64_tr_b16 a[168:169], v29 offset:0
  v_mfma_f32_16x16x32_bf16 v[172:175], a[140:143], v[220:223], v[172:175]
  ds_read_b64_tr_b16 a[170:171], v29 offset:4096
  buffer_load_dwordx4 v25, s[44:47], s32 offen offset:1024  lds
  v_mfma_f32_16x16x32_bf16 v[168:171], a[140:143], v[212:215], v[168:171]
  ds_read_b64_tr_b16 a[172:173], v29 offset:8192
  v_mfma_f32_16x16x32_bf16 v[168:171], a[136:139], v[208:211], v[168:171]
  ds_read_b64_tr_b16 a[174:175], v29 offset:12288
  v_mfma_f32_16x16x32_bf16 v[108:111], a[136:139], v[200:203], v[108:111]
  ds_read_b64_tr_b16 a[176:177], v30 offset:0
  v_mfma_f32_16x16x32_bf16 v[108:111], a[140:143], v[204:207], v[108:111]
  ds_read_b64_tr_b16 a[178:179], v30 offset:4096
  buffer_load_dwordx4 v26, s[44:47], s32 offen offset:2048  lds
  v_mfma_f32_16x16x32_bf16 v[104:107], a[140:143], v[196:199], v[104:107]
  ds_read_b64_tr_b16 a[180:181], v30 offset:8192
  v_mfma_f32_16x16x32_bf16 v[104:107], a[136:139], v[192:195], v[104:107]
  ds_read_b64_tr_b16 a[182:183], v30 offset:12288
  s_waitcnt lgkmcnt(15)
  v_mfma_f32_16x16x32_bf16 v[112:115], a[144:147], v[192:195], v[112:115]
  ds_read_b64_tr_b16 a[184:185], v31 offset:0
  v_mfma_f32_16x16x32_bf16 v[112:115], a[148:151], v[196:199], v[112:115]
  ds_read_b64_tr_b16 a[186:187], v31 offset:4096
  v_mfma_f32_16x16x32_bf16 v[116:119], a[148:151], v[204:207], v[116:119]
  ds_read_b64_tr_b16 a[188:189], v31 offset:8192
  buffer_load_dwordx4 v27, s[44:47], s32 offen offset:3072  lds
  v_mfma_f32_16x16x32_bf16 v[116:119], a[144:147], v[200:203], v[116:119]
  s_waitcnt vmcnt(43)
  s_xor_b32 s34, s101, 0x30000
  s_barrier
  v_mfma_f32_16x16x32_bf16 v[176:179], a[144:147], v[208:211], v[176:179]
  ds_read_b64_tr_b16 a[190:191], v31 offset:12288
  v_mfma_f32_16x16x32_bf16 v[176:179], a[148:151], v[212:215], v[176:179]
  ds_read_b64_tr_b16 a[128:129], v32 offset:16384
  v_mfma_f32_16x16x32_bf16 v[180:183], a[148:151], v[220:223], v[180:183]
  ds_read_b64_tr_b16 a[130:131], v32 offset:20480
  buffer_load_dwordx4 a[0:3], v60, s[40:43], s34 offen offset:0 sc1
  v_mfma_f32_16x16x32_bf16 v[180:183], a[144:147], v[216:219], v[180:183]
  ds_read_b64_tr_b16 a[132:133], v32 offset:24576
  s_waitcnt lgkmcnt(15)
  v_mfma_f32_16x16x32_bf16 v[188:191], a[152:155], v[216:219], v[188:191]
  ds_read_b64_tr_b16 a[134:135], v32 offset:28672
  v_mfma_f32_16x16x32_bf16 v[188:191], a[156:159], v[220:223], v[188:191]
  v_mfma_f32_16x16x32_bf16 v[184:187], a[156:159], v[212:215], v[184:187]
  buffer_load_dwordx4 a[8:11], v60, s[40:43], s34 offen offset:1024 sc1
  v_mfma_f32_16x16x32_bf16 v[184:187], a[152:155], v[208:211], v[184:187]
  v_mfma_f32_16x16x32_bf16 v[124:127], a[152:155], v[200:203], v[124:127]
  ds_read_b64_tr_b16 a[136:137], v33 offset:16384
  v_mfma_f32_16x16x32_bf16 v[124:127], a[156:159], v[204:207], v[124:127]
  ds_read_b64_tr_b16 a[138:139], v33 offset:20480
  v_mfma_f32_16x16x32_bf16 v[120:123], a[156:159], v[196:199], v[120:123]
  ds_read_b64_tr_b16 a[140:141], v33 offset:24576
  v_mfma_f32_16x16x32_bf16 v[120:123], a[152:155], v[192:195], v[120:123]
  ds_read_b64_tr_b16 a[142:143], v33 offset:28672
  buffer_load_dwordx4 a[16:19], v61, s[40:43], s34 offen offset:0 sc1
  v_mfma_f32_16x16x32_bf16 v[128:131], a[160:163], v[208:211], v[128:131]
  v_mfma_f32_16x16x32_bf16 v[128:131], a[164:167], v[212:215], v[128:131]
  v_mfma_f32_16x16x32_bf16 v[132:135], a[164:167], v[220:223], v[132:135]
  v_mfma_f32_16x16x32_bf16 v[132:135], a[160:163], v[216:219], v[132:135]
  s_waitcnt lgkmcnt(15)
  buffer_load_dwordx4 a[24:27], v61, s[40:43], s34 offen offset:1024 sc1
  v_mfma_f32_16x16x32_bf16 v[140:143], a[168:171], v[216:219], v[140:143]
  s_xor_b32 s34, s101, 0x32000
  ds_read_b64_tr_b16 a[144:145], v34 offset:16384
  v_mfma_f32_16x16x32_bf16 v[140:143], a[172:175], v[220:223], v[140:143]
  ds_read_b64_tr_b16 a[146:147], v34 offset:20480
  v_mfma_f32_16x16x32_bf16 v[136:139], a[172:175], v[212:215], v[136:139]
  ds_read_b64_tr_b16 a[148:149], v34 offset:24576
  v_mfma_f32_16x16x32_bf16 v[136:139], a[168:171], v[208:211], v[136:139]
  ds_read_b64_tr_b16 a[150:151], v34 offset:28672
  buffer_load_dwordx4 a[4:7], v60, s[40:43], s34 offen offset:0 sc1
  s_waitcnt lgkmcnt(15)
  v_mfma_f32_16x16x32_bf16 v[144:147], a[176:179], v[208:211], v[144:147]
  v_mfma_f32_16x16x32_bf16 v[144:147], a[180:183], v[212:215], v[144:147]
  v_mfma_f32_16x16x32_bf16 v[148:151], a[180:183], v[220:223], v[148:151]
  v_mfma_f32_16x16x32_bf16 v[148:151], a[176:179], v[216:219], v[148:151]
  s_waitcnt lgkmcnt(14)
  buffer_load_dwordx4 a[12:15], v60, s[40:43], s34 offen offset:1024 sc1
  v_mfma_f32_16x16x32_bf16 v[156:159], a[184:187], v[216:219], v[156:159]
  s_waitcnt lgkmcnt(12)
  ds_read_b64_tr_b16 a[152:153], v35 offset:16384
  v_mfma_f32_16x16x32_bf16 v[156:159], a[188:191], v[220:223], v[156:159]
  ds_read_b64_tr_b16 a[154:155], v35 offset:20480
  v_mfma_f32_16x16x32_bf16 v[152:155], a[188:191], v[212:215], v[152:155]
  ds_read_b64_tr_b16 a[156:157], v35 offset:24576
  v_mfma_f32_16x16x32_bf16 v[152:155], a[184:187], v[208:211], v[152:155]
  s_waitcnt vmcnt(48) lgkmcnt(13)
  ds_read_b64_tr_b16 a[158:159], v35 offset:28672
  v_mfma_f32_16x16x32_bf16 v[96:99], a[128:131], v[224:227], v[96:99]
  s_waitcnt vmcnt(31)
  s_waitcnt lgkmcnt(12)
  ds_read_b64 v[208:209], v56 offset:0
  buffer_load_dwordx4 a[20:23], v61, s[40:43], s34 offen offset:0 sc1
  v_mfma_f32_16x16x32_bf16 v[96:99], a[132:135], v[228:231], v[96:99]
  ds_read_b64 v[210:211], v57 offset:0
  v_mfma_f32_16x16x32_bf16 v[100:103], a[132:135], v[236:239], v[100:103]
  ds_read_b64 v[212:213], v58 offset:0
  v_mfma_f32_16x16x32_bf16 v[100:103], a[128:131], v[232:235], v[100:103]
  s_barrier
  v_mfma_f32_16x16x32_bf16 v[160:163], a[128:131], v[240:243], v[160:163]
  ds_read_b64_tr_b16 a[160:161], v32 offset:32768
  buffer_load_dwordx4 a[28:31], v61, s[40:43], s34 offen offset:1024 sc1
  v_mfma_f32_16x16x32_bf16 v[160:163], a[132:135], v[244:247], v[160:163]
  s_xor_b32 s32, s100, 0x1a0000
  ds_read_b64_tr_b16 a[162:163], v32 offset:36864
  v_mfma_f32_16x16x32_bf16 v[164:167], a[132:135], v[252:255], v[164:167]
  s_add_u32 m0, s37, 81920
  ds_read_b64_tr_b16 a[164:165], v32 offset:40960
  v_mfma_f32_16x16x32_bf16 v[164:167], a[128:131], v[248:251], v[164:167]
  ds_read_b64_tr_b16 a[166:167], v32 offset:45056
  s_waitcnt lgkmcnt(15)
  v_mfma_f32_16x16x32_bf16 v[172:175], a[136:139], v[248:251], v[172:175]
  ds_read_b64 v[214:215], v59 offset:0
  buffer_load_dwordx4 v24, s[44:47], s32 offen offset:0  lds
  v_mfma_f32_16x16x32_bf16 v[172:175], a[140:143], v[252:255], v[172:175]
  ds_read_b64 v[216:217], v56 offset:2048
  v_mfma_f32_16x16x32_bf16 v[168:171], a[140:143], v[244:247], v[168:171]
  ds_read_b64 v[218:219], v57 offset:2048
  v_mfma_f32_16x16x32_bf16 v[168:171], a[136:139], v[240:243], v[168:171]
  ds_read_b64 v[220:221], v58 offset:2048
  v_mfma_f32_16x16x32_bf16 v[108:111], a[136:139], v[232:235], v[108:111]
  ds_read_b64_tr_b16 a[168:169], v33 offset:32768
  v_mfma_f32_16x16x32_bf16 v[108:111], a[140:143], v[236:239], v[108:111]
  ds_read_b64_tr_b16 a[170:171], v33 offset:36864
  buffer_load_dwordx4 v25, s[44:47], s32 offen offset:1024  lds
  v_mfma_f32_16x16x32_bf16 v[104:107], a[140:143], v[228:231], v[104:107]
  ds_read_b64_tr_b16 a[172:173], v33 offset:40960
  v_mfma_f32_16x16x32_bf16 v[104:107], a[136:139], v[224:227], v[104:107]
  ds_read_b64_tr_b16 a[174:175], v33 offset:45056
  s_waitcnt lgkmcnt(15)
  v_mfma_f32_16x16x32_bf16 v[112:115], a[144:147], v[224:227], v[112:115]
  ds_read_b64 v[222:223], v59 offset:2048
  v_mfma_f32_16x16x32_bf16 v[112:115], a[148:151], v[228:231], v[112:115]
  s_waitcnt vmcnt(22)
  v_cmp_ne_u32 vcc, 1, v10
  s_nop 2
  s_cbranch_vccnz L_conv_wait
L_conv_ok:
  v_mfma_f32_16x16x32_bf16 v[116:119], a[148:151], v[236:239], v[116:119]
  buffer_load_dwordx4 v26, s[44:47], s32 offen offset:2048  lds
  v_mfma_f32_16x16x32_bf16 v[116:119], a[144:147], v[232:235], v[116:119]
  v_mfma_f32_16x16x32_bf16 v[176:179], a[144:147], v[240:243], v[176:179]
  ds_read_b64_tr_b16 a[176:177], v34 offset:32768
  v_mfma_f32_16x16x32_bf16 v[176:179], a[148:151], v[244:247], v[176:179]
  ds_read_b64_tr_b16 a[178:179], v34 offset:36864
  buffer_load_dwordx4 v27, s[44:47], s32 offen offset:3072  lds
  v_mfma_f32_16x16x32_bf16 v[180:183], a[148:151], v[252:255], v[180:183]
  ds_read_b64_tr_b16 a[180:181], v34 offset:40960
  v_mfma_f32_16x16x32_bf16 v[180:183], a[144:147], v[248:251], v[180:183]
  s_xor_b32 s34, s101, 0x34000
  ds_read_b64_tr_b16 a[182:183], v34 offset:45056
  v_mfma_f32_16x16x32_bf16 v[188:191], a[152:155], v[248:251], v[188:191]
  v_mfma_f32_16x16x32_bf16 v[188:191], a[156:159], v[252:255], v[188:191]
  v_mfma_f32_16x16x32_bf16 v[184:187], a[156:159], v[244:247], v[184:187]
  buffer_load_dwordx4 a[32:35], v60, s[40:43], s34 offen offset:0 sc1
  v_mfma_f32_16x16x32_bf16 v[184:187], a[152:155], v[240:243], v[184:187]
  v_mfma_f32_16x16x32_bf16 v[124:127], a[152:155], v[232:235], v[124:127]
  ds_read_b64_tr_b16 a[184:185], v35 offset:32768
  v_mfma_f32_16x16x32_bf16 v[124:127], a[156:159], v[236:239], v[124:127]
  ds_read_b64_tr_b16 a[186:187], v35 offset:36864
  v_mfma_f32_16x16x32_bf16 v[120:123], a[156:159], v[228:231], v[120:123]
  ds_read_b64_tr_b16 a[188:189], v35 offset:40960
  buffer_load_dwordx4 a[40:43], v60, s[40:43], s34 offen offset:1024 sc1
  v_mfma_f32_16x16x32_bf16 v[120:123], a[152:155], v[224:227], v[120:123]
  ds_read_b64_tr_b16 a[190:191], v35 offset:45056
  s_waitcnt lgkmcnt(15)
  v_mfma_f32_16x16x32_bf16 v[96:99], a[160:163], a[192:195], v[96:99]
  v_mfma_f32_16x16x32_bf16 v[96:99], a[164:167], a[196:199], v[96:99]
  v_mfma_f32_16x16x32_bf16 v[100:103], a[164:167], a[204:207], v[100:103]
  buffer_load_dwordx4 a[48:51], v61, s[40:43], s34 offen offset:0 sc1
  v_mfma_f32_16x16x32_bf16 v[100:103], a[160:163], a[200:203], v[100:103]
  s_barrier
  v_mfma_f32_16x16x32_bf16 v[160:163], a[160:163], a[208:211], v[160:163]
  ds_read_b64_tr_b16 a[128:129], v32 offset:49152
  v_mfma_f32_16x16x32_bf16 v[160:163], a[164:167], a[212:215], v[160:163]
  ds_read_b64_tr_b16 a[130:131], v32 offset:53248
  v_mfma_f32_16x16x32_bf16 v[164:167], a[164:167], a[220:223], v[164:167]
  ds_read_b64_tr_b16 a[132:133], v32 offset:57344
  buffer_load_dwordx4 a[56:59], v61, s[40:43], s34 offen offset:1024 sc1
  v_mfma_f32_16x16x32_bf16 v[164:167], a[160:163], a[216:219], v[164:167]
  ds_read_b64_tr_b16 a[134:135], v32 offset:61440
  s_waitcnt lgkmcnt(15)
  v_mfma_f32_16x16x32_bf16 v[172:175], a[168:171], a[216:219], v[172:175]
  s_waitcnt lgkmcnt(13)
  s_xor_b32 s34, s101, 0x36000
  v_mfma_f32_16x16x32_bf16 v[172:175], a[172:175], a[220:223], v[172:175]
  v_mfma_f32_16x16x32_bf16 v[168:171], a[172:175], a[212:215], v[168:171]
  v_mfma_f32_16x16x32_bf16 v[168:171], a[168:171], a[208:211], v[168:171]
  buffer_load_dwordx4 a[36:39], v60, s[40:43], s34 offen offset:0 sc1
  v_mfma_f32_16x16x32_bf16 v[108:111], a[168:171], a[200:203], v[108:111]
  ds_read_b64_tr_b16 a[136:137], v33 offset:49152
  v_mfma_f32_16x16x32_bf16 v[108:111], a[172:175], a[204:207], v[108:111]
  ds_read_b64_tr_b16 a[138:139], v33 offset:53248
  v_mfma_f32_16x16x32_bf16 v[104:107], a[172:175], a[196:199], v[104:107]
  ds_read_b64_tr_b16 a[140:141], v33 offset:57344
  v_mfma_f32_16x16x32_bf16 v[104:107], a[168:171], a[192:195], v[104:107]
  s_waitcnt lgkmcnt(13)
  ds_read_b64_tr_b16 a[142:143], v33 offset:61440
  buffer_load_dwordx4 a[44:47], v60, s[40:43], s34 offen offset:1024 sc1
  v_mfma_f32_16x16x32_bf16 v[112:115], a[176:179], a[192:195], v[112:115]
  s_waitcnt lgkmcnt(12)
  v_mfma_f32_16x16x32_bf16 v[112:115], a[180:183], a[196:199], v[112:115]
  v_mfma_f32_16x16x32_bf16 v[116:119], a[180:183], a[204:207], v[116:119]
  v_mfma_f32_16x16x32_bf16 v[116:119], a[176:179], a[200:203], v[116:119]
  buffer_load_dwordx4 a[52:55], v61, s[40:43], s34 offen offset:0 sc1
  v_mfma_f32_16x16x32_bf16 v[176:179], a[176:179], a[208:211], v[176:179]
  ds_read_b64_tr_b16 a[144:145], v34 offset:49152
  v_mfma_f32_16x16x32_bf16 v[176:179], a[180:183], a[212:215], v[176:179]
  ds_read_b64_tr_b16 a[146:147], v34 offset:53248
  v_mfma_f32_16x16x32_bf16 v[180:183], a[180:183], a[220:223], v[180:183]
  ds_read_b64_tr_b16 a[148:149], v34 offset:57344
  v_mfma_f32_16x16x32_bf16 v[180:183], a[176:179], a[216:219], v[180:183]
  s_waitcnt lgkmcnt(13)
  ds_read_b64_tr_b16 a[150:151], v34 offset:61440
  v_mfma_f32_16x16x32_bf16 v[188:191], a[184:187], a[216:219], v[188:191]
  s_waitcnt lgkmcnt(12)
  buffer_load_dwordx4 a[60:63], v61, s[40:43], s34 offen offset:1024 sc1
  v_mfma_f32_16x16x32_bf16 v[188:191], a[188:191], a[220:223], v[188:191]
  s_xor_b32 s32, s100, 0x1c0000
  v_mfma_f32_16x16x32_bf16 v[184:187], a[188:191], a[212:215], v[184:187]
  s_add_u32 m0, s37, 98304
  v_mfma_f32_16x16x32_bf16 v[184:187], a[184:187], a[208:211], v[184:187]
  v_mfma_f32_16x16x32_bf16 v[124:127], a[184:187], a[200:203], v[124:127]
  ds_read_b64_tr_b16 a[152:153], v35 offset:49152
  buffer_load_dwordx4 v24, s[44:47], s32 offen offset:0  lds
  v_mfma_f32_16x16x32_bf16 v[124:127], a[188:191], a[204:207], v[124:127]
  ds_read_b64_tr_b16 a[154:155], v35 offset:53248
  v_mfma_f32_16x16x32_bf16 v[120:123], a[188:191], a[196:199], v[120:123]
  ds_read_b64_tr_b16 a[156:157], v35 offset:57344
  v_mfma_f32_16x16x32_bf16 v[120:123], a[184:187], a[192:195], v[120:123]
  s_waitcnt vmcnt(32) lgkmcnt(13)
  ds_read_b64_tr_b16 a[158:159], v35 offset:61440
  v_mfma_f32_16x16x32_bf16 v[96:99], a[128:131], a[224:227], v[96:99]
  s_waitcnt vmcnt(28) lgkmcnt(12)
  buffer_load_dwordx4 v25, s[44:47], s32 offen offset:1024  lds
  v_mfma_f32_16x16x32_bf16 v[96:99], a[132:135], a[228:231], v[96:99]
  s_waitcnt vmcnt(28)
  v_mfma_f32_16x16x32_bf16 v[100:103], a[132:135], a[236:239], v[100:103]
  s_waitcnt vmcnt(22)
  v_mfma_f32_16x16x32_bf16 v[100:103], a[128:131], a[232:235], v[100:103]
  s_barrier
  v_mfma_f32_16x16x32_bf16 v[160:163], a[128:131], a[240:243], v[160:163]
  ds_read_b64_tr_b16 a[160:161], v40 offset:0
  buffer_load_dwordx4 v26, s[44:47], s32 offen offset:2048  lds
  v_mfma_f32_16x16x32_bf16 v[160:163], a[132:135], a[244:247], v[160:163]
  ds_read_b64_tr_b16 a[162:163], v40 offset:4096
  v_mfma_f32_16x16x32_bf16 v[164:167], a[132:135], a[252:255], v[164:167]
  ds_read_b64_tr_b16 a[164:165], v40 offset:8192
  v_mfma_f32_16x16x32_bf16 v[164:167], a[128:131], a[248:251], v[164:167]
  s_waitcnt lgkmcnt(13)
  ds_read_b64_tr_b16 a[166:167], v40 offset:12288
  v_mfma_f32_16x16x32_bf16 v[172:175], a[136:139], a[248:251], v[172:175]
  s_waitcnt lgkmcnt(12)
  v_mfma_f32_16x16x32_bf16 v[172:175], a[140:143], a[252:255], v[172:175]
  buffer_load_dwordx4 v27, s[44:47], s32 offen offset:3072  lds
  v_mfma_f32_16x16x32_bf16 v[168:171], a[140:143], a[244:247], v[168:171]
  s_xor_b32 s34, s101, 0x38000
  v_mfma_f32_16x16x32_bf16 v[168:171], a[136:139], a[240:243], v[168:171]
  v_mfma_f32_16x16x32_bf16 v[108:111], a[136:139], a[232:235], v[108:111]
  ds_read_b64_tr_b16 a[168:169], v41 offset:0
  v_mfma_f32_16x16x32_bf16 v[108:111], a[140:143], a[236:239], v[108:111]
  ds_read_b64_tr_b16 a[170:171], v41 offset:4096
  buffer_load_dwordx4 a[64:67], v60, s[40:43], s34 offen offset:0 sc1
  v_mfma_f32_16x16x32_bf16 v[104:107], a[140:143], a[228:231], v[104:107]
  ds_read_b64_tr_b16 a[172:173], v41 offset:8192
  v_mfma_f32_16x16x32_bf16 v[104:107], a[136:139], a[224:227], v[104:107]
  s_waitcnt lgkmcnt(13)
  ds_read_b64_tr_b16 a[174:175], v41 offset:12288
  v_mfma_f32_16x16x32_bf16 v[112:115], a[144:147], a[224:227], v[112:115]
  s_waitcnt lgkmcnt(12)
  v_mfma_f32_16x16x32_bf16 v[112:115], a[148:151], a[228:231], v[112:115]
  buffer_load_dwordx4 a[72:75], v60, s[40:43], s34 offen offset:1024 sc1
  v_mfma_f32_16x16x32_bf16 v[116:119], a[148:151], a[236:239], v[116:119]
  v_mfma_f32_16x16x32_bf16 v[116:119], a[144:147], a[232:235], v[116:119]
  v_mfma_f32_16x16x32_bf16 v[176:179], a[144:147], a[240:243], v[176:179]
  ds_read_b64_tr_b16 a[176:177], v42 offset:0
  v_mfma_f32_16x16x32_bf16 v[176:179], a[148:151], a[244:247], v[176:179]
  ds_read_b64_tr_b16 a[178:179], v42 offset:4096
  v_mfma_f32_16x16x32_bf16 v[180:183], a[148:151], a[252:255], v[180:183]
  ds_read_b64_tr_b16 a[180:181], v42 offset:8192
  buffer_load_dwordx4 a[80:83], v61, s[40:43], s34 offen offset:0 sc1
  v_mfma_f32_16x16x32_bf16 v[180:183], a[144:147], a[248:251], v[180:183]
  s_waitcnt lgkmcnt(13)
  ds_read_b64_tr_b16 a[182:183], v42 offset:12288
  v_mfma_f32_16x16x32_bf16 v[188:191], a[152:155], a[248:251], v[188:191]
  s_waitcnt lgkmcnt(12)
  v_mfma_f32_16x16x32_bf16 v[188:191], a[156:159], a[252:255], v[188:191]
  v_mfma_f32_16x16x32_bf16 v[184:187], a[156:159], a[244:247], v[184:187]
  buffer_load_dwordx4 a[88:91], v61, s[40:43], s34 offen offset:1024 sc1
  v_mfma_f32_16x16x32_bf16 v[184:187], a[152:155], a[240:243], v[184:187]
  s_xor_b32 s34, s101, 0x3a000
  v_mfma_f32_16x16x32_bf16 v[124:127], a[152:155], a[232:235], v[124:127]
  ds_read_b64_tr_b16 a[184:185], v43 offset:0
  v_mfma_f32_16x16x32_bf16 v[124:127], a[156:159], a[236:239], v[124:127]
  ds_read_b64_tr_b16 a[186:187], v43 offset:4096
  v_mfma_f32_16x16x32_bf16 v[120:123], a[156:159], a[228:231], v[120:123]
  ds_read_b64_tr_b16 a[188:189], v43 offset:8192
  buffer_load_dwordx4 a[68:71], v60, s[40:43], s34 offen offset:0 sc1
  v_mfma_f32_16x16x32_bf16 v[120:123], a[152:155], a[224:227], v[120:123]
  s_waitcnt vmcnt(28) lgkmcnt(13)
  ds_read_b64_tr_b16 a[190:191], v43 offset:12288
  v_mfma_f32_16x16x32_bf16 v[96:99], a[160:163], a[0:3], v[96:99]
  s_waitcnt vmcnt(24) lgkmcnt(12)
  v_mfma_f32_16x16x32_bf16 v[96:99], a[164:167], a[4:7], v[96:99]
  s_waitcnt vmcnt(23)
  v_mfma_f32_16x16x32_bf16 v[100:103], a[164:167], a[12:15], v[100:103]
  s_waitcnt vmcnt(17)
  v_mfma_f32_16x16x32_bf16 v[100:103], a[160:163], a[8:11], v[100:103]
  s_barrier
  v_mfma_f32_16x16x32_bf16 v[160:163], a[160:163], a[16:19], v[160:163]
  ds_read_b64_tr_b16 a[128:129], v40 offset:16384
  buffer_load_dwordx4 a[76:79], v60, s[40:43], s34 offen offset:1024 sc1
  v_mfma_f32_16x16x32_bf16 v[160:163], a[164:167], a[20:23], v[160:163]
  ds_read_b64_tr_b16 a[130:131], v40 offset:20480
  v_mfma_f32_16x16x32_bf16 v[164:167], a[164:167], a[28:31], v[164:167]
  ds_read_b64_tr_b16 a[132:133], v40 offset:24576
  v_mfma_f32_16x16x32_bf16 v[164:167], a[160:163], a[24:27], v[164:167]
  s_waitcnt lgkmcnt(13)
  ds_read_b64_tr_b16 a[134:135], v40 offset:28672
  buffer_load_dwordx4 a[84:87], v61, s[40:43], s34 offen offset:0 sc1
  v_mfma_f32_16x16x32_bf16 v[172:175], a[168:171], a[24:27], v[172:175]
  s_waitcnt lgkmcnt(12)
  v_mfma_f32_16x16x32_bf16 v[172:175], a[172:175], a[28:31], v[172:175]
  v_mfma_f32_16x16x32_bf16 v[168:171], a[172:175], a[20:23], v[168:171]
  v_mfma_f32_16x16x32_bf16 v[168:171], a[168:171], a[16:19], v[168:171]
  buffer_load_dwordx4 a[92:95], v61, s[40:43], s34 offen offset:1024 sc1
  v_mfma_f32_16x16x32_bf16 v[108:111], a[168:171], a[8:11], v[108:111]
  s_xor_b32 s32, s100, 0x1e0000
  ds_read_b64_tr_b16 a[136:137], v41 offset:16384
  v_mfma_f32_16x16x32_bf16 v[108:111], a[172:175], a[12:15], v[108:111]
  s_add_u32 m0, s37, 114688
  ds_read_b64_tr_b16 a[138:139], v41 offset:20480
  v_mfma_f32_16x16x32_bf16 v[104:107], a[172:175], a[4:7], v[104:107]
  ds_read_b64_tr_b16 a[140:141], v41 offset:24576
  v_mfma_f32_16x16x32_bf16 v[104:107], a[168:171], a[0:3], v[104:107]
  s_waitcnt lgkmcnt(13)
  ds_read_b64_tr_b16 a[142:143], v41 offset:28672
  buffer_load_dwordx4 v24, s[44:47], s32 offen offset:0  lds
  v_mfma_f32_16x16x32_bf16 v[112:115], a[176:179], a[0:3], v[112:115]
  s_waitcnt lgkmcnt(12)
  v_mfma_f32_16x16x32_bf16 v[112:115], a[180:183], a[4:7], v[112:115]
  v_mfma_f32_16x16x32_bf16 v[116:119], a[180:183], a[12:15], v[116:119]
  v_mfma_f32_16x16x32_bf16 v[116:119], a[176:179], a[8:11], v[116:119]
  buffer_load_dwordx4 v25, s[44:47], s32 offen offset:1024  lds
  v_mfma_f32_16x16x32_bf16 v[176:179], a[176:179], a[16:19], v[176:179]
  ds_read_b64_tr_b16 a[144:145], v42 offset:16384
  v_mfma_f32_16x16x32_bf16 v[176:179], a[180:183], a[20:23], v[176:179]
  ds_read_b64_tr_b16 a[146:147], v42 offset:20480
  buffer_load_dwordx4 v26, s[44:47], s32 offen offset:2048  lds
  v_mfma_f32_16x16x32_bf16 v[180:183], a[180:183], a[28:31], v[180:183]
  ds_read_b64_tr_b16 a[148:149], v42 offset:24576
  v_mfma_f32_16x16x32_bf16 v[180:183], a[176:179], a[24:27], v[180:183]
  s_waitcnt lgkmcnt(13)
  ds_read_b64_tr_b16 a[150:151], v42 offset:28672
  buffer_load_dwordx4 v27, s[44:47], s32 offen offset:3072  lds
  v_mfma_f32_16x16x32_bf16 v[188:191], a[184:187], a[24:27], v[188:191]
  s_waitcnt lgkmcnt(12)
  v_mfma_f32_16x16x32_bf16 v[188:191], a[188:191], a[28:31], v[188:191]
  v_mfma_f32_16x16x32_bf16 v[184:187], a[188:191], a[20:23], v[184:187]
  v_mfma_f32_16x16x32_bf16 v[184:187], a[184:187], a[16:19], v[184:187]
  v_mfma_f32_16x16x32_bf16 v[124:127], a[184:187], a[8:11], v[124:127]
  ds_read_b64_tr_b16 a[152:153], v43 offset:16384
  v_mfma_f32_16x16x32_bf16 v[124:127], a[188:191], a[12:15], v[124:127]
  s_xor_b32 s34, s101, 0x3c000
  ds_read_b64_tr_b16 a[154:155], v43 offset:20480
  v_mfma_f32_16x16x32_bf16 v[120:123], a[188:191], a[4:7], v[120:123]
  ds_read_b64_tr_b16 a[156:157], v43 offset:24576
  v_mfma_f32_16x16x32_bf16 v[120:123], a[184:187], a[0:3], v[120:123]
  s_waitcnt vmcnt(23) lgkmcnt(13)
  ds_read_b64_tr_b16 a[158:159], v43 offset:28672
  v_mfma_f32_16x16x32_bf16 v[96:99], a[128:131], a[32:35], v[96:99]
  s_waitcnt vmcnt(19) lgkmcnt(12)
  buffer_load_dwordx4 a[96:99], v60, s[40:43], s34 offen offset:0 sc1
  v_mfma_f32_16x16x32_bf16 v[96:99], a[132:135], a[36:39], v[96:99]
  s_waitcnt vmcnt(19)
  v_mfma_f32_16x16x32_bf16 v[100:103], a[132:135], a[44:47], v[100:103]
  s_waitcnt vmcnt(13)
  v_mfma_f32_16x16x32_bf16 v[100:103], a[128:131], a[40:43], v[100:103]
  s_barrier
  v_mfma_f32_16x16x32_bf16 v[160:163], a[128:131], a[48:51], v[160:163]
  ds_read_b64_tr_b16 a[160:161], v40 offset:32768
  buffer_load_dwordx4 a[104:107], v60, s[40:43], s34 offen offset:1024 sc1
  v_mfma_f32_16x16x32_bf16 v[160:163], a[132:135], a[52:55], v[160:163]
  ds_read_b64_tr_b16 a[162:163], v40 offset:36864
  v_mfma_f32_16x16x32_bf16 v[164:167], a[132:135], a[60:63], v[164:167]
  ds_read_b64_tr_b16 a[164:165], v40 offset:40960
  v_mfma_f32_16x16x32_bf16 v[164:167], a[128:131], a[56:59], v[164:167]
  s_waitcnt lgkmcnt(13)
  ds_read_b64_tr_b16 a[166:167], v40 offset:45056
  v_mfma_f32_16x16x32_bf16 v[172:175], a[136:139], a[56:59], v[172:175]
  s_waitcnt lgkmcnt(12)
  buffer_load_dwordx4 a[112:115], v61, s[40:43], s34 offen offset:0 sc1
  v_mfma_f32_16x16x32_bf16 v[172:175], a[140:143], a[60:63], v[172:175]
  v_mfma_f32_16x16x32_bf16 v[168:171], a[140:143], a[52:55], v[168:171]
  v_mfma_f32_16x16x32_bf16 v[168:171], a[136:139], a[48:51], v[168:171]
  v_mfma_f32_16x16x32_bf16 v[108:111], a[136:139], a[40:43], v[108:111]
  ds_read_b64_tr_b16 a[168:169], v41 offset:32768
  buffer_load_dwordx4 a[120:123], v61, s[40:43], s34 offen offset:1024 sc1
  v_mfma_f32_16x16x32_bf16 v[108:111], a[140:143], a[44:47], v[108:111]
  s_xor_b32 s34, s101, 0x3e000
  ds_read_b64_tr_b16 a[170:171], v41 offset:36864
  v_mfma_f32_16x16x32_bf16 v[104:107], a[140:143], a[36:39], v[104:107]
  ds_read_b64_tr_b16 a[172:173], v41 offset:40960
  buffer_load_dwordx4 a[100:103], v60, s[40:43], s34 offen offset:0 sc1
  v_mfma_f32_16x16x32_bf16 v[104:107], a[136:139], a[32:35], v[104:107]
  s_waitcnt lgkmcnt(13)
  ds_read_b64_tr_b16 a[174:175], v41 offset:45056
  v_mfma_f32_16x16x32_bf16 v[112:115], a[144:147], a[32:35], v[112:115]
  s_waitcnt lgkmcnt(12)
  buffer_load_dwordx4 a[108:111], v60, s[40:43], s34 offen offset:1024 sc1
  v_mfma_f32_16x16x32_bf16 v[112:115], a[148:151], a[36:39], v[112:115]
  v_mfma_f32_16x16x32_bf16 v[116:119], a[148:151], a[44:47], v[116:119]
  buffer_load_dwordx4 a[116:119], v61, s[40:43], s34 offen offset:0 sc1
  v_mfma_f32_16x16x32_bf16 v[116:119], a[144:147], a[40:43], v[116:119]
  v_mfma_f32_16x16x32_bf16 v[176:179], a[144:147], a[48:51], v[176:179]
  ds_read_b64_tr_b16 a[176:177], v42 offset:32768
  buffer_load_dwordx4 a[124:127], v61, s[40:43], s34 offen offset:1024 sc1
  v_mfma_f32_16x16x32_bf16 v[176:179], a[148:151], a[52:55], v[176:179]
  ds_read_b64_tr_b16 a[178:179], v42 offset:36864
  v_mfma_f32_16x16x32_bf16 v[180:183], a[148:151], a[60:63], v[180:183]
  ds_read_b64_tr_b16 a[180:181], v42 offset:40960
  v_mfma_f32_16x16x32_bf16 v[180:183], a[144:147], a[56:59], v[180:183]
  s_waitcnt lgkmcnt(13)
  ds_read_b64_tr_b16 a[182:183], v42 offset:45056
  v_mfma_f32_16x16x32_bf16 v[188:191], a[152:155], a[56:59], v[188:191]
  s_waitcnt lgkmcnt(12)
  v_mfma_f32_16x16x32_bf16 v[188:191], a[156:159], a[60:63], v[188:191]
  v_mfma_f32_16x16x32_bf16 v[184:187], a[156:159], a[52:55], v[184:187]
  v_mfma_f32_16x16x32_bf16 v[184:187], a[152:155], a[48:51], v[184:187]
  v_mfma_f32_16x16x32_bf16 v[124:127], a[152:155], a[40:43], v[124:127]
  ds_read_b64_tr_b16 a[184:185], v43 offset:32768
  v_mfma_f32_16x16x32_bf16 v[124:127], a[156:159], a[44:47], v[124:127]
  ds_read_b64_tr_b16 a[186:187], v43 offset:36864
  v_mfma_f32_16x16x32_bf16 v[120:123], a[156:159], a[36:39], v[120:123]
  ds_read_b64_tr_b16 a[188:189], v43 offset:40960
  v_mfma_f32_16x16x32_bf16 v[120:123], a[152:155], a[32:35], v[120:123]
  s_waitcnt vmcnt(19) lgkmcnt(13)
  ds_read_b64_tr_b16 a[190:191], v43 offset:45056
  v_mfma_f32_16x16x32_bf16 v[96:99], a[160:163], a[64:67], v[96:99]
  s_waitcnt vmcnt(15) lgkmcnt(12)
  v_mfma_f32_16x16x32_bf16 v[96:99], a[164:167], a[68:71], v[96:99]
  s_waitcnt vmcnt(14)
  v_mfma_f32_16x16x32_bf16 v[100:103], a[164:167], a[76:79], v[100:103]
  s_waitcnt vmcnt(8)
  v_mfma_f32_16x16x32_bf16 v[100:103], a[160:163], a[72:75], v[100:103]
  s_barrier
  v_mfma_f32_16x16x32_bf16 v[160:163], a[160:163], a[80:83], v[160:163]
  ds_read_b64_tr_b16 a[128:129], v40 offset:49152
  v_mfma_f32_16x16x32_bf16 v[160:163], a[164:167], a[84:87], v[160:163]
  ds_read_b64_tr_b16 a[130:131], v40 offset:53248
  v_mfma_f32_16x16x32_bf16 v[164:167], a[164:167], a[92:95], v[164:167]
  ds_read_b64_tr_b16 a[132:133], v40 offset:57344
  v_mfma_f32_16x16x32_bf16 v[164:167], a[160:163], a[88:91], v[164:167]
  s_waitcnt lgkmcnt(13)
  ds_read_b64_tr_b16 a[134:135], v40 offset:61440
  v_mfma_f32_16x16x32_bf16 v[172:175], a[168:171], a[88:91], v[172:175]
  s_waitcnt lgkmcnt(12)
  v_mfma_f32_16x16x32_bf16 v[172:175], a[172:175], a[92:95], v[172:175]
  v_mfma_f32_16x16x32_bf16 v[168:171], a[172:175], a[84:87], v[168:171]
  v_mfma_f32_16x16x32_bf16 v[168:171], a[168:171], a[80:83], v[168:171]
  v_mfma_f32_16x16x32_bf16 v[108:111], a[168:171], a[72:75], v[108:111]
  ds_read_b64_tr_b16 a[136:137], v41 offset:49152
  v_mfma_f32_16x16x32_bf16 v[108:111], a[172:175], a[76:79], v[108:111]
  ds_read_b64_tr_b16 a[138:139], v41 offset:53248
  v_mfma_f32_16x16x32_bf16 v[104:107], a[172:175], a[68:71], v[104:107]
  ds_read_b64_tr_b16 a[140:141], v41 offset:57344
  v_mfma_f32_16x16x32_bf16 v[104:107], a[168:171], a[64:67], v[104:107]
  s_waitcnt lgkmcnt(13)
  ds_read_b64_tr_b16 a[142:143], v41 offset:61440
  v_mfma_f32_16x16x32_bf16 v[112:115], a[176:179], a[64:67], v[112:115]
  s_waitcnt lgkmcnt(12)
  v_mfma_f32_16x16x32_bf16 v[112:115], a[180:183], a[68:71], v[112:115]
  v_mfma_f32_16x16x32_bf16 v[116:119], a[180:183], a[76:79], v[116:119]
  v_mfma_f32_16x16x32_bf16 v[116:119], a[176:179], a[72:75], v[116:119]
  v_mfma_f32_16x16x32_bf16 v[176:179], a[176:179], a[80:83], v[176:179]
  ds_read_b64_tr_b16 a[144:145], v42 offset:49152
  v_mfma_f32_16x16x32_bf16 v[176:179], a[180:183], a[84:87], v[176:179]
  ds_read_b64_tr_b16 a[146:147], v42 offset:53248
  v_mfma_f32_16x16x32_bf16 v[180:183], a[180:183], a[92:95], v[180:183]
  ds_read_b64_tr_b16 a[148:149], v42 offset:57344
  v_mfma_f32_16x16x32_bf16 v[180:183], a[176:179], a[88:91], v[180:183]
  s_waitcnt lgkmcnt(13)
  ds_read_b64_tr_b16 a[150:151], v42 offset:61440
  v_mfma_f32_16x16x32_bf16 v[188:191], a[184:187], a[88:91], v[188:191]
  s_waitcnt lgkmcnt(12)
  v_mfma_f32_16x16x32_bf16 v[188:191], a[188:191], a[92:95], v[188:191]
  v_mfma_f32_16x16x32_bf16 v[184:187], a[188:191], a[84:87], v[184:187]
  v_mfma_f32_16x16x32_bf16 v[184:187], a[184:187], a[80:83], v[184:187]
  v_mfma_f32_16x16x32_bf16 v[124:127], a[184:187], a[72:75], v[124:127]
  ds_read_b64_tr_b16 a[152:153], v43 offset:49152
  v_mfma_f32_16x16x32_bf16 v[124:127], a[188:191], a[76:79], v[124:127]
  ds_read_b64_tr_b16 a[154:155], v43 offset:53248
  v_mfma_f32_16x16x32_bf16 v[120:123], a[188:191], a[68:71], v[120:123]
  ds_read_b64_tr_b16 a[156:157], v43 offset:57344
  v_mfma_f32_16x16x32_bf16 v[120:123], a[184:187], a[64:67], v[120:123]
  s_waitcnt vmcnt(7) lgkmcnt(13)
  ds_read_b64_tr_b16 a[158:159], v43 offset:61440
  v_mfma_f32_16x16x32_bf16 v[96:99], a[128:131], a[96:99], v[96:99]
  s_waitcnt vmcnt(3) lgkmcnt(12)
  v_mfma_f32_16x16x32_bf16 v[96:99], a[132:135], a[100:103], v[96:99]
  s_waitcnt vmcnt(2)
  v_mfma_f32_16x16x32_bf16 v[100:103], a[132:135], a[108:111], v[100:103]
  v_mfma_f32_16x16x32_bf16 v[100:103], a[128:131], a[104:107], v[100:103]
  v_mfma_f32_16x16x32_bf16 v[160:163], a[128:131], a[112:115], v[160:163]
  s_waitcnt vmcnt(1)
  ds_read_b64_tr_b16 a[160:161], v28 offset:16384
  v_mfma_f32_16x16x32_bf16 v[160:163], a[132:135], a[116:119], v[160:163]
  s_waitcnt vmcnt(0)
  ds_read_b64_tr_b16 a[162:163], v28 offset:20480
  v_mfma_f32_16x16x32_bf16 v[164:167], a[132:135], a[124:127], v[164:167]
  ds_read_b64_tr_b16 a[164:165], v28 offset:24576
  v_mfma_f32_16x16x32_bf16 v[164:167], a[128:131], a[120:123], v[164:167]
  s_waitcnt lgkmcnt(13)
  ds_read_b64_tr_b16 a[166:167], v28 offset:28672
  v_mfma_f32_16x16x32_bf16 v[172:175], a[136:139], a[120:123], v[172:175]
  s_waitcnt lgkmcnt(12)
  v_cvt_pk_bf16_f32 v96, v96, v97
  v_cvt_pk_bf16_f32 v97, v98, v99
  v_mfma_f32_16x16x32_bf16 v[172:175], a[140:143], a[124:127], v[172:175]
  v_cvt_pk_bf16_f32 v98, v100, v101
  v_cvt_pk_bf16_f32 v99, v102, v103
  v_mfma_f32_16x16x32_bf16 v[168:171], a[140:143], a[116:119], v[168:171]
  ds_read_b64_tr_b16 a[168:169], v29 offset:16384
  v_mfma_f32_16x16x32_bf16 v[168:171], a[136:139], a[112:115], v[168:171]
  ds_read_b64_tr_b16 a[170:171], v29 offset:20480
  v_mfma_f32_16x16x32_bf16 v[108:111], a[136:139], a[104:107], v[108:111]
  v_cvt_pk_bf16_f32 v160, v160, v161
  v_cvt_pk_bf16_f32 v161, v162, v163
  v_mfma_f32_16x16x32_bf16 v[108:111], a[140:143], a[108:111], v[108:111]
  v_cvt_pk_bf16_f32 v162, v164, v165
  v_cvt_pk_bf16_f32 v163, v166, v167
  v_mfma_f32_16x16x32_bf16 v[104:107], a[140:143], a[100:103], v[104:107]
  s_xor_b32 s36, s8, 0x33000
  ds_read_b64_tr_b16 a[172:173], v29 offset:24576
  v_mfma_f32_16x16x32_bf16 v[104:107], a[136:139], a[96:99], v[104:107]
L_pad18:
  s_cbranch_execz L_hr2
  s_waitcnt lgkmcnt(13)
  ds_read_b64_tr_b16 a[174:175], v29 offset:28672
  buffer_store_dwordx4 v[160:163], v3, s[4:7], s36 offen offset:0 sc1
  v_mfma_f32_16x16x32_bf16 v[112:115], a[144:147], a[96:99], v[112:115]
  s_waitcnt lgkmcnt(12)
  v_cvt_pk_bf16_f32 v168, v168, v169
  v_cvt_pk_bf16_f32 v169, v170, v171
  v_mfma_f32_16x16x32_bf16 v[112:115], a[148:151], a[100:103], v[112:115]
  v_cvt_pk_bf16_f32 v170, v172, v173
  v_cvt_pk_bf16_f32 v171, v174, v175
  v_mfma_f32_16x16x32_bf16 v[116:119], a[148:151], a[108:111], v[116:119]
  ds_read_b64_tr_b16 a[176:177], v30 offset:16384
  buffer_store_dwordx4 v[168:171], v3, s[4:7], s36 offen offset:1024 sc1
  v_mfma_f32_16x16x32_bf16 v[116:119], a[144:147], a[104:107], v[116:119]
  ds_read_b64_tr_b16 a[178:179], v30 offset:20480
  v_mfma_f32_16x16x32_bf16 v[176:179], a[144:147], a[112:115], v[176:179]
  v_cvt_pk_bf16_f32 v104, v104, v105
  v_cvt_pk_bf16_f32 v105, v106, v107
  v_mfma_f32_16x16x32_bf16 v[176:179], a[148:151], a[116:119], v[176:179]
  v_cvt_pk_bf16_f32 v106, v108, v109
  v_cvt_pk_bf16_f32 v107, v110, v111
  v_mfma_f32_16x16x32_bf16 v[180:183], a[148:151], a[124:127], v[180:183]
  ds_read_b64_tr_b16 a[180:181], v30 offset:24576
  v_mfma_f32_16x16x32_bf16 v[180:183], a[144:147], a[120:123], v[180:183]
  s_waitcnt lgkmcnt(13)
  ds_read_b64_tr_b16 a[182:183], v30 offset:28672
  v_mfma_f32_16x16x32_bf16 v[188:191], a[152:155], a[120:123], v[188:191]
  s_waitcnt lgkmcnt(12)
  v_cvt_pk_bf16_f32 v112, v112, v113
  v_cvt_pk_bf16_f32 v113, v114, v115
  v_mfma_f32_16x16x32_bf16 v[188:191], a[156:159], a[124:127], v[188:191]
  v_cvt_pk_bf16_f32 v114, v116, v117
  v_cvt_pk_bf16_f32 v115, v118, v119
  v_mfma_f32_16x16x32_bf16 v[184:187], a[156:159], a[116:119], v[184:187]
  ds_read_b64_tr_b16 a[184:185], v31 offset:16384
  v_mfma_f32_16x16x32_bf16 v[184:187], a[152:155], a[112:115], v[184:187]
  ds_read_b64_tr_b16 a[186:187], v31 offset:20480
  v_mfma_f32_16x16x32_bf16 v[124:127], a[152:155], a[104:107], v[124:127]
  v_cvt_pk_bf16_f32 v176, v176, v177
  v_cvt_pk_bf16_f32 v177, v178, v179
  v_mfma_f32_16x16x32_bf16 v[124:127], a[156:159], a[108:111], v[124:127]
  v_cvt_pk_bf16_f32 v178, v180, v181
  v_cvt_pk_bf16_f32 v179, v182, v183
  v_mfma_f32_16x16x32_bf16 v[120:123], a[156:159], a[100:103], v[120:123]
  ds_read_b64_tr_b16 a[188:189], v31 offset:24576
  buffer_store_dwordx4 v[176:179], v3, s[4:7], s36 offen offset:2048 sc1
  v_mfma_f32_16x16x32_bf16 v[120:123], a[152:155], a[96:99], v[120:123]
  s_waitcnt lgkmcnt(13)
  ds_read_b64_tr_b16 a[190:191], v31 offset:28672
  v_mfma_f32_16x16x32_bf16 v[128:131], a[160:163], v[240:243], v[128:131]
  s_waitcnt lgkmcnt(12)
  v_cvt_pk_bf16_f32 v184, v184, v185
  v_cvt_pk_bf16_f32 v185, v186, v187
  v_mfma_f32_16x16x32_bf16 v[128:131], a[164:167], v[244:247], v[128:131]
  v_cvt_pk_bf16_f32 v186, v188, v189
  v_cvt_pk_bf16_f32 v187, v190, v191
  v_mfma_f32_16x16x32_bf16 v[132:135], a[164:167], v[252:255], v[132:135]
  ds_read_b64_tr_b16 a[128:129], v28 offset:32768
  buffer_store_dwordx4 v[184:187], v3, s[4:7], s36 offen offset:3072 sc1
  v_mfma_f32_16x16x32_bf16 v[132:135], a[160:163], v[248:251], v[132:135]
  s_waitcnt lgkmcnt(11)
  s_xor_b32 s36, s8, 0x11000
  ds_read_b64_tr_b16 a[130:131], v28 offset:36864
  v_mfma_f32_16x16x32_bf16 v[140:143], a[168:171], v[248:251], v[140:143]
  s_waitcnt lgkmcnt(10)
  v_cvt_pk_bf16_f32 v120, v120, v121
  v_cvt_pk_bf16_f32 v121, v122, v123
  v_mfma_f32_16x16x32_bf16 v[140:143], a[172:175], v[252:255], v[140:143]
  v_cvt_pk_bf16_f32 v122, v124, v125
  v_cvt_pk_bf16_f32 v123, v126, v127
  v_mfma_f32_16x16x32_bf16 v[136:139], a[172:175], v[244:247], v[136:139]
  ds_read_b64_tr_b16 a[132:133], v28 offset:40960
  buffer_store_dwordx4 v[96:99], v3, s[4:7], s36 offen offset:0 sc1
  v_mfma_f32_16x16x32_bf16 v[136:139], a[168:171], v[240:243], v[136:139]
  s_waitcnt lgkmcnt(9)
  ds_read_b64_tr_b16 a[134:135], v28 offset:45056
  v_mfma_f32_16x16x32_bf16 v[144:147], a[176:179], v[240:243], v[144:147]
  s_waitcnt lgkmcnt(8)
  ds_read_b64_tr_b16 a[136:137], v29 offset:32768
  buffer_store_dwordx4 v[104:107], v3, s[4:7], s36 offen offset:1024 sc1
  v_mfma_f32_16x16x32_bf16 v[144:147], a[180:183], v[244:247], v[144:147]
  ds_read_b64_tr_b16 a[138:139], v29 offset:36864
  v_mfma_f32_16x16x32_bf16 v[148:151], a[180:183], v[252:255], v[148:151]
  ds_read_b64_tr_b16 a[140:141], v29 offset:40960
  v_mfma_f32_16x16x32_bf16 v[148:151], a[176:179], v[248:251], v[148:151]
  s_waitcnt lgkmcnt(9)
  ds_read_b64_tr_b16 a[142:143], v29 offset:45056
  buffer_store_dwordx4 v[112:115], v3, s[4:7], s36 offen offset:2048 sc1
  v_mfma_f32_16x16x32_bf16 v[156:159], a[184:187], v[248:251], v[156:159]
  s_waitcnt lgkmcnt(8)
  ds_read_b64_tr_b16 a[144:145], v30 offset:32768
  v_mfma_f32_16x16x32_bf16 v[156:159], a[188:191], v[252:255], v[156:159]
  ds_read_b64_tr_b16 a[146:147], v30 offset:36864
  v_mfma_f32_16x16x32_bf16 v[152:155], a[188:191], v[244:247], v[152:155]
  ds_read_b64_tr_b16 a[148:149], v30 offset:40960
  buffer_store_dwordx4 v[120:123], v3, s[4:7], s36 offen offset:3072 sc1
  v_mfma_f32_16x16x32_bf16 v[152:155], a[184:187], v[240:243], v[152:155]
  s_waitcnt lgkmcnt(9)
  ds_read_b64_tr_b16 a[150:151], v30 offset:45056
  v_mfma_f32_16x16x32_bf16 v[128:131], a[128:131], a[208:211], v[128:131]
  s_waitcnt lgkmcnt(8)
  s_mov_b32 s13, 0x0
  ds_read_b64_tr_b16 a[152:153], v31 offset:32768
  v_mfma_f32_16x16x32_bf16 v[128:131], a[132:135], a[212:215], v[128:131]
  ds_read_b64_tr_b16 a[154:155], v31 offset:36864
  buffer_load_dwordx4 v[240:243], v47, s[52:55], s13 offen sc1
  v_mfma_f32_16x16x32_bf16 v[132:135], a[132:135], a[220:223], v[132:135]
  s_mov_b32 s13, 0x10000
  ds_read_b64_tr_b16 a[156:157], v31 offset:40960
  v_mfma_f32_16x16x32_bf16 v[132:135], a[128:131], a[216:219], v[132:135]
  s_waitcnt lgkmcnt(9)
  ds_read_b64_tr_b16 a[158:159], v31 offset:45056
  v_mfma_f32_16x16x32_bf16 v[140:143], a[136:139], a[216:219], v[140:143]
  s_waitcnt lgkmcnt(8)
  ds_read_b64_tr_b16 a[160:161], v28 offset:49152
  buffer_load_dwordx4 v[244:247], v47, s[52:55], s13 offen sc1
  v_mfma_f32_16x16x32_bf16 v[140:143], a[140:143], a[220:223], v[140:143]
  s_mov_b32 s13, 0x20000
  ds_read_b64_tr_b16 a[162:163], v28 offset:53248
  v_mfma_f32_16x16x32_bf16 v[136:139], a[140:143], a[212:215], v[136:139]
  ds_read_b64_tr_b16 a[164:165], v28 offset:57344
  v_mfma_f32_16x16x32_bf16 v[136:139], a[136:139], a[208:211], v[136:139]
  s_waitcnt lgkmcnt(9)
  ds_read_b64_tr_b16 a[166:167], v28 offset:61440
  buffer_load_dwordx4 v[248:251], v47, s[52:55], s13 offen sc1
  v_mfma_f32_16x16x32_bf16 v[144:147], a[144:147], a[208:211], v[144:147]
  s_waitcnt lgkmcnt(8)
  s_mov_b32 s13, 0x30000
  ds_read_b64_tr_b16 a[168:169], v29 offset:49152
  v_mfma_f32_16x16x32_bf16 v[144:147], a[148:151], a[212:215], v[144:147]
  ds_read_b64_tr_b16 a[170:171], v29 offset:53248
  v_mfma_f32_16x16x32_bf16 v[148:151], a[148:151], a[220:223], v[148:151]
  ds_read_b64_tr_b16 a[172:173], v29 offset:57344
  buffer_load_dwordx4 v[252:255], v47, s[52:55], s13 offen sc1
  v_mfma_f32_16x16x32_bf16 v[148:151], a[144:147], a[216:219], v[148:151]
  s_waitcnt lgkmcnt(9)
  ds_read_b64_tr_b16 a[174:175], v29 offset:61440
  v_mfma_f32_16x16x32_bf16 v[156:159], a[152:155], a[216:219], v[156:159]
  s_waitcnt lgkmcnt(8)
  ds_read_b64_tr_b16 a[176:177], v30 offset:49152
  v_mfma_f32_16x16x32_bf16 v[156:159], a[156:159], a[220:223], v[156:159]
  ds_read_b64_tr_b16 a[178:179], v30 offset:53248
  v_mfma_f32_16x16x32_bf16 v[152:155], a[156:159], a[212:215], v[152:155]
  ds_read_b64_tr_b16 a[180:181], v30 offset:57344
  v_mfma_f32_16x16x32_bf16 v[152:155], a[152:155], a[208:211], v[152:155]
  s_waitcnt lgkmcnt(9)
  ds_read_b64_tr_b16 a[182:183], v30 offset:61440
  v_mfma_f32_16x16x32_bf16 v[128:131], a[160:163], a[240:243], v[128:131]
  s_waitcnt lgkmcnt(8)
  ds_read_b64_tr_b16 a[184:185], v31 offset:49152
  v_mfma_f32_16x16x32_bf16 v[128:131], a[164:167], a[244:247], v[128:131]
  ds_read_b64_tr_b16 a[186:187], v31 offset:53248
  v_mfma_f32_16x16x32_bf16 v[132:135], a[164:167], a[252:255], v[132:135]
  ds_read_b64_tr_b16 a[188:189], v31 offset:57344
  v_mfma_f32_16x16x32_bf16 v[132:135], a[160:163], a[248:251], v[132:135]
  s_waitcnt lgkmcnt(9)
  ds_read_b64_tr_b16 a[190:191], v31 offset:61440
  v_mfma_f32_16x16x32_bf16 v[140:143], a[168:171], a[248:251], v[140:143]
  s_waitcnt lgkmcnt(8)
  ds_read_b64_tr_b16 a[128:129], v36 offset:0
  v_mfma_f32_16x16x32_bf16 v[140:143], a[172:175], a[252:255], v[140:143]
  ds_read_b64_tr_b16 a[130:131], v36 offset:4096
  v_mfma_f32_16x16x32_bf16 v[136:139], a[172:175], a[244:247], v[136:139]
  ds_read_b64_tr_b16 a[132:133], v36 offset:8192
  v_mfma_f32_16x16x32_bf16 v[136:139], a[168:171], a[240:243], v[136:139]
  s_waitcnt lgkmcnt(9)
  ds_read_b64_tr_b16 a[134:135], v36 offset:12288
  v_mfma_f32_16x16x32_bf16 v[144:147], a[176:179], a[240:243], v[144:147]
  s_waitcnt lgkmcnt(8)
  ds_read_b64_tr_b16 a[136:137], v37 offset:0
  v_mfma_f32_16x16x32_bf16 v[144:147], a[180:183], a[244:247], v[144:147]
  ds_read_b64_tr_b16 a[138:139], v37 offset:4096
  v_mfma_f32_16x16x32_bf16 v[148:151], a[180:183], a[252:255], v[148:151]
  ds_read_b64_tr_b16 a[140:141], v37 offset:8192
  v_mfma_f32_16x16x32_bf16 v[148:151], a[176:179], a[248:251], v[148:151]
  s_waitcnt lgkmcnt(9)
  ds_read_b64_tr_b16 a[142:143], v37 offset:12288
  v_mfma_f32_16x16x32_bf16 v[156:159], a[184:187], a[248:251], v[156:159]
  s_waitcnt lgkmcnt(8)
  ds_read_b64_tr_b16 a[144:145], v38 offset:0
  v_mfma_f32_16x16x32_bf16 v[156:159], a[188:191], a[252:255], v[156:159]
  ds_read_b64_tr_b16 a[146:147], v38 offset:4096
  v_mfma_f32_16x16x32_bf16 v[152:155], a[188:191], a[244:247], v[152:155]
  ds_read_b64_tr_b16 a[148:149], v38 offset:8192
  v_mfma_f32_16x16x32_bf16 v[152:155], a[184:187], a[240:243], v[152:155]
  s_waitcnt lgkmcnt(9)
  ds_read_b64_tr_b16 a[150:151], v38 offset:12288
  v_mfma_f32_16x16x32_bf16 v[128:131], a[128:131], a[16:19], v[128:131]
  s_waitcnt lgkmcnt(8)
  s_xor_b32 s3, s35, 0x1980
  ds_read_b64_tr_b16 a[152:153], v39 offset:0
  v_mfma_f32_16x16x32_bf16 v[128:131], a[132:135], a[20:23], v[128:131]
  s_waitcnt vmcnt(8)
  ds_read_b64_tr_b16 a[154:155], v39 offset:4096
  buffer_store_dword v9, v49, s[20:23], s3 offen sc1
  v_mfma_f32_16x16x32_bf16 v[132:135], a[132:135], a[28:31], v[132:135]
  ds_read_b64_tr_b16 a[156:157], v39 offset:8192
  v_mfma_f32_16x16x32_bf16 v[132:135], a[128:131], a[24:27], v[132:135]
  s_waitcnt lgkmcnt(9)
  ds_read_b64_tr_b16 a[158:159], v39 offset:12288
  v_mfma_f32_16x16x32_bf16 v[140:143], a[136:139], a[24:27], v[140:143]
  s_waitcnt lgkmcnt(8)
  ds_read_b64_tr_b16 a[160:161], v36 offset:16384
  v_mfma_f32_16x16x32_bf16 v[140:143], a[140:143], a[28:31], v[140:143]
  ds_read_b64_tr_b16 a[162:163], v36 offset:20480
  v_mfma_f32_16x16x32_bf16 v[136:139], a[140:143], a[20:23], v[136:139]
  ds_read_b64_tr_b16 a[164:165], v36 offset:24576
  v_mfma_f32_16x16x32_bf16 v[136:139], a[136:139], a[16:19], v[136:139]
  s_waitcnt lgkmcnt(9)
  ds_read_b64_tr_b16 a[166:167], v36 offset:28672
  v_mfma_f32_16x16x32_bf16 v[144:147], a[144:147], a[16:19], v[144:147]
  s_waitcnt lgkmcnt(8)
  ds_read_b64_tr_b16 a[168:169], v37 offset:16384
  v_mfma_f32_16x16x32_bf16 v[144:147], a[148:151], a[20:23], v[144:147]
  ds_read_b64_tr_b16 a[170:171], v37 offset:20480
  v_mfma_f32_16x16x32_bf16 v[148:151], a[148:151], a[28:31], v[148:151]
  ds_read_b64_tr_b16 a[172:173], v37 offset:24576
  v_mfma_f32_16x16x32_bf16 v[148:151], a[144:147], a[24:27], v[148:151]
  s_waitcnt lgkmcnt(9)
  ds_read_b64_tr_b16 a[174:175], v37 offset:28672
  v_mfma_f32_16x16x32_bf16 v[156:159], a[152:155], a[24:27], v[156:159]
  s_waitcnt lgkmcnt(8)
  ds_read_b64_tr_b16 a[176:177], v38 offset:16384
  v_mfma_f32_16x16x32_bf16 v[156:159], a[156:159], a[28:31], v[156:159]
  ds_read_b64_tr_b16 a[178:179], v38 offset:20480
  v_mfma_f32_16x16x32_bf16 v[152:155], a[156:159], a[20:23], v[152:155]
  ds_read_b64_tr_b16 a[180:181], v38 offset:24576
  v_mfma_f32_16x16x32_bf16 v[152:155], a[152:155], a[16:19], v[152:155]
  s_waitcnt lgkmcnt(9)
  ds_read_b64_tr_b16 a[182:183], v38 offset:28672
  v_mfma_f32_16x16x32_bf16 v[128:131], a[160:163], a[48:51], v[128:131]
  s_waitcnt lgkmcnt(8)
  ds_read_b64_tr_b16 a[184:185], v39 offset:16384
  v_mfma_f32_16x16x32_bf16 v[128:131], a[164:167], a[52:55], v[128:131]
  ds_read_b64_tr_b16 a[186:187], v39 offset:20480
  v_mfma_f32_16x16x32_bf16 v[132:135], a[164:167], a[60:63], v[132:135]
  ds_read_b64_tr_b16 a[188:189], v39 offset:24576
  v_sub_f32 v54, 1.0, v50
  v_mfma_f32_16x16x32_bf16 v[132:135], a[160:163], a[56:59], v[132:135]
  s_waitcnt lgkmcnt(9)
  ds_read_b64_tr_b16 a[190:191], v39 offset:28672
  v_lshlrev_b32 v14, 16, v208
  v_mfma_f32_16x16x32_bf16 v[140:143], a[168:171], a[56:59], v[140:143]
  s_waitcnt vmcnt(4) lgkmcnt(8)
  ds_read_b64_tr_b16 a[128:129], v36 offset:32768
  v_lshlrev_b32 v15, 16, v240
  v_mfma_f32_16x16x32_bf16 v[140:143], a[172:175], a[60:63], v[140:143]
  ds_read_b64_tr_b16 a[130:131], v36 offset:36864
  v_mul_f32 v160, v14, v15
  v_mfma_f32_16x16x32_bf16 v[136:139], a[172:175], a[52:55], v[136:139]
  ds_read_b64_tr_b16 a[132:133], v36 offset:40960
  v_mul_f32 v160, v160, v54
  v_mfma_f32_16x16x32_bf16 v[136:139], a[168:171], a[48:51], v[136:139]
  s_waitcnt lgkmcnt(9)
  ds_read_b64_tr_b16 a[134:135], v36 offset:45056
  v_and_b32 v14, s96, v208
  v_mfma_f32_16x16x32_bf16 v[144:147], a[176:179], a[48:51], v[144:147]
  s_waitcnt lgkmcnt(8)
  ds_read_b64_tr_b16 a[136:137], v37 offset:32768
  v_and_b32 v15, s96, v240
  v_mfma_f32_16x16x32_bf16 v[144:147], a[180:183], a[52:55], v[144:147]
  ds_read_b64_tr_b16 a[138:139], v37 offset:36864
  v_mul_f32 v161, v14, v15
  v_mfma_f32_16x16x32_bf16 v[148:151], a[180:183], a[60:63], v[148:151]
  ds_read_b64_tr_b16 a[140:141], v37 offset:40960
  v_mul_f32 v161, v161, v54
  v_mfma_f32_16x16x32_bf16 v[148:151], a[176:179], a[56:59], v[148:151]
  s_waitcnt lgkmcnt(9)
  ds_read_b64_tr_b16 a[142:143], v37 offset:45056
  v_lshlrev_b32 v14, 16, v209
  v_mfma_f32_16x16x32_bf16 v[156:159], a[184:187], a[56:59], v[156:159]
  s_waitcnt lgkmcnt(8)
  ds_read_b64_tr_b16 a[144:145], v38 offset:32768
  v_lshlrev_b32 v15, 16, v241
  v_mfma_f32_16x16x32_bf16 v[156:159], a[188:191], a[60:63], v[156:159]
  ds_read_b64_tr_b16 a[146:147], v38 offset:36864
  v_mul_f32 v162, v14, v15
  v_mfma_f32_16x16x32_bf16 v[152:155], a[188:191], a[52:55], v[152:155]
  ds_read_b64_tr_b16 a[148:149], v38 offset:40960
  v_mul_f32 v162, v162, v54
  v_mfma_f32_16x16x32_bf16 v[152:155], a[184:187], a[48:51], v[152:155]
  s_waitcnt lgkmcnt(9)
  ds_read_b64_tr_b16 a[150:151], v38 offset:45056
  v_and_b32 v14, s96, v209
  v_mfma_f32_16x16x32_bf16 v[128:131], a[128:131], a[80:83], v[128:131]
  s_waitcnt lgkmcnt(8)
  ds_read_b64_tr_b16 a[152:153], v39 offset:32768
  v_and_b32 v15, s96, v241
  v_mfma_f32_16x16x32_bf16 v[128:131], a[132:135], a[84:87], v[128:131]
  ds_read_b64_tr_b16 a[154:155], v39 offset:36864
  v_mul_f32 v163, v14, v15
  v_mfma_f32_16x16x32_bf16 v[132:135], a[132:135], a[92:95], v[132:135]
  ds_read_b64_tr_b16 a[156:157], v39 offset:40960
  v_mul_f32 v163, v163, v54
  v_mfma_f32_16x16x32_bf16 v[132:135], a[128:131], a[88:91], v[132:135]
  s_waitcnt lgkmcnt(9)
  ds_read_b64_tr_b16 a[158:159], v39 offset:45056
  v_lshlrev_b32 v14, 16, v210
  v_mfma_f32_16x16x32_bf16 v[140:143], a[136:139], a[88:91], v[140:143]
  s_waitcnt vmcnt(3) lgkmcnt(8)
  ds_read_b64_tr_b16 a[160:161], v36 offset:49152
  v_lshlrev_b32 v15, 16, v244
  v_mfma_f32_16x16x32_bf16 v[140:143], a[140:143], a[92:95], v[140:143]
  ds_read_b64_tr_b16 a[162:163], v36 offset:53248
  v_mul_f32 v168, v14, v15
  v_mfma_f32_16x16x32_bf16 v[136:139], a[140:143], a[84:87], v[136:139]
  ds_read_b64_tr_b16 a[164:165], v36 offset:57344
  v_mul_f32 v168, v168, v54
  v_mfma_f32_16x16x32_bf16 v[136:139], a[136:139], a[80:83], v[136:139]
  s_waitcnt lgkmcnt(9)
  ds_read_b64_tr_b16 a[166:167], v36 offset:61440
  v_and_b32 v14, s96, v210
  v_mfma_f32_16x16x32_bf16 v[144:147], a[144:147], a[80:83], v[144:147]
  s_waitcnt lgkmcnt(8)
  ds_read_b64_tr_b16 a[168:169], v37 offset:49152
  v_and_b32 v15, s96, v244
  v_mfma_f32_16x16x32_bf16 v[144:147], a[148:151], a[84:87], v[144:147]
  ds_read_b64_tr_b16 a[170:171], v37 offset:53248
  v_mul_f32 v169, v14, v15
  v_mfma_f32_16x16x32_bf16 v[148:151], a[148:151], a[92:95], v[148:151]
  ds_read_b64_tr_b16 a[172:173], v37 offset:57344
  v_mul_f32 v169, v169, v54
  v_mfma_f32_16x16x32_bf16 v[148:151], a[144:147], a[88:91], v[148:151]
  s_waitcnt lgkmcnt(9)
  ds_read_b64_tr_b16 a[174:175], v37 offset:61440
  v_lshlrev_b32 v14, 16, v211
  v_mfma_f32_16x16x32_bf16 v[156:159], a[152:155], a[88:91], v[156:159]
  s_waitcnt lgkmcnt(8)
  ds_read_b64_tr_b16 a[176:177], v38 offset:49152
  v_lshlrev_b32 v15, 16, v245
  v_mfma_f32_16x16x32_bf16 v[156:159], a[156:159], a[92:95], v[156:159]
  ds_read_b64_tr_b16 a[178:179], v38 offset:53248
  v_mul_f32 v170, v14, v15
  v_mfma_f32_16x16x32_bf16 v[152:155], a[156:159], a[84:87], v[152:155]
  ds_read_b64_tr_b16 a[180:181], v38 offset:57344
  v_mul_f32 v170, v170, v54
  v_mfma_f32_16x16x32_bf16 v[152:155], a[152:155], a[80:83], v[152:155]
  s_waitcnt lgkmcnt(9)
  ds_read_b64_tr_b16 a[182:183], v38 offset:61440
  v_and_b32 v14, s96, v211
  v_mfma_f32_16x16x32_bf16 v[128:131], a[160:163], a[112:115], v[128:131]
  s_waitcnt lgkmcnt(8)
  ds_read_b64_tr_b16 a[184:185], v39 offset:49152
  buffer_load_dword v10, v45, s[20:23], s35 offen offset:128 sc1
  v_mfma_f32_16x16x32_bf16 v[128:131], a[164:167], a[116:119], v[128:131]
  ds_read_b64_tr_b16 a[186:187], v39 offset:53248
  v_and_b32 v15, s96, v245
  v_mfma_f32_16x16x32_bf16 v[132:135], a[164:167], a[124:127], v[132:135]
  ds_read_b64_tr_b16 a[188:189], v39 offset:57344
  v_mul_f32 v171, v14, v15
  v_mfma_f32_16x16x32_bf16 v[132:135], a[160:163], a[120:123], v[132:135]
  s_waitcnt lgkmcnt(9)
  ds_read_b64_tr_b16 a[190:191], v39 offset:61440
  v_mul_f32 v171, v171, v54
  v_mfma_f32_16x16x32_bf16 v[140:143], a[168:171], a[120:123], v[140:143]
  s_waitcnt lgkmcnt(8)
  ds_read_b64_tr_b16 a[128:129], v28 offset:0
  v_lshlrev_b32 v14, 16, v212
  v_mfma_f32_16x16x32_bf16 v[140:143], a[172:175], a[124:127], v[140:143]
  s_waitcnt vmcnt(3)
  ds_read_b64_tr_b16 a[130:131], v28 offset:4096
  v_lshlrev_b32 v15, 16, v248
  v_mfma_f32_16x16x32_bf16 v[136:139], a[172:175], a[116:119], v[136:139]
  s_xor_b32 s3, s35, 0x880
  ds_read_b64_tr_b16 a[132:133], v28 offset:8192
  v_mul_f32 v176, v14, v15
  v_mfma_f32_16x16x32_bf16 v[136:139], a[168:171], a[112:115], v[136:139]
  s_waitcnt lgkmcnt(9)
  ds_read_b64_tr_b16 a[134:135], v28 offset:12288
  buffer_store_dword v9, v49, s[20:23], s3 offen sc1
  v_mfma_f32_16x16x32_bf16 v[144:147], a[176:179], a[112:115], v[144:147]
  s_waitcnt lgkmcnt(8)
  v_cvt_pk_bf16_f32 v128, v128, v129
  v_cvt_pk_bf16_f32 v129, v130, v131
  v_mfma_f32_16x16x32_bf16 v[144:147], a[180:183], a[116:119], v[144:147]
  v_cvt_pk_bf16_f32 v130, v132, v133
  v_cvt_pk_bf16_f32 v131, v134, v135
  v_mfma_f32_16x16x32_bf16 v[148:151], a[180:183], a[124:127], v[148:151]
  s_xor_b32 s36, s8, 0x22000
  ds_read_b64_tr_b16 a[136:137], v29 offset:0
  v_mul_f32 v176, v176, v54
  v_mfma_f32_16x16x32_bf16 v[148:151], a[176:179], a[120:123], v[148:151]
  s_waitcnt lgkmcnt(7)
  ds_read_b64_tr_b16 a[138:139], v29 offset:4096
  buffer_store_dwordx4 v[128:131], v3, s[4:7], s36 offen offset:0 sc1
  v_mfma_f32_16x16x32_bf16 v[156:159], a[184:187], a[120:123], v[156:159]
  s_waitcnt lgkmcnt(6)
  ds_read_b64_tr_b16 a[140:141], v29 offset:8192
  v_cvt_pk_bf16_f32 v136, v136, v137
  v_mfma_f32_16x16x32_bf16 v[156:159], a[188:191], a[124:127], v[156:159]
  ds_read_b64_tr_b16 a[142:143], v29 offset:12288
  v_cvt_pk_bf16_f32 v137, v138, v139
  v_mfma_f32_16x16x32_bf16 v[152:155], a[188:191], a[116:119], v[152:155]
  ds_read_b64_tr_b16 a[144:145], v30 offset:0
  v_cvt_pk_bf16_f32 v138, v140, v141
  v_mfma_f32_16x16x32_bf16 v[152:155], a[184:187], a[112:115], v[152:155]
  s_waitcnt lgkmcnt(7)
  ds_read_b64_tr_b16 a[146:147], v30 offset:4096
  v_cvt_pk_bf16_f32 v139, v142, v143
  v_mfma_f32_16x16x32_bf16 v[64:67], a[128:131], v[192:195], v[64:67]
  s_waitcnt lgkmcnt(6)
  ds_read_b64_tr_b16 a[148:149], v30 offset:8192
  v_cvt_pk_bf16_f32 v144, v144, v145
  v_mfma_f32_16x16x32_bf16 v[64:67], a[132:135], v[196:199], v[64:67]
  ds_read_b64_tr_b16 a[150:151], v30 offset:12288
  v_cvt_pk_bf16_f32 v145, v146, v147
  v_mfma_f32_16x16x32_bf16 v[68:71], a[132:135], v[204:207], v[68:71]
  ds_read_b64_tr_b16 a[152:153], v31 offset:0
  v_cvt_pk_bf16_f32 v146, v148, v149
  v_mfma_f32_16x16x32_bf16 v[68:71], a[128:131], v[200:203], v[68:71]
  s_waitcnt lgkmcnt(7)
  ds_read_b64_tr_b16 a[154:155], v31 offset:4096
  v_cvt_pk_bf16_f32 v147, v150, v151
  v_mfma_f32_16x16x32_bf16 v[76:79], a[136:139], v[200:203], v[76:79]
  s_waitcnt lgkmcnt(6)
  ds_read_b64_tr_b16 a[156:157], v31 offset:8192
  v_cvt_pk_bf16_f32 v152, v152, v153
  v_mfma_f32_16x16x32_bf16 v[76:79], a[140:143], v[204:207], v[76:79]
  ds_read_b64_tr_b16 a[158:159], v31 offset:12288
  v_cvt_pk_bf16_f32 v153, v154, v155
  v_mfma_f32_16x16x32_bf16 v[72:75], a[140:143], v[196:199], v[72:75]
  ds_read_b64_tr_b16 a[160:161], v28 offset:16384
  v_cvt_pk_bf16_f32 v154, v156, v157
  v_mfma_f32_16x16x32_bf16 v[72:75], a[136:139], v[192:195], v[72:75]
  s_waitcnt lgkmcnt(7)
  ds_read_b64_tr_b16 a[162:163], v28 offset:20480
  v_cvt_pk_bf16_f32 v155, v158, v159
  v_mfma_f32_16x16x32_bf16 v[80:83], a[144:147], v[192:195], v[80:83]
  s_waitcnt lgkmcnt(6)
  ds_read_b64_tr_b16 a[164:165], v28 offset:24576
  buffer_store_dwordx4 v[136:139], v3, s[4:7], s36 offen offset:1024 sc1
  v_mfma_f32_16x16x32_bf16 v[80:83], a[148:151], v[196:199], v[80:83]
  ds_read_b64_tr_b16 a[166:167], v28 offset:28672
  v_and_b32 v14, s96, v212
  v_mfma_f32_16x16x32_bf16 v[84:87], a[148:151], v[204:207], v[84:87]
  ds_read_b64_tr_b16 a[168:169], v29 offset:16384
  buffer_store_dwordx4 v[144:147], v3, s[4:7], s36 offen offset:2048 sc1
  v_mfma_f32_16x16x32_bf16 v[84:87], a[144:147], v[200:203], v[84:87]
  s_waitcnt lgkmcnt(7)
  ds_read_b64_tr_b16 a[170:171], v29 offset:20480
  v_and_b32 v15, s96, v248
  v_mfma_f32_16x16x32_bf16 v[92:95], a[152:155], v[200:203], v[92:95]
  s_waitcnt lgkmcnt(6)
  ds_read_b64_tr_b16 a[172:173], v29 offset:24576
  buffer_store_dwordx4 v[152:155], v3, s[4:7], s36 offen offset:3072 sc1
  v_mfma_f32_16x16x32_bf16 v[92:95], a[156:159], v[204:207], v[92:95]
  ds_read_b64_tr_b16 a[174:175], v29 offset:28672
  v_mul_f32 v177, v14, v15
  v_mfma_f32_16x16x32_bf16 v[88:91], a[156:159], v[196:199], v[88:91]
  ds_read_b64_tr_b16 a[176:177], v30 offset:16384
  v_mul_f32 v177, v177, v54
  v_mfma_f32_16x16x32_bf16 v[88:91], a[152:155], v[192:195], v[88:91]
  s_waitcnt lgkmcnt(7)
  ds_read_b64_tr_b16 a[178:179], v30 offset:20480
  v_lshlrev_b32 v14, 16, v213
  v_mfma_f32_16x16x32_bf16 v[64:67], a[160:163], v[224:227], v[64:67]
  s_waitcnt lgkmcnt(6)
  ds_read_b64_tr_b16 a[180:181], v30 offset:24576
  v_lshlrev_b32 v15, 16, v249
  v_mfma_f32_16x16x32_bf16 v[64:67], a[164:167], v[228:231], v[64:67]
  ds_read_b64_tr_b16 a[182:183], v30 offset:28672
  v_mul_f32 v178, v14, v15
  v_mfma_f32_16x16x32_bf16 v[68:71], a[164:167], v[236:239], v[68:71]
  ds_read_b64_tr_b16 a[184:185], v31 offset:16384
  v_mul_f32 v178, v178, v54
  v_mfma_f32_16x16x32_bf16 v[68:71], a[160:163], v[232:235], v[68:71]
  s_waitcnt lgkmcnt(7)
  ds_read_b64_tr_b16 a[186:187], v31 offset:20480
  v_and_b32 v14, s96, v213
  v_mfma_f32_16x16x32_bf16 v[76:79], a[168:171], v[232:235], v[76:79]
  s_waitcnt lgkmcnt(6)
  ds_read_b64_tr_b16 a[188:189], v31 offset:24576
  v_and_b32 v15, s96, v249
  v_mfma_f32_16x16x32_bf16 v[76:79], a[172:175], v[236:239], v[76:79]
  ds_read_b64_tr_b16 a[190:191], v31 offset:28672
  v_mul_f32 v179, v14, v15
  v_mfma_f32_16x16x32_bf16 v[72:75], a[172:175], v[228:231], v[72:75]
  ds_read_b64_tr_b16 a[128:129], v28 offset:32768
  v_mul_f32 v179, v179, v54
  v_mfma_f32_16x16x32_bf16 v[72:75], a[168:171], v[224:227], v[72:75]
  s_waitcnt lgkmcnt(7)
  ds_read_b64_tr_b16 a[130:131], v28 offset:36864
  v_lshlrev_b32 v14, 16, v214
  v_mfma_f32_16x16x32_bf16 v[80:83], a[176:179], v[224:227], v[80:83]
  s_waitcnt vmcnt(7) lgkmcnt(6)
  ds_read_b64_tr_b16 a[132:133], v28 offset:40960
  v_lshlrev_b32 v15, 16, v252
  v_mfma_f32_16x16x32_bf16 v[80:83], a[180:183], v[228:231], v[80:83]
  ds_read_b64_tr_b16 a[134:135], v28 offset:45056
  v_mul_f32 v184, v14, v15
  v_mfma_f32_16x16x32_bf16 v[84:87], a[180:183], v[236:239], v[84:87]
  ds_read_b64_tr_b16 a[136:137], v29 offset:32768
  v_mul_f32 v184, v184, v54
  v_mfma_f32_16x16x32_bf16 v[84:87], a[176:179], v[232:235], v[84:87]
  s_waitcnt lgkmcnt(7)
  ds_read_b64_tr_b16 a[138:139], v29 offset:36864
  v_and_b32 v14, s96, v214
  v_mfma_f32_16x16x32_bf16 v[92:95], a[184:187], v[232:235], v[92:95]
  s_waitcnt vmcnt(5) lgkmcnt(6)
  s_add_u32 s10, s8, 12288
  ds_read_b64_tr_b16 a[140:141], v29 offset:40960
  v_cmp_eq_u32 vcc, 1, v10
  v_mfma_f32_16x16x32_bf16 v[92:95], a[188:191], v[236:239], v[92:95]
  ds_read_b64_tr_b16 a[142:143], v29 offset:45056
  v_and_b32 v15, s96, v252
  v_mfma_f32_16x16x32_bf16 v[88:91], a[188:191], v[228:231], v[88:91]
  s_and_b32 s11, vcc_lo, 4
  s_cselect_b32 s10, s10, 0x1000000
  ds_read_b64_tr_b16 a[144:145], v30 offset:32768
  v_mfma_f32_16x16x32_bf16 v[88:91], a[184:187], v[224:227], v[88:91]
  s_waitcnt lgkmcnt(7)
  s_andn2_b32 s9, s9, s11
  ds_read_b64_tr_b16 a[146:147], v30 offset:36864
  v_mul_f32 v185, v14, v15
  v_mfma_f32_16x16x32_bf16 v[64:67], a[128:131], a[192:195], v[64:67]
  s_waitcnt lgkmcnt(6)
  ds_read_b64_tr_b16 a[148:149], v30 offset:40960
  buffer_load_dword v10, v45, s[20:23], s35 offen offset:128 sc1
  v_mfma_f32_16x16x32_bf16 v[64:67], a[132:135], a[196:199], v[64:67]
  ds_read_b64_tr_b16 a[150:151], v30 offset:45056
  v_mul_f32 v185, v185, v54
  v_mfma_f32_16x16x32_bf16 v[68:71], a[132:135], a[204:207], v[68:71]
  ds_read_b64_tr_b16 a[152:153], v31 offset:32768
  buffer_load_dwordx4 v[96:99], v3, s[4:7], s10 offen offset:0 sc1
  v_mfma_f32_16x16x32_bf16 v[68:71], a[128:131], a[200:203], v[68:71]
  s_waitcnt lgkmcnt(7)
  ds_read_b64_tr_b16 a[154:155], v31 offset:36864
  v_lshlrev_b32 v14, 16, v215
  v_mfma_f32_16x16x32_bf16 v[76:79], a[136:139], a[200:203], v[76:79]
  s_waitcnt lgkmcnt(6)
  ds_read_b64_tr_b16 a[156:157], v31 offset:40960
  buffer_load_dwordx4 v[100:103], v3, s[4:7], s10 offen offset:1024 sc1
  v_mfma_f32_16x16x32_bf16 v[76:79], a[140:143], a[204:207], v[76:79]
  ds_read_b64_tr_b16 a[158:159], v31 offset:45056
  v_lshlrev_b32 v15, 16, v253
  v_mfma_f32_16x16x32_bf16 v[72:75], a[140:143], a[196:199], v[72:75]
  ds_read_b64_tr_b16 a[160:161], v28 offset:49152
  v_mul_f32 v186, v14, v15
  v_mfma_f32_16x16x32_bf16 v[72:75], a[136:139], a[192:195], v[72:75]
  s_waitcnt lgkmcnt(7)
  ds_read_b64_tr_b16 a[162:163], v28 offset:53248
  buffer_load_dwordx4 v[104:107], v3, s[4:7], s10 offen offset:2048 sc1
  v_mfma_f32_16x16x32_bf16 v[80:83], a[144:147], a[192:195], v[80:83]
  s_waitcnt lgkmcnt(6)
  ds_read_b64_tr_b16 a[164:165], v28 offset:57344
  v_mul_f32 v186, v186, v54
  v_mfma_f32_16x16x32_bf16 v[80:83], a[148:151], a[196:199], v[80:83]
  ds_read_b64_tr_b16 a[166:167], v28 offset:61440
  v_and_b32 v14, s96, v215
  v_mfma_f32_16x16x32_bf16 v[84:87], a[148:151], a[204:207], v[84:87]
  ds_read_b64_tr_b16 a[168:169], v29 offset:49152
  buffer_load_dwordx4 v[108:111], v3, s[4:7], s10 offen offset:3072 sc1
  v_mfma_f32_16x16x32_bf16 v[84:87], a[144:147], a[200:203], v[84:87]
  s_waitcnt lgkmcnt(7)
  ds_read_b64_tr_b16 a[170:171], v29 offset:53248
  v_and_b32 v15, s96, v253
  v_mfma_f32_16x16x32_bf16 v[92:95], a[152:155], a[200:203], v[92:95]
  s_waitcnt lgkmcnt(6)
  ds_read_b64_tr_b16 a[172:173], v29 offset:57344
  v_mul_f32 v187, v14, v15
  v_mfma_f32_16x16x32_bf16 v[92:95], a[156:159], a[204:207], v[92:95]
  ds_read_b64_tr_b16 a[174:175], v29 offset:61440
  v_mul_f32 v187, v187, v54
  v_mfma_f32_16x16x32_bf16 v[88:91], a[156:159], a[196:199], v[88:91]
  ds_read_b64_tr_b16 a[176:177], v30 offset:49152
  v_sub_f32 v55, 1.0, v51
  v_mfma_f32_16x16x32_bf16 v[88:91], a[152:155], a[192:195], v[88:91]
  s_waitcnt lgkmcnt(7)
  ds_read_b64_tr_b16 a[178:179], v30 offset:53248
  v_lshlrev_b32 v14, 16, v216
  v_mfma_f32_16x16x32_bf16 v[64:67], a[160:163], a[224:227], v[64:67]
  s_waitcnt lgkmcnt(6)
  ds_read_b64_tr_b16 a[180:181], v30 offset:57344
  v_lshlrev_b32 v15, 16, v242
  v_mfma_f32_16x16x32_bf16 v[64:67], a[164:167], a[228:231], v[64:67]
  ds_read_b64_tr_b16 a[182:183], v30 offset:61440
  v_mul_f32 v164, v14, v15
  v_mfma_f32_16x16x32_bf16 v[68:71], a[164:167], a[236:239], v[68:71]
  ds_read_b64_tr_b16 a[184:185], v31 offset:49152
  v_mul_f32 v164, v164, v55
  v_mfma_f32_16x16x32_bf16 v[68:71], a[160:163], a[232:235], v[68:71]
  s_waitcnt lgkmcnt(7)
  ds_read_b64_tr_b16 a[186:187], v31 offset:53248
  v_and_b32 v14, s96, v216
  v_mfma_f32_16x16x32_bf16 v[76:79], a[168:171], a[232:235], v[76:79]
  s_waitcnt lgkmcnt(6)
  s_xor_b32 s3, s35, 0x1100
  ds_read_b64_tr_b16 a[188:189], v31 offset:57344
  v_and_b32 v15, s96, v242
  v_mfma_f32_16x16x32_bf16 v[76:79], a[172:175], a[236:239], v[76:79]
  s_waitcnt vmcnt(5)
  ds_read_b64_tr_b16 a[190:191], v31 offset:61440
  buffer_store_dword v9, v49, s[20:23], s3 offen sc1
  v_mfma_f32_16x16x32_bf16 v[72:75], a[172:175], a[228:231], v[72:75]
L_pad19:
  s_cbranch_execz L_hr2
  ds_read_b64_tr_b16 a[128:129], v36 offset:0
  v_mul_f32 v165, v14, v15
  v_mfma_f32_16x16x32_bf16 v[72:75], a[168:171], a[224:227], v[72:75]
  s_waitcnt lgkmcnt(7)
  ds_read_b64_tr_b16 a[130:131], v36 offset:4096
  v_mul_f32 v165, v165, v55
  v_mfma_f32_16x16x32_bf16 v[80:83], a[176:179], a[224:227], v[80:83]
  s_waitcnt lgkmcnt(6)
  ds_read_b64_tr_b16 a[132:133], v36 offset:8192
  v_lshlrev_b32 v14, 16, v217
  v_mfma_f32_16x16x32_bf16 v[80:83], a[180:183], a[228:231], v[80:83]
  ds_read_b64_tr_b16 a[134:135], v36 offset:12288
  v_lshlrev_b32 v15, 16, v243
  v_mfma_f32_16x16x32_bf16 v[84:87], a[180:183], a[236:239], v[84:87]
  ds_read_b64_tr_b16 a[136:137], v37 offset:0
  v_mul_f32 v166, v14, v15
  v_mfma_f32_16x16x32_bf16 v[84:87], a[176:179], a[232:235], v[84:87]
  s_waitcnt lgkmcnt(7)
  ds_read_b64_tr_b16 a[138:139], v37 offset:4096
  v_mul_f32 v166, v166, v55
  v_mfma_f32_16x16x32_bf16 v[92:95], a[184:187], a[232:235], v[92:95]
  s_waitcnt lgkmcnt(6)
  ds_read_b64_tr_b16 a[140:141], v37 offset:8192
  v_and_b32 v14, s96, v217
  v_mfma_f32_16x16x32_bf16 v[92:95], a[188:191], a[236:239], v[92:95]
  ds_read_b64_tr_b16 a[142:143], v37 offset:12288
  v_and_b32 v15, s96, v243
  v_mfma_f32_16x16x32_bf16 v[88:91], a[188:191], a[228:231], v[88:91]
  ds_read_b64_tr_b16 a[144:145], v38 offset:0
  v_mul_f32 v167, v14, v15
  v_mfma_f32_16x16x32_bf16 v[88:91], a[184:187], a[224:227], v[88:91]
  s_waitcnt lgkmcnt(7)
  ds_read_b64_tr_b16 a[146:147], v38 offset:4096
  v_mul_f32 v167, v167, v55
  v_mfma_f32_16x16x32_bf16 v[64:67], a[128:131], a[0:3], v[64:67]
  s_waitcnt lgkmcnt(6)
  ds_read_b64_tr_b16 a[148:149], v38 offset:8192
  v_lshlrev_b32 v14, 16, v218
  v_mfma_f32_16x16x32_bf16 v[64:67], a[132:135], a[4:7], v[64:67]
  ds_read_b64_tr_b16 a[150:151], v38 offset:12288
  v_lshlrev_b32 v15, 16, v246
  v_mfma_f32_16x16x32_bf16 v[68:71], a[132:135], a[12:15], v[68:71]
  ds_read_b64_tr_b16 a[152:153], v39 offset:0
  v_mul_f32 v172, v14, v15
  v_mfma_f32_16x16x32_bf16 v[68:71], a[128:131], a[8:11], v[68:71]
  s_waitcnt lgkmcnt(7)
  ds_read_b64_tr_b16 a[154:155], v39 offset:4096
  v_mul_f32 v172, v172, v55
  v_mfma_f32_16x16x32_bf16 v[76:79], a[136:139], a[8:11], v[76:79]
  s_waitcnt vmcnt(5) lgkmcnt(6)
  s_add_u32 s10, s8, 4096
  ds_read_b64_tr_b16 a[156:157], v39 offset:8192
  v_cmp_eq_u32 vcc, 1, v10
  v_mfma_f32_16x16x32_bf16 v[76:79], a[140:143], a[12:15], v[76:79]
  ds_read_b64_tr_b16 a[158:159], v39 offset:12288
  v_and_b32 v14, s96, v218
  v_mfma_f32_16x16x32_bf16 v[72:75], a[140:143], a[4:7], v[72:75]
  s_and_b32 s11, vcc_lo, 1
  s_cselect_b32 s10, s10, 0x1000000
  ds_read_b64_tr_b16 a[160:161], v36 offset:16384
  v_mfma_f32_16x16x32_bf16 v[72:75], a[136:139], a[0:3], v[72:75]
  s_waitcnt lgkmcnt(7)
  s_andn2_b32 s9, s9, s11
  ds_read_b64_tr_b16 a[162:163], v36 offset:20480
  v_and_b32 v15, s96, v246
  v_mfma_f32_16x16x32_bf16 v[80:83], a[144:147], a[0:3], v[80:83]
  s_waitcnt lgkmcnt(6)
  ds_read_b64_tr_b16 a[164:165], v36 offset:24576
  v_mul_f32 v173, v14, v15
  v_mfma_f32_16x16x32_bf16 v[80:83], a[148:151], a[4:7], v[80:83]
  ds_read_b64_tr_b16 a[166:167], v36 offset:28672
  buffer_load_dwordx4 v[112:115], v3, s[4:7], s10 offen offset:0 sc1
  v_mfma_f32_16x16x32_bf16 v[84:87], a[148:151], a[12:15], v[84:87]
  ds_read_b64_tr_b16 a[168:169], v37 offset:16384
  v_mul_f32 v173, v173, v55
  v_mfma_f32_16x16x32_bf16 v[84:87], a[144:147], a[8:11], v[84:87]
  s_waitcnt lgkmcnt(7)
  ds_read_b64_tr_b16 a[170:171], v37 offset:20480
  v_lshlrev_b32 v14, 16, v219
  v_mfma_f32_16x16x32_bf16 v[92:95], a[152:155], a[8:11], v[92:95]
  s_waitcnt lgkmcnt(6)
  ds_read_b64_tr_b16 a[172:173], v37 offset:24576
  buffer_load_dwordx4 v[116:119], v3, s[4:7], s10 offen offset:1024 sc1
  v_mfma_f32_16x16x32_bf16 v[92:95], a[156:159], a[12:15], v[92:95]
  ds_read_b64_tr_b16 a[174:175], v37 offset:28672
  v_lshlrev_b32 v15, 16, v247
  v_mfma_f32_16x16x32_bf16 v[88:91], a[156:159], a[4:7], v[88:91]
  ds_read_b64_tr_b16 a[176:177], v38 offset:16384
  v_mul_f32 v174, v14, v15
  v_mfma_f32_16x16x32_bf16 v[88:91], a[152:155], a[0:3], v[88:91]
  s_waitcnt lgkmcnt(7)
  ds_read_b64_tr_b16 a[178:179], v38 offset:20480
  buffer_load_dwordx4 v[120:123], v3, s[4:7], s10 offen offset:2048 sc1
  v_mfma_f32_16x16x32_bf16 v[64:67], a[160:163], a[32:35], v[64:67]
  s_waitcnt lgkmcnt(6)
  ds_read_b64_tr_b16 a[180:181], v38 offset:24576
  v_mul_f32 v174, v174, v55
  v_mfma_f32_16x16x32_bf16 v[64:67], a[164:167], a[36:39], v[64:67]
  ds_read_b64_tr_b16 a[182:183], v38 offset:28672
  v_and_b32 v14, s96, v219
  v_mfma_f32_16x16x32_bf16 v[68:71], a[164:167], a[44:47], v[68:71]
  ds_read_b64_tr_b16 a[184:185], v39 offset:16384
  buffer_load_dwordx4 v[124:127], v3, s[4:7], s10 offen offset:3072 sc1
  v_mfma_f32_16x16x32_bf16 v[68:71], a[160:163], a[40:43], v[68:71]
  s_waitcnt lgkmcnt(7)
  ds_read_b64_tr_b16 a[186:187], v39 offset:20480
  v_and_b32 v15, s96, v247
  v_mfma_f32_16x16x32_bf16 v[76:79], a[168:171], a[40:43], v[76:79]
  s_waitcnt lgkmcnt(6)
  ds_read_b64_tr_b16 a[188:189], v39 offset:24576
  v_mul_f32 v175, v14, v15
  v_mfma_f32_16x16x32_bf16 v[76:79], a[172:175], a[44:47], v[76:79]
  ds_read_b64_tr_b16 a[190:191], v39 offset:28672
  buffer_load_dword v10, v45, s[20:23], s35 offen offset:128 sc1
  v_mfma_f32_16x16x32_bf16 v[72:75], a[172:175], a[36:39], v[72:75]
  ds_read_b64_tr_b16 a[128:129], v36 offset:32768
  v_mul_f32 v175, v175, v55
  v_mfma_f32_16x16x32_bf16 v[72:75], a[168:171], a[32:35], v[72:75]
  s_waitcnt lgkmcnt(7)
  ds_read_b64_tr_b16 a[130:131], v36 offset:36864
  v_lshlrev_b32 v14, 16, v220
  v_mfma_f32_16x16x32_bf16 v[80:83], a[176:179], a[32:35], v[80:83]
  s_waitcnt lgkmcnt(6)
  ds_read_b64_tr_b16 a[132:133], v36 offset:40960
  v_lshlrev_b32 v15, 16, v250
  v_mfma_f32_16x16x32_bf16 v[80:83], a[180:183], a[36:39], v[80:83]
  ds_read_b64_tr_b16 a[134:135], v36 offset:45056
  v_mul_f32 v180, v14, v15
  v_mfma_f32_16x16x32_bf16 v[84:87], a[180:183], a[44:47], v[84:87]
  ds_read_b64_tr_b16 a[136:137], v37 offset:32768
  v_mul_f32 v180, v180, v55
  v_mfma_f32_16x16x32_bf16 v[84:87], a[176:179], a[40:43], v[84:87]
  s_waitcnt lgkmcnt(7)
  ds_read_b64_tr_b16 a[138:139], v37 offset:36864
  v_and_b32 v14, s96, v220
  v_mfma_f32_16x16x32_bf16 v[92:95], a[184:187], a[40:43], v[92:95]
  s_waitcnt lgkmcnt(6)
  ds_read_b64_tr_b16 a[140:141], v37 offset:40960
  v_and_b32 v15, s96, v250
  v_mfma_f32_16x16x32_bf16 v[92:95], a[188:191], a[44:47], v[92:95]
  ds_read_b64_tr_b16 a[142:143], v37 offset:45056
  v_mul_f32 v181, v14, v15
  v_mfma_f32_16x16x32_bf16 v[88:91], a[188:191], a[36:39], v[88:91]
  ds_read_b64_tr_b16 a[144:145], v38 offset:32768
  v_mul_f32 v181, v181, v55
  v_mfma_f32_16x16x32_bf16 v[88:91], a[184:187], a[32:35], v[88:91]
  s_waitcnt lgkmcnt(7)
  ds_read_b64_tr_b16 a[146:147], v38 offset:36864
  v_lshlrev_b32 v14, 16, v221
  v_mfma_f32_16x16x32_bf16 v[64:67], a[128:131], a[64:67], v[64:67]
  s_waitcnt lgkmcnt(6)
  ds_read_b64_tr_b16 a[148:149], v38 offset:40960
  v_lshlrev_b32 v15, 16, v251
  v_mfma_f32_16x16x32_bf16 v[64:67], a[132:135], a[68:71], v[64:67]
  ds_read_b64_tr_b16 a[150:151], v38 offset:45056
  v_mul_f32 v182, v14, v15
  v_mfma_f32_16x16x32_bf16 v[68:71], a[132:135], a[76:79], v[68:71]
  ds_read_b64_tr_b16 a[152:153], v39 offset:32768
  v_mul_f32 v182, v182, v55
  v_mfma_f32_16x16x32_bf16 v[68:71], a[128:131], a[72:75], v[68:71]
  s_waitcnt lgkmcnt(7)
  ds_read_b64_tr_b16 a[154:155], v39 offset:36864
  v_and_b32 v14, s96, v221
  v_mfma_f32_16x16x32_bf16 v[76:79], a[136:139], a[72:75], v[76:79]
  s_waitcnt lgkmcnt(6)
  ds_read_b64_tr_b16 a[156:157], v39 offset:40960
  v_and_b32 v15, s96, v251
  v_mfma_f32_16x16x32_bf16 v[76:79], a[140:143], a[76:79], v[76:79]
  ds_read_b64_tr_b16 a[158:159], v39 offset:45056
  v_mul_f32 v183, v14, v15
  v_mfma_f32_16x16x32_bf16 v[72:75], a[140:143], a[68:71], v[72:75]
  ds_read_b64_tr_b16 a[160:161], v36 offset:49152
  v_mul_f32 v183, v183, v55
  v_mfma_f32_16x16x32_bf16 v[72:75], a[136:139], a[64:67], v[72:75]
  s_waitcnt lgkmcnt(7)
  ds_read_b64_tr_b16 a[162:163], v36 offset:53248
  v_lshlrev_b32 v14, 16, v222
  v_mfma_f32_16x16x32_bf16 v[80:83], a[144:147], a[64:67], v[80:83]
  s_waitcnt lgkmcnt(6)
  ds_read_b64_tr_b16 a[164:165], v36 offset:57344
  v_lshlrev_b32 v15, 16, v254
  v_mfma_f32_16x16x32_bf16 v[80:83], a[148:151], a[68:71], v[80:83]
  ds_read_b64_tr_b16 a[166:167], v36 offset:61440
  v_mul_f32 v188, v14, v15
  v_mfma_f32_16x16x32_bf16 v[84:87], a[148:151], a[76:79], v[84:87]
  ds_read_b64_tr_b16 a[168:169], v37 offset:49152
  v_mul_f32 v188, v188, v55
  v_mfma_f32_16x16x32_bf16 v[84:87], a[144:147], a[72:75], v[84:87]
  s_waitcnt lgkmcnt(7)
  ds_read_b64_tr_b16 a[170:171], v37 offset:53248
  v_and_b32 v14, s96, v222
  v_mfma_f32_16x16x32_bf16 v[92:95], a[152:155], a[72:75], v[92:95]
  s_waitcnt lgkmcnt(6)
  ds_read_b64_tr_b16 a[172:173], v37 offset:57344
  v_and_b32 v15, s96, v254
  v_mfma_f32_16x16x32_bf16 v[92:95], a[156:159], a[76:79], v[92:95]
  ds_read_b64_tr_b16 a[174:175], v37 offset:61440
  v_mul_f32 v189, v14, v15
  v_mfma_f32_16x16x32_bf16 v[88:91], a[156:159], a[68:71], v[88:91]
  ds_read_b64_tr_b16 a[176:177], v38 offset:49152
  v_mul_f32 v189, v189, v55
  v_mfma_f32_16x16x32_bf16 v[88:91], a[152:155], a[64:67], v[88:91]
  s_waitcnt lgkmcnt(7)
  ds_read_b64_tr_b16 a[178:179], v38 offset:53248
  v_lshlrev_b32 v14, 16, v223
  v_mfma_f32_16x16x32_bf16 v[64:67], a[160:163], a[96:99], v[64:67]
  s_waitcnt lgkmcnt(6)
  ds_read_b64_tr_b16 a[180:181], v38 offset:57344
  v_lshlrev_b32 v15, 16, v255
  v_mfma_f32_16x16x32_bf16 v[64:67], a[164:167], a[100:103], v[64:67]
  ds_read_b64_tr_b16 a[182:183], v38 offset:61440
  v_mul_f32 v190, v14, v15
  v_mfma_f32_16x16x32_bf16 v[68:71], a[164:167], a[108:111], v[68:71]
  ds_read_b64_tr_b16 a[184:185], v39 offset:49152
  v_mul_f32 v190, v190, v55
  v_mfma_f32_16x16x32_bf16 v[68:71], a[160:163], a[104:107], v[68:71]
  s_waitcnt lgkmcnt(7)
  ds_read_b64_tr_b16 a[186:187], v39 offset:53248
  v_and_b32 v14, s96, v223
  v_mfma_f32_16x16x32_bf16 v[76:79], a[168:171], a[104:107], v[76:79]
  s_waitcnt lgkmcnt(6)
  ds_read_b64_tr_b16 a[188:189], v39 offset:57344
  v_and_b32 v15, s96, v255
  v_mfma_f32_16x16x32_bf16 v[76:79], a[172:175], a[108:111], v[76:79]
  ds_read_b64_tr_b16 a[190:191], v39 offset:61440
  v_mul_f32 v191, v14, v15
  v_mfma_f32_16x16x32_bf16 v[72:75], a[172:175], a[100:103], v[72:75]
  v_mul_f32 v191, v191, v55
  v_mfma_f32_16x16x32_bf16 v[72:75], a[168:171], a[96:99], v[72:75]
  s_waitcnt lgkmcnt(6)
  v_mfma_f32_16x16x32_bf16 v[80:83], a[176:179], a[96:99], v[80:83]
  s_waitcnt lgkmcnt(4)
  v_mfma_f32_16x16x32_bf16 v[80:83], a[180:183], a[100:103], v[80:83]
  v_mfma_f32_16x16x32_bf16 v[84:87], a[180:183], a[108:111], v[84:87]
  s_waitcnt vmcnt(0)
  s_add_u32 s10, s8, 8192
  v_cmp_eq_u32 vcc, 1, v10
  v_mfma_f32_16x16x32_bf16 v[84:87], a[176:179], a[104:107], v[84:87]
  s_waitcnt lgkmcnt(2)
  v_mfma_f32_16x16x32_bf16 v[92:95], a[184:187], a[104:107], v[92:95]
  s_waitcnt lgkmcnt(0)
  s_and_b32 s11, vcc_lo, 2
  s_cselect_b32 s10, s10, 0x1000000
  v_mfma_f32_16x16x32_bf16 v[92:95], a[188:191], a[108:111], v[92:95]
  s_andn2_b32 s9, s9, s11
  v_mfma_f32_16x16x32_bf16 v[88:91], a[188:191], a[100:103], v[88:91]
  v_mfma_f32_16x16x32_bf16 v[88:91], a[184:187], a[96:99], v[88:91]
  buffer_load_dwordx4 v[128:131], v3, s[4:7], s10 offen offset:0 sc1
  buffer_load_dwordx4 v[132:135], v3, s[4:7], s10 offen offset:1024 sc1
  buffer_load_dwordx4 v[136:139], v3, s[4:7], s10 offen offset:2048 sc1
  buffer_load_dwordx4 v[140:143], v3, s[4:7], s10 offen offset:3072 sc1
  s_mov_b32 s0, 0
  s_mov_b32 s1, s9
  s_cmp_eq_u32 s9, 0
  s_cbranch_scc1 L_ex_done
  buffer_load_dword v10, v45, s[20:23], s35 offen offset:128 sc1
  s_waitcnt vmcnt(0)
L_ex_loop:
  v_cmp_eq_u32 vcc, 1, v10
  s_nop 2
  s_and_b32 s3, vcc_lo, s1
  s_cmp_ge_u32 s0, 0x200000
  s_cselect_b32 s3, s1, s3
  s_andn2_b32 s1, s1, s3
  s_bitcmp0_b32 s3, 2
  s_cbranch_scc1 L_ex_skip3
  s_add_u32 s36, s8, 12288
  buffer_load_dwordx4 v[96:99], v3, s[4:7], s36 offen offset:0 sc1
  buffer_load_dwordx4 v[100:103], v3, s[4:7], s36 offen offset:1024 sc1
  buffer_load_dwordx4 v[104:107], v3, s[4:7], s36 offen offset:2048 sc1
  buffer_load_dwordx4 v[108:111], v3, s[4:7], s36 offen offset:3072 sc1
L_ex_skip3:
  s_bitcmp0_b32 s3, 0
  s_cbranch_scc1 L_ex_skip1
  s_add_u32 s36, s8, 4096
  buffer_load_dwordx4 v[112:115], v3, s[4:7], s36 offen offset:0 sc1
  buffer_load_dwordx4 v[116:119], v3, s[4:7], s36 offen offset:1024 sc1
  buffer_load_dwordx4 v[120:123], v3, s[4:7], s36 offen offset:2048 sc1
  buffer_load_dwordx4 v[124:127], v3, s[4:7], s36 offen offset:3072 sc1
L_ex_skip1:
  s_bitcmp0_b32 s3, 1
  s_cbranch_scc1 L_ex_skip2
  s_add_u32 s36, s8, 8192
  buffer_load_dwordx4 v[128:131], v3, s[4:7], s36 offen offset:0 sc1
  buffer_load_dwordx4 v[132:135], v3, s[4:7], s36 offen offset:1024 sc1
  buffer_load_dwordx4 v[136:139], v3, s[4:7], s36 offen offset:2048 sc1
  buffer_load_dwordx4 v[140:143], v3, s[4:7], s36 offen offset:3072 sc1
L_ex_skip2:
  s_cmp_eq_u32 s1, 0
  s_cbranch_scc1 L_ex_done
  buffer_load_dword v10, v45, s[20:23], s35 offen offset:128 sc1
  s_add_u32 s0, s0, 1
  s_waitcnt vmcnt(0)
  s_branch L_ex_loop
L_ex_done:
  s_waitcnt vmcnt(0)
  v_mfma_f32_16x16x32_bf16 v[64:67], v[18:21], v[96:99], v[64:67]
  s_mov_b32 s36, 0x0
  v_mfma_f32_16x16x32_bf16 v[64:67], v[18:21], v[112:115], v[64:67]
  v_mfma_f32_16x16x32_bf16 v[64:67], v[18:21], v[128:131], v[64:67]
  v_mfma_f32_16x16x32_bf16 v[72:75], v[18:21], v[100:103], v[72:75]
  v_mfma_f32_16x16x32_bf16 v[72:75], v[18:21], v[116:119], v[72:75]
  v_mfma_f32_16x16x32_bf16 v[72:75], v[18:21], v[132:135], v[72:75]
  s_nop 4
  v_fma_f32 v64, v64, v50, v160
  v_fma_f32 v65, v65, v50, v161
  v_mfma_f32_16x16x32_bf16 v[80:83], v[18:21], v[104:107], v[80:83]
  v_fma_f32 v66, v66, v50, v162
  v_fma_f32 v67, v67, v50, v163
  v_mfma_f32_16x16x32_bf16 v[80:83], v[18:21], v[120:123], v[80:83]
  v_cvt_pk_bf16_f32 v144, v64, v65
  v_cvt_pk_bf16_f32 v145, v66, v67
  v_mfma_f32_16x16x32_bf16 v[80:83], v[18:21], v[136:139], v[80:83]
  ds_write_b64 v56, v[144:145] offset:0
  v_fma_f32 v72, v72, v50, v168
  v_mfma_f32_16x16x32_bf16 v[88:91], v[18:21], v[108:111], v[88:91]
  v_fma_f32 v73, v73, v50, v169
  v_fma_f32 v74, v74, v50, v170
  v_mfma_f32_16x16x32_bf16 v[88:91], v[18:21], v[124:127], v[88:91]
  v_fma_f32 v75, v75, v50, v171
  v_cvt_pk_bf16_f32 v148, v72, v73
  v_mfma_f32_16x16x32_bf16 v[88:91], v[18:21], v[140:143], v[88:91]
  v_cvt_pk_bf16_f32 v149, v74, v75
  ds_write_b64 v57, v[148:149] offset:0
  v_mfma_f32_16x16x32_bf16 v[68:71], v[16:19], v[96:99], v[68:71]
  v_fma_f32 v80, v80, v50, v176
  v_fma_f32 v81, v81, v50, v177
  v_mfma_f32_16x16x32_bf16 v[68:71], v[16:19], v[112:115], v[68:71]
  v_fma_f32 v82, v82, v50, v178
  v_fma_f32 v83, v83, v50, v179
  v_mfma_f32_16x16x32_bf16 v[68:71], v[16:19], v[128:131], v[68:71]
  v_cvt_pk_bf16_f32 v152, v80, v81
  v_cvt_pk_bf16_f32 v153, v82, v83
  v_mfma_f32_16x16x32_bf16 v[76:79], v[16:19], v[100:103], v[76:79]
  ds_write_b64 v58, v[152:153] offset:0
  v_fma_f32 v88, v88, v50, v184
  v_mfma_f32_16x16x32_bf16 v[76:79], v[16:19], v[116:119], v[76:79]
  v_fma_f32 v89, v89, v50, v185
  v_fma_f32 v90, v90, v50, v186
  v_mfma_f32_16x16x32_bf16 v[76:79], v[16:19], v[132:135], v[76:79]
  v_fma_f32 v91, v91, v50, v187
  v_cvt_pk_bf16_f32 v156, v88, v89
  v_mfma_f32_16x16x32_bf16 v[84:87], v[16:19], v[104:107], v[84:87]
  v_cvt_pk_bf16_f32 v157, v90, v91
  ds_write_b64 v59, v[156:157] offset:0
  v_mfma_f32_16x16x32_bf16 v[84:87], v[16:19], v[120:123], v[84:87]
  ds_read_b128 v[192:195], v63 offset:0
  ds_read_b128 v[196:199], v63 offset:1024
  v_mfma_f32_16x16x32_bf16 v[84:87], v[16:19], v[136:139], v[84:87]
  v_fma_f32 v68, v68, v51, v164
  v_fma_f32 v69, v69, v51, v165
  v_mfma_f32_16x16x32_bf16 v[92:95], v[16:19], v[108:111], v[92:95]
  v_fma_f32 v70, v70, v51, v166
  v_fma_f32 v71, v71, v51, v167
  v_mfma_f32_16x16x32_bf16 v[92:95], v[16:19], v[124:127], v[92:95]
  v_cvt_pk_bf16_f32 v146, v68, v69
  v_cvt_pk_bf16_f32 v147, v70, v71
  v_mfma_f32_16x16x32_bf16 v[92:95], v[16:19], v[140:143], v[92:95]
  ds_write_b64 v56, v[146:147] offset:2048
  v_fma_f32 v76, v76, v51, v172
  v_fma_f32 v77, v77, v51, v173
  v_fma_f32 v78, v78, v51, v174
  v_fma_f32 v79, v79, v51, v175
  v_cvt_pk_bf16_f32 v150, v76, v77
  v_cvt_pk_bf16_f32 v151, v78, v79
  ds_write_b64 v57, v[150:151] offset:2048
  v_fma_f32 v84, v84, v51, v180
  v_fma_f32 v85, v85, v51, v181
  v_fma_f32 v86, v86, v51, v182
  v_fma_f32 v87, v87, v51, v183
  v_cvt_pk_bf16_f32 v154, v84, v85
  v_cvt_pk_bf16_f32 v155, v86, v87
  ds_write_b64 v58, v[154:155] offset:2048
  v_fma_f32 v92, v92, v51, v188
  v_fma_f32 v93, v93, v51, v189
  v_fma_f32 v94, v94, v51, v190
  v_fma_f32 v95, v95, v51, v191
  v_cvt_pk_bf16_f32 v158, v92, v93
  v_cvt_pk_bf16_f32 v159, v94, v95
  ds_write_b64 v59, v[158:159] offset:2048
  ds_read_b128 v[200:203], v63 offset:2048
  ds_read_b128 v[204:207], v63 offset:3072
  s_waitcnt lgkmcnt(7)
  buffer_store_dwordx4 v[192:195], v62, s[60:63], s36 offen sc1
  s_mov_b32 s36, 0x4000
  s_waitcnt lgkmcnt(6)
  buffer_store_dwordx4 v[196:199], v62, s[60:63], s36 offen sc1
  s_mov_b32 s36, 0x8000
  s_waitcnt lgkmcnt(1)
  buffer_store_dwordx4 v[200:203], v62, s[60:63], s36 offen sc1
  s_mov_b32 s36, 0xc000
  s_waitcnt lgkmcnt(0)
  buffer_store_dwordx4 v[204:207], v62, s[60:63], s36 offen sc1
L_end:
  s_endpgm
L_clr_wait:
  s_mov_b32 s0, 0
L_clr_loop:
  v_cmp_eq_u32 vcc, 0, v10
  s_nop 2
  s_cbranch_vccz L_clr_ok
  buffer_load_dword v10, off, s[4:7], s100 offset:0 sc1
  s_add_u32 s0, s0, 1
  s_cmp_lt_u32 s0, 0x200000
  s_waitcnt vmcnt(0)
  s_cbranch_scc1 L_clr_loop
  s_branch L_clr_ok
L_kv_wait:
  s_mov_b32 s0, 0
L_kv_loop:
  v_cmp_ne_u32 vcc, 1, v10
  s_nop 2
  s_cbranch_vccz L_kv_ok
  buffer_load_dword v10, v7, s[20:23], 0 offen offset:0 sc1
  s_add_u32 s0, s0, 1
  s_cmp_lt_u32 s0, 0x200000
  s_waitcnt vmcnt(0)
  s_cbranch_scc1 L_kv_loop
  s_branch L_kv_ok
L_prep_wait:
  s_mov_b32 s0, 0
L_prep_loop:
  v_cmp_eq_u32 vcc, 0, v10
  s_nop 2
  s_cbranch_vccz L_prep_ok
  buffer_load_dword v10, v6, s[4:7], 0 offen offset:128 sc1
  s_add_u32 s0, s0, 1
  s_cmp_lt_u32 s0, 0x200000
  s_waitcnt vmcnt(0)
  s_cbranch_scc1 L_prep_loop
  s_branch L_prep_ok
L_conv_wait:
  s_mov_b32 s0, 0
L_conv_loop:
  v_cmp_ne_u32 vcc, 1, v10
  s_nop 2
  s_cbranch_vccz L_conv_ok
  buffer_load_dword v10, v7, s[20:23], 0 offen offset:0 sc1
  s_add_u32 s0, s0, 1
  s_cmp_lt_u32 s0, 0x200000
  s_waitcnt vmcnt(0)
  s_cbranch_scc1 L_conv_loop
  s_branch L_conv_ok
L_codeend:
L_slow:
  s_waitcnt vmcnt(0) lgkmcnt(0)
  s_mov_b32 s72, 0
L_slow_qt:
  s_lshl_b32 s3, s30, 1
  s_xor_b32 s31, s3, 30
  s_cmp_lt_u32 s72, 2
  s_cselect_b32 s73, s3, s31
  s_and_b32 s3, s72, 1
  s_add_u32 s73, s73, s3
  s_mov_b32 s69, 0
  v_mov_b32 v14, v13
  v_mov_b32 v15, 0
  v_accvgpr_write_b32 a0, 0
  v_accvgpr_write_b32 a1, 0
  v_accvgpr_write_b32 a2, 0
  v_accvgpr_write_b32 a3, 0
  v_accvgpr_write_b32 a4, 0
  v_accvgpr_write_b32 a5, 0
  v_accvgpr_write_b32 a6, 0
  v_accvgpr_write_b32 a7, 0
  v_accvgpr_write_b32 a8, 0
  v_accvgpr_write_b32 a9, 0
  v_accvgpr_write_b32 a10, 0
  v_accvgpr_write_b32 a11, 0
  v_accvgpr_write_b32 a12, 0
  v_accvgpr_write_b32 a13, 0
  v_accvgpr_write_b32 a14, 0
  v_accvgpr_write_b32 a15, 0
  v_accvgpr_write_b32 a16, 0
  v_accvgpr_write_b32 a17, 0
  v_accvgpr_write_b32 a18, 0
  v_accvgpr_write_b32 a19, 0
  v_accvgpr_write_b32 a20, 0
  v_accvgpr_write_b32 a21, 0
  v_accvgpr_write_b32 a22, 0
  v_accvgpr_write_b32 a23, 0
  v_accvgpr_write_b32 a24, 0
  v_accvgpr_write_b32 a25, 0
  v_accvgpr_write_b32 a26, 0
  v_accvgpr_write_b32 a27, 0
  v_accvgpr_write_b32 a28, 0
  v_accvgpr_write_b32 a29, 0
  v_accvgpr_write_b32 a30, 0
  v_accvgpr_write_b32 a31, 0
  v_accvgpr_write_b32 a128, 0
  v_accvgpr_write_b32 a129, 0
  v_accvgpr_write_b32 a130, 0
  v_accvgpr_write_b32 a131, 0
L_slow_pass:
  v_mov_b32 v24, v15
  v_mov_b32 v25, v15
  v_mov_b32 v26, v15
  v_mov_b32 v27, v15
  v_mov_b32 v28, v15
  v_mov_b32 v29, v15
  v_mov_b32 v30, v15
  v_mov_b32 v31, v15
  v_mov_b32 v32, v15
  v_mov_b32 v33, v15
  v_mov_b32 v34, v15
  v_mov_b32 v35, v15
  v_mov_b32 v36, v15
  v_mov_b32 v37, v15
  v_mov_b32 v38, v15
  v_mov_b32 v39, v15
  s_mov_b32 s68, 0
L_slow_tile:
  s_lshl_b32 s3, s68, 15
  buffer_load_dwordx4 a[160:163], v3, s[24:27], s3 offen offset:0 sc1
  buffer_load_dwordx4 a[164:167], v3, s[24:27], s3 offen offset:1024 sc1
  buffer_load_dwordx4 a[168:171], v3, s[24:27], s3 offen offset:2048 sc1
  buffer_load_dwordx4 a[172:175], v3, s[24:27], s3 offen offset:3072 sc1
  s_add_u32 s3, s3, 4096
  buffer_load_dwordx4 a[176:179], v3, s[24:27], s3 offen offset:0 sc1
  buffer_load_dwordx4 a[180:183], v3, s[24:27], s3 offen offset:1024 sc1
  buffer_load_dwordx4 a[184:187], v3, s[24:27], s3 offen offset:2048 sc1
  buffer_load_dwordx4 a[188:191], v3, s[24:27], s3 offen offset:3072 sc1
  s_add_u32 s3, s3, 4096
  buffer_load_dwordx4 a[192:195], v3, s[24:27], s3 offen offset:0 sc1
  buffer_load_dwordx4 a[196:199], v3, s[24:27], s3 offen offset:1024 sc1
  buffer_load_dwordx4 a[200:203], v3, s[24:27], s3 offen offset:2048 sc1
  buffer_load_dwordx4 a[204:207], v3, s[24:27], s3 offen offset:3072 sc1
  s_add_u32 s3, s3, 4096
  buffer_load_dwordx4 a[208:211], v3, s[24:27], s3 offen offset:0 sc1
  buffer_load_dwordx4 a[212:215], v3, s[24:27], s3 offen offset:1024 sc1
  buffer_load_dwordx4 a[216:219], v3, s[24:27], s3 offen offset:2048 sc1
  buffer_load_dwordx4 a[220:223], v3, s[24:27], s3 offen offset:3072 sc1
  s_add_u32 s3, s3, 4096
  buffer_load_dwordx4 a[32:35], v3, s[24:27], s3 offen offset:0 sc1
  buffer_load_dwordx4 a[36:39], v3, s[24:27], s3 offen offset:1024 sc1
  buffer_load_dwordx4 a[40:43], v3, s[24:27], s3 offen offset:2048 sc1
  buffer_load_dwordx4 a[44:47], v3, s[24:27], s3 offen offset:3072 sc1
  s_add_u32 s3, s3, 4096
  buffer_load_dwordx4 a[48:51], v3, s[24:27], s3 offen offset:0 sc1
  buffer_load_dwordx4 a[52:55], v3, s[24:27], s3 offen offset:1024 sc1
  buffer_load_dwordx4 a[56:59], v3, s[24:27], s3 offen offset:2048 sc1
  buffer_load_dwordx4 a[60:63], v3, s[24:27], s3 offen offset:3072 sc1
  s_add_u32 s3, s3, 4096
  buffer_load_dwordx4 a[64:67], v3, s[24:27], s3 offen offset:0 sc1
  buffer_load_dwordx4 a[68:71], v3, s[24:27], s3 offen offset:1024 sc1
  buffer_load_dwordx4 a[72:75], v3, s[24:27], s3 offen offset:2048 sc1
  buffer_load_dwordx4 a[76:79], v3, s[24:27], s3 offen offset:3072 sc1
  s_add_u32 s3, s3, 4096
  buffer_load_dwordx4 a[80:83], v3, s[24:27], s3 offen offset:0 sc1
  buffer_load_dwordx4 a[84:87], v3, s[24:27], s3 offen offset:1024 sc1
  buffer_load_dwordx4 a[88:91], v3, s[24:27], s3 offen offset:2048 sc1
  buffer_load_dwordx4 a[92:95], v3, s[24:27], s3 offen offset:3072 sc1
  s_add_u32 s3, s3, 4096
  s_cmp_lg_u32 s68, s73
  s_cbranch_scc1 L_slow_nomask
  v_cndmask_b32 v24, v13, v24, s[32:33]
  v_cndmask_b32 v25, v13, v25, s[34:35]
  v_cndmask_b32 v26, v13, v26, s[36:37]
  v_cndmask_b32 v27, v13, v27, s[38:39]
  v_cndmask_b32 v28, v13, v28, s[40:41]
  v_cndmask_b32 v29, v13, v29, s[42:43]
  v_cndmask_b32 v30, v13, v30, s[44:45]
  v_cndmask_b32 v31, v13, v31, s[46:47]
  v_cndmask_b32 v32, v13, v32, s[48:49]
  v_cndmask_b32 v33, v13, v33, s[50:51]
  v_cndmask_b32 v34, v13, v34, s[52:53]
  v_cndmask_b32 v35, v13, v35, s[54:55]
  v_cndmask_b32 v36, v13, v36, s[56:57]
  v_cndmask_b32 v37, v13, v37, s[58:59]
  v_cndmask_b32 v38, v13, v38, s[60:61]
  v_cndmask_b32 v39, v13, v39, s[62:63]
L_slow_nomask:
  s_waitcnt vmcnt(0)
  v_mfma_f32_16x16x32_bf16 v[96:99], a[160:163], v[128:131], v[24:27]
  v_mfma_f32_16x16x32_bf16 v[96:99], a[164:167], v[132:135], v[96:99]
  v_mfma_f32_16x16x32_bf16 v[96:99], a[168:171], v[136:139], v[96:99]
  v_mfma_f32_16x16x32_bf16 v[96:99], a[172:175], v[140:143], v[96:99]
  v_mfma_f32_16x16x32_bf16 v[100:103], a[176:179], v[128:131], v[28:31]
  v_mfma_f32_16x16x32_bf16 v[100:103], a[180:183], v[132:135], v[100:103]
  v_mfma_f32_16x16x32_bf16 v[100:103], a[184:187], v[136:139], v[100:103]
  v_mfma_f32_16x16x32_bf16 v[100:103], a[188:191], v[140:143], v[100:103]
  v_mfma_f32_16x16x32_bf16 v[104:107], a[192:195], v[128:131], v[32:35]
  v_mfma_f32_16x16x32_bf16 v[104:107], a[196:199], v[132:135], v[104:107]
  v_mfma_f32_16x16x32_bf16 v[104:107], a[200:203], v[136:139], v[104:107]
  v_mfma_f32_16x16x32_bf16 v[104:107], a[204:207], v[140:143], v[104:107]
  v_mfma_f32_16x16x32_bf16 v[108:111], a[208:211], v[128:131], v[36:39]
  v_mfma_f32_16x16x32_bf16 v[108:111], a[212:215], v[132:135], v[108:111]
  v_mfma_f32_16x16x32_bf16 v[108:111], a[216:219], v[136:139], v[108:111]
  v_mfma_f32_16x16x32_bf16 v[108:111], a[220:223], v[140:143], v[108:111]
  s_cmp_lg_u32 s69, 0
  s_cbranch_scc1 L_slow_p2
  v_max3_f32 v14, v14, v96, v97
  v_max3_f32 v14, v14, v98, v99
  v_max3_f32 v14, v14, v100, v101
  v_max3_f32 v14, v14, v102, v103
  v_max3_f32 v14, v14, v104, v105
  v_max3_f32 v14, v14, v106, v107
  v_max3_f32 v14, v14, v108, v109
  v_max3_f32 v14, v14, v110, v111
  s_branch L_slow_next
L_slow_p2:
  v_exp_f32 v96, v96
  v_exp_f32 v97, v97
  v_exp_f32 v98, v98
  v_exp_f32 v99, v99
  v_exp_f32 v100, v100
  v_exp_f32 v101, v101
  v_exp_f32 v102, v102
  v_exp_f32 v103, v103
  v_exp_f32 v104, v104
  v_exp_f32 v105, v105
  v_exp_f32 v106, v106
  v_exp_f32 v107, v107
  v_exp_f32 v108, v108
  v_exp_f32 v109, v109
  v_exp_f32 v110, v110
  v_exp_f32 v111, v111
  v_cvt_pk_bf16_f32 v112, v96, v97
  v_cvt_pk_bf16_f32 v113, v98, v99
  v_cvt_pk_bf16_f32 v114, v100, v101
  v_cvt_pk_bf16_f32 v115, v102, v103
  v_cvt_pk_bf16_f32 v116, v104, v105
  v_cvt_pk_bf16_f32 v117, v106, v107
  v_cvt_pk_bf16_f32 v118, v108, v109
  v_cvt_pk_bf16_f32 v119, v110, v111
  v_mfma_f32_16x16x32_bf16 a[128:131], a[144:147], v[112:115], a[128:131]
  s_nop 0
  v_mfma_f32_16x16x32_bf16 a[128:131], a[144:147], v[116:119], a[128:131]
  v_mfma_f32_16x16x32_bf16 a[0:3], a[32:35], v[112:115], a[0:3]
  v_mfma_f32_16x16x32_bf16 a[0:3], a[36:39], v[116:119], a[0:3]
  v_mfma_f32_16x16x32_bf16 a[4:7], a[40:43], v[112:115], a[4:7]
  v_mfma_f32_16x16x32_bf16 a[4:7], a[44:47], v[116:119], a[4:7]
  v_mfma_f32_16x16x32_bf16 a[8:11], a[48:51], v[112:115], a[8:11]
  v_mfma_f32_16x16x32_bf16 a[8:11], a[52:55], v[116:119], a[8:11]
  v_mfma_f32_16x16x32_bf16 a[12:15], a[56:59], v[112:115], a[12:15]
  v_mfma_f32_16x16x32_bf16 a[12:15], a[60:63], v[116:119], a[12:15]
  v_mfma_f32_16x16x32_bf16 a[16:19], a[64:67], v[112:115], a[16:19]
  v_mfma_f32_16x16x32_bf16 a[16:19], a[68:71], v[116:119], a[16:19]
  v_mfma_f32_16x16x32_bf16 a[20:23], a[72:75], v[112:115], a[20:23]
  v_mfma_f32_16x16x32_bf16 a[20:23], a[76:79], v[116:119], a[20:23]
  v_mfma_f32_16x16x32_bf16 a[24:27], a[80:83], v[112:115], a[24:27]
  v_mfma_f32_16x16x32_bf16 a[24:27], a[84:87], v[116:119], a[24:27]
  v_mfma_f32_16x16x32_bf16 a[28:31], a[88:91], v[112:115], a[28:31]
  v_mfma_f32_16x16x32_bf16 a[28:31], a[92:95], v[116:119], a[28:31]
L_slow_next:
  s_add_u32 s68, s68, 1
  s_cmp_le_u32 s68, s73
  s_cbranch_scc1 L_slow_tile
  s_cmp_lg_u32 s69, 0
  s_cbranch_scc1 L_slow_store
  v_mov_b32 v16, v14
  s_nop 1
  v_permlane32_swap_b32 v16, v14
  v_max_f32 v14, v14, v16
  v_mov_b32 v16, v14
  s_nop 1
  v_permlane16_swap_b32 v16, v14
  v_max_f32 v14, v14, v16
  v_sub_f32 v15, 0, v14
  s_mov_b32 s69, 1
  s_branch L_slow_pass
L_slow_store:
  s_lshl_b32 s3, s30, 20
  s_xor_b32 s31, s3, 0xf00000
  s_cmp_lt_u32 s72, 2
  s_cselect_b32 s66, s3, s31
  s_and_b32 s3, s72, 1
  s_lshl_b32 s3, s3, 12
  s_add_u32 s66, s66, s3
  v_accvgpr_read_b32 v16, a128
  v_rcp_f32 v16, v16
  v_accvgpr_read_b32 v192, a0
  v_accvgpr_read_b32 v193, a1
  v_accvgpr_read_b32 v194, a2
  v_accvgpr_read_b32 v195, a3
  v_accvgpr_read_b32 v196, a4
  v_accvgpr_read_b32 v197, a5
  v_accvgpr_read_b32 v198, a6
  v_accvgpr_read_b32 v199, a7
  v_mul_f32 v192, v192, v16
  v_mul_f32 v193, v193, v16
  v_mul_f32 v194, v194, v16
  v_mul_f32 v195, v195, v16
  v_mul_f32 v196, v196, v16
  v_mul_f32 v197, v197, v16
  v_mul_f32 v198, v198, v16
  v_mul_f32 v199, v199, v16
  v_cvt_pk_bf16_f32 v200, v192, v193
  v_cvt_pk_bf16_f32 v201, v194, v195
  v_cvt_pk_bf16_f32 v202, v196, v197
  v_cvt_pk_bf16_f32 v203, v198, v199
  buffer_store_dwordx4 v[200:203], v3, s[4:7], s66 offen sc1
  s_add_u32 s66, s66, 8192
  v_accvgpr_read_b32 v192, a8
  v_accvgpr_read_b32 v193, a9
  v_accvgpr_read_b32 v194, a10
  v_accvgpr_read_b32 v195, a11
  v_accvgpr_read_b32 v196, a12
  v_accvgpr_read_b32 v197, a13
  v_accvgpr_read_b32 v198, a14
  v_accvgpr_read_b32 v199, a15
  v_mul_f32 v192, v192, v16
  v_mul_f32 v193, v193, v16
  v_mul_f32 v194, v194, v16
  v_mul_f32 v195, v195, v16
  v_mul_f32 v196, v196, v16
  v_mul_f32 v197, v197, v16
  v_mul_f32 v198, v198, v16
  v_mul_f32 v199, v199, v16
  v_cvt_pk_bf16_f32 v200, v192, v193
  v_cvt_pk_bf16_f32 v201, v194, v195
  v_cvt_pk_bf16_f32 v202, v196, v197
  v_cvt_pk_bf16_f32 v203, v198, v199
  buffer_store_dwordx4 v[200:203], v3, s[4:7], s66 offen sc1
  s_add_u32 s66, s66, 8192
  v_accvgpr_read_b32 v192, a16
  v_accvgpr_read_b32 v193, a17
  v_accvgpr_read_b32 v194, a18
  v_accvgpr_read_b32 v195, a19
  v_accvgpr_read_b32 v196, a20
  v_accvgpr_read_b32 v197, a21
  v_accvgpr_read_b32 v198, a22
  v_accvgpr_read_b32 v199, a23
  v_mul_f32 v192, v192, v16
  v_mul_f32 v193, v193, v16
  v_mul_f32 v194, v194, v16
  v_mul_f32 v195, v195, v16
  v_mul_f32 v196, v196, v16
  v_mul_f32 v197, v197, v16
  v_mul_f32 v198, v198, v16
  v_mul_f32 v199, v199, v16
  v_cvt_pk_bf16_f32 v200, v192, v193
  v_cvt_pk_bf16_f32 v201, v194, v195
  v_cvt_pk_bf16_f32 v202, v196, v197
  v_cvt_pk_bf16_f32 v203, v198, v199
  buffer_store_dwordx4 v[200:203], v3, s[4:7], s66 offen sc1
  s_add_u32 s66, s66, 8192
  v_accvgpr_read_b32 v192, a24
  v_accvgpr_read_b32 v193, a25
  v_accvgpr_read_b32 v194, a26
  v_accvgpr_read_b32 v195, a27
  v_accvgpr_read_b32 v196, a28
  v_accvgpr_read_b32 v197, a29
  v_accvgpr_read_b32 v198, a30
  v_accvgpr_read_b32 v199, a31
  v_mul_f32 v192, v192, v16
  v_mul_f32 v193, v193, v16
  v_mul_f32 v194, v194, v16
  v_mul_f32 v195, v195, v16
  v_mul_f32 v196, v196, v16
  v_mul_f32 v197, v197, v16
  v_mul_f32 v198, v198, v16
  v_mul_f32 v199, v199, v16
  v_cvt_pk_bf16_f32 v200, v192, v193
  v_cvt_pk_bf16_f32 v201, v194, v195
  v_cvt_pk_bf16_f32 v202, v196, v197
  v_cvt_pk_bf16_f32 v203, v198, v199
  buffer_store_dwordx4 v[200:203], v3, s[4:7], s66 offen sc1
  s_add_u32 s66, s66, 8192
  v_mov_b32 v128, v144
  v_mov_b32 v129, v145
  v_mov_b32 v130, v146
  v_mov_b32 v131, v147
  v_mov_b32 v132, v148
  v_mov_b32 v133, v149
  v_mov_b32 v134, v150
  v_mov_b32 v135, v151
  v_mov_b32 v136, v152
  v_mov_b32 v137, v153
  v_mov_b32 v138, v154
  v_mov_b32 v139, v155
  v_mov_b32 v140, v156
  v_mov_b32 v141, v157
  v_mov_b32 v142, v158
  v_mov_b32 v143, v159
  v_mov_b32 v144, v160
  v_mov_b32 v145, v161
  v_mov_b32 v146, v162
  v_mov_b32 v147, v163
  v_mov_b32 v148, v164
  v_mov_b32 v149, v165
  v_mov_b32 v150, v166
  v_mov_b32 v151, v167
  v_mov_b32 v152, v168
  v_mov_b32 v153, v169
  v_mov_b32 v154, v170
  v_mov_b32 v155, v171
  v_mov_b32 v156, v172
  v_mov_b32 v157, v173
  v_mov_b32 v158, v174
  v_mov_b32 v159, v175
  v_mov_b32 v160, v176
  v_mov_b32 v161, v177
  v_mov_b32 v162, v178
  v_mov_b32 v163, v179
  v_mov_b32 v164, v180
  v_mov_b32 v165, v181
  v_mov_b32 v166, v182
  v_mov_b32 v167, v183
  v_mov_b32 v168, v184
  v_mov_b32 v169, v185
  v_mov_b32 v170, v186
  v_mov_b32 v171, v187
  v_mov_b32 v172, v188
  v_mov_b32 v173, v189
  v_mov_b32 v174, v190
  v_mov_b32 v175, v191
  s_add_u32 s72, s72, 1
  s_cmp_lt_u32 s72, 4
  s_cbranch_scc1 L_slow_qt
  s_waitcnt vmcnt(0)
  ds_read_b128 a[32:35], v68 offset:448
  ds_read_b128 a[0:3], v72
  ds_read_b128 a[36:39], v68 offset:960
  ds_read2_b32 a[4:5], v64 offset0:128 offset1:129
  ds_read2_b32 a[6:7], v64 offset0:130 offset1:131
  ds_read_b128 a[40:43], v68 offset:1472
  ds_read2_b32 a[8:9], v65 offset0:0 offset1:1
  ds_read2_b32 a[10:11], v65 offset0:2 offset1:3
  ds_read_b128 a[44:47], v68 offset:1984
  ds_read2_b32 a[12:13], v65 offset0:128 offset1:129
  ds_read2_b32 a[14:15], v65 offset0:130 offset1:131
  ds_read_b128 a[48:51], v68 offset:2496
  ds_read2_b32 a[16:17], v66 offset0:0 offset1:1
  ds_read2_b32 a[18:19], v66 offset0:2 offset1:3
  ds_read_b128 a[52:55], v68 offset:3008
  ds_read2_b32 a[20:21], v66 offset0:128 offset1:129
  ds_read2_b32 a[22:23], v66 offset0:130 offset1:131
  ds_read_b128 a[56:59], v68 offset:3520
  ds_read2_b32 a[24:25], v67 offset0:0 offset1:1
  ds_read2_b32 a[26:27], v67 offset0:2 offset1:3
  ds_read_b128 a[60:63], v68 offset:4032
  ds_read2_b32 a[28:29], v67 offset0:128 offset1:129
  ds_read2_b32 a[30:31], v67 offset0:130 offset1:131
  s_mov_b32 s6, 0
  s_branch L_slow_ret
.section .rodata,"a"
.p2align 6
.amdhsa_kernel gated_mix__compressed_kv_cla__ssm_conv_h3__prompt_kernel
  .amdhsa_next_free_vgpr 512
  .amdhsa_next_free_sgpr 102
  .amdhsa_accum_offset 256
  .amdhsa_group_segment_fixed_size 0
  .amdhsa_kernarg_size 128
  .amdhsa_user_sgpr_count 2
  .amdhsa_user_sgpr_kernarg_segment_ptr 1
  .amdhsa_system_sgpr_workgroup_id_x 1
  .amdhsa_float_denorm_mode_32 3
.end_amdhsa_kernel
```

```asm
; @launch grid=(256,1,1) block=(256,1,1) lds=163840
.amdgcn_target "amdgcn-amd-amdhsa--gfx950"
.text
.globl gated_mix__compressed_kv_cla__ssm_conv_h3__prompt_kernel
.p2align 8
.type gated_mix__compressed_kv_cla__ssm_conv_h3__prompt_kernel,@function
gated_mix__compressed_kv_cla__ssm_conv_h3__prompt_kernel:
  s_cmp_ge_u32 s2, 256
  s_cbranch_scc1 L_end
  s_load_dwordx16 s[64:79], s[0:1], 0
  s_load_dwordx16 s[80:95], s[0:1], 64
  s_lshr_b32 s54, s2, 3
  s_mul_i32 s54, s54, 20
  v_lshrrev_b32 v20, 3, v0
  v_min_u32 v20, 19, v20
  v_add_u32 v20, s54, v20
  v_min_u32 v20, 629, v20
  v_lshlrev_b32 v20, 7, v20
  s_getpc_b64 s[52:53]
L_pc0:
  s_add_u32 s52, s52, L_pg0-L_pc0
  s_addc_u32 s53, s53, 0
  v_add_co_u32 v20, vcc, s52, v20
  v_mov_b32 v21, s53
  s_nop 0
  v_addc_co_u32 v21, vcc, 0, v21, vcc
  global_load_dword v127, v[20:21], off
L_code0:
  v_lshrrev_b32 v14, 6, v0
  v_and_b32 v1, 63, v0
  v_readfirstlane_b32 s28, v14
  s_and_b32 s3, s2, 7
  s_lshr_b32 s31, s2, 6
  s_lshl_b32 s29, s3, 2
  s_add_u32 s29, s29, s31
  s_lshr_b32 s30, s2, 3
  s_and_b32 s30, s30, 7
  s_lshl_b32 s96, s28, 13
  s_lshl_b32 s97, s28, 12
  v_lshrrev_b32 v16, 4, v1
  s_lshr_b32 s99, s2, 6
  s_lshr_b32 s31, s2, 3
  s_add_u32 s99, s99, s31
  s_and_b32 s55, s99, 1
  v_and_b32 v17, 15, v1
  v_lshlrev_b32 v18, 1, v16
  v_xor_b32 v18, v17, v18
  v_lshlrev_b32 v18, 4, v18
  v_lshl_add_u32 v28, v16, 13, v18
  s_lshl_b32 s98, s55, 19
  v_xor_b32 v28, s98, v28
  v_xor_b32 v29, 0x80, v28
  s_lshl_b32 s3, s29, 8
  s_lshl_b32 s31, s28, 17
  s_add_u32 s3, s3, s31
  s_mov_b32 s48, 0x0
  s_mov_b32 s49, 0x7c00
  s_mov_b32 s50, 0xf800
  s_mov_b32 s51, 0x17400
  s_mov_b32 s10, 0x39e100
  s_mov_b32 s11, 0x20000
  s_add_u32 m0, s97, 0x10000
  s_waitcnt lgkmcnt(0)
  s_add_u32 s8, s70, s3
  s_addc_u32 s9, s71, 0
  buffer_load_dwordx4 v28, s[8:11], s48 offen offset:0  lds
  buffer_load_dwordx4 v28, s[8:11], s49 offen offset:1024  lds
  buffer_load_dwordx4 v29, s[8:11], s50 offen offset:2048  lds
  buffer_load_dwordx4 v29, s[8:11], s51 offen offset:3072  lds
  v_lshrrev_b32 v14, 3, v1
  v_and_b32 v15, 7, v1
  v_xor_b32 v18, v15, v16
  v_lshlrev_b32 v18, 4, v18
  v_lshl_add_u32 v24, v14, 10, v18
  s_lshl_b32 s98, s55, 7
  v_xor_b32 v24, s98, v24
  v_xor_b32 v25, 64, v24
  s_lshl_b32 s98, s30, 17
  s_lshr_b32 s31, s28, 1
  s_lshl_b32 s31, s31, 16
  s_add_u32 s98, s98, s31
  s_and_b32 s31, s28, 1
  s_lshl_b32 s31, s31, 20
  s_add_u32 s98, s98, s31
  s_add_u32 s4, s66, s98
  s_addc_u32 s5, s67, 0
  s_mov_b32 s6, 0x10000
  s_mov_b32 s7, 0x20000
  s_add_u32 m0, s96, 0x0
  s_mov_b32 s32, 0x0
  buffer_load_dwordx4 v24, s[4:7], s32 offen offset:0  lds
  s_mov_b32 s33, 0x1c00
  buffer_load_dwordx4 v25, s[4:7], s33 offen offset:1024  lds
  s_mov_b32 s34, 0x3800
  buffer_load_dwordx4 v24, s[4:7], s34 offen offset:2048  lds
  s_mov_b32 s35, 0x5400
  buffer_load_dwordx4 v25, s[4:7], s35 offen offset:3072  lds
  s_add_u32 m0, s96, 0x1000
  s_mov_b32 s36, 0x8000
  buffer_load_dwordx4 v24, s[4:7], s36 offen offset:0  lds
  s_mov_b32 s37, 0x9c00
  buffer_load_dwordx4 v25, s[4:7], s37 offen offset:1024  lds
  s_mov_b32 s38, 0xb800
  buffer_load_dwordx4 v24, s[4:7], s38 offen offset:2048  lds
  s_mov_b32 s39, 0xd400
  buffer_load_dwordx4 v25, s[4:7], s39 offen offset:3072  lds
  s_add_u32 s12, s72, s3
  s_addc_u32 s13, s73, 0
  s_mov_b32 s14, 0x39e100
  s_mov_b32 s15, 0x20000
  v_lshl_add_u32 v26, v14, 11, v18
  s_and_b32 s99, s99, 1
  s_lshl_b32 s98, s99, 7
  v_xor_b32 v26, s98, v26
  v_xor_b32 v27, 64, v26
  s_xor_b32 s99, s99, s55
  s_xor_b32 s99, s99, 7
  s_lshl_b32 s99, s99, 19
  v_lshlrev_b32 v3, 4, v1
  v_add_u32 v2, s97, v3
  v_lshrrev_b32 v18, 1, v17
  v_xor_b32 v18, v16, v18
  v_lshlrev_b32 v18, 4, v18
  v_lshl_add_u32 v18, v17, 7, v18
  s_and_b32 s31, s28, 1
  s_lshl_b32 s31, s31, 14
  v_add_u32 v30, s31, v18
  v_xor_b32 v31, 64, v30
  v_add_u32 v32, 0x20000, v30
  v_add_u32 v33, 0x20000, v31
  v_add_u32 v34, s96, v18
  v_xor_b32 v35, 64, v34
  v_add_u32 v36, 0x20000, v34
  v_add_u32 v37, 0x20000, v35
  v_bfe_u32 v18, v1, 2, 2
  v_and_b32 v19, 1, v16
  v_lshl_add_u32 v19, v19, 2, v18
  v_lshl_add_u32 v18, v16, 3, v18
  v_lshlrev_b32 v18, 8, v18
  v_lshl_add_u32 v18, v19, 5, v18
  v_and_b32 v19, 3, v1
  v_lshl_add_u32 v18, v19, 3, v18
  v_add_u32 v42, 0x10000, v18
  v_xor_b32 v43, 0x20, v42
  v_xor_b32 v44, 0x40, v42
  v_xor_b32 v45, 0x60, v42
  v_xor_b32 v46, 0x80, v42
  v_xor_b32 v47, 0xa0, v42
  v_xor_b32 v48, 0xc0, v42
  v_xor_b32 v49, 0xe0, v42
  s_lshr_b32 s31, s28, 1
  s_lshl_b32 s31, s31, 7
  v_xor_b32 v38, s31, v42
  v_xor_b32 v39, s31, v43
  v_xor_b32 v40, s31, v44
  v_xor_b32 v41, s31, v45
  s_mov_b64 exec, 0
  s_cmp_eq_u32 s28, 0
  s_cbranch_scc1 L_pad1
  s_cmp_eq_u32 s28, 1
  s_cbranch_scc1 L_pad2
  s_cmp_eq_u32 s28, 2
  s_cbranch_scc1 L_pad3
  s_branch L_pad4
.p2align 12
L_pg0:
L_hr0:
  s_mov_b64 exec, -1
  s_add_u32 m0, s97, 0x14000
  s_nop 0
  buffer_load_dwordx4 v28, s[12:15], s48 offen offset:0  lds
  buffer_load_dwordx4 v28, s[12:15], s49 offen offset:1024  lds
  buffer_load_dwordx4 v29, s[12:15], s50 offen offset:2048  lds
  buffer_load_dwordx4 v29, s[12:15], s51 offen offset:3072  lds
  v_xor_b32 v28, 0x80000, v28
  v_xor_b32 v29, 0x80000, v29
  s_add_u32 m0, s97, 0x18000
  s_nop 0
  buffer_load_dwordx4 v28, s[8:11], s48 offen offset:0  lds
  buffer_load_dwordx4 v28, s[8:11], s49 offen offset:1024  lds
  buffer_load_dwordx4 v29, s[8:11], s50 offen offset:2048  lds
  buffer_load_dwordx4 v29, s[8:11], s51 offen offset:3072  lds
  s_waitcnt vmcnt(8)
  s_barrier
  ds_read_b64_tr_b16 a[192:193], v38 offset:0
  ds_read_b64_tr_b16 a[194:195], v38 offset:1024
  ds_read_b64_tr_b16 a[196:197], v38 offset:8192
  ds_read_b64_tr_b16 a[198:199], v38 offset:9216
  ds_read_b128 a[128:131], v30 offset:0
  ds_read_b128 a[132:135], v31 offset:0
  ds_read_b128 a[140:143], v31 offset:2048
  ds_read_b128 a[136:139], v30 offset:2048
  ds_read_b128 a[144:147], v30 offset:4096
  ds_read_b128 a[148:151], v31 offset:4096
  ds_read_b128 a[156:159], v31 offset:6144
  ds_read_b128 a[152:155], v30 offset:6144
  s_waitcnt lgkmcnt(7)
  v_mfma_f32_16x16x32_bf16 v[128:131], a[192:195], a[128:131], 0
  s_waitcnt lgkmcnt(6)
  s_lshl_b32 s3, s29, 8
  s_lshl_b32 s31, s28, 17
  ds_read_b128 a[160:163], v30 offset:8192
  v_mfma_f32_16x16x32_bf16 v[128:131], a[196:199], a[132:135], v[128:131]
  s_waitcnt lgkmcnt(6)
  s_add_u32 s3, s3, s31
  ds_read_b128 a[164:167], v31 offset:8192
  v_mfma_f32_16x16x32_bf16 v[144:147], a[196:199], a[140:143], 0
  s_waitcnt lgkmcnt(6)
  s_add_u32 s60, s68, s3
  s_addc_u32 s61, s69, 0
  ds_read_b128 a[172:175], v31 offset:10240
  v_mfma_f32_16x16x32_bf16 v[144:147], a[192:195], a[136:139], v[144:147]
  s_waitcnt lgkmcnt(6)
  s_mov_b32 s62, 0x79e100
  s_mov_b32 s63, 0x20000
  ds_read_b128 a[168:171], v30 offset:10240
  v_mfma_f32_16x16x32_bf16 v[160:163], a[192:195], a[144:147], 0
  s_waitcnt lgkmcnt(6)
  s_mov_b32 s56, s64
  s_mov_b32 s57, s65
  ds_read_b128 a[176:179], v30 offset:12288
  v_mfma_f32_16x16x32_bf16 v[160:163], a[196:199], a[148:151], v[160:163]
  s_waitcnt lgkmcnt(6)
  s_mov_b32 s58, 0x400000
  s_mov_b32 s59, 0x20000
  ds_read_b128 a[180:183], v31 offset:12288
  v_mfma_f32_16x16x32_bf16 v[176:179], a[196:199], a[156:159], 0
  s_waitcnt lgkmcnt(6)
  s_lshl_b32 s3, s30, 18
  s_lshl_b32 s31, s28, 15
  ds_read_b128 a[188:191], v31 offset:14336
  v_mfma_f32_16x16x32_bf16 v[176:179], a[192:195], a[152:155], v[176:179]
  s_waitcnt lgkmcnt(6)
  s_add_u32 s40, s3, s31
  s_xor_b32 s3, s3, 0x3c0000
  ds_read_b128 a[184:187], v30 offset:14336
  v_mfma_f32_16x16x32_bf16 v[192:195], a[192:195], a[160:163], 0
  s_waitcnt lgkmcnt(6)
  s_add_u32 s44, s3, s31
  s_add_u32 s41, s40, 0x3c00
  ds_read_b64_tr_b16 a[200:201], v39 offset:0
  v_mfma_f32_16x16x32_bf16 v[192:195], a[196:199], a[164:167], v[192:195]
  s_waitcnt lgkmcnt(6)
  s_add_u32 s45, s44, 0x3c00
  s_add_u32 s42, s40, 0x1f800
  ds_read_b64_tr_b16 a[202:203], v39 offset:1024
  v_mfma_f32_16x16x32_bf16 v[208:211], a[196:199], a[172:175], 0
  s_waitcnt lgkmcnt(6)
  s_add_u32 s46, s44, 0x1f800
  s_add_u32 s43, s40, 0x23400
  ds_read_b64_tr_b16 a[204:205], v39 offset:8192
  v_mfma_f32_16x16x32_bf16 v[208:211], a[192:195], a[168:171], v[208:211]
  s_waitcnt lgkmcnt(6)
  s_add_u32 s47, s44, 0x23400
  s_lshl_b32 s3, s29, 20
  ds_read_b64_tr_b16 a[206:207], v39 offset:9216
  v_mfma_f32_16x16x32_bf16 v[224:227], a[192:195], a[176:179], 0
  s_waitcnt lgkmcnt(6)
  s_add_u32 s16, s94, s3
  s_addc_u32 s17, s95, 0
  ds_read_b64_tr_b16 a[208:209], v40 offset:0
  v_mfma_f32_16x16x32_bf16 v[224:227], a[196:199], a[180:183], v[224:227]
  s_waitcnt lgkmcnt(6)
  s_mov_b32 s18, 0x100000
  s_mov_b32 s19, 0x20000
  ds_read_b64_tr_b16 a[210:211], v40 offset:1024
  v_mfma_f32_16x16x32_bf16 v[240:243], a[196:199], a[188:191], 0
  s_waitcnt lgkmcnt(6)
  s_xor_b32 s31, s30, 15
  s_add_u32 s31, s31, 1
  ds_read_b64_tr_b16 a[212:213], v40 offset:8192
  v_mfma_f32_16x16x32_bf16 v[240:243], a[192:195], a[184:187], v[240:243]
  s_waitcnt lgkmcnt(5)
  s_lshl_b32 s31, s31, 16
  ds_read_b64_tr_b16 a[214:215], v40 offset:9216
  v_xor_b32 v24, 0x80, v24
  v_mfma_f32_16x16x32_bf16 v[244:247], a[200:203], a[184:187], 0
  s_waitcnt lgkmcnt(4)
  s_add_u32 s24, s94, s3
  s_addc_u32 s25, s95, 0
  v_xor_b32 v25, 0x80, v25
  v_mfma_f32_16x16x32_bf16 v[244:247], a[204:207], a[188:191], v[244:247]
  s_mov_b32 s26, s31
  s_mov_b32 s27, 0x20000
  v_mfma_f32_16x16x32_bf16 v[228:231], a[204:207], a[180:183], 0
  s_add_u32 s20, s94, 0x3d00000
  s_addc_u32 s21, s95, 0
  v_mfma_f32_16x16x32_bf16 v[228:231], a[200:203], a[176:179], v[228:231]
  s_mov_b32 s22, 0x100000
  s_mov_b32 s23, 0x20000
  v_mfma_f32_16x16x32_bf16 v[212:215], a[200:203], a[168:171], 0
  s_lshl_b32 s3, s30, 16
  s_and_b32 s31, s28, 1
  v_mfma_f32_16x16x32_bf16 v[212:215], a[204:207], a[172:175], v[212:215]
  s_lshl_b32 s31, s31, 15
  s_add_u32 s3, s3, s31
  v_mfma_f32_16x16x32_bf16 v[196:199], a[204:207], a[164:167], 0
  s_lshr_b32 s31, s28, 1
  s_lshl_b32 s98, s31, 11
  ds_read_b64_tr_b16 a[216:217], v41 offset:0
  v_mfma_f32_16x16x32_bf16 v[196:199], a[200:203], a[160:163], v[196:199]
  s_add_u32 s98, s98, s3
  v_add_u32 v11, s98, v3
  s_lshl_b32 s98, s31, 13
  v_mfma_f32_16x16x32_bf16 v[180:183], a[200:203], a[152:155], 0
  s_add_u32 s98, s98, s3
  s_add_u32 s98, s98, 0x4000
  v_add_u32 v12, s98, v3
  v_mfma_f32_16x16x32_bf16 v[180:183], a[204:207], a[156:159], v[180:183]
  v_lshlrev_b32 v8, 20, v0
  s_lshl_b32 s3, s29, 10
  s_add_u32 s3, s3, 524288
  v_mfma_f32_16x16x32_bf16 v[164:167], a[204:207], a[148:151], 0
  s_add_u32 m0, s96, 0x8000
  v_lshlrev_b32 v7, 7, v15
  v_add_u32 v7, s3, v7
  v_mfma_f32_16x16x32_bf16 v[164:167], a[200:203], a[144:147], v[164:167]
  v_mov_b32 v9, 1
  v_mov_b32 v13, 0xff800000
  v_mfma_f32_16x16x32_bf16 v[148:151], a[200:203], a[136:139], 0
  v_add_u32 v4, 0x10000, v3
  v_mov_b32 v5, v3
  s_mov_b32 s52, s64
  v_mfma_f32_16x16x32_bf16 v[148:151], a[204:207], a[140:143], v[148:151]
  s_mov_b32 s53, s65
  s_mov_b32 s54, 0x400000
  ds_read_b64_tr_b16 a[218:219], v41 offset:1024
  v_mfma_f32_16x16x32_bf16 v[132:135], a[204:207], a[132:135], 0
  s_mov_b32 s55, 0x20000
  s_lshr_b32 s3, s2, 4
  ds_read_b64_tr_b16 a[220:221], v41 offset:8192
  v_mfma_f32_16x16x32_bf16 v[132:135], a[200:203], a[128:131], v[132:135]
  s_waitcnt lgkmcnt(5)
  s_lshl_b32 s3, s3, 18
  s_and_b32 s31, s2, 15
  ds_read_b64_tr_b16 a[222:223], v41 offset:9216
  v_mfma_f32_16x16x32_bf16 v[136:139], a[208:211], a[128:131], 0
  s_waitcnt lgkmcnt(4)
  s_lshl_b32 s31, s31, 7
  buffer_load_dwordx4 v24, s[4:7], s32 offen offset:0  lds
  v_mfma_f32_16x16x32_bf16 v[136:139], a[212:215], a[132:135], v[136:139]
  s_add_u32 s3, s3, s31
  v_lshrrev_b32 v22, 4, v0
  v_lshlrev_b32 v18, 14, v22
  v_mfma_f32_16x16x32_bf16 v[152:155], a[212:215], a[140:143], 0
  v_lshl_add_u32 v18, v17, 3, v18
  v_add_u32 v18, s3, v18
  s_lshl_b32 s31, s31, 2
  v_mfma_f32_16x16x32_bf16 v[152:155], a[208:211], a[136:139], v[152:155]
  v_lshlrev_b32 v19, 5, v17
  v_add_u32 v19, s31, v19
  s_lshl_b32 s31, s31, 9
  v_mfma_f32_16x16x32_bf16 v[168:171], a[208:211], a[144:147], 0
  s_lshr_b32 s3, s2, 4
  s_lshl_b32 s3, s3, 9
  v_mfma_f32_16x16x32_bf16 v[168:171], a[212:215], a[148:151], v[168:171]
  s_add_u32 s3, s3, s31
  s_lshl_b32 s31, s28, 7
  v_mfma_f32_16x16x32_bf16 v[184:187], a[212:215], a[156:159], 0
  s_add_u32 s3, s3, s31
  v_lshlrev_b32 v20, 15, v14
  v_lshl_add_u32 v20, v15, 4, v20
  v_mfma_f32_16x16x32_bf16 v[184:187], a[208:211], a[152:155], v[184:187]
  s_waitcnt vmcnt(5)
  buffer_load_dwordx4 v25, s[4:7], s33 offen offset:1024  lds
  v_mfma_f32_16x16x32_bf16 v[200:203], a[208:211], a[160:163], 0
  s_barrier
  v_mfma_f32_16x16x32_bf16 v[200:203], a[212:215], a[164:167], v[200:203]
  v_add_u32 v20, s3, v20
  v_bfe_u32 v21, v17, 3, 1
  v_mfma_f32_16x16x32_bf16 v[216:219], a[212:215], a[172:175], 0
  v_lshl_add_u32 v21, v21, 2, v16
  v_xor_b32 v21, v21, v15
  v_mfma_f32_16x16x32_bf16 v[216:219], a[208:211], a[168:171], v[216:219]
  v_lshl_add_u32 v6, v15, 3, v21
  v_lshlrev_b32 v6, 4, v6
  v_mfma_f32_16x16x32_bf16 v[232:235], a[208:211], a[176:179], 0
  v_add_u32 v6, s96, v6
  s_lshr_b32 s3, s2, 3
  s_lshl_b32 s3, s3, 18
  v_mfma_f32_16x16x32_bf16 v[232:235], a[212:215], a[180:183], v[232:235]
  s_lshl_b32 s31, s28, 16
  s_add_u32 s3, s3, s31
  ds_read_b64_tr_b16 a[192:193], v38 offset:16384
  v_mfma_f32_16x16x32_bf16 v[248:251], a[212:215], a[188:191], 0
  s_and_b32 s31, s2, 7
  buffer_load_dwordx4 v24, s[4:7], s34 offen offset:2048  lds
  v_mfma_f32_16x16x32_bf16 v[248:251], a[208:211], a[184:187], v[248:251]
  s_waitcnt lgkmcnt(3)
  s_lshl_b32 s31, s31, 10
  s_add_u32 s3, s3, s31
  v_lshrrev_b32 v21, 5, v1
  v_mfma_f32_16x16x32_bf16 v[252:255], a[216:219], a[184:187], 0
  s_waitcnt lgkmcnt(1)
  v_lshlrev_b32 v21, 13, v21
  v_bfe_u32 v22, v1, 2, 3
  v_mfma_f32_16x16x32_bf16 v[252:255], a[220:223], a[188:191], v[252:255]
  v_lshl_add_u32 v21, v22, 7, v21
  v_add_u32 v21, s3, v21
  v_mfma_f32_16x16x32_bf16 v[236:239], a[220:223], a[180:183], 0
  v_xor_b32 v22, v14, v1
  v_lshlrev_b32 v22, 4, v22
  v_mfma_f32_16x16x32_bf16 v[236:239], a[216:219], a[176:179], v[236:239]
  v_add_u32 v22, s96, v22
  s_mov_b32 s101, 0xffff0000
  s_lshl_b32 s3, s28, 20
  v_mfma_f32_16x16x32_bf16 v[220:223], a[216:219], a[168:171], 0
  v_add_u32 v15, s3, v3
  v_mov_b32 v100, 0
  v_mfma_f32_16x16x32_bf16 v[220:223], a[220:223], a[172:175], v[220:223]
  buffer_load_dwordx4 v25, s[4:7], s35 offen offset:3072  lds
  v_mfma_f32_16x16x32_bf16 v[204:207], a[220:223], a[164:167], 0
  s_add_u32 m0, s96, 0x9000
  v_mov_b32 v101, 0
  v_mov_b32 v102, 0
  v_mfma_f32_16x16x32_bf16 v[204:207], a[216:219], a[160:163], v[204:207]
  ds_read_b64_tr_b16 a[194:195], v38 offset:17408
  v_mov_b32 v103, 0
  s_lshl_b32 s77, s2, 14
  v_mfma_f32_16x16x32_bf16 v[188:191], a[216:219], a[152:155], 0
  s_add_u32 s77, s77, s97
  ds_read_b64_tr_b16 a[196:197], v38 offset:24576
  v_subrev_u32 v96, 6144, v18
  v_mfma_f32_16x16x32_bf16 v[188:191], a[220:223], a[156:159], v[188:191]
  ds_read_b64_tr_b16 a[198:199], v38 offset:25600
  v_subrev_u32 v97, 4096, v18
  v_mfma_f32_16x16x32_bf16 v[172:175], a[220:223], a[148:151], 0
  ds_read_b64_tr_b16 a[200:201], v39 offset:16384
  v_subrev_u32 v98, 2048, v18
  v_mfma_f32_16x16x32_bf16 v[172:175], a[216:219], a[144:147], v[172:175]
  buffer_load_dwordx4 v24, s[4:7], s36 offen offset:0  lds
  v_mfma_f32_16x16x32_bf16 v[156:159], a[216:219], a[136:139], 0
  ds_read_b64_tr_b16 a[202:203], v39 offset:17408
  v_mfma_f32_16x16x32_bf16 v[156:159], a[220:223], a[140:143], v[156:159]
  ds_read_b64_tr_b16 a[204:205], v39 offset:24576
  v_mfma_f32_16x16x32_bf16 v[140:143], a[220:223], a[132:135], 0
  buffer_load_dwordx4 v25, s[4:7], s37 offen offset:1024  lds
  v_mfma_f32_16x16x32_bf16 v[140:143], a[216:219], a[128:131], v[140:143]
  s_waitcnt lgkmcnt(5)
  ds_read_b64_tr_b16 a[206:207], v39 offset:25600
  v_mfma_f32_16x16x32_bf16 a[0:3], a[128:131], a[192:195], 0
  s_waitcnt lgkmcnt(4)
  v_mfma_f32_16x16x32_bf16 a[0:3], a[132:135], a[196:199], a[0:3]
  buffer_load_dwordx4 v24, s[4:7], s38 offen offset:2048  lds
  v_mfma_f32_16x16x32_bf16 a[16:19], a[140:143], a[196:199], 0
  v_mfma_f32_16x16x32_bf16 a[16:19], a[136:139], a[192:195], a[16:19]
  v_mfma_f32_16x16x32_bf16 a[32:35], a[144:147], a[192:195], 0
  buffer_load_dwordx4 v25, s[4:7], s39 offen offset:3072  lds
  v_mfma_f32_16x16x32_bf16 a[32:35], a[148:151], a[196:199], a[32:35]
  v_mfma_f32_16x16x32_bf16 a[48:51], a[156:159], a[196:199], 0
  ds_read_b64_tr_b16 a[208:209], v40 offset:16384
  v_mfma_f32_16x16x32_bf16 a[48:51], a[152:155], a[192:195], a[48:51]
  ds_read_b64_tr_b16 a[210:211], v40 offset:17408
  v_mfma_f32_16x16x32_bf16 a[64:67], a[160:163], a[192:195], 0
  ds_read_b64_tr_b16 a[212:213], v40 offset:24576
  v_mfma_f32_16x16x32_bf16 a[64:67], a[164:167], a[196:199], a[64:67]
  ds_read_b64_tr_b16 a[214:215], v40 offset:25600
  v_mfma_f32_16x16x32_bf16 a[80:83], a[172:175], a[196:199], 0
  v_mfma_f32_16x16x32_bf16 a[80:83], a[168:171], a[192:195], a[80:83]
  s_lshl_b32 s76, s2, 11
  v_mfma_f32_16x16x32_bf16 a[96:99], a[176:179], a[192:195], 0
  buffer_store_dwordx4 v[100:103], v15, s[20:23], s76 offen offset:1024 sc1
  v_mfma_f32_16x16x32_bf16 a[96:99], a[180:183], a[196:199], a[96:99]
  v_mfma_f32_16x16x32_bf16 a[112:115], a[188:191], a[196:199], 0
  v_mfma_f32_16x16x32_bf16 a[112:115], a[184:187], a[192:195], a[112:115]
  s_waitcnt lgkmcnt(6)
  buffer_store_dwordx4 v[100:103], v15, s[20:23], s76 offen sc1
  v_mfma_f32_16x16x32_bf16 a[116:119], a[184:187], a[200:203], 0
  s_waitcnt lgkmcnt(4)
  s_lshl_b32 s76, s29, 10
  v_mfma_f32_16x16x32_bf16 a[116:119], a[188:191], a[204:207], a[116:119]
  s_add_u32 s76, s76, 524288
  v_mfma_f32_16x16x32_bf16 a[100:103], a[180:183], a[204:207], 0
  s_cmp_eq_u32 s30, 7
  s_cselect_b32 s76, s76, 0x100000
  v_mfma_f32_16x16x32_bf16 a[100:103], a[176:179], a[200:203], a[100:103]
  buffer_store_dwordx4 v[100:103], v15, s[20:23], s76 offen sc1
  v_mfma_f32_16x16x32_bf16 a[84:87], a[168:171], a[200:203], 0
  s_add_u32 m0, s97, 0x1c000
  v_mfma_f32_16x16x32_bf16 a[84:87], a[172:175], a[204:207], a[84:87]
  v_mfma_f32_16x16x32_bf16 a[68:71], a[164:167], a[204:207], 0
  buffer_load_dwordx4 v28, s[12:15], s48 offen offset:0  lds
  v_mfma_f32_16x16x32_bf16 a[68:71], a[160:163], a[200:203], a[68:71]
  ds_read_b64_tr_b16 a[216:217], v41 offset:16384
  v_mfma_f32_16x16x32_bf16 a[52:55], a[152:155], a[200:203], 0
  ds_read_b64_tr_b16 a[218:219], v41 offset:17408
  v_mfma_f32_16x16x32_bf16 a[52:55], a[156:159], a[204:207], a[52:55]
  buffer_load_dwordx4 v28, s[12:15], s49 offen offset:1024  lds
  v_mfma_f32_16x16x32_bf16 a[36:39], a[148:151], a[204:207], 0
  ds_read_b64_tr_b16 a[220:221], v41 offset:24576
  v_mfma_f32_16x16x32_bf16 a[36:39], a[144:147], a[200:203], a[36:39]
  ds_read_b64_tr_b16 a[222:223], v41 offset:25600
  v_mfma_f32_16x16x32_bf16 a[20:23], a[136:139], a[200:203], 0
  v_mfma_f32_16x16x32_bf16 a[20:23], a[140:143], a[204:207], a[20:23]
  v_mfma_f32_16x16x32_bf16 a[4:7], a[132:135], a[204:207], 0
  v_mfma_f32_16x16x32_bf16 a[4:7], a[128:131], a[200:203], a[4:7]
  s_waitcnt lgkmcnt(6)
  v_mfma_f32_16x16x32_bf16 a[8:11], a[128:131], a[208:211], 0
  s_waitcnt lgkmcnt(4)
  buffer_load_dwordx4 v29, s[12:15], s50 offen offset:2048  lds
  v_mfma_f32_16x16x32_bf16 a[8:11], a[132:135], a[212:215], a[8:11]
  v_mfma_f32_16x16x32_bf16 a[24:27], a[140:143], a[212:215], 0
  v_mfma_f32_16x16x32_bf16 a[24:27], a[136:139], a[208:211], a[24:27]
  v_mfma_f32_16x16x32_bf16 a[40:43], a[144:147], a[208:211], 0
  v_mfma_f32_16x16x32_bf16 a[40:43], a[148:151], a[212:215], a[40:43]
  v_mfma_f32_16x16x32_bf16 a[56:59], a[156:159], a[212:215], 0
  v_mfma_f32_16x16x32_bf16 a[56:59], a[152:155], a[208:211], a[56:59]
  s_waitcnt vmcnt(6)
  buffer_load_dwordx4 v29, s[12:15], s51 offen offset:3072  lds
  v_mfma_f32_16x16x32_bf16 a[72:75], a[160:163], a[208:211], 0
  s_barrier
  v_mfma_f32_16x16x32_bf16 a[72:75], a[164:167], a[212:215], a[72:75]
  s_mov_b32 s52, s78
  ds_read_b64_tr_b16 a[192:193], v38 offset:32768
  v_mfma_f32_16x16x32_bf16 a[88:91], a[172:175], a[212:215], 0
  s_mov_b32 s53, s79
  ds_read_b64_tr_b16 a[194:195], v38 offset:33792
  v_mfma_f32_16x16x32_bf16 a[88:91], a[168:171], a[208:211], a[88:91]
  s_mov_b32 s54, 0x400000
  ds_read_b64_tr_b16 a[196:197], v38 offset:40960
  v_mfma_f32_16x16x32_bf16 a[104:107], a[176:179], a[208:211], 0
  ds_read_b64_tr_b16 a[198:199], v38 offset:41984
  v_mfma_f32_16x16x32_bf16 a[104:107], a[180:183], a[212:215], a[104:107]
  v_mfma_f32_16x16x32_bf16 a[120:123], a[188:191], a[212:215], 0
  buffer_load_dwordx2 v[58:59], v96, s[52:55], 0 offen
  v_mfma_f32_16x16x32_bf16 a[120:123], a[184:187], a[208:211], a[120:123]
  s_waitcnt lgkmcnt(6)
  v_mfma_f32_16x16x32_bf16 a[124:127], a[184:187], a[216:219], 0
  s_waitcnt lgkmcnt(4)
  ds_read_b128 a[184:187], v30 offset:47104
  v_mfma_f32_16x16x32_bf16 a[124:127], a[188:191], a[220:223], a[124:127]
  buffer_load_dwordx2 v[60:61], v97, s[52:55], 0 offen
  v_mfma_f32_16x16x32_bf16 a[108:111], a[180:183], a[220:223], 0
  ds_read_b128 a[188:191], v31 offset:47104
  v_mfma_f32_16x16x32_bf16 a[108:111], a[176:179], a[216:219], a[108:111]
  ds_read_b128 a[180:183], v31 offset:45056
  v_mfma_f32_16x16x32_bf16 a[92:95], a[168:171], a[216:219], 0
  ds_read_b128 a[176:179], v30 offset:45056
  v_mfma_f32_16x16x32_bf16 a[92:95], a[172:175], a[220:223], a[92:95]
  buffer_load_dwordx2 v[62:63], v98, s[52:55], 0 offen
  v_mfma_f32_16x16x32_bf16 a[76:79], a[164:167], a[220:223], 0
  s_mov_b32 s76, 0
  ds_read_b128 a[168:171], v30 offset:43008
  v_mfma_f32_16x16x32_bf16 a[76:79], a[160:163], a[216:219], a[76:79]
  ds_read_b128 a[172:175], v31 offset:43008
  v_mfma_f32_16x16x32_bf16 a[60:63], a[152:155], a[216:219], 0
  buffer_load_dwordx2 v[64:65], v18, s[52:55], s76 offen offset:0
  v_mfma_f32_16x16x32_bf16 a[60:63], a[156:159], a[220:223], a[60:63]
  ds_read_b128 a[164:167], v31 offset:40960
  v_xor_b32 v28, 0x180000, v28
  v_mfma_f32_16x16x32_bf16 a[44:47], a[148:151], a[220:223], 0
  ds_read_b128 a[160:163], v30 offset:40960
  v_xor_b32 v29, 0x180000, v29
  v_mfma_f32_16x16x32_bf16 a[44:47], a[144:147], a[216:219], a[44:47]
  s_add_u32 m0, s97, 0x10000
  ds_read_b128 a[152:155], v30 offset:38912
  v_mfma_f32_16x16x32_bf16 a[28:31], a[136:139], a[216:219], 0
  buffer_load_dwordx4 v28, s[8:11], s48 offen offset:0  lds
  v_mfma_f32_16x16x32_bf16 a[28:31], a[140:143], a[220:223], a[28:31]
  ds_read_b128 a[156:159], v31 offset:38912
  v_mfma_f32_16x16x32_bf16 a[12:15], a[132:135], a[220:223], 0
  ds_read_b128 a[148:151], v31 offset:36864
  v_mfma_f32_16x16x32_bf16 a[12:15], a[128:131], a[216:219], a[12:15]
  s_waitcnt lgkmcnt(10)
  ds_read_b128 a[144:147], v30 offset:36864
  v_mfma_f32_16x16x32_bf16 v[240:243], a[192:195], a[184:187], v[240:243]
  s_waitcnt lgkmcnt(10)
  ds_read_b128 a[136:139], v30 offset:34816
  v_mfma_f32_16x16x32_bf16 v[240:243], a[196:199], a[188:191], v[240:243]
  s_waitcnt lgkmcnt(10)
  ds_read_b128 a[140:143], v31 offset:34816
  v_mfma_f32_16x16x32_bf16 v[224:227], a[196:199], a[180:183], v[224:227]
  s_waitcnt lgkmcnt(10)
  ds_read_b64_tr_b16 a[200:201], v39 offset:32768
  v_mfma_f32_16x16x32_bf16 v[224:227], a[192:195], a[176:179], v[224:227]
  s_waitcnt lgkmcnt(10)
  buffer_load_dwordx4 v28, s[8:11], s49 offen offset:1024  lds
  v_mfma_f32_16x16x32_bf16 v[208:211], a[192:195], a[168:171], v[208:211]
  s_waitcnt lgkmcnt(9)
  ds_read_b128 a[132:135], v31 offset:32768
  v_mfma_f32_16x16x32_bf16 v[208:211], a[196:199], a[172:175], v[208:211]
  s_waitcnt lgkmcnt(9)
  ds_read_b64_tr_b16 a[202:203], v39 offset:33792
  v_mfma_f32_16x16x32_bf16 v[192:195], a[196:199], a[164:167], v[192:195]
  s_waitcnt lgkmcnt(9)
  ds_read_b128 a[128:131], v30 offset:32768
  v_mfma_f32_16x16x32_bf16 v[192:195], a[192:195], a[160:163], v[192:195]
  s_waitcnt lgkmcnt(9)
  ds_read_b64_tr_b16 a[204:205], v39 offset:40960
  v_mfma_f32_16x16x32_bf16 v[176:179], a[192:195], a[152:155], v[176:179]
  s_waitcnt lgkmcnt(9)
  ds_read_b64_tr_b16 a[206:207], v39 offset:41984
  v_mfma_f32_16x16x32_bf16 v[176:179], a[196:199], a[156:159], v[176:179]
  s_waitcnt lgkmcnt(9)
  ds_read_b64_tr_b16 a[208:209], v40 offset:32768
  v_mfma_f32_16x16x32_bf16 v[160:163], a[196:199], a[148:151], v[160:163]
  s_waitcnt lgkmcnt(9)
  buffer_load_dwordx4 v29, s[8:11], s50 offen offset:2048  lds
  v_mfma_f32_16x16x32_bf16 v[160:163], a[192:195], a[144:147], v[160:163]
  s_waitcnt lgkmcnt(8)
  ds_read_b64_tr_b16 a[210:211], v40 offset:33792
  v_mfma_f32_16x16x32_bf16 v[144:147], a[192:195], a[136:139], v[144:147]
  s_waitcnt lgkmcnt(8)
  ds_read_b64_tr_b16 a[212:213], v40 offset:40960
  v_mfma_f32_16x16x32_bf16 v[144:147], a[196:199], a[140:143], v[144:147]
  s_waitcnt lgkmcnt(7)
  ds_read_b64_tr_b16 a[214:215], v40 offset:41984
  v_mfma_f32_16x16x32_bf16 v[128:131], a[196:199], a[132:135], v[128:131]
  s_waitcnt lgkmcnt(6)
  v_mfma_f32_16x16x32_bf16 v[128:131], a[192:195], a[128:131], v[128:131]
  v_mfma_f32_16x16x32_bf16 v[132:135], a[200:203], a[128:131], v[132:135]
  s_waitcnt lgkmcnt(4)
  v_mfma_f32_16x16x32_bf16 v[132:135], a[204:207], a[132:135], v[132:135]
  buffer_load_dwordx4 v29, s[8:11], s51 offen offset:3072  lds
  v_mfma_f32_16x16x32_bf16 v[148:151], a[204:207], a[140:143], v[148:151]
  v_mfma_f32_16x16x32_bf16 v[148:151], a[200:203], a[136:139], v[148:151]
  v_mfma_f32_16x16x32_bf16 v[164:167], a[200:203], a[144:147], v[164:167]
  v_mfma_f32_16x16x32_bf16 v[164:167], a[204:207], a[148:151], v[164:167]
  v_mfma_f32_16x16x32_bf16 v[180:183], a[204:207], a[156:159], v[180:183]
  ds_read_b64_tr_b16 a[216:217], v41 offset:32768
  v_mfma_f32_16x16x32_bf16 v[180:183], a[200:203], a[152:155], v[180:183]
  ds_read_b64_tr_b16 a[218:219], v41 offset:33792
  v_mfma_f32_16x16x32_bf16 v[196:199], a[200:203], a[160:163], v[196:199]
  buffer_load_dwordx2 v[66:67], v18, s[52:55], s76 offen offset:2048
  v_mfma_f32_16x16x32_bf16 v[196:199], a[204:207], a[164:167], v[196:199]
  ds_read_b64_tr_b16 a[220:221], v41 offset:40960
  v_xor_b32 v24, 0x180, v24
  v_mfma_f32_16x16x32_bf16 v[212:215], a[204:207], a[172:175], v[212:215]
  ds_read_b64_tr_b16 a[222:223], v41 offset:41984
  v_xor_b32 v25, 0x180, v25
  v_mfma_f32_16x16x32_bf16 v[212:215], a[200:203], a[168:171], v[212:215]
  s_add_u32 m0, s96, 0x20000
  v_mfma_f32_16x16x32_bf16 v[228:231], a[200:203], a[176:179], v[228:231]
  buffer_load_dwordx4 v24, s[4:7], s32 offen offset:0  lds
  v_mfma_f32_16x16x32_bf16 v[228:231], a[204:207], a[180:183], v[228:231]
  v_mfma_f32_16x16x32_bf16 v[244:247], a[204:207], a[188:191], v[244:247]
  v_mfma_f32_16x16x32_bf16 v[244:247], a[200:203], a[184:187], v[244:247]
  s_waitcnt lgkmcnt(6)
  v_mfma_f32_16x16x32_bf16 v[248:251], a[208:211], a[184:187], v[248:251]
  s_waitcnt lgkmcnt(4)
  buffer_load_dwordx4 v25, s[4:7], s33 offen offset:1024  lds
  v_mfma_f32_16x16x32_bf16 v[248:251], a[212:215], a[188:191], v[248:251]
  v_mfma_f32_16x16x32_bf16 v[232:235], a[212:215], a[180:183], v[232:235]
  v_mfma_f32_16x16x32_bf16 v[232:235], a[208:211], a[176:179], v[232:235]
  buffer_load_dwordx4 v24, s[4:7], s34 offen offset:2048  lds
  v_mfma_f32_16x16x32_bf16 v[216:219], a[208:211], a[168:171], v[216:219]
  v_mfma_f32_16x16x32_bf16 v[216:219], a[212:215], a[172:175], v[216:219]
  v_mfma_f32_16x16x32_bf16 v[200:203], a[212:215], a[164:167], v[200:203]
  buffer_load_dwordx4 v25, s[4:7], s35 offen offset:3072  lds
  v_mfma_f32_16x16x32_bf16 v[200:203], a[208:211], a[160:163], v[200:203]
  s_add_u32 m0, s96, 0x21000
  s_mov_b64 exec, 0
  s_cmp_eq_u32 s28, 0
  s_cbranch_scc1 L_pad9
  s_cmp_eq_u32 s28, 1
  s_cbranch_scc1 L_pad10
  s_cmp_eq_u32 s28, 2
  s_cbranch_scc1 L_pad11
  s_branch L_pad12
L_hr1:
  s_mov_b64 exec, -1
  v_mfma_f32_16x16x32_bf16 v[184:187], a[208:211], a[152:155], v[184:187]
  s_waitcnt vmcnt(13)
  s_barrier
  v_mfma_f32_16x16x32_bf16 v[184:187], a[212:215], a[156:159], v[184:187]
  buffer_load_dwordx4 v24, s[4:7], s36 offen offset:0  lds
  v_mfma_f32_16x16x32_bf16 v[168:171], a[212:215], a[148:151], v[168:171]
  ds_read_b64_tr_b16 a[192:193], v38 offset:49152
  v_mfma_f32_16x16x32_bf16 v[168:171], a[208:211], a[144:147], v[168:171]
  ds_read_b64_tr_b16 a[194:195], v38 offset:50176
  v_mfma_f32_16x16x32_bf16 v[152:155], a[208:211], a[136:139], v[152:155]
  buffer_load_dwordx4 v25, s[4:7], s37 offen offset:1024  lds
  v_mfma_f32_16x16x32_bf16 v[152:155], a[212:215], a[140:143], v[152:155]
  ds_read_b64_tr_b16 a[196:197], v38 offset:57344
  v_mfma_f32_16x16x32_bf16 v[136:139], a[212:215], a[132:135], v[136:139]
  ds_read_b64_tr_b16 a[198:199], v38 offset:58368
  v_mfma_f32_16x16x32_bf16 v[136:139], a[208:211], a[128:131], v[136:139]
  s_waitcnt lgkmcnt(6)
  buffer_load_dwordx4 v24, s[4:7], s38 offen offset:2048  lds
  v_mfma_f32_16x16x32_bf16 v[140:143], a[216:219], a[128:131], v[140:143]
  s_waitcnt lgkmcnt(4)
  v_mfma_f32_16x16x32_bf16 v[140:143], a[220:223], a[132:135], v[140:143]
  v_mfma_f32_16x16x32_bf16 v[156:159], a[220:223], a[140:143], v[156:159]
  buffer_load_dwordx4 v25, s[4:7], s39 offen offset:3072  lds
  v_mfma_f32_16x16x32_bf16 v[156:159], a[216:219], a[136:139], v[156:159]
  s_mov_b32 s76, 4096
  v_mfma_f32_16x16x32_bf16 v[172:175], a[216:219], a[144:147], v[172:175]
  v_mfma_f32_16x16x32_bf16 v[172:175], a[220:223], a[148:151], v[172:175]
  buffer_load_dwordx2 v[68:69], v18, s[52:55], s76 offen offset:0
  v_mfma_f32_16x16x32_bf16 v[188:191], a[220:223], a[156:159], v[188:191]
  ds_read_b64_tr_b16 a[200:201], v39 offset:49152
  v_mfma_f32_16x16x32_bf16 v[188:191], a[216:219], a[152:155], v[188:191]
  ds_read_b64_tr_b16 a[202:203], v39 offset:50176
  v_mfma_f32_16x16x32_bf16 v[204:207], a[216:219], a[160:163], v[204:207]
  buffer_load_dwordx2 v[70:71], v18, s[52:55], s76 offen offset:2048
  v_mfma_f32_16x16x32_bf16 v[204:207], a[220:223], a[164:167], v[204:207]
  s_mov_b32 s76, 8192
  ds_read_b64_tr_b16 a[204:205], v39 offset:57344
  v_mfma_f32_16x16x32_bf16 v[220:223], a[220:223], a[172:175], v[220:223]
  ds_read_b64_tr_b16 a[206:207], v39 offset:58368
  v_mfma_f32_16x16x32_bf16 v[220:223], a[216:219], a[168:171], v[220:223]
  buffer_load_dwordx2 v[72:73], v18, s[52:55], s76 offen offset:0
  v_mfma_f32_16x16x32_bf16 v[236:239], a[216:219], a[176:179], v[236:239]
  v_mfma_f32_16x16x32_bf16 v[236:239], a[220:223], a[180:183], v[236:239]
  v_mfma_f32_16x16x32_bf16 v[252:255], a[220:223], a[188:191], v[252:255]
  buffer_load_dwordx2 v[74:75], v18, s[52:55], s76 offen offset:2048
  v_mfma_f32_16x16x32_bf16 v[252:255], a[216:219], a[184:187], v[252:255]
  s_waitcnt lgkmcnt(6)
  s_mov_b32 s76, 12288
  v_mfma_f32_16x16x32_bf16 a[112:115], a[184:187], a[192:195], a[112:115]
  s_waitcnt lgkmcnt(4)
  v_mfma_f32_16x16x32_bf16 a[112:115], a[188:191], a[196:199], a[112:115]
  buffer_load_dwordx2 v[76:77], v18, s[52:55], s76 offen offset:0
  v_mfma_f32_16x16x32_bf16 a[96:99], a[180:183], a[196:199], a[96:99]
  s_add_u32 m0, s97, 0x14000
  v_mfma_f32_16x16x32_bf16 a[96:99], a[176:179], a[192:195], a[96:99]
  v_mfma_f32_16x16x32_bf16 a[80:83], a[168:171], a[192:195], a[80:83]
  buffer_load_dwordx4 v28, s[12:15], s48 offen offset:0  lds
  v_mfma_f32_16x16x32_bf16 a[80:83], a[172:175], a[196:199], a[80:83]
  v_mfma_f32_16x16x32_bf16 a[64:67], a[164:167], a[196:199], a[64:67]
  ds_read_b64_tr_b16 a[208:209], v40 offset:49152
  v_mfma_f32_16x16x32_bf16 a[64:67], a[160:163], a[192:195], a[64:67]
  ds_read_b64_tr_b16 a[210:211], v40 offset:50176
  v_mfma_f32_16x16x32_bf16 a[48:51], a[152:155], a[192:195], a[48:51]
  ds_read_b64_tr_b16 a[212:213], v40 offset:57344
  v_mfma_f32_16x16x32_bf16 a[48:51], a[156:159], a[196:199], a[48:51]
  ds_read_b64_tr_b16 a[214:215], v40 offset:58368
  v_mfma_f32_16x16x32_bf16 a[32:35], a[148:151], a[196:199], a[32:35]
  buffer_load_dwordx4 v28, s[12:15], s49 offen offset:1024  lds
  v_mfma_f32_16x16x32_bf16 a[32:35], a[144:147], a[192:195], a[32:35]
  v_mfma_f32_16x16x32_bf16 a[16:19], a[136:139], a[192:195], a[16:19]
  v_mfma_f32_16x16x32_bf16 a[16:19], a[140:143], a[196:199], a[16:19]
  v_mfma_f32_16x16x32_bf16 a[0:3], a[132:135], a[196:199], a[0:3]
  v_mfma_f32_16x16x32_bf16 a[0:3], a[128:131], a[192:195], a[0:3]
  s_waitcnt lgkmcnt(6)
  v_mfma_f32_16x16x32_bf16 a[4:7], a[128:131], a[200:203], a[4:7]
  s_waitcnt lgkmcnt(4)
  v_mfma_f32_16x16x32_bf16 a[4:7], a[132:135], a[204:207], a[4:7]
  buffer_load_dwordx4 v29, s[12:15], s50 offen offset:2048  lds
  v_mfma_f32_16x16x32_bf16 a[20:23], a[140:143], a[204:207], a[20:23]
  v_mfma_f32_16x16x32_bf16 a[20:23], a[136:139], a[200:203], a[20:23]
  v_mfma_f32_16x16x32_bf16 a[36:39], a[144:147], a[200:203], a[36:39]
  v_mfma_f32_16x16x32_bf16 a[36:39], a[148:151], a[204:207], a[36:39]
  v_mfma_f32_16x16x32_bf16 a[52:55], a[156:159], a[204:207], a[52:55]
  ds_read_b64_tr_b16 a[216:217], v41 offset:49152
  v_mfma_f32_16x16x32_bf16 a[52:55], a[152:155], a[200:203], a[52:55]
  ds_read_b64_tr_b16 a[218:219], v41 offset:50176
  v_mfma_f32_16x16x32_bf16 a[68:71], a[160:163], a[200:203], a[68:71]
  buffer_load_dwordx4 v29, s[12:15], s51 offen offset:3072  lds
  v_mfma_f32_16x16x32_bf16 a[68:71], a[164:167], a[204:207], a[68:71]
  ds_read_b64_tr_b16 a[220:221], v41 offset:57344
  v_mfma_f32_16x16x32_bf16 a[84:87], a[172:175], a[204:207], a[84:87]
  ds_read_b64_tr_b16 a[222:223], v41 offset:58368
  v_mfma_f32_16x16x32_bf16 a[84:87], a[168:171], a[200:203], a[84:87]
  v_mfma_f32_16x16x32_bf16 a[100:103], a[176:179], a[200:203], a[100:103]
  v_mfma_f32_16x16x32_bf16 a[100:103], a[180:183], a[204:207], a[100:103]
  v_mfma_f32_16x16x32_bf16 a[116:119], a[188:191], a[204:207], a[116:119]
  v_mfma_f32_16x16x32_bf16 a[116:119], a[184:187], a[200:203], a[116:119]
  s_waitcnt lgkmcnt(6)
  buffer_load_dwordx2 v[78:79], v18, s[52:55], s76 offen offset:2048
  v_mfma_f32_16x16x32_bf16 a[120:123], a[184:187], a[208:211], a[120:123]
  s_waitcnt lgkmcnt(4)
  s_mov_b32 s52, s80
  v_mfma_f32_16x16x32_bf16 a[120:123], a[188:191], a[212:215], a[120:123]
L_pad1:
  s_cbranch_execz L_pad5
  s_mov_b32 s53, s81
  v_mfma_f32_16x16x32_bf16 a[104:107], a[180:183], a[212:215], a[104:107]
  s_mov_b32 s54, 0x400000
  v_mfma_f32_16x16x32_bf16 a[104:107], a[176:179], a[208:211], a[104:107]
  s_mov_b32 s76, 0
  v_mfma_f32_16x16x32_bf16 a[88:91], a[168:171], a[208:211], a[88:91]
  buffer_load_dwordx2 v[80:81], v18, s[52:55], s76 offen offset:0
  v_mfma_f32_16x16x32_bf16 a[88:91], a[172:175], a[212:215], a[88:91]
  v_mfma_f32_16x16x32_bf16 a[72:75], a[164:167], a[212:215], a[72:75]
  v_mfma_f32_16x16x32_bf16 a[72:75], a[160:163], a[208:211], a[72:75]
  s_waitcnt vmcnt(11)
  buffer_load_dwordx2 v[82:83], v18, s[52:55], s76 offen offset:2048
  v_mfma_f32_16x16x32_bf16 a[56:59], a[152:155], a[208:211], a[56:59]
  s_barrier
  v_mfma_f32_16x16x32_bf16 a[56:59], a[156:159], a[212:215], a[56:59]
  ds_read_b64_tr_b16 a[192:193], v38 offset:0
  v_xor_b32 v28, 0x80000, v28
  v_mfma_f32_16x16x32_bf16 a[40:43], a[148:151], a[212:215], a[40:43]
  ds_read_b64_tr_b16 a[194:195], v38 offset:1024
  v_xor_b32 v29, 0x80000, v29
  v_mfma_f32_16x16x32_bf16 a[40:43], a[144:147], a[208:211], a[40:43]
  s_add_u32 m0, s97, 0x18000
  ds_read_b64_tr_b16 a[196:197], v38 offset:8192
  v_mfma_f32_16x16x32_bf16 a[24:27], a[136:139], a[208:211], a[24:27]
  buffer_load_dwordx4 v28, s[8:11], s48 offen offset:0  lds
  v_mfma_f32_16x16x32_bf16 a[24:27], a[140:143], a[212:215], a[24:27]
  ds_read_b64_tr_b16 a[198:199], v38 offset:9216
  v_mfma_f32_16x16x32_bf16 a[8:11], a[132:135], a[212:215], a[8:11]
  v_mfma_f32_16x16x32_bf16 a[8:11], a[128:131], a[208:211], a[8:11]
  s_waitcnt lgkmcnt(6)
  v_mfma_f32_16x16x32_bf16 a[12:15], a[128:131], a[216:219], a[12:15]
  s_waitcnt lgkmcnt(4)
  ds_read_b128 a[128:131], v32 offset:0
  v_mfma_f32_16x16x32_bf16 a[12:15], a[132:135], a[220:223], a[12:15]
  buffer_load_dwordx4 v28, s[8:11], s49 offen offset:1024  lds
  v_mfma_f32_16x16x32_bf16 a[28:31], a[140:143], a[220:223], a[28:31]
  ds_read_b128 a[132:135], v33 offset:0
  v_mfma_f32_16x16x32_bf16 a[28:31], a[136:139], a[216:219], a[28:31]
  ds_read_b128 a[140:143], v33 offset:2048
  v_mfma_f32_16x16x32_bf16 a[44:47], a[144:147], a[216:219], a[44:47]
  ds_read_b128 a[136:139], v32 offset:2048
  v_mfma_f32_16x16x32_bf16 a[44:47], a[148:151], a[220:223], a[44:47]
  ds_read_b128 a[144:147], v32 offset:4096
  v_mfma_f32_16x16x32_bf16 a[60:63], a[156:159], a[220:223], a[60:63]
  ds_read_b128 a[148:151], v33 offset:4096
  v_mfma_f32_16x16x32_bf16 a[60:63], a[152:155], a[216:219], a[60:63]
  ds_read_b128 a[156:159], v33 offset:6144
  v_mfma_f32_16x16x32_bf16 a[76:79], a[160:163], a[216:219], a[76:79]
  buffer_load_dwordx4 v29, s[8:11], s50 offen offset:2048  lds
  v_mfma_f32_16x16x32_bf16 a[76:79], a[164:167], a[220:223], a[76:79]
  ds_read_b128 a[152:155], v32 offset:6144
  v_mfma_f32_16x16x32_bf16 a[92:95], a[172:175], a[220:223], a[92:95]
  ds_read_b128 a[160:163], v32 offset:8192
  v_mfma_f32_16x16x32_bf16 a[92:95], a[168:171], a[216:219], a[92:95]
  ds_read_b128 a[164:167], v33 offset:8192
  v_mfma_f32_16x16x32_bf16 a[108:111], a[176:179], a[216:219], a[108:111]
  ds_read_b128 a[172:175], v33 offset:10240
  v_mfma_f32_16x16x32_bf16 a[108:111], a[180:183], a[220:223], a[108:111]
  ds_read_b128 a[168:171], v32 offset:10240
  v_mfma_f32_16x16x32_bf16 a[124:127], a[188:191], a[220:223], a[124:127]
  ds_read_b128 a[176:179], v32 offset:12288
  v_mfma_f32_16x16x32_bf16 a[124:127], a[184:187], a[216:219], a[124:127]
  s_waitcnt lgkmcnt(12)
  buffer_load_dwordx4 v29, s[8:11], s51 offen offset:3072  lds
  v_mfma_f32_16x16x32_bf16 v[128:131], a[192:195], a[128:131], v[128:131]
  s_waitcnt lgkmcnt(11)
  ds_read_b128 a[180:183], v33 offset:12288
  v_mfma_f32_16x16x32_bf16 v[128:131], a[196:199], a[132:135], v[128:131]
  s_waitcnt lgkmcnt(11)
  ds_read_b64_tr_b16 a[200:201], v39 offset:0
  v_mfma_f32_16x16x32_bf16 v[144:147], a[196:199], a[140:143], v[144:147]
  s_waitcnt lgkmcnt(11)
  ds_read_b128 a[188:191], v33 offset:14336
  v_mfma_f32_16x16x32_bf16 v[144:147], a[192:195], a[136:139], v[144:147]
  s_waitcnt lgkmcnt(11)
  s_mov_b32 s76, 4096
  ds_read_b64_tr_b16 a[202:203], v39 offset:1024
  v_mfma_f32_16x16x32_bf16 v[160:163], a[192:195], a[144:147], v[160:163]
  s_waitcnt lgkmcnt(11)
  ds_read_b128 a[184:187], v32 offset:14336
  v_mfma_f32_16x16x32_bf16 v[160:163], a[196:199], a[148:151], v[160:163]
  s_waitcnt lgkmcnt(11)
  ds_read_b64_tr_b16 a[204:205], v39 offset:8192
  v_mfma_f32_16x16x32_bf16 v[176:179], a[196:199], a[156:159], v[176:179]
  s_waitcnt lgkmcnt(11)
  buffer_load_dwordx2 v[84:85], v18, s[52:55], s76 offen offset:0
  v_mfma_f32_16x16x32_bf16 v[176:179], a[192:195], a[152:155], v[176:179]
  s_waitcnt lgkmcnt(10)
  ds_read_b64_tr_b16 a[206:207], v39 offset:9216
  v_mfma_f32_16x16x32_bf16 v[192:195], a[192:195], a[160:163], v[192:195]
  s_waitcnt lgkmcnt(10)
  ds_read_b64_tr_b16 a[208:209], v40 offset:0
  v_mfma_f32_16x16x32_bf16 v[192:195], a[196:199], a[164:167], v[192:195]
  s_waitcnt lgkmcnt(10)
  buffer_load_dwordx2 v[86:87], v18, s[52:55], s76 offen offset:2048
  v_mfma_f32_16x16x32_bf16 v[208:211], a[196:199], a[172:175], v[208:211]
  s_waitcnt lgkmcnt(9)
  ds_read_b64_tr_b16 a[210:211], v40 offset:1024
  v_xor_b32 v24, 0x80, v24
  v_mfma_f32_16x16x32_bf16 v[208:211], a[192:195], a[168:171], v[208:211]
  s_waitcnt lgkmcnt(9)
  ds_read_b64_tr_b16 a[212:213], v40 offset:8192
  v_xor_b32 v25, 0x80, v25
  v_mfma_f32_16x16x32_bf16 v[224:227], a[192:195], a[176:179], v[224:227]
  s_waitcnt lgkmcnt(9)
  s_add_u32 m0, s96, 0x0
  ds_read_b64_tr_b16 a[214:215], v40 offset:9216
  v_mfma_f32_16x16x32_bf16 v[224:227], a[196:199], a[180:183], v[224:227]
  s_waitcnt lgkmcnt(8)
  buffer_load_dwordx4 v24, s[4:7], s32 offen offset:0  lds
  v_mfma_f32_16x16x32_bf16 v[240:243], a[196:199], a[188:191], v[240:243]
  s_waitcnt lgkmcnt(6)
  v_mfma_f32_16x16x32_bf16 v[240:243], a[192:195], a[184:187], v[240:243]
  v_mfma_f32_16x16x32_bf16 v[244:247], a[200:203], a[184:187], v[244:247]
  s_waitcnt lgkmcnt(4)
  v_mfma_f32_16x16x32_bf16 v[244:247], a[204:207], a[188:191], v[244:247]
  v_mfma_f32_16x16x32_bf16 v[228:231], a[204:207], a[180:183], v[228:231]
  v_mfma_f32_16x16x32_bf16 v[228:231], a[200:203], a[176:179], v[228:231]
  v_mfma_f32_16x16x32_bf16 v[212:215], a[200:203], a[168:171], v[212:215]
  buffer_load_dwordx4 v25, s[4:7], s33 offen offset:1024  lds
  v_mfma_f32_16x16x32_bf16 v[212:215], a[204:207], a[172:175], v[212:215]
  v_mfma_f32_16x16x32_bf16 v[196:199], a[204:207], a[164:167], v[196:199]
  ds_read_b64_tr_b16 a[216:217], v41 offset:0
  v_mfma_f32_16x16x32_bf16 v[196:199], a[200:203], a[160:163], v[196:199]
  ds_read_b64_tr_b16 a[218:219], v41 offset:1024
  v_mfma_f32_16x16x32_bf16 v[180:183], a[200:203], a[152:155], v[180:183]
  ds_read_b64_tr_b16 a[220:221], v41 offset:8192
  v_mfma_f32_16x16x32_bf16 v[180:183], a[204:207], a[156:159], v[180:183]
  ds_read_b64_tr_b16 a[222:223], v41 offset:9216
  v_mfma_f32_16x16x32_bf16 v[164:167], a[204:207], a[148:151], v[164:167]
  v_mfma_f32_16x16x32_bf16 v[164:167], a[200:203], a[144:147], v[164:167]
  buffer_load_dwordx4 v24, s[4:7], s34 offen offset:2048  lds
  v_mfma_f32_16x16x32_bf16 v[148:151], a[200:203], a[136:139], v[148:151]
  v_mfma_f32_16x16x32_bf16 v[148:151], a[204:207], a[140:143], v[148:151]
  v_mfma_f32_16x16x32_bf16 v[132:135], a[204:207], a[132:135], v[132:135]
  v_mfma_f32_16x16x32_bf16 v[132:135], a[200:203], a[128:131], v[132:135]
  s_waitcnt lgkmcnt(6)
  v_mfma_f32_16x16x32_bf16 v[136:139], a[208:211], a[128:131], v[136:139]
  s_waitcnt lgkmcnt(4)
  v_mfma_f32_16x16x32_bf16 v[136:139], a[212:215], a[132:135], v[136:139]
  v_mfma_f32_16x16x32_bf16 v[152:155], a[212:215], a[140:143], v[152:155]
  buffer_load_dwordx4 v25, s[4:7], s35 offen offset:3072  lds
  v_mfma_f32_16x16x32_bf16 v[152:155], a[208:211], a[136:139], v[152:155]
  s_add_u32 m0, s96, 0x1000
  v_mfma_f32_16x16x32_bf16 v[168:171], a[208:211], a[144:147], v[168:171]
  v_mfma_f32_16x16x32_bf16 v[168:171], a[212:215], a[148:151], v[168:171]
  buffer_load_dwordx4 v24, s[4:7], s36 offen offset:0  lds
  v_mfma_f32_16x16x32_bf16 v[184:187], a[212:215], a[156:159], v[184:187]
  v_mfma_f32_16x16x32_bf16 v[184:187], a[208:211], a[152:155], v[184:187]
  s_waitcnt vmcnt(14)
  v_mfma_f32_16x16x32_bf16 v[200:203], a[208:211], a[160:163], v[200:203]
  s_barrier
  v_mfma_f32_16x16x32_bf16 v[200:203], a[212:215], a[164:167], v[200:203]
  buffer_load_dwordx4 v25, s[4:7], s37 offen offset:1024  lds
  v_mfma_f32_16x16x32_bf16 v[216:219], a[212:215], a[172:175], v[216:219]
  ds_read_b64_tr_b16 a[192:193], v38 offset:16384
  v_mfma_f32_16x16x32_bf16 v[216:219], a[208:211], a[168:171], v[216:219]
  ds_read_b64_tr_b16 a[194:195], v38 offset:17408
  v_mfma_f32_16x16x32_bf16 v[232:235], a[208:211], a[176:179], v[232:235]
  buffer_load_dwordx4 v24, s[4:7], s38 offen offset:2048  lds
  v_mfma_f32_16x16x32_bf16 v[232:235], a[212:215], a[180:183], v[232:235]
  ds_read_b64_tr_b16 a[196:197], v38 offset:24576
  v_mfma_f32_16x16x32_bf16 v[248:251], a[212:215], a[188:191], v[248:251]
  ds_read_b64_tr_b16 a[198:199], v38 offset:25600
  v_mfma_f32_16x16x32_bf16 v[248:251], a[208:211], a[184:187], v[248:251]
  s_waitcnt lgkmcnt(6)
  buffer_load_dwordx4 v25, s[4:7], s39 offen offset:3072  lds
  v_mfma_f32_16x16x32_bf16 v[252:255], a[216:219], a[184:187], v[252:255]
  s_waitcnt lgkmcnt(4)
  s_mov_b32 s76, 8192
  v_mfma_f32_16x16x32_bf16 v[252:255], a[220:223], a[188:191], v[252:255]
  v_mfma_f32_16x16x32_bf16 v[236:239], a[220:223], a[180:183], v[236:239]
  buffer_load_dwordx2 v[88:89], v18, s[52:55], s76 offen offset:0
  v_mfma_f32_16x16x32_bf16 v[236:239], a[216:219], a[176:179], v[236:239]
  v_mfma_f32_16x16x32_bf16 v[220:223], a[216:219], a[168:171], v[220:223]
  v_mfma_f32_16x16x32_bf16 v[220:223], a[220:223], a[172:175], v[220:223]
  buffer_load_dwordx2 v[90:91], v18, s[52:55], s76 offen offset:2048
  v_mfma_f32_16x16x32_bf16 v[204:207], a[220:223], a[164:167], v[204:207]
  s_mov_b32 s76, 12288
  ds_read_b64_tr_b16 a[200:201], v39 offset:16384
  v_mfma_f32_16x16x32_bf16 v[204:207], a[216:219], a[160:163], v[204:207]
  ds_read_b64_tr_b16 a[202:203], v39 offset:17408
  v_mfma_f32_16x16x32_bf16 v[188:191], a[216:219], a[152:155], v[188:191]
  buffer_load_dwordx2 v[92:93], v18, s[52:55], s76 offen offset:0
  v_mfma_f32_16x16x32_bf16 v[188:191], a[220:223], a[156:159], v[188:191]
  ds_read_b64_tr_b16 a[204:205], v39 offset:24576
  v_mfma_f32_16x16x32_bf16 v[172:175], a[220:223], a[148:151], v[172:175]
  ds_read_b64_tr_b16 a[206:207], v39 offset:25600
  v_mfma_f32_16x16x32_bf16 v[172:175], a[216:219], a[144:147], v[172:175]
  buffer_load_dwordx2 v[94:95], v18, s[52:55], s76 offen offset:2048
  v_mfma_f32_16x16x32_bf16 v[156:159], a[216:219], a[136:139], v[156:159]
  s_mov_b32 s52, s82
  v_mfma_f32_16x16x32_bf16 v[156:159], a[220:223], a[140:143], v[156:159]
  s_mov_b32 s53, s83
  v_mfma_f32_16x16x32_bf16 v[140:143], a[220:223], a[132:135], v[140:143]
  s_mov_b32 s54, 0x2000
  v_mfma_f32_16x16x32_bf16 v[140:143], a[216:219], a[128:131], v[140:143]
  s_waitcnt lgkmcnt(6)
  buffer_load_dwordx4 v[50:53], v19, s[52:55], 0 offen offset:0
  v_mfma_f32_16x16x32_bf16 a[0:3], a[128:131], a[192:195], a[0:3]
  s_waitcnt lgkmcnt(4)
  s_add_u32 m0, s97, 0x1c000
  v_mfma_f32_16x16x32_bf16 a[0:3], a[132:135], a[196:199], a[0:3]
  v_mfma_f32_16x16x32_bf16 a[16:19], a[140:143], a[196:199], a[16:19]
  buffer_load_dwordx4 v28, s[12:15], s48 offen offset:0  lds
  v_mfma_f32_16x16x32_bf16 a[16:19], a[136:139], a[192:195], a[16:19]
  v_mfma_f32_16x16x32_bf16 a[32:35], a[144:147], a[192:195], a[32:35]
  v_mfma_f32_16x16x32_bf16 a[32:35], a[148:151], a[196:199], a[32:35]
  buffer_load_dwordx4 v28, s[12:15], s49 offen offset:1024  lds
  v_mfma_f32_16x16x32_bf16 a[48:51], a[156:159], a[196:199], a[48:51]
  ds_read_b64_tr_b16 a[208:209], v40 offset:16384
  v_mfma_f32_16x16x32_bf16 a[48:51], a[152:155], a[192:195], a[48:51]
  ds_read_b64_tr_b16 a[210:211], v40 offset:17408
  v_mfma_f32_16x16x32_bf16 a[64:67], a[160:163], a[192:195], a[64:67]
  ds_read_b64_tr_b16 a[212:213], v40 offset:24576
  v_mfma_f32_16x16x32_bf16 a[64:67], a[164:167], a[196:199], a[64:67]
  ds_read_b64_tr_b16 a[214:215], v40 offset:25600
  v_mfma_f32_16x16x32_bf16 a[80:83], a[172:175], a[196:199], a[80:83]
  v_mfma_f32_16x16x32_bf16 a[80:83], a[168:171], a[192:195], a[80:83]
  v_mfma_f32_16x16x32_bf16 a[96:99], a[176:179], a[192:195], a[96:99]
  buffer_load_dwordx4 v29, s[12:15], s50 offen offset:2048  lds
  v_mfma_f32_16x16x32_bf16 a[96:99], a[180:183], a[196:199], a[96:99]
  v_mfma_f32_16x16x32_bf16 a[112:115], a[188:191], a[196:199], a[112:115]
  v_mfma_f32_16x16x32_bf16 a[112:115], a[184:187], a[192:195], a[112:115]
  s_waitcnt lgkmcnt(6)
  v_mfma_f32_16x16x32_bf16 a[116:119], a[184:187], a[200:203], a[116:119]
  s_waitcnt lgkmcnt(4)
  v_mfma_f32_16x16x32_bf16 a[116:119], a[188:191], a[204:207], a[116:119]
  v_mfma_f32_16x16x32_bf16 a[100:103], a[180:183], a[204:207], a[100:103]
  v_mfma_f32_16x16x32_bf16 a[100:103], a[176:179], a[200:203], a[100:103]
  buffer_load_dwordx4 v29, s[12:15], s51 offen offset:3072  lds
  v_mfma_f32_16x16x32_bf16 a[84:87], a[168:171], a[200:203], a[84:87]
  v_mfma_f32_16x16x32_bf16 a[84:87], a[172:175], a[204:207], a[84:87]
  v_mfma_f32_16x16x32_bf16 a[68:71], a[164:167], a[204:207], a[68:71]
  ds_read_b64_tr_b16 a[216:217], v41 offset:16384
  v_mfma_f32_16x16x32_bf16 a[68:71], a[160:163], a[200:203], a[68:71]
  ds_read_b64_tr_b16 a[218:219], v41 offset:17408
  v_mfma_f32_16x16x32_bf16 a[52:55], a[152:155], a[200:203], a[52:55]
  ds_read_b64_tr_b16 a[220:221], v41 offset:24576
  v_mfma_f32_16x16x32_bf16 a[52:55], a[156:159], a[204:207], a[52:55]
  ds_read_b64_tr_b16 a[222:223], v41 offset:25600
  v_mfma_f32_16x16x32_bf16 a[36:39], a[148:151], a[204:207], a[36:39]
  buffer_load_dwordx4 v[54:57], v19, s[52:55], 0 offen offset:16
  v_mfma_f32_16x16x32_bf16 a[36:39], a[144:147], a[200:203], a[36:39]
  s_mov_b32 s52, s92
  v_mfma_f32_16x16x32_bf16 a[20:23], a[136:139], a[200:203], a[20:23]
  s_mov_b32 s53, s93
  v_mfma_f32_16x16x32_bf16 a[20:23], a[140:143], a[204:207], a[20:23]
  s_mov_b32 s54, 0x100
  v_mfma_f32_16x16x32_bf16 a[4:7], a[132:135], a[204:207], a[4:7]
  s_lshl_b32 s76, s29, 2
  v_mfma_f32_16x16x32_bf16 a[4:7], a[128:131], a[200:203], a[4:7]
  s_waitcnt lgkmcnt(6)
  s_cmp_eq_u32 s30, 7
  s_cselect_b32 s76, s76, 0x1000
  v_mfma_f32_16x16x32_bf16 a[8:11], a[128:131], a[208:211], a[8:11]
  s_waitcnt lgkmcnt(4)
  buffer_store_dword v9, v8, s[52:55], s76 offen sc1
  v_mfma_f32_16x16x32_bf16 a[8:11], a[132:135], a[212:215], a[8:11]
  v_xor_b32 v24, 0x380, v24
  v_mfma_f32_16x16x32_bf16 a[24:27], a[140:143], a[212:215], a[24:27]
  v_xor_b32 v25, 0x380, v25
  v_mfma_f32_16x16x32_bf16 a[24:27], a[136:139], a[208:211], a[24:27]
  s_add_u32 m0, s96, 0x8000
  v_mfma_f32_16x16x32_bf16 a[40:43], a[144:147], a[208:211], a[40:43]
  buffer_load_dwordx4 v24, s[4:7], s32 offen offset:0  lds
  v_mfma_f32_16x16x32_bf16 a[40:43], a[148:151], a[212:215], a[40:43]
  v_mfma_f32_16x16x32_bf16 a[56:59], a[156:159], a[212:215], a[56:59]
  v_mfma_f32_16x16x32_bf16 a[56:59], a[152:155], a[208:211], a[56:59]
  s_waitcnt vmcnt(12)
  buffer_load_dwordx4 v25, s[4:7], s33 offen offset:1024  lds
  v_mfma_f32_16x16x32_bf16 a[72:75], a[160:163], a[208:211], a[72:75]
  s_barrier
  v_mfma_f32_16x16x32_bf16 a[72:75], a[164:167], a[212:215], a[72:75]
  ds_read_b64_tr_b16 a[192:193], v38 offset:32768
  v_mfma_f32_16x16x32_bf16 a[88:91], a[172:175], a[212:215], a[88:91]
  ds_read_b64_tr_b16 a[194:195], v38 offset:33792
  v_mfma_f32_16x16x32_bf16 a[88:91], a[168:171], a[208:211], a[88:91]
  buffer_load_dwordx4 v24, s[4:7], s34 offen offset:2048  lds
  v_mfma_f32_16x16x32_bf16 a[104:107], a[176:179], a[208:211], a[104:107]
  ds_read_b64_tr_b16 a[196:197], v38 offset:40960
  v_mfma_f32_16x16x32_bf16 a[104:107], a[180:183], a[212:215], a[104:107]
  ds_read_b64_tr_b16 a[198:199], v38 offset:41984
  v_mfma_f32_16x16x32_bf16 a[120:123], a[188:191], a[212:215], a[120:123]
  v_mfma_f32_16x16x32_bf16 a[120:123], a[184:187], a[208:211], a[120:123]
  s_waitcnt lgkmcnt(6)
  v_mfma_f32_16x16x32_bf16 a[124:127], a[184:187], a[216:219], a[124:127]
  s_waitcnt lgkmcnt(4)
  ds_read_b128 a[184:187], v30 offset:14336
  v_mfma_f32_16x16x32_bf16 a[124:127], a[188:191], a[220:223], a[124:127]
  ds_read_b128 a[188:191], v31 offset:14336
  v_mfma_f32_16x16x32_bf16 a[108:111], a[180:183], a[220:223], a[108:111]
  buffer_load_dwordx4 v25, s[4:7], s35 offen offset:3072  lds
  v_mfma_f32_16x16x32_bf16 a[108:111], a[176:179], a[216:219], a[108:111]
  ds_read_b128 a[180:183], v31 offset:12288
  v_mfma_f32_16x16x32_bf16 a[92:95], a[168:171], a[216:219], a[92:95]
  ds_read_b128 a[176:179], v30 offset:12288
  v_xor_b32 v28, 0x380000, v28
  v_mfma_f32_16x16x32_bf16 a[92:95], a[172:175], a[220:223], a[92:95]
  ds_read_b128 a[168:171], v30 offset:10240
  v_xor_b32 v29, 0x380000, v29
  v_mfma_f32_16x16x32_bf16 a[76:79], a[164:167], a[220:223], a[76:79]
  s_add_u32 m0, s97, 0x10000
  ds_read_b128 a[172:175], v31 offset:10240
  v_mfma_f32_16x16x32_bf16 a[76:79], a[160:163], a[216:219], a[76:79]
  ds_read_b128 a[164:167], v31 offset:8192
  v_mfma_f32_16x16x32_bf16 a[60:63], a[152:155], a[216:219], a[60:63]
  ds_read_b128 a[160:163], v30 offset:8192
  v_mfma_f32_16x16x32_bf16 a[60:63], a[156:159], a[220:223], a[60:63]
  buffer_load_dwordx4 v28, s[8:11], s48 offen offset:0  lds
  v_mfma_f32_16x16x32_bf16 a[44:47], a[148:151], a[220:223], a[44:47]
  ds_read_b128 a[152:155], v30 offset:6144
  v_mfma_f32_16x16x32_bf16 a[44:47], a[144:147], a[216:219], a[44:47]
  ds_read_b128 a[156:159], v31 offset:6144
  v_mfma_f32_16x16x32_bf16 a[28:31], a[136:139], a[216:219], a[28:31]
  ds_read_b128 a[148:151], v31 offset:4096
  v_mfma_f32_16x16x32_bf16 a[28:31], a[140:143], a[220:223], a[28:31]
  ds_read_b128 a[144:147], v30 offset:4096
  v_mfma_f32_16x16x32_bf16 a[12:15], a[132:135], a[220:223], a[12:15]
  ds_read_b128 a[136:139], v30 offset:2048
  v_mfma_f32_16x16x32_bf16 a[12:15], a[128:131], a[216:219], a[12:15]
  s_waitcnt lgkmcnt(12)
  ds_read_b128 a[140:143], v31 offset:2048
  v_mfma_f32_16x16x32_bf16 v[240:243], a[192:195], a[184:187], v[240:243]
  s_waitcnt lgkmcnt(12)
  buffer_load_dwordx4 v28, s[8:11], s49 offen offset:1024  lds
  v_mfma_f32_16x16x32_bf16 v[240:243], a[196:199], a[188:191], v[240:243]
  s_waitcnt lgkmcnt(11)
  ds_read_b64_tr_b16 a[200:201], v39 offset:32768
  v_mfma_f32_16x16x32_bf16 v[224:227], a[196:199], a[180:183], v[224:227]
  s_waitcnt lgkmcnt(11)
  ds_read_b128 a[132:135], v31 offset:0
  v_mfma_f32_16x16x32_bf16 v[224:227], a[192:195], a[176:179], v[224:227]
  s_waitcnt lgkmcnt(11)
  ds_read_b64_tr_b16 a[202:203], v39 offset:33792
  v_mfma_f32_16x16x32_bf16 v[208:211], a[192:195], a[168:171], v[208:211]
  s_waitcnt lgkmcnt(11)
  ds_read_b128 a[128:131], v30 offset:0
  v_mfma_f32_16x16x32_bf16 v[208:211], a[196:199], a[172:175], v[208:211]
  s_waitcnt lgkmcnt(11)
  ds_read_b64_tr_b16 a[204:205], v39 offset:40960
  v_mfma_f32_16x16x32_bf16 v[192:195], a[196:199], a[164:167], v[192:195]
  s_waitcnt lgkmcnt(11)
  ds_read_b64_tr_b16 a[206:207], v39 offset:41984
  v_mfma_f32_16x16x32_bf16 v[192:195], a[192:195], a[160:163], v[192:195]
  s_waitcnt lgkmcnt(11)
  buffer_load_dwordx4 v29, s[8:11], s50 offen offset:2048  lds
  v_mfma_f32_16x16x32_bf16 v[176:179], a[192:195], a[152:155], v[176:179]
  s_waitcnt lgkmcnt(10)
  ds_read_b64_tr_b16 a[208:209], v40 offset:32768
  v_mfma_f32_16x16x32_bf16 v[176:179], a[196:199], a[156:159], v[176:179]
  s_waitcnt lgkmcnt(10)
  ds_read_b64_tr_b16 a[210:211], v40 offset:33792
  v_mfma_f32_16x16x32_bf16 v[160:163], a[196:199], a[148:151], v[160:163]
  s_waitcnt lgkmcnt(10)
  ds_read_b64_tr_b16 a[212:213], v40 offset:40960
  v_mfma_f32_16x16x32_bf16 v[160:163], a[192:195], a[144:147], v[160:163]
  s_waitcnt lgkmcnt(10)
  ds_read_b64_tr_b16 a[214:215], v40 offset:41984
  v_mfma_f32_16x16x32_bf16 v[144:147], a[192:195], a[136:139], v[144:147]
  s_waitcnt lgkmcnt(10)
  v_mfma_f32_16x16x32_bf16 v[144:147], a[196:199], a[140:143], v[144:147]
  s_waitcnt lgkmcnt(8)
  v_mfma_f32_16x16x32_bf16 v[128:131], a[196:199], a[132:135], v[128:131]
  s_waitcnt lgkmcnt(6)
  buffer_load_dwordx4 v29, s[8:11], s51 offen offset:3072  lds
  v_mfma_f32_16x16x32_bf16 v[128:131], a[192:195], a[128:131], v[128:131]
  v_mfma_f32_16x16x32_bf16 v[132:135], a[200:203], a[128:131], v[132:135]
  s_waitcnt lgkmcnt(4)
  v_mfma_f32_16x16x32_bf16 v[132:135], a[204:207], a[132:135], v[132:135]
  v_mfma_f32_16x16x32_bf16 v[148:151], a[204:207], a[140:143], v[148:151]
  s_add_u32 m0, s96, 0x9000
  v_mfma_f32_16x16x32_bf16 v[148:151], a[200:203], a[136:139], v[148:151]
  v_mfma_f32_16x16x32_bf16 v[164:167], a[200:203], a[144:147], v[164:167]
  v_mfma_f32_16x16x32_bf16 v[164:167], a[204:207], a[148:151], v[164:167]
  buffer_load_dwordx4 v24, s[4:7], s36 offen offset:0  lds
  v_mfma_f32_16x16x32_bf16 v[180:183], a[204:207], a[156:159], v[180:183]
  s_waitcnt vmcnt(15)
  ds_read_b64_tr_b16 a[216:217], v41 offset:32768
  v_lshlrev_b32 v98, 16, v50
  v_mfma_f32_16x16x32_bf16 v[180:183], a[200:203], a[152:155], v[180:183]
  ds_read_b64_tr_b16 a[218:219], v41 offset:33792
  v_and_b32 v99, s101, v50
  v_mfma_f32_16x16x32_bf16 v[196:199], a[200:203], a[160:163], v[196:199]
  ds_read_b64_tr_b16 a[220:221], v41 offset:40960
  v_lshlrev_b32 v100, 16, v51
  v_mfma_f32_16x16x32_bf16 v[196:199], a[204:207], a[164:167], v[196:199]
  ds_read_b64_tr_b16 a[222:223], v41 offset:41984
  v_and_b32 v101, s101, v51
  v_mfma_f32_16x16x32_bf16 v[212:215], a[204:207], a[172:175], v[212:215]
  v_lshlrev_b32 v104, 16, v58
  v_lshlrev_b32 v105, 16, v60
  v_mfma_f32_16x16x32_bf16 v[212:215], a[200:203], a[168:171], v[212:215]
  v_lshlrev_b32 v106, 16, v62
  v_lshlrev_b32 v107, 16, v64
  v_mfma_f32_16x16x32_bf16 v[228:231], a[200:203], a[176:179], v[228:231]
  buffer_load_dwordx4 v25, s[4:7], s37 offen offset:1024  lds
  v_mfma_f32_16x16x32_bf16 v[228:231], a[204:207], a[180:183], v[228:231]
  v_lshlrev_b32 v108, 16, v66
  v_lshlrev_b32 v109, 16, v68
  v_mfma_f32_16x16x32_bf16 v[244:247], a[204:207], a[188:191], v[244:247]
  v_lshlrev_b32 v110, 16, v70
  v_lshlrev_b32 v111, 16, v72
  v_mfma_f32_16x16x32_bf16 v[244:247], a[200:203], a[184:187], v[244:247]
  s_waitcnt lgkmcnt(6)
  v_lshlrev_b32 v112, 16, v74
  v_lshlrev_b32 v113, 16, v76
  v_mfma_f32_16x16x32_bf16 v[248:251], a[208:211], a[184:187], v[248:251]
  s_waitcnt lgkmcnt(4)
  v_lshlrev_b32 v114, 16, v78
  v_mul_f32 v115, v101, v104
  v_mfma_f32_16x16x32_bf16 v[248:251], a[212:215], a[188:191], v[248:251]
  v_mul_f32 v116, v101, v105
  v_mul_f32 v117, v101, v106
  v_mfma_f32_16x16x32_bf16 v[232:235], a[212:215], a[180:183], v[232:235]
  v_mul_f32 v118, v101, v107
  v_mul_f32 v119, v101, v108
  v_mfma_f32_16x16x32_bf16 v[232:235], a[208:211], a[176:179], v[232:235]
  buffer_load_dwordx4 v24, s[4:7], s38 offen offset:2048  lds
  v_mfma_f32_16x16x32_bf16 v[216:219], a[208:211], a[168:171], v[216:219]
  v_mul_f32 v120, v101, v109
  v_mul_f32 v121, v101, v110
  v_mfma_f32_16x16x32_bf16 v[216:219], a[212:215], a[172:175], v[216:219]
  v_mul_f32 v122, v101, v111
  v_fmac_f32 v115, v100, v105
  v_mfma_f32_16x16x32_bf16 v[200:203], a[212:215], a[164:167], v[200:203]
  v_fmac_f32 v116, v100, v106
  v_fmac_f32 v117, v100, v107
  v_mfma_f32_16x16x32_bf16 v[200:203], a[208:211], a[160:163], v[200:203]
  s_waitcnt vmcnt(13)
  v_fmac_f32 v118, v100, v108
  v_fmac_f32 v119, v100, v109
  v_mfma_f32_16x16x32_bf16 v[184:187], a[208:211], a[152:155], v[184:187]
  s_barrier
  v_mfma_f32_16x16x32_bf16 v[184:187], a[212:215], a[156:159], v[184:187]
  ds_read_b64_tr_b16 a[192:193], v38 offset:49152
  v_fmac_f32 v120, v100, v110
  v_mfma_f32_16x16x32_bf16 v[168:171], a[212:215], a[148:151], v[168:171]
  buffer_load_dwordx4 v25, s[4:7], s39 offen offset:3072  lds
  v_mfma_f32_16x16x32_bf16 v[168:171], a[208:211], a[144:147], v[168:171]
  ds_read_b64_tr_b16 a[194:195], v38 offset:50176
  v_fmac_f32 v121, v100, v111
  v_mfma_f32_16x16x32_bf16 v[152:155], a[208:211], a[136:139], v[152:155]
  ds_read_b64_tr_b16 a[196:197], v38 offset:57344
  v_fmac_f32 v122, v100, v112
  v_mfma_f32_16x16x32_bf16 v[152:155], a[212:215], a[140:143], v[152:155]
  ds_read_b64_tr_b16 a[198:199], v38 offset:58368
  v_fmac_f32 v115, v99, v106
  v_mfma_f32_16x16x32_bf16 v[136:139], a[212:215], a[132:135], v[136:139]
  s_add_u32 m0, s97, 0x14000
  v_fmac_f32 v116, v99, v107
  v_fmac_f32 v117, v99, v108
  v_mfma_f32_16x16x32_bf16 v[136:139], a[208:211], a[128:131], v[136:139]
  s_waitcnt lgkmcnt(6)
  v_fmac_f32 v118, v99, v109
  v_fmac_f32 v119, v99, v110
  v_mfma_f32_16x16x32_bf16 v[140:143], a[216:219], a[128:131], v[140:143]
  s_waitcnt lgkmcnt(4)
  v_fmac_f32 v120, v99, v111
  v_fmac_f32 v121, v99, v112
  v_mfma_f32_16x16x32_bf16 v[140:143], a[220:223], a[132:135], v[140:143]
  buffer_load_dwordx4 v28, s[12:15], s48 offen offset:0  lds
  v_mfma_f32_16x16x32_bf16 v[156:159], a[220:223], a[140:143], v[156:159]
  v_fmac_f32 v122, v99, v113
  v_fmac_f32 v115, v98, v107
  v_mfma_f32_16x16x32_bf16 v[156:159], a[216:219], a[136:139], v[156:159]
  v_fmac_f32 v116, v98, v108
  v_fmac_f32 v117, v98, v109
  v_mfma_f32_16x16x32_bf16 v[172:175], a[216:219], a[144:147], v[172:175]
  v_fmac_f32 v118, v98, v110
  v_fmac_f32 v119, v98, v111
  v_mfma_f32_16x16x32_bf16 v[172:175], a[220:223], a[148:151], v[172:175]
  v_fmac_f32 v120, v98, v112
  v_fmac_f32 v121, v98, v113
  v_mfma_f32_16x16x32_bf16 v[188:191], a[220:223], a[156:159], v[188:191]
  ds_read_b64_tr_b16 a[200:201], v39 offset:49152
  v_fmac_f32 v122, v98, v114
  v_mfma_f32_16x16x32_bf16 v[188:191], a[216:219], a[152:155], v[188:191]
  ds_read_b64_tr_b16 a[202:203], v39 offset:50176
  v_lshlrev_b32 v104, 16, v80
  v_mfma_f32_16x16x32_bf16 v[204:207], a[216:219], a[160:163], v[204:207]
  buffer_load_dwordx4 v28, s[12:15], s49 offen offset:1024  lds
  v_mfma_f32_16x16x32_bf16 v[204:207], a[220:223], a[164:167], v[204:207]
  ds_read_b64_tr_b16 a[204:205], v39 offset:57344
  v_lshlrev_b32 v105, 16, v82
  v_mfma_f32_16x16x32_bf16 v[220:223], a[220:223], a[172:175], v[220:223]
  ds_read_b64_tr_b16 a[206:207], v39 offset:58368
  v_lshlrev_b32 v106, 16, v84
  v_mfma_f32_16x16x32_bf16 v[220:223], a[216:219], a[168:171], v[220:223]
  v_lshlrev_b32 v107, 16, v86
  v_lshlrev_b32 v108, 16, v88
  v_mfma_f32_16x16x32_bf16 v[236:239], a[216:219], a[176:179], v[236:239]
  v_lshlrev_b32 v109, 16, v90
  v_lshlrev_b32 v110, 16, v92
  v_mfma_f32_16x16x32_bf16 v[236:239], a[220:223], a[180:183], v[236:239]
  v_lshlrev_b32 v111, 16, v94
  v_mul_f32 v115, v115, v104
  v_mfma_f32_16x16x32_bf16 v[252:255], a[220:223], a[188:191], v[252:255]
  v_mul_f32 v116, v116, v105
  v_mul_f32 v117, v117, v106
  v_mfma_f32_16x16x32_bf16 v[252:255], a[216:219], a[184:187], v[252:255]
  s_waitcnt lgkmcnt(6)
  buffer_load_dwordx4 v29, s[12:15], s50 offen offset:2048  lds
  v_mfma_f32_16x16x32_bf16 a[112:115], a[184:187], a[192:195], a[112:115]
  s_waitcnt lgkmcnt(4)
  v_mul_f32 v118, v118, v107
  v_mul_f32 v119, v119, v108
  v_mfma_f32_16x16x32_bf16 a[112:115], a[188:191], a[196:199], a[112:115]
  v_mul_f32 v120, v120, v109
  v_mul_f32 v121, v121, v110
  v_mfma_f32_16x16x32_bf16 a[96:99], a[180:183], a[196:199], a[96:99]
  v_mul_f32 v122, v122, v111
  v_cvt_pk_bf16_f32 v124, v122, v121
  v_mfma_f32_16x16x32_bf16 a[96:99], a[176:179], a[192:195], a[96:99]
  v_cvt_pk_bf16_f32 v125, v120, v119
  v_cvt_pk_bf16_f32 v126, v118, v117
  v_mfma_f32_16x16x32_bf16 a[80:83], a[168:171], a[192:195], a[80:83]
  v_cvt_pk_bf16_f32 v127, v116, v115
  v_accvgpr_write_b32 a224, v124
  v_mfma_f32_16x16x32_bf16 a[80:83], a[172:175], a[196:199], a[80:83]
  v_accvgpr_write_b32 a225, v125
  v_accvgpr_write_b32 a226, v126
  v_mfma_f32_16x16x32_bf16 a[64:67], a[164:167], a[196:199], a[64:67]
  buffer_load_dwordx4 v29, s[12:15], s51 offen offset:3072  lds
  v_mfma_f32_16x16x32_bf16 a[64:67], a[160:163], a[192:195], a[64:67]
  ds_read_b64_tr_b16 a[208:209], v40 offset:49152
  v_accvgpr_write_b32 a227, v127
  v_mfma_f32_16x16x32_bf16 a[48:51], a[152:155], a[192:195], a[48:51]
  ds_read_b64_tr_b16 a[210:211], v40 offset:50176
  v_xor_b32 v24, 0x80, v24
  v_mfma_f32_16x16x32_bf16 a[48:51], a[156:159], a[196:199], a[48:51]
  ds_read_b64_tr_b16 a[212:213], v40 offset:57344
  v_xor_b32 v25, 0x80, v25
  v_mfma_f32_16x16x32_bf16 a[32:35], a[148:151], a[196:199], a[32:35]
  s_add_u32 m0, s96, 0x20000
  ds_read_b64_tr_b16 a[214:215], v40 offset:58368
  v_mfma_f32_16x16x32_bf16 a[32:35], a[144:147], a[192:195], a[32:35]
  v_lshlrev_b32 v98, 16, v52
  v_and_b32 v99, s101, v52
  v_mfma_f32_16x16x32_bf16 a[16:19], a[136:139], a[192:195], a[16:19]
  v_lshlrev_b32 v100, 16, v53
  v_and_b32 v101, s101, v53
  v_mfma_f32_16x16x32_bf16 a[16:19], a[140:143], a[196:199], a[16:19]
  buffer_load_dwordx4 v24, s[4:7], s32 offen offset:0  lds
  v_mfma_f32_16x16x32_bf16 a[0:3], a[132:135], a[196:199], a[0:3]
  v_and_b32 v104, s101, v58
  v_and_b32 v105, s101, v60
  v_mfma_f32_16x16x32_bf16 a[0:3], a[128:131], a[192:195], a[0:3]
  s_waitcnt lgkmcnt(6)
  v_and_b32 v106, s101, v62
  v_and_b32 v107, s101, v64
  v_mfma_f32_16x16x32_bf16 a[4:7], a[128:131], a[200:203], a[4:7]
  s_waitcnt lgkmcnt(4)
  v_and_b32 v108, s101, v66
  v_and_b32 v109, s101, v68
  v_mfma_f32_16x16x32_bf16 a[4:7], a[132:135], a[204:207], a[4:7]
  v_and_b32 v110, s101, v70
  v_and_b32 v111, s101, v72
  v_mfma_f32_16x16x32_bf16 a[20:23], a[140:143], a[204:207], a[20:23]
  v_and_b32 v112, s101, v74
  v_and_b32 v113, s101, v76
  v_mfma_f32_16x16x32_bf16 a[20:23], a[136:139], a[200:203], a[20:23]
  v_and_b32 v114, s101, v78
  v_mul_f32 v115, v101, v104
  v_mfma_f32_16x16x32_bf16 a[36:39], a[144:147], a[200:203], a[36:39]
  buffer_load_dwordx4 v25, s[4:7], s33 offen offset:1024  lds
  v_mfma_f32_16x16x32_bf16 a[36:39], a[148:151], a[204:207], a[36:39]
  v_mul_f32 v116, v101, v105
  v_mul_f32 v117, v101, v106
  v_mfma_f32_16x16x32_bf16 a[52:55], a[156:159], a[204:207], a[52:55]
  ds_read_b64_tr_b16 a[216:217], v41 offset:49152
  v_mul_f32 v118, v101, v107
  v_mfma_f32_16x16x32_bf16 a[52:55], a[152:155], a[200:203], a[52:55]
  ds_read_b64_tr_b16 a[218:219], v41 offset:50176
  v_mul_f32 v119, v101, v108
  v_mfma_f32_16x16x32_bf16 a[68:71], a[160:163], a[200:203], a[68:71]
  ds_read_b64_tr_b16 a[220:221], v41 offset:57344
  v_mul_f32 v120, v101, v109
  v_mfma_f32_16x16x32_bf16 a[68:71], a[164:167], a[204:207], a[68:71]
  ds_read_b64_tr_b16 a[222:223], v41 offset:58368
  v_mul_f32 v121, v101, v110
  v_mfma_f32_16x16x32_bf16 a[84:87], a[172:175], a[204:207], a[84:87]
  v_mul_f32 v122, v101, v111
  v_fmac_f32 v115, v100, v105
  v_mfma_f32_16x16x32_bf16 a[84:87], a[168:171], a[200:203], a[84:87]
  buffer_load_dwordx4 v24, s[4:7], s34 offen offset:2048  lds
  v_mfma_f32_16x16x32_bf16 a[100:103], a[176:179], a[200:203], a[100:103]
  v_fmac_f32 v116, v100, v106
  v_fmac_f32 v117, v100, v107
  v_mfma_f32_16x16x32_bf16 a[100:103], a[180:183], a[204:207], a[100:103]
  v_fmac_f32 v118, v100, v108
  v_fmac_f32 v119, v100, v109
  v_mfma_f32_16x16x32_bf16 a[116:119], a[188:191], a[204:207], a[116:119]
  v_fmac_f32 v120, v100, v110
  v_fmac_f32 v121, v100, v111
  v_mfma_f32_16x16x32_bf16 a[116:119], a[184:187], a[200:203], a[116:119]
L_pad2:
  s_cbranch_execz L_pad6
  s_waitcnt lgkmcnt(6)
  v_fmac_f32 v122, v100, v112
  v_fmac_f32 v115, v99, v106
  v_mfma_f32_16x16x32_bf16 a[120:123], a[184:187], a[208:211], a[120:123]
  s_waitcnt lgkmcnt(4)
  v_fmac_f32 v116, v99, v107
  v_fmac_f32 v117, v99, v108
  v_mfma_f32_16x16x32_bf16 a[120:123], a[188:191], a[212:215], a[120:123]
  v_fmac_f32 v118, v99, v109
  v_fmac_f32 v119, v99, v110
  v_mfma_f32_16x16x32_bf16 a[104:107], a[180:183], a[212:215], a[104:107]
  buffer_load_dwordx4 v25, s[4:7], s35 offen offset:3072  lds
  v_mfma_f32_16x16x32_bf16 a[104:107], a[176:179], a[208:211], a[104:107]
  v_fmac_f32 v120, v99, v111
  v_fmac_f32 v121, v99, v112
  v_mfma_f32_16x16x32_bf16 a[88:91], a[168:171], a[208:211], a[88:91]
  v_fmac_f32 v122, v99, v113
  v_fmac_f32 v115, v98, v107
  v_mfma_f32_16x16x32_bf16 a[88:91], a[172:175], a[212:215], a[88:91]
  v_fmac_f32 v116, v98, v108
  v_fmac_f32 v117, v98, v109
  v_mfma_f32_16x16x32_bf16 a[72:75], a[164:167], a[212:215], a[72:75]
  v_fmac_f32 v118, v98, v110
  v_fmac_f32 v119, v98, v111
  v_mfma_f32_16x16x32_bf16 a[72:75], a[160:163], a[208:211], a[72:75]
  s_waitcnt vmcnt(8)
  v_fmac_f32 v120, v98, v112
  v_fmac_f32 v121, v98, v113
  v_mfma_f32_16x16x32_bf16 a[56:59], a[152:155], a[208:211], a[56:59]
  s_barrier
  v_mfma_f32_16x16x32_bf16 a[56:59], a[156:159], a[212:215], a[56:59]
  ds_read_b64_tr_b16 a[192:193], v38 offset:0
  v_xor_b32 v28, 0x80000, v28
  v_mfma_f32_16x16x32_bf16 a[40:43], a[148:151], a[212:215], a[40:43]
  ds_read_b64_tr_b16 a[194:195], v38 offset:1024
  v_xor_b32 v29, 0x80000, v29
  v_mfma_f32_16x16x32_bf16 a[40:43], a[144:147], a[208:211], a[40:43]
  s_add_u32 m0, s97, 0x18000
  ds_read_b64_tr_b16 a[196:197], v38 offset:8192
  v_fmac_f32 v122, v98, v114
  v_mfma_f32_16x16x32_bf16 a[24:27], a[136:139], a[208:211], a[24:27]
  buffer_load_dwordx4 v28, s[8:11], s48 offen offset:0  lds
  v_mfma_f32_16x16x32_bf16 a[24:27], a[140:143], a[212:215], a[24:27]
  ds_read_b64_tr_b16 a[198:199], v38 offset:9216
  v_and_b32 v104, s101, v80
  v_mfma_f32_16x16x32_bf16 a[8:11], a[132:135], a[212:215], a[8:11]
  v_and_b32 v105, s101, v82
  v_and_b32 v106, s101, v84
  v_mfma_f32_16x16x32_bf16 a[8:11], a[128:131], a[208:211], a[8:11]
  s_waitcnt lgkmcnt(6)
  v_and_b32 v107, s101, v86
  v_and_b32 v108, s101, v88
  v_mfma_f32_16x16x32_bf16 a[12:15], a[128:131], a[216:219], a[12:15]
  s_waitcnt lgkmcnt(4)
  buffer_load_dwordx4 v28, s[8:11], s49 offen offset:1024  lds
  v_mfma_f32_16x16x32_bf16 a[12:15], a[132:135], a[220:223], a[12:15]
  ds_read_b128 a[128:131], v30 offset:32768
  v_and_b32 v109, s101, v90
  v_mfma_f32_16x16x32_bf16 a[28:31], a[140:143], a[220:223], a[28:31]
  ds_read_b128 a[132:135], v31 offset:32768
  v_and_b32 v110, s101, v92
  v_mfma_f32_16x16x32_bf16 a[28:31], a[136:139], a[216:219], a[28:31]
  ds_read_b128 a[140:143], v31 offset:34816
  v_and_b32 v111, s101, v94
  v_mfma_f32_16x16x32_bf16 a[44:47], a[144:147], a[216:219], a[44:47]
  ds_read_b128 a[136:139], v30 offset:34816
  v_mul_f32 v115, v115, v104
  v_mfma_f32_16x16x32_bf16 a[44:47], a[148:151], a[220:223], a[44:47]
  ds_read_b128 a[144:147], v30 offset:36864
  v_mul_f32 v116, v116, v105
  v_mfma_f32_16x16x32_bf16 a[60:63], a[156:159], a[220:223], a[60:63]
  ds_read_b128 a[148:151], v31 offset:36864
  v_mul_f32 v117, v117, v106
  v_mfma_f32_16x16x32_bf16 a[60:63], a[152:155], a[216:219], a[60:63]
  buffer_load_dwordx4 v29, s[8:11], s50 offen offset:2048  lds
  v_mfma_f32_16x16x32_bf16 a[76:79], a[160:163], a[216:219], a[76:79]
  ds_read_b128 a[156:159], v31 offset:38912
  v_mul_f32 v118, v118, v107
  v_mfma_f32_16x16x32_bf16 a[76:79], a[164:167], a[220:223], a[76:79]
  ds_read_b128 a[152:155], v30 offset:38912
  v_mul_f32 v119, v119, v108
  v_mfma_f32_16x16x32_bf16 a[92:95], a[172:175], a[220:223], a[92:95]
  ds_read_b128 a[160:163], v30 offset:40960
  v_mul_f32 v120, v120, v109
  v_mfma_f32_16x16x32_bf16 a[92:95], a[168:171], a[216:219], a[92:95]
  ds_read_b128 a[164:167], v31 offset:40960
  v_mul_f32 v121, v121, v110
  v_mfma_f32_16x16x32_bf16 a[108:111], a[176:179], a[216:219], a[108:111]
  ds_read_b128 a[172:175], v31 offset:43008
  v_mul_f32 v122, v122, v111
  v_mfma_f32_16x16x32_bf16 a[108:111], a[180:183], a[220:223], a[108:111]
  ds_read_b128 a[168:171], v30 offset:43008
  v_cvt_pk_bf16_f32 v124, v122, v121
  v_mfma_f32_16x16x32_bf16 a[124:127], a[188:191], a[220:223], a[124:127]
  buffer_load_dwordx4 v29, s[8:11], s51 offen offset:3072  lds
  v_mfma_f32_16x16x32_bf16 a[124:127], a[184:187], a[216:219], a[124:127]
  s_waitcnt lgkmcnt(11)
  ds_read_b128 a[176:179], v30 offset:45056
  v_mfma_f32_16x16x32_bf16 v[128:131], a[192:195], a[128:131], v[128:131]
  s_waitcnt lgkmcnt(11)
  ds_read_b128 a[180:183], v31 offset:45056
  v_cvt_pk_bf16_f32 v125, v120, v119
  v_mfma_f32_16x16x32_bf16 v[128:131], a[196:199], a[132:135], v[128:131]
  s_waitcnt lgkmcnt(11)
  ds_read_b64_tr_b16 a[200:201], v39 offset:0
  v_mfma_f32_16x16x32_bf16 v[144:147], a[196:199], a[140:143], v[144:147]
  s_waitcnt lgkmcnt(11)
  s_add_u32 m0, s96, 0x21000
  ds_read_b128 a[188:191], v31 offset:47104
  v_mfma_f32_16x16x32_bf16 v[144:147], a[192:195], a[136:139], v[144:147]
  s_waitcnt lgkmcnt(11)
  ds_read_b64_tr_b16 a[202:203], v39 offset:1024
  v_mfma_f32_16x16x32_bf16 v[160:163], a[192:195], a[144:147], v[160:163]
  s_waitcnt lgkmcnt(11)
  ds_read_b128 a[184:187], v30 offset:47104
  v_mfma_f32_16x16x32_bf16 v[160:163], a[196:199], a[148:151], v[160:163]
  s_waitcnt lgkmcnt(11)
  buffer_load_dwordx4 v24, s[4:7], s36 offen offset:0  lds
  v_mfma_f32_16x16x32_bf16 v[176:179], a[196:199], a[156:159], v[176:179]
  s_waitcnt lgkmcnt(10)
  ds_read_b64_tr_b16 a[204:205], v39 offset:8192
  v_mfma_f32_16x16x32_bf16 v[176:179], a[192:195], a[152:155], v[176:179]
  s_waitcnt lgkmcnt(10)
  ds_read_b64_tr_b16 a[206:207], v39 offset:9216
  v_mfma_f32_16x16x32_bf16 v[192:195], a[192:195], a[160:163], v[192:195]
  s_waitcnt lgkmcnt(10)
  ds_read_b64_tr_b16 a[208:209], v40 offset:0
  v_cvt_pk_bf16_f32 v126, v118, v117
  v_mfma_f32_16x16x32_bf16 v[192:195], a[196:199], a[164:167], v[192:195]
  s_waitcnt lgkmcnt(10)
  ds_read_b64_tr_b16 a[210:211], v40 offset:1024
  v_mfma_f32_16x16x32_bf16 v[208:211], a[196:199], a[172:175], v[208:211]
  s_waitcnt lgkmcnt(10)
  ds_read_b64_tr_b16 a[212:213], v40 offset:8192
  v_mfma_f32_16x16x32_bf16 v[208:211], a[192:195], a[168:171], v[208:211]
  s_waitcnt lgkmcnt(10)
  ds_read_b64_tr_b16 a[214:215], v40 offset:9216
  v_mfma_f32_16x16x32_bf16 v[224:227], a[192:195], a[176:179], v[224:227]
  s_waitcnt lgkmcnt(10)
  buffer_load_dwordx4 v25, s[4:7], s37 offen offset:1024  lds
  v_mfma_f32_16x16x32_bf16 v[224:227], a[196:199], a[180:183], v[224:227]
  s_waitcnt lgkmcnt(8)
  v_cvt_pk_bf16_f32 v127, v116, v115
  v_accvgpr_write_b32 a228, v124
  v_mfma_f32_16x16x32_bf16 v[240:243], a[196:199], a[188:191], v[240:243]
  s_waitcnt lgkmcnt(6)
  v_accvgpr_write_b32 a229, v125
  v_mfma_f32_16x16x32_bf16 v[240:243], a[192:195], a[184:187], v[240:243]
  v_accvgpr_write_b32 a230, v126
  v_mfma_f32_16x16x32_bf16 v[244:247], a[200:203], a[184:187], v[244:247]
  s_waitcnt lgkmcnt(4)
  v_accvgpr_write_b32 a231, v127
  v_lshlrev_b32 v98, 16, v54
  v_mfma_f32_16x16x32_bf16 v[244:247], a[204:207], a[188:191], v[244:247]
  v_and_b32 v99, s101, v54
  v_lshlrev_b32 v100, 16, v55
  v_mfma_f32_16x16x32_bf16 v[228:231], a[204:207], a[180:183], v[228:231]
  v_and_b32 v101, s101, v55
  v_lshlrev_b32 v104, 16, v59
  v_mfma_f32_16x16x32_bf16 v[228:231], a[200:203], a[176:179], v[228:231]
  buffer_load_dwordx4 v24, s[4:7], s38 offen offset:2048  lds
  v_mfma_f32_16x16x32_bf16 v[212:215], a[200:203], a[168:171], v[212:215]
  v_lshlrev_b32 v105, 16, v61
  v_lshlrev_b32 v106, 16, v63
  v_mfma_f32_16x16x32_bf16 v[212:215], a[204:207], a[172:175], v[212:215]
  v_lshlrev_b32 v107, 16, v65
  v_lshlrev_b32 v108, 16, v67
  v_mfma_f32_16x16x32_bf16 v[196:199], a[204:207], a[164:167], v[196:199]
  ds_read_b64_tr_b16 a[216:217], v41 offset:0
  v_lshlrev_b32 v109, 16, v69
  v_mfma_f32_16x16x32_bf16 v[196:199], a[200:203], a[160:163], v[196:199]
  ds_read_b64_tr_b16 a[218:219], v41 offset:1024
  v_lshlrev_b32 v110, 16, v71
  v_mfma_f32_16x16x32_bf16 v[180:183], a[200:203], a[152:155], v[180:183]
  ds_read_b64_tr_b16 a[220:221], v41 offset:8192
  v_lshlrev_b32 v111, 16, v73
  v_mfma_f32_16x16x32_bf16 v[180:183], a[204:207], a[156:159], v[180:183]
  ds_read_b64_tr_b16 a[222:223], v41 offset:9216
  v_lshlrev_b32 v112, 16, v75
  v_mfma_f32_16x16x32_bf16 v[164:167], a[204:207], a[148:151], v[164:167]
  buffer_load_dwordx4 v25, s[4:7], s39 offen offset:3072  lds
  v_mfma_f32_16x16x32_bf16 v[164:167], a[200:203], a[144:147], v[164:167]
  v_lshlrev_b32 v113, 16, v77
  v_lshlrev_b32 v114, 16, v79
  v_mfma_f32_16x16x32_bf16 v[148:151], a[200:203], a[136:139], v[148:151]
  v_xor_b32 v24, 0x180, v24
  v_mul_f32 v115, v101, v104
  v_mfma_f32_16x16x32_bf16 v[148:151], a[204:207], a[140:143], v[148:151]
  v_xor_b32 v25, 0x180, v25
  v_mul_f32 v116, v101, v105
  v_mfma_f32_16x16x32_bf16 v[132:135], a[204:207], a[132:135], v[132:135]
  s_add_u32 m0, s96, 0x0
  v_mul_f32 v117, v101, v106
  v_mul_f32 v118, v101, v107
  v_mfma_f32_16x16x32_bf16 v[132:135], a[200:203], a[128:131], v[132:135]
  s_waitcnt lgkmcnt(6)
  v_mul_f32 v119, v101, v108
  v_mul_f32 v120, v101, v109
  v_mfma_f32_16x16x32_bf16 v[136:139], a[208:211], a[128:131], v[136:139]
  s_waitcnt lgkmcnt(4)
  v_mul_f32 v121, v101, v110
  v_mul_f32 v122, v101, v111
  v_mfma_f32_16x16x32_bf16 v[136:139], a[212:215], a[132:135], v[136:139]
  buffer_load_dwordx4 v24, s[4:7], s32 offen offset:0  lds
  v_mfma_f32_16x16x32_bf16 v[152:155], a[212:215], a[140:143], v[152:155]
  v_fmac_f32 v115, v100, v105
  v_fmac_f32 v116, v100, v106
  v_mfma_f32_16x16x32_bf16 v[152:155], a[208:211], a[136:139], v[152:155]
  v_fmac_f32 v117, v100, v107
  v_fmac_f32 v118, v100, v108
  v_mfma_f32_16x16x32_bf16 v[168:171], a[208:211], a[144:147], v[168:171]
  v_fmac_f32 v119, v100, v109
  v_fmac_f32 v120, v100, v110
  v_mfma_f32_16x16x32_bf16 v[168:171], a[212:215], a[148:151], v[168:171]
  v_fmac_f32 v121, v100, v111
  v_fmac_f32 v122, v100, v112
  v_mfma_f32_16x16x32_bf16 v[184:187], a[212:215], a[156:159], v[184:187]
  v_fmac_f32 v115, v99, v106
  v_fmac_f32 v116, v99, v107
  v_mfma_f32_16x16x32_bf16 v[184:187], a[208:211], a[152:155], v[184:187]
  s_waitcnt vmcnt(13)
  v_fmac_f32 v117, v99, v108
  v_fmac_f32 v118, v99, v109
  v_mfma_f32_16x16x32_bf16 v[200:203], a[208:211], a[160:163], v[200:203]
  s_barrier
  v_mfma_f32_16x16x32_bf16 v[200:203], a[212:215], a[164:167], v[200:203]
  buffer_load_dwordx4 v25, s[4:7], s33 offen offset:1024  lds
  v_mfma_f32_16x16x32_bf16 v[216:219], a[212:215], a[172:175], v[216:219]
  ds_read_b64_tr_b16 a[192:193], v38 offset:16384
  v_fmac_f32 v119, v99, v110
  v_mfma_f32_16x16x32_bf16 v[216:219], a[208:211], a[168:171], v[216:219]
  ds_read_b64_tr_b16 a[194:195], v38 offset:17408
  v_fmac_f32 v120, v99, v111
  v_mfma_f32_16x16x32_bf16 v[232:235], a[208:211], a[176:179], v[232:235]
  ds_read_b64_tr_b16 a[196:197], v38 offset:24576
  v_fmac_f32 v121, v99, v112
  v_mfma_f32_16x16x32_bf16 v[232:235], a[212:215], a[180:183], v[232:235]
  ds_read_b64_tr_b16 a[198:199], v38 offset:25600
  v_fmac_f32 v122, v99, v113
  v_mfma_f32_16x16x32_bf16 v[248:251], a[212:215], a[188:191], v[248:251]
  v_fmac_f32 v115, v98, v107
  v_fmac_f32 v116, v98, v108
  v_mfma_f32_16x16x32_bf16 v[248:251], a[208:211], a[184:187], v[248:251]
  s_waitcnt lgkmcnt(6)
  buffer_load_dwordx4 v24, s[4:7], s34 offen offset:2048  lds
  v_mfma_f32_16x16x32_bf16 v[252:255], a[216:219], a[184:187], v[252:255]
  s_waitcnt lgkmcnt(4)
  v_fmac_f32 v117, v98, v109
  v_fmac_f32 v118, v98, v110
  v_mfma_f32_16x16x32_bf16 v[252:255], a[220:223], a[188:191], v[252:255]
  v_fmac_f32 v119, v98, v111
  v_fmac_f32 v120, v98, v112
  v_mfma_f32_16x16x32_bf16 v[236:239], a[220:223], a[180:183], v[236:239]
  v_fmac_f32 v121, v98, v113
  v_fmac_f32 v122, v98, v114
  v_mfma_f32_16x16x32_bf16 v[236:239], a[216:219], a[176:179], v[236:239]
  v_lshlrev_b32 v104, 16, v81
  v_lshlrev_b32 v105, 16, v83
  v_mfma_f32_16x16x32_bf16 v[220:223], a[216:219], a[168:171], v[220:223]
  v_lshlrev_b32 v106, 16, v85
  v_lshlrev_b32 v107, 16, v87
  v_mfma_f32_16x16x32_bf16 v[220:223], a[220:223], a[172:175], v[220:223]
  v_lshlrev_b32 v108, 16, v89
  v_lshlrev_b32 v109, 16, v91
  v_mfma_f32_16x16x32_bf16 v[204:207], a[220:223], a[164:167], v[204:207]
  buffer_load_dwordx4 v25, s[4:7], s35 offen offset:3072  lds
  v_mfma_f32_16x16x32_bf16 v[204:207], a[216:219], a[160:163], v[204:207]
  ds_read_b64_tr_b16 a[200:201], v39 offset:16384
  v_lshlrev_b32 v110, 16, v93
  v_mfma_f32_16x16x32_bf16 v[188:191], a[216:219], a[152:155], v[188:191]
  ds_read_b64_tr_b16 a[202:203], v39 offset:17408
  v_lshlrev_b32 v111, 16, v95
  v_mfma_f32_16x16x32_bf16 v[188:191], a[220:223], a[156:159], v[188:191]
  ds_read_b64_tr_b16 a[204:205], v39 offset:24576
  v_mul_f32 v115, v115, v104
  v_mfma_f32_16x16x32_bf16 v[172:175], a[220:223], a[148:151], v[172:175]
  s_add_u32 m0, s97, 0x1c000
  ds_read_b64_tr_b16 a[206:207], v39 offset:25600
  v_mul_f32 v116, v116, v105
  v_mfma_f32_16x16x32_bf16 v[172:175], a[216:219], a[144:147], v[172:175]
  v_mul_f32 v117, v117, v106
  v_mul_f32 v118, v118, v107
  v_mfma_f32_16x16x32_bf16 v[156:159], a[216:219], a[136:139], v[156:159]
  v_mul_f32 v119, v119, v108
  v_mul_f32 v120, v120, v109
  v_mfma_f32_16x16x32_bf16 v[156:159], a[220:223], a[140:143], v[156:159]
  buffer_load_dwordx4 v28, s[12:15], s48 offen offset:0  lds
  v_mfma_f32_16x16x32_bf16 v[140:143], a[220:223], a[132:135], v[140:143]
  v_mul_f32 v121, v121, v110
  v_mul_f32 v122, v122, v111
  v_mfma_f32_16x16x32_bf16 v[140:143], a[216:219], a[128:131], v[140:143]
  s_waitcnt lgkmcnt(6)
  v_cvt_pk_bf16_f32 v124, v122, v121
  v_cvt_pk_bf16_f32 v125, v120, v119
  v_mfma_f32_16x16x32_bf16 a[0:3], a[128:131], a[192:195], a[0:3]
  s_waitcnt lgkmcnt(4)
  v_cvt_pk_bf16_f32 v126, v118, v117
  v_cvt_pk_bf16_f32 v127, v116, v115
  v_mfma_f32_16x16x32_bf16 a[0:3], a[132:135], a[196:199], a[0:3]
  v_accvgpr_write_b32 a232, v124
  v_accvgpr_write_b32 a233, v125
  v_mfma_f32_16x16x32_bf16 a[16:19], a[140:143], a[196:199], a[16:19]
  v_accvgpr_write_b32 a234, v126
  v_accvgpr_write_b32 a235, v127
  v_mfma_f32_16x16x32_bf16 a[16:19], a[136:139], a[192:195], a[16:19]
  v_lshlrev_b32 v98, 16, v56
  v_and_b32 v99, s101, v56
  v_mfma_f32_16x16x32_bf16 a[32:35], a[144:147], a[192:195], a[32:35]
  buffer_load_dwordx4 v28, s[12:15], s49 offen offset:1024  lds
  v_mfma_f32_16x16x32_bf16 a[32:35], a[148:151], a[196:199], a[32:35]
  v_lshlrev_b32 v100, 16, v57
  v_and_b32 v101, s101, v57
  v_mfma_f32_16x16x32_bf16 a[48:51], a[156:159], a[196:199], a[48:51]
  ds_read_b64_tr_b16 a[208:209], v40 offset:16384
  v_and_b32 v104, s101, v59
  v_mfma_f32_16x16x32_bf16 a[48:51], a[152:155], a[192:195], a[48:51]
  ds_read_b64_tr_b16 a[210:211], v40 offset:17408
  v_and_b32 v105, s101, v61
  v_mfma_f32_16x16x32_bf16 a[64:67], a[160:163], a[192:195], a[64:67]
  ds_read_b64_tr_b16 a[212:213], v40 offset:24576
  v_and_b32 v106, s101, v63
  v_mfma_f32_16x16x32_bf16 a[64:67], a[164:167], a[196:199], a[64:67]
  ds_read_b64_tr_b16 a[214:215], v40 offset:25600
  v_and_b32 v107, s101, v65
  v_mfma_f32_16x16x32_bf16 a[80:83], a[172:175], a[196:199], a[80:83]
  v_and_b32 v108, s101, v67
  v_and_b32 v109, s101, v69
  v_mfma_f32_16x16x32_bf16 a[80:83], a[168:171], a[192:195], a[80:83]
  buffer_load_dwordx4 v29, s[12:15], s50 offen offset:2048  lds
  v_mfma_f32_16x16x32_bf16 a[96:99], a[176:179], a[192:195], a[96:99]
  v_and_b32 v110, s101, v71
  v_and_b32 v111, s101, v73
  v_mfma_f32_16x16x32_bf16 a[96:99], a[180:183], a[196:199], a[96:99]
  v_and_b32 v112, s101, v75
  v_and_b32 v113, s101, v77
  v_mfma_f32_16x16x32_bf16 a[112:115], a[188:191], a[196:199], a[112:115]
  v_and_b32 v114, s101, v79
  v_mul_f32 v115, v101, v104
  v_mfma_f32_16x16x32_bf16 a[112:115], a[184:187], a[192:195], a[112:115]
  s_waitcnt lgkmcnt(6)
  v_mul_f32 v116, v101, v105
  v_mul_f32 v117, v101, v106
  v_mfma_f32_16x16x32_bf16 a[116:119], a[184:187], a[200:203], a[116:119]
  s_waitcnt lgkmcnt(4)
  v_mul_f32 v118, v101, v107
  v_mul_f32 v119, v101, v108
  v_mfma_f32_16x16x32_bf16 a[116:119], a[188:191], a[204:207], a[116:119]
  v_mul_f32 v120, v101, v109
  v_mul_f32 v121, v101, v110
  v_mfma_f32_16x16x32_bf16 a[100:103], a[180:183], a[204:207], a[100:103]
  buffer_load_dwordx4 v29, s[12:15], s51 offen offset:3072  lds
  v_mfma_f32_16x16x32_bf16 a[100:103], a[176:179], a[200:203], a[100:103]
  v_mul_f32 v122, v101, v111
  v_fmac_f32 v115, v100, v105
  v_mfma_f32_16x16x32_bf16 a[84:87], a[168:171], a[200:203], a[84:87]
  v_fmac_f32 v116, v100, v106
  v_fmac_f32 v117, v100, v107
  v_mfma_f32_16x16x32_bf16 a[84:87], a[172:175], a[204:207], a[84:87]
  v_fmac_f32 v118, v100, v108
  v_fmac_f32 v119, v100, v109
  v_mfma_f32_16x16x32_bf16 a[68:71], a[164:167], a[204:207], a[68:71]
  s_add_u32 m0, s96, 0x1000
  ds_read_b64_tr_b16 a[216:217], v41 offset:16384
  v_fmac_f32 v120, v100, v110
  v_mfma_f32_16x16x32_bf16 a[68:71], a[160:163], a[200:203], a[68:71]
  ds_read_b64_tr_b16 a[218:219], v41 offset:17408
  v_fmac_f32 v121, v100, v111
  v_mfma_f32_16x16x32_bf16 a[52:55], a[152:155], a[200:203], a[52:55]
  ds_read_b64_tr_b16 a[220:221], v41 offset:24576
  v_fmac_f32 v122, v100, v112
  v_mfma_f32_16x16x32_bf16 a[52:55], a[156:159], a[204:207], a[52:55]
  buffer_load_dwordx4 v24, s[4:7], s36 offen offset:0  lds
  v_mfma_f32_16x16x32_bf16 a[36:39], a[148:151], a[204:207], a[36:39]
  ds_read_b64_tr_b16 a[222:223], v41 offset:25600
  v_fmac_f32 v115, v99, v106
  v_mfma_f32_16x16x32_bf16 a[36:39], a[144:147], a[200:203], a[36:39]
  v_fmac_f32 v116, v99, v107
  v_fmac_f32 v117, v99, v108
  v_mfma_f32_16x16x32_bf16 a[20:23], a[136:139], a[200:203], a[20:23]
  v_fmac_f32 v118, v99, v109
  v_fmac_f32 v119, v99, v110
  v_mfma_f32_16x16x32_bf16 a[20:23], a[140:143], a[204:207], a[20:23]
  v_fmac_f32 v120, v99, v111
  v_fmac_f32 v121, v99, v112
  v_mfma_f32_16x16x32_bf16 a[4:7], a[132:135], a[204:207], a[4:7]
  v_fmac_f32 v122, v99, v113
  v_fmac_f32 v115, v98, v107
  v_mfma_f32_16x16x32_bf16 a[4:7], a[128:131], a[200:203], a[4:7]
  s_waitcnt lgkmcnt(6)
  v_fmac_f32 v116, v98, v108
  v_fmac_f32 v117, v98, v109
  v_mfma_f32_16x16x32_bf16 a[8:11], a[128:131], a[208:211], a[8:11]
  s_waitcnt lgkmcnt(4)
  buffer_load_dwordx4 v25, s[4:7], s37 offen offset:1024  lds
  v_mfma_f32_16x16x32_bf16 a[8:11], a[132:135], a[212:215], a[8:11]
  v_fmac_f32 v118, v98, v110
  v_fmac_f32 v119, v98, v111
  v_mfma_f32_16x16x32_bf16 a[24:27], a[140:143], a[212:215], a[24:27]
  v_fmac_f32 v120, v98, v112
  v_fmac_f32 v121, v98, v113
  v_mfma_f32_16x16x32_bf16 a[24:27], a[136:139], a[208:211], a[24:27]
  v_fmac_f32 v122, v98, v114
  v_and_b32 v104, s101, v81
  v_mfma_f32_16x16x32_bf16 a[40:43], a[144:147], a[208:211], a[40:43]
  v_and_b32 v105, s101, v83
  v_and_b32 v106, s101, v85
  v_mfma_f32_16x16x32_bf16 a[40:43], a[148:151], a[212:215], a[40:43]
  v_and_b32 v107, s101, v87
  v_and_b32 v108, s101, v89
  v_mfma_f32_16x16x32_bf16 a[56:59], a[156:159], a[212:215], a[56:59]
  v_and_b32 v109, s101, v91
  v_and_b32 v110, s101, v93
  v_mfma_f32_16x16x32_bf16 a[56:59], a[152:155], a[208:211], a[56:59]
  s_waitcnt vmcnt(10)
  buffer_load_dwordx4 v24, s[4:7], s38 offen offset:2048  lds
  v_mfma_f32_16x16x32_bf16 a[72:75], a[160:163], a[208:211], a[72:75]
  s_barrier
  v_mfma_f32_16x16x32_bf16 a[72:75], a[164:167], a[212:215], a[72:75]
  ds_read_b64_tr_b16 a[192:193], v38 offset:32768
  v_and_b32 v111, s101, v95
  v_mfma_f32_16x16x32_bf16 a[88:91], a[172:175], a[212:215], a[88:91]
  ds_read_b64_tr_b16 a[194:195], v38 offset:33792
  v_mul_f32 v115, v115, v104
  v_mfma_f32_16x16x32_bf16 a[88:91], a[168:171], a[208:211], a[88:91]
  ds_read_b64_tr_b16 a[196:197], v38 offset:40960
  v_mul_f32 v116, v116, v105
  v_mfma_f32_16x16x32_bf16 a[104:107], a[176:179], a[208:211], a[104:107]
  ds_read_b64_tr_b16 a[198:199], v38 offset:41984
  v_mul_f32 v117, v117, v106
  v_mfma_f32_16x16x32_bf16 a[104:107], a[180:183], a[212:215], a[104:107]
  v_mul_f32 v118, v118, v107
  v_mul_f32 v119, v119, v108
  v_mfma_f32_16x16x32_bf16 a[120:123], a[188:191], a[212:215], a[120:123]
  buffer_load_dwordx4 v25, s[4:7], s39 offen offset:3072  lds
  v_mfma_f32_16x16x32_bf16 a[120:123], a[184:187], a[208:211], a[120:123]
  s_waitcnt lgkmcnt(6)
  v_mul_f32 v120, v120, v109
  v_mul_f32 v121, v121, v110
  v_mfma_f32_16x16x32_bf16 a[124:127], a[184:187], a[216:219], a[124:127]
  s_waitcnt lgkmcnt(4)
  ds_read_b128 a[184:187], v32 offset:14336
  v_xor_b32 v28, 0x180000, v28
  v_mfma_f32_16x16x32_bf16 a[124:127], a[188:191], a[220:223], a[124:127]
  ds_read_b128 a[188:191], v33 offset:14336
  v_xor_b32 v29, 0x180000, v29
  v_mfma_f32_16x16x32_bf16 a[108:111], a[180:183], a[220:223], a[108:111]
  s_add_u32 m0, s97, 0x10000
  ds_read_b128 a[180:183], v33 offset:12288
  v_mul_f32 v122, v122, v111
  v_mfma_f32_16x16x32_bf16 a[108:111], a[176:179], a[216:219], a[108:111]
  ds_read_b128 a[176:179], v32 offset:12288
  v_cvt_pk_bf16_f32 v124, v122, v121
  v_mfma_f32_16x16x32_bf16 a[92:95], a[168:171], a[216:219], a[92:95]
  ds_read_b128 a[168:171], v32 offset:10240
  v_cvt_pk_bf16_f32 v125, v120, v119
  v_mfma_f32_16x16x32_bf16 a[92:95], a[172:175], a[220:223], a[92:95]
  buffer_load_dwordx4 v28, s[8:11], s48 offen offset:0  lds
  v_mfma_f32_16x16x32_bf16 a[76:79], a[164:167], a[220:223], a[76:79]
  ds_read_b128 a[172:175], v33 offset:10240
  v_cvt_pk_bf16_f32 v126, v118, v117
  v_mfma_f32_16x16x32_bf16 a[76:79], a[160:163], a[216:219], a[76:79]
  ds_read_b128 a[164:167], v33 offset:8192
  v_mfma_f32_16x16x32_bf16 a[60:63], a[152:155], a[216:219], a[60:63]
  ds_read_b128 a[160:163], v32 offset:8192
  v_cvt_pk_bf16_f32 v127, v116, v115
  v_mfma_f32_16x16x32_bf16 a[60:63], a[156:159], a[220:223], a[60:63]
  ds_read_b128 a[152:155], v32 offset:6144
  v_mfma_f32_16x16x32_bf16 a[44:47], a[148:151], a[220:223], a[44:47]
  ds_read_b128 a[156:159], v33 offset:6144
  v_mfma_f32_16x16x32_bf16 a[44:47], a[144:147], a[216:219], a[44:47]
  ds_read_b128 a[148:151], v33 offset:4096
  v_mfma_f32_16x16x32_bf16 a[28:31], a[136:139], a[216:219], a[28:31]
  buffer_load_dwordx4 v28, s[8:11], s49 offen offset:1024  lds
  v_mfma_f32_16x16x32_bf16 a[28:31], a[140:143], a[220:223], a[28:31]
  ds_read_b128 a[144:147], v32 offset:4096
  v_accvgpr_write_b32 a236, v124
  v_mfma_f32_16x16x32_bf16 a[12:15], a[132:135], a[220:223], a[12:15]
  ds_read_b128 a[136:139], v32 offset:2048
  v_mfma_f32_16x16x32_bf16 a[12:15], a[128:131], a[216:219], a[12:15]
  s_waitcnt lgkmcnt(12)
  ds_read_b128 a[140:143], v33 offset:2048
  v_mfma_f32_16x16x32_bf16 v[240:243], a[192:195], a[184:187], v[240:243]
  s_waitcnt lgkmcnt(12)
  ds_read_b64_tr_b16 a[200:201], v39 offset:32768
  v_accvgpr_write_b32 a237, v125
  v_mfma_f32_16x16x32_bf16 v[240:243], a[196:199], a[188:191], v[240:243]
  s_waitcnt lgkmcnt(12)
  ds_read_b128 a[132:135], v33 offset:0
  v_mfma_f32_16x16x32_bf16 v[224:227], a[196:199], a[180:183], v[224:227]
  s_waitcnt lgkmcnt(12)
  ds_read_b64_tr_b16 a[202:203], v39 offset:33792
  v_mfma_f32_16x16x32_bf16 v[224:227], a[192:195], a[176:179], v[224:227]
  s_waitcnt lgkmcnt(12)
  buffer_load_dwordx4 v29, s[8:11], s50 offen offset:2048  lds
  v_mfma_f32_16x16x32_bf16 v[208:211], a[192:195], a[168:171], v[208:211]
  s_waitcnt lgkmcnt(11)
  ds_read_b128 a[128:131], v32 offset:0
  v_accvgpr_write_b32 a238, v126
  v_mfma_f32_16x16x32_bf16 v[208:211], a[196:199], a[172:175], v[208:211]
  s_waitcnt lgkmcnt(11)
  ds_read_b64_tr_b16 a[204:205], v39 offset:40960
  v_mfma_f32_16x16x32_bf16 v[192:195], a[196:199], a[164:167], v[192:195]
  s_waitcnt lgkmcnt(11)
  ds_read_b64_tr_b16 a[206:207], v39 offset:41984
  v_mfma_f32_16x16x32_bf16 v[192:195], a[192:195], a[160:163], v[192:195]
  s_waitcnt lgkmcnt(11)
  ds_read_b64_tr_b16 a[208:209], v40 offset:32768
  v_mfma_f32_16x16x32_bf16 v[176:179], a[192:195], a[152:155], v[176:179]
  s_waitcnt lgkmcnt(11)
  ds_read_b64_tr_b16 a[210:211], v40 offset:33792
  v_accvgpr_write_b32 a239, v127
  v_mfma_f32_16x16x32_bf16 v[176:179], a[196:199], a[156:159], v[176:179]
  s_waitcnt lgkmcnt(11)
  ds_read_b64_tr_b16 a[212:213], v40 offset:40960
  v_mfma_f32_16x16x32_bf16 v[160:163], a[196:199], a[148:151], v[160:163]
  s_waitcnt lgkmcnt(11)
  buffer_load_dwordx4 v29, s[8:11], s51 offen offset:3072  lds
  v_mfma_f32_16x16x32_bf16 v[160:163], a[192:195], a[144:147], v[160:163]
  s_waitcnt lgkmcnt(10)
  ds_read_b64_tr_b16 a[214:215], v40 offset:41984
  v_mfma_f32_16x16x32_bf16 v[144:147], a[192:195], a[136:139], v[144:147]
  s_waitcnt lgkmcnt(10)
  v_mfma_f32_16x16x32_bf16 v[144:147], a[196:199], a[140:143], v[144:147]
  s_waitcnt lgkmcnt(8)
  v_mfma_f32_16x16x32_bf16 v[128:131], a[196:199], a[132:135], v[128:131]
  s_waitcnt lgkmcnt(6)
  v_mfma_f32_16x16x32_bf16 v[128:131], a[192:195], a[128:131], v[128:131]
  v_mfma_f32_16x16x32_bf16 v[132:135], a[200:203], a[128:131], v[132:135]
  s_waitcnt lgkmcnt(4)
  v_mfma_f32_16x16x32_bf16 v[132:135], a[204:207], a[132:135], v[132:135]
  global_load_dword v17, v21, s[68:69]
  v_mfma_f32_16x16x32_bf16 v[148:151], a[204:207], a[140:143], v[148:151]
  v_add_u32 v21, 0x4000, v21
  v_mfma_f32_16x16x32_bf16 v[148:151], a[200:203], a[136:139], v[148:151]
  v_mfma_f32_16x16x32_bf16 v[164:167], a[200:203], a[144:147], v[164:167]
  v_mfma_f32_16x16x32_bf16 v[164:167], a[204:207], a[148:151], v[164:167]
  v_mfma_f32_16x16x32_bf16 v[180:183], a[204:207], a[156:159], v[180:183]
  ds_read_b64_tr_b16 a[216:217], v41 offset:32768
  v_mfma_f32_16x16x32_bf16 v[180:183], a[200:203], a[152:155], v[180:183]
  ds_read_b64_tr_b16 a[218:219], v41 offset:33792
  v_mfma_f32_16x16x32_bf16 v[196:199], a[200:203], a[160:163], v[196:199]
  ds_read_b64_tr_b16 a[220:221], v41 offset:40960
  v_mfma_f32_16x16x32_bf16 v[196:199], a[204:207], a[164:167], v[196:199]
  ds_read_b64_tr_b16 a[222:223], v41 offset:41984
  v_mfma_f32_16x16x32_bf16 v[212:215], a[204:207], a[172:175], v[212:215]
  v_xor_b32 v24, 0x80, v24
  v_mfma_f32_16x16x32_bf16 v[212:215], a[200:203], a[168:171], v[212:215]
  v_xor_b32 v25, 0x80, v25
  v_mfma_f32_16x16x32_bf16 v[228:231], a[200:203], a[176:179], v[228:231]
  s_add_u32 m0, s96, 0x8000
  v_mfma_f32_16x16x32_bf16 v[228:231], a[204:207], a[180:183], v[228:231]
  v_mfma_f32_16x16x32_bf16 v[244:247], a[204:207], a[188:191], v[244:247]
  v_mfma_f32_16x16x32_bf16 v[244:247], a[200:203], a[184:187], v[244:247]
  s_waitcnt lgkmcnt(6)
  buffer_load_dwordx4 v24, s[4:7], s32 offen offset:0  lds
  v_mfma_f32_16x16x32_bf16 v[248:251], a[208:211], a[184:187], v[248:251]
  s_waitcnt lgkmcnt(4)
  v_mfma_f32_16x16x32_bf16 v[248:251], a[212:215], a[188:191], v[248:251]
  v_mfma_f32_16x16x32_bf16 v[232:235], a[212:215], a[180:183], v[232:235]
  v_mfma_f32_16x16x32_bf16 v[232:235], a[208:211], a[176:179], v[232:235]
  v_mfma_f32_16x16x32_bf16 v[216:219], a[208:211], a[168:171], v[216:219]
  v_mfma_f32_16x16x32_bf16 v[216:219], a[212:215], a[172:175], v[216:219]
  v_mfma_f32_16x16x32_bf16 v[200:203], a[212:215], a[164:167], v[200:203]
  buffer_load_dwordx4 v25, s[4:7], s33 offen offset:1024  lds
  v_mfma_f32_16x16x32_bf16 v[200:203], a[208:211], a[160:163], v[200:203]
  s_waitcnt vmcnt(11)
  v_mfma_f32_16x16x32_bf16 v[184:187], a[208:211], a[152:155], v[184:187]
  s_barrier
  v_mfma_f32_16x16x32_bf16 v[184:187], a[212:215], a[156:159], v[184:187]
  ds_read_b64_tr_b16 a[192:193], v38 offset:49152
  v_mfma_f32_16x16x32_bf16 v[168:171], a[212:215], a[148:151], v[168:171]
  ds_read_b64_tr_b16 a[194:195], v38 offset:50176
  v_mfma_f32_16x16x32_bf16 v[168:171], a[208:211], a[144:147], v[168:171]
  ds_read_b64_tr_b16 a[196:197], v38 offset:57344
  v_mfma_f32_16x16x32_bf16 v[152:155], a[208:211], a[136:139], v[152:155]
  ds_read_b64_tr_b16 a[198:199], v38 offset:58368
  v_mfma_f32_16x16x32_bf16 v[152:155], a[212:215], a[140:143], v[152:155]
  buffer_load_dwordx4 v24, s[4:7], s34 offen offset:2048  lds
  v_mfma_f32_16x16x32_bf16 v[136:139], a[212:215], a[132:135], v[136:139]
  v_mfma_f32_16x16x32_bf16 v[136:139], a[208:211], a[128:131], v[136:139]
  s_waitcnt lgkmcnt(6)
  v_mfma_f32_16x16x32_bf16 v[140:143], a[216:219], a[128:131], v[140:143]
  s_waitcnt lgkmcnt(4)
  v_mfma_f32_16x16x32_bf16 v[140:143], a[220:223], a[132:135], v[140:143]
  v_mfma_f32_16x16x32_bf16 v[156:159], a[220:223], a[140:143], v[156:159]
  v_mfma_f32_16x16x32_bf16 v[156:159], a[216:219], a[136:139], v[156:159]
  v_mfma_f32_16x16x32_bf16 v[172:175], a[216:219], a[144:147], v[172:175]
  buffer_load_dwordx4 v25, s[4:7], s35 offen offset:3072  lds
  v_mfma_f32_16x16x32_bf16 v[172:175], a[220:223], a[148:151], v[172:175]
  v_mfma_f32_16x16x32_bf16 v[188:191], a[220:223], a[156:159], v[188:191]
  s_mov_b32 s52, s64
  ds_read_b64_tr_b16 a[200:201], v39 offset:49152
  v_mfma_f32_16x16x32_bf16 v[188:191], a[216:219], a[152:155], v[188:191]
  s_mov_b32 s53, s65
  ds_read_b64_tr_b16 a[202:203], v39 offset:50176
  v_mfma_f32_16x16x32_bf16 v[204:207], a[216:219], a[160:163], v[204:207]
  s_mov_b32 s54, 0x400000
  ds_read_b64_tr_b16 a[204:205], v39 offset:57344
  v_mfma_f32_16x16x32_bf16 v[204:207], a[220:223], a[164:167], v[204:207]
  ds_read_b64_tr_b16 a[206:207], v39 offset:58368
  v_mfma_f32_16x16x32_bf16 v[220:223], a[220:223], a[172:175], v[220:223]
  v_mfma_f32_16x16x32_bf16 v[220:223], a[216:219], a[168:171], v[220:223]
  buffer_load_dwordx4 v[112:115], v3, s[52:55], s77 offen offset:0
  v_mfma_f32_16x16x32_bf16 v[236:239], a[216:219], a[176:179], v[236:239]
  v_mfma_f32_16x16x32_bf16 v[236:239], a[220:223], a[180:183], v[236:239]
  v_mfma_f32_16x16x32_bf16 v[252:255], a[220:223], a[188:191], v[252:255]
  v_mfma_f32_16x16x32_bf16 v[252:255], a[216:219], a[184:187], v[252:255]
  s_waitcnt lgkmcnt(6)
  v_mfma_f32_16x16x32_bf16 a[112:115], a[184:187], a[192:195], a[112:115]
  s_waitcnt lgkmcnt(4)
  v_mfma_f32_16x16x32_bf16 a[112:115], a[188:191], a[196:199], a[112:115]
  v_mfma_f32_16x16x32_bf16 a[96:99], a[180:183], a[196:199], a[96:99]
  buffer_load_dwordx4 v[116:119], v3, s[52:55], s77 offen offset:1024
  v_mfma_f32_16x16x32_bf16 a[96:99], a[176:179], a[192:195], a[96:99]
  v_mfma_f32_16x16x32_bf16 a[80:83], a[168:171], a[192:195], a[80:83]
  v_mfma_f32_16x16x32_bf16 a[80:83], a[172:175], a[196:199], a[80:83]
  v_mfma_f32_16x16x32_bf16 a[64:67], a[164:167], a[196:199], a[64:67]
  ds_read_b64_tr_b16 a[208:209], v40 offset:49152
  v_mfma_f32_16x16x32_bf16 a[64:67], a[160:163], a[192:195], a[64:67]
  ds_read_b64_tr_b16 a[210:211], v40 offset:50176
  v_mfma_f32_16x16x32_bf16 a[48:51], a[152:155], a[192:195], a[48:51]
  ds_read_b64_tr_b16 a[212:213], v40 offset:57344
  v_mfma_f32_16x16x32_bf16 a[48:51], a[156:159], a[196:199], a[48:51]
L_pad3:
  s_cbranch_execz L_pad7
  global_load_dword v17, v21, s[68:69]
  v_mfma_f32_16x16x32_bf16 a[32:35], a[148:151], a[196:199], a[32:35]
  ds_read_b64_tr_b16 a[214:215], v40 offset:58368
  v_add_u32 v21, 0x4000, v21
  v_mfma_f32_16x16x32_bf16 a[32:35], a[144:147], a[192:195], a[32:35]
  v_mfma_f32_16x16x32_bf16 a[16:19], a[136:139], a[192:195], a[16:19]
  v_mfma_f32_16x16x32_bf16 a[16:19], a[140:143], a[196:199], a[16:19]
  v_mfma_f32_16x16x32_bf16 a[0:3], a[132:135], a[196:199], a[0:3]
  v_mfma_f32_16x16x32_bf16 a[0:3], a[128:131], a[192:195], a[0:3]
  s_waitcnt lgkmcnt(6)
  v_mfma_f32_16x16x32_bf16 a[4:7], a[128:131], a[200:203], a[4:7]
  s_waitcnt lgkmcnt(4)
  v_mfma_f32_16x16x32_bf16 a[4:7], a[132:135], a[204:207], a[4:7]
  v_mfma_f32_16x16x32_bf16 a[20:23], a[140:143], a[204:207], a[20:23]
  v_mfma_f32_16x16x32_bf16 a[20:23], a[136:139], a[200:203], a[20:23]
  v_mfma_f32_16x16x32_bf16 a[36:39], a[144:147], a[200:203], a[36:39]
  s_add_u32 m0, s97, 0x14000
  v_mfma_f32_16x16x32_bf16 a[36:39], a[148:151], a[204:207], a[36:39]
  v_mfma_f32_16x16x32_bf16 a[52:55], a[156:159], a[204:207], a[52:55]
  ds_read_b64_tr_b16 a[216:217], v41 offset:49152
  v_mfma_f32_16x16x32_bf16 a[52:55], a[152:155], a[200:203], a[52:55]
  buffer_load_dwordx4 v28, s[12:15], s48 offen offset:0  lds
  v_mfma_f32_16x16x32_bf16 a[68:71], a[160:163], a[200:203], a[68:71]
  ds_read_b64_tr_b16 a[218:219], v41 offset:50176
  v_mfma_f32_16x16x32_bf16 a[68:71], a[164:167], a[204:207], a[68:71]
  ds_read_b64_tr_b16 a[220:221], v41 offset:57344
  v_mfma_f32_16x16x32_bf16 a[84:87], a[172:175], a[204:207], a[84:87]
  ds_read_b64_tr_b16 a[222:223], v41 offset:58368
  v_mfma_f32_16x16x32_bf16 a[84:87], a[168:171], a[200:203], a[84:87]
  v_mfma_f32_16x16x32_bf16 a[100:103], a[176:179], a[200:203], a[100:103]
  v_mfma_f32_16x16x32_bf16 a[100:103], a[180:183], a[204:207], a[100:103]
  v_mfma_f32_16x16x32_bf16 a[116:119], a[188:191], a[204:207], a[116:119]
  buffer_load_dwordx4 v28, s[12:15], s49 offen offset:1024  lds
  v_mfma_f32_16x16x32_bf16 a[116:119], a[184:187], a[200:203], a[116:119]
  s_waitcnt lgkmcnt(6)
  v_mfma_f32_16x16x32_bf16 a[120:123], a[184:187], a[208:211], a[120:123]
  s_waitcnt lgkmcnt(4)
  v_mfma_f32_16x16x32_bf16 a[120:123], a[188:191], a[212:215], a[120:123]
  v_mfma_f32_16x16x32_bf16 a[104:107], a[180:183], a[212:215], a[104:107]
  v_mfma_f32_16x16x32_bf16 a[104:107], a[176:179], a[208:211], a[104:107]
  v_mfma_f32_16x16x32_bf16 a[88:91], a[168:171], a[208:211], a[88:91]
  v_mfma_f32_16x16x32_bf16 a[88:91], a[172:175], a[212:215], a[88:91]
  buffer_load_dwordx4 v29, s[12:15], s50 offen offset:2048  lds
  v_mfma_f32_16x16x32_bf16 a[72:75], a[164:167], a[212:215], a[72:75]
  v_mfma_f32_16x16x32_bf16 a[72:75], a[160:163], a[208:211], a[72:75]
  s_waitcnt vmcnt(11)
  v_mfma_f32_16x16x32_bf16 a[56:59], a[152:155], a[208:211], a[56:59]
  s_barrier
  v_mfma_f32_16x16x32_bf16 a[56:59], a[156:159], a[212:215], a[56:59]
  ds_read_b64_tr_b16 a[192:193], v38 offset:0
  v_mfma_f32_16x16x32_bf16 a[40:43], a[148:151], a[212:215], a[40:43]
  ds_read_b64_tr_b16 a[194:195], v38 offset:1024
  v_mfma_f32_16x16x32_bf16 a[40:43], a[144:147], a[208:211], a[40:43]
  buffer_load_dwordx4 v29, s[12:15], s51 offen offset:3072  lds
  v_mfma_f32_16x16x32_bf16 a[24:27], a[136:139], a[208:211], a[24:27]
  ds_read_b64_tr_b16 a[196:197], v38 offset:8192
  v_mfma_f32_16x16x32_bf16 a[24:27], a[140:143], a[212:215], a[24:27]
  ds_read_b64_tr_b16 a[198:199], v38 offset:9216
  v_mfma_f32_16x16x32_bf16 a[8:11], a[132:135], a[212:215], a[8:11]
  buffer_load_dwordx4 v[120:123], v3, s[52:55], s77 offen offset:2048
  v_mfma_f32_16x16x32_bf16 a[8:11], a[128:131], a[208:211], a[8:11]
  s_waitcnt lgkmcnt(6)
  v_mfma_f32_16x16x32_bf16 a[12:15], a[128:131], a[216:219], a[12:15]
  s_waitcnt lgkmcnt(4)
  ds_read_b128 a[128:131], v30 offset:0
  v_mfma_f32_16x16x32_bf16 a[12:15], a[132:135], a[220:223], a[12:15]
  ds_read_b128 a[132:135], v31 offset:0
  v_mfma_f32_16x16x32_bf16 a[28:31], a[140:143], a[220:223], a[28:31]
  buffer_load_dwordx4 v[124:127], v3, s[52:55], s77 offen offset:3072
  v_mfma_f32_16x16x32_bf16 a[28:31], a[136:139], a[216:219], a[28:31]
  ds_read_b128 a[140:143], v31 offset:2048
  v_mfma_f32_16x16x32_bf16 a[44:47], a[144:147], a[216:219], a[44:47]
  s_mov_b32 s52, s88
  ds_read_b128 a[136:139], v30 offset:2048
  v_mfma_f32_16x16x32_bf16 a[44:47], a[148:151], a[220:223], a[44:47]
  s_mov_b32 s53, s89
  ds_read_b128 a[144:147], v30 offset:4096
  v_mfma_f32_16x16x32_bf16 a[60:63], a[156:159], a[220:223], a[60:63]
  s_mov_b32 s54, 0x800
  ds_read_b128 a[148:151], v31 offset:4096
  v_mfma_f32_16x16x32_bf16 a[60:63], a[152:155], a[216:219], a[60:63]
  ds_read_b128 a[156:159], v31 offset:6144
  v_mfma_f32_16x16x32_bf16 a[76:79], a[160:163], a[216:219], a[76:79]
  ds_read_b128 a[152:155], v30 offset:6144
  v_mfma_f32_16x16x32_bf16 a[76:79], a[164:167], a[220:223], a[76:79]
  buffer_load_dwordx4 v[104:107], v3, s[52:55], 0 offen offset:0
  v_mfma_f32_16x16x32_bf16 a[92:95], a[172:175], a[220:223], a[92:95]
  ds_read_b128 a[160:163], v30 offset:8192
  v_mfma_f32_16x16x32_bf16 a[92:95], a[168:171], a[216:219], a[92:95]
  ds_read_b128 a[164:167], v31 offset:8192
  v_mfma_f32_16x16x32_bf16 a[108:111], a[176:179], a[216:219], a[108:111]
  buffer_load_dwordx4 v[108:111], v3, s[52:55], 0 offen offset:1024
  v_mfma_f32_16x16x32_bf16 a[108:111], a[180:183], a[220:223], a[108:111]
  ds_read_b128 a[172:175], v31 offset:10240
  v_mfma_f32_16x16x32_bf16 a[124:127], a[188:191], a[220:223], a[124:127]
  ds_read_b128 a[168:171], v30 offset:10240
  v_mfma_f32_16x16x32_bf16 a[124:127], a[184:187], a[216:219], a[124:127]
  s_waitcnt lgkmcnt(11)
  global_load_dword v17, v21, s[68:69]
  v_mfma_f32_16x16x32_bf16 v[128:131], a[192:195], a[128:131], v[128:131]
  s_waitcnt lgkmcnt(10)
  s_mov_b32 s83, 0x3e0293ee
  ds_read_b128 a[176:179], v30 offset:12288
  v_add_u32 v21, 0x4000, v21
  v_mfma_f32_16x16x32_bf16 v[128:131], a[196:199], a[132:135], v[128:131]
  s_waitcnt lgkmcnt(10)
  ds_read_b128 a[180:183], v31 offset:12288
  v_mfma_f32_16x16x32_bf16 v[144:147], a[196:199], a[140:143], v[144:147]
  s_waitcnt lgkmcnt(10)
  ds_read_b64_tr_b16 a[200:201], v39 offset:0
  v_mfma_f32_16x16x32_bf16 v[144:147], a[192:195], a[136:139], v[144:147]
  s_waitcnt lgkmcnt(10)
  ds_read_b128 a[188:191], v31 offset:14336
  v_mfma_f32_16x16x32_bf16 v[160:163], a[192:195], a[144:147], v[160:163]
  s_waitcnt lgkmcnt(10)
  ds_read_b64_tr_b16 a[202:203], v39 offset:1024
  v_mfma_f32_16x16x32_bf16 v[160:163], a[196:199], a[148:151], v[160:163]
  s_waitcnt lgkmcnt(10)
  ds_read_b128 a[184:187], v30 offset:14336
  v_mfma_f32_16x16x32_bf16 v[176:179], a[196:199], a[156:159], v[176:179]
  s_waitcnt lgkmcnt(10)
  ds_read_b64_tr_b16 a[204:205], v39 offset:8192
  v_xor_b32 v28, 0x80000, v28
  v_mfma_f32_16x16x32_bf16 v[176:179], a[192:195], a[152:155], v[176:179]
  s_waitcnt lgkmcnt(10)
  ds_read_b64_tr_b16 a[206:207], v39 offset:9216
  v_xor_b32 v29, 0x80000, v29
  v_mfma_f32_16x16x32_bf16 v[192:195], a[192:195], a[160:163], v[192:195]
  s_waitcnt lgkmcnt(10)
  s_add_u32 m0, s97, 0x18000
  ds_read_b64_tr_b16 a[208:209], v40 offset:0
  v_mfma_f32_16x16x32_bf16 v[192:195], a[196:199], a[164:167], v[192:195]
  s_waitcnt lgkmcnt(10)
  ds_read_b64_tr_b16 a[210:211], v40 offset:1024
  v_mfma_f32_16x16x32_bf16 v[208:211], a[196:199], a[172:175], v[208:211]
  s_waitcnt lgkmcnt(10)
  ds_read_b64_tr_b16 a[212:213], v40 offset:8192
  v_mfma_f32_16x16x32_bf16 v[208:211], a[192:195], a[168:171], v[208:211]
  s_waitcnt lgkmcnt(10)
  buffer_load_dwordx4 v28, s[8:11], s48 offen offset:0  lds
  v_mfma_f32_16x16x32_bf16 v[224:227], a[192:195], a[176:179], v[224:227]
  s_waitcnt lgkmcnt(9)
  ds_read_b64_tr_b16 a[214:215], v40 offset:9216
  v_mfma_f32_16x16x32_bf16 v[224:227], a[196:199], a[180:183], v[224:227]
  s_waitcnt lgkmcnt(8)
  v_mfma_f32_16x16x32_bf16 v[240:243], a[196:199], a[188:191], v[240:243]
  s_waitcnt lgkmcnt(6)
  v_mfma_f32_16x16x32_bf16 v[240:243], a[192:195], a[184:187], v[240:243]
  v_mfma_f32_16x16x32_bf16 v[244:247], a[200:203], a[184:187], v[244:247]
  s_waitcnt lgkmcnt(4)
  v_mfma_f32_16x16x32_bf16 v[244:247], a[204:207], a[188:191], v[244:247]
  v_mfma_f32_16x16x32_bf16 v[228:231], a[204:207], a[180:183], v[228:231]
  buffer_load_dwordx4 v28, s[8:11], s49 offen offset:1024  lds
  v_mfma_f32_16x16x32_bf16 v[228:231], a[200:203], a[176:179], v[228:231]
  v_mfma_f32_16x16x32_bf16 v[212:215], a[200:203], a[168:171], v[212:215]
  v_mfma_f32_16x16x32_bf16 v[212:215], a[204:207], a[172:175], v[212:215]
  v_mfma_f32_16x16x32_bf16 v[196:199], a[204:207], a[164:167], v[196:199]
  ds_read_b64_tr_b16 a[216:217], v41 offset:0
  v_mfma_f32_16x16x32_bf16 v[196:199], a[200:203], a[160:163], v[196:199]
  ds_read_b64_tr_b16 a[218:219], v41 offset:1024
  v_mfma_f32_16x16x32_bf16 v[180:183], a[200:203], a[152:155], v[180:183]
  ds_read_b64_tr_b16 a[220:221], v41 offset:8192
  v_mfma_f32_16x16x32_bf16 v[180:183], a[204:207], a[156:159], v[180:183]
  buffer_load_dwordx4 v29, s[8:11], s50 offen offset:2048  lds
  v_mfma_f32_16x16x32_bf16 v[164:167], a[204:207], a[148:151], v[164:167]
  ds_read_b64_tr_b16 a[222:223], v41 offset:9216
  v_mfma_f32_16x16x32_bf16 v[164:167], a[200:203], a[144:147], v[164:167]
  v_mfma_f32_16x16x32_bf16 v[148:151], a[200:203], a[136:139], v[148:151]
  v_mfma_f32_16x16x32_bf16 v[148:151], a[204:207], a[140:143], v[148:151]
  v_mfma_f32_16x16x32_bf16 v[132:135], a[204:207], a[132:135], v[132:135]
  v_mfma_f32_16x16x32_bf16 v[132:135], a[200:203], a[128:131], v[132:135]
  s_waitcnt lgkmcnt(6)
  v_mfma_f32_16x16x32_bf16 v[136:139], a[208:211], a[128:131], v[136:139]
  s_waitcnt lgkmcnt(4)
  buffer_load_dwordx4 v29, s[8:11], s51 offen offset:3072  lds
  v_mfma_f32_16x16x32_bf16 v[136:139], a[212:215], a[132:135], v[136:139]
  v_mfma_f32_16x16x32_bf16 v[152:155], a[212:215], a[140:143], v[152:155]
  v_mfma_f32_16x16x32_bf16 v[152:155], a[208:211], a[136:139], v[152:155]
  v_mfma_f32_16x16x32_bf16 v[168:171], a[208:211], a[144:147], v[168:171]
  s_add_u32 m0, s96, 0x9000
  v_mfma_f32_16x16x32_bf16 v[168:171], a[212:215], a[148:151], v[168:171]
  v_mfma_f32_16x16x32_bf16 v[184:187], a[212:215], a[156:159], v[184:187]
  v_mfma_f32_16x16x32_bf16 v[184:187], a[208:211], a[152:155], v[184:187]
  s_waitcnt vmcnt(9)
  buffer_load_dwordx4 v24, s[4:7], s36 offen offset:0  lds
  v_mfma_f32_16x16x32_bf16 v[200:203], a[208:211], a[160:163], v[200:203]
  s_barrier
  v_mfma_f32_16x16x32_bf16 v[200:203], a[212:215], a[164:167], v[200:203]
  ds_read_b64_tr_b16 a[192:193], v38 offset:16384
  v_mfma_f32_16x16x32_bf16 v[216:219], a[212:215], a[172:175], v[216:219]
  ds_write_b128 v6, a[224:227] offset:0
  v_mfma_f32_16x16x32_bf16 v[216:219], a[208:211], a[168:171], v[216:219]
  ds_read_b64_tr_b16 a[194:195], v38 offset:17408
  v_mfma_f32_16x16x32_bf16 v[232:235], a[208:211], a[176:179], v[232:235]
  ds_write_b128 v6, a[228:231] offset:1024
  v_mfma_f32_16x16x32_bf16 v[232:235], a[212:215], a[180:183], v[232:235]
  ds_read_b64_tr_b16 a[196:197], v38 offset:24576
  v_mfma_f32_16x16x32_bf16 v[248:251], a[212:215], a[188:191], v[248:251]
  s_waitcnt vmcnt(7)
  ds_write_b128 v6, a[232:235] offset:2048
  v_lshlrev_b32 v96, 16, v104
  v_mfma_f32_16x16x32_bf16 v[248:251], a[208:211], a[184:187], v[248:251]
  s_waitcnt lgkmcnt(8)
  buffer_load_dwordx4 v25, s[4:7], s37 offen offset:1024  lds
  v_mfma_f32_16x16x32_bf16 v[252:255], a[216:219], a[184:187], v[252:255]
  s_waitcnt lgkmcnt(6)
  ds_write_b128 v6, a[236:239] offset:3072
  v_and_b32 v97, s101, v104
  v_mfma_f32_16x16x32_bf16 v[252:255], a[220:223], a[188:191], v[252:255]
  ds_read_b128 a[224:227], v22 offset:0
  v_lshlrev_b32 v98, 16, v112
  v_mfma_f32_16x16x32_bf16 v[236:239], a[220:223], a[180:183], v[236:239]
  ds_read_b128 a[228:231], v22 offset:1024
  v_and_b32 v99, s101, v112
  v_mfma_f32_16x16x32_bf16 v[236:239], a[216:219], a[176:179], v[236:239]
  ds_read_b128 a[232:235], v22 offset:2048
  v_lshlrev_b32 v100, 16, v120
  v_mfma_f32_16x16x32_bf16 v[220:223], a[216:219], a[168:171], v[220:223]
  ds_read_b128 a[236:239], v22 offset:3072
  v_and_b32 v101, s101, v120
  v_mfma_f32_16x16x32_bf16 v[220:223], a[220:223], a[172:175], v[220:223]
  buffer_load_dwordx4 v24, s[4:7], s38 offen offset:2048  lds
  v_mfma_f32_16x16x32_bf16 v[204:207], a[220:223], a[164:167], v[204:207]
  ds_read_b64_tr_b16 a[198:199], v38 offset:25600
  v_mul_f32 v102, v96, v98
  v_mfma_f32_16x16x32_bf16 v[204:207], a[216:219], a[160:163], v[204:207]
  ds_read_b64_tr_b16 a[200:201], v39 offset:16384
  v_mul_f32 v103, v96, v100
  v_mfma_f32_16x16x32_bf16 v[188:191], a[216:219], a[152:155], v[188:191]
  ds_read_b64_tr_b16 a[202:203], v39 offset:17408
  v_fmac_f32 v102, v97, v99
  v_mfma_f32_16x16x32_bf16 v[188:191], a[220:223], a[156:159], v[188:191]
  ds_read_b64_tr_b16 a[204:205], v39 offset:24576
  v_fmac_f32 v103, v97, v101
  v_mfma_f32_16x16x32_bf16 v[172:175], a[220:223], a[148:151], v[172:175]
  ds_read_b64_tr_b16 a[206:207], v39 offset:25600
  v_lshlrev_b32 v96, 16, v105
  v_mfma_f32_16x16x32_bf16 v[172:175], a[216:219], a[144:147], v[172:175]
  v_and_b32 v97, s101, v105
  v_lshlrev_b32 v98, 16, v113
  v_mfma_f32_16x16x32_bf16 v[156:159], a[216:219], a[136:139], v[156:159]
  buffer_load_dwordx4 v25, s[4:7], s39 offen offset:3072  lds
  v_mfma_f32_16x16x32_bf16 v[156:159], a[220:223], a[140:143], v[156:159]
  v_and_b32 v99, s101, v113
  v_lshlrev_b32 v100, 16, v121
  v_mfma_f32_16x16x32_bf16 v[140:143], a[220:223], a[132:135], v[140:143]
  v_and_b32 v101, s101, v121
  v_fmac_f32 v102, v96, v98
  v_mfma_f32_16x16x32_bf16 v[140:143], a[216:219], a[128:131], v[140:143]
  s_waitcnt lgkmcnt(13)
  v_fmac_f32 v103, v96, v100
  v_fmac_f32 v102, v97, v99
  v_mfma_f32_16x16x32_bf16 a[0:3], a[128:131], a[192:195], a[0:3]
  s_waitcnt lgkmcnt(4)
  v_fmac_f32 v103, v97, v101
  v_lshlrev_b32 v96, 16, v106
  v_mfma_f32_16x16x32_bf16 a[0:3], a[132:135], a[196:199], a[0:3]
  v_and_b32 v97, s101, v106
  v_lshlrev_b32 v98, 16, v114
  v_mfma_f32_16x16x32_bf16 a[16:19], a[140:143], a[196:199], a[16:19]
  v_and_b32 v99, s101, v114
  v_lshlrev_b32 v100, 16, v122
  v_mfma_f32_16x16x32_bf16 a[16:19], a[136:139], a[192:195], a[16:19]
  global_load_dword v17, v21, s[68:69]
  v_mfma_f32_16x16x32_bf16 a[32:35], a[144:147], a[192:195], a[32:35]
  v_add_u32 v21, 0x4000, v21
  v_and_b32 v101, s101, v122
  v_mfma_f32_16x16x32_bf16 a[32:35], a[148:151], a[196:199], a[32:35]
  v_fmac_f32 v102, v96, v98
  v_fmac_f32 v103, v96, v100
  v_mfma_f32_16x16x32_bf16 a[48:51], a[156:159], a[196:199], a[48:51]
  ds_read_b64_tr_b16 a[208:209], v40 offset:16384
  v_fmac_f32 v102, v97, v99
  v_mfma_f32_16x16x32_bf16 a[48:51], a[152:155], a[192:195], a[48:51]
  ds_read_b64_tr_b16 a[210:211], v40 offset:17408
  v_fmac_f32 v103, v97, v101
  v_mfma_f32_16x16x32_bf16 a[64:67], a[160:163], a[192:195], a[64:67]
  ds_read_b64_tr_b16 a[212:213], v40 offset:24576
  v_lshlrev_b32 v96, 16, v107
  v_mfma_f32_16x16x32_bf16 a[64:67], a[164:167], a[196:199], a[64:67]
  ds_read_b64_tr_b16 a[214:215], v40 offset:25600
  v_and_b32 v97, s101, v107
  v_mfma_f32_16x16x32_bf16 a[80:83], a[172:175], a[196:199], a[80:83]
  v_lshlrev_b32 v98, 16, v115
  v_and_b32 v99, s101, v115
  v_mfma_f32_16x16x32_bf16 a[80:83], a[168:171], a[192:195], a[80:83]
  v_lshlrev_b32 v100, 16, v123
  v_and_b32 v101, s101, v123
  v_mfma_f32_16x16x32_bf16 a[96:99], a[176:179], a[192:195], a[96:99]
  v_fmac_f32 v102, v96, v98
  v_fmac_f32 v103, v96, v100
  v_mfma_f32_16x16x32_bf16 a[96:99], a[180:183], a[196:199], a[96:99]
  v_fmac_f32 v102, v97, v99
  v_fmac_f32 v103, v97, v101
  v_mfma_f32_16x16x32_bf16 a[112:115], a[188:191], a[196:199], a[112:115]
  s_waitcnt vmcnt(10)
  s_add_u32 m0, s97, 0x1c000
  v_lshlrev_b32 v96, 16, v108
  v_and_b32 v97, s101, v108
  v_mfma_f32_16x16x32_bf16 a[112:115], a[184:187], a[192:195], a[112:115]
  s_waitcnt lgkmcnt(6)
  v_lshlrev_b32 v98, 16, v116
  v_and_b32 v99, s101, v116
  v_mfma_f32_16x16x32_bf16 a[116:119], a[184:187], a[200:203], a[116:119]
  s_waitcnt lgkmcnt(4)
  v_lshlrev_b32 v100, 16, v124
  v_and_b32 v101, s101, v124
  v_mfma_f32_16x16x32_bf16 a[116:119], a[188:191], a[204:207], a[116:119]
  buffer_load_dwordx4 v28, s[12:15], s48 offen offset:0  lds
  v_mfma_f32_16x16x32_bf16 a[100:103], a[180:183], a[204:207], a[100:103]
  v_fmac_f32 v102, v96, v98
  v_fmac_f32 v103, v96, v100
  v_mfma_f32_16x16x32_bf16 a[100:103], a[176:179], a[200:203], a[100:103]
  v_fmac_f32 v102, v97, v99
  v_fmac_f32 v103, v97, v101
  v_mfma_f32_16x16x32_bf16 a[84:87], a[168:171], a[200:203], a[84:87]
  v_lshlrev_b32 v96, 16, v109
  v_and_b32 v97, s101, v109
  v_mfma_f32_16x16x32_bf16 a[84:87], a[172:175], a[204:207], a[84:87]
  v_lshlrev_b32 v98, 16, v117
  v_and_b32 v99, s101, v117
  v_mfma_f32_16x16x32_bf16 a[68:71], a[164:167], a[204:207], a[68:71]
  ds_read_b64_tr_b16 a[216:217], v41 offset:16384
  v_lshlrev_b32 v100, 16, v125
  v_mfma_f32_16x16x32_bf16 a[68:71], a[160:163], a[200:203], a[68:71]
  ds_read_b64_tr_b16 a[218:219], v41 offset:17408
  v_and_b32 v101, s101, v125
  v_mfma_f32_16x16x32_bf16 a[52:55], a[152:155], a[200:203], a[52:55]
  buffer_load_dwordx4 v28, s[12:15], s49 offen offset:1024  lds
  v_mfma_f32_16x16x32_bf16 a[52:55], a[156:159], a[204:207], a[52:55]
  ds_read_b64_tr_b16 a[220:221], v41 offset:24576
  v_fmac_f32 v102, v96, v98
  v_mfma_f32_16x16x32_bf16 a[36:39], a[148:151], a[204:207], a[36:39]
  ds_read_b64_tr_b16 a[222:223], v41 offset:25600
  v_fmac_f32 v103, v96, v100
  v_mfma_f32_16x16x32_bf16 a[36:39], a[144:147], a[200:203], a[36:39]
  v_fmac_f32 v102, v97, v99
  v_fmac_f32 v103, v97, v101
  v_mfma_f32_16x16x32_bf16 a[20:23], a[136:139], a[200:203], a[20:23]
  v_lshlrev_b32 v96, 16, v110
  v_and_b32 v97, s101, v110
  v_mfma_f32_16x16x32_bf16 a[20:23], a[140:143], a[204:207], a[20:23]
  v_lshlrev_b32 v98, 16, v118
  v_and_b32 v99, s101, v118
  v_mfma_f32_16x16x32_bf16 a[4:7], a[132:135], a[204:207], a[4:7]
  v_lshlrev_b32 v100, 16, v126
  v_and_b32 v101, s101, v126
  v_mfma_f32_16x16x32_bf16 a[4:7], a[128:131], a[200:203], a[4:7]
  s_waitcnt lgkmcnt(6)
  buffer_load_dwordx4 v29, s[12:15], s50 offen offset:2048  lds
  v_mfma_f32_16x16x32_bf16 a[8:11], a[128:131], a[208:211], a[8:11]
  s_waitcnt lgkmcnt(4)
  v_fmac_f32 v102, v96, v98
  v_fmac_f32 v103, v96, v100
  v_mfma_f32_16x16x32_bf16 a[8:11], a[132:135], a[212:215], a[8:11]
  v_fmac_f32 v102, v97, v99
  v_fmac_f32 v103, v97, v101
  v_mfma_f32_16x16x32_bf16 a[24:27], a[140:143], a[212:215], a[24:27]
  v_lshlrev_b32 v96, 16, v111
  v_and_b32 v97, s101, v111
  v_mfma_f32_16x16x32_bf16 a[24:27], a[136:139], a[208:211], a[24:27]
  v_lshlrev_b32 v98, 16, v119
  v_and_b32 v99, s101, v119
  v_mfma_f32_16x16x32_bf16 a[40:43], a[144:147], a[208:211], a[40:43]
  v_lshlrev_b32 v100, 16, v127
  v_and_b32 v101, s101, v127
  v_mfma_f32_16x16x32_bf16 a[40:43], a[148:151], a[212:215], a[40:43]
  v_fmac_f32 v102, v96, v98
  v_fmac_f32 v103, v96, v100
  v_mfma_f32_16x16x32_bf16 a[56:59], a[156:159], a[212:215], a[56:59]
  buffer_load_dwordx4 v29, s[12:15], s51 offen offset:3072  lds
  v_mfma_f32_16x16x32_bf16 a[56:59], a[152:155], a[208:211], a[56:59]
  s_mov_b32 s4, s92
  v_fmac_f32 v102, v97, v99
  v_fmac_f32 v103, v97, v101
  v_mfma_f32_16x16x32_bf16 a[72:75], a[160:163], a[208:211], a[72:75]
  s_waitcnt vmcnt(5)
  s_mov_b32 s5, s93
  s_barrier
  v_mfma_f32_16x16x32_bf16 a[72:75], a[164:167], a[212:215], a[72:75]
  s_mov_b32 s6, 256
  ds_read_b64_tr_b16 a[192:193], v38 offset:32768
  v_add_f32_dpp v102, v102, v102 row_ror:8 row_mask:0xf bank_mask:0xf
  v_mfma_f32_16x16x32_bf16 a[88:91], a[172:175], a[212:215], a[88:91]
  s_lshl_b32 s100, s29, 2
  ds_read_b64_tr_b16 a[194:195], v38 offset:33792
  v_add_f32_dpp v103, v103, v103 row_ror:8 row_mask:0xf bank_mask:0xf
  v_mfma_f32_16x16x32_bf16 a[88:91], a[168:171], a[208:211], a[88:91]
  ds_read_b64_tr_b16 a[196:197], v38 offset:40960
  v_mfma_f32_16x16x32_bf16 a[104:107], a[176:179], a[208:211], a[104:107]
  ds_read_b64_tr_b16 a[198:199], v38 offset:41984
  v_add_f32_dpp v102, v102, v102 row_ror:4 row_mask:0xf bank_mask:0xf
  v_mfma_f32_16x16x32_bf16 a[104:107], a[180:183], a[212:215], a[104:107]
  buffer_load_dword v10, off, s[4:7], s100 offset:0 sc1
  v_mfma_f32_16x16x32_bf16 a[120:123], a[188:191], a[212:215], a[120:123]
  s_add_u32 m0, s96, 0x20000
  v_add_f32_dpp v103, v103, v103 row_ror:4 row_mask:0xf bank_mask:0xf
  v_mfma_f32_16x16x32_bf16 a[120:123], a[184:187], a[208:211], a[120:123]
  s_waitcnt lgkmcnt(6)
  v_mfma_f32_16x16x32_bf16 a[124:127], a[184:187], a[216:219], a[124:127]
  s_waitcnt lgkmcnt(4)
  buffer_load_dwordx4 v26, s[56:59], s40 offen offset:0  lds
  v_mfma_f32_16x16x32_bf16 a[124:127], a[188:191], a[220:223], a[124:127]
  ds_read_b128 a[184:187], v30 offset:47104
  v_add_f32_dpp v102, v102, v102 row_ror:2 row_mask:0xf bank_mask:0xf
  v_mfma_f32_16x16x32_bf16 a[108:111], a[180:183], a[220:223], a[108:111]
  ds_read_b128 a[188:191], v31 offset:47104
  v_add_f32_dpp v103, v103, v103 row_ror:2 row_mask:0xf bank_mask:0xf
  v_mfma_f32_16x16x32_bf16 a[108:111], a[176:179], a[216:219], a[108:111]
  buffer_load_dwordx4 v27, s[56:59], s41 offen offset:1024  lds
  v_mfma_f32_16x16x32_bf16 a[92:95], a[168:171], a[216:219], a[92:95]
  ds_read_b128 a[180:183], v31 offset:45056
  v_add_f32_dpp v102, v102, v102 row_ror:1 row_mask:0xf bank_mask:0xf
  v_mfma_f32_16x16x32_bf16 a[92:95], a[172:175], a[220:223], a[92:95]
  ds_read_b128 a[176:179], v30 offset:45056
  v_add_f32_dpp v103, v103, v103 row_ror:1 row_mask:0xf bank_mask:0xf
  v_mfma_f32_16x16x32_bf16 a[76:79], a[164:167], a[220:223], a[76:79]
  ds_read_b128 a[168:171], v30 offset:43008
  v_mfma_f32_16x16x32_bf16 a[76:79], a[160:163], a[216:219], a[76:79]
  buffer_load_dwordx4 v26, s[56:59], s42 offen offset:2048  lds
  v_mfma_f32_16x16x32_bf16 a[60:63], a[152:155], a[216:219], a[60:63]
  ds_read_b128 a[172:175], v31 offset:43008
  v_mov_b32 v96, v102
  v_mfma_f32_16x16x32_bf16 a[60:63], a[156:159], a[220:223], a[60:63]
  ds_read_b128 a[164:167], v31 offset:40960
  v_mfma_f32_16x16x32_bf16 a[44:47], a[148:151], a[220:223], a[44:47]
  ds_read_b128 a[160:163], v30 offset:40960
  v_mov_b32 v97, v103
  v_mfma_f32_16x16x32_bf16 a[44:47], a[144:147], a[216:219], a[44:47]
  ds_read_b128 a[152:155], v30 offset:38912
  v_mfma_f32_16x16x32_bf16 a[28:31], a[136:139], a[216:219], a[28:31]
  buffer_load_dwordx4 v27, s[56:59], s43 offen offset:3072  lds
  v_mfma_f32_16x16x32_bf16 a[28:31], a[140:143], a[220:223], a[28:31]
  ds_read_b128 a[156:159], v31 offset:38912
  v_permlane32_swap_b32 v96, v102
  v_mfma_f32_16x16x32_bf16 a[12:15], a[132:135], a[220:223], a[12:15]
  s_add_u32 m0, s96, 0x21000
  ds_read_b128 a[148:151], v31 offset:36864
  v_mfma_f32_16x16x32_bf16 a[12:15], a[128:131], a[216:219], a[12:15]
  s_waitcnt lgkmcnt(10)
  ds_read_b128 a[144:147], v30 offset:36864
  v_mfma_f32_16x16x32_bf16 v[240:243], a[192:195], a[184:187], v[240:243]
L_gq0:
  ds_read_b128 a[136:139], v30 offset:34816
  s_waitcnt lgkmcnt(11)
  v_mfma_f32_16x16x32_bf16 v[240:243], a[196:199], a[188:191], v[240:243]
  s_waitcnt lgkmcnt(10)
  buffer_load_dwordx4 v26, s[56:59], s44 offen offset:0  lds
  v_mfma_f32_16x16x32_bf16 v[224:227], a[196:199], a[180:183], v[224:227]
  s_waitcnt lgkmcnt(9)
  ds_read_b128 a[140:143], v31 offset:34816
  v_permlane32_swap_b32 v97, v103
  v_mfma_f32_16x16x32_bf16 v[224:227], a[192:195], a[176:179], v[224:227]
  s_waitcnt lgkmcnt(9)
  ds_read_b64_tr_b16 a[200:201], v39 offset:32768
  v_mfma_f32_16x16x32_bf16 v[208:211], a[192:195], a[168:171], v[208:211]
  s_waitcnt lgkmcnt(9)
  ds_read_b128 a[132:135], v31 offset:32768
  v_add_f32 v102, v102, v96
  v_mfma_f32_16x16x32_bf16 v[208:211], a[196:199], a[172:175], v[208:211]
  s_waitcnt lgkmcnt(9)
  buffer_load_dwordx4 v27, s[56:59], s45 offen offset:1024  lds
  v_mfma_f32_16x16x32_bf16 v[192:195], a[196:199], a[164:167], v[192:195]
  s_waitcnt lgkmcnt(8)
  ds_read_b64_tr_b16 a[202:203], v39 offset:33792
  v_add_f32 v103, v103, v97
  v_mfma_f32_16x16x32_bf16 v[192:195], a[192:195], a[160:163], v[192:195]
  s_waitcnt lgkmcnt(8)
  ds_read_b128 a[128:131], v30 offset:32768
  v_mfma_f32_16x16x32_bf16 v[176:179], a[192:195], a[152:155], v[176:179]
  s_waitcnt lgkmcnt(8)
  ds_read_b64_tr_b16 a[204:205], v39 offset:40960
  v_mov_b32 v96, v102
  v_mfma_f32_16x16x32_bf16 v[176:179], a[196:199], a[156:159], v[176:179]
  s_waitcnt lgkmcnt(8)
  ds_read_b64_tr_b16 a[206:207], v39 offset:41984
  v_mfma_f32_16x16x32_bf16 v[160:163], a[196:199], a[148:151], v[160:163]
  s_waitcnt lgkmcnt(8)
  buffer_load_dwordx4 v26, s[56:59], s46 offen offset:2048  lds
  v_mfma_f32_16x16x32_bf16 v[160:163], a[192:195], a[144:147], v[160:163]
  s_waitcnt lgkmcnt(7)
  ds_read_b64_tr_b16 a[208:209], v40 offset:32768
  v_mov_b32 v97, v103
  v_mfma_f32_16x16x32_bf16 v[144:147], a[192:195], a[136:139], v[144:147]
  s_waitcnt lgkmcnt(7)
  ds_read_b64_tr_b16 a[210:211], v40 offset:33792
  v_mfma_f32_16x16x32_bf16 v[144:147], a[196:199], a[140:143], v[144:147]
  s_waitcnt lgkmcnt(6)
  ds_read_b64_tr_b16 a[212:213], v40 offset:40960
  v_permlane16_swap_b32 v96, v102
  v_mfma_f32_16x16x32_bf16 v[128:131], a[196:199], a[132:135], v[128:131]
  s_waitcnt lgkmcnt(5)
  ds_read_b64_tr_b16 a[214:215], v40 offset:41984
  v_permlane16_swap_b32 v97, v103
  v_mfma_f32_16x16x32_bf16 v[128:131], a[192:195], a[128:131], v[128:131]
  buffer_load_dwordx4 v27, s[56:59], s47 offen offset:3072  lds
  v_mfma_f32_16x16x32_bf16 v[132:135], a[200:203], a[128:131], v[132:135]
  s_waitcnt lgkmcnt(4)
  v_xor_b32 v28, s99, v28
  v_add_f32 v102, v102, v96
  v_mfma_f32_16x16x32_bf16 v[132:135], a[204:207], a[132:135], v[132:135]
  v_xor_b32 v29, s99, v29
  v_add_f32 v103, v103, v97
  v_mfma_f32_16x16x32_bf16 v[148:151], a[204:207], a[140:143], v[148:151]
  s_add_u32 m0, s97, 0x10000
  v_mul_f32 v102, 0xbfb8aa3b, v102
  v_mul_f32 v103, 0xbfb8aa3b, v103
  v_mfma_f32_16x16x32_bf16 v[148:151], a[200:203], a[136:139], v[148:151]
  buffer_load_dwordx4 v28, s[60:63], s48 offen offset:0  lds
  v_mfma_f32_16x16x32_bf16 v[164:167], a[200:203], a[144:147], v[164:167]
  v_exp_f32 v102, v102
  v_mfma_f32_16x16x32_bf16 v[164:167], a[204:207], a[148:151], v[164:167]
  v_exp_f32 v103, v103
  v_mfma_f32_16x16x32_bf16 v[180:183], a[204:207], a[156:159], v[180:183]
  v_add_f32 v102, 1.0, v102
  v_add_f32 v103, 1.0, v103
  v_mfma_f32_16x16x32_bf16 v[180:183], a[200:203], a[152:155], v[180:183]
  v_rcp_f32 v102, v102
  v_mfma_f32_16x16x32_bf16 v[196:199], a[200:203], a[160:163], v[196:199]
  buffer_load_dwordx4 v28, s[60:63], s49 offen offset:1024  lds
  v_mfma_f32_16x16x32_bf16 v[196:199], a[204:207], a[164:167], v[196:199]
  v_rcp_f32 v103, v103
  v_mfma_f32_16x16x32_bf16 v[212:215], a[204:207], a[172:175], v[212:215]
  v_lshlrev_b32 v16, 24, v1
  v_accvgpr_write_b32 a240, v102
  v_mfma_f32_16x16x32_bf16 v[212:215], a[200:203], a[168:171], v[212:215]
  ds_read_b64_tr_b16 a[216:217], v41 offset:32768
  v_accvgpr_write_b32 a241, v103
  v_mfma_f32_16x16x32_bf16 v[228:231], a[200:203], a[176:179], v[228:231]
  ds_read_b64_tr_b16 a[218:219], v41 offset:33792
  v_cvt_pk_bf16_f32 v64, v128, v129
  v_mfma_f32_16x16x32_bf16 v[228:231], a[204:207], a[180:183], v[228:231]
  buffer_load_dwordx4 v29, s[60:63], s50 offen offset:2048  lds
  v_mfma_f32_16x16x32_bf16 v[244:247], a[204:207], a[188:191], v[244:247]
  ds_read_b64_tr_b16 a[220:221], v41 offset:40960
  v_cvt_pk_bf16_f32 v65, v130, v131
  v_mfma_f32_16x16x32_bf16 v[244:247], a[200:203], a[184:187], v[244:247]
  s_waitcnt lgkmcnt(5)
  ds_read_b64_tr_b16 a[222:223], v41 offset:41984
  v_cvt_pk_bf16_f32 v80, v160, v161
  v_mfma_f32_16x16x32_bf16 v[248:251], a[208:211], a[184:187], v[248:251]
  s_waitcnt lgkmcnt(4)
  v_cvt_pk_bf16_f32 v81, v162, v163
  v_mfma_f32_16x16x32_bf16 v[248:251], a[212:215], a[188:191], v[248:251]
  buffer_load_dwordx4 v29, s[60:63], s51 offen offset:3072  lds
  v_mfma_f32_16x16x32_bf16 v[232:235], a[212:215], a[180:183], v[232:235]
  s_add_u32 s52, s94, 0x3000000
  s_addc_u32 s53, s95, 0
  v_mfma_f32_16x16x32_bf16 v[232:235], a[208:211], a[176:179], v[232:235]
  s_mov_b32 s54, 0xc02000
  v_mfma_f32_16x16x32_bf16 v[216:219], a[208:211], a[168:171], v[216:219]
  s_lshl_b32 s76, s2, 5
  v_cvt_pk_bf16_f32 v96, v192, v193
  v_mfma_f32_16x16x32_bf16 v[216:219], a[212:215], a[172:175], v[216:219]
  s_lshl_b32 s77, s28, 3
  v_cvt_pk_bf16_f32 v97, v194, v195
  v_mfma_f32_16x16x32_bf16 v[200:203], a[212:215], a[164:167], v[200:203]
  s_add_u32 s76, s76, s77
  v_cvt_pk_bf16_f32 v112, v224, v225
  v_mfma_f32_16x16x32_bf16 v[200:203], a[208:211], a[160:163], v[200:203]
  s_add_u32 s76, s76, 0xc00000
  v_mfma_f32_16x16x32_bf16 v[184:187], a[208:211], a[152:155], v[184:187]
  s_waitcnt vmcnt(13)
  s_barrier
  v_mfma_f32_16x16x32_bf16 v[184:187], a[212:215], a[156:159], v[184:187]
  buffer_store_dwordx2 a[240:241], v16, s[52:55], s76 offen sc1
  v_mfma_f32_16x16x32_bf16 v[168:171], a[212:215], a[148:151], v[168:171]
  s_mov_b32 s76, 0
  ds_read_b64_tr_b16 a[192:193], v38 offset:49152
  v_cvt_pk_bf16_f32 v113, v226, v227
  v_mfma_f32_16x16x32_bf16 v[168:171], a[208:211], a[144:147], v[168:171]
  ds_read_b64_tr_b16 a[194:195], v38 offset:50176
  v_mfma_f32_16x16x32_bf16 v[152:155], a[208:211], a[136:139], v[152:155]
  buffer_store_dwordx4 a[224:227], v20, s[52:55], s76 offen sc1
  v_mfma_f32_16x16x32_bf16 v[152:155], a[212:215], a[140:143], v[152:155]
  s_mov_b32 s76, 8192
  ds_read_b64_tr_b16 a[196:197], v38 offset:57344
  v_mfma_f32_16x16x32_bf16 v[136:139], a[212:215], a[132:135], v[136:139]
  ds_read_b64_tr_b16 a[198:199], v38 offset:58368
  v_mfma_f32_16x16x32_bf16 v[136:139], a[208:211], a[128:131], v[136:139]
  s_waitcnt lgkmcnt(6)
  v_cvt_pk_bf16_f32 v114, v228, v229
  v_mfma_f32_16x16x32_bf16 v[140:143], a[216:219], a[128:131], v[140:143]
  s_waitcnt lgkmcnt(4)
  buffer_store_dwordx4 a[228:231], v20, s[52:55], s76 offen sc1
  v_mfma_f32_16x16x32_bf16 v[140:143], a[220:223], a[132:135], v[140:143]
  v_cvt_pk_bf16_f32 v115, v230, v231
  v_mfma_f32_16x16x32_bf16 v[156:159], a[220:223], a[140:143], v[156:159]
  s_mov_b32 s76, 16384
  v_cvt_pk_bf16_f32 v98, v196, v197
  v_mfma_f32_16x16x32_bf16 v[156:159], a[216:219], a[136:139], v[156:159]
  v_cvt_pk_bf16_f32 v99, v198, v199
  v_mfma_f32_16x16x32_bf16 v[172:175], a[216:219], a[144:147], v[172:175]
  v_cvt_pk_bf16_f32 v82, v164, v165
  v_mfma_f32_16x16x32_bf16 v[172:175], a[220:223], a[148:151], v[172:175]
  buffer_store_dwordx4 a[232:235], v20, s[52:55], s76 offen sc1
  v_mfma_f32_16x16x32_bf16 v[188:191], a[220:223], a[156:159], v[188:191]
  ds_read_b64_tr_b16 a[200:201], v39 offset:49152
  v_cvt_pk_bf16_f32 v83, v166, v167
  v_mfma_f32_16x16x32_bf16 v[188:191], a[216:219], a[152:155], v[188:191]
  s_mov_b32 s76, 24576
  ds_read_b64_tr_b16 a[202:203], v39 offset:50176
  v_mfma_f32_16x16x32_bf16 v[204:207], a[216:219], a[160:163], v[204:207]
L_pad4:
  s_cbranch_execz L_pad8
  ds_read_b64_tr_b16 a[204:205], v39 offset:57344
  v_mfma_f32_16x16x32_bf16 v[204:207], a[220:223], a[164:167], v[204:207]
  ds_read_b64_tr_b16 a[206:207], v39 offset:58368
  v_mfma_f32_16x16x32_bf16 v[220:223], a[220:223], a[172:175], v[220:223]
  buffer_store_dwordx4 a[236:239], v20, s[52:55], s76 offen sc1
  v_mfma_f32_16x16x32_bf16 v[220:223], a[216:219], a[168:171], v[220:223]
  v_xor_b32 v26, 0x80, v26
  v_mfma_f32_16x16x32_bf16 v[236:239], a[216:219], a[176:179], v[236:239]
  v_xor_b32 v27, 0x80, v27
  v_mfma_f32_16x16x32_bf16 v[236:239], a[220:223], a[180:183], v[236:239]
  s_add_u32 m0, s96, 0x0
  v_cvt_pk_bf16_f32 v66, v132, v133
  v_mfma_f32_16x16x32_bf16 v[252:255], a[220:223], a[188:191], v[252:255]
  v_cvt_pk_bf16_f32 v67, v134, v135
  v_mfma_f32_16x16x32_bf16 v[252:255], a[216:219], a[184:187], v[252:255]
  s_waitcnt lgkmcnt(6)
  buffer_load_dwordx4 v26, s[56:59], s40 offen offset:0  lds
  v_mfma_f32_16x16x32_bf16 a[112:115], a[184:187], a[192:195], a[112:115]
  s_waitcnt lgkmcnt(4)
  v_mul_f32 v136, s83, v136
  v_mul_f32 v137, s83, v137
  v_mfma_f32_16x16x32_bf16 a[112:115], a[188:191], a[196:199], a[112:115]
  s_waitcnt vmcnt(18)
  v_cmp_eq_u32 vcc, 0, v10
  s_nop 2
  s_cbranch_vccnz L_clr_wait
L_clr_ok:
  v_mfma_f32_16x16x32_bf16 a[96:99], a[180:183], a[196:199], a[96:99]
  s_waitcnt vmcnt(10)
  ds_read_b128 a[224:227], v36 offset:0
  v_mul_f32 v138, s83, v138
  v_mfma_f32_16x16x32_bf16 a[96:99], a[176:179], a[192:195], a[96:99]
  v_mul_f32 v139, s83, v139
  v_cvt_pk_bf16_f32 v68, v136, v137
  v_mfma_f32_16x16x32_bf16 a[80:83], a[168:171], a[192:195], a[80:83]
  buffer_load_dwordx4 v27, s[56:59], s41 offen offset:1024  lds
  v_mfma_f32_16x16x32_bf16 a[80:83], a[172:175], a[196:199], a[80:83]
  v_cvt_pk_bf16_f32 v69, v138, v139
  v_mul_f32 v168, s83, v168
  v_mfma_f32_16x16x32_bf16 a[64:67], a[164:167], a[196:199], a[64:67]
  ds_read_b64_tr_b16 a[208:209], v40 offset:49152
  v_mul_f32 v169, s83, v169
  v_mfma_f32_16x16x32_bf16 a[64:67], a[160:163], a[192:195], a[64:67]
  ds_read_b64_tr_b16 a[210:211], v40 offset:50176
  v_mfma_f32_16x16x32_bf16 a[48:51], a[152:155], a[192:195], a[48:51]
  ds_read_b64_tr_b16 a[212:213], v40 offset:57344
  v_mul_f32 v170, s83, v170
  v_mfma_f32_16x16x32_bf16 a[48:51], a[156:159], a[196:199], a[48:51]
  buffer_load_dwordx4 v26, s[56:59], s42 offen offset:2048  lds
  v_mfma_f32_16x16x32_bf16 a[32:35], a[148:151], a[196:199], a[32:35]
  ds_read_b64_tr_b16 a[214:215], v40 offset:58368
  v_mul_f32 v171, s83, v171
  v_mfma_f32_16x16x32_bf16 a[32:35], a[144:147], a[192:195], a[32:35]
  ds_read_b128 a[228:231], v37 offset:0
  v_mfma_f32_16x16x32_bf16 a[16:19], a[136:139], a[192:195], a[16:19]
  ds_read_b128 a[232:235], v36 offset:2048
  v_cvt_pk_bf16_f32 v84, v168, v169
  v_mfma_f32_16x16x32_bf16 a[16:19], a[140:143], a[196:199], a[16:19]
  buffer_load_dwordx4 v27, s[56:59], s43 offen offset:3072  lds
  v_mfma_f32_16x16x32_bf16 a[0:3], a[132:135], a[196:199], a[0:3]
  s_add_u32 m0, s96, 0x1000
  ds_read_b128 a[236:239], v37 offset:2048
  v_mfma_f32_16x16x32_bf16 a[0:3], a[128:131], a[192:195], a[0:3]
  s_waitcnt lgkmcnt(10)
  v_mfma_f32_16x16x32_bf16 a[4:7], a[128:131], a[200:203], a[4:7]
  s_waitcnt lgkmcnt(8)
  buffer_load_dwordx4 v26, s[56:59], s44 offen offset:0  lds
  v_mfma_f32_16x16x32_bf16 a[4:7], a[132:135], a[204:207], a[4:7]
  v_cvt_pk_bf16_f32 v85, v170, v171
  v_mul_f32 v200, s83, v200
  v_mfma_f32_16x16x32_bf16 a[20:23], a[140:143], a[204:207], a[20:23]
  ds_read_b128 a[240:243], v36 offset:4096
  v_mul_f32 v201, s83, v201
  v_mfma_f32_16x16x32_bf16 a[20:23], a[136:139], a[200:203], a[20:23]
  buffer_load_dwordx4 v27, s[56:59], s45 offen offset:1024  lds
  v_mfma_f32_16x16x32_bf16 a[36:39], a[144:147], a[200:203], a[36:39]
  v_mul_f32 v202, s83, v202
  v_mul_f32 v203, s83, v203
  v_mfma_f32_16x16x32_bf16 a[36:39], a[148:151], a[204:207], a[36:39]
  v_cvt_pk_bf16_f32 v100, v200, v201
  v_cvt_pk_bf16_f32 v101, v202, v203
  v_mfma_f32_16x16x32_bf16 a[52:55], a[156:159], a[204:207], a[52:55]
  ds_read_b64_tr_b16 a[216:217], v41 offset:49152
  v_mfma_f32_16x16x32_bf16 a[52:55], a[152:155], a[200:203], a[52:55]
  buffer_load_dwordx4 v26, s[56:59], s46 offen offset:2048  lds
  v_mfma_f32_16x16x32_bf16 a[68:71], a[160:163], a[200:203], a[68:71]
  ds_read_b64_tr_b16 a[218:219], v41 offset:50176
  v_mul_f32 v232, s83, v232
  v_mfma_f32_16x16x32_bf16 a[68:71], a[164:167], a[204:207], a[68:71]
  ds_read_b64_tr_b16 a[220:221], v41 offset:57344
  v_mfma_f32_16x16x32_bf16 a[84:87], a[172:175], a[204:207], a[84:87]
  buffer_load_dwordx4 v27, s[56:59], s47 offen offset:3072  lds
  v_mfma_f32_16x16x32_bf16 a[84:87], a[168:171], a[200:203], a[84:87]
  ds_read_b64_tr_b16 a[222:223], v41 offset:58368
  v_xor_b32 v28, 0x80000, v28
  v_mfma_f32_16x16x32_bf16 a[100:103], a[176:179], a[200:203], a[100:103]
  ds_read_b128 a[244:247], v37 offset:4096
  v_xor_b32 v29, 0x80000, v29
  v_mfma_f32_16x16x32_bf16 a[100:103], a[180:183], a[204:207], a[100:103]
  s_add_u32 m0, s97, 0x14000
  ds_read_b128 a[248:251], v36 offset:6144
  v_mfma_f32_16x16x32_bf16 a[116:119], a[188:191], a[204:207], a[116:119]
  ds_read_b128 a[252:255], v37 offset:6144
  v_mfma_f32_16x16x32_bf16 a[116:119], a[184:187], a[200:203], a[116:119]
  s_waitcnt lgkmcnt(13)
  v_mfma_f32_16x16x32_bf16 a[120:123], a[184:187], a[208:211], a[120:123]
  s_waitcnt lgkmcnt(11)
  buffer_load_dwordx4 v28, s[60:63], s48 offen offset:0  lds
  v_mfma_f32_16x16x32_bf16 a[120:123], a[188:191], a[212:215], a[120:123]
  v_mul_f32 v233, s83, v233
  v_mul_f32 v234, s83, v234
  v_mfma_f32_16x16x32_bf16 a[104:107], a[180:183], a[212:215], a[104:107]
  v_mul_f32 v235, s83, v235
  v_cvt_pk_bf16_f32 v116, v232, v233
  v_mfma_f32_16x16x32_bf16 a[104:107], a[176:179], a[208:211], a[104:107]
  v_cvt_pk_bf16_f32 v117, v234, v235
  v_mfma_f32_16x16x32_bf16 a[88:91], a[168:171], a[208:211], a[88:91]
  v_mul_f32 v236, s83, v236
  v_mul_f32 v237, s83, v237
  v_mfma_f32_16x16x32_bf16 a[88:91], a[172:175], a[212:215], a[88:91]
  buffer_load_dwordx4 v28, s[60:63], s49 offen offset:1024  lds
  v_mfma_f32_16x16x32_bf16 a[72:75], a[164:167], a[212:215], a[72:75]
  v_mul_f32 v238, s83, v238
  v_mul_f32 v239, s83, v239
  v_mfma_f32_16x16x32_bf16 a[72:75], a[160:163], a[208:211], a[72:75]
  s_waitcnt vmcnt(15)
  v_mul_f32 v204, s83, v204
  v_mul_f32 v205, s83, v205
  v_mfma_f32_16x16x32_bf16 a[56:59], a[152:155], a[208:211], a[56:59]
  s_barrier
  v_mfma_f32_16x16x32_bf16 a[56:59], a[156:159], a[212:215], a[56:59]
  ds_read_b64_tr_b16 a[192:193], v42 offset:0
  v_mul_f32 v206, s83, v206
  v_mfma_f32_16x16x32_bf16 a[40:43], a[148:151], a[212:215], a[40:43]
  buffer_load_dwordx4 v29, s[60:63], s50 offen offset:2048  lds
  v_mfma_f32_16x16x32_bf16 a[40:43], a[144:147], a[208:211], a[40:43]
  ds_read_b64_tr_b16 a[194:195], v42 offset:1024
  v_mul_f32 v207, s83, v207
  v_mfma_f32_16x16x32_bf16 a[24:27], a[136:139], a[208:211], a[24:27]
  ds_read_b64_tr_b16 a[196:197], v42 offset:8192
  v_cvt_pk_bf16_f32 v118, v236, v237
  v_mfma_f32_16x16x32_bf16 a[24:27], a[140:143], a[212:215], a[24:27]
  ds_read_b64_tr_b16 a[198:199], v42 offset:9216
  v_cvt_pk_bf16_f32 v119, v238, v239
  v_mfma_f32_16x16x32_bf16 a[8:11], a[132:135], a[212:215], a[8:11]
  buffer_load_dwordx4 v29, s[60:63], s51 offen offset:3072  lds
  v_mfma_f32_16x16x32_bf16 a[8:11], a[128:131], a[208:211], a[8:11]
  s_waitcnt lgkmcnt(9)
  ds_read_b64_tr_b16 a[200:201], v43 offset:0
  v_xor_b32 v26, 0x180, v26
  v_mfma_f32_16x16x32_bf16 a[12:15], a[128:131], a[216:219], a[12:15]
  s_waitcnt lgkmcnt(8)
  ds_read_b64_tr_b16 a[202:203], v43 offset:1024
  v_xor_b32 v27, 0x180, v27
  v_mfma_f32_16x16x32_bf16 a[12:15], a[132:135], a[220:223], a[12:15]
  s_add_u32 m0, s96, 0x8000
  ds_read_b64_tr_b16 a[204:205], v43 offset:8192
  v_mul_f32 v172, s83, v172
  v_mfma_f32_16x16x32_bf16 a[28:31], a[140:143], a[220:223], a[28:31]
  ds_read_b64_tr_b16 a[206:207], v43 offset:9216
  v_mul_f32 v173, s83, v173
  v_mfma_f32_16x16x32_bf16 a[28:31], a[136:139], a[216:219], a[28:31]
  buffer_load_dwordx4 v26, s[56:59], s40 offen offset:0  lds
  v_mfma_f32_16x16x32_bf16 a[44:47], a[144:147], a[216:219], a[44:47]
  v_mul_f32 v174, s83, v174
  v_mul_f32 v175, s83, v175
  v_mfma_f32_16x16x32_bf16 a[44:47], a[148:151], a[220:223], a[44:47]
  v_cvt_pk_bf16_f32 v102, v204, v205
  v_cvt_pk_bf16_f32 v103, v206, v207
  v_mfma_f32_16x16x32_bf16 a[60:63], a[156:159], a[220:223], a[60:63]
  ds_read_b64_tr_b16 a[208:209], v44 offset:0
  v_mul_f32 v140, s83, v140
  v_mfma_f32_16x16x32_bf16 a[60:63], a[152:155], a[216:219], a[60:63]
  ds_read_b64_tr_b16 a[210:211], v44 offset:1024
  v_mul_f32 v141, s83, v141
  v_mfma_f32_16x16x32_bf16 a[76:79], a[160:163], a[216:219], a[76:79]
  buffer_load_dwordx4 v27, s[56:59], s41 offen offset:1024  lds
  v_mfma_f32_16x16x32_bf16 a[76:79], a[164:167], a[220:223], a[76:79]
  ds_read_b64_tr_b16 a[212:213], v44 offset:8192
  v_mul_f32 v142, s83, v142
  v_mfma_f32_16x16x32_bf16 a[92:95], a[172:175], a[220:223], a[92:95]
  ds_read_b64_tr_b16 a[214:215], v44 offset:9216
  v_mul_f32 v143, s83, v143
  v_mfma_f32_16x16x32_bf16 a[92:95], a[168:171], a[216:219], a[92:95]
  v_cvt_pk_bf16_f32 v86, v172, v173
  v_cvt_pk_bf16_f32 v87, v174, v175
  v_mfma_f32_16x16x32_bf16 a[108:111], a[176:179], a[216:219], a[108:111]
  v_cvt_pk_bf16_f32 v70, v140, v141
  v_cvt_pk_bf16_f32 v71, v142, v143
  v_mfma_f32_16x16x32_bf16 a[108:111], a[180:183], a[220:223], a[108:111]
  buffer_load_dwordx4 v26, s[56:59], s42 offen offset:2048  lds
  v_mfma_f32_16x16x32_bf16 a[124:127], a[188:191], a[220:223], a[124:127]
  v_cvt_pk_bf16_f32 v72, v144, v145
  v_cvt_pk_bf16_f32 v73, v146, v147
  v_mfma_f32_16x16x32_bf16 a[124:127], a[184:187], a[216:219], a[124:127]
  s_waitcnt lgkmcnt(10)
  v_cvt_pk_bf16_f32 v88, v176, v177
  v_cvt_pk_bf16_f32 v89, v178, v179
  v_mfma_f32_16x16x32_bf16 v[128:131], a[192:195], a[224:227], 0
  s_waitcnt lgkmcnt(8)
  ds_read_b64_tr_b16 a[216:217], v45 offset:0
  v_cvt_pk_bf16_f32 v104, v208, v209
  v_mfma_f32_16x16x32_bf16 v[128:131], a[196:199], a[228:231], v[128:131]
  buffer_load_dwordx4 v27, s[56:59], s43 offen offset:3072  lds
  v_mfma_f32_16x16x32_bf16 v[160:163], a[196:199], a[236:239], 0
  ds_read_b64_tr_b16 a[218:219], v45 offset:1024
  v_cvt_pk_bf16_f32 v105, v210, v211
  v_mfma_f32_16x16x32_bf16 v[160:163], a[192:195], a[232:235], v[160:163]
  s_add_u32 m0, s96, 0x9000
  ds_read_b64_tr_b16 a[220:221], v45 offset:8192
  v_cvt_pk_bf16_f32 v120, v240, v241
  v_mfma_f32_16x16x32_bf16 v[192:195], a[192:195], a[240:243], 0
  ds_read_b64_tr_b16 a[222:223], v45 offset:9216
  v_cvt_pk_bf16_f32 v121, v242, v243
  v_mfma_f32_16x16x32_bf16 v[192:195], a[196:199], a[244:247], v[192:195]
  s_waitcnt vmcnt(8)
  ds_read_b128 a[160:163], v34 offset:0
  v_cvt_pk_bf16_f32 v122, v244, v245
  v_mfma_f32_16x16x32_bf16 v[224:227], a[196:199], a[252:255], 0
  buffer_load_dwordx4 v26, s[56:59], s44 offen offset:0  lds
  v_mfma_f32_16x16x32_bf16 v[224:227], a[192:195], a[248:251], v[224:227]
  s_waitcnt lgkmcnt(11)
  ds_read_b128 a[164:167], v35 offset:0
  v_cvt_pk_bf16_f32 v123, v246, v247
  v_mfma_f32_16x16x32_bf16 v[228:231], a[200:203], a[248:251], 0
  s_waitcnt lgkmcnt(10)
  ds_read_b64_tr_b16 a[192:193], v46 offset:0
  v_cvt_pk_bf16_f32 v106, v212, v213
  v_mfma_f32_16x16x32_bf16 v[228:231], a[204:207], a[252:255], v[228:231]
  ds_read_b64_tr_b16 a[194:195], v46 offset:1024
  v_cvt_pk_bf16_f32 v107, v214, v215
  v_mfma_f32_16x16x32_bf16 v[196:199], a[204:207], a[244:247], 0
  ds_read_b64_tr_b16 a[196:197], v46 offset:8192
  v_cvt_pk_bf16_f32 v90, v180, v181
  v_mfma_f32_16x16x32_bf16 v[196:199], a[200:203], a[240:243], v[196:199]
  buffer_load_dwordx4 v27, s[56:59], s45 offen offset:1024  lds
  v_mfma_f32_16x16x32_bf16 v[164:167], a[200:203], a[232:235], 0
  ds_read_b64_tr_b16 a[198:199], v46 offset:9216
  v_cvt_pk_bf16_f32 v91, v182, v183
  v_mfma_f32_16x16x32_bf16 v[164:167], a[204:207], a[236:239], v[164:167]
  ds_read_b128 a[168:171], v34 offset:2048
  v_cvt_pk_bf16_f32 v74, v148, v149
  v_mfma_f32_16x16x32_bf16 v[132:135], a[204:207], a[228:231], 0
  ds_read_b128 a[172:175], v35 offset:2048
  v_cvt_pk_bf16_f32 v75, v150, v151
  v_mfma_f32_16x16x32_bf16 v[132:135], a[200:203], a[224:227], v[132:135]
  s_waitcnt lgkmcnt(14)
  buffer_load_dwordx4 v26, s[56:59], s46 offen offset:2048  lds
  v_mfma_f32_16x16x32_bf16 v[136:139], a[208:211], a[224:227], 0
  s_waitcnt lgkmcnt(12)
  ds_read_b64_tr_b16 a[200:201], v47 offset:0
  v_mul_f32 v152, s83, v152
  v_mfma_f32_16x16x32_bf16 v[136:139], a[212:215], a[228:231], v[136:139]
  ds_read_b64_tr_b16 a[202:203], v47 offset:1024
  v_mul_f32 v153, s83, v153
  v_mfma_f32_16x16x32_bf16 v[168:171], a[212:215], a[236:239], 0
  ds_read_b64_tr_b16 a[204:205], v47 offset:8192
  v_mul_f32 v154, s83, v154
  v_mfma_f32_16x16x32_bf16 v[168:171], a[208:211], a[232:235], v[168:171]
  ds_read_b64_tr_b16 a[206:207], v47 offset:9216
  v_mul_f32 v155, s83, v155
  v_mfma_f32_16x16x32_bf16 v[200:203], a[208:211], a[240:243], 0
  buffer_load_dwordx4 v27, s[56:59], s47 offen offset:3072  lds
  v_mfma_f32_16x16x32_bf16 v[200:203], a[212:215], a[244:247], v[200:203]
  ds_read_b128 a[176:179], v34 offset:4096
  v_cvt_pk_bf16_f32 v76, v152, v153
  v_mfma_f32_16x16x32_bf16 v[232:235], a[212:215], a[252:255], 0
  s_mov_b32 s3, 0x0
  ds_read_b128 a[180:183], v35 offset:4096
  v_cvt_pk_bf16_f32 v77, v154, v155
  v_mfma_f32_16x16x32_bf16 v[232:235], a[208:211], a[248:251], v[232:235]
  s_waitcnt lgkmcnt(15)
  v_mul_f32 v184, s83, v184
  v_mul_f32 v185, s83, v185
  v_mfma_f32_16x16x32_bf16 v[236:239], a[216:219], a[248:251], 0
  ds_read_b64_tr_b16 a[208:209], v48 offset:0
  v_mul_f32 v186, s83, v186
  s_waitcnt lgkmcnt(15)
  v_mfma_f32_16x16x32_bf16 v[236:239], a[220:223], a[252:255], v[236:239]
  buffer_store_dwordx4 v[64:67], v11, s[16:19], s3 offen offset:0 sc1
  v_mfma_f32_16x16x32_bf16 v[204:207], a[220:223], a[244:247], 0
  ds_read_b64_tr_b16 a[210:211], v48 offset:1024
  v_xor_b32 v28, 0x180000, v28
  v_mfma_f32_16x16x32_bf16 v[204:207], a[216:219], a[240:243], v[204:207]
  ds_read_b64_tr_b16 a[212:213], v48 offset:8192
  v_xor_b32 v29, 0x180000, v29
  v_mfma_f32_16x16x32_bf16 v[172:175], a[216:219], a[232:235], 0
  s_add_u32 m0, s97, 0x18000
  ds_read_b64_tr_b16 a[214:215], v48 offset:9216
  v_mul_f32 v187, s83, v187
  v_mfma_f32_16x16x32_bf16 v[172:175], a[220:223], a[236:239], v[172:175]
  ds_read_b128 a[184:187], v34 offset:6144
  v_cvt_pk_bf16_f32 v92, v184, v185
  v_mfma_f32_16x16x32_bf16 v[140:143], a[220:223], a[228:231], 0
  v_cvt_pk_bf16_f32 v93, v186, v187
  v_mul_f32 v216, s83, v216
  v_mfma_f32_16x16x32_bf16 v[140:143], a[216:219], a[224:227], v[140:143]
  s_waitcnt lgkmcnt(15)
  buffer_load_dwordx4 v28, s[60:63], s48 offen offset:0  lds
  v_mfma_f32_16x16x32_bf16 v[144:147], a[192:195], a[224:227], 0
  s_waitcnt lgkmcnt(13)
  ds_read_b64_tr_b16 a[216:217], v49 offset:0
  v_mul_f32 v217, s83, v217
  v_mfma_f32_16x16x32_bf16 v[144:147], a[196:199], a[228:231], v[144:147]
  ds_read_b64_tr_b16 a[218:219], v49 offset:1024
  v_mul_f32 v218, s83, v218
  v_mfma_f32_16x16x32_bf16 v[176:179], a[196:199], a[236:239], 0
  ds_read_b64_tr_b16 a[220:221], v49 offset:8192
  v_mul_f32 v219, s83, v219
  v_mfma_f32_16x16x32_bf16 v[176:179], a[192:195], a[232:235], v[176:179]
  buffer_load_dwordx4 v28, s[60:63], s49 offen offset:1024  lds
  v_mfma_f32_16x16x32_bf16 v[208:211], a[192:195], a[240:243], 0
  ds_read_b64_tr_b16 a[222:223], v49 offset:9216
  v_cvt_pk_bf16_f32 v108, v216, v217
  v_mfma_f32_16x16x32_bf16 v[208:211], a[196:199], a[244:247], v[208:211]
  v_cvt_pk_bf16_f32 v109, v218, v219
  v_mul_f32 v248, s83, v248
  v_mfma_f32_16x16x32_bf16 v[240:243], a[196:199], a[252:255], 0
  v_mul_f32 v249, s83, v249
  v_mul_f32 v250, s83, v250
  v_mfma_f32_16x16x32_bf16 v[240:243], a[192:195], a[248:251], v[240:243]
  s_waitcnt vmcnt(11) lgkmcnt(13)
  ds_read_b128 a[188:191], v35 offset:6144
  v_mul_f32 v251, s83, v251
  v_mfma_f32_16x16x32_bf16 v[244:247], a[200:203], a[248:251], 0
  s_barrier
  s_waitcnt lgkmcnt(12)
  v_mfma_f32_16x16x32_bf16 v[244:247], a[204:207], a[252:255], v[244:247]
  buffer_load_dwordx4 v29, s[60:63], s50 offen offset:2048  lds
  v_mfma_f32_16x16x32_bf16 v[212:215], a[204:207], a[244:247], 0
  v_cvt_pk_bf16_f32 v124, v248, v249
  v_cvt_pk_bf16_f32 v125, v250, v251
  v_mfma_f32_16x16x32_bf16 v[212:215], a[200:203], a[240:243], v[212:215]
  v_mul_f32 v252, s83, v252
  v_mul_f32 v253, s83, v253
  v_mfma_f32_16x16x32_bf16 v[180:183], a[200:203], a[232:235], 0
  v_mul_f32 v254, s83, v254
  v_mul_f32 v255, s83, v255
  v_mfma_f32_16x16x32_bf16 v[180:183], a[204:207], a[236:239], v[180:183]
  buffer_load_dwordx4 v29, s[60:63], s51 offen offset:3072  lds
  v_mfma_f32_16x16x32_bf16 v[148:151], a[204:207], a[228:231], 0
  ds_read_b64_tr_b16 a[192:193], v42 offset:16384
  v_mul_f32 v220, s83, v220
  v_mfma_f32_16x16x32_bf16 v[148:151], a[200:203], a[224:227], v[148:151]
  s_waitcnt lgkmcnt(9)
  s_mov_b32 s3, 0x0
  ds_read_b64_tr_b16 a[194:195], v42 offset:17408
  v_mul_f32 v221, s83, v221
  v_mfma_f32_16x16x32_bf16 v[152:155], a[208:211], a[224:227], 0
  s_waitcnt lgkmcnt(8)
  v_mul_f32 v222, s83, v222
  v_mul_f32 v223, s83, v223
  v_mfma_f32_16x16x32_bf16 v[152:155], a[212:215], a[228:231], v[152:155]
  v_cvt_pk_bf16_f32 v126, v252, v253
  v_cvt_pk_bf16_f32 v127, v254, v255
  v_mfma_f32_16x16x32_bf16 v[184:187], a[212:215], a[236:239], 0
  buffer_store_dwordx4 v[68:71], v11, s[16:19], s3 offen offset:1024 sc1
  v_mfma_f32_16x16x32_bf16 v[184:187], a[208:211], a[232:235], v[184:187]
  ds_read_b64_tr_b16 a[196:197], v42 offset:24576
  v_xor_b32 v26, 0x80, v26
  v_mfma_f32_16x16x32_bf16 v[216:219], a[208:211], a[240:243], 0
  ds_read_b64_tr_b16 a[198:199], v42 offset:25600
  v_xor_b32 v27, 0x80, v27
  v_mfma_f32_16x16x32_bf16 v[216:219], a[212:215], a[244:247], v[216:219]
  s_add_u32 m0, s96, 0x20000
  v_mul_f32 v188, s83, v188
  v_mul_f32 v189, s83, v189
  v_mfma_f32_16x16x32_bf16 v[248:251], a[212:215], a[252:255], 0
  v_mul_f32 v190, s83, v190
  v_mul_f32 v191, s83, v191
  v_mfma_f32_16x16x32_bf16 v[248:251], a[208:211], a[248:251], v[248:251]
  s_waitcnt lgkmcnt(7)
  v_cvt_pk_bf16_f32 v110, v220, v221
  v_cvt_pk_bf16_f32 v111, v222, v223
  v_mfma_f32_16x16x32_bf16 v[252:255], a[216:219], a[248:251], 0
  s_waitcnt lgkmcnt(5)
  buffer_load_dwordx4 v26, s[56:59], s40 offen offset:0  lds
  v_mfma_f32_16x16x32_bf16 v[252:255], a[220:223], a[252:255], v[252:255]
  v_mul_f32 v156, s83, v156
  v_mul_f32 v157, s83, v157
  v_mfma_f32_16x16x32_bf16 v[220:223], a[220:223], a[244:247], 0
  v_mul_f32 v158, s83, v158
  v_mul_f32 v159, s83, v159
  v_mfma_f32_16x16x32_bf16 v[220:223], a[216:219], a[240:243], v[220:223]
  v_cvt_pk_bf16_f32 v94, v188, v189
  v_cvt_pk_bf16_f32 v95, v190, v191
  v_mfma_f32_16x16x32_bf16 v[188:191], a[216:219], a[232:235], 0
  buffer_load_dwordx4 v27, s[56:59], s41 offen offset:1024  lds
  v_mfma_f32_16x16x32_bf16 v[188:191], a[220:223], a[236:239], v[188:191]
  v_cvt_pk_bf16_f32 v78, v156, v157
  v_cvt_pk_bf16_f32 v79, v158, v159
  v_mfma_f32_16x16x32_bf16 v[156:159], a[220:223], a[228:231], 0
  ds_read_b64_tr_b16 a[200:201], v43 offset:16384
  v_mfma_f32_16x16x32_bf16 v[156:159], a[216:219], a[224:227], v[156:159]
  s_waitcnt lgkmcnt(3)
  ds_read_b64_tr_b16 a[202:203], v43 offset:17408
  v_mfma_f32_16x16x32_bf16 v[128:131], a[192:195], a[160:163], v[128:131]
  s_waitcnt lgkmcnt(2)
  ds_read_b64_tr_b16 a[204:205], v43 offset:24576
  v_mfma_f32_16x16x32_bf16 v[128:131], a[196:199], a[164:167], v[128:131]
  ds_read_b64_tr_b16 a[206:207], v43 offset:25600
  v_mfma_f32_16x16x32_bf16 v[160:163], a[196:199], a[172:175], v[160:163]
  buffer_load_dwordx4 v26, s[56:59], s42 offen offset:2048  lds
  v_mfma_f32_16x16x32_bf16 v[160:163], a[192:195], a[168:171], v[160:163]
  ds_read_b64_tr_b16 a[208:209], v44 offset:16384
  v_mfma_f32_16x16x32_bf16 v[192:195], a[192:195], a[176:179], v[192:195]
  ds_read_b64_tr_b16 a[210:211], v44 offset:17408
  v_mfma_f32_16x16x32_bf16 v[192:195], a[196:199], a[180:183], v[192:195]
  ds_read_b64_tr_b16 a[212:213], v44 offset:24576
  v_mfma_f32_16x16x32_bf16 v[224:227], a[196:199], a[188:191], v[224:227]
  buffer_load_dwordx4 v27, s[56:59], s43 offen offset:3072  lds
  v_mfma_f32_16x16x32_bf16 v[224:227], a[192:195], a[184:187], v[224:227]
  s_waitcnt lgkmcnt(5)
  s_add_u32 m0, s96, 0x21000
  ds_read_b64_tr_b16 a[214:215], v44 offset:25600
  v_mfma_f32_16x16x32_bf16 v[228:231], a[200:203], a[184:187], v[228:231]
  s_waitcnt lgkmcnt(4)
  ds_read_b64_tr_b16 a[216:217], v45 offset:16384
  v_mfma_f32_16x16x32_bf16 v[228:231], a[204:207], a[188:191], v[228:231]
  ds_read_b64_tr_b16 a[218:219], v45 offset:17408
  v_mfma_f32_16x16x32_bf16 v[196:199], a[204:207], a[180:183], v[196:199]
  buffer_load_dwordx4 v26, s[56:59], s44 offen offset:0  lds
  v_mfma_f32_16x16x32_bf16 v[196:199], a[200:203], a[176:179], v[196:199]
  ds_read_b64_tr_b16 a[220:221], v45 offset:24576
  v_mfma_f32_16x16x32_bf16 v[164:167], a[200:203], a[168:171], v[164:167]
  ds_read_b64_tr_b16 a[222:223], v45 offset:25600
  v_mfma_f32_16x16x32_bf16 v[164:167], a[204:207], a[172:175], v[164:167]
  ds_read_b64_tr_b16 a[192:193], v46 offset:16384
  v_mfma_f32_16x16x32_bf16 v[132:135], a[204:207], a[164:167], v[132:135]
  ds_read_b64_tr_b16 a[194:195], v46 offset:17408
  v_mfma_f32_16x16x32_bf16 v[132:135], a[200:203], a[160:163], v[132:135]
  s_waitcnt lgkmcnt(8)
  buffer_load_dwordx4 v27, s[56:59], s45 offen offset:1024  lds
  v_mfma_f32_16x16x32_bf16 v[136:139], a[208:211], a[160:163], v[136:139]
  s_waitcnt lgkmcnt(6)
  ds_read_b64_tr_b16 a[196:197], v46 offset:24576
  v_mfma_f32_16x16x32_bf16 v[136:139], a[212:215], a[164:167], v[136:139]
  s_waitcnt vmcnt(12)
  ds_read_b128 a[224:227], v34 offset:32768
  v_mfma_f32_16x16x32_bf16 v[168:171], a[212:215], a[172:175], v[168:171]
  ds_read_b64_tr_b16 a[198:199], v46 offset:25600
  v_mfma_f32_16x16x32_bf16 v[168:171], a[208:211], a[168:171], v[168:171]
  ds_read_b128 a[228:231], v35 offset:32768
  v_mfma_f32_16x16x32_bf16 v[200:203], a[208:211], a[176:179], v[200:203]
  buffer_load_dwordx4 v26, s[56:59], s46 offen offset:2048  lds
  v_mfma_f32_16x16x32_bf16 v[200:203], a[212:215], a[180:183], v[200:203]
  ds_read_b64_tr_b16 a[200:201], v47 offset:16384
  v_mfma_f32_16x16x32_bf16 v[232:235], a[212:215], a[188:191], v[232:235]
  ds_read_b64_tr_b16 a[202:203], v47 offset:17408
  v_mfma_f32_16x16x32_bf16 v[232:235], a[208:211], a[184:187], v[232:235]
  s_waitcnt lgkmcnt(10)
  ds_read_b64_tr_b16 a[204:205], v47 offset:24576
  v_mfma_f32_16x16x32_bf16 v[236:239], a[216:219], a[184:187], v[236:239]
  s_waitcnt lgkmcnt(9)
  buffer_load_dwordx4 v27, s[56:59], s47 offen offset:3072  lds
  v_mfma_f32_16x16x32_bf16 v[236:239], a[220:223], a[188:191], v[236:239]
  ds_read_b128 a[232:235], v34 offset:34816
  v_mfma_f32_16x16x32_bf16 v[204:207], a[220:223], a[180:183], v[204:207]
  s_mov_b32 s3, 0x1000
  ds_read_b64_tr_b16 a[206:207], v47 offset:25600
  v_mfma_f32_16x16x32_bf16 v[204:207], a[216:219], a[176:179], v[204:207]
  ds_read_b128 a[236:239], v35 offset:34816
  v_mfma_f32_16x16x32_bf16 v[172:175], a[216:219], a[168:171], v[172:175]
  ds_read_b64_tr_b16 a[208:209], v48 offset:16384
  v_mfma_f32_16x16x32_bf16 v[172:175], a[220:223], a[172:175], v[172:175]
  buffer_store_dwordx4 v[72:75], v11, s[16:19], s3 offen offset:0 sc1
  v_mfma_f32_16x16x32_bf16 v[140:143], a[220:223], a[164:167], v[140:143]
  ds_read_b64_tr_b16 a[210:211], v48 offset:17408
  v_xor_b32 v28, 0x80000, v28
  v_mfma_f32_16x16x32_bf16 v[140:143], a[216:219], a[160:163], v[140:143]
  s_waitcnt lgkmcnt(12)
  ds_read_b64_tr_b16 a[212:213], v48 offset:24576
  v_xor_b32 v29, 0x80000, v29
  v_mfma_f32_16x16x32_bf16 v[144:147], a[192:195], a[160:163], v[144:147]
  s_waitcnt lgkmcnt(10)
  s_add_u32 m0, s97, 0x1c000
  ds_read_b128 a[240:243], v34 offset:36864
  v_mfma_f32_16x16x32_bf16 v[144:147], a[196:199], a[164:167], v[144:147]
  ds_read_b64_tr_b16 a[214:215], v48 offset:25600
  v_mfma_f32_16x16x32_bf16 v[176:179], a[196:199], a[172:175], v[176:179]
  ds_read_b128 a[244:247], v35 offset:36864
  v_mfma_f32_16x16x32_bf16 v[176:179], a[192:195], a[168:171], v[176:179]
  buffer_load_dwordx4 v28, s[60:63], s48 offen offset:0  lds
  v_mfma_f32_16x16x32_bf16 v[208:211], a[192:195], a[176:179], v[208:211]
  ds_read_b64_tr_b16 a[216:217], v49 offset:16384
  v_mfma_f32_16x16x32_bf16 v[208:211], a[196:199], a[180:183], v[208:211]
  ds_read_b64_tr_b16 a[218:219], v49 offset:17408
  v_mfma_f32_16x16x32_bf16 v[240:243], a[196:199], a[188:191], v[240:243]
  ds_read_b64_tr_b16 a[220:221], v49 offset:24576
  v_mfma_f32_16x16x32_bf16 v[240:243], a[192:195], a[184:187], v[240:243]
  s_waitcnt vmcnt(11) lgkmcnt(13)
  ds_read_b128 a[248:251], v34 offset:38912
  v_mfma_f32_16x16x32_bf16 v[244:247], a[200:203], a[184:187], v[244:247]
  s_barrier
  s_waitcnt lgkmcnt(11)
  v_mfma_f32_16x16x32_bf16 v[244:247], a[204:207], a[188:191], v[244:247]
  buffer_load_dwordx4 v28, s[60:63], s49 offen offset:1024  lds
  v_mfma_f32_16x16x32_bf16 v[212:215], a[204:207], a[180:183], v[212:215]
  ds_read_b64_tr_b16 a[222:223], v49 offset:25600
  v_mov_b32 v19, 0x30000
  v_mfma_f32_16x16x32_bf16 v[212:215], a[200:203], a[176:179], v[212:215]
  ds_read_b128 a[252:255], v35 offset:38912
  v_mfma_f32_16x16x32_bf16 v[180:183], a[200:203], a[168:171], v[180:183]
  ds_read_b64_tr_b16 a[192:193], v42 offset:32768
  v_mfma_f32_16x16x32_bf16 v[180:183], a[204:207], a[172:175], v[180:183]
  buffer_load_dwordx4 v29, s[60:63], s50 offen offset:2048  lds
  v_mfma_f32_16x16x32_bf16 v[148:151], a[204:207], a[164:167], v[148:151]
  ds_read_b64_tr_b16 a[194:195], v42 offset:33792
  v_mfma_f32_16x16x32_bf16 v[148:151], a[200:203], a[160:163], v[148:151]
  s_waitcnt lgkmcnt(12)
  ds_read_b64_tr_b16 a[196:197], v42 offset:40960
  v_mfma_f32_16x16x32_bf16 v[152:155], a[208:211], a[160:163], v[152:155]
  s_waitcnt lgkmcnt(10)
  ds_read_b64_tr_b16 a[198:199], v42 offset:41984
  v_mfma_f32_16x16x32_bf16 v[152:155], a[212:215], a[164:167], v[152:155]
  buffer_load_dwordx4 v29, s[60:63], s51 offen offset:3072  lds
  v_mfma_f32_16x16x32_bf16 v[184:187], a[212:215], a[172:175], v[184:187]
  ds_read_b64_tr_b16 a[200:201], v43 offset:32768
  v_xor_b32 v26, 0x380, v26
  v_mfma_f32_16x16x32_bf16 v[184:187], a[208:211], a[168:171], v[184:187]
  ds_read_b64_tr_b16 a[202:203], v43 offset:33792
  v_xor_b32 v27, 0x380, v27
  v_mfma_f32_16x16x32_bf16 v[216:219], a[208:211], a[176:179], v[216:219]
  s_add_u32 m0, s96, 0x0
  ds_read_b64_tr_b16 a[204:205], v43 offset:40960
  v_mfma_f32_16x16x32_bf16 v[216:219], a[212:215], a[180:183], v[216:219]
  ds_read_b64_tr_b16 a[206:207], v43 offset:41984
  v_mfma_f32_16x16x32_bf16 v[248:251], a[212:215], a[188:191], v[248:251]
  buffer_load_dwordx4 v26, s[56:59], s40 offen offset:0  lds
  v_mfma_f32_16x16x32_bf16 v[248:251], a[208:211], a[184:187], v[248:251]
  s_waitcnt lgkmcnt(12)
  v_mfma_f32_16x16x32_bf16 v[252:255], a[216:219], a[184:187], v[252:255]
  s_waitcnt lgkmcnt(9)
  ds_read_b64_tr_b16 a[208:209], v44 offset:32768
  v_mfma_f32_16x16x32_bf16 v[252:255], a[220:223], a[188:191], v[252:255]
  ds_read_b64_tr_b16 a[210:211], v44 offset:33792
  v_mfma_f32_16x16x32_bf16 v[220:223], a[220:223], a[180:183], v[220:223]
  ds_read_b64_tr_b16 a[212:213], v44 offset:40960
  v_mfma_f32_16x16x32_bf16 v[220:223], a[216:219], a[176:179], v[220:223]
  buffer_load_dwordx4 v27, s[56:59], s41 offen offset:1024  lds
  v_mfma_f32_16x16x32_bf16 v[188:191], a[216:219], a[168:171], v[188:191]
  ds_read_b64_tr_b16 a[214:215], v44 offset:41984
  v_mfma_f32_16x16x32_bf16 v[188:191], a[220:223], a[172:175], v[188:191]
  v_mfma_f32_16x16x32_bf16 v[156:159], a[220:223], a[164:167], v[156:159]
  v_mfma_f32_16x16x32_bf16 v[156:159], a[216:219], a[160:163], v[156:159]
  s_waitcnt lgkmcnt(10)
  buffer_load_dwordx4 v26, s[56:59], s42 offen offset:2048  lds
  v_mfma_f32_16x16x32_bf16 v[128:131], a[192:195], a[224:227], v[128:131]
  s_waitcnt lgkmcnt(8)
  ds_read_b64_tr_b16 a[216:217], v45 offset:32768
  v_mfma_f32_16x16x32_bf16 v[128:131], a[196:199], a[228:231], v[128:131]
  ds_read_b64_tr_b16 a[218:219], v45 offset:33792
  v_mfma_f32_16x16x32_bf16 v[160:163], a[196:199], a[236:239], v[160:163]
  ds_read_b64_tr_b16 a[220:221], v45 offset:40960
  v_mfma_f32_16x16x32_bf16 v[160:163], a[192:195], a[232:235], v[160:163]
  buffer_load_dwordx4 v27, s[56:59], s43 offen offset:3072  lds
  v_mfma_f32_16x16x32_bf16 v[192:195], a[192:195], a[240:243], v[192:195]
  s_add_u32 m0, s96, 0x1000
  ds_read_b64_tr_b16 a[222:223], v45 offset:41984
  v_mfma_f32_16x16x32_bf16 v[192:195], a[196:199], a[244:247], v[192:195]
  s_waitcnt vmcnt(9)
  ds_read_b128 a[160:163], v36 offset:0
  v_mfma_f32_16x16x32_bf16 v[224:227], a[196:199], a[252:255], v[224:227]
  buffer_load_dwordx4 v26, s[56:59], s44 offen offset:0  lds
  v_mfma_f32_16x16x32_bf16 v[224:227], a[192:195], a[248:251], v[224:227]
  s_waitcnt lgkmcnt(11)
  ds_read_b128 a[164:167], v37 offset:0
  v_mfma_f32_16x16x32_bf16 v[228:231], a[200:203], a[248:251], v[228:231]
  s_waitcnt lgkmcnt(10)
  ds_read_b64_tr_b16 a[192:193], v46 offset:32768
  v_mfma_f32_16x16x32_bf16 v[228:231], a[204:207], a[252:255], v[228:231]
  buffer_load_dwordx4 v27, s[56:59], s45 offen offset:1024  lds
  v_mfma_f32_16x16x32_bf16 v[196:199], a[204:207], a[244:247], v[196:199]
L_pad5:
  s_cbranch_execz L_hr0
  ds_read_b64_tr_b16 a[194:195], v46 offset:33792
  v_mfma_f32_16x16x32_bf16 v[196:199], a[200:203], a[240:243], v[196:199]
  ds_read_b64_tr_b16 a[196:197], v46 offset:40960
  v_mfma_f32_16x16x32_bf16 v[164:167], a[200:203], a[232:235], v[164:167]
  buffer_load_dwordx4 v26, s[56:59], s46 offen offset:2048  lds
  v_mfma_f32_16x16x32_bf16 v[164:167], a[204:207], a[236:239], v[164:167]
  ds_read_b64_tr_b16 a[198:199], v46 offset:41984
  v_mfma_f32_16x16x32_bf16 v[132:135], a[204:207], a[228:231], v[132:135]
  ds_read_b128 a[168:171], v36 offset:2048
  v_mfma_f32_16x16x32_bf16 v[132:135], a[200:203], a[224:227], v[132:135]
  s_waitcnt lgkmcnt(13)
  buffer_load_dwordx4 v27, s[56:59], s47 offen offset:3072  lds
  v_mfma_f32_16x16x32_bf16 v[136:139], a[208:211], a[224:227], v[136:139]
  s_waitcnt lgkmcnt(11)
  s_mov_b32 s3, 0x1000
  ds_read_b64_tr_b16 a[200:201], v47 offset:32768
  v_mfma_f32_16x16x32_bf16 v[136:139], a[212:215], a[228:231], v[136:139]
  ds_read_b64_tr_b16 a[202:203], v47 offset:33792
  v_mfma_f32_16x16x32_bf16 v[168:171], a[212:215], a[236:239], v[168:171]
  buffer_store_dwordx4 v[76:79], v11, s[16:19], s3 offen offset:1024 sc1
  v_mfma_f32_16x16x32_bf16 v[168:171], a[208:211], a[232:235], v[168:171]
  ds_read_b64_tr_b16 a[204:205], v47 offset:40960
  v_xor_b32 v28, 0x380000, v28
  v_mfma_f32_16x16x32_bf16 v[200:203], a[208:211], a[240:243], v[200:203]
  ds_read_b64_tr_b16 a[206:207], v47 offset:41984
  v_xor_b32 v29, 0x380000, v29
  v_mfma_f32_16x16x32_bf16 v[200:203], a[212:215], a[244:247], v[200:203]
  s_add_u32 m0, s97, 0x10000
  ds_read_b128 a[172:175], v37 offset:2048
  v_mfma_f32_16x16x32_bf16 v[232:235], a[212:215], a[252:255], v[232:235]
  buffer_load_dwordx4 v28, s[60:63], s48 offen offset:0  lds
  v_mfma_f32_16x16x32_bf16 v[232:235], a[208:211], a[248:251], v[232:235]
  ds_read_b128 a[176:179], v36 offset:4096
  s_waitcnt lgkmcnt(15)
  v_mfma_f32_16x16x32_bf16 v[236:239], a[216:219], a[248:251], v[236:239]
  s_waitcnt lgkmcnt(13)
  ds_read_b64_tr_b16 a[208:209], v48 offset:32768
  v_mfma_f32_16x16x32_bf16 v[236:239], a[220:223], a[252:255], v[236:239]
  buffer_load_dwordx4 v28, s[60:63], s49 offen offset:1024  lds
  v_mfma_f32_16x16x32_bf16 v[204:207], a[220:223], a[244:247], v[204:207]
  ds_read_b64_tr_b16 a[210:211], v48 offset:33792
  v_mfma_f32_16x16x32_bf16 v[204:207], a[216:219], a[240:243], v[204:207]
  ds_read_b64_tr_b16 a[212:213], v48 offset:40960
  v_mfma_f32_16x16x32_bf16 v[172:175], a[216:219], a[232:235], v[172:175]
  ds_read_b64_tr_b16 a[214:215], v48 offset:41984
  v_mfma_f32_16x16x32_bf16 v[172:175], a[220:223], a[236:239], v[172:175]
  ds_read_b128 a[180:183], v37 offset:4096
  v_mfma_f32_16x16x32_bf16 v[140:143], a[220:223], a[228:231], v[140:143]
  buffer_load_dwordx4 v29, s[60:63], s50 offen offset:2048  lds
  v_mfma_f32_16x16x32_bf16 v[140:143], a[216:219], a[224:227], v[140:143]
  ds_read_b128 a[184:187], v36 offset:6144
  s_waitcnt lgkmcnt(15)
  v_mfma_f32_16x16x32_bf16 v[144:147], a[192:195], a[224:227], v[144:147]
  s_waitcnt lgkmcnt(13)
  ds_read_b64_tr_b16 a[216:217], v49 offset:32768
  v_mfma_f32_16x16x32_bf16 v[144:147], a[196:199], a[228:231], v[144:147]
  ds_read_b64_tr_b16 a[218:219], v49 offset:33792
  v_mfma_f32_16x16x32_bf16 v[176:179], a[196:199], a[236:239], v[176:179]
  ds_read_b64_tr_b16 a[220:221], v49 offset:40960
  v_mfma_f32_16x16x32_bf16 v[176:179], a[192:195], a[232:235], v[176:179]
  buffer_load_dwordx4 v29, s[60:63], s51 offen offset:3072  lds
  v_mfma_f32_16x16x32_bf16 v[208:211], a[192:195], a[240:243], v[208:211]
  s_mov_b32 s3, 0x2000
  ds_read_b64_tr_b16 a[222:223], v49 offset:41984
  v_mfma_f32_16x16x32_bf16 v[208:211], a[196:199], a[244:247], v[208:211]
  ds_read_b128 a[188:191], v37 offset:6144
  v_mfma_f32_16x16x32_bf16 v[240:243], a[196:199], a[252:255], v[240:243]
  ds_read_b128 a[128:131], v19
  v_mfma_f32_16x16x32_bf16 v[240:243], a[192:195], a[248:251], v[240:243]
  s_waitcnt vmcnt(13) lgkmcnt(15)
  buffer_store_dwordx4 v[80:83], v11, s[16:19], s3 offen offset:0 sc1
  v_mfma_f32_16x16x32_bf16 v[244:247], a[200:203], a[248:251], v[244:247]
  s_barrier
  s_waitcnt lgkmcnt(14)
  v_mfma_f32_16x16x32_bf16 v[244:247], a[204:207], a[252:255], v[244:247]
  ds_read_b64_tr_b16 a[192:193], v42 offset:49152
  v_xor_b32 v26, 0x80, v26
  v_mfma_f32_16x16x32_bf16 v[212:215], a[204:207], a[244:247], v[212:215]
  ds_read_b64_tr_b16 a[194:195], v42 offset:50176
  v_xor_b32 v27, 0x80, v27
  v_mfma_f32_16x16x32_bf16 v[212:215], a[200:203], a[240:243], v[212:215]
  s_add_u32 m0, s96, 0x8000
  ds_read_b64_tr_b16 a[196:197], v42 offset:57344
  v_mfma_f32_16x16x32_bf16 v[180:183], a[200:203], a[232:235], v[180:183]
  ds_read_b64_tr_b16 a[198:199], v42 offset:58368
  v_mfma_f32_16x16x32_bf16 v[180:183], a[204:207], a[236:239], v[180:183]
  buffer_load_dwordx4 v26, s[56:59], s40 offen offset:0  lds
  v_mfma_f32_16x16x32_bf16 v[148:151], a[204:207], a[228:231], v[148:151]
  ds_read_b128 a[132:135], v19
  v_mfma_f32_16x16x32_bf16 v[148:151], a[200:203], a[224:227], v[148:151]
  ds_read_b128 a[136:139], v19
  s_waitcnt lgkmcnt(15)
  v_mfma_f32_16x16x32_bf16 v[152:155], a[208:211], a[224:227], v[152:155]
  ds_read_b64_tr_b16 a[200:201], v43 offset:49152
  s_waitcnt lgkmcnt(15)
  v_mfma_f32_16x16x32_bf16 v[152:155], a[212:215], a[228:231], v[152:155]
  ds_read_b64_tr_b16 a[202:203], v43 offset:50176
  v_mfma_f32_16x16x32_bf16 v[184:187], a[212:215], a[236:239], v[184:187]
  buffer_load_dwordx4 v27, s[56:59], s41 offen offset:1024  lds
  v_mfma_f32_16x16x32_bf16 v[184:187], a[208:211], a[232:235], v[184:187]
  ds_read_b64_tr_b16 a[204:205], v43 offset:57344
  v_mfma_f32_16x16x32_bf16 v[216:219], a[208:211], a[240:243], v[216:219]
  ds_read_b64_tr_b16 a[206:207], v43 offset:58368
  v_mfma_f32_16x16x32_bf16 v[216:219], a[212:215], a[244:247], v[216:219]
  ds_read_b128 a[140:143], v19
  v_mfma_f32_16x16x32_bf16 v[248:251], a[212:215], a[252:255], v[248:251]
  v_mfma_f32_16x16x32_bf16 v[248:251], a[208:211], a[248:251], v[248:251]
  s_waitcnt lgkmcnt(15)
  buffer_load_dwordx4 v26, s[56:59], s42 offen offset:2048  lds
  v_mfma_f32_16x16x32_bf16 v[252:255], a[216:219], a[248:251], v[252:255]
  s_waitcnt lgkmcnt(13)
  ds_read_b64_tr_b16 a[208:209], v44 offset:49152
  v_mfma_f32_16x16x32_bf16 v[252:255], a[220:223], a[252:255], v[252:255]
  ds_read_b64_tr_b16 a[210:211], v44 offset:50176
  v_mfma_f32_16x16x32_bf16 v[220:223], a[220:223], a[244:247], v[220:223]
  ds_read_b64_tr_b16 a[212:213], v44 offset:57344
  v_mfma_f32_16x16x32_bf16 v[220:223], a[216:219], a[240:243], v[220:223]
  buffer_load_dwordx4 v27, s[56:59], s43 offen offset:3072  lds
  v_mfma_f32_16x16x32_bf16 v[188:191], a[216:219], a[232:235], v[188:191]
  ds_read_b64_tr_b16 a[214:215], v44 offset:58368
  v_mfma_f32_16x16x32_bf16 v[188:191], a[220:223], a[236:239], v[188:191]
  s_add_u32 m0, s96, 0x9000
  v_mfma_f32_16x16x32_bf16 v[156:159], a[220:223], a[228:231], v[156:159]
  v_mfma_f32_16x16x32_bf16 v[156:159], a[216:219], a[224:227], v[156:159]
  s_waitcnt lgkmcnt(13)
  v_mfma_f32_16x16x32_bf16 v[128:131], a[192:195], a[160:163], v[128:131]
  s_waitcnt lgkmcnt(11)
  buffer_load_dwordx4 v26, s[56:59], s44 offen offset:0  lds
  v_mfma_f32_16x16x32_bf16 v[128:131], a[196:199], a[164:167], v[128:131]
  ds_read_b64_tr_b16 a[216:217], v45 offset:49152
  v_mfma_f32_16x16x32_bf16 v[160:163], a[196:199], a[172:175], v[160:163]
  ds_read_b64_tr_b16 a[218:219], v45 offset:50176
  v_mfma_f32_16x16x32_bf16 v[160:163], a[192:195], a[168:171], v[160:163]
  ds_read_b64_tr_b16 a[220:221], v45 offset:57344
  v_mfma_f32_16x16x32_bf16 v[192:195], a[192:195], a[176:179], v[192:195]
  ds_read_b64_tr_b16 a[222:223], v45 offset:58368
  v_mfma_f32_16x16x32_bf16 v[192:195], a[196:199], a[180:183], v[192:195]
  buffer_load_dwordx4 v27, s[56:59], s45 offen offset:1024  lds
  v_mfma_f32_16x16x32_bf16 v[224:227], a[196:199], a[188:191], v[224:227]
  s_waitcnt vmcnt(12)
  ds_read_b128 a[224:227], v34 offset:0
  v_mfma_f32_16x16x32_bf16 v[224:227], a[192:195], a[184:187], v[224:227]
  s_waitcnt lgkmcnt(12)
  ds_read_b128 a[228:231], v35 offset:0
  v_mfma_f32_16x16x32_bf16 v[228:231], a[200:203], a[184:187], v[228:231]
  s_waitcnt lgkmcnt(11)
  ds_read_b64_tr_b16 a[192:193], v46 offset:49152
  v_mfma_f32_16x16x32_bf16 v[228:231], a[204:207], a[188:191], v[228:231]
  ds_read_b64_tr_b16 a[194:195], v46 offset:50176
  v_mfma_f32_16x16x32_bf16 v[196:199], a[204:207], a[180:183], v[196:199]
  buffer_load_dwordx4 v26, s[56:59], s46 offen offset:2048  lds
  v_mfma_f32_16x16x32_bf16 v[196:199], a[200:203], a[176:179], v[196:199]
  ds_read_b64_tr_b16 a[196:197], v46 offset:57344
  v_mfma_f32_16x16x32_bf16 v[164:167], a[200:203], a[168:171], v[164:167]
  ds_read_b64_tr_b16 a[198:199], v46 offset:58368
  v_mfma_f32_16x16x32_bf16 v[164:167], a[204:207], a[172:175], v[164:167]
  ds_read_b128 a[232:235], v34 offset:2048
  v_mfma_f32_16x16x32_bf16 v[132:135], a[204:207], a[164:167], v[132:135]
  buffer_load_dwordx4 v27, s[56:59], s47 offen offset:3072  lds
  v_mfma_f32_16x16x32_bf16 v[132:135], a[200:203], a[160:163], v[132:135]
  s_waitcnt lgkmcnt(13)
  ds_read_b128 a[236:239], v35 offset:2048
  v_mfma_f32_16x16x32_bf16 v[136:139], a[208:211], a[160:163], v[136:139]
  s_waitcnt lgkmcnt(12)
  s_mov_b32 s3, 0x2000
  ds_read_b64_tr_b16 a[200:201], v47 offset:49152
  v_mfma_f32_16x16x32_bf16 v[136:139], a[212:215], a[164:167], v[136:139]
  ds_read_b64_tr_b16 a[202:203], v47 offset:50176
  v_mfma_f32_16x16x32_bf16 v[168:171], a[212:215], a[172:175], v[168:171]
  ds_read_b64_tr_b16 a[204:205], v47 offset:57344
  v_mfma_f32_16x16x32_bf16 v[168:171], a[208:211], a[168:171], v[168:171]
  buffer_store_dwordx4 v[84:87], v11, s[16:19], s3 offen offset:1024 sc1
  v_mfma_f32_16x16x32_bf16 v[200:203], a[208:211], a[176:179], v[200:203]
  ds_read_b64_tr_b16 a[206:207], v47 offset:58368
  v_xor_b32 v28, 0x80000, v28
  v_mfma_f32_16x16x32_bf16 v[200:203], a[212:215], a[180:183], v[200:203]
  ds_read_b128 a[240:243], v34 offset:4096
  v_xor_b32 v29, 0x80000, v29
  v_mfma_f32_16x16x32_bf16 v[232:235], a[212:215], a[188:191], v[232:235]
  s_add_u32 m0, s97, 0x14000
  ds_read_b128 a[244:247], v35 offset:4096
  v_mfma_f32_16x16x32_bf16 v[232:235], a[208:211], a[184:187], v[232:235]
  s_waitcnt lgkmcnt(15)
  v_mfma_f32_16x16x32_bf16 v[236:239], a[216:219], a[184:187], v[236:239]
  ds_read_b64_tr_b16 a[208:209], v48 offset:49152
  s_waitcnt lgkmcnt(15)
  v_mfma_f32_16x16x32_bf16 v[236:239], a[220:223], a[188:191], v[236:239]
  buffer_load_dwordx4 v28, s[60:63], s48 offen offset:0  lds
  v_mfma_f32_16x16x32_bf16 v[204:207], a[220:223], a[180:183], v[204:207]
  ds_read_b64_tr_b16 a[210:211], v48 offset:50176
  v_mfma_f32_16x16x32_bf16 v[204:207], a[216:219], a[176:179], v[204:207]
  ds_read_b64_tr_b16 a[212:213], v48 offset:57344
  v_mfma_f32_16x16x32_bf16 v[172:175], a[216:219], a[168:171], v[172:175]
  ds_read_b64_tr_b16 a[214:215], v48 offset:58368
  v_mfma_f32_16x16x32_bf16 v[172:175], a[220:223], a[172:175], v[172:175]
  ds_read_b128 a[248:251], v34 offset:6144
  v_mfma_f32_16x16x32_bf16 v[140:143], a[220:223], a[164:167], v[140:143]
  buffer_load_dwordx4 v28, s[60:63], s49 offen offset:1024  lds
  v_mfma_f32_16x16x32_bf16 v[140:143], a[216:219], a[160:163], v[140:143]
  ds_read_b128 a[252:255], v35 offset:6144
  v_accvgpr_read_b32 v50, a0
  s_waitcnt lgkmcnt(15)
  v_mfma_f32_16x16x32_bf16 v[144:147], a[192:195], a[160:163], v[144:147]
  ds_read_b64_tr_b16 a[216:217], v49 offset:49152
  s_waitcnt lgkmcnt(15)
  v_mfma_f32_16x16x32_bf16 v[144:147], a[196:199], a[164:167], v[144:147]
  ds_read_b64_tr_b16 a[218:219], v49 offset:50176
  v_mfma_f32_16x16x32_bf16 v[176:179], a[196:199], a[172:175], v[176:179]
  buffer_load_dwordx4 v29, s[60:63], s50 offen offset:2048  lds
  v_mfma_f32_16x16x32_bf16 v[176:179], a[192:195], a[168:171], v[176:179]
  ds_read_b64_tr_b16 a[220:221], v49 offset:57344
  v_accvgpr_read_b32 v51, a1
  v_mfma_f32_16x16x32_bf16 v[208:211], a[192:195], a[176:179], v[208:211]
  ds_read_b64_tr_b16 a[222:223], v49 offset:58368
  v_mfma_f32_16x16x32_bf16 v[208:211], a[196:199], a[180:183], v[208:211]
  v_accvgpr_read_b32 v52, a2
  v_mfma_f32_16x16x32_bf16 v[240:243], a[196:199], a[188:191], v[240:243]
  v_accvgpr_read_b32 v53, a3
  v_accvgpr_read_b32 v54, a16
  v_mfma_f32_16x16x32_bf16 v[240:243], a[192:195], a[184:187], v[240:243]
  s_waitcnt vmcnt(13) lgkmcnt(14)
  buffer_load_dwordx4 v29, s[60:63], s51 offen offset:3072  lds
  v_mfma_f32_16x16x32_bf16 v[244:247], a[200:203], a[184:187], v[244:247]
  s_barrier
  s_waitcnt lgkmcnt(12)
  v_mfma_f32_16x16x32_bf16 v[244:247], a[204:207], a[188:191], v[244:247]
  s_mov_b32 s3, 0x3000
  ds_read_b64_tr_b16 a[192:193], v42 offset:0
  v_mfma_f32_16x16x32_bf16 v[212:215], a[204:207], a[180:183], v[212:215]
  ds_read_b64_tr_b16 a[194:195], v42 offset:1024
  v_mfma_f32_16x16x32_bf16 v[212:215], a[200:203], a[176:179], v[212:215]
  ds_read_b64_tr_b16 a[196:197], v42 offset:8192
  v_mfma_f32_16x16x32_bf16 v[180:183], a[200:203], a[168:171], v[180:183]
  buffer_store_dwordx4 v[88:91], v11, s[16:19], s3 offen offset:0 sc1
  v_mfma_f32_16x16x32_bf16 v[180:183], a[204:207], a[172:175], v[180:183]
  ds_read_b64_tr_b16 a[198:199], v42 offset:9216
  v_xor_b32 v26, 0x180, v26
  v_mfma_f32_16x16x32_bf16 v[148:151], a[204:207], a[164:167], v[148:151]
  ds_read_b128 a[0:3], v19
  v_xor_b32 v27, 0x180, v27
  v_mfma_f32_16x16x32_bf16 v[148:151], a[200:203], a[160:163], v[148:151]
  s_waitcnt lgkmcnt(13)
  s_add_u32 m0, s96, 0x20000
  v_mfma_f32_16x16x32_bf16 v[152:155], a[208:211], a[160:163], v[152:155]
  s_waitcnt lgkmcnt(11)
  ds_read_b64_tr_b16 a[200:201], v43 offset:0
  v_mfma_f32_16x16x32_bf16 v[152:155], a[212:215], a[164:167], v[152:155]
  ds_read_b64_tr_b16 a[202:203], v43 offset:1024
  v_mfma_f32_16x16x32_bf16 v[184:187], a[212:215], a[172:175], v[184:187]
  buffer_load_dwordx4 v26, s[56:59], s40 offen offset:0  lds
  v_mfma_f32_16x16x32_bf16 v[184:187], a[208:211], a[168:171], v[184:187]
  ds_read_b64_tr_b16 a[204:205], v43 offset:8192
  v_mfma_f32_16x16x32_bf16 v[216:219], a[208:211], a[176:179], v[216:219]
  ds_read_b64_tr_b16 a[206:207], v43 offset:9216
  v_accvgpr_read_b32 v55, a17
  v_mfma_f32_16x16x32_bf16 v[216:219], a[212:215], a[180:183], v[216:219]
  v_accvgpr_read_b32 v56, a18
  v_mfma_f32_16x16x32_bf16 v[248:251], a[212:215], a[188:191], v[248:251]
  buffer_load_dwordx4 v27, s[56:59], s41 offen offset:1024  lds
  v_mfma_f32_16x16x32_bf16 v[248:251], a[208:211], a[184:187], v[248:251]
  s_waitcnt lgkmcnt(11)
  v_accvgpr_read_b32 v57, a19
  v_mfma_f32_16x16x32_bf16 v[252:255], a[216:219], a[184:187], v[252:255]
  s_waitcnt lgkmcnt(9)
  ds_read_b64_tr_b16 a[208:209], v44 offset:0
  v_cvt_pk_bf16_f32 v64, v50, v51
  v_mfma_f32_16x16x32_bf16 v[252:255], a[220:223], a[188:191], v[252:255]
  ds_read_b64_tr_b16 a[210:211], v44 offset:1024
  v_mfma_f32_16x16x32_bf16 v[220:223], a[220:223], a[180:183], v[220:223]
  ds_read_b64_tr_b16 a[212:213], v44 offset:8192
  v_mfma_f32_16x16x32_bf16 v[220:223], a[216:219], a[176:179], v[220:223]
  buffer_load_dwordx4 v26, s[56:59], s42 offen offset:2048  lds
  v_mfma_f32_16x16x32_bf16 v[188:191], a[216:219], a[168:171], v[188:191]
  ds_read_b64_tr_b16 a[214:215], v44 offset:9216
  v_cvt_pk_bf16_f32 v65, v52, v53
  v_mfma_f32_16x16x32_bf16 v[188:191], a[220:223], a[172:175], v[188:191]
  ds_read_b128 a[16:19], v19
  v_cvt_pk_bf16_f32 v66, v54, v55
  v_mfma_f32_16x16x32_bf16 v[156:159], a[220:223], a[164:167], v[156:159]
  v_mfma_f32_16x16x32_bf16 v[156:159], a[216:219], a[160:163], v[156:159]
  s_waitcnt lgkmcnt(12)
  v_cvt_pk_bf16_f32 v67, v56, v57
  v_mfma_f32_16x16x32_bf16 v[128:131], a[192:195], a[224:227], v[128:131]
  s_waitcnt lgkmcnt(10)
  buffer_load_dwordx4 v27, s[56:59], s43 offen offset:3072  lds
  v_mfma_f32_16x16x32_bf16 v[128:131], a[196:199], a[228:231], v[128:131]
  ds_read_b64_tr_b16 a[216:217], v45 offset:0
  v_and_b32 v14, 2, v1
  v_mfma_f32_16x16x32_bf16 v[160:163], a[196:199], a[236:239], v[160:163]
  s_add_u32 m0, s96, 0x21000
  ds_read_b64_tr_b16 a[218:219], v45 offset:1024
  v_mfma_f32_16x16x32_bf16 v[160:163], a[192:195], a[232:235], v[160:163]
  ds_read_b64_tr_b16 a[220:221], v45 offset:8192
  v_mfma_f32_16x16x32_bf16 v[192:195], a[192:195], a[240:243], v[192:195]
  ds_read_b64_tr_b16 a[222:223], v45 offset:9216
  v_mfma_f32_16x16x32_bf16 v[192:195], a[196:199], a[244:247], v[192:195]
  buffer_load_dwordx4 v26, s[56:59], s44 offen offset:0  lds
  v_mfma_f32_16x16x32_bf16 v[224:227], a[196:199], a[252:255], v[224:227]
  s_waitcnt vmcnt(11)
  ds_read_b128 a[160:163], v34 offset:32768
  v_min_u32 v14, 1, v14
  v_mfma_f32_16x16x32_bf16 v[224:227], a[192:195], a[248:251], v[224:227]
  s_waitcnt lgkmcnt(12)
  ds_read_b128 a[164:167], v35 offset:32768
  v_mfma_f32_16x16x32_bf16 v[228:231], a[200:203], a[248:251], v[228:231]
  s_waitcnt lgkmcnt(11)
  ds_read_b64_tr_b16 a[192:193], v46 offset:0
  v_subrev_u32 v14, 1, v14
  v_mfma_f32_16x16x32_bf16 v[228:231], a[204:207], a[252:255], v[228:231]
  buffer_load_dwordx4 v27, s[56:59], s45 offen offset:1024  lds
  v_mfma_f32_16x16x32_bf16 v[196:199], a[204:207], a[244:247], v[196:199]
  ds_read_b64_tr_b16 a[194:195], v46 offset:1024
  v_and_b32 v14, 0x3f803f80, v14
  v_mfma_f32_16x16x32_bf16 v[196:199], a[200:203], a[240:243], v[196:199]
  ds_read_b64_tr_b16 a[196:197], v46 offset:8192
  v_mfma_f32_16x16x32_bf16 v[164:167], a[200:203], a[232:235], v[164:167]
  ds_read_b64_tr_b16 a[198:199], v46 offset:9216
  v_mfma_f32_16x16x32_bf16 v[164:167], a[204:207], a[236:239], v[164:167]
  ds_read_b128 a[168:171], v34 offset:34816
  v_mfma_f32_16x16x32_bf16 v[132:135], a[204:207], a[228:231], v[132:135]
  buffer_load_dwordx4 v26, s[56:59], s46 offen offset:2048  lds
  v_mfma_f32_16x16x32_bf16 v[132:135], a[200:203], a[224:227], v[132:135]
  ds_read_b128 a[172:175], v35 offset:34816
  v_accvgpr_read_b32 v58, a32
  s_waitcnt lgkmcnt(15)
  v_mfma_f32_16x16x32_bf16 v[136:139], a[208:211], a[224:227], v[136:139]
  s_waitcnt lgkmcnt(13)
  ds_read_b64_tr_b16 a[200:201], v47 offset:0
  v_mfma_f32_16x16x32_bf16 v[136:139], a[212:215], a[228:231], v[136:139]
  ds_read_b64_tr_b16 a[202:203], v47 offset:1024
  v_mfma_f32_16x16x32_bf16 v[168:171], a[212:215], a[236:239], v[168:171]
  ds_read_b64_tr_b16 a[204:205], v47 offset:8192
  v_accvgpr_read_b32 v59, a33
  v_mfma_f32_16x16x32_bf16 v[168:171], a[208:211], a[232:235], v[168:171]
  buffer_load_dwordx4 v27, s[56:59], s47 offen offset:3072  lds
  v_mfma_f32_16x16x32_bf16 v[200:203], a[208:211], a[240:243], v[200:203]
  s_mov_b32 s3, 0x3000
  ds_read_b64_tr_b16 a[206:207], v47 offset:9216
  v_mfma_f32_16x16x32_bf16 v[200:203], a[212:215], a[244:247], v[200:203]
  ds_read_b128 a[176:179], v34 offset:36864
  v_mfma_f32_16x16x32_bf16 v[232:235], a[212:215], a[252:255], v[232:235]
  ds_read_b128 a[180:183], v35 offset:36864
  v_mfma_f32_16x16x32_bf16 v[232:235], a[208:211], a[248:251], v[232:235]
  s_waitcnt lgkmcnt(15)
  buffer_store_dwordx4 v[92:95], v11, s[16:19], s3 offen offset:1024 sc1
  v_mfma_f32_16x16x32_bf16 v[236:239], a[216:219], a[248:251], v[236:239]
  ds_read_b64_tr_b16 a[208:209], v48 offset:0
  v_xor_b32 v28, 0x180000, v28
  s_waitcnt lgkmcnt(15)
  v_mfma_f32_16x16x32_bf16 v[236:239], a[220:223], a[252:255], v[236:239]
  ds_read_b64_tr_b16 a[210:211], v48 offset:1024
  v_xor_b32 v29, 0x180000, v29
  v_mfma_f32_16x16x32_bf16 v[204:207], a[220:223], a[244:247], v[204:207]
  s_add_u32 m0, s97, 0x18000
  ds_read_b64_tr_b16 a[212:213], v48 offset:8192
  v_mfma_f32_16x16x32_bf16 v[204:207], a[216:219], a[240:243], v[204:207]
  ds_read_b64_tr_b16 a[214:215], v48 offset:9216
  v_mfma_f32_16x16x32_bf16 v[172:175], a[216:219], a[232:235], v[172:175]
  ds_read_b128 a[184:187], v34 offset:38912
  v_mfma_f32_16x16x32_bf16 v[172:175], a[220:223], a[236:239], v[172:175]
  buffer_load_dwordx4 v28, s[60:63], s48 offen offset:0  lds
  v_mfma_f32_16x16x32_bf16 v[140:143], a[220:223], a[228:231], v[140:143]
  ds_read_b128 a[188:191], v35 offset:38912
  v_mfma_f32_16x16x32_bf16 v[140:143], a[216:219], a[224:227], v[140:143]
  s_waitcnt lgkmcnt(15)
  v_mfma_f32_16x16x32_bf16 v[144:147], a[192:195], a[224:227], v[144:147]
  ds_read_b64_tr_b16 a[216:217], v49 offset:0
  s_waitcnt lgkmcnt(15)
  v_mfma_f32_16x16x32_bf16 v[144:147], a[196:199], a[228:231], v[144:147]
  ds_read_b64_tr_b16 a[218:219], v49 offset:1024
  v_mfma_f32_16x16x32_bf16 v[176:179], a[196:199], a[236:239], v[176:179]
  buffer_load_dwordx4 v28, s[60:63], s49 offen offset:1024  lds
  v_mfma_f32_16x16x32_bf16 v[176:179], a[192:195], a[232:235], v[176:179]
  ds_read_b64_tr_b16 a[220:221], v49 offset:8192
  v_accvgpr_read_b32 v60, a34
  v_mfma_f32_16x16x32_bf16 v[208:211], a[192:195], a[240:243], v[208:211]
  ds_read_b64_tr_b16 a[222:223], v49 offset:9216
  v_mfma_f32_16x16x32_bf16 v[208:211], a[196:199], a[244:247], v[208:211]
  v_accvgpr_read_b32 v61, a35
  v_mfma_f32_16x16x32_bf16 v[240:243], a[196:199], a[252:255], v[240:243]
  v_accvgpr_read_b32 v62, a48
  v_accvgpr_read_b32 v63, a49
  v_mfma_f32_16x16x32_bf16 v[240:243], a[192:195], a[248:251], v[240:243]
  s_waitcnt vmcnt(12) lgkmcnt(14)
  buffer_load_dwordx4 v29, s[60:63], s50 offen offset:2048  lds
  v_mfma_f32_16x16x32_bf16 v[244:247], a[200:203], a[248:251], v[244:247]
  s_barrier
  s_waitcnt lgkmcnt(12)
  v_mfma_f32_16x16x32_bf16 v[244:247], a[204:207], a[252:255], v[244:247]
  ds_read_b64_tr_b16 a[192:193], v42 offset:16384
  v_accvgpr_read_b32 v50, a50
  v_mfma_f32_16x16x32_bf16 v[212:215], a[204:207], a[244:247], v[212:215]
  ds_read_b64_tr_b16 a[194:195], v42 offset:17408
  v_accvgpr_read_b32 v51, a51
  v_mfma_f32_16x16x32_bf16 v[212:215], a[200:203], a[240:243], v[212:215]
  buffer_load_dwordx4 v29, s[60:63], s51 offen offset:3072  lds
  v_mfma_f32_16x16x32_bf16 v[180:183], a[200:203], a[232:235], v[180:183]
  ds_read_b64_tr_b16 a[196:197], v42 offset:24576
  v_cvt_pk_bf16_f32 v68, v58, v59
  v_mfma_f32_16x16x32_bf16 v[180:183], a[204:207], a[236:239], v[180:183]
  s_mov_b32 s3, 0x0
  ds_read_b64_tr_b16 a[198:199], v42 offset:25600
  v_cvt_pk_bf16_f32 v69, v60, v61
  v_mfma_f32_16x16x32_bf16 v[148:151], a[204:207], a[228:231], v[148:151]
  v_cvt_pk_bf16_f32 v70, v62, v63
  v_cvt_pk_bf16_f32 v71, v50, v51
  v_mfma_f32_16x16x32_bf16 v[148:151], a[200:203], a[224:227], v[148:151]
  s_waitcnt lgkmcnt(12)
  ds_read_b128 a[32:35], v19
  v_mfma_f32_16x16x32_bf16 v[152:155], a[208:211], a[224:227], v[152:155]
  s_waitcnt lgkmcnt(11)
  buffer_store_dwordx4 v[64:67], v12, s[16:19], s3 offen offset:0 sc1
  v_mfma_f32_16x16x32_bf16 v[152:155], a[212:215], a[228:231], v[152:155]
  ds_read_b64_tr_b16 a[200:201], v43 offset:16384
  v_xor_b32 v26, 0x80, v26
  v_mfma_f32_16x16x32_bf16 v[184:187], a[212:215], a[236:239], v[184:187]
  ds_read_b64_tr_b16 a[202:203], v43 offset:17408
  v_xor_b32 v27, 0x80, v27
  v_mfma_f32_16x16x32_bf16 v[184:187], a[208:211], a[232:235], v[184:187]
  s_add_u32 m0, s96, 0x0
  ds_read_b64_tr_b16 a[204:205], v43 offset:24576
  v_mfma_f32_16x16x32_bf16 v[216:219], a[208:211], a[240:243], v[216:219]
  ds_read_b64_tr_b16 a[206:207], v43 offset:25600
  v_mfma_f32_16x16x32_bf16 v[216:219], a[212:215], a[244:247], v[216:219]
  ds_read_b128 a[48:51], v19
  v_mfma_f32_16x16x32_bf16 v[248:251], a[212:215], a[252:255], v[248:251]
  buffer_load_dwordx4 v26, s[56:59], s40 offen offset:0  lds
  v_mfma_f32_16x16x32_bf16 v[248:251], a[208:211], a[248:251], v[248:251]
  s_waitcnt lgkmcnt(12)
  v_mfma_f32_16x16x32_bf16 v[252:255], a[216:219], a[248:251], v[252:255]
  s_waitcnt lgkmcnt(10)
  ds_read_b64_tr_b16 a[208:209], v44 offset:16384
  v_mfma_f32_16x16x32_bf16 v[252:255], a[220:223], a[252:255], v[252:255]
  ds_read_b64_tr_b16 a[210:211], v44 offset:17408
  v_mfma_f32_16x16x32_bf16 v[220:223], a[220:223], a[244:247], v[220:223]
  ds_read_b64_tr_b16 a[212:213], v44 offset:24576
  v_mfma_f32_16x16x32_bf16 v[220:223], a[216:219], a[240:243], v[220:223]
  buffer_load_dwordx4 v27, s[56:59], s41 offen offset:1024  lds
  v_mfma_f32_16x16x32_bf16 v[188:191], a[216:219], a[232:235], v[188:191]
  ds_read_b64_tr_b16 a[214:215], v44 offset:25600
  v_mfma_f32_16x16x32_bf16 v[188:191], a[220:223], a[236:239], v[188:191]
  v_mfma_f32_16x16x32_bf16 v[156:159], a[220:223], a[228:231], v[156:159]
  v_accvgpr_read_b32 v52, a4
  v_mfma_f32_16x16x32_bf16 v[156:159], a[216:219], a[224:227], v[156:159]
  s_waitcnt lgkmcnt(12)
  v_accvgpr_read_b32 v53, a5
  v_mfma_f32_16x16x32_bf16 v[128:131], a[192:195], a[160:163], v[128:131]
  s_waitcnt lgkmcnt(10)
  buffer_load_dwordx4 v26, s[56:59], s42 offen offset:2048  lds
  v_mfma_f32_16x16x32_bf16 v[128:131], a[196:199], a[164:167], v[128:131]
  ds_read_b64_tr_b16 a[216:217], v45 offset:16384
  v_accvgpr_read_b32 v54, a6
  v_mfma_f32_16x16x32_bf16 v[160:163], a[196:199], a[172:175], v[160:163]
  ds_read_b64_tr_b16 a[218:219], v45 offset:17408
  v_mfma_f32_16x16x32_bf16 v[160:163], a[192:195], a[168:171], v[160:163]
  ds_read_b64_tr_b16 a[220:221], v45 offset:24576
  v_mfma_f32_16x16x32_bf16 v[192:195], a[192:195], a[176:179], v[192:195]
  buffer_load_dwordx4 v27, s[56:59], s43 offen offset:3072  lds
  v_mfma_f32_16x16x32_bf16 v[192:195], a[196:199], a[180:183], v[192:195]
  ds_read_b64_tr_b16 a[222:223], v45 offset:25600
  v_accvgpr_read_b32 v55, a7
  v_mfma_f32_16x16x32_bf16 v[224:227], a[196:199], a[188:191], v[224:227]
  s_waitcnt vmcnt(10)
  s_add_u32 m0, s96, 0x1000
  ds_read_b128 a[224:227], v36 offset:0
  v_mfma_f32_16x16x32_bf16 v[224:227], a[192:195], a[184:187], v[224:227]
  s_waitcnt lgkmcnt(12)
  ds_read_b128 a[228:231], v37 offset:0
  v_mfma_f32_16x16x32_bf16 v[228:231], a[200:203], a[184:187], v[228:231]
  s_waitcnt lgkmcnt(11)
  ds_read_b64_tr_b16 a[192:193], v46 offset:16384
  v_mfma_f32_16x16x32_bf16 v[228:231], a[204:207], a[188:191], v[228:231]
  buffer_load_dwordx4 v26, s[56:59], s44 offen offset:0  lds
  v_mfma_f32_16x16x32_bf16 v[196:199], a[204:207], a[180:183], v[196:199]
  ds_read_b64_tr_b16 a[194:195], v46 offset:17408
  v_accvgpr_read_b32 v56, a20
  v_mfma_f32_16x16x32_bf16 v[196:199], a[200:203], a[176:179], v[196:199]
  ds_read_b64_tr_b16 a[196:197], v46 offset:24576
  v_accvgpr_read_b32 v57, a21
  v_mfma_f32_16x16x32_bf16 v[164:167], a[200:203], a[168:171], v[164:167]
  ds_read_b64_tr_b16 a[198:199], v46 offset:25600
  v_accvgpr_read_b32 v58, a22
  v_mfma_f32_16x16x32_bf16 v[164:167], a[204:207], a[172:175], v[164:167]
  ds_read_b128 a[232:235], v36 offset:2048
  v_accvgpr_read_b32 v59, a23
  v_mfma_f32_16x16x32_bf16 v[132:135], a[204:207], a[164:167], v[132:135]
  buffer_load_dwordx4 v27, s[56:59], s45 offen offset:1024  lds
  v_mfma_f32_16x16x32_bf16 v[132:135], a[200:203], a[160:163], v[132:135]
  s_waitcnt lgkmcnt(13)
  ds_read_b128 a[236:239], v37 offset:2048
  v_cvt_pk_bf16_f32 v72, v52, v53
  v_mfma_f32_16x16x32_bf16 v[136:139], a[208:211], a[160:163], v[136:139]
  s_waitcnt lgkmcnt(12)
  ds_read_b64_tr_b16 a[200:201], v47 offset:16384
  v_cvt_pk_bf16_f32 v73, v54, v55
  v_mfma_f32_16x16x32_bf16 v[136:139], a[212:215], a[164:167], v[136:139]
  ds_read_b64_tr_b16 a[202:203], v47 offset:17408
  v_cvt_pk_bf16_f32 v74, v56, v57
  v_mfma_f32_16x16x32_bf16 v[168:171], a[212:215], a[172:175], v[168:171]
  buffer_load_dwordx4 v26, s[56:59], s46 offen offset:2048  lds
  v_mfma_f32_16x16x32_bf16 v[168:171], a[208:211], a[168:171], v[168:171]
  ds_read_b64_tr_b16 a[204:205], v47 offset:24576
  v_cvt_pk_bf16_f32 v75, v58, v59
  v_mfma_f32_16x16x32_bf16 v[200:203], a[208:211], a[176:179], v[200:203]
  ds_read_b64_tr_b16 a[206:207], v47 offset:25600
  v_mfma_f32_16x16x32_bf16 v[200:203], a[212:215], a[180:183], v[200:203]
  ds_read_b128 a[240:243], v36 offset:4096
  v_mfma_f32_16x16x32_bf16 v[232:235], a[212:215], a[188:191], v[232:235]
  ds_read_b128 a[244:247], v37 offset:4096
  v_mfma_f32_16x16x32_bf16 v[232:235], a[208:211], a[184:187], v[232:235]
  s_waitcnt lgkmcnt(15)
  buffer_load_dwordx4 v27, s[56:59], s47 offen offset:3072  lds
  v_mfma_f32_16x16x32_bf16 v[236:239], a[216:219], a[184:187], v[236:239]
  ds_read_b64_tr_b16 a[208:209], v48 offset:16384
  s_waitcnt lgkmcnt(15)
  v_mfma_f32_16x16x32_bf16 v[236:239], a[220:223], a[188:191], v[236:239]
  s_mov_b32 s3, 0x0
  ds_read_b64_tr_b16 a[210:211], v48 offset:17408
  v_mfma_f32_16x16x32_bf16 v[204:207], a[220:223], a[180:183], v[204:207]
  ds_read_b64_tr_b16 a[212:213], v48 offset:24576
  v_mfma_f32_16x16x32_bf16 v[204:207], a[216:219], a[176:179], v[204:207]
  ds_read_b64_tr_b16 a[214:215], v48 offset:25600
  v_mfma_f32_16x16x32_bf16 v[172:175], a[216:219], a[168:171], v[172:175]
  buffer_store_dwordx4 v[68:71], v12, s[16:19], s3 offen offset:1024 sc1
  v_mfma_f32_16x16x32_bf16 v[172:175], a[220:223], a[172:175], v[172:175]
  ds_read_b128 a[248:251], v36 offset:6144
  v_xor_b32 v28, 0x80000, v28
  v_mfma_f32_16x16x32_bf16 v[140:143], a[220:223], a[164:167], v[140:143]
  ds_read_b128 a[252:255], v37 offset:6144
  v_xor_b32 v29, 0x80000, v29
  v_mfma_f32_16x16x32_bf16 v[140:143], a[216:219], a[160:163], v[140:143]
  s_add_u32 m0, s97, 0x1c000
  ds_read_b128 a[4:7], v19
  s_waitcnt lgkmcnt(15)
  v_mfma_f32_16x16x32_bf16 v[144:147], a[192:195], a[160:163], v[144:147]
  ds_read_b64_tr_b16 a[216:217], v49 offset:16384
  v_mfma_f32_16x16x32_bf16 v[144:147], a[196:199], a[164:167], v[144:147]
  ds_read_b64_tr_b16 a[218:219], v49 offset:17408
  v_mfma_f32_16x16x32_bf16 v[176:179], a[196:199], a[172:175], v[176:179]
  buffer_load_dwordx4 v28, s[60:63], s48 offen offset:0  lds
  v_mfma_f32_16x16x32_bf16 v[176:179], a[192:195], a[168:171], v[176:179]
  ds_read_b64_tr_b16 a[220:221], v49 offset:24576
  v_mfma_f32_16x16x32_bf16 v[208:211], a[192:195], a[176:179], v[208:211]
  ds_read_b64_tr_b16 a[222:223], v49 offset:25600
  v_mfma_f32_16x16x32_bf16 v[208:211], a[196:199], a[180:183], v[208:211]
L_pad6:
  s_cbranch_execz L_hr0
  ds_read_b128 a[20:23], v19
  v_mfma_f32_16x16x32_bf16 v[240:243], a[196:199], a[188:191], v[240:243]
  buffer_load_dwordx4 v28, s[60:63], s49 offen offset:1024  lds
  v_mfma_f32_16x16x32_bf16 v[240:243], a[192:195], a[184:187], v[240:243]
  s_waitcnt vmcnt(12) lgkmcnt(15)
  v_mfma_f32_16x16x32_bf16 v[244:247], a[200:203], a[184:187], v[244:247]
  s_barrier
  s_waitcnt lgkmcnt(14)
  v_mfma_f32_16x16x32_bf16 v[244:247], a[204:207], a[188:191], v[244:247]
  ds_read_b64_tr_b16 a[192:193], v42 offset:32768
  v_mfma_f32_16x16x32_bf16 v[212:215], a[204:207], a[180:183], v[212:215]
  ds_read_b64_tr_b16 a[194:195], v42 offset:33792
  v_mfma_f32_16x16x32_bf16 v[212:215], a[200:203], a[176:179], v[212:215]
  buffer_load_dwordx4 v29, s[60:63], s50 offen offset:2048  lds
  v_mfma_f32_16x16x32_bf16 v[180:183], a[200:203], a[168:171], v[180:183]
  ds_read_b64_tr_b16 a[196:197], v42 offset:40960
  v_mfma_f32_16x16x32_bf16 v[180:183], a[204:207], a[172:175], v[180:183]
  ds_read_b64_tr_b16 a[198:199], v42 offset:41984
  v_mfma_f32_16x16x32_bf16 v[148:151], a[204:207], a[164:167], v[148:151]
  v_mfma_f32_16x16x32_bf16 v[148:151], a[200:203], a[160:163], v[148:151]
  s_waitcnt lgkmcnt(14)
  v_accvgpr_read_b32 v60, a36
  v_accvgpr_read_b32 v61, a37
  v_mfma_f32_16x16x32_bf16 v[152:155], a[208:211], a[160:163], v[152:155]
  s_waitcnt lgkmcnt(12)
  buffer_load_dwordx4 v29, s[60:63], s51 offen offset:3072  lds
  v_mfma_f32_16x16x32_bf16 v[152:155], a[212:215], a[164:167], v[152:155]
  ds_read_b64_tr_b16 a[200:201], v43 offset:32768
  v_xor_b32 v26, 0x780, v26
  v_mfma_f32_16x16x32_bf16 v[184:187], a[212:215], a[172:175], v[184:187]
  ds_read_b64_tr_b16 a[202:203], v43 offset:33792
  v_xor_b32 v27, 0x780, v27
  v_mfma_f32_16x16x32_bf16 v[184:187], a[208:211], a[168:171], v[184:187]
  s_add_u32 m0, s96, 0x8000
  ds_read_b64_tr_b16 a[204:205], v43 offset:40960
  v_accvgpr_read_b32 v62, a38
  v_mfma_f32_16x16x32_bf16 v[216:219], a[208:211], a[176:179], v[216:219]
  ds_read_b64_tr_b16 a[206:207], v43 offset:41984
  v_accvgpr_read_b32 v63, a39
  v_mfma_f32_16x16x32_bf16 v[216:219], a[212:215], a[180:183], v[216:219]
  buffer_load_dwordx4 v26, s[56:59], s40 offen offset:0  lds
  v_mfma_f32_16x16x32_bf16 v[248:251], a[212:215], a[188:191], v[248:251]
  v_accvgpr_read_b32 v50, a52
  v_accvgpr_read_b32 v51, a53
  v_mfma_f32_16x16x32_bf16 v[248:251], a[208:211], a[184:187], v[248:251]
  s_waitcnt lgkmcnt(11)
  v_accvgpr_read_b32 v52, a54
  v_accvgpr_read_b32 v53, a55
  v_mfma_f32_16x16x32_bf16 v[252:255], a[216:219], a[184:187], v[252:255]
  s_waitcnt lgkmcnt(9)
  ds_read_b64_tr_b16 a[208:209], v44 offset:32768
  v_cvt_pk_bf16_f32 v76, v60, v61
  v_mfma_f32_16x16x32_bf16 v[252:255], a[220:223], a[188:191], v[252:255]
  buffer_load_dwordx4 v27, s[56:59], s41 offen offset:1024  lds
  v_mfma_f32_16x16x32_bf16 v[220:223], a[220:223], a[180:183], v[220:223]
  ds_read_b64_tr_b16 a[210:211], v44 offset:33792
  v_cvt_pk_bf16_f32 v77, v62, v63
  v_mfma_f32_16x16x32_bf16 v[220:223], a[216:219], a[176:179], v[220:223]
  ds_read_b64_tr_b16 a[212:213], v44 offset:40960
  v_cvt_pk_bf16_f32 v78, v50, v51
  v_mfma_f32_16x16x32_bf16 v[188:191], a[216:219], a[168:171], v[188:191]
  ds_read_b64_tr_b16 a[214:215], v44 offset:41984
  v_cvt_pk_bf16_f32 v79, v52, v53
  v_mfma_f32_16x16x32_bf16 v[188:191], a[220:223], a[172:175], v[188:191]
  ds_read_b128 a[36:39], v19
  v_mfma_f32_16x16x32_bf16 v[156:159], a[220:223], a[164:167], v[156:159]
  buffer_load_dwordx4 v26, s[56:59], s42 offen offset:2048  lds
  v_mfma_f32_16x16x32_bf16 v[156:159], a[216:219], a[160:163], v[156:159]
  s_waitcnt lgkmcnt(11)
  ds_read_b128 a[52:55], v19
  v_mfma_f32_16x16x32_bf16 v[128:131], a[192:195], a[224:227], v[128:131]
  s_waitcnt lgkmcnt(10)
  ds_read_b64_tr_b16 a[216:217], v45 offset:32768
  v_mfma_f32_16x16x32_bf16 v[128:131], a[196:199], a[228:231], v[128:131]
  ds_read_b64_tr_b16 a[218:219], v45 offset:33792
  v_mfma_f32_16x16x32_bf16 v[160:163], a[196:199], a[236:239], v[160:163]
  ds_read_b64_tr_b16 a[220:221], v45 offset:40960
  v_mfma_f32_16x16x32_bf16 v[160:163], a[192:195], a[232:235], v[160:163]
  buffer_load_dwordx4 v27, s[56:59], s43 offen offset:3072  lds
  v_mfma_f32_16x16x32_bf16 v[192:195], a[192:195], a[240:243], v[192:195]
  s_add_u32 m0, s96, 0x9000
  ds_read_b64_tr_b16 a[222:223], v45 offset:41984
  v_accvgpr_read_b32 v54, a64
  v_mfma_f32_16x16x32_bf16 v[192:195], a[196:199], a[244:247], v[192:195]
  s_waitcnt vmcnt(9)
  ds_read_b128 a[160:163], v34 offset:0
  v_accvgpr_read_b32 v55, a65
  v_mfma_f32_16x16x32_bf16 v[224:227], a[196:199], a[252:255], v[224:227]
  buffer_load_dwordx4 v26, s[56:59], s44 offen offset:0  lds
  v_mfma_f32_16x16x32_bf16 v[224:227], a[192:195], a[248:251], v[224:227]
  s_waitcnt lgkmcnt(13)
  ds_read_b128 a[164:167], v35 offset:0
  v_accvgpr_read_b32 v56, a66
  v_mfma_f32_16x16x32_bf16 v[228:231], a[200:203], a[248:251], v[228:231]
  s_waitcnt lgkmcnt(12)
  ds_read_b64_tr_b16 a[192:193], v46 offset:32768
  v_accvgpr_read_b32 v57, a67
  v_mfma_f32_16x16x32_bf16 v[228:231], a[204:207], a[252:255], v[228:231]
  buffer_load_dwordx4 v27, s[56:59], s45 offen offset:1024  lds
  v_mfma_f32_16x16x32_bf16 v[196:199], a[204:207], a[244:247], v[196:199]
  ds_read_b64_tr_b16 a[194:195], v46 offset:33792
  v_accvgpr_read_b32 v58, a80
  v_mfma_f32_16x16x32_bf16 v[196:199], a[200:203], a[240:243], v[196:199]
  ds_read_b64_tr_b16 a[196:197], v46 offset:40960
  v_accvgpr_read_b32 v59, a81
  v_mfma_f32_16x16x32_bf16 v[164:167], a[200:203], a[232:235], v[164:167]
  buffer_load_dwordx4 v26, s[56:59], s46 offen offset:2048  lds
  v_mfma_f32_16x16x32_bf16 v[164:167], a[204:207], a[236:239], v[164:167]
  ds_read_b64_tr_b16 a[198:199], v46 offset:41984
  v_accvgpr_read_b32 v60, a82
  v_mfma_f32_16x16x32_bf16 v[132:135], a[204:207], a[228:231], v[132:135]
  v_accvgpr_read_b32 v61, a83
  v_cvt_pk_bf16_f32 v64, v54, v55
  v_mfma_f32_16x16x32_bf16 v[132:135], a[200:203], a[224:227], v[132:135]
  s_waitcnt lgkmcnt(14)
  buffer_load_dwordx4 v27, s[56:59], s47 offen offset:3072  lds
  v_mfma_f32_16x16x32_bf16 v[136:139], a[208:211], a[224:227], v[136:139]
  s_waitcnt lgkmcnt(12)
  s_mov_b32 s3, 0x0
  ds_read_b64_tr_b16 a[200:201], v47 offset:32768
  v_cvt_pk_bf16_f32 v65, v56, v57
  v_mfma_f32_16x16x32_bf16 v[136:139], a[212:215], a[228:231], v[136:139]
  v_cvt_pk_bf16_f32 v66, v58, v59
  v_cvt_pk_bf16_f32 v67, v60, v61
  v_mfma_f32_16x16x32_bf16 v[168:171], a[212:215], a[236:239], v[168:171]
  buffer_store_dwordx4 v[72:75], v12, s[16:19], s3 offen offset:2048 sc1
  v_mfma_f32_16x16x32_bf16 v[168:171], a[208:211], a[232:235], v[168:171]
  ds_read_b64_tr_b16 a[202:203], v47 offset:33792
  v_xor_b32 v28, 0x780000, v28
  v_mfma_f32_16x16x32_bf16 v[200:203], a[208:211], a[240:243], v[200:203]
  ds_read_b64_tr_b16 a[204:205], v47 offset:40960
  v_xor_b32 v29, 0x780000, v29
  v_mfma_f32_16x16x32_bf16 v[200:203], a[212:215], a[244:247], v[200:203]
  s_add_u32 m0, s97, 0x10000
  ds_read_b128 a[168:171], v34 offset:2048
  v_accvgpr_read_b32 v62, a8
  v_mfma_f32_16x16x32_bf16 v[232:235], a[212:215], a[252:255], v[232:235]
  buffer_load_dwordx4 v28, s[60:63], s48 offen offset:0  lds
  v_mfma_f32_16x16x32_bf16 v[232:235], a[208:211], a[248:251], v[232:235]
  s_waitcnt lgkmcnt(12)
  ds_read_b64_tr_b16 a[206:207], v47 offset:41984
  v_accvgpr_read_b32 v63, a9
  v_mfma_f32_16x16x32_bf16 v[236:239], a[216:219], a[248:251], v[236:239]
  s_waitcnt lgkmcnt(11)
  ds_read_b128 a[172:175], v35 offset:2048
  v_accvgpr_read_b32 v50, a10
  v_mfma_f32_16x16x32_bf16 v[236:239], a[220:223], a[252:255], v[236:239]
  buffer_load_dwordx4 v28, s[60:63], s49 offen offset:1024  lds
  v_mfma_f32_16x16x32_bf16 v[204:207], a[220:223], a[244:247], v[204:207]
  ds_read_b64_tr_b16 a[208:209], v48 offset:32768
  v_accvgpr_read_b32 v51, a11
  v_mfma_f32_16x16x32_bf16 v[204:207], a[216:219], a[240:243], v[204:207]
  ds_read_b64_tr_b16 a[210:211], v48 offset:33792
  v_accvgpr_read_b32 v52, a24
  v_mfma_f32_16x16x32_bf16 v[172:175], a[216:219], a[232:235], v[172:175]
  ds_read_b64_tr_b16 a[212:213], v48 offset:40960
  v_accvgpr_read_b32 v53, a25
  v_mfma_f32_16x16x32_bf16 v[172:175], a[220:223], a[236:239], v[172:175]
  ds_read_b128 a[176:179], v34 offset:4096
  v_accvgpr_read_b32 v54, a26
  v_mfma_f32_16x16x32_bf16 v[140:143], a[220:223], a[228:231], v[140:143]
  buffer_load_dwordx4 v29, s[60:63], s50 offen offset:2048  lds
  v_mfma_f32_16x16x32_bf16 v[140:143], a[216:219], a[224:227], v[140:143]
  s_waitcnt lgkmcnt(12)
  ds_read_b64_tr_b16 a[214:215], v48 offset:41984
  v_accvgpr_read_b32 v55, a27
  v_mfma_f32_16x16x32_bf16 v[144:147], a[192:195], a[224:227], v[144:147]
  s_waitcnt lgkmcnt(11)
  ds_read_b128 a[180:183], v35 offset:4096
  v_cvt_pk_bf16_f32 v80, v62, v63
  v_mfma_f32_16x16x32_bf16 v[144:147], a[196:199], a[228:231], v[144:147]
  ds_read_b64_tr_b16 a[216:217], v49 offset:32768
  v_cvt_pk_bf16_f32 v81, v50, v51
  v_mfma_f32_16x16x32_bf16 v[176:179], a[196:199], a[236:239], v[176:179]
  v_cvt_pk_bf16_f32 v82, v52, v53
  v_cvt_pk_bf16_f32 v83, v54, v55
  v_mfma_f32_16x16x32_bf16 v[176:179], a[192:195], a[232:235], v[176:179]
  buffer_load_dwordx4 v29, s[60:63], s51 offen offset:3072  lds
  v_mfma_f32_16x16x32_bf16 v[208:211], a[192:195], a[240:243], v[208:211]
  s_mov_b32 s3, 0x0
  ds_read_b64_tr_b16 a[218:219], v49 offset:33792
  v_mfma_f32_16x16x32_bf16 v[208:211], a[196:199], a[244:247], v[208:211]
  ds_read_b64_tr_b16 a[220:221], v49 offset:40960
  v_mfma_f32_16x16x32_bf16 v[240:243], a[196:199], a[252:255], v[240:243]
  ds_read_b128 a[184:187], v34 offset:6144
  v_mfma_f32_16x16x32_bf16 v[240:243], a[192:195], a[248:251], v[240:243]
  s_waitcnt vmcnt(13) lgkmcnt(14)
  buffer_store_dwordx4 v[76:79], v12, s[16:19], s3 offen offset:3072 sc1
  v_mfma_f32_16x16x32_bf16 v[244:247], a[200:203], a[248:251], v[244:247]
  s_barrier
  s_waitcnt lgkmcnt(11)
  v_mfma_f32_16x16x32_bf16 v[244:247], a[204:207], a[252:255], v[244:247]
  ds_read_b64_tr_b16 a[222:223], v49 offset:41984
  v_xor_b32 v26, 0x80, v26
  v_mfma_f32_16x16x32_bf16 v[212:215], a[204:207], a[244:247], v[212:215]
  ds_read_b128 a[188:191], v35 offset:6144
  v_xor_b32 v27, 0x80, v27
  v_mfma_f32_16x16x32_bf16 v[212:215], a[200:203], a[240:243], v[212:215]
  s_add_u32 m0, s96, 0x20000
  ds_read_b64_tr_b16 a[192:193], v42 offset:49152
  v_accvgpr_read_b32 v56, a96
  v_mfma_f32_16x16x32_bf16 v[180:183], a[200:203], a[232:235], v[180:183]
  ds_read_b64_tr_b16 a[194:195], v42 offset:50176
  v_accvgpr_read_b32 v57, a97
  v_mfma_f32_16x16x32_bf16 v[180:183], a[204:207], a[236:239], v[180:183]
  buffer_load_dwordx4 v26, s[56:59], s40 offen offset:0  lds
  v_mfma_f32_16x16x32_bf16 v[148:151], a[204:207], a[228:231], v[148:151]
  ds_read_b64_tr_b16 a[196:197], v42 offset:57344
  v_accvgpr_read_b32 v58, a98
  v_mfma_f32_16x16x32_bf16 v[148:151], a[200:203], a[224:227], v[148:151]
  s_waitcnt lgkmcnt(13)
  ds_read_b64_tr_b16 a[198:199], v42 offset:58368
  v_accvgpr_read_b32 v59, a99
  v_mfma_f32_16x16x32_bf16 v[152:155], a[208:211], a[224:227], v[152:155]
  s_waitcnt lgkmcnt(11)
  ds_read_b64_tr_b16 a[200:201], v43 offset:49152
  v_accvgpr_read_b32 v60, a112
  v_mfma_f32_16x16x32_bf16 v[152:155], a[212:215], a[228:231], v[152:155]
  ds_read_b64_tr_b16 a[202:203], v43 offset:50176
  v_accvgpr_read_b32 v61, a113
  v_mfma_f32_16x16x32_bf16 v[184:187], a[212:215], a[236:239], v[184:187]
  buffer_load_dwordx4 v27, s[56:59], s41 offen offset:1024  lds
  v_mfma_f32_16x16x32_bf16 v[184:187], a[208:211], a[232:235], v[184:187]
  ds_read_b64_tr_b16 a[204:205], v43 offset:57344
  v_accvgpr_read_b32 v62, a114
  v_mfma_f32_16x16x32_bf16 v[216:219], a[208:211], a[240:243], v[216:219]
  ds_read_b64_tr_b16 a[206:207], v43 offset:58368
  v_accvgpr_read_b32 v63, a115
  v_mfma_f32_16x16x32_bf16 v[216:219], a[212:215], a[244:247], v[216:219]
  v_cvt_pk_bf16_f32 v68, v56, v57
  v_cvt_pk_bf16_f32 v69, v58, v59
  v_mfma_f32_16x16x32_bf16 v[248:251], a[212:215], a[252:255], v[248:251]
  v_cvt_pk_bf16_f32 v70, v60, v61
  v_cvt_pk_bf16_f32 v71, v62, v63
  v_mfma_f32_16x16x32_bf16 v[248:251], a[208:211], a[248:251], v[248:251]
  s_waitcnt lgkmcnt(12)
  buffer_load_dwordx4 v26, s[56:59], s42 offen offset:2048  lds
  v_mfma_f32_16x16x32_bf16 v[252:255], a[216:219], a[248:251], v[252:255]
  s_waitcnt lgkmcnt(9)
  ds_read_b64_tr_b16 a[208:209], v44 offset:49152
  v_accvgpr_read_b32 v50, a40
  v_mfma_f32_16x16x32_bf16 v[252:255], a[220:223], a[252:255], v[252:255]
  ds_read_b64_tr_b16 a[210:211], v44 offset:50176
  v_accvgpr_read_b32 v51, a41
  v_mfma_f32_16x16x32_bf16 v[220:223], a[220:223], a[244:247], v[220:223]
  ds_read_b64_tr_b16 a[212:213], v44 offset:57344
  v_accvgpr_read_b32 v52, a42
  v_mfma_f32_16x16x32_bf16 v[220:223], a[216:219], a[240:243], v[220:223]
  buffer_load_dwordx4 v27, s[56:59], s43 offen offset:3072  lds
  v_mfma_f32_16x16x32_bf16 v[188:191], a[216:219], a[232:235], v[188:191]
  ds_read_b64_tr_b16 a[214:215], v44 offset:58368
  v_accvgpr_read_b32 v53, a43
  v_mfma_f32_16x16x32_bf16 v[188:191], a[220:223], a[236:239], v[188:191]
  s_add_u32 m0, s96, 0x21000
  v_accvgpr_read_b32 v54, a56
  v_accvgpr_read_b32 v55, a57
  v_mfma_f32_16x16x32_bf16 v[156:159], a[220:223], a[228:231], v[156:159]
  v_accvgpr_read_b32 v56, a58
  v_accvgpr_read_b32 v57, a59
  v_mfma_f32_16x16x32_bf16 v[156:159], a[216:219], a[224:227], v[156:159]
  s_waitcnt lgkmcnt(10)
  v_cvt_pk_bf16_f32 v84, v50, v51
  v_cvt_pk_bf16_f32 v85, v52, v53
  v_mfma_f32_16x16x32_bf16 v[128:131], a[192:195], a[160:163], v[128:131]
L_gq1:
  buffer_load_dwordx4 v26, s[56:59], s44 offen offset:0  lds
  s_waitcnt lgkmcnt(8)
  v_mfma_f32_16x16x32_bf16 v[128:131], a[196:199], a[164:167], v[128:131]
  ds_read_b64_tr_b16 a[216:217], v45 offset:49152
  v_cvt_pk_bf16_f32 v86, v54, v55
  v_mfma_f32_16x16x32_bf16 v[160:163], a[196:199], a[172:175], v[160:163]
  ds_read_b64_tr_b16 a[218:219], v45 offset:50176
  v_cvt_pk_bf16_f32 v87, v56, v57
  v_mfma_f32_16x16x32_bf16 v[160:163], a[192:195], a[168:171], v[160:163]
  ds_read_b64_tr_b16 a[220:221], v45 offset:57344
  v_mfma_f32_16x16x32_bf16 v[192:195], a[192:195], a[176:179], v[192:195]
  ds_read_b64_tr_b16 a[222:223], v45 offset:58368
  v_mfma_f32_16x16x32_bf16 v[192:195], a[196:199], a[180:183], v[192:195]
  buffer_load_dwordx4 v27, s[56:59], s45 offen offset:1024  lds
  v_mfma_f32_16x16x32_bf16 v[224:227], a[196:199], a[188:191], v[224:227]
  s_waitcnt vmcnt(12)
  ds_read_b128 a[224:227], v34 offset:32768
  v_mfma_f32_16x16x32_bf16 v[224:227], a[192:195], a[184:187], v[224:227]
  s_waitcnt lgkmcnt(11)
  ds_read_b128 a[228:231], v35 offset:32768
  v_mfma_f32_16x16x32_bf16 v[228:231], a[200:203], a[184:187], v[228:231]
  s_waitcnt lgkmcnt(10)
  ds_read_b64_tr_b16 a[192:193], v46 offset:49152
  v_mfma_f32_16x16x32_bf16 v[228:231], a[204:207], a[188:191], v[228:231]
  ds_read_b64_tr_b16 a[194:195], v46 offset:50176
  v_mfma_f32_16x16x32_bf16 v[196:199], a[204:207], a[180:183], v[196:199]
  buffer_load_dwordx4 v26, s[56:59], s46 offen offset:2048  lds
  v_mfma_f32_16x16x32_bf16 v[196:199], a[200:203], a[176:179], v[196:199]
  ds_read_b64_tr_b16 a[196:197], v46 offset:57344
  v_mfma_f32_16x16x32_bf16 v[164:167], a[200:203], a[168:171], v[164:167]
  ds_read_b64_tr_b16 a[198:199], v46 offset:58368
  v_mfma_f32_16x16x32_bf16 v[164:167], a[204:207], a[172:175], v[164:167]
  ds_read_b128 a[232:235], v34 offset:34816
  v_accvgpr_read_b32 v58, a68
  v_mfma_f32_16x16x32_bf16 v[132:135], a[204:207], a[164:167], v[132:135]
  buffer_load_dwordx4 v27, s[56:59], s47 offen offset:3072  lds
  v_mfma_f32_16x16x32_bf16 v[132:135], a[200:203], a[160:163], v[132:135]
  s_waitcnt lgkmcnt(13)
  ds_read_b128 a[236:239], v35 offset:34816
  v_accvgpr_read_b32 v59, a69
  v_mfma_f32_16x16x32_bf16 v[136:139], a[208:211], a[160:163], v[136:139]
  s_waitcnt lgkmcnt(12)
  s_mov_b32 s3, 0x1000
  ds_read_b64_tr_b16 a[200:201], v47 offset:49152
  v_accvgpr_read_b32 v60, a70
  v_mfma_f32_16x16x32_bf16 v[136:139], a[212:215], a[164:167], v[136:139]
  ds_read_b64_tr_b16 a[202:203], v47 offset:50176
  v_accvgpr_read_b32 v61, a71
  v_mfma_f32_16x16x32_bf16 v[168:171], a[212:215], a[172:175], v[168:171]
  ds_read_b64_tr_b16 a[204:205], v47 offset:57344
  v_accvgpr_read_b32 v62, a84
  v_mfma_f32_16x16x32_bf16 v[168:171], a[208:211], a[168:171], v[168:171]
  buffer_store_dwordx4 v[80:83], v12, s[16:19], s3 offen offset:0 sc1
  v_mfma_f32_16x16x32_bf16 v[200:203], a[208:211], a[176:179], v[200:203]
  ds_read_b64_tr_b16 a[206:207], v47 offset:58368
  v_xor_b32 v28, 0x80000, v28
  v_mfma_f32_16x16x32_bf16 v[200:203], a[212:215], a[180:183], v[200:203]
  v_xor_b32 v29, 0x80000, v29
  v_accvgpr_read_b32 v63, a85
  v_mfma_f32_16x16x32_bf16 v[232:235], a[212:215], a[188:191], v[232:235]
  s_add_u32 m0, s97, 0x14000
  v_accvgpr_read_b32 v50, a86
  v_accvgpr_read_b32 v51, a87
  v_mfma_f32_16x16x32_bf16 v[232:235], a[208:211], a[184:187], v[232:235]
  s_waitcnt lgkmcnt(14)
  v_cvt_pk_bf16_f32 v72, v58, v59
  v_cvt_pk_bf16_f32 v73, v60, v61
  v_mfma_f32_16x16x32_bf16 v[236:239], a[216:219], a[184:187], v[236:239]
  s_waitcnt lgkmcnt(12)
  ds_read_b64_tr_b16 a[208:209], v48 offset:49152
  v_cvt_pk_bf16_f32 v74, v62, v63
  v_mfma_f32_16x16x32_bf16 v[236:239], a[220:223], a[188:191], v[236:239]
  buffer_load_dwordx4 v28, s[60:63], s48 offen offset:0  lds
  v_mfma_f32_16x16x32_bf16 v[204:207], a[220:223], a[180:183], v[204:207]
  ds_read_b64_tr_b16 a[210:211], v48 offset:50176
  v_cvt_pk_bf16_f32 v75, v50, v51
  v_mfma_f32_16x16x32_bf16 v[204:207], a[216:219], a[176:179], v[204:207]
  ds_read_b64_tr_b16 a[212:213], v48 offset:57344
  v_mfma_f32_16x16x32_bf16 v[172:175], a[216:219], a[168:171], v[172:175]
  ds_read_b128 a[240:243], v34 offset:36864
  v_mfma_f32_16x16x32_bf16 v[172:175], a[220:223], a[172:175], v[172:175]
  ds_read_b64_tr_b16 a[214:215], v48 offset:58368
  v_accvgpr_read_b32 v52, a12
  v_mfma_f32_16x16x32_bf16 v[140:143], a[220:223], a[164:167], v[140:143]
  buffer_load_dwordx4 v28, s[60:63], s49 offen offset:1024  lds
  v_mfma_f32_16x16x32_bf16 v[140:143], a[216:219], a[160:163], v[140:143]
  s_waitcnt lgkmcnt(13)
  ds_read_b128 a[244:247], v35 offset:36864
  v_accvgpr_read_b32 v53, a13
  v_mfma_f32_16x16x32_bf16 v[144:147], a[192:195], a[160:163], v[144:147]
  s_waitcnt lgkmcnt(12)
  ds_read_b64_tr_b16 a[216:217], v49 offset:49152
  v_accvgpr_read_b32 v54, a14
  v_mfma_f32_16x16x32_bf16 v[144:147], a[196:199], a[164:167], v[144:147]
  ds_read_b64_tr_b16 a[218:219], v49 offset:50176
  v_accvgpr_read_b32 v55, a15
  v_mfma_f32_16x16x32_bf16 v[176:179], a[196:199], a[172:175], v[176:179]
  buffer_load_dwordx4 v29, s[60:63], s50 offen offset:2048  lds
  v_mfma_f32_16x16x32_bf16 v[176:179], a[192:195], a[168:171], v[176:179]
  ds_read_b64_tr_b16 a[220:221], v49 offset:57344
  v_accvgpr_read_b32 v56, a28
  v_mfma_f32_16x16x32_bf16 v[208:211], a[192:195], a[176:179], v[208:211]
  ds_read_b128 a[248:251], v34 offset:38912
  v_accvgpr_read_b32 v57, a29
  v_mfma_f32_16x16x32_bf16 v[208:211], a[196:199], a[180:183], v[208:211]
  ds_read_b64_tr_b16 a[222:223], v49 offset:58368
  v_accvgpr_read_b32 v58, a30
  v_mfma_f32_16x16x32_bf16 v[240:243], a[196:199], a[188:191], v[240:243]
  ds_read_b128 a[252:255], v35 offset:38912
  v_accvgpr_read_b32 v59, a31
  v_mfma_f32_16x16x32_bf16 v[240:243], a[192:195], a[184:187], v[240:243]
  s_waitcnt vmcnt(13) lgkmcnt(14)
  buffer_load_dwordx4 v29, s[60:63], s51 offen offset:3072  lds
  v_mfma_f32_16x16x32_bf16 v[244:247], a[200:203], a[184:187], v[244:247]
  s_barrier
  s_waitcnt lgkmcnt(12)
  v_mfma_f32_16x16x32_bf16 v[244:247], a[204:207], a[188:191], v[244:247]
  s_mov_b32 s3, 0x1000
  ds_read_b64_tr_b16 a[192:193], v42 offset:0
  v_cvt_pk_bf16_f32 v88, v52, v53
  v_mfma_f32_16x16x32_bf16 v[212:215], a[204:207], a[180:183], v[212:215]
  ds_read_b64_tr_b16 a[194:195], v42 offset:1024
  v_cvt_pk_bf16_f32 v89, v54, v55
  v_mfma_f32_16x16x32_bf16 v[212:215], a[200:203], a[176:179], v[212:215]
  v_cvt_pk_bf16_f32 v90, v56, v57
  v_cvt_pk_bf16_f32 v91, v58, v59
  v_mfma_f32_16x16x32_bf16 v[180:183], a[200:203], a[168:171], v[180:183]
  buffer_store_dwordx4 v[84:87], v12, s[16:19], s3 offen offset:1024 sc1
  v_mfma_f32_16x16x32_bf16 v[180:183], a[204:207], a[172:175], v[180:183]
  ds_read_b64_tr_b16 a[196:197], v42 offset:8192
  v_xor_b32 v26, 0x180, v26
  v_mfma_f32_16x16x32_bf16 v[148:151], a[204:207], a[164:167], v[148:151]
  ds_read_b64_tr_b16 a[198:199], v42 offset:9216
  v_xor_b32 v27, 0x180, v27
  v_mfma_f32_16x16x32_bf16 v[148:151], a[200:203], a[160:163], v[148:151]
  s_add_u32 m0, s96, 0x0
  ds_read_b128 a[8:11], v19
  s_waitcnt lgkmcnt(15)
  v_mfma_f32_16x16x32_bf16 v[152:155], a[208:211], a[160:163], v[152:155]
  s_waitcnt lgkmcnt(12)
  ds_read_b64_tr_b16 a[200:201], v43 offset:0
  v_mfma_f32_16x16x32_bf16 v[152:155], a[212:215], a[164:167], v[152:155]
  ds_read_b64_tr_b16 a[202:203], v43 offset:1024
  v_mfma_f32_16x16x32_bf16 v[184:187], a[212:215], a[172:175], v[184:187]
  buffer_load_dwordx4 v26, s[56:59], s40 offen offset:0  lds
  v_mfma_f32_16x16x32_bf16 v[184:187], a[208:211], a[168:171], v[184:187]
  ds_read_b64_tr_b16 a[204:205], v43 offset:8192
  v_accvgpr_read_b32 v60, a100
  v_mfma_f32_16x16x32_bf16 v[216:219], a[208:211], a[176:179], v[216:219]
  ds_read_b64_tr_b16 a[206:207], v43 offset:9216
  v_accvgpr_read_b32 v61, a101
  v_mfma_f32_16x16x32_bf16 v[216:219], a[212:215], a[180:183], v[216:219]
  v_accvgpr_read_b32 v62, a102
  v_accvgpr_read_b32 v63, a103
  v_mfma_f32_16x16x32_bf16 v[248:251], a[212:215], a[188:191], v[248:251]
  buffer_load_dwordx4 v27, s[56:59], s41 offen offset:1024  lds
  v_mfma_f32_16x16x32_bf16 v[248:251], a[208:211], a[184:187], v[248:251]
  s_waitcnt lgkmcnt(13)
  v_accvgpr_read_b32 v50, a116
  v_accvgpr_read_b32 v51, a117
  v_mfma_f32_16x16x32_bf16 v[252:255], a[216:219], a[184:187], v[252:255]
  s_waitcnt lgkmcnt(10)
  ds_read_b64_tr_b16 a[208:209], v44 offset:0
  v_accvgpr_read_b32 v52, a118
  v_mfma_f32_16x16x32_bf16 v[252:255], a[220:223], a[188:191], v[252:255]
  ds_read_b64_tr_b16 a[210:211], v44 offset:1024
  v_accvgpr_read_b32 v53, a119
  v_mfma_f32_16x16x32_bf16 v[220:223], a[220:223], a[180:183], v[220:223]
  ds_read_b64_tr_b16 a[212:213], v44 offset:8192
  v_cvt_pk_bf16_f32 v76, v60, v61
  v_mfma_f32_16x16x32_bf16 v[220:223], a[216:219], a[176:179], v[220:223]
  buffer_load_dwordx4 v26, s[56:59], s42 offen offset:2048  lds
  v_mfma_f32_16x16x32_bf16 v[188:191], a[216:219], a[168:171], v[188:191]
  ds_read_b64_tr_b16 a[214:215], v44 offset:9216
  v_cvt_pk_bf16_f32 v77, v62, v63
  v_mfma_f32_16x16x32_bf16 v[188:191], a[220:223], a[172:175], v[188:191]
  v_cvt_pk_bf16_f32 v78, v50, v51
  v_cvt_pk_bf16_f32 v79, v52, v53
  v_mfma_f32_16x16x32_bf16 v[156:159], a[220:223], a[164:167], v[156:159]
  ds_read_b128 a[12:15], v19
  v_mfma_f32_16x16x32_bf16 v[156:159], a[216:219], a[160:163], v[156:159]
  s_waitcnt lgkmcnt(12)
  ds_read_b128 a[24:27], v19
  v_mfma_f32_16x16x32_bf16 v[128:131], a[192:195], a[224:227], v[128:131]
  s_waitcnt lgkmcnt(11)
  buffer_load_dwordx4 v27, s[56:59], s43 offen offset:3072  lds
  v_mfma_f32_16x16x32_bf16 v[128:131], a[196:199], a[228:231], v[128:131]
  ds_read_b64_tr_b16 a[216:217], v45 offset:0
  v_mfma_f32_16x16x32_bf16 v[160:163], a[196:199], a[236:239], v[160:163]
  s_add_u32 m0, s96, 0x1000
  ds_read_b64_tr_b16 a[218:219], v45 offset:1024
  v_accvgpr_read_b32 v54, a44
  v_mfma_f32_16x16x32_bf16 v[160:163], a[192:195], a[232:235], v[160:163]
  ds_read_b64_tr_b16 a[220:221], v45 offset:8192
  v_accvgpr_read_b32 v55, a45
  v_mfma_f32_16x16x32_bf16 v[192:195], a[192:195], a[240:243], v[192:195]
  ds_read_b64_tr_b16 a[222:223], v45 offset:9216
  v_accvgpr_read_b32 v56, a46
  v_mfma_f32_16x16x32_bf16 v[192:195], a[196:199], a[244:247], v[192:195]
  buffer_load_dwordx4 v26, s[56:59], s44 offen offset:0  lds
  v_mfma_f32_16x16x32_bf16 v[224:227], a[196:199], a[252:255], v[224:227]
  s_waitcnt vmcnt(11)
  ds_read_b128 a[160:163], v36 offset:0
  v_accvgpr_read_b32 v57, a47
  v_mfma_f32_16x16x32_bf16 v[224:227], a[192:195], a[248:251], v[224:227]
  s_waitcnt lgkmcnt(13)
  v_accvgpr_read_b32 v58, a60
  v_accvgpr_read_b32 v59, a61
  v_mfma_f32_16x16x32_bf16 v[228:231], a[200:203], a[248:251], v[228:231]
  s_waitcnt lgkmcnt(11)
  ds_read_b64_tr_b16 a[192:193], v46 offset:0
  v_accvgpr_read_b32 v60, a62
  v_mfma_f32_16x16x32_bf16 v[228:231], a[204:207], a[252:255], v[228:231]
  buffer_load_dwordx4 v27, s[56:59], s45 offen offset:1024  lds
  v_mfma_f32_16x16x32_bf16 v[196:199], a[204:207], a[244:247], v[196:199]
  ds_read_b64_tr_b16 a[194:195], v46 offset:1024
  v_accvgpr_read_b32 v61, a63
  v_mfma_f32_16x16x32_bf16 v[196:199], a[200:203], a[240:243], v[196:199]
  ds_read_b64_tr_b16 a[196:197], v46 offset:8192
  v_cvt_pk_bf16_f32 v92, v54, v55
  v_mfma_f32_16x16x32_bf16 v[164:167], a[200:203], a[232:235], v[164:167]
  ds_read_b64_tr_b16 a[198:199], v46 offset:9216
  v_cvt_pk_bf16_f32 v93, v56, v57
  v_mfma_f32_16x16x32_bf16 v[164:167], a[204:207], a[236:239], v[164:167]
  ds_read_b128 a[164:167], v37 offset:0
  v_cvt_pk_bf16_f32 v94, v58, v59
  v_mfma_f32_16x16x32_bf16 v[132:135], a[204:207], a[228:231], v[132:135]
  buffer_load_dwordx4 v26, s[56:59], s46 offen offset:2048  lds
  v_mfma_f32_16x16x32_bf16 v[132:135], a[200:203], a[224:227], v[132:135]
  ds_read_b128 a[168:171], v36 offset:2048
  v_cvt_pk_bf16_f32 v95, v60, v61
  s_waitcnt lgkmcnt(15)
  v_mfma_f32_16x16x32_bf16 v[136:139], a[208:211], a[224:227], v[136:139]
  s_waitcnt lgkmcnt(13)
  ds_read_b64_tr_b16 a[200:201], v47 offset:0
  v_mfma_f32_16x16x32_bf16 v[136:139], a[212:215], a[228:231], v[136:139]
  ds_read_b64_tr_b16 a[202:203], v47 offset:1024
  v_mfma_f32_16x16x32_bf16 v[168:171], a[212:215], a[236:239], v[168:171]
  ds_read_b64_tr_b16 a[204:205], v47 offset:8192
  v_mfma_f32_16x16x32_bf16 v[168:171], a[208:211], a[232:235], v[168:171]
  buffer_load_dwordx4 v27, s[56:59], s47 offen offset:3072  lds
  v_mfma_f32_16x16x32_bf16 v[200:203], a[208:211], a[240:243], v[200:203]
  s_mov_b32 s3, 0x1000
  ds_read_b64_tr_b16 a[206:207], v47 offset:9216
  v_mfma_f32_16x16x32_bf16 v[200:203], a[212:215], a[244:247], v[200:203]
  ds_read_b128 a[172:175], v37 offset:2048
  v_mfma_f32_16x16x32_bf16 v[232:235], a[212:215], a[252:255], v[232:235]
  ds_read_b128 a[176:179], v36 offset:4096
  v_mfma_f32_16x16x32_bf16 v[232:235], a[208:211], a[248:251], v[232:235]
  s_waitcnt lgkmcnt(15)
  buffer_store_dwordx4 v[88:91], v12, s[16:19], s3 offen offset:2048 sc1
  v_mfma_f32_16x16x32_bf16 v[236:239], a[216:219], a[248:251], v[236:239]
  s_waitcnt lgkmcnt(13)
  ds_read_b64_tr_b16 a[208:209], v48 offset:0
  v_xor_b32 v28, 0x180000, v28
  v_mfma_f32_16x16x32_bf16 v[236:239], a[220:223], a[252:255], v[236:239]
  ds_read_b64_tr_b16 a[210:211], v48 offset:1024
  v_xor_b32 v29, 0x180000, v29
  v_mfma_f32_16x16x32_bf16 v[204:207], a[220:223], a[244:247], v[204:207]
  s_add_u32 m0, s97, 0x18000
  ds_read_b64_tr_b16 a[212:213], v48 offset:8192
  v_mfma_f32_16x16x32_bf16 v[204:207], a[216:219], a[240:243], v[204:207]
  ds_read_b64_tr_b16 a[214:215], v48 offset:9216
  v_mfma_f32_16x16x32_bf16 v[172:175], a[216:219], a[232:235], v[172:175]
  ds_read_b128 a[180:183], v37 offset:4096
  v_mfma_f32_16x16x32_bf16 v[172:175], a[220:223], a[236:239], v[172:175]
  buffer_load_dwordx4 v28, s[60:63], s48 offen offset:0  lds
  v_mfma_f32_16x16x32_bf16 v[140:143], a[220:223], a[228:231], v[140:143]
  ds_read_b128 a[184:187], v36 offset:6144
  v_mfma_f32_16x16x32_bf16 v[140:143], a[216:219], a[224:227], v[140:143]
  ds_read_b128 a[188:191], v37 offset:6144
  s_waitcnt lgkmcnt(15)
  v_mfma_f32_16x16x32_bf16 v[144:147], a[192:195], a[224:227], v[144:147]
  ds_read_b64_tr_b16 a[216:217], v49 offset:0
  v_mfma_f32_16x16x32_bf16 v[144:147], a[196:199], a[228:231], v[144:147]
L_pad7:
  s_cbranch_execz L_hr0
  ds_read_b64_tr_b16 a[218:219], v49 offset:1024
  v_mfma_f32_16x16x32_bf16 v[176:179], a[196:199], a[236:239], v[176:179]
  buffer_load_dwordx4 v28, s[60:63], s49 offen offset:1024  lds
  v_mfma_f32_16x16x32_bf16 v[176:179], a[192:195], a[232:235], v[176:179]
  ds_read_b64_tr_b16 a[220:221], v49 offset:8192
  v_mfma_f32_16x16x32_bf16 v[208:211], a[192:195], a[240:243], v[208:211]
  ds_read_b64_tr_b16 a[222:223], v49 offset:9216
  v_mfma_f32_16x16x32_bf16 v[208:211], a[196:199], a[244:247], v[208:211]
  ds_read_b128 a[28:31], v19
  v_mfma_f32_16x16x32_bf16 v[240:243], a[196:199], a[252:255], v[240:243]
  ds_read_b128 a[40:43], v19
  v_mfma_f32_16x16x32_bf16 v[240:243], a[192:195], a[248:251], v[240:243]
  s_waitcnt vmcnt(12) lgkmcnt(15)
  buffer_load_dwordx4 v29, s[60:63], s50 offen offset:2048  lds
  v_mfma_f32_16x16x32_bf16 v[244:247], a[200:203], a[248:251], v[244:247]
  s_barrier
  v_mfma_f32_16x16x32_bf16 v[244:247], a[204:207], a[252:255], v[244:247]
  ds_read_b64_tr_b16 a[192:193], v42 offset:16384
  v_mfma_f32_16x16x32_bf16 v[212:215], a[204:207], a[244:247], v[212:215]
  ds_read_b64_tr_b16 a[194:195], v42 offset:17408
  v_mfma_f32_16x16x32_bf16 v[212:215], a[200:203], a[240:243], v[212:215]
  buffer_load_dwordx4 v29, s[60:63], s51 offen offset:3072  lds
  v_mfma_f32_16x16x32_bf16 v[180:183], a[200:203], a[232:235], v[180:183]
  ds_read_b64_tr_b16 a[196:197], v42 offset:24576
  v_mfma_f32_16x16x32_bf16 v[180:183], a[204:207], a[236:239], v[180:183]
  s_mov_b32 s3, 0x1000
  ds_read_b64_tr_b16 a[198:199], v42 offset:25600
  v_mfma_f32_16x16x32_bf16 v[148:151], a[204:207], a[228:231], v[148:151]
  ds_read_b128 a[44:47], v19
  v_mfma_f32_16x16x32_bf16 v[148:151], a[200:203], a[224:227], v[148:151]
  ds_read_b128 a[56:59], v19
  s_waitcnt lgkmcnt(15)
  v_mfma_f32_16x16x32_bf16 v[152:155], a[208:211], a[224:227], v[152:155]
  buffer_store_dwordx4 v[92:95], v12, s[16:19], s3 offen offset:3072 sc1
  v_mfma_f32_16x16x32_bf16 v[152:155], a[212:215], a[228:231], v[152:155]
  ds_read_b64_tr_b16 a[200:201], v43 offset:16384
  v_xor_b32 v26, 0x80, v26
  v_mfma_f32_16x16x32_bf16 v[184:187], a[212:215], a[236:239], v[184:187]
  ds_read_b64_tr_b16 a[202:203], v43 offset:17408
  v_xor_b32 v27, 0x80, v27
  v_mfma_f32_16x16x32_bf16 v[184:187], a[208:211], a[232:235], v[184:187]
  s_add_u32 m0, s96, 0x8000
  ds_read_b64_tr_b16 a[204:205], v43 offset:24576
  v_mfma_f32_16x16x32_bf16 v[216:219], a[208:211], a[240:243], v[216:219]
  ds_read_b64_tr_b16 a[206:207], v43 offset:25600
  v_mfma_f32_16x16x32_bf16 v[216:219], a[212:215], a[244:247], v[216:219]
  ds_read_b128 a[60:63], v19
  v_mfma_f32_16x16x32_bf16 v[248:251], a[212:215], a[252:255], v[248:251]
  buffer_load_dwordx4 v26, s[56:59], s40 offen offset:0  lds
  v_mfma_f32_16x16x32_bf16 v[248:251], a[208:211], a[248:251], v[248:251]
  ds_read_b128 a[64:67], v19
  s_waitcnt lgkmcnt(15)
  v_mfma_f32_16x16x32_bf16 v[252:255], a[216:219], a[248:251], v[252:255]
  ds_read_b64_tr_b16 a[208:209], v44 offset:16384
  s_waitcnt lgkmcnt(15)
  v_mfma_f32_16x16x32_bf16 v[252:255], a[220:223], a[252:255], v[252:255]
  ds_read_b64_tr_b16 a[210:211], v44 offset:17408
  v_mfma_f32_16x16x32_bf16 v[220:223], a[220:223], a[244:247], v[220:223]
  ds_read_b64_tr_b16 a[212:213], v44 offset:24576
  v_mfma_f32_16x16x32_bf16 v[220:223], a[216:219], a[240:243], v[220:223]
  buffer_load_dwordx4 v27, s[56:59], s41 offen offset:1024  lds
  v_mfma_f32_16x16x32_bf16 v[188:191], a[216:219], a[232:235], v[188:191]
  ds_read_b64_tr_b16 a[214:215], v44 offset:25600
  v_mfma_f32_16x16x32_bf16 v[188:191], a[220:223], a[236:239], v[188:191]
  ds_read_b128 a[68:71], v19
  v_mfma_f32_16x16x32_bf16 v[156:159], a[220:223], a[228:231], v[156:159]
  ds_read_b128 a[80:83], v19
  v_mfma_f32_16x16x32_bf16 v[156:159], a[216:219], a[224:227], v[156:159]
  ds_read_b128 a[84:87], v19
  s_waitcnt lgkmcnt(15)
  v_mfma_f32_16x16x32_bf16 v[128:131], a[192:195], a[160:163], v[128:131]
  buffer_load_dwordx4 v26, s[56:59], s42 offen offset:2048  lds
  v_mfma_f32_16x16x32_bf16 v[128:131], a[196:199], a[164:167], v[128:131]
  ds_read_b64_tr_b16 a[216:217], v45 offset:16384
  v_mfma_f32_16x16x32_bf16 v[160:163], a[196:199], a[172:175], v[160:163]
  ds_read_b64_tr_b16 a[218:219], v45 offset:17408
  v_mfma_f32_16x16x32_bf16 v[160:163], a[192:195], a[168:171], v[160:163]
  ds_read_b64_tr_b16 a[220:221], v45 offset:24576
  v_mfma_f32_16x16x32_bf16 v[192:195], a[192:195], a[176:179], v[192:195]
  buffer_load_dwordx4 v27, s[56:59], s43 offen offset:3072  lds
  v_mfma_f32_16x16x32_bf16 v[192:195], a[196:199], a[180:183], v[192:195]
  ds_read_b64_tr_b16 a[222:223], v45 offset:25600
  v_mfma_f32_16x16x32_bf16 v[224:227], a[196:199], a[188:191], v[224:227]
  s_waitcnt vmcnt(10)
  s_add_u32 m0, s96, 0x9000
  ds_read_b128 a[224:227], v34 offset:0
  v_mfma_f32_16x16x32_bf16 v[224:227], a[192:195], a[184:187], v[224:227]
  ds_read_b128 a[228:231], v35 offset:0
  s_waitcnt lgkmcnt(15)
  v_mfma_f32_16x16x32_bf16 v[228:231], a[200:203], a[184:187], v[228:231]
  ds_read_b64_tr_b16 a[192:193], v46 offset:16384
  v_mfma_f32_16x16x32_bf16 v[228:231], a[204:207], a[188:191], v[228:231]
  buffer_load_dwordx4 v26, s[56:59], s44 offen offset:0  lds
  v_mfma_f32_16x16x32_bf16 v[196:199], a[204:207], a[180:183], v[196:199]
  ds_read_b64_tr_b16 a[194:195], v46 offset:17408
  v_mfma_f32_16x16x32_bf16 v[196:199], a[200:203], a[176:179], v[196:199]
  ds_read_b64_tr_b16 a[196:197], v46 offset:24576
  v_mfma_f32_16x16x32_bf16 v[164:167], a[200:203], a[168:171], v[164:167]
  ds_read_b64_tr_b16 a[198:199], v46 offset:25600
  v_mfma_f32_16x16x32_bf16 v[164:167], a[204:207], a[172:175], v[164:167]
  ds_read_b128 a[232:235], v34 offset:2048
  v_mfma_f32_16x16x32_bf16 v[132:135], a[204:207], a[164:167], v[132:135]
  buffer_load_dwordx4 v27, s[56:59], s45 offen offset:1024  lds
  v_mfma_f32_16x16x32_bf16 v[132:135], a[200:203], a[160:163], v[132:135]
  ds_read_b128 a[236:239], v35 offset:2048
  s_waitcnt lgkmcnt(15)
  v_mfma_f32_16x16x32_bf16 v[136:139], a[208:211], a[160:163], v[136:139]
  ds_read_b64_tr_b16 a[200:201], v47 offset:16384
  v_mfma_f32_16x16x32_bf16 v[136:139], a[212:215], a[164:167], v[136:139]
  ds_read_b64_tr_b16 a[202:203], v47 offset:17408
  v_mfma_f32_16x16x32_bf16 v[168:171], a[212:215], a[172:175], v[168:171]
  buffer_load_dwordx4 v26, s[56:59], s46 offen offset:2048  lds
  v_mfma_f32_16x16x32_bf16 v[168:171], a[208:211], a[168:171], v[168:171]
  ds_read_b64_tr_b16 a[204:205], v47 offset:24576
  v_mfma_f32_16x16x32_bf16 v[200:203], a[208:211], a[176:179], v[200:203]
  ds_read_b64_tr_b16 a[206:207], v47 offset:25600
  v_mfma_f32_16x16x32_bf16 v[200:203], a[212:215], a[180:183], v[200:203]
  ds_read_b128 a[240:243], v34 offset:4096
  v_mfma_f32_16x16x32_bf16 v[232:235], a[212:215], a[188:191], v[232:235]
  ds_read_b128 a[244:247], v35 offset:4096
  v_mfma_f32_16x16x32_bf16 v[232:235], a[208:211], a[184:187], v[232:235]
  s_waitcnt lgkmcnt(15)
  buffer_load_dwordx4 v27, s[56:59], s47 offen offset:3072  lds
  v_mfma_f32_16x16x32_bf16 v[236:239], a[216:219], a[184:187], v[236:239]
  ds_read_b64_tr_b16 a[208:209], v48 offset:16384
  v_xor_b32 v28, 0x80000, v28
  s_waitcnt lgkmcnt(15)
  v_mfma_f32_16x16x32_bf16 v[236:239], a[220:223], a[188:191], v[236:239]
  ds_read_b64_tr_b16 a[210:211], v48 offset:17408
  v_xor_b32 v29, 0x80000, v29
  v_mfma_f32_16x16x32_bf16 v[204:207], a[220:223], a[180:183], v[204:207]
  s_add_u32 m0, s97, 0x1c000
  ds_read_b64_tr_b16 a[212:213], v48 offset:24576
  v_mfma_f32_16x16x32_bf16 v[204:207], a[216:219], a[176:179], v[204:207]
  ds_read_b64_tr_b16 a[214:215], v48 offset:25600
  v_mfma_f32_16x16x32_bf16 v[172:175], a[216:219], a[168:171], v[172:175]
  buffer_load_dwordx4 v28, s[60:63], s48 offen offset:0  lds
  v_mfma_f32_16x16x32_bf16 v[172:175], a[220:223], a[172:175], v[172:175]
  ds_read_b128 a[248:251], v34 offset:6144
  v_mfma_f32_16x16x32_bf16 v[140:143], a[220:223], a[164:167], v[140:143]
  ds_read_b128 a[252:255], v35 offset:6144
  v_mfma_f32_16x16x32_bf16 v[140:143], a[216:219], a[160:163], v[140:143]
  ds_read_b128 a[96:99], v19
  s_waitcnt lgkmcnt(15)
  v_mfma_f32_16x16x32_bf16 v[144:147], a[192:195], a[160:163], v[144:147]
  buffer_load_dwordx4 v28, s[60:63], s49 offen offset:1024  lds
  v_mfma_f32_16x16x32_bf16 v[144:147], a[196:199], a[164:167], v[144:147]
  ds_read_b64_tr_b16 a[216:217], v49 offset:16384
  v_accvgpr_read_b32 v62, a72
  v_mfma_f32_16x16x32_bf16 v[176:179], a[196:199], a[172:175], v[176:179]
  ds_read_b64_tr_b16 a[218:219], v49 offset:17408
  v_accvgpr_read_b32 v63, a73
  v_mfma_f32_16x16x32_bf16 v[176:179], a[192:195], a[168:171], v[176:179]
  ds_read_b64_tr_b16 a[220:221], v49 offset:24576
  v_accvgpr_read_b32 v50, a74
  v_mfma_f32_16x16x32_bf16 v[208:211], a[192:195], a[176:179], v[208:211]
  ds_read_b64_tr_b16 a[222:223], v49 offset:25600
  v_accvgpr_read_b32 v51, a75
  v_mfma_f32_16x16x32_bf16 v[208:211], a[196:199], a[180:183], v[208:211]
  buffer_load_dwordx4 v29, s[60:63], s50 offen offset:2048  lds
  v_mfma_f32_16x16x32_bf16 v[240:243], a[196:199], a[188:191], v[240:243]
  v_accvgpr_read_b32 v52, a88
  v_accvgpr_read_b32 v53, a89
  v_mfma_f32_16x16x32_bf16 v[240:243], a[192:195], a[184:187], v[240:243]
  s_waitcnt vmcnt(11) lgkmcnt(15)
  v_accvgpr_read_b32 v54, a90
  v_accvgpr_read_b32 v55, a91
  v_mfma_f32_16x16x32_bf16 v[244:247], a[200:203], a[184:187], v[244:247]
  s_barrier
  s_waitcnt lgkmcnt(13)
  v_mfma_f32_16x16x32_bf16 v[244:247], a[204:207], a[188:191], v[244:247]
  ds_read_b64_tr_b16 a[192:193], v42 offset:32768
  v_cvt_pk_bf16_f32 v80, v62, v63
  v_mfma_f32_16x16x32_bf16 v[212:215], a[204:207], a[180:183], v[212:215]
  buffer_load_dwordx4 v29, s[60:63], s51 offen offset:3072  lds
  v_mfma_f32_16x16x32_bf16 v[212:215], a[200:203], a[176:179], v[212:215]
  s_lshl_b32 s3, s29, 3
  ds_read_b64_tr_b16 a[194:195], v42 offset:33792
  v_cvt_pk_bf16_f32 v81, v50, v51
  v_mfma_f32_16x16x32_bf16 v[180:183], a[200:203], a[168:171], v[180:183]
  s_add_u32 s3, s3, s30
  ds_read_b64_tr_b16 a[196:197], v42 offset:40960
  v_cvt_pk_bf16_f32 v82, v52, v53
  v_mfma_f32_16x16x32_bf16 v[180:183], a[204:207], a[172:175], v[180:183]
  s_lshl_b32 s3, s3, 7
  ds_read_b64_tr_b16 a[198:199], v42 offset:41984
  v_cvt_pk_bf16_f32 v83, v54, v55
  v_mfma_f32_16x16x32_bf16 v[148:151], a[204:207], a[164:167], v[148:151]
  s_add_u32 s3, s3, 524288
  ds_read_b128 a[72:75], v19
  v_mfma_f32_16x16x32_bf16 v[148:151], a[200:203], a[160:163], v[148:151]
  s_waitcnt lgkmcnt(14)
  buffer_store_dword v9, v8, s[20:23], s3 offen sc1
  v_mfma_f32_16x16x32_bf16 v[152:155], a[208:211], a[160:163], v[152:155]
  s_waitcnt lgkmcnt(12)
  ds_read_b64_tr_b16 a[200:201], v43 offset:32768
  v_xor_b32 v26, 0x380, v26
  v_mfma_f32_16x16x32_bf16 v[152:155], a[212:215], a[164:167], v[152:155]
  ds_read_b64_tr_b16 a[202:203], v43 offset:33792
  v_xor_b32 v27, 0x380, v27
  v_mfma_f32_16x16x32_bf16 v[184:187], a[212:215], a[172:175], v[184:187]
  s_add_u32 m0, s96, 0x20000
  ds_read_b64_tr_b16 a[204:205], v43 offset:40960
  v_mfma_f32_16x16x32_bf16 v[184:187], a[208:211], a[168:171], v[184:187]
  buffer_load_dwordx4 v26, s[56:59], s40 offen offset:0  lds
  v_mfma_f32_16x16x32_bf16 v[216:219], a[208:211], a[176:179], v[216:219]
  ds_read_b64_tr_b16 a[206:207], v43 offset:41984
  v_mfma_f32_16x16x32_bf16 v[216:219], a[212:215], a[180:183], v[216:219]
  ds_read_b128 a[88:91], v19
  v_mfma_f32_16x16x32_bf16 v[248:251], a[212:215], a[188:191], v[248:251]
  buffer_load_dwordx4 v27, s[56:59], s41 offen offset:1024  lds
  v_mfma_f32_16x16x32_bf16 v[248:251], a[208:211], a[184:187], v[248:251]
  s_waitcnt lgkmcnt(12)
  ds_read_b128 a[100:103], v19
  v_mfma_f32_16x16x32_bf16 v[252:255], a[216:219], a[184:187], v[252:255]
  s_waitcnt lgkmcnt(11)
  ds_read_b64_tr_b16 a[208:209], v44 offset:32768
  v_mfma_f32_16x16x32_bf16 v[252:255], a[220:223], a[188:191], v[252:255]
  buffer_load_dwordx4 v26, s[56:59], s42 offen offset:2048  lds
  v_mfma_f32_16x16x32_bf16 v[220:223], a[220:223], a[180:183], v[220:223]
  ds_read_b64_tr_b16 a[210:211], v44 offset:33792
  v_mfma_f32_16x16x32_bf16 v[220:223], a[216:219], a[176:179], v[220:223]
  ds_read_b64_tr_b16 a[212:213], v44 offset:40960
  v_mfma_f32_16x16x32_bf16 v[188:191], a[216:219], a[168:171], v[188:191]
  ds_read_b64_tr_b16 a[214:215], v44 offset:41984
  v_mfma_f32_16x16x32_bf16 v[188:191], a[220:223], a[172:175], v[188:191]
  ds_read_b128 a[112:115], v19
  v_mfma_f32_16x16x32_bf16 v[156:159], a[220:223], a[164:167], v[156:159]
  buffer_load_dwordx4 v27, s[56:59], s43 offen offset:3072  lds
  v_mfma_f32_16x16x32_bf16 v[156:159], a[216:219], a[160:163], v[156:159]
  s_waitcnt lgkmcnt(14)
  s_add_u32 m0, s96, 0x21000
  v_accvgpr_read_b32 v56, a104
  v_accvgpr_read_b32 v57, a105
  v_mfma_f32_16x16x32_bf16 v[128:131], a[192:195], a[224:227], v[128:131]
  s_waitcnt lgkmcnt(12)
  ds_read_b64_tr_b16 a[216:217], v45 offset:32768
  v_accvgpr_read_b32 v58, a106
  v_mfma_f32_16x16x32_bf16 v[128:131], a[196:199], a[228:231], v[128:131]
  ds_read_b64_tr_b16 a[218:219], v45 offset:33792
  v_accvgpr_read_b32 v59, a107
  v_mfma_f32_16x16x32_bf16 v[160:163], a[196:199], a[236:239], v[160:163]
  buffer_load_dwordx4 v26, s[56:59], s44 offen offset:0  lds
  v_mfma_f32_16x16x32_bf16 v[160:163], a[192:195], a[232:235], v[160:163]
  ds_read_b64_tr_b16 a[220:221], v45 offset:40960
  v_accvgpr_read_b32 v60, a120
  v_mfma_f32_16x16x32_bf16 v[192:195], a[192:195], a[240:243], v[192:195]
  ds_read_b64_tr_b16 a[222:223], v45 offset:41984
  v_accvgpr_read_b32 v61, a121
  v_mfma_f32_16x16x32_bf16 v[192:195], a[196:199], a[244:247], v[192:195]
  v_accvgpr_read_b32 v62, a122
  v_accvgpr_read_b32 v63, a123
  v_mfma_f32_16x16x32_bf16 v[224:227], a[196:199], a[252:255], v[224:227]
  s_waitcnt vmcnt(10)
  ds_read_b128 a[160:163], v34 offset:32768
  v_cvt_pk_bf16_f32 v84, v56, v57
  v_mfma_f32_16x16x32_bf16 v[224:227], a[192:195], a[248:251], v[224:227]
  s_waitcnt lgkmcnt(14)
  buffer_load_dwordx4 v27, s[56:59], s45 offen offset:1024  lds
  v_mfma_f32_16x16x32_bf16 v[228:231], a[200:203], a[248:251], v[228:231]
  s_waitcnt lgkmcnt(12)
  ds_read_b64_tr_b16 a[192:193], v46 offset:32768
  v_cvt_pk_bf16_f32 v85, v58, v59
  v_mfma_f32_16x16x32_bf16 v[228:231], a[204:207], a[252:255], v[228:231]
  ds_read_b64_tr_b16 a[194:195], v46 offset:33792
  v_cvt_pk_bf16_f32 v86, v60, v61
  v_mfma_f32_16x16x32_bf16 v[196:199], a[204:207], a[244:247], v[196:199]
  ds_read_b64_tr_b16 a[196:197], v46 offset:40960
  v_cvt_pk_bf16_f32 v87, v62, v63
  v_mfma_f32_16x16x32_bf16 v[196:199], a[200:203], a[240:243], v[196:199]
  ds_read_b64_tr_b16 a[198:199], v46 offset:41984
  v_mfma_f32_16x16x32_bf16 v[164:167], a[200:203], a[232:235], v[164:167]
  buffer_load_dwordx4 v26, s[56:59], s46 offen offset:2048  lds
  v_mfma_f32_16x16x32_bf16 v[164:167], a[204:207], a[236:239], v[164:167]
  ds_read_b128 a[164:167], v35 offset:32768
  v_mfma_f32_16x16x32_bf16 v[132:135], a[204:207], a[228:231], v[132:135]
  ds_read_b128 a[168:171], v34 offset:34816
  v_mfma_f32_16x16x32_bf16 v[132:135], a[200:203], a[224:227], v[132:135]
  ds_read_b128 a[172:175], v35 offset:34816
  s_waitcnt lgkmcnt(15)
  v_mfma_f32_16x16x32_bf16 v[136:139], a[208:211], a[224:227], v[136:139]
  s_waitcnt lgkmcnt(13)
  buffer_load_dwordx4 v27, s[56:59], s47 offen offset:3072  lds
  v_mfma_f32_16x16x32_bf16 v[136:139], a[212:215], a[228:231], v[136:139]
  ds_read_b64_tr_b16 a[200:201], v47 offset:32768
  v_xor_b32 v28, 0x380000, v28
  v_mfma_f32_16x16x32_bf16 v[168:171], a[212:215], a[236:239], v[168:171]
  ds_read_b64_tr_b16 a[202:203], v47 offset:33792
  v_xor_b32 v29, 0x380000, v29
  v_mfma_f32_16x16x32_bf16 v[168:171], a[208:211], a[232:235], v[168:171]
  s_add_u32 m0, s97, 0x10000
  ds_read_b64_tr_b16 a[204:205], v47 offset:40960
  v_mfma_f32_16x16x32_bf16 v[200:203], a[208:211], a[240:243], v[200:203]
  ds_read_b64_tr_b16 a[206:207], v47 offset:41984
  v_mfma_f32_16x16x32_bf16 v[200:203], a[212:215], a[244:247], v[200:203]
  buffer_load_dwordx4 v28, s[60:63], s48 offen offset:0  lds
  v_mfma_f32_16x16x32_bf16 v[232:235], a[212:215], a[252:255], v[232:235]
  ds_read_b128 a[176:179], v34 offset:36864
  v_mfma_f32_16x16x32_bf16 v[232:235], a[208:211], a[248:251], v[232:235]
  ds_read_b128 a[180:183], v35 offset:36864
  s_waitcnt lgkmcnt(15)
  v_mfma_f32_16x16x32_bf16 v[236:239], a[216:219], a[248:251], v[236:239]
  ds_read_b64_tr_b16 a[208:209], v48 offset:32768
  s_waitcnt lgkmcnt(15)
  v_mfma_f32_16x16x32_bf16 v[236:239], a[220:223], a[252:255], v[236:239]
  ds_read_b64_tr_b16 a[210:211], v48 offset:33792
  v_mfma_f32_16x16x32_bf16 v[204:207], a[220:223], a[244:247], v[204:207]
  buffer_load_dwordx4 v28, s[60:63], s49 offen offset:1024  lds
  v_mfma_f32_16x16x32_bf16 v[204:207], a[216:219], a[240:243], v[204:207]
  ds_read_b64_tr_b16 a[212:213], v48 offset:40960
  v_mfma_f32_16x16x32_bf16 v[172:175], a[216:219], a[232:235], v[172:175]
  ds_read_b64_tr_b16 a[214:215], v48 offset:41984
  v_accvgpr_read_b32 v50, a76
  v_mfma_f32_16x16x32_bf16 v[172:175], a[220:223], a[236:239], v[172:175]
  ds_read_b128 a[184:187], v34 offset:38912
  v_accvgpr_read_b32 v51, a77
  v_mfma_f32_16x16x32_bf16 v[140:143], a[220:223], a[228:231], v[140:143]
  ds_read_b128 a[188:191], v35 offset:38912
  v_accvgpr_read_b32 v52, a78
  v_mfma_f32_16x16x32_bf16 v[140:143], a[216:219], a[224:227], v[140:143]
  s_waitcnt lgkmcnt(15)
  buffer_load_dwordx4 v29, s[60:63], s50 offen offset:2048  lds
  v_mfma_f32_16x16x32_bf16 v[144:147], a[192:195], a[224:227], v[144:147]
  ds_read_b64_tr_b16 a[216:217], v49 offset:32768
  v_accvgpr_read_b32 v53, a79
  v_mfma_f32_16x16x32_bf16 v[144:147], a[196:199], a[228:231], v[144:147]
  ds_read_b64_tr_b16 a[218:219], v49 offset:33792
  v_accvgpr_read_b32 v54, a92
  v_mfma_f32_16x16x32_bf16 v[176:179], a[196:199], a[236:239], v[176:179]
  ds_read_b64_tr_b16 a[220:221], v49 offset:40960
  v_accvgpr_read_b32 v55, a93
  v_mfma_f32_16x16x32_bf16 v[176:179], a[192:195], a[232:235], v[176:179]
  buffer_load_dwordx4 v29, s[60:63], s51 offen offset:3072  lds
  v_mfma_f32_16x16x32_bf16 v[208:211], a[192:195], a[240:243], v[208:211]
  ds_read_b64_tr_b16 a[222:223], v49 offset:41984
  v_xor_b32 v26, 0x80, v26
  v_mfma_f32_16x16x32_bf16 v[208:211], a[196:199], a[244:247], v[208:211]
  v_xor_b32 v27, 0x80, v27
  v_accvgpr_read_b32 v56, a94
  v_mfma_f32_16x16x32_bf16 v[240:243], a[196:199], a[252:255], v[240:243]
  s_add_u32 m0, s96, 0x0
  v_accvgpr_read_b32 v57, a95
  v_cvt_pk_bf16_f32 v88, v50, v51
  v_mfma_f32_16x16x32_bf16 v[240:243], a[192:195], a[248:251], v[240:243]
  s_waitcnt vmcnt(13) lgkmcnt(14)
  v_cvt_pk_bf16_f32 v89, v52, v53
  v_cvt_pk_bf16_f32 v90, v54, v55
  v_mfma_f32_16x16x32_bf16 v[244:247], a[200:203], a[248:251], v[244:247]
  s_barrier
  s_waitcnt lgkmcnt(12)
  v_mfma_f32_16x16x32_bf16 v[244:247], a[204:207], a[252:255], v[244:247]
  buffer_load_dwordx4 v26, s[56:59], s40 offen offset:0  lds
  v_mfma_f32_16x16x32_bf16 v[212:215], a[204:207], a[244:247], v[212:215]
  ds_read_b64_tr_b16 a[192:193], v42 offset:49152
  v_cvt_pk_bf16_f32 v91, v56, v57
  v_mfma_f32_16x16x32_bf16 v[212:215], a[200:203], a[240:243], v[212:215]
  ds_read_b64_tr_b16 a[194:195], v42 offset:50176
  v_mfma_f32_16x16x32_bf16 v[180:183], a[200:203], a[232:235], v[180:183]
  ds_read_b64_tr_b16 a[196:197], v42 offset:57344
  v_mfma_f32_16x16x32_bf16 v[180:183], a[204:207], a[236:239], v[180:183]
  buffer_load_dwordx4 v27, s[56:59], s41 offen offset:1024  lds
  v_mfma_f32_16x16x32_bf16 v[148:151], a[204:207], a[228:231], v[148:151]
  ds_read_b64_tr_b16 a[198:199], v42 offset:58368
  v_mfma_f32_16x16x32_bf16 v[148:151], a[200:203], a[224:227], v[148:151]
  s_waitcnt lgkmcnt(12)
  ds_read_b128 a[76:79], v19
  v_mfma_f32_16x16x32_bf16 v[152:155], a[208:211], a[224:227], v[152:155]
  s_waitcnt lgkmcnt(11)
  ds_read_b64_tr_b16 a[200:201], v43 offset:49152
  v_mfma_f32_16x16x32_bf16 v[152:155], a[212:215], a[228:231], v[152:155]
  buffer_load_dwordx4 v26, s[56:59], s42 offen offset:2048  lds
  v_mfma_f32_16x16x32_bf16 v[184:187], a[212:215], a[236:239], v[184:187]
  ds_read_b64_tr_b16 a[202:203], v43 offset:50176
  v_mfma_f32_16x16x32_bf16 v[184:187], a[208:211], a[232:235], v[184:187]
  ds_read_b64_tr_b16 a[204:205], v43 offset:57344
  v_mfma_f32_16x16x32_bf16 v[216:219], a[208:211], a[240:243], v[216:219]
  ds_read_b64_tr_b16 a[206:207], v43 offset:58368
  v_mfma_f32_16x16x32_bf16 v[216:219], a[212:215], a[244:247], v[216:219]
  ds_read_b128 a[92:95], v19
  v_mfma_f32_16x16x32_bf16 v[248:251], a[212:215], a[252:255], v[248:251]
  buffer_load_dwordx4 v27, s[56:59], s43 offen offset:3072  lds
  v_mfma_f32_16x16x32_bf16 v[248:251], a[208:211], a[248:251], v[248:251]
  s_waitcnt lgkmcnt(12)
  ds_read_b128 a[104:107], v19
  v_mfma_f32_16x16x32_bf16 v[252:255], a[216:219], a[248:251], v[252:255]
  s_waitcnt lgkmcnt(11)
  s_add_u32 m0, s96, 0x1000
  ds_read_b64_tr_b16 a[208:209], v44 offset:49152
  v_mfma_f32_16x16x32_bf16 v[252:255], a[220:223], a[252:255], v[252:255]
  ds_read_b64_tr_b16 a[210:211], v44 offset:50176
  v_mfma_f32_16x16x32_bf16 v[220:223], a[220:223], a[244:247], v[220:223]
  ds_read_b64_tr_b16 a[212:213], v44 offset:57344
  v_accvgpr_read_b32 v58, a108
  v_mfma_f32_16x16x32_bf16 v[220:223], a[216:219], a[240:243], v[220:223]
  buffer_load_dwordx4 v26, s[56:59], s44 offen offset:0  lds
  v_mfma_f32_16x16x32_bf16 v[188:191], a[216:219], a[232:235], v[188:191]
  ds_read_b64_tr_b16 a[214:215], v44 offset:58368
  v_accvgpr_read_b32 v59, a109
  v_mfma_f32_16x16x32_bf16 v[188:191], a[220:223], a[236:239], v[188:191]
  v_accvgpr_read_b32 v60, a110
  v_accvgpr_read_b32 v61, a111
  v_mfma_f32_16x16x32_bf16 v[156:159], a[220:223], a[228:231], v[156:159]
  v_accvgpr_read_b32 v62, a124
  v_accvgpr_read_b32 v63, a125
  v_mfma_f32_16x16x32_bf16 v[156:159], a[216:219], a[224:227], v[156:159]
  s_waitcnt lgkmcnt(13)
  buffer_load_dwordx4 v27, s[56:59], s45 offen offset:1024  lds
  v_mfma_f32_16x16x32_bf16 v[128:131], a[192:195], a[160:163], v[128:131]
  s_waitcnt lgkmcnt(11)
  s_lshl_b32 s12, s29, 18
  ds_read_b64_tr_b16 a[216:217], v45 offset:49152
  v_accvgpr_read_b32 v50, a126
  v_mfma_f32_16x16x32_bf16 v[128:131], a[196:199], a[164:167], v[128:131]
  ds_read_b64_tr_b16 a[218:219], v45 offset:50176
  v_accvgpr_read_b32 v51, a127
  v_mfma_f32_16x16x32_bf16 v[160:163], a[196:199], a[172:175], v[160:163]
  ds_read_b64_tr_b16 a[220:221], v45 offset:57344
  v_cvt_pk_bf16_f32 v92, v58, v59
  v_mfma_f32_16x16x32_bf16 v[160:163], a[192:195], a[168:171], v[160:163]
  ds_read_b64_tr_b16 a[222:223], v45 offset:58368
  v_cvt_pk_bf16_f32 v93, v60, v61
  v_mfma_f32_16x16x32_bf16 v[192:195], a[192:195], a[176:179], v[192:195]
  buffer_load_dwordx4 v26, s[56:59], s46 offen offset:2048  lds
  v_mfma_f32_16x16x32_bf16 v[192:195], a[196:199], a[180:183], v[192:195]
  v_cvt_pk_bf16_f32 v94, v62, v63
  v_cvt_pk_bf16_f32 v95, v50, v51
  v_mfma_f32_16x16x32_bf16 v[224:227], a[196:199], a[188:191], v[224:227]
  s_waitcnt vmcnt(11)
  s_add_u32 s8, s74, s12
  s_addc_u32 s9, s75, 0
  ds_read_b128 a[224:227], v36 offset:0
  v_mfma_f32_16x16x32_bf16 v[224:227], a[192:195], a[184:187], v[224:227]
  s_waitcnt lgkmcnt(13)
  s_mov_b32 s10, 0x40000
  ds_read_b128 a[228:231], v37 offset:0
  v_mfma_f32_16x16x32_bf16 v[228:231], a[200:203], a[184:187], v[228:231]
  s_waitcnt lgkmcnt(12)
  s_mov_b32 s11, 0x20000
  ds_read_b64_tr_b16 a[192:193], v46 offset:49152
  v_mfma_f32_16x16x32_bf16 v[228:231], a[204:207], a[188:191], v[228:231]
  s_sub_u32 s12, s30, 1
  buffer_load_dwordx4 v27, s[56:59], s47 offen offset:3072  lds
  v_mfma_f32_16x16x32_bf16 v[196:199], a[204:207], a[180:183], v[196:199]
  s_lshl_b32 s12, s12, 14
  ds_read_b64_tr_b16 a[194:195], v46 offset:50176
  v_xor_b32 v28, 0x80000, v28
  v_mfma_f32_16x16x32_bf16 v[196:199], a[200:203], a[176:179], v[196:199]
  s_mov_b32 s13, 0x18000
  ds_read_b64_tr_b16 a[196:197], v46 offset:57344
  v_xor_b32 v29, 0x80000, v29
  v_mfma_f32_16x16x32_bf16 v[164:167], a[200:203], a[168:171], v[164:167]
  s_add_u32 m0, s97, 0x14000
  ds_read_b64_tr_b16 a[198:199], v46 offset:58368
  v_mfma_f32_16x16x32_bf16 v[164:167], a[204:207], a[172:175], v[164:167]
  ds_read_b128 a[232:235], v36 offset:2048
  v_mfma_f32_16x16x32_bf16 v[132:135], a[204:207], a[164:167], v[132:135]
  buffer_load_dwordx4 v28, s[60:63], s48 offen offset:0  lds
  v_mfma_f32_16x16x32_bf16 v[132:135], a[200:203], a[160:163], v[132:135]
  s_waitcnt lgkmcnt(13)
  ds_read_b128 a[236:239], v37 offset:2048
  v_mfma_f32_16x16x32_bf16 v[136:139], a[208:211], a[160:163], v[136:139]
  s_waitcnt lgkmcnt(12)
  ds_read_b64_tr_b16 a[200:201], v47 offset:49152
  v_mfma_f32_16x16x32_bf16 v[136:139], a[212:215], a[164:167], v[136:139]
  ds_read_b64_tr_b16 a[202:203], v47 offset:50176
  v_mfma_f32_16x16x32_bf16 v[168:171], a[212:215], a[172:175], v[168:171]
  buffer_load_dwordx4 v28, s[60:63], s49 offen offset:1024  lds
  v_mfma_f32_16x16x32_bf16 v[168:171], a[208:211], a[168:171], v[168:171]
  ds_read_b64_tr_b16 a[204:205], v47 offset:57344
  v_mfma_f32_16x16x32_bf16 v[200:203], a[208:211], a[176:179], v[200:203]
  ds_read_b64_tr_b16 a[206:207], v47 offset:58368
  v_mfma_f32_16x16x32_bf16 v[200:203], a[212:215], a[180:183], v[200:203]
  ds_read_b128 a[240:243], v36 offset:4096
  v_mfma_f32_16x16x32_bf16 v[232:235], a[212:215], a[188:191], v[232:235]
  ds_read_b128 a[244:247], v37 offset:4096
  v_mfma_f32_16x16x32_bf16 v[232:235], a[208:211], a[184:187], v[232:235]
  s_waitcnt lgkmcnt(15)
  buffer_load_dwordx4 v29, s[60:63], s50 offen offset:2048  lds
  v_mfma_f32_16x16x32_bf16 v[236:239], a[216:219], a[184:187], v[236:239]
  ds_read_b64_tr_b16 a[208:209], v48 offset:49152
  s_waitcnt lgkmcnt(15)
  v_mfma_f32_16x16x32_bf16 v[236:239], a[220:223], a[188:191], v[236:239]
  ds_read_b64_tr_b16 a[210:211], v48 offset:50176
  v_mfma_f32_16x16x32_bf16 v[204:207], a[220:223], a[180:183], v[204:207]
  ds_read_b64_tr_b16 a[212:213], v48 offset:57344
  v_mfma_f32_16x16x32_bf16 v[204:207], a[216:219], a[176:179], v[204:207]
  ds_read_b64_tr_b16 a[214:215], v48 offset:58368
  v_mfma_f32_16x16x32_bf16 v[172:175], a[216:219], a[168:171], v[172:175]
  buffer_load_dwordx4 v29, s[60:63], s51 offen offset:3072  lds
  v_mfma_f32_16x16x32_bf16 v[172:175], a[220:223], a[172:175], v[172:175]
  ds_read_b128 a[248:251], v36 offset:6144
  v_xor_b32 v26, 0x180, v26
  v_mfma_f32_16x16x32_bf16 v[140:143], a[220:223], a[164:167], v[140:143]
  ds_read_b128 a[252:255], v37 offset:6144
  v_xor_b32 v27, 0x180, v27
  v_mfma_f32_16x16x32_bf16 v[140:143], a[216:219], a[160:163], v[140:143]
  s_add_u32 m0, s96, 0x8000
  ds_read_b128 a[108:111], v19
  s_waitcnt lgkmcnt(15)
  v_mfma_f32_16x16x32_bf16 v[144:147], a[192:195], a[160:163], v[144:147]
  buffer_load_dwordx4 v26, s[56:59], s40 offen offset:0  lds
  v_mfma_f32_16x16x32_bf16 v[144:147], a[196:199], a[164:167], v[144:147]
  ds_read_b64_tr_b16 a[216:217], v49 offset:49152
  v_mfma_f32_16x16x32_bf16 v[176:179], a[196:199], a[172:175], v[176:179]
  ds_read_b64_tr_b16 a[218:219], v49 offset:50176
  v_mfma_f32_16x16x32_bf16 v[176:179], a[192:195], a[168:171], v[176:179]
  ds_read_b64_tr_b16 a[220:221], v49 offset:57344
  v_mfma_f32_16x16x32_bf16 v[208:211], a[192:195], a[176:179], v[208:211]
  ds_read_b64_tr_b16 a[222:223], v49 offset:58368
  v_mfma_f32_16x16x32_bf16 v[208:211], a[196:199], a[180:183], v[208:211]
  buffer_load_dwordx4 v27, s[56:59], s41 offen offset:1024  lds
  v_mfma_f32_16x16x32_bf16 v[240:243], a[196:199], a[188:191], v[240:243]
  ds_read_b128 a[116:119], v19
  v_mfma_f32_16x16x32_bf16 v[240:243], a[192:195], a[184:187], v[240:243]
  s_waitcnt vmcnt(14)
  ds_read_b128 a[120:123], v19
  s_waitcnt lgkmcnt(15)
  v_mfma_f32_16x16x32_bf16 v[244:247], a[200:203], a[184:187], v[244:247]
  s_barrier
  v_mfma_f32_16x16x32_bf16 v[244:247], a[204:207], a[188:191], v[244:247]
  ds_read_b64_tr_b16 a[192:193], v42 offset:0
  v_mfma_f32_16x16x32_bf16 v[212:215], a[204:207], a[180:183], v[212:215]
  buffer_load_dwordx4 v26, s[56:59], s42 offen offset:2048  lds
  v_mfma_f32_16x16x32_bf16 v[212:215], a[200:203], a[176:179], v[212:215]
  ds_read_b64_tr_b16 a[194:195], v42 offset:1024
  v_mfma_f32_16x16x32_bf16 v[180:183], a[200:203], a[168:171], v[180:183]
  ds_read_b64_tr_b16 a[196:197], v42 offset:8192
  v_mfma_f32_16x16x32_bf16 v[180:183], a[204:207], a[172:175], v[180:183]
  ds_read_b64_tr_b16 a[198:199], v42 offset:9216
  v_mfma_f32_16x16x32_bf16 v[148:151], a[204:207], a[164:167], v[148:151]
  buffer_load_dwordx4 v27, s[56:59], s43 offen offset:3072  lds
  v_mfma_f32_16x16x32_bf16 v[148:151], a[200:203], a[160:163], v[148:151]
  ds_read_b128 a[124:127], v19
  s_waitcnt lgkmcnt(15)
  v_mfma_f32_16x16x32_bf16 v[152:155], a[208:211], a[160:163], v[152:155]
  s_add_u32 m0, s96, 0x9000
  ds_read_b64_tr_b16 a[200:201], v43 offset:0
  s_waitcnt lgkmcnt(15)
  v_mfma_f32_16x16x32_bf16 v[152:155], a[212:215], a[164:167], v[152:155]
  ds_read_b64_tr_b16 a[202:203], v43 offset:1024
  v_mfma_f32_16x16x32_bf16 v[184:187], a[212:215], a[172:175], v[184:187]
L_pad8:
  s_cbranch_execz L_hr0
  ds_read_b64_tr_b16 a[204:205], v43 offset:8192
  v_mfma_f32_16x16x32_bf16 v[184:187], a[208:211], a[168:171], v[184:187]
  buffer_load_dwordx4 v26, s[56:59], s44 offen offset:0  lds
  v_mfma_f32_16x16x32_bf16 v[216:219], a[208:211], a[176:179], v[216:219]
  ds_read_b64_tr_b16 a[206:207], v43 offset:9216
  v_mfma_f32_16x16x32_bf16 v[216:219], a[212:215], a[180:183], v[216:219]
  v_mfma_f32_16x16x32_bf16 v[248:251], a[212:215], a[188:191], v[248:251]
  v_mfma_f32_16x16x32_bf16 v[248:251], a[208:211], a[184:187], v[248:251]
  s_waitcnt lgkmcnt(13)
  v_mfma_f32_16x16x32_bf16 v[252:255], a[216:219], a[184:187], v[252:255]
  s_waitcnt lgkmcnt(11)
  buffer_load_dwordx4 v27, s[56:59], s45 offen offset:1024  lds
  v_mfma_f32_16x16x32_bf16 v[252:255], a[220:223], a[188:191], v[252:255]
  ds_read_b64_tr_b16 a[208:209], v44 offset:0
  v_mfma_f32_16x16x32_bf16 v[220:223], a[220:223], a[180:183], v[220:223]
  ds_read_b64_tr_b16 a[210:211], v44 offset:1024
  v_mfma_f32_16x16x32_bf16 v[220:223], a[216:219], a[176:179], v[220:223]
  ds_read_b64_tr_b16 a[212:213], v44 offset:8192
  v_mfma_f32_16x16x32_bf16 v[188:191], a[216:219], a[168:171], v[188:191]
  ds_read_b64_tr_b16 a[214:215], v44 offset:9216
  v_mfma_f32_16x16x32_bf16 v[188:191], a[220:223], a[172:175], v[188:191]
  buffer_load_dwordx4 v26, s[56:59], s46 offen offset:2048  lds
  v_mfma_f32_16x16x32_bf16 v[156:159], a[220:223], a[164:167], v[156:159]
  v_mfma_f32_16x16x32_bf16 v[156:159], a[216:219], a[160:163], v[156:159]
  s_waitcnt lgkmcnt(11)
  v_mfma_f32_16x16x32_bf16 v[128:131], a[192:195], a[224:227], v[128:131]
  s_waitcnt lgkmcnt(9)
  ds_read_b64_tr_b16 a[216:217], v45 offset:0
  v_mfma_f32_16x16x32_bf16 v[128:131], a[196:199], a[228:231], v[128:131]
  buffer_load_dwordx4 v27, s[56:59], s47 offen offset:3072  lds
  v_mfma_f32_16x16x32_bf16 v[160:163], a[196:199], a[236:239], v[160:163]
  ds_read_b64_tr_b16 a[218:219], v45 offset:1024
  v_xor_b32 v28, 0x180000, v28
  v_mfma_f32_16x16x32_bf16 v[160:163], a[192:195], a[232:235], v[160:163]
  ds_read_b64_tr_b16 a[220:221], v45 offset:8192
  v_xor_b32 v29, 0x180000, v29
  v_mfma_f32_16x16x32_bf16 v[192:195], a[192:195], a[240:243], v[192:195]
  s_add_u32 m0, s97, 0x18000
  ds_read_b64_tr_b16 a[222:223], v45 offset:9216
  v_mfma_f32_16x16x32_bf16 v[192:195], a[196:199], a[244:247], v[192:195]
  s_waitcnt vmcnt(12)
  ds_read_b128 a[160:163], v34 offset:0
  v_mfma_f32_16x16x32_bf16 v[224:227], a[196:199], a[252:255], v[224:227]
  buffer_load_dwordx4 v28, s[60:63], s48 offen offset:0  lds
  v_mfma_f32_16x16x32_bf16 v[224:227], a[192:195], a[248:251], v[224:227]
  s_waitcnt lgkmcnt(11)
  ds_read_b128 a[164:167], v35 offset:0
  v_mfma_f32_16x16x32_bf16 v[228:231], a[200:203], a[248:251], v[228:231]
  s_waitcnt lgkmcnt(10)
  ds_read_b64_tr_b16 a[192:193], v46 offset:0
  v_mfma_f32_16x16x32_bf16 v[228:231], a[204:207], a[252:255], v[228:231]
  ds_read_b64_tr_b16 a[194:195], v46 offset:1024
  v_mfma_f32_16x16x32_bf16 v[196:199], a[204:207], a[244:247], v[196:199]
  ds_read_b64_tr_b16 a[196:197], v46 offset:8192
  v_mfma_f32_16x16x32_bf16 v[196:199], a[200:203], a[240:243], v[196:199]
  buffer_load_dwordx4 v28, s[60:63], s49 offen offset:1024  lds
  v_mfma_f32_16x16x32_bf16 v[164:167], a[200:203], a[232:235], v[164:167]
  ds_read_b64_tr_b16 a[198:199], v46 offset:9216
  v_mfma_f32_16x16x32_bf16 v[164:167], a[204:207], a[236:239], v[164:167]
  ds_read_b128 a[168:171], v34 offset:2048
  v_mfma_f32_16x16x32_bf16 v[132:135], a[204:207], a[228:231], v[132:135]
  ds_read_b128 a[172:175], v35 offset:2048
  v_mfma_f32_16x16x32_bf16 v[132:135], a[200:203], a[224:227], v[132:135]
  s_waitcnt lgkmcnt(14)
  buffer_load_dwordx4 v29, s[60:63], s50 offen offset:2048  lds
  v_mfma_f32_16x16x32_bf16 v[136:139], a[208:211], a[224:227], v[136:139]
  s_waitcnt lgkmcnt(12)
  ds_read_b64_tr_b16 a[200:201], v47 offset:0
  v_mfma_f32_16x16x32_bf16 v[136:139], a[212:215], a[228:231], v[136:139]
  ds_read_b64_tr_b16 a[202:203], v47 offset:1024
  v_mfma_f32_16x16x32_bf16 v[168:171], a[212:215], a[236:239], v[168:171]
  ds_read_b64_tr_b16 a[204:205], v47 offset:8192
  v_mfma_f32_16x16x32_bf16 v[168:171], a[208:211], a[232:235], v[168:171]
  ds_read_b64_tr_b16 a[206:207], v47 offset:9216
  v_mfma_f32_16x16x32_bf16 v[200:203], a[208:211], a[240:243], v[200:203]
  buffer_load_dwordx4 v29, s[60:63], s51 offen offset:3072  lds
  v_mfma_f32_16x16x32_bf16 v[200:203], a[212:215], a[244:247], v[200:203]
  ds_read_b128 a[176:179], v34 offset:4096
  v_xor_b32 v26, 0x80, v26
  v_mfma_f32_16x16x32_bf16 v[232:235], a[212:215], a[252:255], v[232:235]
  ds_read_b128 a[180:183], v35 offset:4096
  v_xor_b32 v27, 0x80, v27
  v_mfma_f32_16x16x32_bf16 v[232:235], a[208:211], a[248:251], v[232:235]
  s_waitcnt lgkmcnt(15)
  s_add_u32 m0, s96, 0x20000
  v_mfma_f32_16x16x32_bf16 v[236:239], a[216:219], a[248:251], v[236:239]
  ds_read_b64_tr_b16 a[208:209], v48 offset:0
  s_waitcnt lgkmcnt(15)
  v_mfma_f32_16x16x32_bf16 v[236:239], a[220:223], a[252:255], v[236:239]
  buffer_load_dwordx4 v26, s[56:59], s40 offen offset:0  lds
  v_mfma_f32_16x16x32_bf16 v[204:207], a[220:223], a[244:247], v[204:207]
  ds_read_b64_tr_b16 a[210:211], v48 offset:1024
  v_mfma_f32_16x16x32_bf16 v[204:207], a[216:219], a[240:243], v[204:207]
  ds_read_b64_tr_b16 a[212:213], v48 offset:8192
  v_mfma_f32_16x16x32_bf16 v[172:175], a[216:219], a[232:235], v[172:175]
  ds_read_b64_tr_b16 a[214:215], v48 offset:9216
  v_mfma_f32_16x16x32_bf16 v[172:175], a[220:223], a[236:239], v[172:175]
  buffer_load_dwordx4 v27, s[56:59], s41 offen offset:1024  lds
  v_mfma_f32_16x16x32_bf16 v[140:143], a[220:223], a[228:231], v[140:143]
  ds_read_b128 a[184:187], v34 offset:6144
  v_mfma_f32_16x16x32_bf16 v[140:143], a[216:219], a[224:227], v[140:143]
  ds_read_b128 a[188:191], v35 offset:6144
  s_waitcnt lgkmcnt(15)
  v_mfma_f32_16x16x32_bf16 v[144:147], a[192:195], a[224:227], v[144:147]
  ds_read_b64_tr_b16 a[216:217], v49 offset:0
  s_waitcnt lgkmcnt(15)
  v_mfma_f32_16x16x32_bf16 v[144:147], a[196:199], a[228:231], v[144:147]
  ds_read_b64_tr_b16 a[218:219], v49 offset:1024
  v_mfma_f32_16x16x32_bf16 v[176:179], a[196:199], a[236:239], v[176:179]
  buffer_load_dwordx4 v26, s[56:59], s42 offen offset:2048  lds
  v_mfma_f32_16x16x32_bf16 v[176:179], a[192:195], a[232:235], v[176:179]
  ds_read_b64_tr_b16 a[220:221], v49 offset:8192
  v_mfma_f32_16x16x32_bf16 v[208:211], a[192:195], a[240:243], v[208:211]
  ds_read_b64_tr_b16 a[222:223], v49 offset:9216
  v_mfma_f32_16x16x32_bf16 v[208:211], a[196:199], a[244:247], v[208:211]
  v_mfma_f32_16x16x32_bf16 v[240:243], a[196:199], a[252:255], v[240:243]
  v_mfma_f32_16x16x32_bf16 v[240:243], a[192:195], a[248:251], v[240:243]
  s_waitcnt vmcnt(15) lgkmcnt(14)
  buffer_load_dwordx4 v27, s[56:59], s43 offen offset:3072  lds
  v_mfma_f32_16x16x32_bf16 v[244:247], a[200:203], a[248:251], v[244:247]
  s_barrier
  s_waitcnt lgkmcnt(12)
  v_mfma_f32_16x16x32_bf16 v[244:247], a[204:207], a[252:255], v[244:247]
  ds_read_b64_tr_b16 a[192:193], v42 offset:16384
  v_accvgpr_write_b32 a144, v14
  v_mfma_f32_16x16x32_bf16 v[212:215], a[204:207], a[244:247], v[212:215]
  ds_read_b64_tr_b16 a[194:195], v42 offset:17408
  v_accvgpr_write_b32 a145, v14
  v_mfma_f32_16x16x32_bf16 v[212:215], a[200:203], a[240:243], v[212:215]
  ds_read_b64_tr_b16 a[196:197], v42 offset:24576
  v_accvgpr_write_b32 a146, v14
  v_mfma_f32_16x16x32_bf16 v[180:183], a[200:203], a[232:235], v[180:183]
  buffer_load_dword v10, v7, s[20:23], 0 offen offset:0 sc1
  v_mfma_f32_16x16x32_bf16 v[180:183], a[204:207], a[236:239], v[180:183]
  s_add_u32 m0, s96, 0x21000
  ds_read_b64_tr_b16 a[198:199], v42 offset:25600
  v_accvgpr_write_b32 a147, v14
  v_mfma_f32_16x16x32_bf16 v[148:151], a[204:207], a[228:231], v[148:151]
  v_mfma_f32_16x16x32_bf16 v[148:151], a[200:203], a[224:227], v[148:151]
  s_waitcnt lgkmcnt(12)
  buffer_load_dwordx4 v26, s[56:59], s44 offen offset:0  lds
  v_mfma_f32_16x16x32_bf16 v[152:155], a[208:211], a[224:227], v[152:155]
  s_waitcnt lgkmcnt(10)
  ds_read_b64_tr_b16 a[200:201], v43 offset:16384
  v_mfma_f32_16x16x32_bf16 v[152:155], a[212:215], a[228:231], v[152:155]
  ds_read_b64_tr_b16 a[202:203], v43 offset:17408
  v_mfma_f32_16x16x32_bf16 v[184:187], a[212:215], a[236:239], v[184:187]
  buffer_load_dwordx4 v27, s[56:59], s45 offen offset:1024  lds
  v_mfma_f32_16x16x32_bf16 v[184:187], a[208:211], a[232:235], v[184:187]
  ds_read_b64_tr_b16 a[204:205], v43 offset:24576
  v_mfma_f32_16x16x32_bf16 v[216:219], a[208:211], a[240:243], v[216:219]
  ds_read_b64_tr_b16 a[206:207], v43 offset:25600
  v_mfma_f32_16x16x32_bf16 v[216:219], a[212:215], a[244:247], v[216:219]
  v_mfma_f32_16x16x32_bf16 v[248:251], a[212:215], a[252:255], v[248:251]
  buffer_load_dwordx4 v26, s[56:59], s46 offen offset:2048  lds
  v_mfma_f32_16x16x32_bf16 v[248:251], a[208:211], a[248:251], v[248:251]
  s_waitcnt lgkmcnt(10)
  v_mfma_f32_16x16x32_bf16 v[252:255], a[216:219], a[248:251], v[252:255]
  s_waitcnt lgkmcnt(8)
  ds_read_b64_tr_b16 a[208:209], v44 offset:16384
  v_lshlrev_b32 v22, 6, v0
  v_mfma_f32_16x16x32_bf16 v[252:255], a[220:223], a[252:255], v[252:255]
  ds_read_b64_tr_b16 a[210:211], v44 offset:17408
  v_mfma_f32_16x16x32_bf16 v[220:223], a[220:223], a[244:247], v[220:223]
  ds_read_b64_tr_b16 a[212:213], v44 offset:24576
  v_mfma_f32_16x16x32_bf16 v[220:223], a[216:219], a[240:243], v[220:223]
  buffer_load_dwordx4 v27, s[56:59], s47 offen offset:3072  lds
  v_mfma_f32_16x16x32_bf16 v[188:191], a[216:219], a[232:235], v[188:191]
  ds_read_b64_tr_b16 a[214:215], v44 offset:25600
  v_xor_b32 v28, 0x80000, v28
  v_mfma_f32_16x16x32_bf16 v[188:191], a[220:223], a[236:239], v[188:191]
  v_xor_b32 v29, 0x80000, v29
  v_mfma_f32_16x16x32_bf16 v[156:159], a[220:223], a[228:231], v[156:159]
  s_add_u32 m0, s97, 0x1c000
  v_mfma_f32_16x16x32_bf16 v[156:159], a[216:219], a[224:227], v[156:159]
  s_waitcnt lgkmcnt(10)
  buffer_load_dwordx4 v28, s[60:63], s48 offen offset:0  lds
  v_mfma_f32_16x16x32_bf16 v[128:131], a[192:195], a[160:163], v[128:131]
  s_waitcnt lgkmcnt(8)
  ds_read_b64_tr_b16 a[216:217], v45 offset:16384
  v_mfma_f32_16x16x32_bf16 v[128:131], a[196:199], a[164:167], v[128:131]
  ds_read_b64_tr_b16 a[218:219], v45 offset:17408
  v_mfma_f32_16x16x32_bf16 v[160:163], a[196:199], a[172:175], v[160:163]
  ds_read_b64_tr_b16 a[220:221], v45 offset:24576
  v_mfma_f32_16x16x32_bf16 v[160:163], a[192:195], a[168:171], v[160:163]
  ds_read_b64_tr_b16 a[222:223], v45 offset:25600
  v_mfma_f32_16x16x32_bf16 v[192:195], a[192:195], a[176:179], v[192:195]
  buffer_load_dwordx4 v28, s[60:63], s49 offen offset:1024  lds
  v_mfma_f32_16x16x32_bf16 v[192:195], a[196:199], a[180:183], v[192:195]
  s_waitcnt vmcnt(15)
  ds_read_b128 a[224:227], v34 offset:32768
  v_mfma_f32_16x16x32_bf16 v[224:227], a[196:199], a[188:191], v[224:227]
  ds_read_b128 a[228:231], v35 offset:32768
  v_mfma_f32_16x16x32_bf16 v[224:227], a[192:195], a[184:187], v[224:227]
  s_waitcnt lgkmcnt(12)
  v_mfma_f32_16x16x32_bf16 v[228:231], a[200:203], a[184:187], v[228:231]
  s_waitcnt lgkmcnt(10)
  ds_read_b64_tr_b16 a[192:193], v46 offset:16384
  v_mfma_f32_16x16x32_bf16 v[228:231], a[204:207], a[188:191], v[228:231]
  buffer_load_dwordx4 v29, s[60:63], s50 offen offset:2048  lds
  v_mfma_f32_16x16x32_bf16 v[196:199], a[204:207], a[180:183], v[196:199]
  ds_read_b64_tr_b16 a[194:195], v46 offset:17408
  v_mfma_f32_16x16x32_bf16 v[196:199], a[200:203], a[176:179], v[196:199]
  ds_read_b64_tr_b16 a[196:197], v46 offset:24576
  v_mfma_f32_16x16x32_bf16 v[164:167], a[200:203], a[168:171], v[164:167]
  ds_read_b64_tr_b16 a[198:199], v46 offset:25600
  v_mfma_f32_16x16x32_bf16 v[164:167], a[204:207], a[172:175], v[164:167]
  buffer_load_dwordx4 v29, s[60:63], s51 offen offset:3072  lds
  v_mfma_f32_16x16x32_bf16 v[132:135], a[204:207], a[164:167], v[132:135]
  ds_read_b128 a[232:235], v34 offset:34816
  v_mfma_f32_16x16x32_bf16 v[132:135], a[200:203], a[160:163], v[132:135]
  s_waitcnt lgkmcnt(13)
  s_mov_b32 s3, 0x80000
  ds_read_b128 a[236:239], v35 offset:34816
  v_mfma_f32_16x16x32_bf16 v[136:139], a[208:211], a[160:163], v[136:139]
  s_waitcnt lgkmcnt(12)
  ds_read_b64_tr_b16 a[200:201], v47 offset:16384
  v_mfma_f32_16x16x32_bf16 v[136:139], a[212:215], a[164:167], v[136:139]
  ds_read_b64_tr_b16 a[202:203], v47 offset:17408
  v_mfma_f32_16x16x32_bf16 v[168:171], a[212:215], a[172:175], v[168:171]
  buffer_store_dwordx4 v[64:67], v12, s[16:19], s3 offen offset:0 sc1
  v_mfma_f32_16x16x32_bf16 v[168:171], a[208:211], a[168:171], v[168:171]
  s_mov_b32 s3, 0x81000
  ds_read_b64_tr_b16 a[204:205], v47 offset:24576
  v_mfma_f32_16x16x32_bf16 v[200:203], a[208:211], a[176:179], v[200:203]
  ds_read_b64_tr_b16 a[206:207], v47 offset:25600
  v_mfma_f32_16x16x32_bf16 v[200:203], a[212:215], a[180:183], v[200:203]
  buffer_store_dwordx4 v[80:83], v12, s[16:19], s3 offen offset:0 sc1
  v_mfma_f32_16x16x32_bf16 v[232:235], a[212:215], a[188:191], v[232:235]
  ds_read_b128 a[240:243], v34 offset:36864
  v_mfma_f32_16x16x32_bf16 v[232:235], a[208:211], a[184:187], v[232:235]
  ds_read_b128 a[244:247], v35 offset:36864
  s_waitcnt lgkmcnt(15)
  v_mfma_f32_16x16x32_bf16 v[236:239], a[216:219], a[184:187], v[236:239]
  ds_read_b64_tr_b16 a[208:209], v48 offset:16384
  s_waitcnt lgkmcnt(15)
  v_mfma_f32_16x16x32_bf16 v[236:239], a[220:223], a[188:191], v[236:239]
  ds_read_b64_tr_b16 a[210:211], v48 offset:17408
  v_mfma_f32_16x16x32_bf16 v[204:207], a[220:223], a[180:183], v[204:207]
  ds_read_b64_tr_b16 a[212:213], v48 offset:24576
  v_mfma_f32_16x16x32_bf16 v[204:207], a[216:219], a[176:179], v[204:207]
  ds_read_b64_tr_b16 a[214:215], v48 offset:25600
  v_mfma_f32_16x16x32_bf16 v[172:175], a[216:219], a[168:171], v[172:175]
  ds_read_b128 a[248:251], v34 offset:38912
  v_mfma_f32_16x16x32_bf16 v[172:175], a[220:223], a[172:175], v[172:175]
  v_mfma_f32_16x16x32_bf16 v[140:143], a[220:223], a[164:167], v[140:143]
  ds_read_b128 a[252:255], v35 offset:38912
  v_mfma_f32_16x16x32_bf16 v[140:143], a[216:219], a[160:163], v[140:143]
  s_waitcnt lgkmcnt(15)
  v_mfma_f32_16x16x32_bf16 v[144:147], a[192:195], a[160:163], v[144:147]
  ds_read_b64_tr_b16 a[216:217], v49 offset:16384
  s_waitcnt lgkmcnt(15)
  v_mfma_f32_16x16x32_bf16 v[144:147], a[196:199], a[164:167], v[144:147]
  ds_read_b64_tr_b16 a[218:219], v49 offset:17408
  v_mfma_f32_16x16x32_bf16 v[176:179], a[196:199], a[172:175], v[176:179]
  ds_read_b64_tr_b16 a[220:221], v49 offset:24576
  v_mfma_f32_16x16x32_bf16 v[176:179], a[192:195], a[168:171], v[176:179]
  ds_read_b64_tr_b16 a[222:223], v49 offset:25600
  v_mfma_f32_16x16x32_bf16 v[208:211], a[192:195], a[176:179], v[208:211]
  v_mfma_f32_16x16x32_bf16 v[208:211], a[196:199], a[180:183], v[208:211]
  v_mfma_f32_16x16x32_bf16 v[240:243], a[196:199], a[188:191], v[240:243]
  s_waitcnt vmcnt(10)
  v_cmp_ne_u32 vcc, 1, v10
  s_nop 2
  s_cbranch_vccnz L_kv_wait
L_kv_ok:
  v_mfma_f32_16x16x32_bf16 v[240:243], a[192:195], a[184:187], v[240:243]
  s_waitcnt lgkmcnt(14)
  v_mfma_f32_16x16x32_bf16 v[244:247], a[200:203], a[184:187], v[244:247]
  s_barrier
  s_waitcnt lgkmcnt(12)
  v_mfma_f32_16x16x32_bf16 v[244:247], a[204:207], a[188:191], v[244:247]
  s_mov_b32 s3, 0x80000
  ds_read_b64_tr_b16 a[192:193], v42 offset:32768
  v_mfma_f32_16x16x32_bf16 v[212:215], a[204:207], a[180:183], v[212:215]
  buffer_store_dwordx4 v[96:99], v11, s[16:19], s3 offen offset:0 sc1
  v_mfma_f32_16x16x32_bf16 v[212:215], a[200:203], a[176:179], v[212:215]
  s_add_u32 s3, s100, 128
  ds_read_b64_tr_b16 a[194:195], v42 offset:33792
  v_mfma_f32_16x16x32_bf16 v[180:183], a[200:203], a[168:171], v[180:183]
  s_cmp_eq_u32 s30, 7
  s_cselect_b32 s3, s3, 0x1000
  ds_read_b64_tr_b16 a[196:197], v42 offset:40960
  v_mfma_f32_16x16x32_bf16 v[180:183], a[204:207], a[172:175], v[180:183]
  buffer_store_dword v9, v8, s[4:7], s3 offen sc1
  v_mfma_f32_16x16x32_bf16 v[148:151], a[204:207], a[164:167], v[148:151]
  s_mov_b32 s98, 0x0
  ds_read_b64_tr_b16 a[198:199], v42 offset:41984
  v_mfma_f32_16x16x32_bf16 v[148:151], a[200:203], a[160:163], v[148:151]
  s_waitcnt lgkmcnt(12)
  s_add_u32 m0, s97, 0x10000
  v_mfma_f32_16x16x32_bf16 v[152:155], a[208:211], a[160:163], v[152:155]
  s_waitcnt lgkmcnt(10)
  buffer_load_dwordx4 v2, s[24:27], s98 offen offset:0 sc1 lds
  v_mfma_f32_16x16x32_bf16 v[152:155], a[212:215], a[164:167], v[152:155]
  ds_read_b64_tr_b16 a[200:201], v43 offset:32768
  v_mfma_f32_16x16x32_bf16 v[184:187], a[212:215], a[172:175], v[184:187]
  ds_read_b64_tr_b16 a[202:203], v43 offset:33792
  v_mfma_f32_16x16x32_bf16 v[184:187], a[208:211], a[168:171], v[184:187]
  buffer_load_dwordx4 v2, s[24:27], s98 offen offset:1024 sc1 lds
  v_mfma_f32_16x16x32_bf16 v[216:219], a[208:211], a[176:179], v[216:219]
  ds_read_b64_tr_b16 a[204:205], v43 offset:40960
  v_mfma_f32_16x16x32_bf16 v[216:219], a[212:215], a[180:183], v[216:219]
  ds_read_b64_tr_b16 a[206:207], v43 offset:41984
  v_mfma_f32_16x16x32_bf16 v[248:251], a[212:215], a[188:191], v[248:251]
  buffer_load_dwordx4 v2, s[24:27], s98 offen offset:2048 sc1 lds
  v_mfma_f32_16x16x32_bf16 v[248:251], a[208:211], a[184:187], v[248:251]
  s_waitcnt lgkmcnt(10)
  v_mfma_f32_16x16x32_bf16 v[252:255], a[216:219], a[184:187], v[252:255]
  s_waitcnt lgkmcnt(8)
  ds_read_b64_tr_b16 a[208:209], v44 offset:32768
  v_mfma_f32_16x16x32_bf16 v[252:255], a[220:223], a[188:191], v[252:255]
  ds_read_b64_tr_b16 a[210:211], v44 offset:33792
  v_mfma_f32_16x16x32_bf16 v[220:223], a[220:223], a[180:183], v[220:223]
  ds_read_b64_tr_b16 a[212:213], v44 offset:40960
  v_mfma_f32_16x16x32_bf16 v[220:223], a[216:219], a[176:179], v[220:223]
  buffer_load_dwordx4 v2, s[24:27], s98 offen offset:3072 sc1 lds
  v_mfma_f32_16x16x32_bf16 v[188:191], a[216:219], a[168:171], v[188:191]
  s_mov_b32 s98, 0x4000
  ds_read_b64_tr_b16 a[214:215], v44 offset:41984
  v_mfma_f32_16x16x32_bf16 v[188:191], a[220:223], a[172:175], v[188:191]
  s_add_u32 m0, s97, 0x0
  v_mfma_f32_16x16x32_bf16 v[156:159], a[220:223], a[164:167], v[156:159]
  v_mfma_f32_16x16x32_bf16 v[156:159], a[216:219], a[160:163], v[156:159]
  s_waitcnt lgkmcnt(10)
  buffer_load_dwordx4 v2, s[24:27], s98 offen offset:0 sc1 lds
  v_mfma_f32_16x16x32_bf16 v[128:131], a[192:195], a[224:227], v[128:131]
  s_waitcnt lgkmcnt(8)
  s_mov_b32 s82, 26
  ds_read_b64_tr_b16 a[216:217], v45 offset:32768
  v_mfma_f32_16x16x32_bf16 v[128:131], a[196:199], a[228:231], v[128:131]
  s_mov_b32 s99, 0x14000
  ds_read_b64_tr_b16 a[218:219], v45 offset:33792
  v_mfma_f32_16x16x32_bf16 v[160:163], a[196:199], a[236:239], v[160:163]
  s_add_u32 s100, s97, 0x10000
  ds_read_b64_tr_b16 a[220:221], v45 offset:40960
  v_mfma_f32_16x16x32_bf16 v[160:163], a[192:195], a[232:235], v[160:163]
  s_add_u32 s101, s97, 0x8000
  ds_read_b64_tr_b16 a[222:223], v45 offset:41984
  v_mfma_f32_16x16x32_bf16 v[192:195], a[192:195], a[240:243], v[192:195]
  s_lshl_b32 s88, s29, 3
  buffer_load_dwordx4 v2, s[24:27], s98 offen offset:1024 sc1 lds
  v_mfma_f32_16x16x32_bf16 v[192:195], a[196:199], a[244:247], v[192:195]
  s_waitcnt vmcnt(14)
  s_add_u32 s88, s88, s30
  ds_read_b128 a[160:163], v36 offset:0
  v_mfma_f32_16x16x32_bf16 v[224:227], a[196:199], a[252:255], v[224:227]
  s_lshl_b32 s88, s88, 7
  ds_read_b128 a[164:167], v37 offset:0
  v_mfma_f32_16x16x32_bf16 v[224:227], a[192:195], a[248:251], v[224:227]
  s_waitcnt lgkmcnt(12)
  s_add_u32 s88, s88, 524288
  v_mfma_f32_16x16x32_bf16 v[228:231], a[200:203], a[248:251], v[228:231]
  s_waitcnt lgkmcnt(10)
  ds_read_b64_tr_b16 a[192:193], v46 offset:32768
  v_mfma_f32_16x16x32_bf16 v[228:231], a[204:207], a[252:255], v[228:231]
  buffer_load_dwordx4 v2, s[24:27], s98 offen offset:2048 sc1 lds
  v_mfma_f32_16x16x32_bf16 v[196:199], a[204:207], a[244:247], v[196:199]
  ds_read_b64_tr_b16 a[194:195], v46 offset:33792
  v_mfma_f32_16x16x32_bf16 v[196:199], a[200:203], a[240:243], v[196:199]
  ds_read_b64_tr_b16 a[196:197], v46 offset:40960
  v_mfma_f32_16x16x32_bf16 v[164:167], a[200:203], a[232:235], v[164:167]
  ds_read_b64_tr_b16 a[198:199], v46 offset:41984
  v_and_b32 v14, 15, v1
  v_mfma_f32_16x16x32_bf16 v[164:167], a[204:207], a[236:239], v[164:167]
  buffer_load_dwordx4 v2, s[24:27], s98 offen offset:3072 sc1 lds
  v_mfma_f32_16x16x32_bf16 v[132:135], a[204:207], a[228:231], v[132:135]
  ds_read_b128 a[168:171], v36 offset:2048
  v_lshrrev_b32 v15, 4, v1
  v_mfma_f32_16x16x32_bf16 v[132:135], a[200:203], a[224:227], v[132:135]
  s_waitcnt lgkmcnt(13)
  s_mov_b32 s3, 0x82000
  ds_read_b128 a[172:175], v37 offset:2048
  v_lshlrev_b32 v15, 2, v15
  v_mfma_f32_16x16x32_bf16 v[136:139], a[208:211], a[224:227], v[136:139]
  s_waitcnt lgkmcnt(12)
  ds_read_b64_tr_b16 a[200:201], v47 offset:32768
  v_sub_u32 v14, v14, v15
  v_mfma_f32_16x16x32_bf16 v[136:139], a[212:215], a[228:231], v[136:139]
  ds_read_b64_tr_b16 a[202:203], v47 offset:33792
  v_mfma_f32_16x16x32_bf16 v[168:171], a[212:215], a[236:239], v[168:171]
  buffer_store_dwordx4 v[112:115], v11, s[16:19], s3 offen offset:0 sc1
  v_mfma_f32_16x16x32_bf16 v[168:171], a[208:211], a[232:235], v[168:171]
  ds_read_b64_tr_b16 a[204:205], v47 offset:40960
  v_lshrrev_b32 v15, 6, v0
  v_mfma_f32_16x16x32_bf16 v[200:203], a[208:211], a[240:243], v[200:203]
  ds_read_b64_tr_b16 a[206:207], v47 offset:41984
  v_lshl_add_u32 v14, v15, 4, v14
  v_mfma_f32_16x16x32_bf16 v[200:203], a[212:215], a[244:247], v[200:203]
  ds_read_b128 a[176:179], v36 offset:4096
  v_mov_b32 v15, 0
  v_mfma_f32_16x16x32_bf16 v[232:235], a[212:215], a[252:255], v[232:235]
  ds_read_b128 a[180:183], v37 offset:4096
  v_cmp_le_i32 s[32:33], 0, v14
  v_mfma_f32_16x16x32_bf16 v[232:235], a[208:211], a[248:251], v[232:235]
  s_waitcnt lgkmcnt(15)
  v_mfma_f32_16x16x32_bf16 v[236:239], a[216:219], a[248:251], v[236:239]
  ds_read_b64_tr_b16 a[208:209], v48 offset:32768
  v_cmp_le_i32 s[34:35], 1, v14
  s_waitcnt lgkmcnt(15)
  v_mfma_f32_16x16x32_bf16 v[236:239], a[220:223], a[252:255], v[236:239]
  s_mov_b32 s3, 0x80000
  ds_read_b64_tr_b16 a[210:211], v48 offset:33792
  v_cmp_le_i32 s[36:37], 2, v14
  v_mfma_f32_16x16x32_bf16 v[204:207], a[220:223], a[244:247], v[204:207]
  buffer_store_dwordx4 v[68:71], v12, s[16:19], s3 offen offset:1024 sc1
  v_mfma_f32_16x16x32_bf16 v[204:207], a[216:219], a[240:243], v[204:207]
  ds_read_b64_tr_b16 a[212:213], v48 offset:40960
  v_cmp_le_i32 s[38:39], 3, v14
  v_mfma_f32_16x16x32_bf16 v[172:175], a[216:219], a[232:235], v[172:175]
  ds_read_b64_tr_b16 a[214:215], v48 offset:41984
  v_cmp_le_i32 s[40:41], 16, v14
  v_mfma_f32_16x16x32_bf16 v[172:175], a[220:223], a[236:239], v[172:175]
  ds_read_b128 a[184:187], v36 offset:6144
  v_mfma_f32_16x16x32_bf16 v[140:143], a[220:223], a[228:231], v[140:143]
  ds_read_b128 a[188:191], v37 offset:6144
  v_cmp_le_i32 s[42:43], 17, v14
  v_mfma_f32_16x16x32_bf16 v[140:143], a[216:219], a[224:227], v[140:143]
  s_waitcnt lgkmcnt(15)
  v_cmp_le_i32 s[44:45], 18, v14
  v_mfma_f32_16x16x32_bf16 v[144:147], a[192:195], a[224:227], v[144:147]
  ds_read_b64_tr_b16 a[216:217], v49 offset:32768
  s_waitcnt lgkmcnt(15)
  v_mfma_f32_16x16x32_bf16 v[144:147], a[196:199], a[228:231], v[144:147]
  ds_read_b64_tr_b16 a[218:219], v49 offset:33792
  v_cmp_le_i32 s[46:47], 19, v14
  v_mfma_f32_16x16x32_bf16 v[176:179], a[196:199], a[236:239], v[176:179]
  ds_read_b64_tr_b16 a[220:221], v49 offset:40960
  v_cmp_le_i32 s[48:49], 32, v14
  v_mfma_f32_16x16x32_bf16 v[176:179], a[192:195], a[232:235], v[176:179]
  ds_read_b64_tr_b16 a[222:223], v49 offset:41984
  v_mfma_f32_16x16x32_bf16 v[208:211], a[192:195], a[240:243], v[208:211]
  v_cmp_le_i32 s[50:51], 33, v14
  v_mfma_f32_16x16x32_bf16 v[208:211], a[196:199], a[244:247], v[208:211]
  v_cmp_le_i32 s[52:53], 34, v14
  v_mfma_f32_16x16x32_bf16 v[240:243], a[196:199], a[252:255], v[240:243]
  v_mfma_f32_16x16x32_bf16 v[240:243], a[192:195], a[248:251], v[240:243]
  s_waitcnt vmcnt(14) lgkmcnt(14)
  v_cmp_le_i32 s[54:55], 35, v14
  v_mfma_f32_16x16x32_bf16 v[244:247], a[200:203], a[248:251], v[244:247]
  s_barrier
  s_waitcnt lgkmcnt(12)
  v_mfma_f32_16x16x32_bf16 v[244:247], a[204:207], a[252:255], v[244:247]
  s_mov_b32 s98, 0x8000
  ds_read_b64_tr_b16 a[192:193], v42 offset:49152
  v_cmp_le_i32 s[56:57], 48, v14
  v_mfma_f32_16x16x32_bf16 v[212:215], a[204:207], a[244:247], v[212:215]
  s_add_u32 m0, s97, 0x14000
  ds_read_b64_tr_b16 a[194:195], v42 offset:50176
  v_cmp_le_i32 s[58:59], 49, v14
  v_mfma_f32_16x16x32_bf16 v[212:215], a[200:203], a[240:243], v[212:215]
  buffer_load_dwordx4 v2, s[24:27], s98 offen offset:0 sc1 lds
  v_mfma_f32_16x16x32_bf16 v[180:183], a[200:203], a[232:235], v[180:183]
  ds_read_b64_tr_b16 a[196:197], v42 offset:57344
  v_cmp_le_i32 s[60:61], 50, v14
  v_mfma_f32_16x16x32_bf16 v[180:183], a[204:207], a[236:239], v[180:183]
  ds_read_b64_tr_b16 a[198:199], v42 offset:58368
  v_cmp_le_i32 s[62:63], 51, v14
  v_mfma_f32_16x16x32_bf16 v[148:151], a[204:207], a[228:231], v[148:151]
  buffer_load_dwordx4 v2, s[24:27], s98 offen offset:1024 sc1 lds
  v_mfma_f32_16x16x32_bf16 v[148:151], a[200:203], a[224:227], v[148:151]
  s_waitcnt lgkmcnt(12)
  s_cmp_eq_u32 s30, 0
  s_cselect_b64 s[0:1], s[32:33], -1
  v_mfma_f32_16x16x32_bf16 v[152:155], a[208:211], a[224:227], v[152:155]
  s_waitcnt lgkmcnt(10)
  ds_read_b64_tr_b16 a[200:201], v43 offset:49152
  v_mfma_f32_16x16x32_bf16 v[152:155], a[212:215], a[228:231], v[152:155]
  ds_read_b64_tr_b16 a[202:203], v43 offset:50176
  v_mfma_f32_16x16x32_bf16 v[184:187], a[212:215], a[236:239], v[184:187]
  buffer_load_dwordx4 v2, s[24:27], s98 offen offset:2048 sc1 lds
  v_mfma_f32_16x16x32_bf16 v[184:187], a[208:211], a[232:235], v[184:187]
  ds_read_b64_tr_b16 a[204:205], v43 offset:57344
  v_cndmask_b32 v24, v13, v15, s[0:1]
  v_mfma_f32_16x16x32_bf16 v[216:219], a[208:211], a[240:243], v[216:219]
  ds_read_b64_tr_b16 a[206:207], v43 offset:58368
  v_mfma_f32_16x16x32_bf16 v[216:219], a[212:215], a[244:247], v[216:219]
  s_cmp_eq_u32 s30, 0
  s_cselect_b64 s[0:1], s[34:35], -1
  v_mfma_f32_16x16x32_bf16 v[248:251], a[212:215], a[252:255], v[248:251]
  v_cndmask_b32 v25, v13, v15, s[0:1]
  v_mfma_f32_16x16x32_bf16 v[248:251], a[208:211], a[248:251], v[248:251]
  s_waitcnt lgkmcnt(10)
  buffer_load_dwordx4 v2, s[24:27], s98 offen offset:3072 sc1 lds
  v_mfma_f32_16x16x32_bf16 v[252:255], a[216:219], a[248:251], v[252:255]
  s_waitcnt lgkmcnt(8)
  s_mov_b32 s3, 0x81000
  ds_read_b64_tr_b16 a[208:209], v44 offset:49152
  v_mfma_f32_16x16x32_bf16 v[252:255], a[220:223], a[252:255], v[252:255]
  s_cmp_eq_u32 s30, 0
  s_cselect_b64 s[0:1], s[36:37], -1
  ds_read_b64_tr_b16 a[210:211], v44 offset:50176
  v_mfma_f32_16x16x32_bf16 v[220:223], a[220:223], a[244:247], v[220:223]
  ds_read_b64_tr_b16 a[212:213], v44 offset:57344
  v_cndmask_b32 v26, v13, v15, s[0:1]
  v_mfma_f32_16x16x32_bf16 v[220:223], a[216:219], a[240:243], v[220:223]
  buffer_store_dwordx4 v[84:87], v12, s[16:19], s3 offen offset:1024 sc1
  v_mfma_f32_16x16x32_bf16 v[188:191], a[216:219], a[232:235], v[188:191]
  s_cmp_eq_u32 s30, 0
  s_cselect_b64 s[0:1], s[38:39], -1
  ds_read_b64_tr_b16 a[214:215], v44 offset:58368
  v_mfma_f32_16x16x32_bf16 v[188:191], a[220:223], a[236:239], v[188:191]
  v_cndmask_b32 v27, v13, v15, s[0:1]
  v_mfma_f32_16x16x32_bf16 v[156:159], a[220:223], a[228:231], v[156:159]
  v_mfma_f32_16x16x32_bf16 v[156:159], a[216:219], a[224:227], v[156:159]
  s_waitcnt lgkmcnt(10)
  v_mfma_f32_16x16x32_bf16 v[128:131], a[192:195], a[160:163], v[128:131]
  s_waitcnt lgkmcnt(8)
  ds_read_b64_tr_b16 a[216:217], v45 offset:49152
  v_mfma_f32_16x16x32_bf16 v[128:131], a[196:199], a[164:167], v[128:131]
  ds_read_b64_tr_b16 a[218:219], v45 offset:50176
  v_mfma_f32_16x16x32_bf16 v[160:163], a[196:199], a[172:175], v[160:163]
  ds_read_b64_tr_b16 a[220:221], v45 offset:57344
  v_mfma_f32_16x16x32_bf16 v[160:163], a[192:195], a[168:171], v[160:163]
  ds_read_b64_tr_b16 a[222:223], v45 offset:58368
  v_mfma_f32_16x16x32_bf16 v[192:195], a[192:195], a[176:179], v[192:195]
  v_mfma_f32_16x16x32_bf16 v[192:195], a[196:199], a[180:183], v[192:195]
  v_mfma_f32_16x16x32_bf16 v[224:227], a[196:199], a[188:191], v[224:227]
  v_mul_f32 v128, s83, v128
  v_mul_f32 v129, s83, v129
  v_mfma_f32_16x16x32_bf16 v[224:227], a[192:195], a[184:187], v[224:227]
  s_waitcnt lgkmcnt(10)
  v_mul_f32 v130, s83, v130
  v_mul_f32 v131, s83, v131
  v_mfma_f32_16x16x32_bf16 v[228:231], a[200:203], a[184:187], v[228:231]
  s_waitcnt lgkmcnt(8)
  s_mov_b32 s3, 0x80000
  ds_read_b64_tr_b16 a[192:193], v46 offset:49152
  v_mul_f32 v160, s83, v160
  v_mfma_f32_16x16x32_bf16 v[228:231], a[204:207], a[188:191], v[228:231]
  buffer_store_dwordx4 v[100:103], v11, s[16:19], s3 offen offset:1024 sc1
  v_mfma_f32_16x16x32_bf16 v[196:199], a[204:207], a[180:183], v[196:199]
  ds_read_b64_tr_b16 a[194:195], v46 offset:50176
  v_mul_f32 v161, s83, v161
  v_mfma_f32_16x16x32_bf16 v[196:199], a[200:203], a[176:179], v[196:199]
  ds_read_b64_tr_b16 a[196:197], v46 offset:57344
  v_mul_f32 v162, s83, v162
  v_mfma_f32_16x16x32_bf16 v[164:167], a[200:203], a[168:171], v[164:167]
  ds_read_b64_tr_b16 a[198:199], v46 offset:58368
  v_mul_f32 v163, s83, v163
  v_mfma_f32_16x16x32_bf16 v[164:167], a[204:207], a[172:175], v[164:167]
  v_mul_f32 v192, s83, v192
  v_mul_f32 v193, s83, v193
  v_mfma_f32_16x16x32_bf16 v[132:135], a[204:207], a[164:167], v[132:135]
  v_mul_f32 v194, s83, v194
  v_mul_f32 v195, s83, v195
  v_mfma_f32_16x16x32_bf16 v[132:135], a[200:203], a[160:163], v[132:135]
  s_waitcnt lgkmcnt(10)
  v_mul_f32 v224, s83, v224
  v_mul_f32 v225, s83, v225
  v_mfma_f32_16x16x32_bf16 v[136:139], a[208:211], a[160:163], v[136:139]
  s_waitcnt lgkmcnt(8)
  ds_read_b64_tr_b16 a[200:201], v47 offset:49152
  v_mul_f32 v196, s83, v196
  v_mfma_f32_16x16x32_bf16 v[136:139], a[212:215], a[164:167], v[136:139]
  ds_read_b64_tr_b16 a[202:203], v47 offset:50176
  v_mul_f32 v197, s83, v197
  v_mfma_f32_16x16x32_bf16 v[168:171], a[212:215], a[172:175], v[168:171]
  ds_read_b64_tr_b16 a[204:205], v47 offset:57344
  v_mul_f32 v164, s83, v164
  v_mfma_f32_16x16x32_bf16 v[168:171], a[208:211], a[168:171], v[168:171]
  ds_read_b64_tr_b16 a[206:207], v47 offset:58368
  v_mul_f32 v165, s83, v165
  v_mfma_f32_16x16x32_bf16 v[200:203], a[208:211], a[176:179], v[200:203]
  v_mul_f32 v132, s83, v132
  v_mul_f32 v133, s83, v133
  v_mfma_f32_16x16x32_bf16 v[200:203], a[212:215], a[180:183], v[200:203]
L_pad9:
  s_cbranch_execz L_pad13
  v_mul_f32 v134, s83, v134
  v_mul_f32 v135, s83, v135
  v_mfma_f32_16x16x32_bf16 v[232:235], a[212:215], a[188:191], v[232:235]
  v_mul_f32 v166, s83, v166
  v_mul_f32 v167, s83, v167
  v_mfma_f32_16x16x32_bf16 v[232:235], a[208:211], a[184:187], v[232:235]
  s_waitcnt lgkmcnt(10)
  v_mul_f32 v198, s83, v198
  v_mul_f32 v199, s83, v199
  v_mfma_f32_16x16x32_bf16 v[236:239], a[216:219], a[184:187], v[236:239]
  s_waitcnt lgkmcnt(8)
  ds_read_b64_tr_b16 a[208:209], v48 offset:49152
  v_mul_f32 v226, s83, v226
  v_mfma_f32_16x16x32_bf16 v[236:239], a[220:223], a[188:191], v[236:239]
  ds_read_b64_tr_b16 a[210:211], v48 offset:50176
  v_mul_f32 v227, s83, v227
  v_mfma_f32_16x16x32_bf16 v[204:207], a[220:223], a[180:183], v[204:207]
  ds_read_b64_tr_b16 a[212:213], v48 offset:57344
  v_mul_f32 v228, s83, v228
  v_mfma_f32_16x16x32_bf16 v[204:207], a[216:219], a[176:179], v[204:207]
  ds_read_b64_tr_b16 a[214:215], v48 offset:58368
  v_mul_f32 v229, s83, v229
  v_mfma_f32_16x16x32_bf16 v[172:175], a[216:219], a[168:171], v[172:175]
  v_mul_f32 v230, s83, v230
  v_mul_f32 v231, s83, v231
  v_mfma_f32_16x16x32_bf16 v[172:175], a[220:223], a[172:175], v[172:175]
  v_mfma_f32_16x16x32_bf16 v[140:143], a[220:223], a[164:167], v[140:143]
  v_mfma_f32_16x16x32_bf16 v[140:143], a[216:219], a[160:163], v[140:143]
  s_waitcnt lgkmcnt(10)
  v_mfma_f32_16x16x32_bf16 v[144:147], a[192:195], a[160:163], v[144:147]
  s_waitcnt lgkmcnt(8)
  s_mov_b32 s3, 0x82000
  ds_read_b64_tr_b16 a[216:217], v49 offset:49152
  v_mfma_f32_16x16x32_bf16 v[144:147], a[196:199], a[164:167], v[144:147]
  buffer_store_dwordx4 v[116:119], v11, s[16:19], s3 offen offset:1024 sc1
  v_mfma_f32_16x16x32_bf16 v[176:179], a[196:199], a[172:175], v[176:179]
  ds_read_b64_tr_b16 a[218:219], v49 offset:50176
  v_mfma_f32_16x16x32_bf16 v[176:179], a[192:195], a[168:171], v[176:179]
  ds_read_b64_tr_b16 a[220:221], v49 offset:57344
  v_mfma_f32_16x16x32_bf16 v[208:211], a[192:195], a[176:179], v[208:211]
  ds_read_b64_tr_b16 a[222:223], v49 offset:58368
  v_mfma_f32_16x16x32_bf16 v[208:211], a[196:199], a[180:183], v[208:211]
  v_mfma_f32_16x16x32_bf16 v[240:243], a[196:199], a[188:191], v[240:243]
  v_mul_f32 v144, s83, v144
  v_mul_f32 v145, s83, v145
  v_mfma_f32_16x16x32_bf16 v[240:243], a[192:195], a[184:187], v[240:243]
  s_waitcnt vmcnt(13) lgkmcnt(10)
  v_mul_f32 v146, s83, v146
  v_mul_f32 v147, s83, v147
  v_mfma_f32_16x16x32_bf16 v[244:247], a[200:203], a[184:187], v[244:247]
  s_barrier
  s_waitcnt lgkmcnt(8)
  v_mfma_f32_16x16x32_bf16 v[244:247], a[204:207], a[188:191], v[244:247]
  s_mov_b32 s98, 0x10000
  ds_read_b128 a[224:227], v4 offset:0
  v_mul_f32 v176, s83, v176
  v_mfma_f32_16x16x32_bf16 v[212:215], a[204:207], a[180:183], v[212:215]
  s_add_u32 m0, s97, 0x18000
  ds_read_b128 a[228:231], v4 offset:1024
  v_mul_f32 v177, s83, v177
  v_mfma_f32_16x16x32_bf16 v[212:215], a[200:203], a[176:179], v[212:215]
  buffer_load_dwordx4 v2, s[24:27], s98 offen offset:0 sc1 lds
  v_mfma_f32_16x16x32_bf16 v[180:183], a[200:203], a[168:171], v[180:183]
  ds_read_b128 a[232:235], v4 offset:2048
  v_mul_f32 v178, s83, v178
  v_mfma_f32_16x16x32_bf16 v[180:183], a[204:207], a[172:175], v[180:183]
  ds_read_b128 a[236:239], v4 offset:3072
  v_mul_f32 v179, s83, v179
  v_mfma_f32_16x16x32_bf16 v[148:151], a[204:207], a[164:167], v[148:151]
  buffer_load_dwordx4 v2, s[24:27], s98 offen offset:1024 sc1 lds
  v_mfma_f32_16x16x32_bf16 v[148:151], a[200:203], a[160:163], v[148:151]
  s_waitcnt lgkmcnt(10)
  v_mul_f32 v208, s83, v208
  v_mul_f32 v209, s83, v209
  v_mfma_f32_16x16x32_bf16 v[152:155], a[208:211], a[160:163], v[152:155]
  s_waitcnt lgkmcnt(8)
  v_mul_f32 v210, s83, v210
  v_mul_f32 v211, s83, v211
  v_mfma_f32_16x16x32_bf16 v[152:155], a[212:215], a[164:167], v[152:155]
  buffer_load_dwordx4 v2, s[24:27], s98 offen offset:2048 sc1 lds
  v_mfma_f32_16x16x32_bf16 v[184:187], a[212:215], a[172:175], v[184:187]
  v_mul_f32 v180, s83, v180
  v_mul_f32 v181, s83, v181
  v_mfma_f32_16x16x32_bf16 v[184:187], a[208:211], a[168:171], v[184:187]
  v_mul_f32 v182, s83, v182
  v_mul_f32 v183, s83, v183
  v_mfma_f32_16x16x32_bf16 v[216:219], a[208:211], a[176:179], v[216:219]
  buffer_load_dwordx4 v2, s[24:27], s98 offen offset:3072 sc1 lds
  v_mfma_f32_16x16x32_bf16 v[216:219], a[212:215], a[180:183], v[216:219]
  s_mov_b32 s98, 0xc000
  v_mul_f32 v148, s83, v148
  v_mul_f32 v149, s83, v149
  v_mfma_f32_16x16x32_bf16 v[248:251], a[212:215], a[188:191], v[248:251]
  s_add_u32 m0, s97, 0x4000
  v_mul_f32 v150, s83, v150
  v_mul_f32 v151, s83, v151
  v_mfma_f32_16x16x32_bf16 v[248:251], a[208:211], a[184:187], v[248:251]
  s_waitcnt lgkmcnt(6)
  buffer_load_dwordx4 v2, s[24:27], s98 offen offset:0 sc1 lds
  v_mfma_f32_16x16x32_bf16 v[252:255], a[216:219], a[184:187], v[252:255]
  s_waitcnt lgkmcnt(4)
  v_mul_f32 v212, s83, v212
  v_mul_f32 v213, s83, v213
  v_mfma_f32_16x16x32_bf16 v[252:255], a[220:223], a[188:191], v[252:255]
  v_mul_f32 v214, s83, v214
  v_mul_f32 v215, s83, v215
  v_mfma_f32_16x16x32_bf16 v[220:223], a[220:223], a[180:183], v[220:223]
  buffer_load_dwordx4 v2, s[24:27], s98 offen offset:1024 sc1 lds
  v_mfma_f32_16x16x32_bf16 v[220:223], a[216:219], a[176:179], v[220:223]
  v_mul_f32 v240, s83, v240
  v_mul_f32 v241, s83, v241
  v_mfma_f32_16x16x32_bf16 v[188:191], a[216:219], a[168:171], v[188:191]
  v_mul_f32 v242, s83, v242
  v_mul_f32 v243, s83, v243
  v_mfma_f32_16x16x32_bf16 v[188:191], a[220:223], a[172:175], v[188:191]
  buffer_load_dwordx4 v2, s[24:27], s98 offen offset:2048 sc1 lds
  v_mfma_f32_16x16x32_bf16 v[156:159], a[220:223], a[164:167], v[156:159]
  v_mul_f32 v244, s83, v244
  v_mul_f32 v245, s83, v245
  v_mfma_f32_16x16x32_bf16 v[156:159], a[216:219], a[160:163], v[156:159]
  v_mul_f32 v246, s83, v246
  v_mul_f32 v247, s83, v247
  buffer_load_dwordx4 v2, s[24:27], s98 offen offset:3072 sc1 lds
L_attn:
  ds_read_b128 a[176:179], v4 offset:4096
  ds_read_b128 a[180:183], v4 offset:5120
  ds_read_b128 a[184:187], v4 offset:6144
  ds_read_b128 a[188:191], v4 offset:7168
  ds_read_b128 a[192:195], v4 offset:8192
  ds_read_b128 a[196:199], v4 offset:9216
  ds_read_b128 a[200:203], v4 offset:10240
  ds_read_b128 a[204:207], v4 offset:11264
  ds_read_b128 a[208:211], v4 offset:12288
  ds_read_b128 a[212:215], v4 offset:13312
  ds_read_b128 a[216:219], v4 offset:14336
  ds_read_b128 a[220:223], v4 offset:15360
  s_mov_b32 s3, 0x80000
  buffer_store_dwordx4 v[72:75], v12, s[16:19], s3 offen offset:2048 sc1
  v_cvt_pk_bf16_f32 v128, v128, v129
  s_mov_b32 s3, 0x81000
  v_cvt_pk_bf16_f32 v129, v130, v131
  v_cvt_pk_bf16_f32 v130, v132, v133
  v_cvt_pk_bf16_f32 v131, v134, v135
  v_cvt_pk_bf16_f32 v132, v136, v137
  v_cvt_pk_bf16_f32 v133, v138, v139
  s_waitcnt lgkmcnt(15)
  v_mfma_f32_16x16x32_bf16 v[64:67], a[224:227], v[128:131], v[24:27]
  s_cmp_eq_u32 s30, 0
  v_cvt_pk_bf16_f32 v134, v140, v141
  v_cvt_pk_bf16_f32 v135, v142, v143
  v_cvt_pk_bf16_f32 v136, v144, v145
  v_cvt_pk_bf16_f32 v137, v146, v147
  s_waitcnt lgkmcnt(14)
  v_mfma_f32_16x16x32_bf16 v[64:67], a[228:231], v[132:135], v[64:67]
  s_cselect_b64 s[0:1], s[40:41], -1
  v_cvt_pk_bf16_f32 v138, v148, v149
  v_cvt_pk_bf16_f32 v139, v150, v151
  v_cvt_pk_bf16_f32 v140, v152, v153
  v_cvt_pk_bf16_f32 v141, v154, v155
  s_waitcnt lgkmcnt(13)
  v_mfma_f32_16x16x32_bf16 v[64:67], a[232:235], v[136:139], v[64:67]
  s_cmp_eq_u32 s30, 0
  v_cvt_pk_bf16_f32 v142, v156, v157
  v_cvt_pk_bf16_f32 v143, v158, v159
  v_cvt_pk_bf16_f32 v144, v160, v161
  v_cvt_pk_bf16_f32 v145, v162, v163
  s_waitcnt lgkmcnt(12)
  v_mfma_f32_16x16x32_bf16 v[64:67], a[236:239], v[140:143], v[64:67]
  s_cselect_b64 s[66:67], s[42:43], -1
  v_cvt_pk_bf16_f32 v146, v164, v165
  v_cvt_pk_bf16_f32 v147, v166, v167
  v_cvt_pk_bf16_f32 v148, v168, v169
  v_cvt_pk_bf16_f32 v149, v170, v171
  v_mfma_f32_16x16x32_bf16 v[80:83], a[224:227], v[144:147], 0
  s_cmp_eq_u32 s30, 0
  v_cvt_pk_bf16_f32 v150, v172, v173
  v_cvt_pk_bf16_f32 v151, v174, v175
  v_cvt_pk_bf16_f32 v152, v176, v177
  v_cvt_pk_bf16_f32 v153, v178, v179
  v_mfma_f32_16x16x32_bf16 v[80:83], a[228:231], v[148:151], v[80:83]
  buffer_store_dwordx4 v[88:91], v12, s[16:19], s3 offen offset:2048 sc1
  v_cvt_pk_bf16_f32 v154, v180, v181
  s_mov_b32 s3, 0x81000
  v_cvt_pk_bf16_f32 v155, v182, v183
  v_cvt_pk_bf16_f32 v156, v184, v185
  v_cvt_pk_bf16_f32 v157, v186, v187
  v_mfma_f32_16x16x32_bf16 v[80:83], a[232:235], v[152:155], v[80:83]
  s_mov_b32 s98, 0x18000
  v_cvt_pk_bf16_f32 v158, v188, v189
  v_cvt_pk_bf16_f32 v159, v190, v191
  v_cvt_pk_bf16_f32 v160, v192, v193
  v_cvt_pk_bf16_f32 v161, v194, v195
  v_mfma_f32_16x16x32_bf16 v[80:83], a[236:239], v[156:159], v[80:83]
  v_cvt_pk_bf16_f32 v162, v196, v197
  v_cvt_pk_bf16_f32 v163, v198, v199
  v_cvt_pk_bf16_f32 v164, v200, v201
  v_cvt_pk_bf16_f32 v165, v202, v203
  v_mfma_f32_16x16x32_bf16 v[96:99], a[224:227], v[160:163], 0
  v_cvt_pk_bf16_f32 v166, v204, v205
  v_cvt_pk_bf16_f32 v167, v206, v207
  v_cvt_pk_bf16_f32 v168, v208, v209
  v_cvt_pk_bf16_f32 v169, v210, v211
  v_mfma_f32_16x16x32_bf16 v[96:99], a[228:231], v[164:167], v[96:99]
  v_cvt_pk_bf16_f32 v170, v212, v213
  v_cvt_pk_bf16_f32 v171, v214, v215
  v_cvt_pk_bf16_f32 v172, v216, v217
  v_cvt_pk_bf16_f32 v173, v218, v219
  v_mfma_f32_16x16x32_bf16 v[96:99], a[232:235], v[168:171], v[96:99]
  v_cvt_pk_bf16_f32 v174, v220, v221
  v_cvt_pk_bf16_f32 v175, v222, v223
  v_cvt_pk_bf16_f32 v176, v224, v225
  v_cvt_pk_bf16_f32 v177, v226, v227
  v_mfma_f32_16x16x32_bf16 v[96:99], a[236:239], v[172:175], v[96:99]
  v_cvt_pk_bf16_f32 v178, v228, v229
  buffer_store_dwordx4 v[104:107], v11, s[16:19], s3 offen offset:0 sc1
  v_cvt_pk_bf16_f32 v179, v230, v231
  s_mov_b32 s3, 0x83000
  v_cvt_pk_bf16_f32 v180, v232, v233
  v_mfma_f32_16x16x32_bf16 v[112:115], a[224:227], v[176:179], 0
  v_cvt_pk_bf16_f32 v181, v234, v235
  v_cvt_pk_bf16_f32 v182, v236, v237
  v_cvt_pk_bf16_f32 v183, v238, v239
  v_cvt_pk_bf16_f32 v184, v240, v241
  v_cvt_pk_bf16_f32 v185, v242, v243
  v_mfma_f32_16x16x32_bf16 v[112:115], a[228:231], v[180:183], v[112:115]
  v_cvt_pk_bf16_f32 v186, v244, v245
  v_cvt_pk_bf16_f32 v187, v246, v247
  v_cvt_pk_bf16_f32 v188, v248, v249
  v_cvt_pk_bf16_f32 v189, v250, v251
  v_mfma_f32_16x16x32_bf16 v[112:115], a[232:235], v[184:187], v[112:115]
  v_cvt_pk_bf16_f32 v190, v252, v253
  v_cvt_pk_bf16_f32 v191, v254, v255
  v_max3_f32 v14, v64, v65, v66
  v_max_f32 v14, v14, v67
  v_mfma_f32_16x16x32_bf16 v[112:115], a[236:239], v[188:191], v[112:115]
  v_mov_b32 v18, v14
  v_max3_f32 v15, v80, v81, v82
  v_max_f32 v15, v15, v83
  v_permlane32_swap_b32 v18, v14
  v_max_f32 v14, v14, v18
  v_mov_b32 v18, v14
  v_mov_b32 v19, v15
  v_max3_f32 v16, v96, v97, v98
  v_permlane16_swap_b32 v18, v14
  v_max_f32 v14, v14, v18
  v_sub_f32 v18, 0, v14
  v_mov_b32 v24, v18
  v_mov_b32 v25, v18
  v_mov_b32 v26, v18
  buffer_store_dwordx4 v[120:123], v11, s[16:19], s3 offen offset:0 sc1
  v_mov_b32 v27, v18
  s_mov_b32 s3, 0x80000
  v_cndmask_b32 v28, v13, v18, s[0:1]
  v_cndmask_b32 v29, v13, v18, s[66:67]
  s_cselect_b64 s[0:1], s[44:45], -1
  v_cndmask_b32 v30, v13, v18, s[0:1]
  s_cmp_eq_u32 s30, 0
  s_cselect_b64 s[66:67], s[46:47], -1
  v_cndmask_b32 v31, v13, v18, s[66:67]
  s_cmp_eq_u32 s30, 0
  s_cselect_b64 s[0:1], s[48:49], -1
  s_waitcnt lgkmcnt(11)
  v_mfma_f32_16x16x32_bf16 v[68:71], a[176:179], v[128:131], v[28:31]
  s_waitcnt lgkmcnt(10)
  s_cmp_eq_u32 s30, 0
  v_cndmask_b32 v32, v13, v18, s[0:1]
  s_cselect_b64 s[66:67], s[50:51], -1
  v_mfma_f32_16x16x32_bf16 v[68:71], a[180:183], v[132:135], v[68:71]
  s_waitcnt lgkmcnt(9)
  s_cmp_eq_u32 s30, 0
  v_cndmask_b32 v33, v13, v18, s[66:67]
  s_cselect_b64 s[0:1], s[52:53], -1
  v_mfma_f32_16x16x32_bf16 v[68:71], a[184:187], v[136:139], v[68:71]
  s_waitcnt lgkmcnt(8)
  s_cmp_eq_u32 s30, 0
  v_cndmask_b32 v34, v13, v18, s[0:1]
  s_cselect_b64 s[66:67], s[54:55], -1
  v_mfma_f32_16x16x32_bf16 v[68:71], a[188:191], v[140:143], v[68:71]
  s_cmp_eq_u32 s30, 0
  v_cndmask_b32 v35, v13, v18, s[66:67]
  s_cselect_b64 s[0:1], s[56:57], -1
  v_cndmask_b32 v36, v13, v18, s[0:1]
  s_waitcnt lgkmcnt(7)
  v_mfma_f32_16x16x32_bf16 v[72:75], a[192:195], v[128:131], v[32:35]
  s_waitcnt lgkmcnt(6)
  s_cmp_eq_u32 s30, 0
  s_cselect_b64 s[66:67], s[58:59], -1
  v_cndmask_b32 v37, v13, v18, s[66:67]
  v_mfma_f32_16x16x32_bf16 v[72:75], a[196:199], v[132:135], v[72:75]
  s_waitcnt lgkmcnt(5)
  s_cmp_eq_u32 s30, 0
  s_cselect_b64 s[0:1], s[60:61], -1
  v_cndmask_b32 v38, v13, v18, s[0:1]
  v_mfma_f32_16x16x32_bf16 v[72:75], a[200:203], v[136:139], v[72:75]
  s_waitcnt lgkmcnt(4)
  buffer_store_dwordx4 v[76:79], v12, s[16:19], s3 offen offset:3072 sc1
  v_mfma_f32_16x16x32_bf16 v[72:75], a[204:207], v[140:143], v[72:75]
  s_mov_b32 s3, 0x81000
  s_cmp_eq_u32 s30, 0
  s_cselect_b64 s[66:67], s[62:63], -1
  v_cndmask_b32 v39, v13, v18, s[66:67]
  v_permlane32_swap_b32 v19, v15
  v_max_f32 v15, v15, v19
  s_waitcnt lgkmcnt(3)
  v_mfma_f32_16x16x32_bf16 v[76:79], a[208:211], v[128:131], v[36:39]
  s_waitcnt lgkmcnt(2)
  s_add_u32 m0, s97, 0x1c000
  v_mov_b32 v19, v15
  v_max_f32 v16, v16, v99
  v_mfma_f32_16x16x32_bf16 v[76:79], a[212:215], v[132:135], v[76:79]
  s_waitcnt lgkmcnt(1)
  v_permlane16_swap_b32 v19, v15
  v_max_f32 v15, v15, v19
  v_mfma_f32_16x16x32_bf16 v[76:79], a[216:219], v[136:139], v[76:79]
  s_waitcnt lgkmcnt(0)
  v_sub_f32 v56, 0, v15
  v_sub_f32 v57, 0, v15
  v_mfma_f32_16x16x32_bf16 v[76:79], a[220:223], v[140:143], v[76:79]
  v_sub_f32 v58, 0, v15
  v_sub_f32 v59, 0, v15
  v_mov_b32 v20, v16
  v_max3_f32 v17, v112, v113, v114
  v_mfma_f32_16x16x32_bf16 v[84:87], a[176:179], v[144:147], v[56:59]
  v_permlane32_swap_b32 v20, v16
  v_max_f32 v16, v16, v20
  v_mfma_f32_16x16x32_bf16 v[84:87], a[180:183], v[148:151], v[84:87]
  v_mov_b32 v20, v16
  v_max_f32 v17, v17, v115
  v_mfma_f32_16x16x32_bf16 v[84:87], a[184:187], v[152:155], v[84:87]
  v_permlane16_swap_b32 v20, v16
  v_max_f32 v16, v16, v20
  v_mfma_f32_16x16x32_bf16 v[84:87], a[188:191], v[156:159], v[84:87]
  buffer_store_dwordx4 v[92:95], v12, s[16:19], s3 offen offset:3072 sc1
  v_mfma_f32_16x16x32_bf16 v[88:91], a[192:195], v[144:147], v[56:59]
  s_mov_b32 s3, 0x81000
  v_sub_f32 v40, 0, v16
  v_sub_f32 v41, 0, v16
  v_mfma_f32_16x16x32_bf16 v[88:91], a[196:199], v[148:151], v[88:91]
  v_sub_f32 v42, 0, v16
  v_sub_f32 v43, 0, v16
  v_mfma_f32_16x16x32_bf16 v[88:91], a[200:203], v[152:155], v[88:91]
  v_sub_f32 v44, 0, v16
  v_sub_f32 v45, 0, v16
  v_mfma_f32_16x16x32_bf16 v[88:91], a[204:207], v[156:159], v[88:91]
  v_sub_f32 v46, 0, v16
  v_sub_f32 v47, 0, v16
  v_mfma_f32_16x16x32_bf16 v[92:95], a[208:211], v[144:147], v[56:59]
  v_sub_f32 v48, 0, v16
  v_sub_f32 v49, 0, v16
  v_mfma_f32_16x16x32_bf16 v[92:95], a[212:215], v[148:151], v[92:95]
  v_sub_f32 v50, 0, v16
  v_sub_f32 v51, 0, v16
  v_mfma_f32_16x16x32_bf16 v[92:95], a[216:219], v[152:155], v[92:95]
  v_sub_f32 v52, 0, v16
  v_sub_f32 v53, 0, v16
  v_mfma_f32_16x16x32_bf16 v[92:95], a[220:223], v[156:159], v[92:95]
  v_sub_f32 v54, 0, v16
  v_sub_f32 v55, 0, v16
  v_mfma_f32_16x16x32_bf16 v[100:103], a[176:179], v[160:163], v[44:47]
  v_mov_b32 v21, v17
  v_sub_f32 v64, v64, v14
  v_mfma_f32_16x16x32_bf16 v[100:103], a[180:183], v[164:167], v[100:103]
  buffer_store_dwordx4 v[108:111], v11, s[16:19], s3 offen offset:1024 sc1
  v_mfma_f32_16x16x32_bf16 v[100:103], a[184:187], v[168:171], v[100:103]
  s_mov_b32 s3, 0x83000
  v_permlane32_swap_b32 v21, v17
  v_max_f32 v17, v17, v21
  v_mfma_f32_16x16x32_bf16 v[100:103], a[188:191], v[172:175], v[100:103]
  v_mov_b32 v21, v17
  v_sub_f32 v65, v65, v14
  v_mfma_f32_16x16x32_bf16 v[104:107], a[192:195], v[160:163], v[48:51]
  v_permlane16_swap_b32 v21, v17
  v_max_f32 v17, v17, v21
  v_mfma_f32_16x16x32_bf16 v[104:107], a[196:199], v[164:167], v[104:107]
  v_sub_f32 v60, 0, v17
  v_sub_f32 v61, 0, v17
  v_mfma_f32_16x16x32_bf16 v[104:107], a[200:203], v[168:171], v[104:107]
  v_sub_f32 v62, 0, v17
  v_sub_f32 v63, 0, v17
  v_mfma_f32_16x16x32_bf16 v[104:107], a[204:207], v[172:175], v[104:107]
  v_sub_f32 v66, v66, v14
  v_sub_f32 v67, v67, v14
  v_mfma_f32_16x16x32_bf16 v[108:111], a[208:211], v[160:163], v[52:55]
  v_exp_f32 v64, v64
  v_mfma_f32_16x16x32_bf16 v[108:111], a[212:215], v[164:167], v[108:111]
  v_exp_f32 v65, v65
  v_mfma_f32_16x16x32_bf16 v[108:111], a[216:219], v[168:171], v[108:111]
  v_exp_f32 v66, v66
  v_mfma_f32_16x16x32_bf16 v[108:111], a[220:223], v[172:175], v[108:111]
  buffer_store_dwordx4 v[124:127], v11, s[16:19], s3 offen offset:1024 sc1
  v_mfma_f32_16x16x32_bf16 v[116:119], a[176:179], v[176:179], v[60:63]
  s_waitcnt vmcnt(19) lgkmcnt(0)
  s_barrier
  ds_read_b128 a[160:163], v4 offset:16384
  v_mfma_f32_16x16x32_bf16 v[116:119], a[180:183], v[180:183], v[116:119]
  ds_read_b128 a[164:167], v4 offset:17408
  ds_read_b128 a[168:171], v4 offset:18432
  v_mfma_f32_16x16x32_bf16 v[116:119], a[184:187], v[184:187], v[116:119]
  ds_read_b128 a[172:175], v4 offset:19456
  v_exp_f32 v67, v67
  v_mfma_f32_16x16x32_bf16 v[116:119], a[188:191], v[188:191], v[116:119]
  ds_read_b128 a[176:179], v4 offset:20480
  v_cvt_pk_bf16_f32 v192, v64, v65
  v_mfma_f32_16x16x32_bf16 v[120:123], a[192:195], v[176:179], v[60:63]
  ds_read_b128 a[180:183], v4 offset:21504
  v_cvt_pk_bf16_f32 v193, v66, v67
  v_mfma_f32_16x16x32_bf16 v[120:123], a[196:199], v[180:183], v[120:123]
  ds_read_b128 a[184:187], v4 offset:22528
  v_exp_f32 v68, v68
  v_mfma_f32_16x16x32_bf16 v[120:123], a[200:203], v[184:187], v[120:123]
  ds_read_b128 a[188:191], v4 offset:23552
  v_exp_f32 v69, v69
  v_mfma_f32_16x16x32_bf16 v[120:123], a[204:207], v[188:191], v[120:123]
  v_exp_f32 v70, v70
  v_mfma_f32_16x16x32_bf16 v[124:127], a[208:211], v[176:179], v[60:63]
  v_exp_f32 v71, v71
  v_mfma_f32_16x16x32_bf16 v[124:127], a[212:215], v[180:183], v[124:127]
  buffer_load_dwordx4 v2, s[24:27], s98 offen offset:0 sc1 lds
  v_mfma_f32_16x16x32_bf16 v[124:127], a[216:219], v[184:187], v[124:127]
  v_cvt_pk_bf16_f32 v194, v68, v69
  v_cvt_pk_bf16_f32 v195, v70, v71
  v_mfma_f32_16x16x32_bf16 v[124:127], a[220:223], v[188:191], v[124:127]
  v_exp_f32 v72, v72
  v_exp_f32 v73, v73
  v_exp_f32 v74, v74
  v_exp_f32 v75, v75
  v_cvt_pk_bf16_f32 v196, v72, v73
  v_cvt_pk_bf16_f32 v197, v74, v75
  v_exp_f32 v76, v76
  v_exp_f32 v77, v77
  v_exp_f32 v78, v78
  v_exp_f32 v79, v79
  v_cvt_pk_bf16_f32 v198, v76, v77
  v_cvt_pk_bf16_f32 v199, v78, v79
  v_sub_f32 v80, v80, v15
  v_sub_f32 v81, v81, v15
  v_sub_f32 v82, v82, v15
  v_sub_f32 v83, v83, v15
  v_exp_f32 v80, v80
  v_exp_f32 v81, v81
  v_exp_f32 v82, v82
  v_exp_f32 v83, v83
  buffer_load_dwordx4 v2, s[24:27], s98 offen offset:1024 sc1 lds
  v_cvt_pk_bf16_f32 v200, v80, v81
  v_cvt_pk_bf16_f32 v201, v82, v83
  v_exp_f32 v84, v84
  v_exp_f32 v85, v85
  v_exp_f32 v86, v86
  v_exp_f32 v87, v87
  v_cvt_pk_bf16_f32 v202, v84, v85
  v_cvt_pk_bf16_f32 v203, v86, v87
  v_exp_f32 v88, v88
  v_exp_f32 v89, v89
  v_exp_f32 v90, v90
  v_exp_f32 v91, v91
  v_cvt_pk_bf16_f32 v204, v88, v89
  v_cvt_pk_bf16_f32 v205, v90, v91
  v_exp_f32 v92, v92
  v_exp_f32 v93, v93
  v_exp_f32 v94, v94
  v_exp_f32 v95, v95
  v_cvt_pk_bf16_f32 v206, v92, v93
  v_cvt_pk_bf16_f32 v207, v94, v95
  v_sub_f32 v96, v96, v16
  v_sub_f32 v97, v97, v16
  v_sub_f32 v98, v98, v16
  v_sub_f32 v99, v99, v16
  v_exp_f32 v96, v96
  buffer_load_dwordx4 v2, s[24:27], s98 offen offset:2048 sc1 lds
  v_exp_f32 v97, v97
  v_exp_f32 v98, v98
  v_exp_f32 v99, v99
  v_cvt_pk_bf16_f32 v208, v96, v97
  v_cvt_pk_bf16_f32 v209, v98, v99
  v_exp_f32 v100, v100
  v_exp_f32 v101, v101
  v_exp_f32 v102, v102
  v_exp_f32 v103, v103
  v_cvt_pk_bf16_f32 v210, v100, v101
  v_cvt_pk_bf16_f32 v211, v102, v103
  v_exp_f32 v104, v104
  v_exp_f32 v105, v105
  v_exp_f32 v106, v106
  v_exp_f32 v107, v107
  v_cvt_pk_bf16_f32 v212, v104, v105
  v_cvt_pk_bf16_f32 v213, v106, v107
  v_exp_f32 v108, v108
  v_exp_f32 v109, v109
  v_exp_f32 v110, v110
  v_exp_f32 v111, v111
  v_cvt_pk_bf16_f32 v214, v108, v109
  v_cvt_pk_bf16_f32 v215, v110, v111
  buffer_load_dwordx4 v2, s[24:27], s98 offen offset:3072 sc1 lds
  s_mov_b32 s98, 0x14000
  s_add_u32 m0, s97, 0x8000
  v_sub_f32 v112, v112, v17
  v_sub_f32 v113, v113, v17
  v_sub_f32 v114, v114, v17
  v_sub_f32 v115, v115, v17
  v_exp_f32 v112, v112
  v_exp_f32 v113, v113
  v_exp_f32 v114, v114
  v_exp_f32 v115, v115
  v_cvt_pk_bf16_f32 v216, v112, v113
  v_cvt_pk_bf16_f32 v217, v114, v115
  v_exp_f32 v116, v116
  v_exp_f32 v117, v117
  v_exp_f32 v118, v118
  v_exp_f32 v119, v119
  v_cvt_pk_bf16_f32 v218, v116, v117
  v_cvt_pk_bf16_f32 v219, v118, v119
  v_exp_f32 v120, v120
  v_exp_f32 v121, v121
  v_exp_f32 v122, v122
  v_exp_f32 v123, v123
  v_cvt_pk_bf16_f32 v220, v120, v121
  v_cvt_pk_bf16_f32 v221, v122, v123
  v_mov_b32 v16, v24
  v_mov_b32 v17, v24
  buffer_load_dwordx4 v2, s[24:27], s98 offen offset:0 sc1 lds
  v_mov_b32 v18, v24
  v_mov_b32 v19, v24
  v_and_b32 v20, 1, v1
  v_sub_u32 v20, 0, v20
  v_and_b32 v20, 0xaaaaaaaa, v20
  v_or_b32 v20, 0x44444444, v20
  buffer_load_dwordx4 v2, s[24:27], s98 offen offset:1024 sc1 lds
  buffer_load_dwordx4 v2, s[24:27], s98 offen offset:2048 sc1 lds
  buffer_load_dwordx4 v2, s[24:27], s98 offen offset:3072 sc1 lds
  s_mov_b32 s98, 0x18000
  s_waitcnt lgkmcnt(7)
  s_mov_b32 s31, s30
  s_cmp_lt_u32 s31, 2
  s_cbranch_scc1 L_last4
.p2align 6
L_loop4:
  v_mfma_f32_16x16x32_bf16 v[112:115], a[160:163], v[176:179], v[60:63]
  s_waitcnt lgkmcnt(6)
  v_exp_f32 v124, v124
  v_mfma_f32_16x16x32_bf16 v[112:115], a[164:167], v[180:183], v[112:115]
  s_waitcnt lgkmcnt(5)
  v_exp_f32 v125, v125
  v_mfma_f32_16x16x32_bf16 v[112:115], a[168:171], v[184:187], v[112:115]
  s_waitcnt lgkmcnt(4)
  ds_read_b128 a[192:195], v4 offset:24576
  v_cvt_pk_bf16_f32 v222, v124, v125
  v_mfma_f32_16x16x32_bf16 v[112:115], a[172:175], v[188:191], v[112:115]
  s_add_u32 m0, s100, 0
  v_exp_f32 v126, v126
  v_mfma_f32_16x16x32_bf16 v[96:99], a[172:175], v[172:175], v[40:43]
  s_add_u32 s98, s98, 0x8000
  v_exp_f32 v127, v127
  v_mfma_f32_16x16x32_bf16 v[96:99], a[168:171], v[168:171], v[96:99]
  buffer_load_dwordx4 v2, s[24:27], s98 offen offset:0 sc1 lds
  v_mfma_f32_16x16x32_bf16 v[96:99], a[164:167], v[164:167], v[96:99]
  ds_read_b128 a[196:199], v4 offset:25600
  v_cvt_pk_bf16_f32 v223, v126, v127
  v_mfma_f32_16x16x32_bf16 v[96:99], a[160:163], v[160:163], v[96:99]
  v_exp_f32 v112, v112
  v_mfma_f32_16x16x32_bf16 v[80:83], a[160:163], v[144:147], v[56:59]
  v_exp_f32 v113, v113
  v_mfma_f32_16x16x32_bf16 v[80:83], a[164:167], v[148:151], v[80:83]
  ds_read_b128 a[200:203], v4 offset:26624
  v_cvt_pk_bf16_f32 v248, v112, v113
  v_mfma_f32_16x16x32_bf16 v[80:83], a[168:171], v[152:155], v[80:83]
  buffer_load_dwordx4 v2, s[24:27], s98 offen offset:1024 sc1 lds
  v_mfma_f32_16x16x32_bf16 v[80:83], a[172:175], v[156:159], v[80:83]
  v_exp_f32 v114, v114
  v_mfma_f32_16x16x32_bf16 v[64:67], a[172:175], v[140:143], v[16:19]
  v_exp_f32 v115, v115
  v_mfma_f32_16x16x32_bf16 v[64:67], a[168:171], v[136:139], v[64:67]
  ds_read_b128 a[204:207], v4 offset:27648
  v_cvt_pk_bf16_f32 v249, v114, v115
  v_mfma_f32_16x16x32_bf16 v[64:67], a[164:167], v[132:135], v[64:67]
  v_exp_f32 v96, v96
  v_mfma_f32_16x16x32_bf16 v[64:67], a[160:163], v[128:131], v[64:67]
  s_waitcnt lgkmcnt(7)
  buffer_load_dwordx4 v2, s[24:27], s98 offen offset:2048 sc1 lds
  v_mfma_f32_16x16x32_bf16 v[68:71], a[176:179], v[128:131], v[16:19]
  s_waitcnt lgkmcnt(6)
  v_exp_f32 v97, v97
  v_mfma_f32_16x16x32_bf16 v[68:71], a[180:183], v[132:135], v[68:71]
  s_waitcnt lgkmcnt(5)
  ds_read_b128 a[208:211], v4 offset:28672
  v_cvt_pk_bf16_f32 v240, v96, v97
  v_mfma_f32_16x16x32_bf16 v[68:71], a[184:187], v[136:139], v[68:71]
  s_waitcnt lgkmcnt(5)
  v_exp_f32 v98, v98
  v_mfma_f32_16x16x32_bf16 v[68:71], a[188:191], v[140:143], v[68:71]
  v_exp_f32 v99, v99
  v_mfma_f32_16x16x32_bf16 v[84:87], a[188:191], v[156:159], v[56:59]
  buffer_load_dwordx4 v2, s[24:27], s98 offen offset:3072 sc1 lds
  v_mfma_f32_16x16x32_bf16 v[84:87], a[184:187], v[152:155], v[84:87]
  ds_read_b128 a[212:215], v4 offset:29696
  v_cvt_pk_bf16_f32 v241, v98, v99
  v_mfma_f32_16x16x32_bf16 v[84:87], a[180:183], v[148:151], v[84:87]
  v_exp_f32 v80, v80
  v_mfma_f32_16x16x32_bf16 v[84:87], a[176:179], v[144:147], v[84:87]
  v_exp_f32 v81, v81
  v_mfma_f32_16x16x32_bf16 v[100:103], a[176:179], v[160:163], v[44:47]
  ds_read_b128 a[216:219], v4 offset:30720
  v_cvt_pk_bf16_f32 v232, v80, v81
  v_mfma_f32_16x16x32_bf16 v[100:103], a[180:183], v[164:167], v[100:103]
  buffer_load_dword v12, v22, s[8:11], s12 offen
  v_mfma_f32_16x16x32_bf16 v[100:103], a[184:187], v[168:171], v[100:103]
  s_add_u32 m0, s101, 16384
  v_exp_f32 v82, v82
  v_mfma_f32_16x16x32_bf16 v[100:103], a[188:191], v[172:175], v[100:103]
  s_add_u32 s99, s99, 0x8000
  v_exp_f32 v83, v83
  v_mfma_f32_16x16x32_bf16 v[116:119], a[188:191], v[188:191], v[60:63]
  s_add_u32 s12, s12, s13
  ds_read_b128 a[220:223], v4 offset:31744
  v_cvt_pk_bf16_f32 v233, v82, v83
  v_mfma_f32_16x16x32_bf16 v[116:119], a[184:187], v[184:187], v[116:119]
  s_sub_u32 s13, s13, 0x4000
  v_exp_f32 v64, v64
  v_mfma_f32_16x16x32_bf16 v[116:119], a[180:183], v[180:183], v[116:119]
  v_exp_f32 v65, v65
  v_mfma_f32_16x16x32_bf16 v[116:119], a[176:179], v[176:179], v[116:119]
  s_waitcnt lgkmcnt(7)
  ds_read_b128 a[224:227], v5 offset:0
  v_cvt_pk_bf16_f32 v224, v64, v65
  v_mfma_f32_16x16x32_bf16 v[120:123], a[192:195], v[176:179], v[60:63]
  s_waitcnt lgkmcnt(7)
  v_exp_f32 v66, v66
  v_mfma_f32_16x16x32_bf16 v[120:123], a[196:199], v[180:183], v[120:123]
  s_waitcnt lgkmcnt(6)
  v_exp_f32 v67, v67
  v_mfma_f32_16x16x32_bf16 v[120:123], a[200:203], v[184:187], v[120:123]
  s_waitcnt lgkmcnt(5)
  ds_read_b128 a[228:231], v5 offset:1024
  v_cvt_pk_bf16_f32 v225, v66, v67
  v_mfma_f32_16x16x32_bf16 v[120:123], a[204:207], v[188:191], v[120:123]
  v_exp_f32 v68, v68
  v_mfma_f32_16x16x32_bf16 v[104:107], a[204:207], v[172:175], v[48:51]
  v_exp_f32 v69, v69
  v_mfma_f32_16x16x32_bf16 v[104:107], a[200:203], v[168:171], v[104:107]
  ds_read_b128 a[232:235], v5 offset:2048
  v_cvt_pk_bf16_f32 v226, v68, v69
  v_mfma_f32_16x16x32_bf16 v[104:107], a[196:199], v[164:167], v[104:107]
  v_exp_f32 v70, v70
  v_mfma_f32_16x16x32_bf16 v[104:107], a[192:195], v[160:163], v[104:107]
  v_exp_f32 v71, v71
  v_mfma_f32_16x16x32_bf16 v[88:91], a[192:195], v[144:147], v[56:59]
  ds_read_b128 a[236:239], v5 offset:3072
  v_cvt_pk_bf16_f32 v227, v70, v71
  v_mfma_f32_16x16x32_bf16 v[88:91], a[196:199], v[148:151], v[88:91]
  v_exp_f32 v84, v84
  v_mfma_f32_16x16x32_bf16 v[88:91], a[200:203], v[152:155], v[88:91]
  v_exp_f32 v85, v85
  v_mfma_f32_16x16x32_bf16 v[88:91], a[204:207], v[156:159], v[88:91]
L_pad10:
  s_cbranch_execz L_pad14
  ds_read_b128 a[240:243], v5 offset:4096
  v_cvt_pk_bf16_f32 v234, v84, v85
  v_mfma_f32_16x16x32_bf16 v[72:75], a[204:207], v[140:143], v[16:19]
  v_exp_f32 v86, v86
  v_mfma_f32_16x16x32_bf16 v[72:75], a[200:203], v[136:139], v[72:75]
  v_exp_f32 v87, v87
  v_mfma_f32_16x16x32_bf16 v[72:75], a[196:199], v[132:135], v[72:75]
  ds_read_b128 a[244:247], v5 offset:5120
  v_cvt_pk_bf16_f32 v235, v86, v87
  v_mfma_f32_16x16x32_bf16 v[72:75], a[192:195], v[128:131], v[72:75]
  s_waitcnt lgkmcnt(9)
  v_exp_f32 v100, v100
  v_mfma_f32_16x16x32_bf16 v[76:79], a[208:211], v[128:131], v[16:19]
  s_waitcnt lgkmcnt(8)
  v_exp_f32 v101, v101
  v_mfma_f32_16x16x32_bf16 v[76:79], a[212:215], v[132:135], v[76:79]
  s_waitcnt lgkmcnt(7)
  ds_read_b128 a[248:251], v5 offset:6144
  v_cvt_pk_bf16_f32 v242, v100, v101
  v_mfma_f32_16x16x32_bf16 v[76:79], a[216:219], v[136:139], v[76:79]
  s_waitcnt lgkmcnt(7)
  v_exp_f32 v102, v102
  v_mfma_f32_16x16x32_bf16 v[76:79], a[220:223], v[140:143], v[76:79]
  v_exp_f32 v103, v103
  v_mfma_f32_16x16x32_bf16 v[92:95], a[220:223], v[156:159], v[56:59]
  ds_read_b128 a[252:255], v5 offset:7168
  v_cvt_pk_bf16_f32 v243, v102, v103
  v_mfma_f32_16x16x32_bf16 v[92:95], a[216:219], v[152:155], v[92:95]
  v_exp_f32 v116, v116
  v_mfma_f32_16x16x32_bf16 v[92:95], a[212:215], v[148:151], v[92:95]
  v_exp_f32 v117, v117
  v_mfma_f32_16x16x32_bf16 v[92:95], a[208:211], v[144:147], v[92:95]
  v_cvt_pk_bf16_f32 v250, v116, v117
  v_xor_b32 v4, 0x8000, v4
  v_mfma_f32_16x16x32_bf16 v[108:111], a[208:211], v[160:163], v[52:55]
  v_exp_f32 v118, v118
  v_mfma_f32_16x16x32_bf16 v[108:111], a[212:215], v[164:167], v[108:111]
  v_exp_f32 v119, v119
  v_mfma_f32_16x16x32_bf16 v[108:111], a[216:219], v[168:171], v[108:111]
  v_cvt_pk_bf16_f32 v251, v118, v119
  v_mfma_f32_16x16x32_bf16 v[108:111], a[220:223], v[172:175], v[108:111]
  v_exp_f32 v120, v120
  v_mfma_f32_16x16x32_bf16 v[124:127], a[220:223], v[188:191], v[60:63]
  v_exp_f32 v121, v121
  v_mfma_f32_16x16x32_bf16 v[124:127], a[216:219], v[184:187], v[124:127]
  v_cvt_pk_bf16_f32 v252, v120, v121
  v_mfma_f32_16x16x32_bf16 v[124:127], a[212:215], v[180:183], v[124:127]
  v_exp_f32 v122, v122
  v_mfma_f32_16x16x32_bf16 v[124:127], a[208:211], v[176:179], v[124:127]
  v_exp_f32 v123, v123
  v_smfmac_f32_16x16x64_bf16 a[128:131], a[144:147], v[192:199], v20
  v_cvt_pk_bf16_f32 v253, v122, v123
  v_smfmac_f32_16x16x64_bf16 a[132:135], a[144:147], v[200:207], v20
  v_smfmac_f32_16x16x64_bf16 a[136:139], a[144:147], v[208:215], v20
  v_smfmac_f32_16x16x64_bf16 a[140:143], a[144:147], v[216:223], v20
  s_waitcnt lgkmcnt(7)
  v_mfma_f32_16x16x32_bf16 a[96:99], a[224:227], v[216:219], a[96:99]
  s_waitcnt lgkmcnt(6)
  v_exp_f32 v104, v104
  v_mfma_f32_16x16x32_bf16 a[96:99], a[228:231], v[220:223], a[96:99]
  v_exp_f32 v105, v105
  v_mfma_f32_16x16x32_bf16 a[64:67], a[228:231], v[212:215], a[64:67]
  v_cvt_pk_bf16_f32 v244, v104, v105
  v_mfma_f32_16x16x32_bf16 a[64:67], a[224:227], v[208:211], a[64:67]
  v_exp_f32 v106, v106
  v_mfma_f32_16x16x32_bf16 a[32:35], a[224:227], v[200:203], a[32:35]
  v_exp_f32 v107, v107
  v_mfma_f32_16x16x32_bf16 a[32:35], a[228:231], v[204:207], a[32:35]
  v_cvt_pk_bf16_f32 v245, v106, v107
  v_mfma_f32_16x16x32_bf16 a[0:3], a[228:231], v[196:199], a[0:3]
  v_exp_f32 v88, v88
  v_mfma_f32_16x16x32_bf16 a[0:3], a[224:227], v[192:195], a[0:3]
  s_waitcnt lgkmcnt(5)
  v_exp_f32 v89, v89
  v_mfma_f32_16x16x32_bf16 a[4:7], a[232:235], v[192:195], a[4:7]
  s_waitcnt lgkmcnt(4)
  ds_read_b128 a[224:227], v5 offset:8192
  v_cvt_pk_bf16_f32 v236, v88, v89
  v_mfma_f32_16x16x32_bf16 a[4:7], a[236:239], v[196:199], a[4:7]
  v_exp_f32 v90, v90
  v_mfma_f32_16x16x32_bf16 a[36:39], a[236:239], v[204:207], a[36:39]
  ds_read_b128 a[228:231], v5 offset:9216
  v_mfma_f32_16x16x32_bf16 a[36:39], a[232:235], v[200:203], a[36:39]
  v_exp_f32 v91, v91
  v_mfma_f32_16x16x32_bf16 a[68:71], a[232:235], v[208:211], a[68:71]
  v_cvt_pk_bf16_f32 v237, v90, v91
  v_mfma_f32_16x16x32_bf16 a[68:71], a[236:239], v[212:215], a[68:71]
  v_exp_f32 v72, v72
  v_mfma_f32_16x16x32_bf16 a[100:103], a[236:239], v[220:223], a[100:103]
  v_exp_f32 v73, v73
  v_mfma_f32_16x16x32_bf16 a[100:103], a[232:235], v[216:219], a[100:103]
  s_waitcnt lgkmcnt(5)
  ds_read_b128 a[232:235], v5 offset:10240
  v_cvt_pk_bf16_f32 v228, v72, v73
  v_mfma_f32_16x16x32_bf16 a[104:107], a[240:243], v[216:219], a[104:107]
  s_waitcnt lgkmcnt(5)
  v_exp_f32 v74, v74
  v_mfma_f32_16x16x32_bf16 a[104:107], a[244:247], v[220:223], a[104:107]
  ds_read_b128 a[236:239], v5 offset:11264
  v_mfma_f32_16x16x32_bf16 a[72:75], a[244:247], v[212:215], a[72:75]
  v_exp_f32 v75, v75
  v_mfma_f32_16x16x32_bf16 a[72:75], a[240:243], v[208:211], a[72:75]
  v_cvt_pk_bf16_f32 v229, v74, v75
  v_mfma_f32_16x16x32_bf16 a[40:43], a[240:243], v[200:203], a[40:43]
  v_exp_f32 v76, v76
  v_mfma_f32_16x16x32_bf16 a[40:43], a[244:247], v[204:207], a[40:43]
  v_exp_f32 v77, v77
  v_mfma_f32_16x16x32_bf16 a[8:11], a[244:247], v[196:199], a[8:11]
  ds_read_b128 a[244:247], v5 offset:13312
  v_cvt_pk_bf16_f32 v230, v76, v77
  v_mfma_f32_16x16x32_bf16 a[8:11], a[240:243], v[192:195], a[8:11]
  s_waitcnt vmcnt(13) lgkmcnt(6)
  v_exp_f32 v78, v78
  v_mfma_f32_16x16x32_bf16 a[12:15], a[248:251], v[192:195], a[12:15]
  s_barrier
  s_waitcnt lgkmcnt(5)
  v_mfma_f32_16x16x32_bf16 a[12:15], a[252:255], v[196:199], a[12:15]
  buffer_load_dwordx4 v2, s[24:27], s99 offen offset:0 sc1 lds
  v_mfma_f32_16x16x32_bf16 a[44:47], a[252:255], v[204:207], a[44:47]
  s_xor_b32 s101, s101, 0x8000
  ds_read_b128 a[240:243], v5 offset:12288
  v_mfma_f32_16x16x32_bf16 a[44:47], a[248:251], v[200:203], a[44:47]
  v_exp_f32 v79, v79
  v_mfma_f32_16x16x32_bf16 a[76:79], a[248:251], v[208:211], a[76:79]
  ds_read_b128 a[160:163], v4 offset:0
  v_cvt_pk_bf16_f32 v231, v78, v79
  v_mfma_f32_16x16x32_bf16 a[76:79], a[252:255], v[212:215], a[76:79]
  v_exp_f32 v92, v92
  v_mfma_f32_16x16x32_bf16 a[108:111], a[252:255], v[220:223], a[108:111]
  v_exp_f32 v93, v93
  v_mfma_f32_16x16x32_bf16 a[108:111], a[248:251], v[216:219], a[108:111]
  s_waitcnt lgkmcnt(6)
  ds_read_b128 a[248:251], v5 offset:14336
  v_cvt_pk_bf16_f32 v238, v92, v93
  v_mfma_f32_16x16x32_bf16 a[112:115], a[224:227], v[216:219], a[112:115]
  s_waitcnt lgkmcnt(6)
  v_exp_f32 v94, v94
  v_mfma_f32_16x16x32_bf16 a[112:115], a[228:231], v[220:223], a[112:115]
  buffer_load_dwordx4 v2, s[24:27], s99 offen offset:1024 sc1 lds
  v_mfma_f32_16x16x32_bf16 a[80:83], a[228:231], v[212:215], a[80:83]
  ds_read_b128 a[252:255], v5 offset:15360
  v_mfma_f32_16x16x32_bf16 a[80:83], a[224:227], v[208:211], a[80:83]
  v_exp_f32 v95, v95
  v_mfma_f32_16x16x32_bf16 a[48:51], a[224:227], v[200:203], a[48:51]
  ds_read_b128 a[164:167], v4 offset:1024
  v_cvt_pk_bf16_f32 v239, v94, v95
  v_mfma_f32_16x16x32_bf16 a[48:51], a[228:231], v[204:207], a[48:51]
  v_exp_f32 v108, v108
  v_mfma_f32_16x16x32_bf16 a[16:19], a[228:231], v[196:199], a[16:19]
  v_exp_f32 v109, v109
  v_mfma_f32_16x16x32_bf16 a[16:19], a[224:227], v[192:195], a[16:19]
  s_waitcnt lgkmcnt(7)
  ds_read_b128 a[168:171], v4 offset:2048
  v_cvt_pk_bf16_f32 v246, v108, v109
  v_mfma_f32_16x16x32_bf16 a[20:23], a[232:235], v[192:195], a[20:23]
  s_waitcnt lgkmcnt(7)
  v_exp_f32 v110, v110
  v_mfma_f32_16x16x32_bf16 a[20:23], a[236:239], v[196:199], a[20:23]
  buffer_load_dwordx4 v2, s[24:27], s99 offen offset:2048 sc1 lds
  v_mfma_f32_16x16x32_bf16 a[52:55], a[236:239], v[204:207], a[52:55]
  ds_read_b128 a[172:175], v4 offset:3072
  v_mfma_f32_16x16x32_bf16 a[52:55], a[232:235], v[200:203], a[52:55]
  ds_read_b128 a[176:179], v4 offset:4096
  v_mfma_f32_16x16x32_bf16 a[84:87], a[232:235], v[208:211], a[84:87]
  v_exp_f32 v111, v111
  v_mfma_f32_16x16x32_bf16 a[84:87], a[236:239], v[212:215], a[84:87]
  ds_read_b128 a[180:183], v4 offset:5120
  v_cvt_pk_bf16_f32 v247, v110, v111
  v_mfma_f32_16x16x32_bf16 a[116:119], a[236:239], v[220:223], a[116:119]
  ds_read_b128 a[184:187], v4 offset:6144
  v_mfma_f32_16x16x32_bf16 a[116:119], a[232:235], v[216:219], a[116:119]
  s_waitcnt lgkmcnt(9)
  ds_read_b128 a[188:191], v4 offset:7168
  v_mfma_f32_16x16x32_bf16 a[120:123], a[240:243], v[216:219], a[120:123]
  v_mfma_f32_16x16x32_bf16 a[120:123], a[244:247], v[220:223], a[120:123]
  buffer_load_dwordx4 v2, s[24:27], s99 offen offset:3072 sc1 lds
  v_mfma_f32_16x16x32_bf16 a[88:91], a[244:247], v[212:215], a[88:91]
  v_mfma_f32_16x16x32_bf16 a[88:91], a[240:243], v[208:211], a[88:91]
  v_mfma_f32_16x16x32_bf16 a[56:59], a[240:243], v[200:203], a[56:59]
  v_mfma_f32_16x16x32_bf16 a[56:59], a[244:247], v[204:207], a[56:59]
  v_mfma_f32_16x16x32_bf16 a[24:27], a[244:247], v[196:199], a[24:27]
  v_mfma_f32_16x16x32_bf16 a[24:27], a[240:243], v[192:195], a[24:27]
  s_waitcnt lgkmcnt(8)
  v_mfma_f32_16x16x32_bf16 a[28:31], a[248:251], v[192:195], a[28:31]
  s_waitcnt lgkmcnt(7)
  v_mfma_f32_16x16x32_bf16 a[28:31], a[252:255], v[196:199], a[28:31]
  v_mfma_f32_16x16x32_bf16 a[60:63], a[252:255], v[204:207], a[60:63]
  v_mfma_f32_16x16x32_bf16 a[60:63], a[248:251], v[200:203], a[60:63]
  v_mfma_f32_16x16x32_bf16 a[92:95], a[248:251], v[208:211], a[92:95]
  v_mfma_f32_16x16x32_bf16 a[92:95], a[252:255], v[212:215], a[92:95]
  v_mfma_f32_16x16x32_bf16 a[124:127], a[252:255], v[220:223], a[124:127]
  v_mfma_f32_16x16x32_bf16 a[124:127], a[248:251], v[216:219], a[124:127]
  v_mfma_f32_16x16x32_bf16 v[112:115], a[160:163], v[176:179], v[60:63]
  s_waitcnt lgkmcnt(6)
  v_exp_f32 v124, v124
  v_mfma_f32_16x16x32_bf16 v[112:115], a[164:167], v[180:183], v[112:115]
  s_waitcnt lgkmcnt(5)
  v_exp_f32 v125, v125
  v_mfma_f32_16x16x32_bf16 v[112:115], a[168:171], v[184:187], v[112:115]
  s_waitcnt lgkmcnt(4)
  ds_read_b128 a[192:195], v4 offset:8192
  v_cvt_pk_bf16_f32 v254, v124, v125
  v_mfma_f32_16x16x32_bf16 v[112:115], a[172:175], v[188:191], v[112:115]
  s_add_u32 m0, s100, 16384
  v_exp_f32 v126, v126
  v_mfma_f32_16x16x32_bf16 v[96:99], a[172:175], v[172:175], v[40:43]
  s_add_u32 s98, s98, 0x8000
  v_exp_f32 v127, v127
  v_mfma_f32_16x16x32_bf16 v[96:99], a[168:171], v[168:171], v[96:99]
  buffer_load_dwordx4 v2, s[24:27], s98 offen offset:0 sc1 lds
  v_mfma_f32_16x16x32_bf16 v[96:99], a[164:167], v[164:167], v[96:99]
  s_xor_b32 s100, s100, 0x8000
  ds_read_b128 a[196:199], v4 offset:9216
  v_cvt_pk_bf16_f32 v255, v126, v127
  v_mfma_f32_16x16x32_bf16 v[96:99], a[160:163], v[160:163], v[96:99]
  v_exp_f32 v112, v112
  v_mfma_f32_16x16x32_bf16 v[80:83], a[160:163], v[144:147], v[56:59]
  v_exp_f32 v113, v113
  v_mfma_f32_16x16x32_bf16 v[80:83], a[164:167], v[148:151], v[80:83]
  ds_read_b128 a[200:203], v4 offset:10240
  v_cvt_pk_bf16_f32 v216, v112, v113
  v_mfma_f32_16x16x32_bf16 v[80:83], a[168:171], v[152:155], v[80:83]
  v_exp_f32 v114, v114
  v_mfma_f32_16x16x32_bf16 v[80:83], a[172:175], v[156:159], v[80:83]
  v_exp_f32 v115, v115
  v_mfma_f32_16x16x32_bf16 v[64:67], a[172:175], v[140:143], v[24:27]
  ds_read_b128 a[204:207], v4 offset:11264
  v_cvt_pk_bf16_f32 v217, v114, v115
  v_mfma_f32_16x16x32_bf16 v[64:67], a[168:171], v[136:139], v[64:67]
  buffer_load_dwordx4 v2, s[24:27], s98 offen offset:1024 sc1 lds
  v_mfma_f32_16x16x32_bf16 v[64:67], a[164:167], v[132:135], v[64:67]
  v_exp_f32 v96, v96
  v_mfma_f32_16x16x32_bf16 v[64:67], a[160:163], v[128:131], v[64:67]
  s_waitcnt lgkmcnt(7)
  v_exp_f32 v97, v97
  v_mfma_f32_16x16x32_bf16 v[68:71], a[176:179], v[128:131], v[28:31]
  s_waitcnt lgkmcnt(6)
  ds_read_b128 a[208:211], v4 offset:12288
  v_cvt_pk_bf16_f32 v208, v96, v97
  v_mfma_f32_16x16x32_bf16 v[68:71], a[180:183], v[132:135], v[68:71]
  s_waitcnt lgkmcnt(6)
  v_exp_f32 v98, v98
  v_mfma_f32_16x16x32_bf16 v[68:71], a[184:187], v[136:139], v[68:71]
  s_waitcnt lgkmcnt(5)
  v_exp_f32 v99, v99
  v_mfma_f32_16x16x32_bf16 v[68:71], a[188:191], v[140:143], v[68:71]
  ds_read_b128 a[212:215], v4 offset:13312
  v_cvt_pk_bf16_f32 v209, v98, v99
  v_mfma_f32_16x16x32_bf16 v[84:87], a[188:191], v[156:159], v[56:59]
  v_exp_f32 v80, v80
  v_mfma_f32_16x16x32_bf16 v[84:87], a[184:187], v[152:155], v[84:87]
  buffer_load_dwordx4 v2, s[24:27], s98 offen offset:2048 sc1 lds
  v_mfma_f32_16x16x32_bf16 v[84:87], a[180:183], v[148:151], v[84:87]
  v_exp_f32 v81, v81
  v_mfma_f32_16x16x32_bf16 v[84:87], a[176:179], v[144:147], v[84:87]
  ds_read_b128 a[216:219], v4 offset:14336
  v_cvt_pk_bf16_f32 v200, v80, v81
  v_mfma_f32_16x16x32_bf16 v[100:103], a[176:179], v[160:163], v[44:47]
  v_exp_f32 v82, v82
  v_mfma_f32_16x16x32_bf16 v[100:103], a[180:183], v[164:167], v[100:103]
  v_exp_f32 v83, v83
  v_mfma_f32_16x16x32_bf16 v[100:103], a[184:187], v[168:171], v[100:103]
  ds_read_b128 a[220:223], v4 offset:15360
  v_cvt_pk_bf16_f32 v201, v82, v83
  v_mfma_f32_16x16x32_bf16 v[100:103], a[188:191], v[172:175], v[100:103]
  v_exp_f32 v64, v64
  v_mfma_f32_16x16x32_bf16 v[116:119], a[188:191], v[188:191], v[60:63]
  v_exp_f32 v65, v65
  v_mfma_f32_16x16x32_bf16 v[116:119], a[184:187], v[184:187], v[116:119]
  buffer_load_dwordx4 v2, s[24:27], s98 offen offset:3072 sc1 lds
  v_mfma_f32_16x16x32_bf16 v[116:119], a[180:183], v[180:183], v[116:119]
  s_add_u32 m0, s101, 0
  ds_read_b128 a[224:227], v5 offset:16384
  v_cvt_pk_bf16_f32 v192, v64, v65
  v_mfma_f32_16x16x32_bf16 v[116:119], a[176:179], v[176:179], v[116:119]
  s_waitcnt lgkmcnt(8)
  v_exp_f32 v66, v66
  v_mfma_f32_16x16x32_bf16 v[120:123], a[192:195], v[176:179], v[60:63]
  s_waitcnt lgkmcnt(7)
  v_exp_f32 v67, v67
  v_mfma_f32_16x16x32_bf16 v[120:123], a[196:199], v[180:183], v[120:123]
  s_waitcnt lgkmcnt(6)
  ds_read_b128 a[228:231], v5 offset:17408
  v_cvt_pk_bf16_f32 v193, v66, v67
  v_mfma_f32_16x16x32_bf16 v[120:123], a[200:203], v[184:187], v[120:123]
  s_waitcnt lgkmcnt(6)
  v_exp_f32 v68, v68
  v_mfma_f32_16x16x32_bf16 v[120:123], a[204:207], v[188:191], v[120:123]
  s_add_u32 s99, s99, 0x8000
  v_exp_f32 v69, v69
  v_mfma_f32_16x16x32_bf16 v[104:107], a[204:207], v[172:175], v[48:51]
  ds_read_b128 a[232:235], v5 offset:18432
  v_cvt_pk_bf16_f32 v194, v68, v69
  v_mfma_f32_16x16x32_bf16 v[104:107], a[200:203], v[168:171], v[104:107]
  v_exp_f32 v70, v70
  v_mfma_f32_16x16x32_bf16 v[104:107], a[196:199], v[164:167], v[104:107]
  v_exp_f32 v71, v71
  v_mfma_f32_16x16x32_bf16 v[104:107], a[192:195], v[160:163], v[104:107]
  ds_read_b128 a[236:239], v5 offset:19456
  v_cvt_pk_bf16_f32 v195, v70, v71
  v_mfma_f32_16x16x32_bf16 v[88:91], a[192:195], v[144:147], v[56:59]
  v_exp_f32 v84, v84
  v_mfma_f32_16x16x32_bf16 v[88:91], a[196:199], v[148:151], v[88:91]
  v_exp_f32 v85, v85
  v_mfma_f32_16x16x32_bf16 v[88:91], a[200:203], v[152:155], v[88:91]
  ds_read_b128 a[240:243], v5 offset:20480
  v_cvt_pk_bf16_f32 v202, v84, v85
  v_mfma_f32_16x16x32_bf16 v[88:91], a[204:207], v[156:159], v[88:91]
  v_exp_f32 v86, v86
  v_mfma_f32_16x16x32_bf16 v[72:75], a[204:207], v[140:143], v[32:35]
  v_exp_f32 v87, v87
  v_mfma_f32_16x16x32_bf16 v[72:75], a[200:203], v[136:139], v[72:75]
  ds_read_b128 a[244:247], v5 offset:21504
  v_cvt_pk_bf16_f32 v203, v86, v87
  v_mfma_f32_16x16x32_bf16 v[72:75], a[196:199], v[132:135], v[72:75]
  v_exp_f32 v100, v100
  v_mfma_f32_16x16x32_bf16 v[72:75], a[192:195], v[128:131], v[72:75]
  s_waitcnt lgkmcnt(9)
  v_exp_f32 v101, v101
  v_mfma_f32_16x16x32_bf16 v[76:79], a[208:211], v[128:131], v[36:39]
  s_waitcnt lgkmcnt(8)
  ds_read_b128 a[248:251], v5 offset:22528
  v_cvt_pk_bf16_f32 v210, v100, v101
  v_mfma_f32_16x16x32_bf16 v[76:79], a[212:215], v[132:135], v[76:79]
  s_waitcnt lgkmcnt(8)
  v_exp_f32 v102, v102
  v_mfma_f32_16x16x32_bf16 v[76:79], a[216:219], v[136:139], v[76:79]
  s_waitcnt lgkmcnt(7)
  v_exp_f32 v103, v103
  v_mfma_f32_16x16x32_bf16 v[76:79], a[220:223], v[140:143], v[76:79]
  ds_read_b128 a[252:255], v5 offset:23552
  v_cvt_pk_bf16_f32 v211, v102, v103
  v_mfma_f32_16x16x32_bf16 v[92:95], a[220:223], v[156:159], v[56:59]
  v_exp_f32 v116, v116
  v_mfma_f32_16x16x32_bf16 v[92:95], a[216:219], v[152:155], v[92:95]
  v_exp_f32 v117, v117
  v_mfma_f32_16x16x32_bf16 v[92:95], a[212:215], v[148:151], v[92:95]
  v_cvt_pk_bf16_f32 v218, v116, v117
  v_mfma_f32_16x16x32_bf16 v[92:95], a[208:211], v[144:147], v[92:95]
  v_exp_f32 v118, v118
  v_mfma_f32_16x16x32_bf16 v[108:111], a[208:211], v[160:163], v[52:55]
  v_exp_f32 v119, v119
  v_mfma_f32_16x16x32_bf16 v[108:111], a[212:215], v[164:167], v[108:111]
  v_cvt_pk_bf16_f32 v219, v118, v119
  v_mfma_f32_16x16x32_bf16 v[108:111], a[216:219], v[168:171], v[108:111]
  v_exp_f32 v120, v120
  v_mfma_f32_16x16x32_bf16 v[108:111], a[220:223], v[172:175], v[108:111]
  v_exp_f32 v121, v121
  v_mfma_f32_16x16x32_bf16 v[124:127], a[220:223], v[188:191], v[60:63]
  v_cvt_pk_bf16_f32 v220, v120, v121
  v_mfma_f32_16x16x32_bf16 v[124:127], a[216:219], v[184:187], v[124:127]
  v_exp_f32 v122, v122
  v_mfma_f32_16x16x32_bf16 v[124:127], a[212:215], v[180:183], v[124:127]
  v_exp_f32 v123, v123
  v_mfma_f32_16x16x32_bf16 v[124:127], a[208:211], v[176:179], v[124:127]
  v_cvt_pk_bf16_f32 v221, v122, v123
  v_smfmac_f32_16x16x64_bf16 a[128:131], a[144:147], v[224:231], v20
  v_smfmac_f32_16x16x64_bf16 a[132:135], a[144:147], v[232:239], v20
  v_smfmac_f32_16x16x64_bf16 a[136:139], a[144:147], v[240:247], v20
  v_smfmac_f32_16x16x64_bf16 a[140:143], a[144:147], v[248:255], v20
  s_waitcnt lgkmcnt(7)
  v_mfma_f32_16x16x32_bf16 a[96:99], a[224:227], v[248:251], a[96:99]
  s_waitcnt lgkmcnt(6)
  v_exp_f32 v104, v104
  v_mfma_f32_16x16x32_bf16 a[96:99], a[228:231], v[252:255], a[96:99]
  v_exp_f32 v105, v105
  v_mfma_f32_16x16x32_bf16 a[64:67], a[228:231], v[244:247], a[64:67]
  v_cvt_pk_bf16_f32 v212, v104, v105
  v_mfma_f32_16x16x32_bf16 a[64:67], a[224:227], v[240:243], a[64:67]
  v_exp_f32 v106, v106
  v_mfma_f32_16x16x32_bf16 a[32:35], a[224:227], v[232:235], a[32:35]
  v_exp_f32 v107, v107
  v_mfma_f32_16x16x32_bf16 a[32:35], a[228:231], v[236:239], a[32:35]
  v_cvt_pk_bf16_f32 v213, v106, v107
  v_mfma_f32_16x16x32_bf16 a[0:3], a[228:231], v[228:231], a[0:3]
  v_exp_f32 v88, v88
  v_mfma_f32_16x16x32_bf16 a[0:3], a[224:227], v[224:227], a[0:3]
  s_waitcnt lgkmcnt(5)
  v_exp_f32 v89, v89
  v_mfma_f32_16x16x32_bf16 a[4:7], a[232:235], v[224:227], a[4:7]
  s_waitcnt lgkmcnt(4)
  ds_read_b128 a[224:227], v5 offset:24576
  v_cvt_pk_bf16_f32 v204, v88, v89
  v_mfma_f32_16x16x32_bf16 a[4:7], a[236:239], v[228:231], a[4:7]
  v_exp_f32 v90, v90
  v_mfma_f32_16x16x32_bf16 a[36:39], a[236:239], v[236:239], a[36:39]
  ds_read_b128 a[228:231], v5 offset:25600
  v_mfma_f32_16x16x32_bf16 a[36:39], a[232:235], v[232:235], a[36:39]
  v_exp_f32 v91, v91
  v_mfma_f32_16x16x32_bf16 a[68:71], a[232:235], v[240:243], a[68:71]
  v_cvt_pk_bf16_f32 v205, v90, v91
  v_mfma_f32_16x16x32_bf16 a[68:71], a[236:239], v[244:247], a[68:71]
  v_exp_f32 v72, v72
  v_mfma_f32_16x16x32_bf16 a[100:103], a[236:239], v[252:255], a[100:103]
  v_exp_f32 v73, v73
  v_mfma_f32_16x16x32_bf16 a[100:103], a[232:235], v[248:251], a[100:103]
  s_waitcnt lgkmcnt(5)
  ds_read_b128 a[232:235], v5 offset:26624
  v_cvt_pk_bf16_f32 v196, v72, v73
  v_mfma_f32_16x16x32_bf16 a[104:107], a[240:243], v[248:251], a[104:107]
  s_waitcnt lgkmcnt(5)
  v_exp_f32 v74, v74
  v_mfma_f32_16x16x32_bf16 a[104:107], a[244:247], v[252:255], a[104:107]
  ds_read_b128 a[236:239], v5 offset:27648
  v_mfma_f32_16x16x32_bf16 a[72:75], a[244:247], v[244:247], a[72:75]
  v_exp_f32 v75, v75
  v_mfma_f32_16x16x32_bf16 a[72:75], a[240:243], v[240:243], a[72:75]
  v_cvt_pk_bf16_f32 v197, v74, v75
  v_mfma_f32_16x16x32_bf16 a[40:43], a[240:243], v[232:235], a[40:43]
  v_exp_f32 v76, v76
  v_mfma_f32_16x16x32_bf16 a[40:43], a[244:247], v[236:239], a[40:43]
  v_exp_f32 v77, v77
  v_mfma_f32_16x16x32_bf16 a[8:11], a[244:247], v[228:231], a[8:11]
  ds_read_b128 a[244:247], v5 offset:29696
  v_cvt_pk_bf16_f32 v198, v76, v77
  v_mfma_f32_16x16x32_bf16 a[8:11], a[240:243], v[224:227], a[8:11]
  s_waitcnt vmcnt(13) lgkmcnt(6)
  v_exp_f32 v78, v78
  v_mfma_f32_16x16x32_bf16 a[12:15], a[248:251], v[224:227], a[12:15]
  s_barrier
  s_waitcnt lgkmcnt(5)
  v_mfma_f32_16x16x32_bf16 a[12:15], a[252:255], v[228:231], a[12:15]
  buffer_load_dwordx4 v2, s[24:27], s99 offen offset:0 sc1 lds
  v_mfma_f32_16x16x32_bf16 a[44:47], a[252:255], v[236:239], a[44:47]
  ds_read_b128 a[240:243], v5 offset:28672
  v_mfma_f32_16x16x32_bf16 a[44:47], a[248:251], v[232:235], a[44:47]
  v_exp_f32 v79, v79
  v_mfma_f32_16x16x32_bf16 a[76:79], a[248:251], v[240:243], a[76:79]
  ds_read_b128 a[160:163], v4 offset:16384
  v_cvt_pk_bf16_f32 v199, v78, v79
  v_mfma_f32_16x16x32_bf16 a[76:79], a[252:255], v[244:247], a[76:79]
  v_exp_f32 v92, v92
  v_mfma_f32_16x16x32_bf16 a[108:111], a[252:255], v[252:255], a[108:111]
  v_exp_f32 v93, v93
  v_mfma_f32_16x16x32_bf16 a[108:111], a[248:251], v[248:251], a[108:111]
  s_waitcnt lgkmcnt(6)
  ds_read_b128 a[248:251], v5 offset:30720
  v_cvt_pk_bf16_f32 v206, v92, v93
  v_mfma_f32_16x16x32_bf16 a[112:115], a[224:227], v[248:251], a[112:115]
  s_waitcnt lgkmcnt(6)
  v_exp_f32 v94, v94
  v_mfma_f32_16x16x32_bf16 a[112:115], a[228:231], v[252:255], a[112:115]
  buffer_load_dwordx4 v2, s[24:27], s99 offen offset:1024 sc1 lds
  v_mfma_f32_16x16x32_bf16 a[80:83], a[228:231], v[244:247], a[80:83]
  ds_read_b128 a[252:255], v5 offset:31744
  v_mfma_f32_16x16x32_bf16 a[80:83], a[224:227], v[240:243], a[80:83]
  v_exp_f32 v95, v95
  v_mfma_f32_16x16x32_bf16 a[48:51], a[224:227], v[232:235], a[48:51]
  ds_read_b128 a[164:167], v4 offset:17408
  v_cvt_pk_bf16_f32 v207, v94, v95
  v_mfma_f32_16x16x32_bf16 a[48:51], a[228:231], v[236:239], a[48:51]
  v_exp_f32 v108, v108
  v_mfma_f32_16x16x32_bf16 a[16:19], a[228:231], v[228:231], a[16:19]
  v_exp_f32 v109, v109
  v_mfma_f32_16x16x32_bf16 a[16:19], a[224:227], v[224:227], a[16:19]
  s_waitcnt lgkmcnt(7)
  ds_read_b128 a[168:171], v4 offset:18432
  v_cvt_pk_bf16_f32 v214, v108, v109
  v_mfma_f32_16x16x32_bf16 a[20:23], a[232:235], v[224:227], a[20:23]
  s_waitcnt lgkmcnt(7)
  v_exp_f32 v110, v110
  v_mfma_f32_16x16x32_bf16 a[20:23], a[236:239], v[228:231], a[20:23]
  buffer_load_dwordx4 v2, s[24:27], s99 offen offset:2048 sc1 lds
  v_mfma_f32_16x16x32_bf16 a[52:55], a[236:239], v[236:239], a[52:55]
  s_sub_u32 s31, s31, 1
  ds_read_b128 a[172:175], v4 offset:19456
  v_xor_b32 v5, 0x8000, v5
  v_mfma_f32_16x16x32_bf16 a[52:55], a[232:235], v[232:235], a[52:55]
  s_lshr_b32 s82, s82, 1
  ds_read_b128 a[176:179], v4 offset:20480
  v_mfma_f32_16x16x32_bf16 a[84:87], a[232:235], v[240:243], a[84:87]
  s_bitcmp1_b32 s82, 0
  v_exp_f32 v111, v111
  v_mfma_f32_16x16x32_bf16 a[84:87], a[236:239], v[244:247], a[84:87]
  s_cselect_b32 s3, 0, s31
  ds_read_b128 a[180:183], v4 offset:21504
  v_cvt_pk_bf16_f32 v215, v110, v111
  v_mfma_f32_16x16x32_bf16 a[116:119], a[236:239], v[252:255], a[116:119]
  s_cmp_gt_u32 s3, 1
  ds_read_b128 a[184:187], v4 offset:22528
  v_mfma_f32_16x16x32_bf16 a[116:119], a[232:235], v[248:251], a[116:119]
  s_waitcnt lgkmcnt(9)
  ds_read_b128 a[188:191], v4 offset:23552
  v_mfma_f32_16x16x32_bf16 a[120:123], a[240:243], v[248:251], a[120:123]
  v_mfma_f32_16x16x32_bf16 a[120:123], a[244:247], v[252:255], a[120:123]
  buffer_load_dwordx4 v2, s[24:27], s99 offen offset:3072 sc1 lds
  v_mfma_f32_16x16x32_bf16 a[88:91], a[244:247], v[244:247], a[88:91]
  v_mfma_f32_16x16x32_bf16 a[88:91], a[240:243], v[240:243], a[88:91]
  v_mfma_f32_16x16x32_bf16 a[56:59], a[240:243], v[232:235], a[56:59]
  v_mfma_f32_16x16x32_bf16 a[56:59], a[244:247], v[236:239], a[56:59]
  v_mfma_f32_16x16x32_bf16 a[24:27], a[244:247], v[228:231], a[24:27]
  v_mfma_f32_16x16x32_bf16 a[24:27], a[240:243], v[224:227], a[24:27]
  s_waitcnt lgkmcnt(8)
  v_mfma_f32_16x16x32_bf16 a[28:31], a[248:251], v[224:227], a[28:31]
  s_waitcnt lgkmcnt(7)
  v_mfma_f32_16x16x32_bf16 a[28:31], a[252:255], v[228:231], a[28:31]
  v_mfma_f32_16x16x32_bf16 a[60:63], a[252:255], v[236:239], a[60:63]
  v_mfma_f32_16x16x32_bf16 a[60:63], a[248:251], v[232:235], a[60:63]
  v_mfma_f32_16x16x32_bf16 a[92:95], a[248:251], v[240:243], a[92:95]
  v_mfma_f32_16x16x32_bf16 a[92:95], a[252:255], v[244:247], a[92:95]
  v_mfma_f32_16x16x32_bf16 a[124:127], a[252:255], v[252:255], a[124:127]
  v_mfma_f32_16x16x32_bf16 a[124:127], a[248:251], v[248:251], a[124:127]
  s_cbranch_scc1 L_loop4
L_ev4:
  s_bitcmp1_b32 s82, 0
  s_cbranch_scc1 L_hook4
L_last4:
  s_cmp_eq_u32 s31, 0
  s_cbranch_scc1 L_after4
  v_cndmask_b32 v24, v13, v24, s[32:33]
  v_cndmask_b32 v25, v13, v25, s[34:35]
  v_cndmask_b32 v26, v13, v26, s[36:37]
  v_cndmask_b32 v27, v13, v27, s[38:39]
  v_cndmask_b32 v28, v13, v28, s[40:41]
  v_cndmask_b32 v29, v13, v29, s[42:43]
  v_cndmask_b32 v30, v13, v30, s[44:45]
  v_cndmask_b32 v31, v13, v31, s[46:47]
  v_cndmask_b32 v32, v13, v32, s[48:49]
  v_cndmask_b32 v33, v13, v33, s[50:51]
  v_cndmask_b32 v34, v13, v34, s[52:53]
  v_cndmask_b32 v35, v13, v35, s[54:55]
  v_cndmask_b32 v36, v13, v36, s[56:57]
  v_cndmask_b32 v37, v13, v37, s[58:59]
  v_cndmask_b32 v38, v13, v38, s[60:61]
  v_cndmask_b32 v39, v13, v39, s[62:63]
  s_branch L_loop4
L_hook4:
  s_cmp_lt_u32 s82, 4
  s_cbranch_scc1 L_hook4_b
  s_cmp_gt_u32 s31, 1
  buffer_store_dword v9, v8, s[20:23], s88 offen offset:4 sc1
  s_cbranch_scc1 L_loop4
  s_branch L_last4
L_hook4_b:
  s_cmp_eq_u32 s82, 1
  s_cbranch_scc1 L_hook4_chk
  s_cmp_gt_u32 s31, 1
  buffer_load_dword v21, v7, s[20:23], 0 offen offset:4 sc1
  s_cbranch_scc1 L_loop4
  s_branch L_last4
L_hook4_chk:
  s_waitcnt vmcnt(8)
  s_mov_b32 s0, 0
L_hook4_loop:
  v_cmp_ne_u32 vcc, 1, v21
  s_nop 2
  s_cbranch_vccz L_hook4_ok
  buffer_load_dword v21, v7, s[20:23], 0 offen offset:4 sc1
  s_add_u32 s0, s0, 1
  s_cmp_lt_u32 s0, 0x200000
  s_waitcnt vmcnt(0)
  s_cbranch_scc1 L_hook4_loop
L_hook4_ok:
  s_cmp_gt_u32 s31, 1
  s_cbranch_scc1 L_loop4
  s_branch L_last4
L_after4:
  v_cndmask_b32 v24, v13, v56, s[32:33]
  v_cndmask_b32 v25, v13, v56, s[34:35]
  v_cndmask_b32 v26, v13, v56, s[36:37]
  v_cndmask_b32 v27, v13, v56, s[38:39]
  v_cndmask_b32 v28, v13, v56, s[40:41]
  v_cndmask_b32 v29, v13, v56, s[42:43]
  v_cndmask_b32 v30, v13, v56, s[44:45]
  v_cndmask_b32 v31, v13, v56, s[46:47]
  v_cndmask_b32 v32, v13, v56, s[48:49]
  v_cndmask_b32 v33, v13, v56, s[50:51]
  v_cndmask_b32 v34, v13, v56, s[52:53]
  v_cndmask_b32 v35, v13, v56, s[54:55]
  v_cndmask_b32 v36, v13, v56, s[56:57]
  v_cndmask_b32 v37, v13, v56, s[58:59]
  v_cndmask_b32 v38, v13, v56, s[60:61]
  v_cndmask_b32 v39, v13, v56, s[62:63]
  v_mfma_f32_16x16x32_bf16 v[112:115], a[160:163], v[176:179], v[60:63]
  s_waitcnt lgkmcnt(6)
  v_exp_f32 v124, v124
  v_mfma_f32_16x16x32_bf16 v[112:115], a[164:167], v[180:183], v[112:115]
  s_waitcnt lgkmcnt(5)
  v_exp_f32 v125, v125
  v_mfma_f32_16x16x32_bf16 v[112:115], a[168:171], v[184:187], v[112:115]
  s_waitcnt lgkmcnt(4)
  ds_read_b128 a[192:195], v4 offset:24576
  v_cvt_pk_bf16_f32 v222, v124, v125
  v_mfma_f32_16x16x32_bf16 v[112:115], a[172:175], v[188:191], v[112:115]
  v_exp_f32 v126, v126
  v_mfma_f32_16x16x32_bf16 v[96:99], a[172:175], v[172:175], v[40:43]
  v_exp_f32 v127, v127
  v_mfma_f32_16x16x32_bf16 v[96:99], a[168:171], v[168:171], v[96:99]
  ds_read_b128 a[196:199], v4 offset:25600
  v_cvt_pk_bf16_f32 v223, v126, v127
  v_mfma_f32_16x16x32_bf16 v[96:99], a[164:167], v[164:167], v[96:99]
  ds_read_b128 a[200:203], v4 offset:26624
  v_and_b32 v6, 31, v1
  v_mfma_f32_16x16x32_bf16 v[96:99], a[160:163], v[160:163], v[96:99]
  v_exp_f32 v112, v112
  v_mfma_f32_16x16x32_bf16 v[80:83], a[160:163], v[144:147], v[24:27]
  v_exp_f32 v113, v113
  v_mfma_f32_16x16x32_bf16 v[80:83], a[164:167], v[148:151], v[80:83]
  ds_read_b128 a[204:207], v4 offset:27648
  v_cvt_pk_bf16_f32 v248, v112, v113
  v_mfma_f32_16x16x32_bf16 v[80:83], a[168:171], v[152:155], v[80:83]
  v_exp_f32 v114, v114
  v_mfma_f32_16x16x32_bf16 v[80:83], a[172:175], v[156:159], v[80:83]
  s_waitcnt lgkmcnt(7)
  v_exp_f32 v115, v115
  v_mfma_f32_16x16x32_bf16 v[84:87], a[176:179], v[144:147], v[28:31]
  s_waitcnt lgkmcnt(6)
  v_cvt_pk_bf16_f32 v249, v114, v115
  v_lshlrev_b32 v6, 2, v6
  v_mfma_f32_16x16x32_bf16 v[84:87], a[180:183], v[148:151], v[84:87]
  s_waitcnt lgkmcnt(5)
  v_and_b32 v14, 60, v1
  v_lshl_add_u32 v71, v14, 4, v3
  v_mfma_f32_16x16x32_bf16 v[84:87], a[184:187], v[152:155], v[84:87]
  s_waitcnt lgkmcnt(4)
  ds_read_b128 a[208:211], v4 offset:28672
  v_subrev_u32 v73, 32, v3
  v_mfma_f32_16x16x32_bf16 v[84:87], a[188:191], v[156:159], v[84:87]
  s_lshl_b32 s3, s2, 2
  buffer_load_dword v10, v6, s[4:7], 0 offen offset:128 sc1
  v_mfma_f32_16x16x32_bf16 v[100:103], a[188:191], v[172:175], v[44:47]
  s_add_u32 m0, s100, 0
  v_exp_f32 v96, v96
  v_mfma_f32_16x16x32_bf16 v[100:103], a[184:187], v[168:171], v[100:103]
L_pad11:
  s_cbranch_execz L_pad15
  s_add_u32 s98, s98, 0x8000
  v_exp_f32 v97, v97
  v_mfma_f32_16x16x32_bf16 v[100:103], a[180:183], v[164:167], v[100:103]
  s_add_u32 s3, s3, s28
  ds_read_b128 a[212:215], v4 offset:29696
  v_cvt_pk_bf16_f32 v240, v96, v97
  v_mfma_f32_16x16x32_bf16 v[100:103], a[176:179], v[160:163], v[100:103]
  s_lshl_b32 s79, s3, 1
  v_exp_f32 v98, v98
  v_mfma_f32_16x16x32_bf16 v[116:119], a[176:179], v[176:179], v[60:63]
  s_lshl_b32 s3, s3, 12
  v_exp_f32 v99, v99
  v_mfma_f32_16x16x32_bf16 v[116:119], a[180:183], v[180:183], v[116:119]
  s_sub_u32 s78, 0x400000, s3
  ds_read_b128 a[216:219], v4 offset:30720
  v_cvt_pk_bf16_f32 v241, v98, v99
  v_mfma_f32_16x16x32_bf16 v[116:119], a[184:187], v[184:187], v[116:119]
  s_add_u32 s8, s84, s3
  s_addc_u32 s9, s85, 0
  ds_read_b128 a[220:223], v4 offset:31744
  v_mfma_f32_16x16x32_bf16 v[116:119], a[188:191], v[188:191], v[116:119]
  s_waitcnt lgkmcnt(7)
  buffer_load_dwordx4 v2, s[24:27], s98 offen offset:0 sc1 lds
  v_mfma_f32_16x16x32_bf16 v[120:123], a[192:195], v[176:179], v[60:63]
  s_waitcnt lgkmcnt(6)
  v_exp_f32 v80, v80
  v_mfma_f32_16x16x32_bf16 v[120:123], a[196:199], v[180:183], v[120:123]
  s_waitcnt lgkmcnt(5)
  v_exp_f32 v81, v81
  v_mfma_f32_16x16x32_bf16 v[120:123], a[200:203], v[184:187], v[120:123]
  s_waitcnt lgkmcnt(4)
  ds_read_b128 a[224:227], v5 offset:0
  v_cvt_pk_bf16_f32 v232, v80, v81
  v_mfma_f32_16x16x32_bf16 v[120:123], a[204:207], v[188:191], v[120:123]
  s_mov_b32 s10, s78
  v_exp_f32 v82, v82
  v_mfma_f32_16x16x32_bf16 v[104:107], a[204:207], v[172:175], v[48:51]
  s_mov_b32 s11, 0x20000
  v_exp_f32 v83, v83
  v_mfma_f32_16x16x32_bf16 v[104:107], a[200:203], v[168:171], v[104:107]
  s_lshr_b32 s3, s2, 4
  ds_read_b128 a[228:231], v5 offset:1024
  v_cvt_pk_bf16_f32 v233, v82, v83
  v_mfma_f32_16x16x32_bf16 v[104:107], a[196:199], v[164:167], v[104:107]
  s_lshl_b32 s3, s3, 3
  v_exp_f32 v84, v84
  v_mfma_f32_16x16x32_bf16 v[104:107], a[192:195], v[160:163], v[104:107]
  s_and_b32 s78, s2, 7
  buffer_load_dwordx4 v2, s[24:27], s98 offen offset:1024 sc1 lds
  v_mfma_f32_16x16x32_bf16 v[88:91], a[192:195], v[144:147], v[32:35]
  s_add_u32 s3, s3, s78
  v_exp_f32 v85, v85
  v_mfma_f32_16x16x32_bf16 v[88:91], a[196:199], v[148:151], v[88:91]
  s_bfe_u32 s78, s2, 0x10003
  ds_read_b128 a[232:235], v5 offset:2048
  v_cvt_pk_bf16_f32 v234, v84, v85
  v_mfma_f32_16x16x32_bf16 v[88:91], a[200:203], v[152:155], v[88:91]
  s_lshl_b32 s3, s3, 2
  v_exp_f32 v86, v86
  v_mfma_f32_16x16x32_bf16 v[88:91], a[204:207], v[156:159], v[88:91]
  s_waitcnt lgkmcnt(6)
  v_exp_f32 v87, v87
  v_mfma_f32_16x16x32_bf16 v[92:95], a[208:211], v[144:147], v[36:39]
  s_waitcnt lgkmcnt(5)
  ds_read_b128 a[236:239], v5 offset:3072
  v_cvt_pk_bf16_f32 v235, v86, v87
  v_mfma_f32_16x16x32_bf16 v[92:95], a[212:215], v[148:151], v[92:95]
  s_waitcnt lgkmcnt(5)
  v_exp_f32 v100, v100
  v_mfma_f32_16x16x32_bf16 v[92:95], a[216:219], v[152:155], v[92:95]
  s_waitcnt lgkmcnt(4)
  v_exp_f32 v101, v101
  v_mfma_f32_16x16x32_bf16 v[92:95], a[220:223], v[156:159], v[92:95]
  s_add_u32 s3, s3, s28
  buffer_load_dwordx4 v2, s[24:27], s98 offen offset:2048 sc1 lds
  v_mfma_f32_16x16x32_bf16 v[108:111], a[220:223], v[172:175], v[52:55]
  s_lshl_b32 s3, s3, 7
  ds_read_b128 a[240:243], v5 offset:4096
  v_cvt_pk_bf16_f32 v242, v100, v101
  v_mfma_f32_16x16x32_bf16 v[108:111], a[216:219], v[168:171], v[108:111]
  s_add_u32 s3, s3, s78
  v_exp_f32 v102, v102
  v_mfma_f32_16x16x32_bf16 v[108:111], a[212:215], v[164:167], v[108:111]
  s_lshl_b32 s3, s3, 6
  v_exp_f32 v103, v103
  v_mfma_f32_16x16x32_bf16 v[108:111], a[208:211], v[160:163], v[108:111]
  ds_read_b128 a[244:247], v5 offset:5120
  v_cvt_pk_bf16_f32 v243, v102, v103
  v_mfma_f32_16x16x32_bf16 v[124:127], a[208:211], v[176:179], v[60:63]
  v_exp_f32 v116, v116
  v_mfma_f32_16x16x32_bf16 v[124:127], a[212:215], v[180:183], v[124:127]
  v_exp_f32 v117, v117
  v_mfma_f32_16x16x32_bf16 v[124:127], a[216:219], v[184:187], v[124:127]
  ds_read_b128 a[248:251], v5 offset:6144
  v_cvt_pk_bf16_f32 v250, v116, v117
  v_mfma_f32_16x16x32_bf16 v[124:127], a[220:223], v[188:191], v[124:127]
  buffer_load_dwordx4 v2, s[24:27], s98 offen offset:3072 sc1 lds
  v_smfmac_f32_16x16x64_bf16 a[128:131], a[144:147], v[192:199], v20
  s_add_u32 m0, s101, 16384
  v_xor_b32 v4, 0x8000, v4
  v_smfmac_f32_16x16x64_bf16 a[132:135], a[144:147], v[200:207], v20
  s_add_u32 s99, s99, 0x8000
  v_smfmac_f32_16x16x64_bf16 a[136:139], a[144:147], v[208:215], v20
  s_add_u32 s12, s94, s3
  s_addc_u32 s13, s95, 0
  v_smfmac_f32_16x16x64_bf16 a[140:143], a[144:147], v[216:223], v20
  s_waitcnt lgkmcnt(6)
  v_mfma_f32_16x16x32_bf16 a[96:99], a[224:227], v[216:219], a[96:99]
  s_waitcnt lgkmcnt(5)
  v_exp_f32 v118, v118
  v_mfma_f32_16x16x32_bf16 a[96:99], a[228:231], v[220:223], a[96:99]
  v_exp_f32 v119, v119
  v_mfma_f32_16x16x32_bf16 a[64:67], a[228:231], v[212:215], a[64:67]
  ds_read_b128 a[252:255], v5 offset:7168
  v_cvt_pk_bf16_f32 v251, v118, v119
  v_mfma_f32_16x16x32_bf16 a[64:67], a[224:227], v[208:211], a[64:67]
  v_exp_f32 v120, v120
  v_mfma_f32_16x16x32_bf16 a[32:35], a[224:227], v[200:203], a[32:35]
  v_exp_f32 v121, v121
  v_mfma_f32_16x16x32_bf16 a[32:35], a[228:231], v[204:207], a[32:35]
  s_add_u32 s12, s12, 0x3000000
  s_addc_u32 s13, s13, 0
  v_cvt_pk_bf16_f32 v252, v120, v121
  v_mfma_f32_16x16x32_bf16 a[0:3], a[228:231], v[196:199], a[0:3]
  s_mov_b32 s14, 0x1fc0
  v_exp_f32 v122, v122
  v_mfma_f32_16x16x32_bf16 a[0:3], a[224:227], v[192:195], a[0:3]
  s_waitcnt lgkmcnt(5)
  v_exp_f32 v123, v123
  v_mfma_f32_16x16x32_bf16 a[4:7], a[232:235], v[192:195], a[4:7]
  s_waitcnt lgkmcnt(4)
  ds_read_b128 a[224:227], v5 offset:8192
  v_cvt_pk_bf16_f32 v253, v122, v123
  v_mfma_f32_16x16x32_bf16 a[4:7], a[236:239], v[196:199], a[4:7]
  s_mov_b32 s15, 0x20000
  v_exp_f32 v104, v104
  v_mfma_f32_16x16x32_bf16 a[36:39], a[236:239], v[204:207], a[36:39]
  s_mul_i32 s78, s28, 5120
  v_exp_f32 v105, v105
  v_mfma_f32_16x16x32_bf16 a[36:39], a[232:235], v[200:203], a[36:39]
  s_add_u32 s78, s78, 66560
  ds_read_b128 a[228:231], v5 offset:9216
  v_cvt_pk_bf16_f32 v244, v104, v105
  v_mfma_f32_16x16x32_bf16 a[68:71], a[232:235], v[208:211], a[68:71]
  s_mul_i32 s80, s28, 8192
  v_exp_f32 v106, v106
  v_mfma_f32_16x16x32_bf16 a[68:71], a[236:239], v[212:215], a[68:71]
  s_add_u32 s80, s80, 131072
  v_exp_f32 v107, v107
  v_mfma_f32_16x16x32_bf16 a[100:103], a[236:239], v[220:223], a[100:103]
  ds_read_b128 a[236:239], v5 offset:11264
  v_cvt_pk_bf16_f32 v245, v106, v107
  v_mfma_f32_16x16x32_bf16 a[100:103], a[232:235], v[216:219], a[100:103]
  s_waitcnt lgkmcnt(6)
  v_exp_f32 v88, v88
  v_mfma_f32_16x16x32_bf16 a[104:107], a[240:243], v[216:219], a[104:107]
  s_waitcnt lgkmcnt(5)
  ds_read_b128 a[232:235], v5 offset:10240
  v_and_b32 v16, 15, v1
  v_mfma_f32_16x16x32_bf16 a[104:107], a[244:247], v[220:223], a[104:107]
  v_exp_f32 v89, v89
  v_mfma_f32_16x16x32_bf16 a[72:75], a[244:247], v[212:215], a[72:75]
  v_cvt_pk_bf16_f32 v236, v88, v89
  v_lshrrev_b32 v17, 4, v1
  v_mfma_f32_16x16x32_bf16 a[72:75], a[240:243], v[208:211], a[72:75]
  v_exp_f32 v90, v90
  v_mfma_f32_16x16x32_bf16 a[40:43], a[240:243], v[200:203], a[40:43]
  v_exp_f32 v91, v91
  v_mfma_f32_16x16x32_bf16 a[40:43], a[244:247], v[204:207], a[40:43]
  v_cvt_pk_bf16_f32 v237, v90, v91
  v_lshl_add_u32 v18, v17, 3, v16
  v_mfma_f32_16x16x32_bf16 a[8:11], a[244:247], v[196:199], a[8:11]
  v_exp_f32 v92, v92
  v_mfma_f32_16x16x32_bf16 a[8:11], a[240:243], v[192:195], a[8:11]
  s_waitcnt vmcnt(13) lgkmcnt(5)
  ds_read_b128 a[240:243], v5 offset:12288
  v_add_u32 v18, 1, v18
  v_mfma_f32_16x16x32_bf16 a[12:15], a[248:251], v[192:195], a[12:15]
  s_barrier
  s_waitcnt lgkmcnt(5)
  v_mfma_f32_16x16x32_bf16 a[12:15], a[252:255], v[196:199], a[12:15]
  s_waitcnt vmcnt(4)
  v_cmp_eq_u32 vcc, 0, v10
  s_nop 2
  s_cbranch_vccnz L_prep_wait
L_prep_ok:
  v_mfma_f32_16x16x32_bf16 a[44:47], a[252:255], v[204:207], a[44:47]
  buffer_load_dwordx4 v2, s[24:27], s99 offen offset:0 sc1 lds
  v_mfma_f32_16x16x32_bf16 a[44:47], a[248:251], v[200:203], a[44:47]
  s_xor_b32 s101, s101, 0x8000
  ds_read_b128 a[244:247], v5 offset:13312
  v_lshlrev_b32 v74, 1, v18
  v_mfma_f32_16x16x32_bf16 a[76:79], a[248:251], v[208:211], a[76:79]
  v_exp_f32 v93, v93
  v_mfma_f32_16x16x32_bf16 a[76:79], a[252:255], v[212:215], a[76:79]
  v_cvt_pk_bf16_f32 v238, v92, v93
  v_add_u32 v72, s80, v74
  v_mfma_f32_16x16x32_bf16 a[108:111], a[252:255], v[220:223], a[108:111]
  buffer_load_dwordx4 v2, s[24:27], s99 offen offset:1024 sc1 lds
  v_mfma_f32_16x16x32_bf16 a[108:111], a[248:251], v[216:219], a[108:111]
  s_waitcnt lgkmcnt(5)
  v_exp_f32 v94, v94
  v_mfma_f32_16x16x32_bf16 a[112:115], a[224:227], v[216:219], a[112:115]
  s_waitcnt lgkmcnt(4)
  v_exp_f32 v95, v95
  v_mfma_f32_16x16x32_bf16 a[112:115], a[228:231], v[220:223], a[112:115]
  ds_read_b128 a[248:251], v5 offset:14336
  v_cvt_pk_bf16_f32 v239, v94, v95
  v_mfma_f32_16x16x32_bf16 a[80:83], a[228:231], v[212:215], a[80:83]
  buffer_load_dwordx4 v2, s[24:27], s99 offen offset:2048 sc1 lds
  v_mfma_f32_16x16x32_bf16 a[80:83], a[224:227], v[208:211], a[80:83]
  ds_read_b128 a[252:255], v5 offset:15360
  v_and_b32 v18, 1, v18
  v_mfma_f32_16x16x32_bf16 a[48:51], a[224:227], v[200:203], a[48:51]
  v_exp_f32 v108, v108
  v_mfma_f32_16x16x32_bf16 a[48:51], a[228:231], v[204:207], a[48:51]
  v_exp_f32 v109, v109
  v_mfma_f32_16x16x32_bf16 a[16:19], a[228:231], v[196:199], a[16:19]
  buffer_load_dwordx4 v2, s[24:27], s99 offen offset:3072 sc1 lds
  v_mfma_f32_16x16x32_bf16 a[16:19], a[224:227], v[192:195], a[16:19]
  s_waitcnt lgkmcnt(4)
  v_mul_u32_u24 v18, 4030, v18
  v_add_u32 v64, v72, v18
  v_mfma_f32_16x16x32_bf16 a[20:23], a[232:235], v[192:195], a[20:23]
  v_add_u32 v65, 0x400, v64
  v_add_u32 v66, 0x800, v64
  v_mfma_f32_16x16x32_bf16 a[20:23], a[236:239], v[196:199], a[20:23]
  s_mov_b32 m0, s80
  v_add_u32 v67, 0xc00, v64
  v_add_u32 v75, s80, v3
  v_mfma_f32_16x16x32_bf16 a[52:55], a[236:239], v[204:207], a[52:55]
  buffer_load_dwordx4 v73, s[8:11], 0 offen lds
  v_mfma_f32_16x16x32_bf16 a[52:55], a[232:235], v[200:203], a[52:55]
  s_add_u32 m0, s80, 1024
  v_lshlrev_b32 v68, 5, v16
  v_lshlrev_b32 v18, 4, v17
  v_mfma_f32_16x16x32_bf16 a[84:87], a[232:235], v[208:211], a[84:87]
  s_mov_b32 s76, 992
  v_sub_u32 v68, v68, v18
  v_add_u32 v68, s78, v68
  v_mfma_f32_16x16x32_bf16 a[84:87], a[236:239], v[212:215], a[84:87]
  v_subrev_u32 v68, 432, v68
  v_cvt_pk_bf16_f32 v246, v108, v109
  v_mfma_f32_16x16x32_bf16 a[116:119], a[236:239], v[220:223], a[116:119]
  buffer_load_dwordx4 v3, s[8:11], s76 offen offset:0 lds
  v_mfma_f32_16x16x32_bf16 a[116:119], a[232:235], v[216:219], a[116:119]
  s_waitcnt lgkmcnt(3)
  ds_read_b128 a[160:163], v4 offset:0
  v_mfma_f32_16x16x32_bf16 a[120:123], a[240:243], v[216:219], a[120:123]
  s_waitcnt lgkmcnt(3)
  v_exp_f32 v110, v110
  v_mfma_f32_16x16x32_bf16 a[120:123], a[244:247], v[220:223], a[120:123]
  ds_read_b128 a[164:167], v4 offset:1024
  v_mfma_f32_16x16x32_bf16 a[88:91], a[244:247], v[212:215], a[88:91]
  buffer_load_dwordx4 v3, s[8:11], s76 offen offset:1024 lds
  v_mfma_f32_16x16x32_bf16 a[88:91], a[240:243], v[208:211], a[88:91]
  ds_read_b128 a[168:171], v4 offset:2048
  v_mfma_f32_16x16x32_bf16 a[56:59], a[240:243], v[200:203], a[56:59]
  v_exp_f32 v111, v111
  v_mfma_f32_16x16x32_bf16 a[56:59], a[244:247], v[204:207], a[56:59]
  ds_read_b128 a[172:175], v4 offset:3072
  v_cvt_pk_bf16_f32 v247, v110, v111
  v_mfma_f32_16x16x32_bf16 a[24:27], a[244:247], v[196:199], a[24:27]
  buffer_load_dwordx4 v3, s[8:11], s76 offen offset:2048 lds
  v_mfma_f32_16x16x32_bf16 a[24:27], a[240:243], v[192:195], a[24:27]
  s_waitcnt lgkmcnt(5)
  ds_read_b128 a[176:179], v4 offset:4096
  v_mfma_f32_16x16x32_bf16 a[28:31], a[248:251], v[192:195], a[28:31]
  s_waitcnt lgkmcnt(5)
  ds_read_b128 a[180:183], v4 offset:5120
  v_mfma_f32_16x16x32_bf16 a[28:31], a[252:255], v[196:199], a[28:31]
  s_mov_b32 s16, s86
  ds_read_b128 a[184:187], v4 offset:6144
  v_mfma_f32_16x16x32_bf16 a[60:63], a[252:255], v[204:207], a[60:63]
  s_mov_b32 s17, s87
  ds_read_b128 a[188:191], v4 offset:7168
  v_mfma_f32_16x16x32_bf16 a[60:63], a[248:251], v[200:203], a[60:63]
  s_mov_b32 s18, 2048
  v_mfma_f32_16x16x32_bf16 a[92:95], a[248:251], v[208:211], a[92:95]
  s_cmp_lg_u32 s30, 7
  buffer_load_ushort v11, off, s[16:19], s79
  v_mfma_f32_16x16x32_bf16 a[92:95], a[252:255], v[212:215], a[92:95]
  v_mfma_f32_16x16x32_bf16 a[124:127], a[252:255], v[220:223], a[124:127]
  v_mfma_f32_16x16x32_bf16 a[124:127], a[248:251], v[216:219], a[124:127]
  s_waitcnt lgkmcnt(7)
  s_cbranch_scc1 L_nomask2
  v_cndmask_b32 v40, v13, v40, s[32:33]
  v_cndmask_b32 v41, v13, v41, s[34:35]
  v_cndmask_b32 v42, v13, v42, s[36:37]
  v_cndmask_b32 v43, v13, v43, s[38:39]
  v_cndmask_b32 v44, v13, v44, s[40:41]
  v_cndmask_b32 v45, v13, v45, s[42:43]
  v_cndmask_b32 v46, v13, v46, s[44:45]
  v_cndmask_b32 v47, v13, v47, s[46:47]
  v_cndmask_b32 v48, v13, v48, s[48:49]
  v_cndmask_b32 v49, v13, v49, s[50:51]
  v_cndmask_b32 v50, v13, v50, s[52:53]
  v_cndmask_b32 v51, v13, v51, s[54:55]
  v_cndmask_b32 v52, v13, v52, s[56:57]
  v_cndmask_b32 v53, v13, v53, s[58:59]
  v_cndmask_b32 v54, v13, v54, s[60:61]
  v_cndmask_b32 v55, v13, v55, s[62:63]
L_nomask2:
  v_mfma_f32_16x16x32_bf16 v[112:115], a[160:163], v[176:179], v[60:63]
  s_waitcnt lgkmcnt(6)
  v_exp_f32 v124, v124
  v_mfma_f32_16x16x32_bf16 v[112:115], a[164:167], v[180:183], v[112:115]
  s_waitcnt lgkmcnt(5)
  v_exp_f32 v125, v125
  v_mfma_f32_16x16x32_bf16 v[112:115], a[168:171], v[184:187], v[112:115]
  s_waitcnt lgkmcnt(4)
  ds_read_b128 a[192:195], v4 offset:8192
  v_cvt_pk_bf16_f32 v254, v124, v125
  v_mfma_f32_16x16x32_bf16 v[112:115], a[172:175], v[188:191], v[112:115]
  s_add_u32 m0, s100, 16384
  ds_read_b128 a[196:199], v4 offset:9216
  v_mov_b32 v24, v40
  v_mfma_f32_16x16x32_bf16 v[96:99], a[172:175], v[172:175], v[40:43]
  s_add_u32 s98, s98, 0x8000
  v_exp_f32 v126, v126
  v_mfma_f32_16x16x32_bf16 v[96:99], a[168:171], v[168:171], v[96:99]
  buffer_load_dwordx4 v2, s[24:27], s98 offen offset:0 sc1 lds
  v_mfma_f32_16x16x32_bf16 v[96:99], a[164:167], v[164:167], v[96:99]
  s_xor_b32 s100, s100, 0x8000
  ds_read_b128 a[200:203], v4 offset:10240
  v_mov_b32 v25, v40
  v_mfma_f32_16x16x32_bf16 v[96:99], a[160:163], v[160:163], v[96:99]
  s_waitcnt lgkmcnt(6)
  ds_read_b128 a[204:207], v4 offset:11264
  v_mov_b32 v26, v40
  v_mfma_f32_16x16x32_bf16 v[100:103], a[176:179], v[160:163], v[44:47]
  s_waitcnt lgkmcnt(6)
  v_exp_f32 v127, v127
  v_mfma_f32_16x16x32_bf16 v[100:103], a[180:183], v[164:167], v[100:103]
  s_waitcnt lgkmcnt(5)
  ds_read_b128 a[208:211], v4 offset:12288
  v_cvt_pk_bf16_f32 v255, v126, v127
  v_mfma_f32_16x16x32_bf16 v[100:103], a[184:187], v[168:171], v[100:103]
  s_waitcnt lgkmcnt(5)
  v_exp_f32 v112, v112
  v_mfma_f32_16x16x32_bf16 v[100:103], a[188:191], v[172:175], v[100:103]
  v_exp_f32 v113, v113
  v_mfma_f32_16x16x32_bf16 v[116:119], a[188:191], v[188:191], v[60:63]
  ds_read_b128 a[212:215], v4 offset:13312
  v_cvt_pk_bf16_f32 v216, v112, v113
  v_mfma_f32_16x16x32_bf16 v[116:119], a[184:187], v[184:187], v[116:119]
  buffer_load_dwordx4 v2, s[24:27], s98 offen offset:1024 sc1 lds
  v_mfma_f32_16x16x32_bf16 v[116:119], a[180:183], v[180:183], v[116:119]
  v_exp_f32 v114, v114
  v_mfma_f32_16x16x32_bf16 v[116:119], a[176:179], v[176:179], v[116:119]
  s_waitcnt lgkmcnt(5)
  ds_read_b128 a[216:219], v4 offset:14336
  v_mov_b32 v27, v40
  v_mfma_f32_16x16x32_bf16 v[120:123], a[192:195], v[176:179], v[60:63]
  s_waitcnt lgkmcnt(5)
  ds_read_b128 a[220:223], v4 offset:15360
  v_mfma_f32_16x16x32_bf16 v[120:123], a[196:199], v[180:183], v[120:123]
  s_waitcnt lgkmcnt(5)
  v_exp_f32 v115, v115
  v_mfma_f32_16x16x32_bf16 v[120:123], a[200:203], v[184:187], v[120:123]
  s_waitcnt lgkmcnt(4)
  ds_read_b128 a[224:227], v5 offset:16384
  v_cvt_pk_bf16_f32 v217, v114, v115
  v_mfma_f32_16x16x32_bf16 v[120:123], a[204:207], v[188:191], v[120:123]
  v_exp_f32 v96, v96
  v_mfma_f32_16x16x32_bf16 v[104:107], a[204:207], v[172:175], v[48:51]
  v_exp_f32 v97, v97
  v_mfma_f32_16x16x32_bf16 v[104:107], a[200:203], v[168:171], v[104:107]
  buffer_load_dwordx4 v2, s[24:27], s98 offen offset:2048 sc1 lds
  v_mfma_f32_16x16x32_bf16 v[104:107], a[196:199], v[164:167], v[104:107]
  ds_read_b128 a[228:231], v5 offset:17408
  v_cvt_pk_bf16_f32 v208, v96, v97
  v_mfma_f32_16x16x32_bf16 v[104:107], a[192:195], v[160:163], v[104:107]
  s_waitcnt lgkmcnt(5)
  v_exp_f32 v98, v98
  v_mfma_f32_16x16x32_bf16 v[108:111], a[208:211], v[160:163], v[52:55]
  s_waitcnt lgkmcnt(4)
  v_exp_f32 v99, v99
  v_mfma_f32_16x16x32_bf16 v[108:111], a[212:215], v[164:167], v[108:111]
  s_waitcnt lgkmcnt(3)
  ds_read_b128 a[232:235], v5 offset:18432
  v_cvt_pk_bf16_f32 v209, v98, v99
  v_mfma_f32_16x16x32_bf16 v[108:111], a[216:219], v[168:171], v[108:111]
  s_waitcnt lgkmcnt(3)
  ds_read_b128 a[236:239], v5 offset:19456
  v_mfma_f32_16x16x32_bf16 v[108:111], a[220:223], v[172:175], v[108:111]
  v_exp_f32 v100, v100
  v_mfma_f32_16x16x32_bf16 v[124:127], a[220:223], v[188:191], v[60:63]
  v_exp_f32 v101, v101
  v_mfma_f32_16x16x32_bf16 v[124:127], a[216:219], v[184:187], v[124:127]
  buffer_load_dwordx4 v2, s[24:27], s98 offen offset:3072 sc1 lds
  v_mfma_f32_16x16x32_bf16 v[124:127], a[212:215], v[180:183], v[124:127]
  s_add_u32 m0, s101, 0
  ds_read_b128 a[240:243], v5 offset:20480
  v_cvt_pk_bf16_f32 v210, v100, v101
  v_mfma_f32_16x16x32_bf16 v[124:127], a[208:211], v[176:179], v[124:127]
  s_add_u32 s99, s99, 0x8000
  v_exp_f32 v102, v102
  v_smfmac_f32_16x16x64_bf16 a[132:135], a[144:147], v[232:239], v20
  v_smfmac_f32_16x16x64_bf16 a[136:139], a[144:147], v[240:247], v20
  v_smfmac_f32_16x16x64_bf16 a[140:143], a[144:147], v[248:255], v20
  s_waitcnt lgkmcnt(4)
  v_mfma_f32_16x16x32_bf16 a[96:99], a[224:227], v[248:251], a[96:99]
  s_waitcnt lgkmcnt(3)
  ds_read_b128 a[244:247], v5 offset:21504
  v_mfma_f32_16x16x32_bf16 a[96:99], a[228:231], v[252:255], a[96:99]
  v_exp_f32 v103, v103
  v_mfma_f32_16x16x32_bf16 a[64:67], a[228:231], v[244:247], a[64:67]
  ds_read_b128 a[248:251], v5 offset:22528
  v_cvt_pk_bf16_f32 v211, v102, v103
  v_mfma_f32_16x16x32_bf16 a[64:67], a[224:227], v[240:243], a[64:67]
  v_exp_f32 v116, v116
  v_mfma_f32_16x16x32_bf16 a[32:35], a[224:227], v[232:235], a[32:35]
  ds_read_b128 a[252:255], v5 offset:23552
  v_mfma_f32_16x16x32_bf16 a[32:35], a[228:231], v[236:239], a[32:35]
  s_waitcnt lgkmcnt(5)
  v_exp_f32 v117, v117
  v_mfma_f32_16x16x32_bf16 a[36:39], a[232:235], v[232:235], a[36:39]
  s_waitcnt lgkmcnt(4)
  ds_read_b128 a[224:227], v5 offset:24576
  v_cvt_pk_bf16_f32 v218, v116, v117
  v_mfma_f32_16x16x32_bf16 a[36:39], a[236:239], v[236:239], a[36:39]
  v_exp_f32 v118, v118
  v_mfma_f32_16x16x32_bf16 a[68:71], a[236:239], v[244:247], a[68:71]
  v_exp_f32 v119, v119
  v_mfma_f32_16x16x32_bf16 a[68:71], a[232:235], v[240:243], a[68:71]
  ds_read_b128 a[228:231], v5 offset:25600
  v_cvt_pk_bf16_f32 v219, v118, v119
  v_mfma_f32_16x16x32_bf16 a[100:103], a[232:235], v[248:251], a[100:103]
  v_exp_f32 v120, v120
  v_mfma_f32_16x16x32_bf16 a[100:103], a[236:239], v[252:255], a[100:103]
  s_waitcnt lgkmcnt(5)
  v_exp_f32 v121, v121
  v_mfma_f32_16x16x32_bf16 a[104:107], a[240:243], v[248:251], a[104:107]
  s_waitcnt lgkmcnt(4)
  ds_read_b128 a[232:235], v5 offset:26624
  v_cvt_pk_bf16_f32 v220, v120, v121
  v_mfma_f32_16x16x32_bf16 a[104:107], a[244:247], v[252:255], a[104:107]
  v_exp_f32 v122, v122
  v_mfma_f32_16x16x32_bf16 a[72:75], a[244:247], v[244:247], a[72:75]
  v_exp_f32 v123, v123
  v_mfma_f32_16x16x32_bf16 a[72:75], a[240:243], v[240:243], a[72:75]
  ds_read_b128 a[236:239], v5 offset:27648
  v_cvt_pk_bf16_f32 v221, v122, v123
  v_mfma_f32_16x16x32_bf16 a[40:43], a[240:243], v[232:235], a[40:43]
  v_exp_f32 v104, v104
  v_mfma_f32_16x16x32_bf16 a[40:43], a[244:247], v[236:239], a[40:43]
  s_waitcnt vmcnt(18) lgkmcnt(5)
  v_exp_f32 v105, v105
  v_mfma_f32_16x16x32_bf16 a[44:47], a[248:251], v[232:235], a[44:47]
  s_barrier
  s_waitcnt lgkmcnt(4)
  v_mfma_f32_16x16x32_bf16 a[44:47], a[252:255], v[236:239], a[44:47]
  buffer_load_dwordx4 v2, s[24:27], s99 offen offset:0 sc1 lds
  v_mfma_f32_16x16x32_bf16 a[76:79], a[252:255], v[244:247], a[76:79]
  ds_read_b128 a[240:243], v5 offset:28672
  v_cvt_pk_bf16_f32 v212, v104, v105
  v_mfma_f32_16x16x32_bf16 a[76:79], a[248:251], v[240:243], a[76:79]
  v_exp_f32 v106, v106
  v_mfma_f32_16x16x32_bf16 a[108:111], a[248:251], v[248:251], a[108:111]
  ds_read_b128 a[244:247], v5 offset:29696
  v_and_b32 v16, 15, v1
  v_mfma_f32_16x16x32_bf16 a[108:111], a[252:255], v[252:255], a[108:111]
  s_waitcnt lgkmcnt(5)
  v_exp_f32 v107, v107
  v_mfma_f32_16x16x32_bf16 a[112:115], a[224:227], v[248:251], a[112:115]
  s_waitcnt lgkmcnt(4)
  buffer_load_dwordx4 v2, s[24:27], s99 offen offset:1024 sc1 lds
  v_mfma_f32_16x16x32_bf16 a[112:115], a[228:231], v[252:255], a[112:115]
  ds_read_b128 a[248:251], v5 offset:30720
  v_cvt_pk_bf16_f32 v213, v106, v107
  v_mfma_f32_16x16x32_bf16 a[80:83], a[228:231], v[244:247], a[80:83]
  v_exp_f32 v108, v108
  v_mfma_f32_16x16x32_bf16 a[80:83], a[224:227], v[240:243], a[80:83]
  ds_read_b128 a[252:255], v5 offset:31744
  v_lshrrev_b32 v17, 4, v1
  v_mfma_f32_16x16x32_bf16 a[48:51], a[224:227], v[232:235], a[48:51]
  v_exp_f32 v109, v109
  v_mfma_f32_16x16x32_bf16 a[48:51], a[228:231], v[236:239], a[48:51]
  s_waitcnt lgkmcnt(5)
  buffer_load_dwordx4 v2, s[24:27], s99 offen offset:2048 sc1 lds
  v_mfma_f32_16x16x32_bf16 a[52:55], a[232:235], v[232:235], a[52:55]
  s_waitcnt lgkmcnt(4)
  ds_read_b128 a[160:163], v4 offset:16384
  v_cvt_pk_bf16_f32 v214, v108, v109
  v_mfma_f32_16x16x32_bf16 a[52:55], a[236:239], v[236:239], a[52:55]
  v_exp_f32 v110, v110
  v_mfma_f32_16x16x32_bf16 a[84:87], a[236:239], v[244:247], a[84:87]
  ds_read_b128 a[164:167], v4 offset:17408
  v_xor_b32 v5, 0x8000, v5
  v_mfma_f32_16x16x32_bf16 a[84:87], a[232:235], v[240:243], a[84:87]
  ds_read_b128 a[168:171], v4 offset:18432
  v_lshl_add_u32 v16, v17, 3, v16
  v_mfma_f32_16x16x32_bf16 a[116:119], a[232:235], v[248:251], a[116:119]
  buffer_load_dwordx4 v2, s[24:27], s99 offen offset:3072 sc1 lds
  v_mfma_f32_16x16x32_bf16 a[116:119], a[236:239], v[252:255], a[116:119]
  s_waitcnt lgkmcnt(6)
  v_exp_f32 v111, v111
  v_mfma_f32_16x16x32_bf16 a[120:123], a[240:243], v[248:251], a[120:123]
  s_waitcnt lgkmcnt(5)
  ds_read_b128 a[172:175], v4 offset:19456
  v_cvt_pk_bf16_f32 v215, v110, v111
  v_mfma_f32_16x16x32_bf16 a[120:123], a[244:247], v[252:255], a[120:123]
  ds_read_b128 a[176:179], v4 offset:20480
  v_sub_u32 v16, 15, v16
  v_mfma_f32_16x16x32_bf16 a[88:91], a[244:247], v[244:247], a[88:91]
  ds_read_b128 a[180:183], v4 offset:21504
  v_and_b32 v17, 1, v16
  v_mfma_f32_16x16x32_bf16 a[88:91], a[240:243], v[240:243], a[88:91]
  buffer_load_dwordx4 v[76:79], v74, s[8:11], 0 offen offset:4000
  v_mfma_f32_16x16x32_bf16 a[56:59], a[240:243], v[232:235], a[56:59]
  ds_read_b128 a[184:187], v4 offset:22528
  v_lshlrev_b32 v17, 4, v17
  v_mfma_f32_16x16x32_bf16 a[56:59], a[244:247], v[236:239], a[56:59]
  s_waitcnt vmcnt(9) lgkmcnt(8)
  ds_read_b128 a[188:191], v4 offset:23552
  v_lshlrev_b32 v17, v17, v11
  v_mfma_f32_16x16x32_bf16 a[60:63], a[248:251], v[232:235], a[60:63]
  s_waitcnt lgkmcnt(8)
  v_ashrrev_i32 v16, 1, v16
  v_cmp_eq_u32 vcc, 0, v16
  v_mfma_f32_16x16x32_bf16 a[60:63], a[252:255], v[236:239], a[60:63]
  v_mfma_f32_16x16x32_bf16 a[92:95], a[252:255], v[244:247], a[92:95]
  v_cndmask_b32 v56, 0, v17, vcc
  v_cmp_eq_u32 vcc, 1, v16
  v_mfma_f32_16x16x32_bf16 a[92:95], a[248:251], v[240:243], a[92:95]
  v_mfma_f32_16x16x32_bf16 a[124:127], a[248:251], v[248:251], a[124:127]
  v_cndmask_b32 v57, 0, v17, vcc
  v_cmp_eq_u32 vcc, 2, v16
  v_mfma_f32_16x16x32_bf16 a[124:127], a[252:255], v[252:255], a[124:127]
  s_waitcnt lgkmcnt(7)
  v_cndmask_b32 v58, 0, v17, vcc
  v_cmp_eq_u32 vcc, 3, v16
  s_nop 1
  v_cndmask_b32 v59, 0, v17, vcc
  s_lshl_b32 s3, s29, 15
  s_lshl_b32 s31, s28, 10
  s_add_u32 s3, s3, s31
  s_add_u32 s4, s94, s3
  s_addc_u32 s5, s95, 0
  s_add_u32 s4, s4, 0x2000000
  s_addc_u32 s5, s5, 0
  s_mov_b32 s6, 0xf07400
  s_mov_b32 s7, 0x20000
  s_lshl_b32 s87, s30, 20
  v_accvgpr_read_b32 v14, a128
  v_accvgpr_read_b32 v22, a129
  v_add_f32 v14, v14, v22
  v_rcp_f32 v22, v14
  v_accvgpr_read_b32 v192, a0
  v_accvgpr_read_b32 v193, a1
  v_accvgpr_read_b32 v194, a2
  v_accvgpr_read_b32 v195, a3
  v_accvgpr_read_b32 v196, a4
  v_accvgpr_read_b32 v197, a5
  v_accvgpr_read_b32 v198, a6
  v_accvgpr_read_b32 v199, a7
  v_mul_f32 v192, v192, v22
  v_mul_f32 v193, v193, v22
  v_mul_f32 v194, v194, v22
  v_mul_f32 v195, v195, v22
  v_mul_f32 v196, v196, v22
  v_mul_f32 v197, v197, v22
  v_mul_f32 v198, v198, v22
  v_mul_f32 v199, v199, v22
  v_cvt_pk_bf16_f32 v200, v192, v193
  v_cvt_pk_bf16_f32 v201, v194, v195
  v_cvt_pk_bf16_f32 v202, v196, v197
  v_cvt_pk_bf16_f32 v203, v198, v199
  s_add_u32 s86, s87, 0x0
  buffer_store_dwordx4 v[200:203], v3, s[4:7], s86 offen sc1
  v_accvgpr_read_b32 v224, a8
  v_accvgpr_read_b32 v225, a9
  v_accvgpr_read_b32 v226, a10
  v_accvgpr_read_b32 v227, a11
  v_accvgpr_read_b32 v228, a12
  v_accvgpr_read_b32 v229, a13
  v_accvgpr_read_b32 v230, a14
  v_accvgpr_read_b32 v231, a15
  v_mul_f32 v224, v224, v22
  v_mul_f32 v225, v225, v22
  v_mul_f32 v226, v226, v22
  v_mul_f32 v227, v227, v22
  v_mul_f32 v228, v228, v22
  v_mul_f32 v229, v229, v22
  v_mul_f32 v230, v230, v22
  v_mul_f32 v231, v231, v22
  v_cvt_pk_bf16_f32 v232, v224, v225
  v_cvt_pk_bf16_f32 v233, v226, v227
  v_cvt_pk_bf16_f32 v234, v228, v229
  v_cvt_pk_bf16_f32 v235, v230, v231
  s_add_u32 s86, s87, 0x2000
  buffer_store_dwordx4 v[232:235], v3, s[4:7], s86 offen sc1
  v_accvgpr_read_b32 v192, a16
  v_accvgpr_read_b32 v193, a17
  v_accvgpr_read_b32 v194, a18
  v_accvgpr_read_b32 v195, a19
  v_accvgpr_read_b32 v196, a20
  v_accvgpr_read_b32 v197, a21
  v_accvgpr_read_b32 v198, a22
  v_accvgpr_read_b32 v199, a23
  v_mul_f32 v192, v192, v22
  v_mul_f32 v193, v193, v22
  v_mul_f32 v194, v194, v22
  v_mul_f32 v195, v195, v22
  v_mul_f32 v196, v196, v22
  v_mul_f32 v197, v197, v22
  v_mul_f32 v198, v198, v22
  v_mul_f32 v199, v199, v22
  v_cvt_pk_bf16_f32 v200, v192, v193
  v_cvt_pk_bf16_f32 v201, v194, v195
  v_cvt_pk_bf16_f32 v202, v196, v197
  v_cvt_pk_bf16_f32 v203, v198, v199
  s_add_u32 s86, s87, 0x4000
  buffer_store_dwordx4 v[200:203], v3, s[4:7], s86 offen sc1
  v_accvgpr_read_b32 v224, a24
  v_accvgpr_read_b32 v225, a25
  v_accvgpr_read_b32 v226, a26
  v_accvgpr_read_b32 v227, a27
  v_accvgpr_read_b32 v228, a28
  v_accvgpr_read_b32 v229, a29
  v_accvgpr_read_b32 v230, a30
  v_accvgpr_read_b32 v231, a31
  v_mul_f32 v224, v224, v22
  v_mul_f32 v225, v225, v22
  v_mul_f32 v226, v226, v22
  v_mul_f32 v227, v227, v22
  v_mul_f32 v228, v228, v22
  v_mul_f32 v229, v229, v22
  v_mul_f32 v230, v230, v22
  v_mul_f32 v231, v231, v22
  v_cvt_pk_bf16_f32 v232, v224, v225
  v_cvt_pk_bf16_f32 v233, v226, v227
  v_cvt_pk_bf16_f32 v234, v228, v229
L_pad12:
  s_cbranch_execz L_hr1
  v_cvt_pk_bf16_f32 v235, v230, v231
  s_add_u32 s86, s87, 0x6000
  buffer_store_dwordx4 v[232:235], v3, s[4:7], s86 offen sc1
  v_accvgpr_read_b32 v15, a132
  v_accvgpr_read_b32 v12, a133
  v_add_f32 v15, v15, v12
  v_rcp_f32 v12, v15
  v_accvgpr_read_b32 v192, a32
  v_accvgpr_read_b32 v193, a33
  v_accvgpr_read_b32 v194, a34
  v_accvgpr_read_b32 v195, a35
  v_accvgpr_read_b32 v196, a36
  v_accvgpr_read_b32 v197, a37
  v_accvgpr_read_b32 v198, a38
  v_accvgpr_read_b32 v199, a39
  v_mul_f32 v192, v192, v12
  v_mul_f32 v193, v193, v12
  v_mul_f32 v194, v194, v12
  v_mul_f32 v195, v195, v12
  v_mul_f32 v196, v196, v12
  v_mul_f32 v197, v197, v12
  v_mul_f32 v198, v198, v12
  v_mul_f32 v199, v199, v12
  v_cvt_pk_bf16_f32 v200, v192, v193
  v_cvt_pk_bf16_f32 v201, v194, v195
  v_cvt_pk_bf16_f32 v202, v196, v197
  v_cvt_pk_bf16_f32 v203, v198, v199
  s_add_u32 s86, s87, 0x1000
  buffer_store_dwordx4 v[200:203], v3, s[4:7], s86 offen sc1
  v_accvgpr_read_b32 v224, a40
  v_accvgpr_read_b32 v225, a41
  v_accvgpr_read_b32 v226, a42
  v_accvgpr_read_b32 v227, a43
  v_accvgpr_read_b32 v228, a44
  v_accvgpr_read_b32 v229, a45
  v_accvgpr_read_b32 v230, a46
  v_accvgpr_read_b32 v231, a47
  v_mul_f32 v224, v224, v12
  v_mul_f32 v225, v225, v12
  v_mul_f32 v226, v226, v12
  v_mul_f32 v227, v227, v12
  v_mul_f32 v228, v228, v12
  v_mul_f32 v229, v229, v12
  v_mul_f32 v230, v230, v12
  v_mul_f32 v231, v231, v12
  v_cvt_pk_bf16_f32 v232, v224, v225
  v_cvt_pk_bf16_f32 v233, v226, v227
  v_cvt_pk_bf16_f32 v234, v228, v229
  v_cvt_pk_bf16_f32 v235, v230, v231
  s_add_u32 s86, s87, 0x3000
  buffer_store_dwordx4 v[232:235], v3, s[4:7], s86 offen sc1
  v_accvgpr_read_b32 v192, a48
  v_accvgpr_read_b32 v193, a49
  v_accvgpr_read_b32 v194, a50
  v_accvgpr_read_b32 v195, a51
  v_accvgpr_read_b32 v196, a52
  v_accvgpr_read_b32 v197, a53
  v_accvgpr_read_b32 v198, a54
  v_accvgpr_read_b32 v199, a55
  v_mul_f32 v192, v192, v12
  v_mul_f32 v193, v193, v12
  v_mul_f32 v194, v194, v12
  v_mul_f32 v195, v195, v12
  v_mul_f32 v196, v196, v12
  v_mul_f32 v197, v197, v12
  v_mul_f32 v198, v198, v12
  v_mul_f32 v199, v199, v12
  v_cvt_pk_bf16_f32 v200, v192, v193
  v_cvt_pk_bf16_f32 v201, v194, v195
  v_cvt_pk_bf16_f32 v202, v196, v197
  v_cvt_pk_bf16_f32 v203, v198, v199
  s_add_u32 s86, s87, 0x5000
  buffer_store_dwordx4 v[200:203], v3, s[4:7], s86 offen sc1
  v_accvgpr_read_b32 v224, a56
  v_accvgpr_read_b32 v225, a57
  v_accvgpr_read_b32 v226, a58
  v_accvgpr_read_b32 v227, a59
  v_accvgpr_read_b32 v228, a60
  v_accvgpr_read_b32 v229, a61
  v_accvgpr_read_b32 v230, a62
  v_accvgpr_read_b32 v231, a63
  v_mul_f32 v224, v224, v12
  v_mul_f32 v225, v225, v12
  v_mul_f32 v226, v226, v12
  v_mul_f32 v227, v227, v12
  v_mul_f32 v228, v228, v12
  v_mul_f32 v229, v229, v12
  v_mul_f32 v230, v230, v12
  v_mul_f32 v231, v231, v12
  v_cvt_pk_bf16_f32 v232, v224, v225
  v_cvt_pk_bf16_f32 v233, v226, v227
  v_cvt_pk_bf16_f32 v234, v228, v229
  v_cvt_pk_bf16_f32 v235, v230, v231
  s_add_u32 s86, s87, 0x7000
  buffer_store_dwordx4 v[232:235], v3, s[4:7], s86 offen sc1
  v_add_f32 v22, v14, v15
  v_cmp_ngt_f32 vcc, 0x5d800000, v22
  s_nop 2
  s_mov_b64 s[70:71], vcc
  s_xor_b32 s31, s30, 15
  s_sub_u32 s31, s31, s30
  s_sub_u32 s31, s31, 1
  s_lshr_b32 s82, s82, 1
  s_bitcmp1_b32 s82, 0
  s_cselect_b32 s3, 0, s31
  s_cmp_lt_u32 s3, 2
  s_cbranch_scc1 L_ev2
.p2align 6
L_loop2:
  v_mfma_f32_16x16x32_bf16 v[112:115], a[160:163], v[176:179], v[60:63]
  s_waitcnt lgkmcnt(5)
  v_exp_f32 v124, v124
  v_mfma_f32_16x16x32_bf16 v[112:115], a[164:167], v[180:183], v[112:115]
  s_waitcnt lgkmcnt(4)
  v_exp_f32 v125, v125
  v_mfma_f32_16x16x32_bf16 v[112:115], a[168:171], v[184:187], v[112:115]
  s_waitcnt lgkmcnt(3)
  ds_read_b128 a[204:207], v4 offset:27648
  v_cvt_pk_bf16_f32 v222, v124, v125
  v_mfma_f32_16x16x32_bf16 v[112:115], a[172:175], v[188:191], v[112:115]
  s_add_u32 m0, s100, 0
  ds_read_b128 a[196:199], v4 offset:25600
  v_mfma_f32_16x16x32_bf16 v[96:99], a[172:175], v[172:175], v[24:27]
  s_add_u32 s98, s98, 0x8000
  v_exp_f32 v126, v126
  v_mfma_f32_16x16x32_bf16 v[96:99], a[168:171], v[168:171], v[96:99]
  ds_read_b128 a[192:195], v4 offset:24576
  buffer_load_dwordx4 v2, s[24:27], s98 offen offset:0 sc1 lds
  v_mfma_f32_16x16x32_bf16 v[96:99], a[164:167], v[164:167], v[96:99]
  v_exp_f32 v127, v127
  v_mfma_f32_16x16x32_bf16 v[96:99], a[160:163], v[160:163], v[96:99]
  s_waitcnt lgkmcnt(5)
  ds_read_b128 a[208:211], v4 offset:28672
  v_cvt_pk_bf16_f32 v223, v126, v127
  v_mfma_f32_16x16x32_bf16 v[100:103], a[176:179], v[160:163], v[24:27]
  s_waitcnt lgkmcnt(6)
  v_exp_f32 v112, v112
  v_mfma_f32_16x16x32_bf16 v[100:103], a[180:183], v[164:167], v[100:103]
  s_waitcnt lgkmcnt(5)
  v_exp_f32 v113, v113
  v_mfma_f32_16x16x32_bf16 v[100:103], a[184:187], v[168:171], v[100:103]
  s_waitcnt lgkmcnt(4)
  ds_read_b128 a[200:203], v4 offset:26624
  v_cvt_pk_bf16_f32 v248, v112, v113
  v_mfma_f32_16x16x32_bf16 v[100:103], a[188:191], v[172:175], v[100:103]
  ds_read_b128 a[212:215], v4 offset:29696
  v_mfma_f32_16x16x32_bf16 v[116:119], a[188:191], v[188:191], v[60:63]
  ds_read_b128 a[228:231], v5 offset:1024
  buffer_load_dwordx4 v2, s[24:27], s98 offen offset:1024 sc1 lds
  v_mfma_f32_16x16x32_bf16 v[116:119], a[184:187], v[184:187], v[116:119]
  v_exp_f32 v115, v115
  v_mfma_f32_16x16x32_bf16 v[116:119], a[180:183], v[180:183], v[116:119]
  ds_read_b128 a[216:219], v4 offset:30720
  v_exp_f32 v97, v97
  v_mfma_f32_16x16x32_bf16 v[116:119], a[176:179], v[176:179], v[116:119]
  s_waitcnt lgkmcnt(5)
  v_exp_f32 v98, v98
  v_mfma_f32_16x16x32_bf16 v[120:123], a[192:195], v[176:179], v[60:63]
  v_exp_f32 v96, v96
  v_mfma_f32_16x16x32_bf16 v[120:123], a[196:199], v[180:183], v[120:123]
  s_waitcnt lgkmcnt(3)
  ds_read_b128 a[224:227], v5 offset:0
  v_cvt_pk_bf16_f32 v240, v96, v97
  v_mfma_f32_16x16x32_bf16 v[120:123], a[200:203], v[184:187], v[120:123]
  v_exp_f32 v114, v114
  v_mfma_f32_16x16x32_bf16 v[120:123], a[204:207], v[188:191], v[120:123]
  buffer_load_dwordx4 v2, s[24:27], s98 offen offset:2048 sc1 lds
  v_mfma_f32_16x16x32_bf16 v[104:107], a[204:207], v[172:175], v[24:27]
  ds_read_b128 a[220:223], v4 offset:31744
  v_cvt_pk_bf16_f32 v249, v114, v115
  v_mfma_f32_16x16x32_bf16 v[104:107], a[200:203], v[168:171], v[104:107]
  v_exp_f32 v99, v99
  v_mfma_f32_16x16x32_bf16 v[104:107], a[196:199], v[164:167], v[104:107]
  ds_read_b128 a[236:239], v5 offset:3072
  v_cvt_pk_bf16_f32 v241, v98, v99
  v_mfma_f32_16x16x32_bf16 v[104:107], a[192:195], v[160:163], v[104:107]
  v_exp_f32 v100, v100
  v_mfma_f32_16x16x32_bf16 v[108:111], a[208:211], v[160:163], v[24:27]
  s_waitcnt lgkmcnt(5)
  v_exp_f32 v102, v102
  v_mfma_f32_16x16x32_bf16 v[108:111], a[212:215], v[164:167], v[108:111]
  s_waitcnt lgkmcnt(3)
  v_exp_f32 v103, v103
  v_mfma_f32_16x16x32_bf16 v[108:111], a[216:219], v[168:171], v[108:111]
  s_waitcnt lgkmcnt(1)
  buffer_load_dwordx4 v2, s[24:27], s98 offen offset:3072 sc1 lds
  v_mfma_f32_16x16x32_bf16 v[108:111], a[220:223], v[172:175], v[108:111]
  s_add_u32 m0, s101, 16384
  ds_read_b128 a[244:247], v5 offset:5120
  v_cvt_pk_bf16_f32 v243, v102, v103
  v_mfma_f32_16x16x32_bf16 v[124:127], a[220:223], v[188:191], v[60:63]
  s_add_u32 s99, s99, 0x8000
  ds_read_b128 a[240:243], v5 offset:4096
  v_xor_b32 v4, 0x8000, v4
  v_mfma_f32_16x16x32_bf16 v[124:127], a[216:219], v[184:187], v[124:127]
  v_exp_f32 v101, v101
  v_mfma_f32_16x16x32_bf16 v[124:127], a[212:215], v[180:183], v[124:127]
  ds_read_b128 a[232:235], v5 offset:2048
  v_cvt_pk_bf16_f32 v242, v100, v101
  v_mfma_f32_16x16x32_bf16 v[124:127], a[208:211], v[176:179], v[124:127]
  v_exp_f32 v116, v116
  v_smfmac_f32_16x16x64_bf16 a[136:139], a[144:147], v[208:215], v20
  v_smfmac_f32_16x16x64_bf16 a[140:143], a[144:147], v[216:223], v20
  s_waitcnt vmcnt(12)
  v_mfma_f32_16x16x32_bf16 a[96:99], a[224:227], v[216:219], a[96:99]
  s_barrier
  v_mfma_f32_16x16x32_bf16 a[96:99], a[228:231], v[220:223], a[96:99]
  buffer_load_dwordx4 v2, s[24:27], s99 offen offset:0 sc1 lds
  v_mfma_f32_16x16x32_bf16 a[64:67], a[228:231], v[212:215], a[64:67]
  s_xor_b32 s101, s101, 0x8000
  v_exp_f32 v117, v117
  v_mfma_f32_16x16x32_bf16 a[64:67], a[224:227], v[208:211], a[64:67]
  s_waitcnt lgkmcnt(0)
  ds_read_b128 a[248:251], v5 offset:6144
  v_cvt_pk_bf16_f32 v250, v116, v117
  v_mfma_f32_16x16x32_bf16 a[68:71], a[232:235], v[208:211], a[68:71]
  ds_read_b128 a[252:255], v5 offset:7168
  v_mfma_f32_16x16x32_bf16 a[68:71], a[236:239], v[212:215], a[68:71]
  v_exp_f32 v118, v118
  v_mfma_f32_16x16x32_bf16 a[100:103], a[236:239], v[220:223], a[100:103]
  v_exp_f32 v119, v119
  v_mfma_f32_16x16x32_bf16 a[100:103], a[232:235], v[216:219], a[100:103]
  ds_read_b128 a[224:227], v5 offset:8192
  v_exp_f32 v120, v120
  v_mfma_f32_16x16x32_bf16 a[104:107], a[240:243], v[216:219], a[104:107]
  buffer_load_dwordx4 v2, s[24:27], s99 offen offset:1024 sc1 lds
  v_mfma_f32_16x16x32_bf16 a[104:107], a[244:247], v[220:223], a[104:107]
  ds_read_b128 a[228:231], v5 offset:9216
  v_cvt_pk_bf16_f32 v251, v118, v119
  v_mfma_f32_16x16x32_bf16 a[72:75], a[244:247], v[212:215], a[72:75]
  v_exp_f32 v121, v121
  v_mfma_f32_16x16x32_bf16 a[72:75], a[240:243], v[208:211], a[72:75]
  s_waitcnt lgkmcnt(3)
  v_exp_f32 v122, v122
  v_mfma_f32_16x16x32_bf16 a[76:79], a[248:251], v[208:211], a[76:79]
  s_waitcnt lgkmcnt(2)
  ds_read_b128 a[240:243], v5 offset:12288
  v_cvt_pk_bf16_f32 v252, v120, v121
  v_mfma_f32_16x16x32_bf16 a[76:79], a[252:255], v[212:215], a[76:79]
  v_exp_f32 v106, v106
  v_mfma_f32_16x16x32_bf16 a[108:111], a[252:255], v[220:223], a[108:111]
  ds_read_b128 a[232:235], v5 offset:10240
  v_mfma_f32_16x16x32_bf16 a[108:111], a[248:251], v[216:219], a[108:111]
  s_waitcnt lgkmcnt(3)
  ds_read_b128 a[236:239], v5 offset:11264
  v_mfma_f32_16x16x32_bf16 a[112:115], a[224:227], v[216:219], a[112:115]
  s_waitcnt lgkmcnt(3)
  ds_read_b128 a[244:247], v5 offset:13312
  buffer_load_dwordx4 v2, s[24:27], s99 offen offset:2048 sc1 lds
  v_mfma_f32_16x16x32_bf16 a[112:115], a[228:231], v[220:223], a[112:115]
  ds_read_b128 a[248:251], v5 offset:14336
  v_exp_f32 v105, v105
  v_mfma_f32_16x16x32_bf16 a[80:83], a[228:231], v[212:215], a[80:83]
  v_exp_f32 v123, v123
  v_mfma_f32_16x16x32_bf16 a[80:83], a[224:227], v[208:211], a[80:83]
  s_waitcnt lgkmcnt(3)
  ds_read_b128 a[172:175], v4 offset:3072
  v_cvt_pk_bf16_f32 v253, v122, v123
  v_mfma_f32_16x16x32_bf16 a[84:87], a[232:235], v[208:211], a[84:87]
  s_waitcnt lgkmcnt(3)
  v_exp_f32 v104, v104
  v_mfma_f32_16x16x32_bf16 a[84:87], a[236:239], v[212:215], a[84:87]
  v_exp_f32 v108, v108
  v_mfma_f32_16x16x32_bf16 a[116:119], a[236:239], v[220:223], a[116:119]
  ds_read_b128 a[252:255], v5 offset:15360
  v_exp_f32 v107, v107
  v_mfma_f32_16x16x32_bf16 a[116:119], a[232:235], v[216:219], a[116:119]
  ds_read_b128 a[160:163], v4 offset:0
  v_cvt_pk_bf16_f32 v245, v106, v107
  v_mfma_f32_16x16x32_bf16 a[120:123], a[240:243], v[216:219], a[120:123]
  s_waitcnt lgkmcnt(4)
  ds_read_b128 a[164:167], v4 offset:1024
  buffer_load_dwordx4 v2, s[24:27], s99 offen offset:3072 sc1 lds
  v_mfma_f32_16x16x32_bf16 a[120:123], a[244:247], v[220:223], a[120:123]
  ds_read_b128 a[168:171], v4 offset:2048
  v_exp_f32 v109, v109
  v_mfma_f32_16x16x32_bf16 a[88:91], a[244:247], v[212:215], a[88:91]
  v_exp_f32 v110, v110
  v_mfma_f32_16x16x32_bf16 a[88:91], a[240:243], v[208:211], a[88:91]
  s_waitcnt lgkmcnt(5)
  ds_read_b128 a[176:179], v4 offset:4096
  v_cvt_pk_bf16_f32 v244, v104, v105
  v_mfma_f32_16x16x32_bf16 a[92:95], a[248:251], v[208:211], a[92:95]
  s_waitcnt lgkmcnt(4)
  v_exp_f32 v111, v111
  v_mfma_f32_16x16x32_bf16 a[92:95], a[252:255], v[212:215], a[92:95]
  ds_read_b128 a[180:183], v4 offset:5120
  v_cvt_pk_bf16_f32 v246, v108, v109
  v_mfma_f32_16x16x32_bf16 a[124:127], a[252:255], v[220:223], a[124:127]
  ds_read_b128 a[184:187], v4 offset:6144
  v_cvt_pk_bf16_f32 v247, v110, v111
  v_mfma_f32_16x16x32_bf16 a[124:127], a[248:251], v[216:219], a[124:127]
  s_waitcnt lgkmcnt(5)
  ds_read_b128 a[188:191], v4 offset:7168
  v_mfma_f32_16x16x32_bf16 v[112:115], a[160:163], v[176:179], v[60:63]
  s_waitcnt lgkmcnt(5)
  ds_read_b128 a[192:195], v4 offset:8192
  v_mfma_f32_16x16x32_bf16 v[112:115], a[164:167], v[180:183], v[112:115]
  s_waitcnt lgkmcnt(5)
  ds_read_b128 a[196:199], v4 offset:9216
  v_exp_f32 v125, v125
  v_mfma_f32_16x16x32_bf16 v[112:115], a[168:171], v[184:187], v[112:115]
  ds_read_b128 a[200:203], v4 offset:10240
  v_mfma_f32_16x16x32_bf16 v[112:115], a[172:175], v[188:191], v[112:115]
  s_add_u32 m0, s100, 16384
  ds_read_b128 a[204:207], v4 offset:11264
  v_exp_f32 v124, v124
  v_mfma_f32_16x16x32_bf16 v[96:99], a[172:175], v[172:175], v[40:43]
  s_add_u32 s98, s98, 0x8000
  v_exp_f32 v127, v127
  v_mfma_f32_16x16x32_bf16 v[96:99], a[168:171], v[168:171], v[96:99]
  buffer_load_dwordx4 v2, s[24:27], s98 offen offset:0 sc1 lds
  v_mfma_f32_16x16x32_bf16 v[96:99], a[164:167], v[164:167], v[96:99]
  s_xor_b32 s100, s100, 0x8000
  ds_read_b128 a[208:211], v4 offset:12288
  v_cvt_pk_bf16_f32 v254, v124, v125
  v_mfma_f32_16x16x32_bf16 v[96:99], a[160:163], v[160:163], v[96:99]
  s_waitcnt lgkmcnt(8)
  v_exp_f32 v115, v115
  v_mfma_f32_16x16x32_bf16 v[100:103], a[176:179], v[160:163], v[44:47]
  s_waitcnt lgkmcnt(7)
  v_exp_f32 v126, v126
  v_mfma_f32_16x16x32_bf16 v[100:103], a[180:183], v[164:167], v[100:103]
  s_waitcnt lgkmcnt(6)
  ds_read_b128 a[212:215], v4 offset:13312
  v_cvt_pk_bf16_f32 v255, v126, v127
  v_mfma_f32_16x16x32_bf16 v[100:103], a[184:187], v[168:171], v[100:103]
  s_waitcnt lgkmcnt(6)
  v_exp_f32 v112, v112
  v_mfma_f32_16x16x32_bf16 v[100:103], a[188:191], v[172:175], v[100:103]
  v_exp_f32 v96, v96
  v_mfma_f32_16x16x32_bf16 v[116:119], a[188:191], v[188:191], v[60:63]
  buffer_load_dwordx4 v2, s[24:27], s98 offen offset:1024 sc1 lds
  v_mfma_f32_16x16x32_bf16 v[116:119], a[184:187], v[184:187], v[116:119]
  v_exp_f32 v98, v98
  v_mfma_f32_16x16x32_bf16 v[116:119], a[180:183], v[180:183], v[116:119]
  v_exp_f32 v113, v113
  v_mfma_f32_16x16x32_bf16 v[116:119], a[176:179], v[176:179], v[116:119]
  s_waitcnt lgkmcnt(5)
  ds_read_b128 a[224:227], v5 offset:16384
  v_cvt_pk_bf16_f32 v216, v112, v113
  v_mfma_f32_16x16x32_bf16 v[120:123], a[192:195], v[176:179], v[60:63]
  s_waitcnt lgkmcnt(5)
  ds_read_b128 a[228:231], v5 offset:17408
  v_exp_f32 v114, v114
  v_mfma_f32_16x16x32_bf16 v[120:123], a[196:199], v[180:183], v[120:123]
  s_waitcnt lgkmcnt(5)
  ds_read_b128 a[216:219], v4 offset:14336
  v_cvt_pk_bf16_f32 v217, v114, v115
  v_mfma_f32_16x16x32_bf16 v[120:123], a[200:203], v[184:187], v[120:123]
  s_waitcnt lgkmcnt(5)
  v_exp_f32 v99, v99
  v_mfma_f32_16x16x32_bf16 v[120:123], a[204:207], v[188:191], v[120:123]
  buffer_load_dwordx4 v2, s[24:27], s98 offen offset:2048 sc1 lds
  v_mfma_f32_16x16x32_bf16 v[104:107], a[204:207], v[172:175], v[48:51]
  ds_read_b128 a[220:223], v4 offset:15360
  v_cvt_pk_bf16_f32 v209, v98, v99
  v_mfma_f32_16x16x32_bf16 v[104:107], a[200:203], v[168:171], v[104:107]
  ds_read_b128 a[236:239], v5 offset:19456
  v_mfma_f32_16x16x32_bf16 v[104:107], a[196:199], v[164:167], v[104:107]
  ds_read_b128 a[248:251], v5 offset:22528
  v_exp_f32 v97, v97
  v_mfma_f32_16x16x32_bf16 v[104:107], a[192:195], v[160:163], v[104:107]
  s_waitcnt lgkmcnt(7)
  ds_read_b128 a[244:247], v5 offset:21504
  v_cvt_pk_bf16_f32 v208, v96, v97
  v_mfma_f32_16x16x32_bf16 v[108:111], a[208:211], v[160:163], v[52:55]
  s_waitcnt lgkmcnt(7)
  v_exp_f32 v101, v101
  v_mfma_f32_16x16x32_bf16 v[108:111], a[212:215], v[164:167], v[108:111]
  s_waitcnt lgkmcnt(4)
  ds_read_b128 a[240:243], v5 offset:20480
  v_exp_f32 v100, v100
  v_mfma_f32_16x16x32_bf16 v[108:111], a[216:219], v[168:171], v[108:111]
  s_waitcnt lgkmcnt(4)
  buffer_load_dwordx4 v2, s[24:27], s98 offen offset:3072 sc1 lds
  v_mfma_f32_16x16x32_bf16 v[108:111], a[220:223], v[172:175], v[108:111]
  s_add_u32 m0, s101, 0
  ds_read_b128 a[232:235], v5 offset:18432
  v_cvt_pk_bf16_f32 v210, v100, v101
  v_mfma_f32_16x16x32_bf16 v[124:127], a[220:223], v[188:191], v[60:63]
  s_add_u32 s99, s99, 0x8000
  v_exp_f32 v102, v102
  v_mfma_f32_16x16x32_bf16 v[124:127], a[216:219], v[184:187], v[124:127]
  v_exp_f32 v117, v117
  v_mfma_f32_16x16x32_bf16 v[124:127], a[212:215], v[180:183], v[124:127]
  v_exp_f32 v116, v116
  v_mfma_f32_16x16x32_bf16 v[124:127], a[208:211], v[176:179], v[124:127]
  v_exp_f32 v103, v103
  v_smfmac_f32_16x16x64_bf16 a[136:139], a[144:147], v[240:247], v20
  v_cvt_pk_bf16_f32 v211, v102, v103
  v_smfmac_f32_16x16x64_bf16 a[140:143], a[144:147], v[248:255], v20
  s_waitcnt vmcnt(12)
  v_cvt_pk_bf16_f32 v218, v116, v117
  v_mfma_f32_16x16x32_bf16 a[96:99], a[224:227], v[248:251], a[96:99]
  s_barrier
  v_mfma_f32_16x16x32_bf16 a[96:99], a[228:231], v[252:255], a[96:99]
  buffer_load_dwordx4 v2, s[24:27], s99 offen offset:0 sc1 lds
  v_mfma_f32_16x16x32_bf16 a[64:67], a[228:231], v[244:247], a[64:67]
  ds_read_b128 a[252:255], v5 offset:23552
  v_exp_f32 v119, v119
  v_mfma_f32_16x16x32_bf16 a[64:67], a[224:227], v[240:243], a[64:67]
  s_waitcnt lgkmcnt(1)
  v_exp_f32 v120, v120
  v_mfma_f32_16x16x32_bf16 a[68:71], a[232:235], v[240:243], a[68:71]
  ds_read_b128 a[228:231], v5 offset:25600
  v_mfma_f32_16x16x32_bf16 a[68:71], a[236:239], v[244:247], a[68:71]
  v_exp_f32 v118, v118
  v_mfma_f32_16x16x32_bf16 a[100:103], a[236:239], v[252:255], a[100:103]
  ds_read_b128 a[224:227], v5 offset:24576
  v_cvt_pk_bf16_f32 v219, v118, v119
  v_mfma_f32_16x16x32_bf16 a[100:103], a[232:235], v[248:251], a[100:103]
  v_exp_f32 v123, v123
  v_mfma_f32_16x16x32_bf16 a[104:107], a[240:243], v[248:251], a[104:107]
  buffer_load_dwordx4 v2, s[24:27], s99 offen offset:1024 sc1 lds
  v_mfma_f32_16x16x32_bf16 a[104:107], a[244:247], v[252:255], a[104:107]
  v_exp_f32 v104, v104
  v_mfma_f32_16x16x32_bf16 a[72:75], a[244:247], v[244:247], a[72:75]
  s_sub_u32 s31, s31, 1
  ds_read_b128 a[232:235], v5 offset:26624
  v_mfma_f32_16x16x32_bf16 a[72:75], a[240:243], v[240:243], a[72:75]
  v_exp_f32 v122, v122
  v_mfma_f32_16x16x32_bf16 a[76:79], a[248:251], v[240:243], a[76:79]
  s_waitcnt lgkmcnt(3)
  v_exp_f32 v105, v105
  v_mfma_f32_16x16x32_bf16 a[76:79], a[252:255], v[244:247], a[76:79]
  s_lshr_b32 s82, s82, 1
  ds_read_b128 a[236:239], v5 offset:27648
  v_cvt_pk_bf16_f32 v221, v122, v123
  v_mfma_f32_16x16x32_bf16 a[108:111], a[252:255], v[252:255], a[108:111]
  s_bitcmp1_b32 s82, 0
  ds_read_b128 a[240:243], v5 offset:28672
  v_exp_f32 v121, v121
  v_mfma_f32_16x16x32_bf16 a[108:111], a[248:251], v[248:251], a[108:111]
  s_waitcnt lgkmcnt(3)
  buffer_load_dwordx4 v2, s[24:27], s99 offen offset:2048 sc1 lds
  v_mfma_f32_16x16x32_bf16 a[112:115], a[224:227], v[248:251], a[112:115]
  ds_read_b128 a[160:163], v4 offset:16384
  v_cvt_pk_bf16_f32 v220, v120, v121
  v_mfma_f32_16x16x32_bf16 a[112:115], a[228:231], v[252:255], a[112:115]
  s_cselect_b32 s3, 0, s31
  ds_read_b128 a[244:247], v5 offset:29696
  v_exp_f32 v108, v108
  v_mfma_f32_16x16x32_bf16 a[80:83], a[228:231], v[244:247], a[80:83]
  s_cmp_gt_u32 s3, 1
  v_exp_f32 v109, v109
  v_mfma_f32_16x16x32_bf16 a[80:83], a[224:227], v[240:243], a[80:83]
  s_waitcnt lgkmcnt(4)
  ds_read_b128 a[248:251], v5 offset:30720
  v_cvt_pk_bf16_f32 v212, v104, v105
  v_mfma_f32_16x16x32_bf16 a[84:87], a[232:235], v[240:243], a[84:87]
  s_waitcnt lgkmcnt(4)
  v_exp_f32 v110, v110
  v_mfma_f32_16x16x32_bf16 a[84:87], a[236:239], v[244:247], a[84:87]
  ds_read_b128 a[180:183], v4 offset:21504
  v_exp_f32 v106, v106
  v_mfma_f32_16x16x32_bf16 a[116:119], a[236:239], v[252:255], a[116:119]
  buffer_load_dwordx4 v2, s[24:27], s99 offen offset:3072 sc1 lds
  v_mfma_f32_16x16x32_bf16 a[116:119], a[232:235], v[248:251], a[116:119]
  s_waitcnt lgkmcnt(4)
  ds_read_b128 a[252:255], v5 offset:31744
  v_cvt_pk_bf16_f32 v214, v108, v109
  v_mfma_f32_16x16x32_bf16 a[120:123], a[240:243], v[248:251], a[120:123]
  s_waitcnt lgkmcnt(3)
  ds_read_b128 a[164:167], v4 offset:17408
  v_xor_b32 v5, 0x8000, v5
  v_mfma_f32_16x16x32_bf16 a[120:123], a[244:247], v[252:255], a[120:123]
  ds_read_b128 a[168:171], v4 offset:18432
  v_mfma_f32_16x16x32_bf16 a[88:91], a[244:247], v[244:247], a[88:91]
  ds_read_b128 a[172:175], v4 offset:19456
  v_exp_f32 v107, v107
  v_mfma_f32_16x16x32_bf16 a[88:91], a[240:243], v[240:243], a[88:91]
  s_waitcnt lgkmcnt(5)
  ds_read_b128 a[176:179], v4 offset:20480
  v_cvt_pk_bf16_f32 v213, v106, v107
  v_mfma_f32_16x16x32_bf16 a[92:95], a[248:251], v[240:243], a[92:95]
  s_waitcnt lgkmcnt(4)
  v_exp_f32 v111, v111
  v_mfma_f32_16x16x32_bf16 a[92:95], a[252:255], v[244:247], a[92:95]
  ds_read_b128 a[184:187], v4 offset:22528
  v_cvt_pk_bf16_f32 v215, v110, v111
  v_mfma_f32_16x16x32_bf16 a[124:127], a[252:255], v[252:255], a[124:127]
  ds_read_b128 a[188:191], v4 offset:23552
  v_mfma_f32_16x16x32_bf16 a[124:127], a[248:251], v[248:251], a[124:127]
  s_cbranch_scc1 L_loop2
L_ev2:
  s_bitcmp1_b32 s82, 0
  s_cbranch_scc1 L_hook2
L_last2:
  s_cmp_eq_u32 s31, 0
  s_cbranch_scc1 L_after2
  v_cndmask_b32 v40, v13, v40, s[32:33]
  v_cndmask_b32 v41, v13, v41, s[34:35]
  v_cndmask_b32 v42, v13, v42, s[36:37]
  v_cndmask_b32 v43, v13, v43, s[38:39]
  v_cndmask_b32 v44, v13, v44, s[40:41]
  v_cndmask_b32 v45, v13, v45, s[42:43]
  v_cndmask_b32 v46, v13, v46, s[44:45]
  v_cndmask_b32 v47, v13, v47, s[46:47]
  v_cndmask_b32 v48, v13, v48, s[48:49]
  v_cndmask_b32 v49, v13, v49, s[50:51]
  v_cndmask_b32 v50, v13, v50, s[52:53]
  v_cndmask_b32 v51, v13, v51, s[54:55]
  v_cndmask_b32 v52, v13, v52, s[56:57]
  v_cndmask_b32 v53, v13, v53, s[58:59]
  v_cndmask_b32 v54, v13, v54, s[60:61]
  v_cndmask_b32 v55, v13, v55, s[62:63]
  s_branch L_loop2
L_hook2:
  s_cmp_lt_u32 s82, 4
  s_cbranch_scc1 L_hook2_b
  s_cmp_gt_u32 s31, 1
  buffer_store_dword v9, v8, s[20:23], s88 offen offset:4 sc1
  s_cbranch_scc1 L_loop2
  s_branch L_last2
L_hook2_b:
  s_cmp_eq_u32 s82, 1
  s_cbranch_scc1 L_hook2_chk
  s_cmp_gt_u32 s31, 1
  buffer_load_dword v21, v7, s[20:23], 0 offen offset:4 sc1
  s_cbranch_scc1 L_loop2
  s_branch L_last2
L_hook2_chk:
  s_waitcnt vmcnt(8)
  s_mov_b32 s0, 0
L_hook2_loop:
  v_cmp_ne_u32 vcc, 1, v21
  s_nop 2
  s_cbranch_vccz L_hook2_ok
  buffer_load_dword v21, v7, s[20:23], 0 offen offset:4 sc1
  s_add_u32 s0, s0, 1
  s_cmp_lt_u32 s0, 0x200000
  s_waitcnt vmcnt(0)
  s_cbranch_scc1 L_hook2_loop
L_hook2_ok:
  s_cmp_gt_u32 s31, 1
  s_cbranch_scc1 L_loop2
  s_branch L_last2
L_after2:
  v_smfmac_f32_16x16x64_bf16 a[136:139], a[144:147], v[208:215], v20
  ds_read_b128 a[192:195], v4 offset:24576
  ds_read_b128 a[196:199], v4 offset:25600
  ds_read_b128 a[200:203], v4 offset:26624
  ds_read_b128 a[204:207], v4 offset:27648
  ds_read_b128 a[208:211], v4 offset:28672
  ds_read_b128 a[212:215], v4 offset:29696
  ds_read_b128 a[216:219], v4 offset:30720
  ds_read_b128 a[220:223], v4 offset:31744
  v_cndmask_b32 v24, v13, v60, s[32:33]
  v_cndmask_b32 v25, v13, v60, s[34:35]
  v_cndmask_b32 v26, v13, v60, s[36:37]
  v_cndmask_b32 v27, v13, v60, s[38:39]
  v_cndmask_b32 v28, v13, v60, s[40:41]
  v_cndmask_b32 v29, v13, v60, s[42:43]
  v_mfma_f32_16x16x32_bf16 v[112:115], a[160:163], v[176:179], v[24:27]
  s_waitcnt lgkmcnt(13)
  ds_read_b128 a[224:227], v5 offset:0
  v_cndmask_b32 v30, v13, v60, s[44:45]
  v_mfma_f32_16x16x32_bf16 v[112:115], a[164:167], v[180:183], v[112:115]
  s_waitcnt lgkmcnt(13)
  ds_read_b128 a[228:231], v5 offset:1024
  v_cndmask_b32 v31, v13, v60, s[46:47]
  v_mfma_f32_16x16x32_bf16 v[112:115], a[168:171], v[184:187], v[112:115]
  s_waitcnt lgkmcnt(13)
  ds_read_b128 a[232:235], v5 offset:2048
  v_exp_f32 v124, v124
  v_mfma_f32_16x16x32_bf16 v[112:115], a[172:175], v[188:191], v[112:115]
  s_waitcnt lgkmcnt(13)
  ds_read_b128 a[236:239], v5 offset:3072
  v_exp_f32 v125, v125
  v_mfma_f32_16x16x32_bf16 v[116:119], a[176:179], v[176:179], v[28:31]
  ds_read_b128 a[240:243], v5 offset:4096
  v_exp_f32 v126, v126
  v_mfma_f32_16x16x32_bf16 v[116:119], a[180:183], v[180:183], v[116:119]
  ds_read_b128 a[244:247], v5 offset:5120
  v_exp_f32 v127, v127
  s_waitcnt lgkmcnt(15)
  v_mfma_f32_16x16x32_bf16 v[116:119], a[184:187], v[184:187], v[116:119]
  ds_read_b128 a[248:251], v5 offset:6144
  v_cvt_pk_bf16_f32 v222, v124, v125
  s_waitcnt lgkmcnt(15)
  v_mfma_f32_16x16x32_bf16 v[116:119], a[188:191], v[188:191], v[116:119]
  s_waitcnt lgkmcnt(6)
  ds_read_b128 a[252:255], v5 offset:7168
  v_cvt_pk_bf16_f32 v223, v126, v127
  v_mfma_f32_16x16x32_bf16 a[64:67], a[224:227], v[208:211], a[64:67]
  s_mov_b32 m0, s78
  v_cndmask_b32 v32, v13, v60, s[48:49]
  v_cndmask_b32 v33, v13, v60, s[50:51]
  v_smfmac_f32_16x16x64_bf16 a[140:143], a[144:147], v[216:223], v20
  s_waitcnt lgkmcnt(6)
  s_mov_b32 s76, 0
  v_cndmask_b32 v34, v13, v60, s[52:53]
  v_mfma_f32_16x16x32_bf16 a[64:67], a[228:231], v[212:215], a[64:67]
  v_cndmask_b32 v35, v13, v60, s[54:55]
  v_cndmask_b32 v36, v13, v60, s[56:57]
  v_mfma_f32_16x16x32_bf16 a[96:99], a[224:227], v[216:219], a[96:99]
  v_cndmask_b32 v37, v13, v60, s[58:59]
  v_cndmask_b32 v38, v13, v60, s[60:61]
  v_mfma_f32_16x16x32_bf16 v[120:123], a[192:195], v[176:179], v[32:35]
  v_cndmask_b32 v39, v13, v60, s[62:63]
  s_waitcnt vmcnt(0)
  v_mfma_f32_16x16x32_bf16 v[120:123], a[196:199], v[180:183], v[120:123]
  s_barrier
  buffer_load_dwordx4 v71, s[12:15], s76 offen offset:0 sc1 lds
  v_mfma_f32_16x16x32_bf16 v[120:123], a[200:203], v[184:187], v[120:123]
  s_mov_b32 s76, 1024
  ds_read_b128 a[224:227], v5 offset:8192
  v_exp_f32 v112, v112
  v_mfma_f32_16x16x32_bf16 v[120:123], a[204:207], v[188:191], v[120:123]
  ds_read_b128 a[160:163], v5 offset:16384
  v_exp_f32 v113, v113
  v_mfma_f32_16x16x32_bf16 v[124:127], a[208:211], v[176:179], v[36:39]
  ds_read_b128 a[164:167], v5 offset:17408
  v_exp_f32 v114, v114
  v_mfma_f32_16x16x32_bf16 v[124:127], a[212:215], v[180:183], v[124:127]
  buffer_load_dwordx4 v71, s[12:15], s76 offen offset:1024 sc1 lds
  v_mfma_f32_16x16x32_bf16 v[124:127], a[216:219], v[184:187], v[124:127]
L_pad13:
  s_cbranch_execz L_hr1
  s_mov_b32 s76, 2048
  v_exp_f32 v115, v115
  v_mfma_f32_16x16x32_bf16 v[124:127], a[220:223], v[188:191], v[124:127]
  ds_read_b128 a[168:171], v5 offset:18432
  v_cvt_pk_bf16_f32 v248, v112, v113
  v_mfma_f32_16x16x32_bf16 a[96:99], a[228:231], v[220:223], a[96:99]
  s_waitcnt lgkmcnt(9)
  ds_read_b128 a[228:231], v5 offset:9216
  v_cvt_pk_bf16_f32 v249, v114, v115
  v_mfma_f32_16x16x32_bf16 a[68:71], a[232:235], v[208:211], a[68:71]
  s_waitcnt lgkmcnt(9)
  ds_read_b128 a[172:175], v5 offset:19456
  v_exp_f32 v116, v116
  v_mfma_f32_16x16x32_bf16 a[68:71], a[236:239], v[212:215], a[68:71]
  buffer_load_dwordx4 v71, s[12:15], s76 offen offset:2048 sc1 lds
  v_mfma_f32_16x16x32_bf16 a[100:103], a[232:235], v[216:219], a[100:103]
  s_mov_b32 s76, 3072
  ds_read_b128 a[232:235], v5 offset:10240
  v_exp_f32 v117, v117
  v_mfma_f32_16x16x32_bf16 a[100:103], a[236:239], v[220:223], a[100:103]
  s_waitcnt lgkmcnt(10)
  ds_read_b128 a[236:239], v5 offset:11264
  v_exp_f32 v118, v118
  v_mfma_f32_16x16x32_bf16 a[72:75], a[240:243], v[208:211], a[72:75]
  s_waitcnt lgkmcnt(10)
  ds_read_b128 a[176:179], v5 offset:20480
  v_exp_f32 v119, v119
  v_mfma_f32_16x16x32_bf16 a[72:75], a[244:247], v[212:215], a[72:75]
  buffer_load_dwordx4 v71, s[12:15], s76 offen offset:3072 sc1 lds
  v_mfma_f32_16x16x32_bf16 a[104:107], a[240:243], v[216:219], a[104:107]
  s_sub_u32 m0, s78, 1024
  s_mov_b32 s76, 0x100000
  v_cvt_pk_bf16_f32 v250, v116, v117
  v_mfma_f32_16x16x32_bf16 a[104:107], a[244:247], v[220:223], a[104:107]
  s_waitcnt lgkmcnt(10)
  ds_read_b128 a[240:243], v5 offset:12288
  v_cvt_pk_bf16_f32 v251, v118, v119
  v_mfma_f32_16x16x32_bf16 a[76:79], a[248:251], v[208:211], a[76:79]
  s_waitcnt lgkmcnt(10)
  ds_read_b128 a[244:247], v5 offset:13312
  v_exp_f32 v120, v120
  v_mfma_f32_16x16x32_bf16 a[76:79], a[252:255], v[212:215], a[76:79]
  ds_read_b128 a[180:183], v5 offset:21504
  buffer_load_dwordx4 v3, s[12:15], s76 offen lds
  v_mfma_f32_16x16x32_bf16 a[108:111], a[248:251], v[216:219], a[108:111]
  ds_read_b128 a[248:251], v5 offset:14336
  v_exp_f32 v121, v121
  v_mfma_f32_16x16x32_bf16 a[108:111], a[252:255], v[220:223], a[108:111]
  s_waitcnt lgkmcnt(12)
  ds_read_b128 a[252:255], v5 offset:15360
  v_exp_f32 v122, v122
  v_mfma_f32_16x16x32_bf16 a[80:83], a[224:227], v[208:211], a[80:83]
  s_waitcnt lgkmcnt(9)
  ds_read_b128 a[184:187], v5 offset:22528
  v_exp_f32 v123, v123
  v_mfma_f32_16x16x32_bf16 a[80:83], a[228:231], v[212:215], a[80:83]
  ds_read_b128 a[188:191], v5 offset:23552
  v_cvt_pk_bf16_f32 v252, v120, v121
  v_mfma_f32_16x16x32_bf16 a[112:115], a[224:227], v[216:219], a[112:115]
  ds_read_b128 a[192:195], v5 offset:24576
  v_cvt_pk_bf16_f32 v253, v122, v123
  v_mfma_f32_16x16x32_bf16 a[112:115], a[228:231], v[220:223], a[112:115]
  s_waitcnt lgkmcnt(10)
  ds_read_b128 a[196:199], v5 offset:25600
  v_exp_f32 v124, v124
  v_mfma_f32_16x16x32_bf16 a[84:87], a[232:235], v[208:211], a[84:87]
  s_waitcnt lgkmcnt(10)
  ds_read_b128 a[200:203], v5 offset:26624
  v_exp_f32 v125, v125
  v_mfma_f32_16x16x32_bf16 a[84:87], a[236:239], v[212:215], a[84:87]
  ds_read_b128 a[204:207], v5 offset:27648
  v_exp_f32 v126, v126
  v_mfma_f32_16x16x32_bf16 a[116:119], a[232:235], v[216:219], a[116:119]
  ds_read_b128 a[208:211], v5 offset:28672
  v_exp_f32 v127, v127
  v_mfma_f32_16x16x32_bf16 a[116:119], a[236:239], v[220:223], a[116:119]
  s_waitcnt lgkmcnt(11)
  ds_read_b128 a[212:215], v5 offset:29696
  v_cvt_pk_bf16_f32 v254, v124, v125
  v_mfma_f32_16x16x32_bf16 a[88:91], a[240:243], v[208:211], a[88:91]
  s_waitcnt lgkmcnt(11)
  ds_read_b128 a[216:219], v5 offset:30720
  v_cvt_pk_bf16_f32 v255, v126, v127
  v_mfma_f32_16x16x32_bf16 a[88:91], a[244:247], v[212:215], a[88:91]
  ds_read_b128 a[220:223], v5 offset:31744
  ds_read_b128 v[192:195], v75 offset:64
  v_mfma_f32_16x16x32_bf16 a[120:123], a[240:243], v[216:219], a[120:123]
  ds_read_b32 v196, v75 offset:80
  ds_read_b128 v[200:203], v75 offset:1088
  v_mfma_f32_16x16x32_bf16 a[120:123], a[244:247], v[220:223], a[120:123]
  ds_read_b32 v204, v75 offset:1104
  ds_read_b128 v[224:227], v75 offset:2112
  s_waitcnt lgkmcnt(15)
  v_mfma_f32_16x16x32_bf16 a[92:95], a[248:251], v[208:211], a[92:95]
  ds_read_b32 v228, v75 offset:2128
  ds_read_b128 v[232:235], v75 offset:3136
  v_mfma_f32_16x16x32_bf16 a[92:95], a[252:255], v[212:215], a[92:95]
  ds_read_b32 v236, v75 offset:3152
  s_lshl_b32 s87, s30, 20
  v_mfma_f32_16x16x32_bf16 a[124:127], a[248:251], v[216:219], a[124:127]
  s_xor_b32 s87, s87, 0xf00000
  v_accvgpr_read_b32 v14, a136
  v_accvgpr_read_b32 v22, a137
  v_mfma_f32_16x16x32_bf16 a[124:127], a[252:255], v[220:223], a[124:127]
  s_add_u32 s86, s87, 0x0
  v_add_f32 v14, v14, v22
  v_rcp_f32 v22, v14
  v_smfmac_f32_16x16x64_bf16 a[140:143], a[144:147], v[248:255], v20
  s_waitcnt lgkmcnt(7)
  v_alignbit_b32 v96, v193, v192, 16
  v_mfma_f32_16x16x32_bf16 a[96:99], a[160:163], v[248:251], a[96:99]
  v_alignbit_b32 v97, v194, v193, 16
  v_alignbit_b32 v98, v195, v194, 16
  v_mfma_f32_16x16x32_bf16 a[96:99], a[164:167], v[252:255], a[96:99]
  s_waitcnt lgkmcnt(6)
  v_alignbit_b32 v99, v196, v195, 16
  ds_write_b128 v75, v[96:99] offset:4096
  v_mfma_f32_16x16x32_bf16 a[100:103], a[168:171], v[248:251], a[100:103]
  s_waitcnt lgkmcnt(6)
  v_alignbit_b32 v100, v201, v200, 16
  v_alignbit_b32 v101, v202, v201, 16
  v_mfma_f32_16x16x32_bf16 a[100:103], a[172:175], v[252:255], a[100:103]
  s_waitcnt lgkmcnt(5)
  v_alignbit_b32 v102, v203, v202, 16
  v_alignbit_b32 v103, v204, v203, 16
  v_mfma_f32_16x16x32_bf16 a[104:107], a[176:179], v[248:251], a[104:107]
  s_waitcnt lgkmcnt(4)
  v_alignbit_b32 v104, v225, v224, 16
  v_alignbit_b32 v105, v226, v225, 16
  v_mfma_f32_16x16x32_bf16 a[104:107], a[180:183], v[252:255], a[104:107]
  ds_write_b128 v75, v[100:103] offset:5120
  v_alignbit_b32 v106, v227, v226, 16
  v_mfma_f32_16x16x32_bf16 a[108:111], a[184:187], v[248:251], a[108:111]
  s_waitcnt lgkmcnt(4)
  s_waitcnt lgkmcnt(3)
  v_alignbit_b32 v107, v228, v227, 16
  v_alignbit_b32 v108, v233, v232, 16
  v_mfma_f32_16x16x32_bf16 a[108:111], a[188:191], v[252:255], a[108:111]
  v_alignbit_b32 v109, v234, v233, 16
  v_alignbit_b32 v110, v235, v234, 16
  v_mfma_f32_16x16x32_bf16 a[112:115], a[192:195], v[248:251], a[112:115]
  s_waitcnt lgkmcnt(2)
  v_alignbit_b32 v111, v236, v235, 16
  ds_write_b128 v75, v[104:107] offset:6144
  v_mfma_f32_16x16x32_bf16 a[112:115], a[196:199], v[252:255], a[112:115]
  v_accvgpr_read_b32 v40, a64
  v_accvgpr_read_b32 v41, a65
  v_mfma_f32_16x16x32_bf16 a[116:119], a[200:203], v[248:251], a[116:119]
  v_accvgpr_read_b32 v42, a66
  v_accvgpr_read_b32 v43, a67
  v_mfma_f32_16x16x32_bf16 a[116:119], a[204:207], v[252:255], a[116:119]
  v_accvgpr_read_b32 v44, a68
  v_accvgpr_read_b32 v45, a69
  v_mfma_f32_16x16x32_bf16 a[120:123], a[208:211], v[248:251], a[120:123]
  ds_write_b128 v75, v[108:111] offset:7168
  v_accvgpr_read_b32 v46, a70
  v_mfma_f32_16x16x32_bf16 a[120:123], a[212:215], v[252:255], a[120:123]
  ds_read_b128 a[0:3], v72
  v_accvgpr_read_b32 v47, a71
  v_mfma_f32_16x16x32_bf16 a[124:127], a[216:219], v[248:251], a[124:127]
  ds_read2_b32 a[4:5], v64 offset0:128 offset1:129
  v_mul_f32 v40, v40, v22
  v_mfma_f32_16x16x32_bf16 a[124:127], a[220:223], v[252:255], a[124:127]
  ds_read2_b32 a[6:7], v64 offset0:130 offset1:131
  v_mul_f32 v41, v41, v22
  v_mul_f32 v42, v42, v22
  v_mul_f32 v43, v43, v22
  v_mul_f32 v44, v44, v22
  v_mul_f32 v45, v45, v22
  v_mul_f32 v46, v46, v22
  v_mul_f32 v47, v47, v22
  v_cvt_pk_bf16_f32 v48, v40, v41
  v_cvt_pk_bf16_f32 v49, v42, v43
  v_cvt_pk_bf16_f32 v50, v44, v45
  v_cvt_pk_bf16_f32 v51, v46, v47
  buffer_store_dwordx4 v[48:51], v3, s[4:7], s86 offen sc1
  v_accvgpr_read_b32 v24, a72
  v_accvgpr_read_b32 v25, a73
  v_accvgpr_read_b32 v26, a74
  v_accvgpr_read_b32 v27, a75
  v_accvgpr_read_b32 v28, a76
  v_accvgpr_read_b32 v29, a77
  v_accvgpr_read_b32 v30, a78
  v_accvgpr_read_b32 v31, a79
  v_mul_f32 v24, v24, v22
  v_mul_f32 v25, v25, v22
  v_mul_f32 v26, v26, v22
  v_mul_f32 v27, v27, v22
  v_mul_f32 v28, v28, v22
  v_mul_f32 v29, v29, v22
  v_mul_f32 v30, v30, v22
  v_mul_f32 v31, v31, v22
  v_cvt_pk_bf16_f32 v32, v24, v25
  v_cvt_pk_bf16_f32 v33, v26, v27
  v_cvt_pk_bf16_f32 v34, v28, v29
  v_cvt_pk_bf16_f32 v35, v30, v31
  s_add_u32 s86, s87, 0x2000
  buffer_store_dwordx4 v[32:35], v3, s[4:7], s86 offen sc1
  v_accvgpr_read_b32 v40, a80
  v_accvgpr_read_b32 v41, a81
  v_accvgpr_read_b32 v42, a82
  v_accvgpr_read_b32 v43, a83
  v_accvgpr_read_b32 v44, a84
  v_accvgpr_read_b32 v45, a85
  v_accvgpr_read_b32 v46, a86
  v_accvgpr_read_b32 v47, a87
  v_mul_f32 v40, v40, v22
  v_mul_f32 v41, v41, v22
  v_mul_f32 v42, v42, v22
  v_mul_f32 v43, v43, v22
  v_mul_f32 v44, v44, v22
  v_mul_f32 v45, v45, v22
  v_mul_f32 v46, v46, v22
  v_mul_f32 v47, v47, v22
  v_cvt_pk_bf16_f32 v48, v40, v41
  v_cvt_pk_bf16_f32 v49, v42, v43
  v_cvt_pk_bf16_f32 v50, v44, v45
  v_cvt_pk_bf16_f32 v51, v46, v47
  s_add_u32 s86, s87, 0x4000
  buffer_store_dwordx4 v[48:51], v3, s[4:7], s86 offen sc1
  v_accvgpr_read_b32 v24, a88
  v_accvgpr_read_b32 v25, a89
  v_accvgpr_read_b32 v26, a90
  v_accvgpr_read_b32 v27, a91
  v_accvgpr_read_b32 v28, a92
  v_accvgpr_read_b32 v29, a93
  v_accvgpr_read_b32 v30, a94
  v_accvgpr_read_b32 v31, a95
  v_mul_f32 v24, v24, v22
  v_mul_f32 v25, v25, v22
  v_mul_f32 v26, v26, v22
  v_mul_f32 v27, v27, v22
  v_mul_f32 v28, v28, v22
  v_mul_f32 v29, v29, v22
  v_mul_f32 v30, v30, v22
  v_mul_f32 v31, v31, v22
  v_cvt_pk_bf16_f32 v32, v24, v25
  v_cvt_pk_bf16_f32 v33, v26, v27
  v_cvt_pk_bf16_f32 v34, v28, v29
  v_cvt_pk_bf16_f32 v35, v30, v31
  s_add_u32 s86, s87, 0x6000
  buffer_store_dwordx4 v[32:35], v3, s[4:7], s86 offen sc1
  v_accvgpr_read_b32 v15, a140
  v_accvgpr_read_b32 v12, a141
  v_add_f32 v15, v15, v12
  v_rcp_f32 v12, v15
  v_accvgpr_read_b32 v40, a96
  v_accvgpr_read_b32 v41, a97
  v_accvgpr_read_b32 v42, a98
  v_accvgpr_read_b32 v43, a99
  v_accvgpr_read_b32 v44, a100
  v_accvgpr_read_b32 v45, a101
  v_accvgpr_read_b32 v46, a102
  v_accvgpr_read_b32 v47, a103
  v_mul_f32 v40, v40, v12
  v_mul_f32 v41, v41, v12
  v_mul_f32 v42, v42, v12
  v_mul_f32 v43, v43, v12
  v_mul_f32 v44, v44, v12
  v_mul_f32 v45, v45, v12
  v_mul_f32 v46, v46, v12
  v_mul_f32 v47, v47, v12
  v_cvt_pk_bf16_f32 v48, v40, v41
  v_cvt_pk_bf16_f32 v49, v42, v43
  v_cvt_pk_bf16_f32 v50, v44, v45
  v_cvt_pk_bf16_f32 v51, v46, v47
  s_add_u32 s86, s87, 0x1000
  buffer_store_dwordx4 v[48:51], v3, s[4:7], s86 offen sc1
  v_accvgpr_read_b32 v24, a104
  v_accvgpr_read_b32 v25, a105
  v_accvgpr_read_b32 v26, a106
  v_accvgpr_read_b32 v27, a107
  v_accvgpr_read_b32 v28, a108
  v_accvgpr_read_b32 v29, a109
  v_accvgpr_read_b32 v30, a110
  v_accvgpr_read_b32 v31, a111
  v_mul_f32 v24, v24, v12
  v_mul_f32 v25, v25, v12
  v_mul_f32 v26, v26, v12
  v_mul_f32 v27, v27, v12
  v_mul_f32 v28, v28, v12
  v_mul_f32 v29, v29, v12
  v_mul_f32 v30, v30, v12
  v_mul_f32 v31, v31, v12
  v_cvt_pk_bf16_f32 v32, v24, v25
  v_cvt_pk_bf16_f32 v33, v26, v27
  v_cvt_pk_bf16_f32 v34, v28, v29
  v_cvt_pk_bf16_f32 v35, v30, v31
  s_add_u32 s86, s87, 0x3000
  buffer_store_dwordx4 v[32:35], v3, s[4:7], s86 offen sc1
  v_accvgpr_read_b32 v40, a112
  v_accvgpr_read_b32 v41, a113
  v_accvgpr_read_b32 v42, a114
  v_accvgpr_read_b32 v43, a115
  v_accvgpr_read_b32 v44, a116
  v_accvgpr_read_b32 v45, a117
  v_accvgpr_read_b32 v46, a118
  v_accvgpr_read_b32 v47, a119
  v_mul_f32 v40, v40, v12
  v_mul_f32 v41, v41, v12
  v_mul_f32 v42, v42, v12
  v_mul_f32 v43, v43, v12
  v_mul_f32 v44, v44, v12
  v_mul_f32 v45, v45, v12
  v_mul_f32 v46, v46, v12
  v_mul_f32 v47, v47, v12
  v_cvt_pk_bf16_f32 v48, v40, v41
  v_cvt_pk_bf16_f32 v49, v42, v43
  v_cvt_pk_bf16_f32 v50, v44, v45
  v_cvt_pk_bf16_f32 v51, v46, v47
  s_add_u32 s86, s87, 0x5000
  buffer_store_dwordx4 v[48:51], v3, s[4:7], s86 offen sc1
  v_accvgpr_read_b32 v24, a120
  v_accvgpr_read_b32 v25, a121
  v_accvgpr_read_b32 v26, a122
  v_accvgpr_read_b32 v27, a123
  v_accvgpr_read_b32 v28, a124
  v_accvgpr_read_b32 v29, a125
  v_accvgpr_read_b32 v30, a126
  v_accvgpr_read_b32 v31, a127
  v_mul_f32 v24, v24, v12
  v_mul_f32 v25, v25, v12
  v_mul_f32 v26, v26, v12
  v_mul_f32 v27, v27, v12
  v_mul_f32 v28, v28, v12
  v_mul_f32 v29, v29, v12
  v_mul_f32 v30, v30, v12
  v_mul_f32 v31, v31, v12
  v_cvt_pk_bf16_f32 v32, v24, v25
  v_cvt_pk_bf16_f32 v33, v26, v27
  v_cvt_pk_bf16_f32 v34, v28, v29
  v_cvt_pk_bf16_f32 v35, v30, v31
  s_add_u32 s86, s87, 0x7000
  buffer_store_dwordx4 v[32:35], v3, s[4:7], s86 offen sc1
  v_add_f32 v22, v14, v15
  v_cmp_ngt_f32 vcc, 0x5d800000, v22
  s_waitcnt vmcnt(8)
  ds_read_b128 a[32:35], v68 offset:448
  ds_read_b128 a[36:39], v68 offset:960
  ds_read_b128 a[40:43], v68 offset:1472
  ds_read2_b32 a[8:9], v65 offset0:0 offset1:1
  ds_read2_b32 a[10:11], v65 offset0:2 offset1:3
  ds_read_b128 a[44:47], v68 offset:1984
  ds_read2_b32 a[12:13], v65 offset0:128 offset1:129
  ds_read2_b32 a[14:15], v65 offset0:130 offset1:131
  ds_read_b128 a[48:51], v68 offset:2496
  ds_read2_b32 a[16:17], v66 offset0:0 offset1:1
  ds_read2_b32 a[18:19], v66 offset0:2 offset1:3
  ds_read_b128 a[52:55], v68 offset:3008
  ds_read2_b32 a[20:21], v66 offset0:128 offset1:129
  ds_read2_b32 a[22:23], v66 offset0:130 offset1:131
  ds_read_b128 a[56:59], v68 offset:3520
  ds_read2_b32 a[24:25], v67 offset0:0 offset1:1
  ds_read2_b32 a[26:27], v67 offset0:2 offset1:3
  ds_read_b128 a[60:63], v68 offset:4032
  ds_read2_b32 a[28:29], v67 offset0:128 offset1:129
  ds_read2_b32 a[30:31], v67 offset0:130 offset1:131
  s_or_b64 vcc, vcc, s[70:71]
  s_cbranch_scc1 L_slow
L_slow_ret:
  s_waitcnt lgkmcnt(15)
  v_mfma_f32_16x16x32_bf16 v[96:99], v[56:59], a[32:35], 0
  s_and_b32 s8, s2, 3
  s_and_b32 s3, s2, 4
  ds_read_b128 a[96:99], v68 offset:384
  v_mfma_f32_16x16x32_bf16 v[96:99], a[0:3], a[32:35], v[96:99]
  s_lshr_b32 s31, s2, 6
  s_add_u32 s3, s3, s31
  ds_read2_b32 a[64:65], v64 offset0:16 offset1:17
  v_mfma_f32_16x16x32_bf16 v[100:103], v[56:59], a[36:39], 0
  s_lshl_b32 s3, s3, 1
  s_lshr_b32 s77, s28, 1
  ds_read2_b32 a[66:67], v64 offset0:18 offset1:19
  v_mfma_f32_16x16x32_bf16 v[100:103], a[4:7], a[32:35], v[100:103]
  s_add_u32 s38, s3, s77
  s_xor_b32 s3, s30, 5
  v_mfma_f32_16x16x32_bf16 v[100:103], a[0:3], a[36:39], v[100:103]
  s_lshr_b32 s39, s3, 1
  s_and_b32 s3, s3, 1
  ds_read_b128 a[100:103], v68 offset:896
  v_mfma_f32_16x16x32_bf16 v[104:107], v[56:59], a[40:43], 0
  s_lshl_b32 s3, s3, 2
  s_or_b32 s39, s39, s3
  ds_read2_b32 a[68:69], v64 offset0:144 offset1:145
  v_mfma_f32_16x16x32_bf16 v[104:107], a[0:3], a[40:43], v[104:107]
  s_add_u32 s31, s31, s39
  s_and_b32 s31, s31, 1
  ds_read2_b32 a[70:71], v64 offset0:146 offset1:147
  v_mfma_f32_16x16x32_bf16 v[104:107], a[4:7], a[36:39], v[104:107]
  s_lshl_b32 s100, s31, 17
  s_lshl_b32 s101, s31, 14
  v_mfma_f32_16x16x32_bf16 v[104:107], a[8:11], a[32:35], v[104:107]
  s_and_b32 s3, s2, 1
  s_mul_i32 s3, s3, 0
  ds_read_b128 a[104:107], v68 offset:1408
  s_waitcnt lgkmcnt(15)
  v_mfma_f32_16x16x32_bf16 v[108:111], v[56:59], a[44:47], 0
  s_lshl_b32 s14, s8, 4
  s_add_u32 s14, s14, s3
  ds_read2_b32 a[72:73], v65 offset0:16 offset1:17
  v_mfma_f32_16x16x32_bf16 v[108:111], a[12:15], a[32:35], v[108:111]
  s_lshl_b32 s3, s14, 17
  s_lshl_b32 s31, s28, 15
  ds_read2_b32 a[74:75], v65 offset0:18 offset1:19
  v_mfma_f32_16x16x32_bf16 v[108:111], a[8:11], a[36:39], v[108:111]
  s_add_u32 s3, s3, s31
  s_lshl_b32 s31, s39, 8
  v_mfma_f32_16x16x32_bf16 v[108:111], a[4:7], a[40:43], v[108:111]
  s_add_u32 s3, s3, s31
  s_sub_u32 s31, 0x800000, s3
  ds_read_b128 a[108:111], v68 offset:1920
  v_mfma_f32_16x16x32_bf16 v[108:111], a[0:3], a[44:47], v[108:111]
  s_add_u32 s44, s74, s3
  s_addc_u32 s45, s75, 0
  ds_read2_b32 a[76:77], v65 offset0:144 offset1:145
  v_mfma_f32_16x16x32_bf16 v[112:115], v[56:59], a[48:51], 0
  s_mov_b32 s46, s31
  s_mov_b32 s47, 0x20000
  ds_read2_b32 a[78:79], v65 offset0:146 offset1:147
  v_mfma_f32_16x16x32_bf16 v[112:115], a[0:3], a[48:51], v[112:115]
  s_lshl_b32 s37, s28, 12
  v_lshrrev_b32 v16, 4, v1
  v_and_b32 v17, 15, v1
  v_mfma_f32_16x16x32_bf16 v[112:115], a[4:7], a[44:47], v[112:115]
  ds_read_b128 a[112:115], v68 offset:2432
  v_lshlrev_b32 v18, 1, v16
  v_mfma_f32_16x16x32_bf16 v[112:115], a[8:11], a[40:43], v[112:115]
  ds_read2_b32 a[80:81], v66 offset0:16 offset1:17
  v_xor_b32 v18, v17, v18
  v_mfma_f32_16x16x32_bf16 v[112:115], a[12:15], a[36:39], v[112:115]
  ds_read2_b32 a[82:83], v66 offset0:18 offset1:19
  v_lshlrev_b32 v18, 4, v18
  v_mfma_f32_16x16x32_bf16 v[112:115], a[16:19], a[32:35], v[112:115]
  v_lshl_add_u32 v24, v16, 11, v18
  v_xor_b32 v25, 0x80, v24
  v_mfma_f32_16x16x32_bf16 v[116:119], v[56:59], a[52:55], 0
  ds_read_b128 a[116:119], v68 offset:2944
  v_add_u32 v25, 0x1c00, v25
  s_waitcnt lgkmcnt(15)
  v_mfma_f32_16x16x32_bf16 v[116:119], a[20:23], a[32:35], v[116:119]
  ds_read2_b32 a[84:85], v66 offset0:144 offset1:145
  v_add_u32 v26, 0x3800, v24
  v_mfma_f32_16x16x32_bf16 v[116:119], a[16:19], a[36:39], v[116:119]
  ds_read2_b32 a[86:87], v66 offset0:146 offset1:147
  v_add_u32 v27, 0x3800, v25
  v_mfma_f32_16x16x32_bf16 v[116:119], a[12:15], a[40:43], v[116:119]
  v_mfma_f32_16x16x32_bf16 v[116:119], a[8:11], a[44:47], v[116:119]
  ds_read_b128 a[120:123], v68 offset:3456
  v_mfma_f32_16x16x32_bf16 v[116:119], a[4:7], a[48:51], v[116:119]
  ds_read2_b32 a[88:89], v67 offset0:16 offset1:17
  v_mfma_f32_16x16x32_bf16 v[116:119], a[0:3], a[52:55], v[116:119]
  ds_read2_b32 a[90:91], v67 offset0:18 offset1:19
  v_mfma_f32_16x16x32_bf16 v[120:123], v[56:59], a[56:59], 0
  v_mfma_f32_16x16x32_bf16 v[120:123], a[0:3], a[56:59], v[120:123]
  ds_read_b128 a[124:127], v68 offset:3968
  v_mfma_f32_16x16x32_bf16 v[120:123], a[4:7], a[52:55], v[120:123]
  ds_read2_b32 a[92:93], v67 offset0:144 offset1:145
  v_mfma_f32_16x16x32_bf16 v[120:123], a[8:11], a[48:51], v[120:123]
  ds_read2_b32 a[94:95], v67 offset0:146 offset1:147
  v_mfma_f32_16x16x32_bf16 v[120:123], a[12:15], a[44:47], v[120:123]
  v_mfma_f32_16x16x32_bf16 v[120:123], a[16:19], a[40:43], v[120:123]
  v_mfma_f32_16x16x32_bf16 v[120:123], a[20:23], a[36:39], v[120:123]
  v_mfma_f32_16x16x32_bf16 v[120:123], a[24:27], a[32:35], v[120:123]
  v_mfma_f32_16x16x32_bf16 v[124:127], v[56:59], a[60:63], 0
  v_mfma_f32_16x16x32_bf16 v[124:127], a[28:31], a[32:35], v[124:127]
  v_mfma_f32_16x16x32_bf16 v[124:127], a[24:27], a[36:39], v[124:127]
  v_mfma_f32_16x16x32_bf16 v[124:127], a[20:23], a[40:43], v[124:127]
  v_mfma_f32_16x16x32_bf16 v[124:127], a[16:19], a[44:47], v[124:127]
  v_mfma_f32_16x16x32_bf16 v[124:127], a[12:15], a[48:51], v[124:127]
  v_mfma_f32_16x16x32_bf16 v[124:127], a[8:11], a[52:55], v[124:127]
  v_mfma_f32_16x16x32_bf16 v[124:127], a[4:7], a[56:59], v[124:127]
  v_mfma_f32_16x16x32_bf16 v[124:127], a[0:3], a[60:63], v[124:127]
  s_waitcnt vmcnt(0) lgkmcnt(15)
  v_mfma_f32_16x16x32_bf16 v[96:99], a[64:67], a[96:99], v[96:99]
  s_barrier
  v_mfma_f32_16x16x32_bf16 v[100:103], a[68:71], a[96:99], v[100:103]
  buffer_store_dword v9, v8, s[20:23], s88 offen offset:8 sc1
  v_mfma_f32_16x16x32_bf16 v[100:103], a[64:67], a[100:103], v[100:103]
  s_xor_b32 s32, s100, 0x0
  s_and_b32 s97, s28, 1
  ds_read_b128 a[32:35], v68 offset:320
  v_mfma_f32_16x16x32_bf16 v[104:107], a[64:67], a[104:107], v[104:107]
  s_add_u32 m0, s37, 0
  s_lshl_b32 s3, s38, 20
  ds_read2_b32 a[0:1], v64 offset0:32 offset1:33
  v_mfma_f32_16x16x32_bf16 v[104:107], a[68:71], a[100:103], v[104:107]
  s_lshl_b32 s31, s14, 14
  buffer_load_dwordx4 v24, s[44:47], s32 offen offset:0  lds
  v_mfma_f32_16x16x32_bf16 v[104:107], a[72:75], a[96:99], v[104:107]
  s_add_u32 s3, s3, s31
  ds_read2_b32 a[2:3], v64 offset0:34 offset1:35
  s_waitcnt lgkmcnt(15)
  v_mfma_f32_16x16x32_bf16 v[108:111], a[76:79], a[96:99], v[108:111]
  s_lshl_b32 s31, s97, 12
  ds_read_b128 a[36:39], v68 offset:832
  v_mfma_f32_16x16x32_bf16 v[108:111], a[72:75], a[100:103], v[108:111]
  s_add_u32 s3, s3, s31
  buffer_load_dwordx4 v25, s[44:47], s32 offen offset:1024  lds
  v_mfma_f32_16x16x32_bf16 v[108:111], a[68:71], a[104:107], v[108:111]
  s_add_u32 s40, s94, s3
  s_addc_u32 s41, s95, 0
  ds_read2_b32 a[4:5], v64 offset0:160 offset1:161
  v_mfma_f32_16x16x32_bf16 v[108:111], a[64:67], a[108:111], v[108:111]
  s_add_u32 s40, s40, 0x2000000
  s_addc_u32 s41, s41, 0
  ds_read2_b32 a[6:7], v64 offset0:162 offset1:163
  s_waitcnt lgkmcnt(15)
  v_mfma_f32_16x16x32_bf16 v[112:115], a[64:67], a[112:115], v[112:115]
  s_mov_b32 s42, 0x3f000
  ds_read_b128 a[40:43], v68 offset:1344
  v_mfma_f32_16x16x32_bf16 v[112:115], a[68:71], a[108:111], v[112:115]
  s_mov_b32 s43, 0x20000
  ds_read2_b32 a[8:9], v65 offset0:32 offset1:33
  v_mfma_f32_16x16x32_bf16 v[112:115], a[72:75], a[104:107], v[112:115]
  s_xor_b32 s3, s38, 15
  buffer_load_dwordx4 v26, s[44:47], s32 offen offset:2048  lds
  v_mfma_f32_16x16x32_bf16 v[112:115], a[76:79], a[100:103], v[112:115]
  s_min_u32 s3, s3, s38
  ds_read2_b32 a[10:11], v65 offset0:34 offset1:35
  v_mfma_f32_16x16x32_bf16 v[112:115], a[80:83], a[96:99], v[112:115]
  s_lshl_b32 s3, s3, 7
  ds_read_b128 a[44:47], v68 offset:1856
  s_waitcnt lgkmcnt(15)
  v_mfma_f32_16x16x32_bf16 v[116:119], a[84:87], a[96:99], v[116:119]
  s_lshl_b32 s31, s8, 13
  ds_read2_b32 a[12:13], v65 offset0:160 offset1:161
  v_mfma_f32_16x16x32_bf16 v[116:119], a[80:83], a[100:103], v[116:119]
  s_add_u32 s3, s3, s31
  ds_read2_b32 a[14:15], v65 offset0:162 offset1:163
  v_mfma_f32_16x16x32_bf16 v[116:119], a[76:79], a[104:107], v[116:119]
  s_add_u32 s3, s3, 524288
  buffer_load_dwordx4 v27, s[44:47], s32 offen offset:3072  lds
  v_mfma_f32_16x16x32_bf16 v[116:119], a[72:75], a[108:111], v[116:119]
  s_xor_b32 s32, s100, 0x20000
  s_and_b32 s31, s2, 1
  ds_read_b128 a[48:51], v68 offset:2368
  v_mfma_f32_16x16x32_bf16 v[116:119], a[68:71], a[112:115], v[116:119]
  s_add_u32 m0, s37, 16384
  s_mul_i32 s31, s31, 0
  ds_read2_b32 a[16:17], v66 offset0:32 offset1:33
  v_mfma_f32_16x16x32_bf16 v[116:119], a[64:67], a[116:119], v[116:119]
  s_sub_u32 s31, 7, s31
  ds_read2_b32 a[18:19], v66 offset0:34 offset1:35
  v_mfma_f32_16x16x32_bf16 v[120:123], a[64:67], a[120:123], v[120:123]
  ds_read_b128 a[52:55], v68 offset:2880
  v_min_u32 v18, s31, v1
  v_mfma_f32_16x16x32_bf16 v[120:123], a[68:71], a[116:119], v[120:123]
  buffer_load_dwordx4 v24, s[44:47], s32 offen offset:0  lds
  v_mfma_f32_16x16x32_bf16 v[120:123], a[72:75], a[112:115], v[120:123]
  ds_read2_b32 a[20:21], v66 offset0:160 offset1:161
  v_lshlrev_b32 v6, 10, v18
  v_mfma_f32_16x16x32_bf16 v[120:123], a[76:79], a[108:111], v[120:123]
  ds_read2_b32 a[22:23], v66 offset0:162 offset1:163
  v_add_u32 v6, s3, v6
  v_mfma_f32_16x16x32_bf16 v[120:123], a[80:83], a[104:107], v[120:123]
  s_and_b32 s3, s8, 2
  ds_read_b128 a[56:59], v68 offset:3392
  v_mfma_f32_16x16x32_bf16 v[120:123], a[84:87], a[100:103], v[120:123]
  s_lshl_b32 s3, s3, 10
  ds_read2_b32 a[24:25], v67 offset0:32 offset1:33
  s_waitcnt lgkmcnt(15)
  v_mfma_f32_16x16x32_bf16 v[120:123], a[88:91], a[96:99], v[120:123]
  buffer_load_dwordx4 v25, s[44:47], s32 offen offset:1024  lds
  v_mfma_f32_16x16x32_bf16 v[124:127], a[92:95], a[96:99], v[124:127]
  ds_read2_b32 a[26:27], v67 offset0:34 offset1:35
  v_add_u32 v60, s3, v3
  v_mfma_f32_16x16x32_bf16 v[124:127], a[88:91], a[100:103], v[124:127]
  ds_read_b128 a[60:63], v68 offset:3904
  v_xor_b32 v61, 0x800, v60
  v_mfma_f32_16x16x32_bf16 v[124:127], a[84:87], a[104:107], v[124:127]
  ds_read2_b32 a[28:29], v67 offset0:160 offset1:161
  v_bfe_u32 v18, v1, 2, 2
  v_mfma_f32_16x16x32_bf16 v[124:127], a[80:83], a[108:111], v[124:127]
  ds_read2_b32 a[30:31], v67 offset0:162 offset1:163
  v_lshl_add_u32 v18, v16, 2, v18
  v_mfma_f32_16x16x32_bf16 v[124:127], a[76:79], a[112:115], v[124:127]
  buffer_load_dwordx4 v26, s[44:47], s32 offen offset:2048  lds
  v_mfma_f32_16x16x32_bf16 v[124:127], a[72:75], a[116:119], v[124:127]
  v_and_b32 v19, 7, v18
  v_mfma_f32_16x16x32_bf16 v[124:127], a[68:71], a[120:123], v[124:127]
  v_lshlrev_b32 v18, 8, v18
  v_mfma_f32_16x16x32_bf16 v[124:127], a[64:67], a[124:127], v[124:127]
  v_lshl_add_u32 v18, v19, 5, v18
  v_mfma_f32_16x16x32_bf16 v[96:99], a[0:3], a[32:35], v[96:99]
  ds_read_b128 a[96:99], v68 offset:256
  v_and_b32 v19, 3, v1
  s_waitcnt lgkmcnt(15)
  v_mfma_f32_16x16x32_bf16 v[100:103], a[4:7], a[32:35], v[100:103]
  buffer_load_dwordx4 v27, s[44:47], s32 offen offset:3072  lds
  v_mfma_f32_16x16x32_bf16 v[100:103], a[0:3], a[36:39], v[100:103]
  s_xor_b32 s32, s100, 0x40000
  ds_read2_b32 a[64:65], v64 offset0:48 offset1:49
  v_lshl_add_u32 v18, v19, 3, v18
  v_mfma_f32_16x16x32_bf16 v[104:107], a[0:3], a[40:43], v[104:107]
  s_add_u32 m0, s37, 32768
  s_and_b32 s3, s2, 1
  ds_read2_b32 a[66:67], v64 offset0:50 offset1:51
  v_mfma_f32_16x16x32_bf16 v[104:107], a[4:7], a[36:39], v[104:107]
  s_lshl_b32 s3, s3, 7
  ds_read_b128 a[100:103], v68 offset:768
  v_mfma_f32_16x16x32_bf16 v[104:107], a[8:11], a[32:35], v[104:107]
  ds_read2_b32 a[68:69], v64 offset0:176 offset1:177
  v_xor_b32 v28, s3, v18
  s_waitcnt lgkmcnt(15)
  v_mfma_f32_16x16x32_bf16 v[108:111], a[12:15], a[32:35], v[108:111]
L_pad14:
  s_cbranch_execz L_hr1
  buffer_load_dwordx4 v24, s[44:47], s32 offen offset:0  lds
  v_mfma_f32_16x16x32_bf16 v[108:111], a[8:11], a[36:39], v[108:111]
  ds_read2_b32 a[70:71], v64 offset0:178 offset1:179
  v_xor_b32 v29, 32, v28
  v_mfma_f32_16x16x32_bf16 v[108:111], a[4:7], a[40:43], v[108:111]
  ds_read_b128 a[104:107], v68 offset:1280
  v_xor_b32 v30, 64, v28
  v_mfma_f32_16x16x32_bf16 v[108:111], a[0:3], a[44:47], v[108:111]
  ds_read2_b32 a[72:73], v65 offset0:48 offset1:49
  v_xor_b32 v31, 96, v28
  v_mfma_f32_16x16x32_bf16 v[112:115], a[0:3], a[48:51], v[112:115]
  ds_read2_b32 a[74:75], v65 offset0:50 offset1:51
  v_xor_b32 v32, 128, v28
  v_mfma_f32_16x16x32_bf16 v[112:115], a[4:7], a[44:47], v[112:115]
  buffer_load_dwordx4 v25, s[44:47], s32 offen offset:1024  lds
  v_mfma_f32_16x16x32_bf16 v[112:115], a[8:11], a[40:43], v[112:115]
  ds_read_b128 a[108:111], v68 offset:1792
  v_xor_b32 v33, 160, v28
  v_mfma_f32_16x16x32_bf16 v[112:115], a[12:15], a[36:39], v[112:115]
  ds_read2_b32 a[76:77], v65 offset0:176 offset1:177
  v_xor_b32 v34, 192, v28
  s_waitcnt lgkmcnt(15)
  v_mfma_f32_16x16x32_bf16 v[112:115], a[16:19], a[32:35], v[112:115]
  ds_read2_b32 a[78:79], v65 offset0:178 offset1:179
  v_xor_b32 v35, 224, v28
  v_mfma_f32_16x16x32_bf16 v[116:119], a[20:23], a[32:35], v[116:119]
  v_add_u32 v36, 0x10000, v28
  v_mfma_f32_16x16x32_bf16 v[116:119], a[16:19], a[36:39], v[116:119]
  buffer_load_dwordx4 v26, s[44:47], s32 offen offset:2048  lds
  v_mfma_f32_16x16x32_bf16 v[116:119], a[12:15], a[40:43], v[116:119]
  ds_read_b128 a[112:115], v68 offset:2304
  v_add_u32 v37, 0x10000, v29
  v_mfma_f32_16x16x32_bf16 v[116:119], a[8:11], a[44:47], v[116:119]
  ds_read2_b32 a[80:81], v66 offset0:48 offset1:49
  v_add_u32 v38, 0x10000, v30
  v_mfma_f32_16x16x32_bf16 v[116:119], a[4:7], a[48:51], v[116:119]
  ds_read2_b32 a[82:83], v66 offset0:50 offset1:51
  v_add_u32 v39, 0x10000, v31
  v_mfma_f32_16x16x32_bf16 v[116:119], a[0:3], a[52:55], v[116:119]
  ds_read_b128 a[116:119], v68 offset:2816
  v_add_u32 v40, 0x10000, v32
  v_mfma_f32_16x16x32_bf16 v[120:123], a[0:3], a[56:59], v[120:123]
  buffer_load_dwordx4 v27, s[44:47], s32 offen offset:3072  lds
  v_mfma_f32_16x16x32_bf16 v[120:123], a[4:7], a[52:55], v[120:123]
  s_xor_b32 s32, s100, 0x60000
  ds_read2_b32 a[84:85], v66 offset0:176 offset1:177
  v_add_u32 v41, 0x10000, v33
  v_mfma_f32_16x16x32_bf16 v[120:123], a[8:11], a[48:51], v[120:123]
  s_add_u32 m0, s37, 49152
  ds_read2_b32 a[86:87], v66 offset0:178 offset1:179
  v_add_u32 v42, 0x10000, v34
  v_mfma_f32_16x16x32_bf16 v[120:123], a[12:15], a[44:47], v[120:123]
  ds_read_b128 a[120:123], v68 offset:3328
  v_add_u32 v43, 0x10000, v35
  v_mfma_f32_16x16x32_bf16 v[120:123], a[16:19], a[40:43], v[120:123]
  s_lshl_b32 s3, s38, 2
  ds_read2_b32 a[88:89], v67 offset0:48 offset1:49
  v_mfma_f32_16x16x32_bf16 v[120:123], a[20:23], a[36:39], v[120:123]
  s_waitcnt lgkmcnt(15)
  s_lshl_b32 s31, s97, 1
  buffer_load_dwordx4 v24, s[44:47], s32 offen offset:0  lds
  v_mfma_f32_16x16x32_bf16 v[120:123], a[24:27], a[32:35], v[120:123]
  s_add_u32 s3, s3, s31
  ds_read2_b32 a[90:91], v67 offset0:50 offset1:51
  v_mfma_f32_16x16x32_bf16 v[124:127], a[28:31], a[32:35], v[124:127]
  s_lshr_b32 s31, s8, 1
  ds_read_b128 a[124:127], v68 offset:3840
  v_mfma_f32_16x16x32_bf16 v[124:127], a[24:27], a[36:39], v[124:127]
  s_add_u32 s97, s3, s31
  ds_read2_b32 a[92:93], v67 offset0:176 offset1:177
  v_mfma_f32_16x16x32_bf16 v[124:127], a[20:23], a[40:43], v[124:127]
  s_lshl_b32 s3, s39, 1
  ds_read2_b32 a[94:95], v67 offset0:178 offset1:179
  v_mfma_f32_16x16x32_bf16 v[124:127], a[16:19], a[44:47], v[124:127]
  s_and_b32 s31, s2, 1
  buffer_load_dwordx4 v25, s[44:47], s32 offen offset:1024  lds
  v_mfma_f32_16x16x32_bf16 v[124:127], a[12:15], a[48:51], v[124:127]
  s_add_u32 s76, s3, s31
  v_mfma_f32_16x16x32_bf16 v[124:127], a[8:11], a[52:55], v[124:127]
  s_lshl_b32 s3, s97, 16
  v_mfma_f32_16x16x32_bf16 v[124:127], a[4:7], a[56:59], v[124:127]
  s_lshl_b32 s31, s76, 7
  v_mfma_f32_16x16x32_bf16 v[124:127], a[0:3], a[60:63], v[124:127]
  s_add_u32 s3, s3, s31
  v_mfma_f32_16x16x32_bf16 v[96:99], a[64:67], a[96:99], v[96:99]
  s_waitcnt lgkmcnt(15)
  buffer_load_dwordx4 v26, s[44:47], s32 offen offset:2048  lds
  v_mfma_f32_16x16x32_bf16 v[100:103], a[68:71], a[96:99], v[100:103]
  s_add_u32 s48, s64, s3
  s_addc_u32 s49, s65, 0
  ds_read_b128 a[32:35], v68 offset:192
  v_mfma_f32_16x16x32_bf16 v[100:103], a[64:67], a[100:103], v[100:103]
  s_mov_b32 s50, 0xf880
  ds_read2_b32 a[0:1], v64 offset0:64 offset1:65
  v_mfma_f32_16x16x32_bf16 v[104:107], a[64:67], a[104:107], v[104:107]
  s_mov_b32 s51, 0x20000
  ds_read2_b32 a[2:3], v64 offset0:66 offset1:67
  v_mfma_f32_16x16x32_bf16 v[104:107], a[68:71], a[100:103], v[104:107]
  s_add_u32 s60, s90, s3
  s_addc_u32 s61, s91, 0
  ds_read_b128 a[36:39], v68 offset:704
  v_mfma_f32_16x16x32_bf16 v[104:107], a[72:75], a[96:99], v[104:107]
  s_waitcnt lgkmcnt(15)
  s_mov_b32 s62, 0xf880
  buffer_load_dwordx4 v27, s[44:47], s32 offen offset:3072  lds
  v_mfma_f32_16x16x32_bf16 v[108:111], a[76:79], a[96:99], v[108:111]
  s_mov_b32 s63, 0x20000
  ds_read2_b32 a[4:5], v64 offset0:192 offset1:193
  v_mfma_f32_16x16x32_bf16 v[108:111], a[72:75], a[100:103], v[108:111]
  s_lshl_b32 s3, s76, 18
  ds_read2_b32 a[6:7], v64 offset0:194 offset1:195
  v_mfma_f32_16x16x32_bf16 v[108:111], a[68:71], a[104:107], v[108:111]
  s_lshl_b32 s31, s97, 8
  ds_read_b128 a[40:43], v68 offset:1216
  v_mfma_f32_16x16x32_bf16 v[108:111], a[64:67], a[108:111], v[108:111]
  s_add_u32 s3, s3, s31
  ds_read2_b32 a[8:9], v65 offset0:64 offset1:65
  v_mfma_f32_16x16x32_bf16 v[112:115], a[64:67], a[112:115], v[112:115]
  s_add_u32 s52, s94, s3
  s_addc_u32 s53, s95, 0
  ds_read2_b32 a[10:11], v65 offset0:66 offset1:67
  v_mfma_f32_16x16x32_bf16 v[112:115], a[68:71], a[108:111], v[112:115]
  s_add_u32 s52, s52, 0x3800000
  s_addc_u32 s53, s53, 0
  v_mfma_f32_16x16x32_bf16 v[112:115], a[72:75], a[104:107], v[112:115]
  s_mov_b32 s54, 0x3c100
  ds_read_b128 a[44:47], v68 offset:1728
  v_mfma_f32_16x16x32_bf16 v[112:115], a[76:79], a[100:103], v[112:115]
  s_mov_b32 s55, 0x20000
  ds_read2_b32 a[12:13], v65 offset0:192 offset1:193
  s_waitcnt lgkmcnt(15)
  v_mfma_f32_16x16x32_bf16 v[112:115], a[80:83], a[96:99], v[112:115]
  s_lshl_b32 s3, s97, 7
  ds_read2_b32 a[14:15], v65 offset0:194 offset1:195
  v_mfma_f32_16x16x32_bf16 v[116:119], a[84:87], a[96:99], v[116:119]
  s_add_u32 s56, s94, s3
  s_addc_u32 s57, s95, 0
  v_mfma_f32_16x16x32_bf16 v[116:119], a[80:83], a[100:103], v[116:119]
  s_add_u32 s56, s56, 0x3c00000
  s_addc_u32 s57, s57, 0
  ds_read_b128 a[48:51], v68 offset:2240
  v_mfma_f32_16x16x32_bf16 v[116:119], a[76:79], a[104:107], v[116:119]
  s_mov_b32 s58, 0x80
  ds_read2_b32 a[16:17], v66 offset0:64 offset1:65
  v_mfma_f32_16x16x32_bf16 v[116:119], a[72:75], a[108:111], v[116:119]
  s_mov_b32 s59, 0x20000
  ds_read2_b32 a[18:19], v66 offset0:66 offset1:67
  v_mfma_f32_16x16x32_bf16 v[116:119], a[68:71], a[112:115], v[116:119]
  s_lshr_b32 s3, s2, 2
  v_mfma_f32_16x16x32_bf16 v[116:119], a[64:67], a[116:119], v[116:119]
  s_lshl_b32 s3, s3, 18
  ds_read_b128 a[52:55], v68 offset:2752
  v_mfma_f32_16x16x32_bf16 v[120:123], a[64:67], a[120:123], v[120:123]
  s_lshl_b32 s31, s28, 14
  ds_read2_b32 a[20:21], v66 offset0:192 offset1:193
  v_mfma_f32_16x16x32_bf16 v[120:123], a[68:71], a[116:119], v[120:123]
  s_add_u32 s3, s3, s31
  ds_read2_b32 a[22:23], v66 offset0:194 offset1:195
  v_mfma_f32_16x16x32_bf16 v[120:123], a[72:75], a[112:115], v[120:123]
  s_add_u32 s4, s94, s3
  s_addc_u32 s5, s95, 0
  v_mfma_f32_16x16x32_bf16 v[120:123], a[76:79], a[108:111], v[120:123]
  buffer_load_dword v10, v6, s[20:23], 0 offen offset:8 sc1
  v_mfma_f32_16x16x32_bf16 v[120:123], a[80:83], a[104:107], v[120:123]
  s_add_u32 s4, s4, 0x4000000
  s_addc_u32 s5, s5, 0
  ds_read_b128 a[56:59], v68 offset:3264
  v_mfma_f32_16x16x32_bf16 v[120:123], a[84:87], a[100:103], v[120:123]
  s_mov_b32 s6, 0x34000
  ds_read2_b32 a[24:25], v67 offset0:64 offset1:65
  s_waitcnt lgkmcnt(15)
  v_mfma_f32_16x16x32_bf16 v[120:123], a[88:91], a[96:99], v[120:123]
  s_mov_b32 s7, 0x20000
  ds_read2_b32 a[26:27], v67 offset0:66 offset1:67
  v_mfma_f32_16x16x32_bf16 v[124:127], a[92:95], a[96:99], v[124:127]
  s_lshl_b32 s8, s8, 16
  ds_read_b128 a[60:63], v68 offset:3776
  v_mfma_f32_16x16x32_bf16 v[124:127], a[88:91], a[100:103], v[124:127]
  s_lshl_b32 s3, s2, 11
  ds_read2_b32 a[28:29], v67 offset0:192 offset1:193
  v_mfma_f32_16x16x32_bf16 v[124:127], a[84:87], a[104:107], v[124:127]
  s_lshl_b32 s31, s28, 9
  ds_read2_b32 a[30:31], v67 offset0:194 offset1:195
  v_mfma_f32_16x16x32_bf16 v[124:127], a[80:83], a[108:111], v[124:127]
  s_add_u32 s35, s3, s31
  v_mfma_f32_16x16x32_bf16 v[124:127], a[76:79], a[112:115], v[124:127]
  v_min_u32 v18, 2, v1
  v_mfma_f32_16x16x32_bf16 v[124:127], a[72:75], a[116:119], v[124:127]
  v_lshlrev_b32 v45, 7, v18
  v_mfma_f32_16x16x32_bf16 v[124:127], a[68:71], a[120:123], v[124:127]
  s_lshl_b32 s3, s76, 15
  v_lshrrev_b32 v80, 4, v1
  v_bfe_u32 v81, v1, 2, 2
  v_mfma_f32_16x16x32_bf16 v[124:127], a[64:67], a[124:127], v[124:127]
  v_lshlrev_b32 v7, 11, v17
  v_xor_b32 v69, v80, v81
  v_mfma_f32_16x16x32_bf16 v[96:99], a[0:3], a[32:35], v[96:99]
  ds_read_b128 a[96:99], v68 offset:128
  v_add_u32 v7, s3, v7
  s_waitcnt lgkmcnt(15)
  v_mfma_f32_16x16x32_bf16 v[100:103], a[4:7], a[32:35], v[100:103]
  s_add_u32 s3, s37, 0x20000
  ds_read2_b32 a[64:65], v64 offset0:80 offset1:81
  v_lshlrev_b32 v69, 3, v69
  v_mfma_f32_16x16x32_bf16 v[100:103], a[0:3], a[36:39], v[100:103]
  ds_read2_b32 a[66:67], v64 offset0:82 offset1:83
  v_lshrrev_b32 v18, 3, v1
  v_mfma_f32_16x16x32_bf16 v[104:107], a[0:3], a[40:43], v[104:107]
  v_and_b32 v19, 7, v1
  v_mul_u32_u24 v70, 4224, v81
  v_mfma_f32_16x16x32_bf16 v[104:107], a[4:7], a[36:39], v[104:107]
  ds_read_b128 a[100:103], v68 offset:640
  v_lshlrev_b32 v62, 11, v18
  v_mfma_f32_16x16x32_bf16 v[104:107], a[8:11], a[32:35], v[104:107]
  ds_read2_b32 a[68:69], v64 offset0:208 offset1:209
  v_lshl_add_u32 v62, v19, 4, v62
  s_waitcnt lgkmcnt(15)
  v_mfma_f32_16x16x32_bf16 v[108:111], a[12:15], a[32:35], v[108:111]
  ds_read2_b32 a[70:71], v64 offset0:210 offset1:211
  v_xor_b32 v19, v19, v18
  v_mfma_f32_16x16x32_bf16 v[108:111], a[8:11], a[36:39], v[108:111]
  v_lshlrev_b32 v19, 4, v19
  v_lshrrev_b32 v81, 1, v81
  v_mfma_f32_16x16x32_bf16 v[108:111], a[4:7], a[40:43], v[108:111]
  ds_read_b128 a[104:107], v68 offset:1152
  v_lshl_add_u32 v46, v18, 11, v19
  v_mfma_f32_16x16x32_bf16 v[108:111], a[0:3], a[44:47], v[108:111]
  ds_read2_b32 a[72:73], v65 offset0:80 offset1:81
  v_lshl_add_u32 v63, v18, 7, v19
  v_mfma_f32_16x16x32_bf16 v[112:115], a[0:3], a[48:51], v[112:115]
  ds_read2_b32 a[74:75], v65 offset0:82 offset1:83
  v_add_u32 v63, s3, v63
  v_mfma_f32_16x16x32_bf16 v[112:115], a[4:7], a[44:47], v[112:115]
  v_and_b32 v18, 7, v17
  v_lshl_add_u32 v70, v81, 5, v70
  v_mfma_f32_16x16x32_bf16 v[112:115], a[8:11], a[40:43], v[112:115]
  ds_read_b128 a[108:111], v68 offset:1664
  v_lshrrev_b32 v19, 1, v16
  v_mfma_f32_16x16x32_bf16 v[112:115], a[12:15], a[36:39], v[112:115]
  ds_read2_b32 a[76:77], v65 offset0:208 offset1:209
  v_xor_b32 v18, v18, v19
  s_waitcnt lgkmcnt(15)
  v_mfma_f32_16x16x32_bf16 v[112:115], a[16:19], a[32:35], v[112:115]
  ds_read2_b32 a[78:79], v65 offset0:210 offset1:211
  v_lshlrev_b32 v18, 4, v18
  v_mfma_f32_16x16x32_bf16 v[116:119], a[20:23], a[32:35], v[116:119]
  v_lshl_add_u32 v18, v17, 7, v18
  v_lshl_add_u32 v70, v80, 6, v70
  v_mfma_f32_16x16x32_bf16 v[116:119], a[16:19], a[36:39], v[116:119]
  ds_read_b128 a[112:115], v68 offset:2176
  v_and_b32 v19, 1, v16
  v_mfma_f32_16x16x32_bf16 v[116:119], a[12:15], a[40:43], v[116:119]
  s_waitcnt vmcnt(13)
  ds_read2_b32 a[80:81], v66 offset0:80 offset1:81
  v_lshl_add_u32 v18, v19, 3, v18
  v_mfma_f32_16x16x32_bf16 v[116:119], a[8:11], a[44:47], v[116:119]
  s_barrier
  v_mfma_f32_16x16x32_bf16 v[116:119], a[4:7], a[48:51], v[116:119]
  ds_read2_b32 a[82:83], v66 offset0:82 offset1:83
  v_add_u32 v44, s3, v18
  v_mfma_f32_16x16x32_bf16 v[116:119], a[0:3], a[52:55], v[116:119]
  ds_read_b128 a[116:119], v68 offset:2688
  v_lshlrev_b32 v47, 14, v16
  v_mfma_f32_16x16x32_bf16 v[120:123], a[0:3], a[56:59], v[120:123]
  ds_read2_b32 a[84:85], v66 offset0:208 offset1:209
  v_lshl_add_u32 v47, v17, 4, v47
  v_mfma_f32_16x16x32_bf16 v[120:123], a[4:7], a[52:55], v[120:123]
  ds_read2_b32 a[86:87], v66 offset0:210 offset1:211
  v_lshlrev_b32 v48, 2, v17
  v_mfma_f32_16x16x32_bf16 v[120:123], a[8:11], a[48:51], v[120:123]
  v_lshlrev_b32 v49, 20, v1
  v_lshrrev_b32 v80, 1, v80
  v_mfma_f32_16x16x32_bf16 v[120:123], a[12:15], a[44:47], v[120:123]
  ds_read_b128 a[120:123], v68 offset:3200
  v_xor_b32 v56, 0, v44
  v_mfma_f32_16x16x32_bf16 v[120:123], a[16:19], a[40:43], v[120:123]
  ds_read2_b32 a[88:89], v67 offset0:80 offset1:81
  v_xor_b32 v57, 32, v44
  v_mfma_f32_16x16x32_bf16 v[120:123], a[20:23], a[36:39], v[120:123]
  ds_read2_b32 a[90:91], v67 offset0:82 offset1:83
  v_xor_b32 v58, 64, v44
  s_waitcnt lgkmcnt(15)
  v_mfma_f32_16x16x32_bf16 v[120:123], a[24:27], a[32:35], v[120:123]
  v_xor_b32 v59, 96, v44
  v_and_b32 v81, 3, v1
  v_mfma_f32_16x16x32_bf16 v[124:127], a[28:31], a[32:35], v[124:127]
  ds_read_b128 a[124:127], v68 offset:3712
  v_xor_b32 v80, v80, v81
  v_mfma_f32_16x16x32_bf16 v[124:127], a[24:27], a[36:39], v[124:127]
  ds_read2_b32 a[92:93], v67 offset0:208 offset1:209
  v_lshl_add_u32 v70, v80, 3, v70
  v_mfma_f32_16x16x32_bf16 v[124:127], a[20:23], a[40:43], v[124:127]
  ds_read2_b32 a[94:95], v67 offset0:210 offset1:211
  v_lshrrev_b32 v81, 6, v0
  v_mfma_f32_16x16x32_bf16 v[124:127], a[16:19], a[44:47], v[124:127]
  v_lshl_add_u32 v70, v81, 10, v70
  v_add_u32 v70, 0x18000, v70
  v_mfma_f32_16x16x32_bf16 v[124:127], a[12:15], a[48:51], v[124:127]
  v_xor_b32 v71, 16, v70
  v_mul_u32_u24 v80, 4224, v81
  v_mfma_f32_16x16x32_bf16 v[124:127], a[8:11], a[52:55], v[124:127]
  v_add_u32 v69, v69, v80
  v_lshrrev_b32 v81, 1, v81
  v_mfma_f32_16x16x32_bf16 v[124:127], a[4:7], a[56:59], v[124:127]
  v_and_b32 v80, 15, v1
  v_add_u32 v80, v80, v81
  v_mfma_f32_16x16x32_bf16 v[124:127], a[0:3], a[60:63], v[124:127]
  v_lshl_add_u32 v69, v80, 5, v69
  v_add_u32 v69, 0x18000, v69
  v_mfma_f32_16x16x32_bf16 v[96:99], a[64:67], a[96:99], v[96:99]
  s_mov_b64 exec, 0
  s_cmp_eq_u32 s28, 0
  s_cbranch_scc1 L_pad16
  s_cmp_eq_u32 s28, 1
  s_cbranch_scc1 L_pad17
  s_cmp_eq_u32 s28, 2
  s_cbranch_scc1 L_pad18
  s_branch L_pad19
L_hr2:
  s_mov_b64 exec, -1
  v_mfma_f32_16x16x32_bf16 v[100:103], a[68:71], a[96:99], v[100:103]
  ds_read_b128 a[32:35], v68 offset:64
  v_mfma_f32_16x16x32_bf16 v[100:103], a[64:67], a[100:103], v[100:103]
  s_waitcnt vmcnt(0)
  s_mov_b32 s0, 0
L_ctx_loop:
  v_cmp_ne_u32 vcc, 1, v10
  s_nop 2
  s_cbranch_vccz L_ctx_ok
  buffer_load_dword v10, v6, s[20:23], 0 offen offset:8 sc1
  s_add_u32 s0, s0, 1
  s_cmp_lt_u32 s0, 0x200000
  s_waitcnt vmcnt(0)
  s_cbranch_scc1 L_ctx_loop
L_ctx_ok:
  s_waitcnt lgkmcnt(15)
  v_mfma_f32_16x16x32_bf16 v[104:107], a[64:67], a[104:107], v[104:107]
  s_xor_b32 s34, s101, 0x0
  ds_read2_b32 a[0:1], v64 offset0:96 offset1:97
  v_mfma_f32_16x16x32_bf16 v[104:107], a[68:71], a[100:103], v[104:107]
  buffer_load_dwordx4 v[192:195], v60, s[40:43], s34 offen offset:0 sc1
  v_mfma_f32_16x16x32_bf16 v[104:107], a[72:75], a[96:99], v[104:107]
  ds_read2_b32 a[2:3], v64 offset0:98 offset1:99
  s_waitcnt lgkmcnt(15)
  v_mfma_f32_16x16x32_bf16 v[108:111], a[76:79], a[96:99], v[108:111]
  ds_read_b128 a[36:39], v68 offset:576
  v_mfma_f32_16x16x32_bf16 v[108:111], a[72:75], a[100:103], v[108:111]
  buffer_load_dwordx4 v[200:203], v60, s[40:43], s34 offen offset:1024 sc1
  v_mfma_f32_16x16x32_bf16 v[108:111], a[68:71], a[104:107], v[108:111]
  ds_read2_b32 a[4:5], v64 offset0:224 offset1:225
  v_mfma_f32_16x16x32_bf16 v[108:111], a[64:67], a[108:111], v[108:111]
  ds_read2_b32 a[6:7], v64 offset0:226 offset1:227
  s_waitcnt lgkmcnt(15)
  v_mfma_f32_16x16x32_bf16 v[112:115], a[64:67], a[112:115], v[112:115]
  ds_read_b128 a[40:43], v68 offset:1088
  v_mfma_f32_16x16x32_bf16 v[112:115], a[68:71], a[108:111], v[112:115]
  buffer_load_dwordx4 v[208:211], v61, s[40:43], s34 offen offset:0 sc1
  v_mfma_f32_16x16x32_bf16 v[112:115], a[72:75], a[104:107], v[112:115]
  ds_read2_b32 a[8:9], v65 offset0:96 offset1:97
  v_mfma_f32_16x16x32_bf16 v[112:115], a[76:79], a[100:103], v[112:115]
  ds_read2_b32 a[10:11], v65 offset0:98 offset1:99
  v_mfma_f32_16x16x32_bf16 v[112:115], a[80:83], a[96:99], v[112:115]
  ds_read_b128 a[44:47], v68 offset:1600
  s_waitcnt lgkmcnt(15)
  v_mfma_f32_16x16x32_bf16 v[116:119], a[84:87], a[96:99], v[116:119]
  buffer_load_dwordx4 v[216:219], v61, s[40:43], s34 offen offset:1024 sc1
  v_mfma_f32_16x16x32_bf16 v[116:119], a[80:83], a[100:103], v[116:119]
  s_xor_b32 s34, s101, 0x2000
  ds_read2_b32 a[12:13], v65 offset0:224 offset1:225
  v_mfma_f32_16x16x32_bf16 v[116:119], a[76:79], a[104:107], v[116:119]
  ds_read2_b32 a[14:15], v65 offset0:226 offset1:227
  v_mfma_f32_16x16x32_bf16 v[116:119], a[72:75], a[108:111], v[116:119]
  ds_read_b128 a[48:51], v68 offset:2112
  v_mfma_f32_16x16x32_bf16 v[116:119], a[68:71], a[112:115], v[116:119]
  buffer_load_dwordx4 v[196:199], v60, s[40:43], s34 offen offset:0 sc1
  v_mfma_f32_16x16x32_bf16 v[116:119], a[64:67], a[116:119], v[116:119]
  ds_read2_b32 a[16:17], v66 offset0:96 offset1:97
  v_mfma_f32_16x16x32_bf16 v[120:123], a[64:67], a[120:123], v[120:123]
  ds_read2_b32 a[18:19], v66 offset0:98 offset1:99
  v_mfma_f32_16x16x32_bf16 v[120:123], a[68:71], a[116:119], v[120:123]
  ds_read_b128 a[52:55], v68 offset:2624
  v_mfma_f32_16x16x32_bf16 v[120:123], a[72:75], a[112:115], v[120:123]
  buffer_load_dwordx4 v[204:207], v60, s[40:43], s34 offen offset:1024 sc1
  v_mfma_f32_16x16x32_bf16 v[120:123], a[76:79], a[108:111], v[120:123]
  ds_read2_b32 a[20:21], v66 offset0:224 offset1:225
  v_mfma_f32_16x16x32_bf16 v[120:123], a[80:83], a[104:107], v[120:123]
  ds_read2_b32 a[22:23], v66 offset0:226 offset1:227
  v_mfma_f32_16x16x32_bf16 v[120:123], a[84:87], a[100:103], v[120:123]
  ds_read_b128 a[56:59], v68 offset:3136
  s_waitcnt lgkmcnt(15)
  v_mfma_f32_16x16x32_bf16 v[120:123], a[88:91], a[96:99], v[120:123]
  buffer_load_dwordx4 v[212:215], v61, s[40:43], s34 offen offset:0 sc1
  v_mfma_f32_16x16x32_bf16 v[124:127], a[92:95], a[96:99], v[124:127]
  ds_read2_b32 a[24:25], v67 offset0:96 offset1:97
  v_mfma_f32_16x16x32_bf16 v[124:127], a[88:91], a[100:103], v[124:127]
  ds_read2_b32 a[26:27], v67 offset0:98 offset1:99
  v_mfma_f32_16x16x32_bf16 v[124:127], a[84:87], a[104:107], v[124:127]
  ds_read_b128 a[60:63], v68 offset:3648
  v_mfma_f32_16x16x32_bf16 v[124:127], a[80:83], a[108:111], v[124:127]
  buffer_load_dwordx4 v[220:223], v61, s[40:43], s34 offen offset:1024 sc1
  v_mfma_f32_16x16x32_bf16 v[124:127], a[76:79], a[112:115], v[124:127]
  s_xor_b32 s34, s101, 0x4000
  ds_read2_b32 a[28:29], v67 offset0:224 offset1:225
  v_mfma_f32_16x16x32_bf16 v[124:127], a[72:75], a[116:119], v[124:127]
  ds_read2_b32 a[30:31], v67 offset0:226 offset1:227
  v_mfma_f32_16x16x32_bf16 v[124:127], a[68:71], a[120:123], v[124:127]
  ds_read_b64_tr_b16 a[128:129], v28 offset:0
  v_mfma_f32_16x16x32_bf16 v[124:127], a[64:67], a[124:127], v[124:127]
  buffer_load_dwordx4 v[224:227], v60, s[40:43], s34 offen offset:0 sc1
  v_mfma_f32_16x16x32_bf16 v[96:99], a[0:3], a[32:35], v[96:99]
  ds_read_b128 a[96:99], v68 offset:0
  s_waitcnt lgkmcnt(15)
  v_mfma_f32_16x16x32_bf16 v[100:103], a[4:7], a[32:35], v[100:103]
  ds_read2_b32 a[64:65], v64 offset0:112 offset1:113
  v_mfma_f32_16x16x32_bf16 v[100:103], a[0:3], a[36:39], v[100:103]
  ds_read2_b32 a[66:67], v64 offset0:114 offset1:115
  v_mfma_f32_16x16x32_bf16 v[104:107], a[0:3], a[40:43], v[104:107]
  buffer_load_dwordx4 v[232:235], v60, s[40:43], s34 offen offset:1024 sc1
  v_mfma_f32_16x16x32_bf16 v[104:107], a[4:7], a[36:39], v[104:107]
  ds_read_b128 a[100:103], v68 offset:512
  v_mfma_f32_16x16x32_bf16 v[104:107], a[8:11], a[32:35], v[104:107]
  ds_read2_b32 a[68:69], v64 offset0:240 offset1:241
  s_waitcnt lgkmcnt(15)
  v_mfma_f32_16x16x32_bf16 v[108:111], a[12:15], a[32:35], v[108:111]
  s_lshl_b32 s3, s2, 14
  ds_read2_b32 a[70:71], v64 offset0:242 offset1:243
  v_mfma_f32_16x16x32_bf16 v[108:111], a[8:11], a[36:39], v[108:111]
  s_lshl_b32 s31, s28, 12
  buffer_load_dwordx4 v[240:243], v61, s[40:43], s34 offen offset:0 sc1
  v_mfma_f32_16x16x32_bf16 v[108:111], a[4:7], a[40:43], v[108:111]
  s_add_u32 s3, s3, s31
  ds_read_b128 a[104:107], v68 offset:1024
  v_mfma_f32_16x16x32_bf16 v[108:111], a[0:3], a[44:47], v[108:111]
  s_add_u32 s24, s94, s3
  s_addc_u32 s25, s95, 0
  ds_read2_b32 a[72:73], v65 offset0:112 offset1:113
  v_mfma_f32_16x16x32_bf16 v[112:115], a[0:3], a[48:51], v[112:115]
  s_add_u32 s24, s24, 0x3800000
  s_addc_u32 s25, s25, 0
  ds_read2_b32 a[74:75], v65 offset0:114 offset1:115
  v_mfma_f32_16x16x32_bf16 v[112:115], a[4:7], a[44:47], v[112:115]
  s_mov_b32 s26, 0x1000
  buffer_load_dwordx4 v[248:251], v61, s[40:43], s34 offen offset:1024 sc1
  v_mfma_f32_16x16x32_bf16 v[112:115], a[8:11], a[40:43], v[112:115]
  s_xor_b32 s34, s101, 0x6000
  s_mov_b32 s27, 0x20000
  ds_read_b128 a[108:111], v68 offset:1536
  v_mfma_f32_16x16x32_bf16 v[112:115], a[12:15], a[36:39], v[112:115]
  ds_read2_b32 a[76:77], v65 offset0:240 offset1:241
  v_mfma_f32_16x16x32_bf16 v[112:115], a[16:19], a[32:35], v[112:115]
  ds_read2_b32 a[78:79], v65 offset0:242 offset1:243
  s_waitcnt lgkmcnt(15)
  v_mfma_f32_16x16x32_bf16 v[116:119], a[20:23], a[32:35], v[116:119]
  buffer_load_dwordx4 v[228:231], v60, s[40:43], s34 offen offset:0 sc1
  v_mfma_f32_16x16x32_bf16 v[116:119], a[16:19], a[36:39], v[116:119]
  ds_read_b128 a[112:115], v68 offset:2048
  v_mfma_f32_16x16x32_bf16 v[116:119], a[12:15], a[40:43], v[116:119]
  ds_read2_b32 a[80:81], v66 offset0:112 offset1:113
  v_mfma_f32_16x16x32_bf16 v[116:119], a[8:11], a[44:47], v[116:119]
  ds_read2_b32 a[82:83], v66 offset0:114 offset1:115
  v_mfma_f32_16x16x32_bf16 v[116:119], a[4:7], a[48:51], v[116:119]
  buffer_load_dwordx4 v[236:239], v60, s[40:43], s34 offen offset:1024 sc1
  v_mfma_f32_16x16x32_bf16 v[116:119], a[0:3], a[52:55], v[116:119]
  ds_read_b128 a[116:119], v68 offset:2560
  v_mfma_f32_16x16x32_bf16 v[120:123], a[0:3], a[56:59], v[120:123]
  ds_read2_b32 a[84:85], v66 offset0:240 offset1:241
  v_mfma_f32_16x16x32_bf16 v[120:123], a[4:7], a[52:55], v[120:123]
  ds_read2_b32 a[86:87], v66 offset0:242 offset1:243
  v_mfma_f32_16x16x32_bf16 v[120:123], a[8:11], a[48:51], v[120:123]
  buffer_load_dwordx4 v[244:247], v61, s[40:43], s34 offen offset:0 sc1
  v_mfma_f32_16x16x32_bf16 v[120:123], a[12:15], a[44:47], v[120:123]
  ds_read_b128 a[120:123], v68 offset:3072
  v_mfma_f32_16x16x32_bf16 v[120:123], a[16:19], a[40:43], v[120:123]
  ds_read2_b32 a[88:89], v67 offset0:112 offset1:113
  v_mfma_f32_16x16x32_bf16 v[120:123], a[20:23], a[36:39], v[120:123]
  ds_read2_b32 a[90:91], v67 offset0:114 offset1:115
  v_mfma_f32_16x16x32_bf16 v[120:123], a[24:27], a[32:35], v[120:123]
  s_waitcnt lgkmcnt(15)
  buffer_load_dwordx4 v[252:255], v61, s[40:43], s34 offen offset:1024 sc1
  v_mfma_f32_16x16x32_bf16 v[124:127], a[28:31], a[32:35], v[124:127]
  s_xor_b32 s34, s101, 0x8000
  ds_read_b128 a[124:127], v68 offset:3584
  v_mfma_f32_16x16x32_bf16 v[124:127], a[24:27], a[36:39], v[124:127]
  ds_read_b64_tr_b16 a[130:131], v28 offset:4096
  v_mfma_f32_16x16x32_bf16 v[124:127], a[20:23], a[40:43], v[124:127]
  ds_read_b64_tr_b16 a[132:133], v28 offset:8192
  v_mfma_f32_16x16x32_bf16 v[124:127], a[16:19], a[44:47], v[124:127]
  buffer_load_dwordx4 a[192:195], v60, s[40:43], s34 offen offset:0 sc1
  v_mfma_f32_16x16x32_bf16 v[124:127], a[12:15], a[48:51], v[124:127]
  ds_read_b64_tr_b16 a[134:135], v28 offset:12288
  v_mfma_f32_16x16x32_bf16 v[124:127], a[8:11], a[52:55], v[124:127]
  ds_read_b64_tr_b16 a[136:137], v29 offset:0
  v_mfma_f32_16x16x32_bf16 v[124:127], a[4:7], a[56:59], v[124:127]
  ds_read_b64_tr_b16 a[138:139], v29 offset:4096
  v_mfma_f32_16x16x32_bf16 v[124:127], a[0:3], a[60:63], v[124:127]
  buffer_load_dwordx4 a[200:203], v60, s[40:43], s34 offen offset:1024 sc1
  v_mfma_f32_16x16x32_bf16 v[96:99], a[64:67], a[96:99], v[96:99]
  ds_read_b64_tr_b16 a[140:141], v29 offset:8192
  v_mfma_f32_16x16x32_bf16 v[100:103], a[68:71], a[96:99], v[100:103]
  ds_read_b64_tr_b16 a[142:143], v29 offset:12288
  v_mfma_f32_16x16x32_bf16 v[100:103], a[64:67], a[100:103], v[100:103]
  ds_read_b64_tr_b16 a[144:145], v30 offset:0
  s_waitcnt lgkmcnt(15)
  v_mfma_f32_16x16x32_bf16 v[104:107], a[64:67], a[104:107], v[104:107]
  buffer_load_dwordx4 a[208:211], v61, s[40:43], s34 offen offset:0 sc1
  v_mfma_f32_16x16x32_bf16 v[104:107], a[68:71], a[100:103], v[104:107]
  ds_read_b64_tr_b16 a[146:147], v30 offset:4096
  v_mfma_f32_16x16x32_bf16 v[104:107], a[72:75], a[96:99], v[104:107]
  ds_read_b64_tr_b16 a[148:149], v30 offset:8192
  v_mfma_f32_16x16x32_bf16 v[108:111], a[76:79], a[96:99], v[108:111]
  ds_read_b64_tr_b16 a[150:151], v30 offset:12288
  v_mfma_f32_16x16x32_bf16 v[108:111], a[72:75], a[100:103], v[108:111]
  buffer_load_dwordx4 a[216:219], v61, s[40:43], s34 offen offset:1024 sc1
  v_mfma_f32_16x16x32_bf16 v[108:111], a[68:71], a[104:107], v[108:111]
  s_xor_b32 s34, s101, 0xa000
  ds_read_b64_tr_b16 a[152:153], v31 offset:0
  v_cvt_pk_bf16_f32 v96, v96, v97
  v_mfma_f32_16x16x32_bf16 v[108:111], a[64:67], a[108:111], v[108:111]
  ds_read_b64_tr_b16 a[154:155], v31 offset:4096
  v_cvt_pk_bf16_f32 v97, v98, v99
  v_mfma_f32_16x16x32_bf16 v[112:115], a[64:67], a[112:115], v[112:115]
  ds_read_b64_tr_b16 a[156:157], v31 offset:8192
  v_cvt_pk_bf16_f32 v100, v100, v101
  v_mfma_f32_16x16x32_bf16 v[112:115], a[68:71], a[108:111], v[112:115]
  buffer_load_dwordx4 a[196:199], v60, s[40:43], s34 offen offset:0 sc1
  v_mfma_f32_16x16x32_bf16 v[112:115], a[72:75], a[104:107], v[112:115]
  ds_read_b64_tr_b16 a[158:159], v31 offset:12288
  v_cvt_pk_bf16_f32 v101, v102, v103
  v_mfma_f32_16x16x32_bf16 v[112:115], a[76:79], a[100:103], v[112:115]
  ds_read_b64_tr_b16 a[160:161], v32 offset:0
  v_cvt_pk_bf16_f32 v104, v104, v105
  v_mfma_f32_16x16x32_bf16 v[112:115], a[80:83], a[96:99], v[112:115]
  ds_read_b64_tr_b16 a[162:163], v32 offset:4096
  v_cvt_pk_bf16_f32 v105, v106, v107
  s_waitcnt lgkmcnt(15)
  v_mfma_f32_16x16x32_bf16 v[116:119], a[84:87], a[96:99], v[116:119]
  buffer_load_dwordx4 a[204:207], v60, s[40:43], s34 offen offset:1024 sc1
  v_mfma_f32_16x16x32_bf16 v[116:119], a[80:83], a[100:103], v[116:119]
  ds_read_b64_tr_b16 a[164:165], v32 offset:8192
  v_cvt_pk_bf16_f32 v108, v108, v109
  v_mfma_f32_16x16x32_bf16 v[116:119], a[76:79], a[104:107], v[116:119]
  ds_read_b64_tr_b16 a[166:167], v32 offset:12288
  v_cvt_pk_bf16_f32 v109, v110, v111
  v_mfma_f32_16x16x32_bf16 v[116:119], a[72:75], a[108:111], v[116:119]
  ds_read_b64_tr_b16 a[168:169], v33 offset:0
  v_mfma_f32_16x16x32_bf16 v[116:119], a[68:71], a[112:115], v[116:119]
  buffer_load_dwordx4 a[212:215], v61, s[40:43], s34 offen offset:0 sc1
  v_mfma_f32_16x16x32_bf16 v[116:119], a[64:67], a[116:119], v[116:119]
  ds_read_b64_tr_b16 a[170:171], v33 offset:4096
  v_mfma_f32_16x16x32_bf16 v[120:123], a[64:67], a[120:123], v[120:123]
  ds_read_b64_tr_b16 a[172:173], v33 offset:8192
  v_cvt_pk_bf16_f32 v112, v112, v113
  v_mfma_f32_16x16x32_bf16 v[120:123], a[68:71], a[116:119], v[120:123]
  ds_read_b64_tr_b16 a[174:175], v33 offset:12288
  v_cvt_pk_bf16_f32 v113, v114, v115
  v_mfma_f32_16x16x32_bf16 v[120:123], a[72:75], a[112:115], v[120:123]
  buffer_load_dwordx4 a[220:223], v61, s[40:43], s34 offen offset:1024 sc1
  v_mfma_f32_16x16x32_bf16 v[120:123], a[76:79], a[108:111], v[120:123]
  ds_read_b64_tr_b16 a[176:177], v34 offset:0
  v_mfma_f32_16x16x32_bf16 v[120:123], a[80:83], a[104:107], v[120:123]
  ds_read_b64_tr_b16 a[178:179], v34 offset:4096
  v_mfma_f32_16x16x32_bf16 v[120:123], a[84:87], a[100:103], v[120:123]
  ds_read_b64_tr_b16 a[180:181], v34 offset:8192
  v_mfma_f32_16x16x32_bf16 v[120:123], a[88:91], a[96:99], v[120:123]
  ds_read_b64_tr_b16 a[182:183], v34 offset:12288
  v_cvt_pk_bf16_f32 v116, v116, v117
  v_mfma_f32_16x16x32_bf16 v[124:127], v[76:79], a[96:99], v[124:127]
  ds_read_b64_tr_b16 a[184:185], v35 offset:0
  v_cvt_pk_bf16_f32 v117, v118, v119
  v_mfma_f32_16x16x32_bf16 v[124:127], a[88:91], a[100:103], v[124:127]
  ds_read_b64_tr_b16 a[186:187], v35 offset:4096
  v_mfma_f32_16x16x32_bf16 v[124:127], a[84:87], a[104:107], v[124:127]
  ds_read_b64_tr_b16 a[188:189], v35 offset:8192
  v_mfma_f32_16x16x32_bf16 v[124:127], a[80:83], a[108:111], v[124:127]
L_pad15:
  s_cbranch_execz L_hr1
  ds_read_b64_tr_b16 a[190:191], v35 offset:12288
  v_mfma_f32_16x16x32_bf16 v[124:127], a[76:79], a[112:115], v[124:127]
  ds_write_b64 v69, v[96:97] offset:0
  v_mfma_f32_16x16x32_bf16 v[124:127], a[72:75], a[116:119], v[124:127]
  ds_write_b64 v69, v[100:101] offset:512
  v_mfma_f32_16x16x32_bf16 v[124:127], a[68:71], a[120:123], v[124:127]
  v_cvt_pk_bf16_f32 v120, v120, v121
  v_cvt_pk_bf16_f32 v121, v122, v123
  v_mfma_f32_16x16x32_bf16 v[124:127], a[64:67], a[124:127], v[124:127]
  ds_write_b64 v69, v[104:105] offset:1024
L_outmain:
  s_waitcnt vmcnt(21)
  v_mfma_f32_16x16x32_bf16 v[128:131], a[128:131], v[208:211], 0
  s_waitcnt vmcnt(17) lgkmcnt(15)
  s_xor_b32 s34, s101, 0xc000
  s_mov_b32 s96, 0xffff0000
  v_mfma_f32_16x16x32_bf16 v[128:131], a[132:135], v[212:215], v[128:131]
  s_waitcnt vmcnt(16)
  v_mfma_f32_16x16x32_bf16 v[132:135], a[132:135], v[220:223], 0
  buffer_load_dwordx4 a[224:227], v60, s[40:43], s34 offen offset:0 sc1
  v_mfma_f32_16x16x32_bf16 v[132:135], a[128:131], v[216:219], v[132:135]
  v_mfma_f32_16x16x32_bf16 v[140:143], a[136:139], v[216:219], 0
  v_mfma_f32_16x16x32_bf16 v[140:143], a[140:143], v[220:223], v[140:143]
  ds_write_b64 v69, v[108:109] offset:1536
  v_mfma_f32_16x16x32_bf16 v[136:139], a[140:143], v[212:215], 0
  ds_write_b64 v69, v[112:113] offset:2048
  v_mfma_f32_16x16x32_bf16 v[136:139], a[136:139], v[208:211], v[136:139]
  ds_write_b64 v69, v[116:117] offset:2560
  v_mfma_f32_16x16x32_bf16 v[144:147], a[144:147], v[208:211], 0
  ds_write_b64 v69, v[120:121] offset:3072
  v_cvt_pk_bf16_f32 v124, v124, v125
  v_mfma_f32_16x16x32_bf16 v[144:147], a[148:151], v[212:215], v[144:147]
  v_cvt_pk_bf16_f32 v125, v126, v127
  v_mfma_f32_16x16x32_bf16 v[148:151], a[148:151], v[220:223], 0
  s_mov_b32 s9, 7
  ds_write_b64 v69, v[124:125] offset:3584
  v_mfma_f32_16x16x32_bf16 v[148:151], a[144:147], v[216:219], v[148:151]
  buffer_load_dwordx4 a[232:235], v60, s[40:43], s34 offen offset:1024 sc1
  v_mfma_f32_16x16x32_bf16 v[156:159], a[152:155], v[216:219], 0
  v_mfma_f32_16x16x32_bf16 v[156:159], a[156:159], v[220:223], v[156:159]
  s_waitcnt lgkmcnt(0)
  s_barrier
  v_mfma_f32_16x16x32_bf16 v[152:155], a[156:159], v[212:215], 0
  ds_read_b64_tr_b16 a[64:65], v70 offset:0
  v_mfma_f32_16x16x32_bf16 v[152:155], a[152:155], v[208:211], v[152:155]
  ds_read_b64_tr_b16 a[66:67], v70 offset:32
  v_mfma_f32_16x16x32_bf16 v[160:163], a[160:163], v[208:211], 0
  ds_read_b64_tr_b16 a[68:69], v71 offset:256
  v_mfma_f32_16x16x32_bf16 v[160:163], a[164:167], v[212:215], v[160:163]
  ds_read_b64_tr_b16 a[70:71], v71 offset:288
  v_mfma_f32_16x16x32_bf16 v[164:167], a[164:167], v[220:223], 0
  ds_read_b64_tr_b16 a[72:73], v70 offset:512
  v_mfma_f32_16x16x32_bf16 v[164:167], a[160:163], v[216:219], v[164:167]
  ds_read_b64_tr_b16 a[74:75], v70 offset:544
  v_mfma_f32_16x16x32_bf16 v[172:175], a[168:171], v[216:219], 0
  ds_read_b64_tr_b16 a[76:77], v71 offset:768
  v_mfma_f32_16x16x32_bf16 v[172:175], a[172:175], v[220:223], v[172:175]
  ds_read_b64_tr_b16 a[78:79], v71 offset:800
  v_mfma_f32_16x16x32_bf16 v[168:171], a[172:175], v[212:215], 0
  buffer_load_dwordx4 a[240:243], v61, s[40:43], s34 offen offset:0 sc1
  v_mfma_f32_16x16x32_bf16 v[168:171], a[168:171], v[208:211], v[168:171]
  v_mfma_f32_16x16x32_bf16 v[176:179], a[176:179], v[208:211], 0
  buffer_load_dwordx4 a[248:251], v61, s[40:43], s34 offen offset:1024 sc1
  v_mfma_f32_16x16x32_bf16 v[176:179], a[180:183], v[212:215], v[176:179]
  s_xor_b32 s34, s101, 0xe000
  v_mfma_f32_16x16x32_bf16 v[180:183], a[180:183], v[220:223], 0
  buffer_load_dwordx4 a[228:231], v60, s[40:43], s34 offen offset:0 sc1
  v_mfma_f32_16x16x32_bf16 v[180:183], a[176:179], v[216:219], v[180:183]
  v_mfma_f32_16x16x32_bf16 v[188:191], a[184:187], v[216:219], 0
  buffer_load_dwordx4 a[236:239], v60, s[40:43], s34 offen offset:1024 sc1
  v_mfma_f32_16x16x32_bf16 v[188:191], a[188:191], v[220:223], v[188:191]
  v_mfma_f32_16x16x32_bf16 v[184:187], a[188:191], v[212:215], 0
  buffer_load_dwordx4 a[244:247], v61, s[40:43], s34 offen offset:0 sc1
  v_mfma_f32_16x16x32_bf16 v[184:187], a[184:187], v[208:211], v[184:187]
  v_mfma_f32_16x16x32_bf16 v[64:67], a[128:131], v[192:195], 0
  buffer_load_dwordx4 a[252:255], v61, s[40:43], s34 offen offset:1024 sc1
  v_mfma_f32_16x16x32_bf16 v[64:67], a[132:135], v[196:199], v[64:67]
  v_mfma_f32_16x16x32_bf16 v[68:71], a[132:135], v[204:207], 0
  v_mfma_f32_16x16x32_bf16 v[68:71], a[128:131], v[200:203], v[68:71]
  s_waitcnt lgkmcnt(0)
  s_barrier
  v_mfma_f32_16x16x32_bf16 v[76:79], a[136:139], v[200:203], 0
  buffer_store_dwordx4 a[64:67], v3, s[24:27], 0 offen offset:0 sc1
  v_mfma_f32_16x16x32_bf16 v[76:79], a[140:143], v[204:207], v[76:79]
  ds_read_b64_tr_b16 a[128:129], v28 offset:16384
  v_mfma_f32_16x16x32_bf16 v[72:75], a[140:143], v[196:199], 0
  ds_read_b64_tr_b16 a[130:131], v28 offset:20480
  v_mfma_f32_16x16x32_bf16 v[72:75], a[136:139], v[192:195], v[72:75]
  ds_read_b64_tr_b16 a[132:133], v28 offset:24576
  v_mfma_f32_16x16x32_bf16 v[80:83], a[144:147], v[192:195], 0
  ds_read_b64_tr_b16 a[134:135], v28 offset:28672
  v_mfma_f32_16x16x32_bf16 v[80:83], a[148:151], v[196:199], v[80:83]
  v_mfma_f32_16x16x32_bf16 v[84:87], a[148:151], v[204:207], 0
  s_xor_b32 s32, s100, 0x80000
  v_mfma_f32_16x16x32_bf16 v[84:87], a[144:147], v[200:203], v[84:87]
  s_add_u32 m0, s37, 65536
  v_mfma_f32_16x16x32_bf16 v[92:95], a[152:155], v[200:203], 0
  ds_read_b64_tr_b16 a[136:137], v29 offset:16384
  v_mfma_f32_16x16x32_bf16 v[92:95], a[156:159], v[204:207], v[92:95]
  ds_read_b64_tr_b16 a[138:139], v29 offset:20480
  v_mfma_f32_16x16x32_bf16 v[88:91], a[156:159], v[196:199], 0
  buffer_load_dwordx4 v24, s[44:47], s32 offen offset:0  lds
  v_mfma_f32_16x16x32_bf16 v[88:91], a[152:155], v[192:195], v[88:91]
  ds_read_b64_tr_b16 a[140:141], v29 offset:24576
  v_mfma_f32_16x16x32_bf16 v[96:99], a[160:163], v[192:195], 0
  ds_read_b64_tr_b16 a[142:143], v29 offset:28672
  v_mfma_f32_16x16x32_bf16 v[96:99], a[164:167], v[196:199], v[96:99]
  v_mfma_f32_16x16x32_bf16 v[100:103], a[164:167], v[204:207], 0
  buffer_load_dwordx4 v25, s[44:47], s32 offen offset:1024  lds
  v_mfma_f32_16x16x32_bf16 v[100:103], a[160:163], v[200:203], v[100:103]
  v_mfma_f32_16x16x32_bf16 v[108:111], a[168:171], v[200:203], 0
  ds_read_b64_tr_b16 a[144:145], v30 offset:16384
  v_mfma_f32_16x16x32_bf16 v[108:111], a[172:175], v[204:207], v[108:111]
  ds_read_b64_tr_b16 a[146:147], v30 offset:20480
  v_mfma_f32_16x16x32_bf16 v[104:107], a[172:175], v[196:199], 0
  buffer_load_dwordx4 v26, s[44:47], s32 offen offset:2048  lds
  v_mfma_f32_16x16x32_bf16 v[104:107], a[168:171], v[192:195], v[104:107]
  ds_read_b64_tr_b16 a[148:149], v30 offset:24576
  v_mfma_f32_16x16x32_bf16 v[112:115], a[176:179], v[192:195], 0
  ds_read_b64_tr_b16 a[150:151], v30 offset:28672
  v_mfma_f32_16x16x32_bf16 v[112:115], a[180:183], v[196:199], v[112:115]
  v_mfma_f32_16x16x32_bf16 v[116:119], a[180:183], v[204:207], 0
  v_mfma_f32_16x16x32_bf16 v[116:119], a[176:179], v[200:203], v[116:119]
  buffer_load_dwordx4 v27, s[44:47], s32 offen offset:3072  lds
  v_mfma_f32_16x16x32_bf16 v[124:127], a[184:187], v[200:203], 0
  ds_read_b64_tr_b16 a[152:153], v31 offset:16384
  v_mfma_f32_16x16x32_bf16 v[124:127], a[188:191], v[204:207], v[124:127]
  ds_read_b64_tr_b16 a[154:155], v31 offset:20480
  v_mfma_f32_16x16x32_bf16 v[120:123], a[188:191], v[196:199], 0
  ds_read_b64_tr_b16 a[156:157], v31 offset:24576
  v_mfma_f32_16x16x32_bf16 v[120:123], a[184:187], v[192:195], v[120:123]
  s_waitcnt vmcnt(28) lgkmcnt(13)
  buffer_store_dwordx4 a[68:71], v3, s[24:27], 0 offen offset:1024 sc1
  v_mfma_f32_16x16x32_bf16 v[64:67], a[128:131], v[224:227], v[64:67]
  s_waitcnt vmcnt(25) lgkmcnt(11)
  ds_read_b64_tr_b16 a[158:159], v31 offset:28672
  v_mfma_f32_16x16x32_bf16 v[64:67], a[132:135], v[228:231], v[64:67]
  s_waitcnt vmcnt(24)
  v_mfma_f32_16x16x32_bf16 v[68:71], a[132:135], v[236:239], v[68:71]
  v_mfma_f32_16x16x32_bf16 v[68:71], a[128:131], v[232:235], v[68:71]
  v_mfma_f32_16x16x32_bf16 v[128:131], a[128:131], v[240:243], v[128:131]
  s_waitcnt vmcnt(23)
  ds_read_b64_tr_b16 a[160:161], v32 offset:16384
  v_mfma_f32_16x16x32_bf16 v[128:131], a[132:135], v[244:247], v[128:131]
  s_waitcnt vmcnt(22)
  ds_read_b64_tr_b16 a[162:163], v32 offset:20480
  v_mfma_f32_16x16x32_bf16 v[132:135], a[132:135], v[252:255], v[132:135]
  ds_read_b64_tr_b16 a[164:165], v32 offset:24576
  v_mfma_f32_16x16x32_bf16 v[132:135], a[128:131], v[248:251], v[132:135]
  s_waitcnt lgkmcnt(13)
  ds_read_b64_tr_b16 a[166:167], v32 offset:28672
  v_mfma_f32_16x16x32_bf16 v[140:143], a[136:139], v[248:251], v[140:143]
  s_waitcnt lgkmcnt(12)
  v_mfma_f32_16x16x32_bf16 v[140:143], a[140:143], v[252:255], v[140:143]
  buffer_store_dwordx4 a[72:75], v3, s[24:27], 0 offen offset:2048 sc1
  v_mfma_f32_16x16x32_bf16 v[136:139], a[140:143], v[244:247], v[136:139]
  v_mfma_f32_16x16x32_bf16 v[136:139], a[136:139], v[240:243], v[136:139]
  v_mfma_f32_16x16x32_bf16 v[76:79], a[136:139], v[232:235], v[76:79]
  ds_read_b64_tr_b16 a[168:169], v33 offset:16384
  v_mfma_f32_16x16x32_bf16 v[76:79], a[140:143], v[236:239], v[76:79]
  ds_read_b64_tr_b16 a[170:171], v33 offset:20480
  v_mfma_f32_16x16x32_bf16 v[72:75], a[140:143], v[228:231], v[72:75]
  ds_read_b64_tr_b16 a[172:173], v33 offset:24576
  v_mfma_f32_16x16x32_bf16 v[72:75], a[136:139], v[224:227], v[72:75]
  s_waitcnt lgkmcnt(13)
  ds_read_b64_tr_b16 a[174:175], v33 offset:28672
  v_mfma_f32_16x16x32_bf16 v[80:83], a[144:147], v[224:227], v[80:83]
  s_waitcnt lgkmcnt(12)
  s_xor_b32 s34, s101, 0x10000
  v_mfma_f32_16x16x32_bf16 v[80:83], a[148:151], v[228:231], v[80:83]
  v_mfma_f32_16x16x32_bf16 v[84:87], a[148:151], v[236:239], v[84:87]
  v_mfma_f32_16x16x32_bf16 v[84:87], a[144:147], v[232:235], v[84:87]
  buffer_load_dwordx4 a[0:3], v60, s[40:43], s34 offen offset:0 sc1
  v_mfma_f32_16x16x32_bf16 v[144:147], a[144:147], v[240:243], v[144:147]
  ds_read_b64_tr_b16 a[176:177], v34 offset:16384
  v_mfma_f32_16x16x32_bf16 v[144:147], a[148:151], v[244:247], v[144:147]
  ds_read_b64_tr_b16 a[178:179], v34 offset:20480
  v_mfma_f32_16x16x32_bf16 v[148:151], a[148:151], v[252:255], v[148:151]
  ds_read_b64_tr_b16 a[180:181], v34 offset:24576
  v_mfma_f32_16x16x32_bf16 v[148:151], a[144:147], v[248:251], v[148:151]
  s_waitcnt lgkmcnt(13)
  buffer_load_dwordx4 a[8:11], v60, s[40:43], s34 offen offset:1024 sc1
  v_mfma_f32_16x16x32_bf16 v[156:159], a[152:155], v[248:251], v[156:159]
  s_waitcnt lgkmcnt(11)
  ds_read_b64_tr_b16 a[182:183], v34 offset:28672
  v_mfma_f32_16x16x32_bf16 v[156:159], a[156:159], v[252:255], v[156:159]
  v_mfma_f32_16x16x32_bf16 v[152:155], a[156:159], v[244:247], v[152:155]
  v_mfma_f32_16x16x32_bf16 v[152:155], a[152:155], v[240:243], v[152:155]
  v_mfma_f32_16x16x32_bf16 v[92:95], a[152:155], v[232:235], v[92:95]
  buffer_load_dwordx4 a[16:19], v61, s[40:43], s34 offen offset:0 sc1
  v_mfma_f32_16x16x32_bf16 v[92:95], a[156:159], v[236:239], v[92:95]
  ds_read_b64_tr_b16 a[184:185], v35 offset:16384
  v_mfma_f32_16x16x32_bf16 v[88:91], a[156:159], v[228:231], v[88:91]
  ds_read_b64_tr_b16 a[186:187], v35 offset:20480
  v_mfma_f32_16x16x32_bf16 v[88:91], a[152:155], v[224:227], v[88:91]
  s_waitcnt lgkmcnt(12)
  ds_read_b64_tr_b16 a[188:189], v35 offset:24576
  v_mfma_f32_16x16x32_bf16 v[96:99], a[160:163], v[224:227], v[96:99]
  s_waitcnt lgkmcnt(11)
  buffer_load_dwordx4 a[24:27], v61, s[40:43], s34 offen offset:1024 sc1
  v_mfma_f32_16x16x32_bf16 v[96:99], a[164:167], v[228:231], v[96:99]
  ds_read_b64_tr_b16 a[190:191], v35 offset:28672
  v_mfma_f32_16x16x32_bf16 v[100:103], a[164:167], v[236:239], v[100:103]
  v_mfma_f32_16x16x32_bf16 v[100:103], a[160:163], v[232:235], v[100:103]
  s_barrier
  v_mfma_f32_16x16x32_bf16 v[160:163], a[160:163], v[240:243], v[160:163]
  buffer_store_dwordx4 a[76:79], v3, s[24:27], 0 offen offset:3072 sc1
  v_mfma_f32_16x16x32_bf16 v[160:163], a[164:167], v[244:247], v[160:163]
  ds_read_b64_tr_b16 a[128:129], v28 offset:32768
  v_lshrrev_b32 v14, 4, v1
  v_mfma_f32_16x16x32_bf16 v[164:167], a[164:167], v[252:255], v[164:167]
  ds_read_b64_tr_b16 a[130:131], v28 offset:36864
  v_bfe_u32 v15, v1, 2, 2
  v_mfma_f32_16x16x32_bf16 v[164:167], a[160:163], v[248:251], v[164:167]
  s_waitcnt lgkmcnt(12)
  ds_read_b64_tr_b16 a[132:133], v28 offset:40960
  v_cmp_eq_u32 s[84:85], v14, v15
  v_mfma_f32_16x16x32_bf16 v[172:175], a[168:171], v[248:251], v[172:175]
  s_waitcnt lgkmcnt(11)
  ds_read_b64_tr_b16 a[134:135], v28 offset:45056
  v_and_b32 v14, 1, v1
  v_mfma_f32_16x16x32_bf16 v[172:175], a[172:175], v[252:255], v[172:175]
  v_lshlrev_b32 v14, 4, v14
  v_mov_b32 v15, 0x3f80
  v_mfma_f32_16x16x32_bf16 v[168:171], a[172:175], v[244:247], v[168:171]
  v_lshlrev_b32 v14, v14, v15
  v_cndmask_b32 v14, 0, v14, s[84:85]
  v_mfma_f32_16x16x32_bf16 v[168:171], a[168:171], v[240:243], v[168:171]
  s_xor_b32 s34, s101, 0x12000
  v_and_b32 v15, 2, v1
  v_cmp_eq_u32 s[84:85], 0, v15
  v_mfma_f32_16x16x32_bf16 v[108:111], a[168:171], v[232:235], v[108:111]
  ds_read_b64_tr_b16 a[136:137], v29 offset:32768
  v_mov_b32 v16, 0
  v_mfma_f32_16x16x32_bf16 v[108:111], a[172:175], v[236:239], v[108:111]
  ds_read_b64_tr_b16 a[138:139], v29 offset:36864
  v_mov_b32 v17, 0
  v_mfma_f32_16x16x32_bf16 v[104:107], a[172:175], v[228:231], v[104:107]
  buffer_load_dwordx4 a[4:7], v60, s[40:43], s34 offen offset:0 sc1
  v_mfma_f32_16x16x32_bf16 v[104:107], a[168:171], v[224:227], v[104:107]
  s_waitcnt lgkmcnt(12)
  ds_read_b64_tr_b16 a[140:141], v29 offset:40960
  v_mov_b32 v20, 0
  v_mfma_f32_16x16x32_bf16 v[112:115], a[176:179], v[224:227], v[112:115]
  s_waitcnt lgkmcnt(11)
  ds_read_b64_tr_b16 a[142:143], v29 offset:45056
  v_mov_b32 v21, 0
  v_mfma_f32_16x16x32_bf16 v[112:115], a[180:183], v[228:231], v[112:115]
  v_cndmask_b32 v18, 0, v14, s[84:85]
  v_cndmask_b32 v19, v14, 0, s[84:85]
  v_mfma_f32_16x16x32_bf16 v[116:119], a[180:183], v[236:239], v[116:119]
  v_mfma_f32_16x16x32_bf16 v[116:119], a[176:179], v[232:235], v[116:119]
  buffer_load_dwordx4 a[12:15], v60, s[40:43], s34 offen offset:1024 sc1
  v_mfma_f32_16x16x32_bf16 v[176:179], a[176:179], v[240:243], v[176:179]
  ds_read_b64_tr_b16 a[144:145], v30 offset:32768
  v_mfma_f32_16x16x32_bf16 v[176:179], a[180:183], v[244:247], v[176:179]
  ds_read_b64_tr_b16 a[146:147], v30 offset:36864
  v_mfma_f32_16x16x32_bf16 v[180:183], a[180:183], v[252:255], v[180:183]
  ds_read_b64_tr_b16 a[148:149], v30 offset:40960
  v_mfma_f32_16x16x32_bf16 v[180:183], a[176:179], v[248:251], v[180:183]
  s_waitcnt lgkmcnt(13)
  buffer_load_dwordx4 a[20:23], v61, s[40:43], s34 offen offset:0 sc1
  v_mfma_f32_16x16x32_bf16 v[188:191], a[184:187], v[248:251], v[188:191]
  s_waitcnt lgkmcnt(11)
  ds_read_b64_tr_b16 a[150:151], v30 offset:45056
  v_mfma_f32_16x16x32_bf16 v[188:191], a[188:191], v[252:255], v[188:191]
  v_mfma_f32_16x16x32_bf16 v[184:187], a[188:191], v[244:247], v[184:187]
  v_mfma_f32_16x16x32_bf16 v[184:187], a[184:187], v[240:243], v[184:187]
  buffer_load_dwordx4 a[28:31], v61, s[40:43], s34 offen offset:1024 sc1
  v_mfma_f32_16x16x32_bf16 v[124:127], a[184:187], v[232:235], v[124:127]
  s_xor_b32 s32, s100, 0xa0000
  ds_read_b64_tr_b16 a[152:153], v31 offset:32768
  v_mfma_f32_16x16x32_bf16 v[124:127], a[188:191], v[236:239], v[124:127]
  s_add_u32 m0, s37, 81920
  ds_read_b64_tr_b16 a[154:155], v31 offset:36864
  v_mfma_f32_16x16x32_bf16 v[120:123], a[188:191], v[228:231], v[120:123]
  ds_read_b64_tr_b16 a[156:157], v31 offset:40960
  v_mfma_f32_16x16x32_bf16 v[120:123], a[184:187], v[224:227], v[120:123]
  s_waitcnt vmcnt(31) lgkmcnt(13)
  buffer_load_dwordx4 v24, s[44:47], s32 offen offset:0  lds
  v_mfma_f32_16x16x32_bf16 v[64:67], a[128:131], a[192:195], v[64:67]
  s_waitcnt vmcnt(28) lgkmcnt(11)
  ds_read_b64_tr_b16 a[158:159], v31 offset:45056
  v_mfma_f32_16x16x32_bf16 v[64:67], a[132:135], a[196:199], v[64:67]
  s_waitcnt vmcnt(27)
  v_mfma_f32_16x16x32_bf16 v[68:71], a[132:135], a[204:207], v[68:71]
  v_mfma_f32_16x16x32_bf16 v[68:71], a[128:131], a[200:203], v[68:71]
  v_mfma_f32_16x16x32_bf16 v[128:131], a[128:131], a[208:211], v[128:131]
  s_waitcnt vmcnt(26)
  buffer_load_dwordx4 v25, s[44:47], s32 offen offset:1024  lds
  v_mfma_f32_16x16x32_bf16 v[128:131], a[132:135], a[212:215], v[128:131]
  s_waitcnt vmcnt(26)
  ds_read_b64_tr_b16 a[160:161], v32 offset:32768
  v_mfma_f32_16x16x32_bf16 v[132:135], a[132:135], a[220:223], v[132:135]
  ds_read_b64_tr_b16 a[162:163], v32 offset:36864
  v_mfma_f32_16x16x32_bf16 v[132:135], a[128:131], a[216:219], v[132:135]
  s_waitcnt lgkmcnt(12)
  ds_read_b64_tr_b16 a[164:165], v32 offset:40960
  v_mfma_f32_16x16x32_bf16 v[140:143], a[136:139], a[216:219], v[140:143]
  s_waitcnt lgkmcnt(11)
  buffer_load_dwordx4 v26, s[44:47], s32 offen offset:2048  lds
  v_mfma_f32_16x16x32_bf16 v[140:143], a[140:143], a[220:223], v[140:143]
  ds_read_b64_tr_b16 a[166:167], v32 offset:45056
  v_mfma_f32_16x16x32_bf16 v[136:139], a[140:143], a[212:215], v[136:139]
  v_mfma_f32_16x16x32_bf16 v[136:139], a[136:139], a[208:211], v[136:139]
  v_mfma_f32_16x16x32_bf16 v[76:79], a[136:139], a[200:203], v[76:79]
  buffer_load_dwordx4 v27, s[44:47], s32 offen offset:3072  lds
  v_mfma_f32_16x16x32_bf16 v[76:79], a[140:143], a[204:207], v[76:79]
  ds_read_b64_tr_b16 a[168:169], v33 offset:32768
  v_mfma_f32_16x16x32_bf16 v[72:75], a[140:143], a[196:199], v[72:75]
  s_xor_b32 s34, s101, 0x14000
  ds_read_b64_tr_b16 a[170:171], v33 offset:36864
  v_mfma_f32_16x16x32_bf16 v[72:75], a[136:139], a[192:195], v[72:75]
  s_waitcnt lgkmcnt(12)
  ds_read_b64_tr_b16 a[172:173], v33 offset:40960
  v_mfma_f32_16x16x32_bf16 v[80:83], a[144:147], a[192:195], v[80:83]
  s_waitcnt lgkmcnt(11)
  ds_read_b64_tr_b16 a[174:175], v33 offset:45056
  v_mfma_f32_16x16x32_bf16 v[80:83], a[148:151], a[196:199], v[80:83]
  buffer_load_dwordx4 a[32:35], v60, s[40:43], s34 offen offset:0 sc1
  v_mfma_f32_16x16x32_bf16 v[84:87], a[148:151], a[204:207], v[84:87]
  v_mfma_f32_16x16x32_bf16 v[84:87], a[144:147], a[200:203], v[84:87]
  v_mfma_f32_16x16x32_bf16 v[144:147], a[144:147], a[208:211], v[144:147]
  ds_read_b64_tr_b16 a[176:177], v34 offset:32768
  v_mfma_f32_16x16x32_bf16 v[144:147], a[148:151], a[212:215], v[144:147]
  buffer_load_dwordx4 a[40:43], v60, s[40:43], s34 offen offset:1024 sc1
  v_mfma_f32_16x16x32_bf16 v[148:151], a[148:151], a[220:223], v[148:151]
  ds_read_b64_tr_b16 a[178:179], v34 offset:36864
  v_mfma_f32_16x16x32_bf16 v[148:151], a[144:147], a[216:219], v[148:151]
  s_waitcnt lgkmcnt(12)
  ds_read_b64_tr_b16 a[180:181], v34 offset:40960
  v_mfma_f32_16x16x32_bf16 v[156:159], a[152:155], a[216:219], v[156:159]
  s_waitcnt lgkmcnt(11)
  ds_read_b64_tr_b16 a[182:183], v34 offset:45056
  v_mfma_f32_16x16x32_bf16 v[156:159], a[156:159], a[220:223], v[156:159]
  buffer_load_dwordx4 a[48:51], v61, s[40:43], s34 offen offset:0 sc1
  v_mfma_f32_16x16x32_bf16 v[152:155], a[156:159], a[212:215], v[152:155]
  v_mfma_f32_16x16x32_bf16 v[152:155], a[152:155], a[208:211], v[152:155]
  v_mfma_f32_16x16x32_bf16 v[92:95], a[152:155], a[200:203], v[92:95]
  ds_read_b64_tr_b16 a[184:185], v35 offset:32768
  v_mfma_f32_16x16x32_bf16 v[92:95], a[156:159], a[204:207], v[92:95]
  ds_read_b64_tr_b16 a[186:187], v35 offset:36864
  v_mfma_f32_16x16x32_bf16 v[88:91], a[156:159], a[196:199], v[88:91]
  buffer_load_dwordx4 a[56:59], v61, s[40:43], s34 offen offset:1024 sc1
  v_mfma_f32_16x16x32_bf16 v[88:91], a[152:155], a[192:195], v[88:91]
  s_waitcnt lgkmcnt(12)
  s_xor_b32 s34, s101, 0x16000
  ds_read_b64_tr_b16 a[188:189], v35 offset:40960
  v_mfma_f32_16x16x32_bf16 v[96:99], a[160:163], a[192:195], v[96:99]
  s_waitcnt lgkmcnt(11)
  ds_read_b64_tr_b16 a[190:191], v35 offset:45056
  v_mfma_f32_16x16x32_bf16 v[96:99], a[164:167], a[196:199], v[96:99]
  v_mfma_f32_16x16x32_bf16 v[100:103], a[164:167], a[204:207], v[100:103]
  buffer_load_dwordx4 a[36:39], v60, s[40:43], s34 offen offset:0 sc1
  v_mfma_f32_16x16x32_bf16 v[100:103], a[160:163], a[200:203], v[100:103]
  s_barrier
  v_mfma_f32_16x16x32_bf16 v[160:163], a[160:163], a[208:211], v[160:163]
  ds_read_b64_tr_b16 a[128:129], v28 offset:49152
  v_mfma_f32_16x16x32_bf16 v[160:163], a[164:167], a[212:215], v[160:163]
  ds_read_b64_tr_b16 a[130:131], v28 offset:53248
  v_mfma_f32_16x16x32_bf16 v[164:167], a[164:167], a[220:223], v[164:167]
  buffer_load_dwordx4 a[44:47], v60, s[40:43], s34 offen offset:1024 sc1
  v_mfma_f32_16x16x32_bf16 v[164:167], a[160:163], a[216:219], v[164:167]
  s_waitcnt lgkmcnt(12)
  ds_read_b64_tr_b16 a[132:133], v28 offset:57344
  v_mfma_f32_16x16x32_bf16 v[172:175], a[168:171], a[216:219], v[172:175]
  s_waitcnt lgkmcnt(11)
  ds_read_b64_tr_b16 a[134:135], v28 offset:61440
  v_mfma_f32_16x16x32_bf16 v[172:175], a[172:175], a[220:223], v[172:175]
  v_mfma_f32_16x16x32_bf16 v[168:171], a[172:175], a[212:215], v[168:171]
  v_mfma_f32_16x16x32_bf16 v[168:171], a[168:171], a[208:211], v[168:171]
  buffer_load_dwordx4 a[52:55], v61, s[40:43], s34 offen offset:0 sc1
  v_mfma_f32_16x16x32_bf16 v[108:111], a[168:171], a[200:203], v[108:111]
  ds_read_b64_tr_b16 a[136:137], v29 offset:49152
  v_mfma_f32_16x16x32_bf16 v[108:111], a[172:175], a[204:207], v[108:111]
  ds_read_b64_tr_b16 a[138:139], v29 offset:53248
  v_mfma_f32_16x16x32_bf16 v[104:107], a[172:175], a[196:199], v[104:107]
  ds_read_b64_tr_b16 a[140:141], v29 offset:57344
  v_mfma_f32_16x16x32_bf16 v[104:107], a[168:171], a[192:195], v[104:107]
  s_waitcnt lgkmcnt(13)
  buffer_load_dwordx4 a[60:63], v61, s[40:43], s34 offen offset:1024 sc1
  v_mfma_f32_16x16x32_bf16 v[112:115], a[176:179], a[192:195], v[112:115]
  s_waitcnt lgkmcnt(11)
  s_xor_b32 s32, s100, 0xc0000
  ds_read_b64_tr_b16 a[142:143], v29 offset:61440
  v_mfma_f32_16x16x32_bf16 v[112:115], a[180:183], a[196:199], v[112:115]
  s_add_u32 m0, s37, 98304
  v_mfma_f32_16x16x32_bf16 v[116:119], a[180:183], a[204:207], v[116:119]
  v_mfma_f32_16x16x32_bf16 v[116:119], a[176:179], a[200:203], v[116:119]
  buffer_load_dwordx4 v24, s[44:47], s32 offen offset:0  lds
  v_mfma_f32_16x16x32_bf16 v[176:179], a[176:179], a[208:211], v[176:179]
  ds_read_b64_tr_b16 a[144:145], v30 offset:49152
  v_mfma_f32_16x16x32_bf16 v[176:179], a[180:183], a[212:215], v[176:179]
  ds_read_b64_tr_b16 a[146:147], v30 offset:53248
  v_mfma_f32_16x16x32_bf16 v[180:183], a[180:183], a[220:223], v[180:183]
  ds_read_b64_tr_b16 a[148:149], v30 offset:57344
  v_mfma_f32_16x16x32_bf16 v[180:183], a[176:179], a[216:219], v[180:183]
  s_waitcnt lgkmcnt(13)
  buffer_load_dwordx4 v25, s[44:47], s32 offen offset:1024  lds
  v_mfma_f32_16x16x32_bf16 v[188:191], a[184:187], a[216:219], v[188:191]
  s_waitcnt lgkmcnt(11)
  ds_read_b64_tr_b16 a[150:151], v30 offset:61440
  v_mfma_f32_16x16x32_bf16 v[188:191], a[188:191], a[220:223], v[188:191]
  v_mfma_f32_16x16x32_bf16 v[184:187], a[188:191], a[212:215], v[184:187]
  v_mfma_f32_16x16x32_bf16 v[184:187], a[184:187], a[208:211], v[184:187]
  v_mfma_f32_16x16x32_bf16 v[124:127], a[184:187], a[200:203], v[124:127]
  buffer_load_dwordx4 v26, s[44:47], s32 offen offset:2048  lds
  v_mfma_f32_16x16x32_bf16 v[124:127], a[188:191], a[204:207], v[124:127]
  ds_read_b64_tr_b16 a[152:153], v31 offset:49152
  v_mfma_f32_16x16x32_bf16 v[120:123], a[188:191], a[196:199], v[120:123]
  ds_read_b64_tr_b16 a[154:155], v31 offset:53248
  v_mfma_f32_16x16x32_bf16 v[120:123], a[184:187], a[192:195], v[120:123]
  s_waitcnt vmcnt(38) lgkmcnt(12)
  ds_read_b64_tr_b16 a[156:157], v31 offset:57344
  v_mfma_f32_16x16x32_bf16 v[64:67], a[128:131], a[224:227], v[64:67]
  s_waitcnt vmcnt(34) lgkmcnt(11)
  buffer_load_dwordx4 v27, s[44:47], s32 offen offset:3072  lds
  v_mfma_f32_16x16x32_bf16 v[64:67], a[132:135], a[228:231], v[64:67]
  s_waitcnt vmcnt(34)
  s_xor_b32 s34, s101, 0x18000
  ds_read_b64_tr_b16 a[158:159], v31 offset:61440
  v_mfma_f32_16x16x32_bf16 v[68:71], a[132:135], a[236:239], v[68:71]
  v_mfma_f32_16x16x32_bf16 v[68:71], a[128:131], a[232:235], v[68:71]
  v_mfma_f32_16x16x32_bf16 v[128:131], a[128:131], a[240:243], v[128:131]
  s_waitcnt vmcnt(33)
  buffer_load_dwordx4 a[64:67], v60, s[40:43], s34 offen offset:0 sc1
  v_mfma_f32_16x16x32_bf16 v[128:131], a[132:135], a[244:247], v[128:131]
  s_waitcnt vmcnt(33)
  ds_read_b64_tr_b16 a[160:161], v32 offset:49152
  v_mfma_f32_16x16x32_bf16 v[132:135], a[132:135], a[252:255], v[132:135]
  ds_read_b64_tr_b16 a[162:163], v32 offset:53248
  v_mfma_f32_16x16x32_bf16 v[132:135], a[128:131], a[248:251], v[132:135]
  s_waitcnt vmcnt(21) lgkmcnt(12)
  ds_read_b64_tr_b16 a[164:165], v32 offset:57344
  v_mfma_f32_16x16x32_bf16 v[140:143], a[136:139], a[248:251], v[140:143]
  s_barrier
  s_waitcnt lgkmcnt(11)
  v_mfma_f32_16x16x32_bf16 v[140:143], a[140:143], a[252:255], v[140:143]
  buffer_load_dwordx4 a[72:75], v60, s[40:43], s34 offen offset:1024 sc1
  v_mfma_f32_16x16x32_bf16 v[136:139], a[140:143], a[244:247], v[136:139]
  ds_read_b64_tr_b16 a[166:167], v32 offset:61440
  v_mfma_f32_16x16x32_bf16 v[136:139], a[136:139], a[240:243], v[136:139]
  v_mfma_f32_16x16x32_bf16 v[76:79], a[136:139], a[232:235], v[76:79]
  ds_read_b64_tr_b16 a[168:169], v33 offset:49152
  v_mfma_f32_16x16x32_bf16 v[76:79], a[140:143], a[236:239], v[76:79]
  buffer_load_dwordx4 a[80:83], v61, s[40:43], s34 offen offset:0 sc1
  v_mfma_f32_16x16x32_bf16 v[72:75], a[140:143], a[228:231], v[72:75]
  ds_read_b64_tr_b16 a[170:171], v33 offset:53248
  v_mfma_f32_16x16x32_bf16 v[72:75], a[136:139], a[224:227], v[72:75]
  s_waitcnt lgkmcnt(12)
  ds_read_b64_tr_b16 a[172:173], v33 offset:57344
  v_mfma_f32_16x16x32_bf16 v[80:83], a[144:147], a[224:227], v[80:83]
  s_waitcnt lgkmcnt(11)
  ds_read_b64_tr_b16 a[174:175], v33 offset:61440
  v_mfma_f32_16x16x32_bf16 v[80:83], a[148:151], a[228:231], v[80:83]
  buffer_load_dwordx4 a[88:91], v61, s[40:43], s34 offen offset:1024 sc1
  v_mfma_f32_16x16x32_bf16 v[84:87], a[148:151], a[236:239], v[84:87]
  v_mfma_f32_16x16x32_bf16 v[84:87], a[144:147], a[232:235], v[84:87]
  s_lshl_b32 s98, s2, 11
  v_mfma_f32_16x16x32_bf16 v[144:147], a[144:147], a[240:243], v[144:147]
  ds_read_b64_tr_b16 a[176:177], v34 offset:49152
  v_mfma_f32_16x16x32_bf16 v[144:147], a[148:151], a[244:247], v[144:147]
  ds_read_b64_tr_b16 a[178:179], v34 offset:53248
  v_mfma_f32_16x16x32_bf16 v[148:151], a[148:151], a[252:255], v[148:151]
  buffer_store_dword v9, v8, s[20:23], s98 offen sc1
  v_mfma_f32_16x16x32_bf16 v[148:151], a[144:147], a[248:251], v[148:151]
  s_waitcnt lgkmcnt(12)
  s_xor_b32 s34, s101, 0x1a000
  ds_read_b64_tr_b16 a[180:181], v34 offset:57344
  v_mfma_f32_16x16x32_bf16 v[156:159], a[152:155], a[248:251], v[156:159]
  s_waitcnt lgkmcnt(11)
  buffer_load_dwordx4 a[68:71], v60, s[40:43], s34 offen offset:0 sc1
  v_mfma_f32_16x16x32_bf16 v[156:159], a[156:159], a[252:255], v[156:159]
  ds_read_b64_tr_b16 a[182:183], v34 offset:61440
  v_mfma_f32_16x16x32_bf16 v[152:155], a[156:159], a[244:247], v[152:155]
  v_mfma_f32_16x16x32_bf16 v[152:155], a[152:155], a[240:243], v[152:155]
  v_mfma_f32_16x16x32_bf16 v[92:95], a[152:155], a[232:235], v[92:95]
  buffer_load_dwordx4 a[76:79], v60, s[40:43], s34 offen offset:1024 sc1
  v_mfma_f32_16x16x32_bf16 v[92:95], a[156:159], a[236:239], v[92:95]
  ds_read_b64_tr_b16 a[184:185], v35 offset:49152
  v_mfma_f32_16x16x32_bf16 v[88:91], a[156:159], a[228:231], v[88:91]
  ds_read_b64_tr_b16 a[186:187], v35 offset:53248
  v_mfma_f32_16x16x32_bf16 v[88:91], a[152:155], a[224:227], v[88:91]
  s_waitcnt lgkmcnt(12)
  ds_read_b64_tr_b16 a[188:189], v35 offset:57344
  v_mfma_f32_16x16x32_bf16 v[96:99], a[160:163], a[224:227], v[96:99]
  s_waitcnt lgkmcnt(11)
  buffer_load_dwordx4 a[84:87], v61, s[40:43], s34 offen offset:0 sc1
  v_mfma_f32_16x16x32_bf16 v[96:99], a[164:167], a[228:231], v[96:99]
  ds_read_b64_tr_b16 a[190:191], v35 offset:61440
  v_mfma_f32_16x16x32_bf16 v[100:103], a[164:167], a[236:239], v[100:103]
  v_mfma_f32_16x16x32_bf16 v[100:103], a[160:163], a[232:235], v[100:103]
  s_barrier
  v_mfma_f32_16x16x32_bf16 v[160:163], a[160:163], a[240:243], v[160:163]
  buffer_load_dwordx4 a[92:95], v61, s[40:43], s34 offen offset:1024 sc1
  v_mfma_f32_16x16x32_bf16 v[160:163], a[164:167], a[244:247], v[160:163]
  s_xor_b32 s32, s100, 0xe0000
  ds_read_b64_tr_b16 a[128:129], v36 offset:0
  v_mfma_f32_16x16x32_bf16 v[164:167], a[164:167], a[252:255], v[164:167]
  s_add_u32 m0, s37, 114688
  ds_read_b64_tr_b16 a[130:131], v36 offset:4096
  v_mfma_f32_16x16x32_bf16 v[164:167], a[160:163], a[248:251], v[164:167]
  s_waitcnt lgkmcnt(12)
  ds_read_b64_tr_b16 a[132:133], v36 offset:8192
  v_mfma_f32_16x16x32_bf16 v[172:175], a[168:171], a[248:251], v[172:175]
  s_waitcnt lgkmcnt(11)
  ds_read_b64_tr_b16 a[134:135], v36 offset:12288
  v_mfma_f32_16x16x32_bf16 v[172:175], a[172:175], a[252:255], v[172:175]
  buffer_load_dwordx4 v24, s[44:47], s32 offen offset:0  lds
  v_mfma_f32_16x16x32_bf16 v[168:171], a[172:175], a[244:247], v[168:171]
  v_mfma_f32_16x16x32_bf16 v[168:171], a[168:171], a[240:243], v[168:171]
  v_mfma_f32_16x16x32_bf16 v[108:111], a[168:171], a[232:235], v[108:111]
  ds_read_b64_tr_b16 a[136:137], v37 offset:0
  v_mfma_f32_16x16x32_bf16 v[108:111], a[172:175], a[236:239], v[108:111]
  buffer_load_dwordx4 v25, s[44:47], s32 offen offset:1024  lds
  v_mfma_f32_16x16x32_bf16 v[104:107], a[172:175], a[228:231], v[104:107]
  ds_read_b64_tr_b16 a[138:139], v37 offset:4096
  v_mfma_f32_16x16x32_bf16 v[104:107], a[168:171], a[224:227], v[104:107]
  s_waitcnt lgkmcnt(12)
  ds_read_b64_tr_b16 a[140:141], v37 offset:8192
  v_mfma_f32_16x16x32_bf16 v[112:115], a[176:179], a[224:227], v[112:115]
  s_waitcnt lgkmcnt(11)
  ds_read_b64_tr_b16 a[142:143], v37 offset:12288
  v_mfma_f32_16x16x32_bf16 v[112:115], a[180:183], a[228:231], v[112:115]
  buffer_load_dwordx4 v26, s[44:47], s32 offen offset:2048  lds
  v_mfma_f32_16x16x32_bf16 v[116:119], a[180:183], a[236:239], v[116:119]
  v_mfma_f32_16x16x32_bf16 v[116:119], a[176:179], a[232:235], v[116:119]
  v_mfma_f32_16x16x32_bf16 v[176:179], a[176:179], a[240:243], v[176:179]
  ds_read_b64_tr_b16 a[144:145], v38 offset:0
  v_mfma_f32_16x16x32_bf16 v[176:179], a[180:183], a[244:247], v[176:179]
  ds_read_b64_tr_b16 a[146:147], v38 offset:4096
  v_mfma_f32_16x16x32_bf16 v[180:183], a[180:183], a[252:255], v[180:183]
  buffer_load_dwordx4 v27, s[44:47], s32 offen offset:3072  lds
  v_mfma_f32_16x16x32_bf16 v[180:183], a[176:179], a[248:251], v[180:183]
  s_waitcnt lgkmcnt(12)
  s_xor_b32 s34, s101, 0x1c000
  ds_read_b64_tr_b16 a[148:149], v38 offset:8192
  v_mfma_f32_16x16x32_bf16 v[188:191], a[184:187], a[248:251], v[188:191]
  s_waitcnt lgkmcnt(11)
  ds_read_b64_tr_b16 a[150:151], v38 offset:12288
  v_mfma_f32_16x16x32_bf16 v[188:191], a[188:191], a[252:255], v[188:191]
  v_mfma_f32_16x16x32_bf16 v[184:187], a[188:191], a[244:247], v[184:187]
  buffer_load_dwordx4 a[96:99], v60, s[40:43], s34 offen offset:0 sc1
  v_mfma_f32_16x16x32_bf16 v[184:187], a[184:187], a[240:243], v[184:187]
  v_mfma_f32_16x16x32_bf16 v[124:127], a[184:187], a[232:235], v[124:127]
  ds_read_b64_tr_b16 a[152:153], v39 offset:0
  v_mfma_f32_16x16x32_bf16 v[124:127], a[188:191], a[236:239], v[124:127]
  ds_read_b64_tr_b16 a[154:155], v39 offset:4096
  v_mfma_f32_16x16x32_bf16 v[120:123], a[188:191], a[228:231], v[120:123]
  buffer_load_dwordx4 a[104:107], v60, s[40:43], s34 offen offset:1024 sc1
  v_mfma_f32_16x16x32_bf16 v[120:123], a[184:187], a[224:227], v[120:123]
L_pad16:
  s_cbranch_execz L_hr2
  s_waitcnt lgkmcnt(12)
  ds_read_b64_tr_b16 a[156:157], v39 offset:8192
  v_mfma_f32_16x16x32_bf16 v[64:67], a[128:131], a[0:3], v[64:67]
  s_waitcnt vmcnt(34) lgkmcnt(11)
  ds_read_b64_tr_b16 a[158:159], v39 offset:12288
  v_mfma_f32_16x16x32_bf16 v[64:67], a[132:135], a[4:7], v[64:67]
  s_waitcnt vmcnt(33)
  v_mfma_f32_16x16x32_bf16 v[68:71], a[132:135], a[12:15], v[68:71]
  v_mfma_f32_16x16x32_bf16 v[68:71], a[128:131], a[8:11], v[68:71]
  buffer_load_dwordx4 a[112:115], v61, s[40:43], s34 offen offset:0 sc1
  v_mfma_f32_16x16x32_bf16 v[128:131], a[128:131], a[16:19], v[128:131]
  s_waitcnt vmcnt(33)
  ds_read_b64_tr_b16 a[160:161], v40 offset:0
  v_mfma_f32_16x16x32_bf16 v[128:131], a[132:135], a[20:23], v[128:131]
  s_waitcnt vmcnt(32)
  ds_read_b64_tr_b16 a[162:163], v40 offset:4096
  v_mfma_f32_16x16x32_bf16 v[132:135], a[132:135], a[28:31], v[132:135]
  ds_read_b64_tr_b16 a[164:165], v40 offset:8192
  v_mfma_f32_16x16x32_bf16 v[132:135], a[128:131], a[24:27], v[132:135]
  s_waitcnt lgkmcnt(13)
  buffer_load_dwordx4 a[120:123], v61, s[40:43], s34 offen offset:1024 sc1
  v_mfma_f32_16x16x32_bf16 v[140:143], a[136:139], a[24:27], v[140:143]
  s_waitcnt lgkmcnt(11)
  s_xor_b32 s34, s101, 0x1e000
  ds_read_b64_tr_b16 a[166:167], v40 offset:12288
  v_mfma_f32_16x16x32_bf16 v[140:143], a[140:143], a[28:31], v[140:143]
  v_mfma_f32_16x16x32_bf16 v[136:139], a[140:143], a[20:23], v[136:139]
  v_mfma_f32_16x16x32_bf16 v[136:139], a[136:139], a[16:19], v[136:139]
  buffer_load_dwordx4 a[100:103], v60, s[40:43], s34 offen offset:0 sc1
  v_mfma_f32_16x16x32_bf16 v[76:79], a[136:139], a[8:11], v[76:79]
  ds_read_b64_tr_b16 a[168:169], v41 offset:0
  v_mfma_f32_16x16x32_bf16 v[76:79], a[140:143], a[12:15], v[76:79]
  ds_read_b64_tr_b16 a[170:171], v41 offset:4096
  v_mfma_f32_16x16x32_bf16 v[72:75], a[140:143], a[4:7], v[72:75]
  ds_read_b64_tr_b16 a[172:173], v41 offset:8192
  v_mfma_f32_16x16x32_bf16 v[72:75], a[136:139], a[0:3], v[72:75]
  s_waitcnt lgkmcnt(13)
  buffer_load_dwordx4 a[108:111], v60, s[40:43], s34 offen offset:1024 sc1
  v_mfma_f32_16x16x32_bf16 v[80:83], a[144:147], a[0:3], v[80:83]
  s_waitcnt lgkmcnt(11)
  ds_read_b64_tr_b16 a[174:175], v41 offset:12288
  v_mfma_f32_16x16x32_bf16 v[80:83], a[148:151], a[4:7], v[80:83]
  v_mfma_f32_16x16x32_bf16 v[84:87], a[148:151], a[12:15], v[84:87]
  v_mfma_f32_16x16x32_bf16 v[84:87], a[144:147], a[8:11], v[84:87]
  v_mfma_f32_16x16x32_bf16 v[144:147], a[144:147], a[16:19], v[144:147]
  buffer_load_dwordx4 a[116:119], v61, s[40:43], s34 offen offset:0 sc1
  v_mfma_f32_16x16x32_bf16 v[144:147], a[148:151], a[20:23], v[144:147]
  ds_read_b64_tr_b16 a[176:177], v42 offset:0
  v_mfma_f32_16x16x32_bf16 v[148:151], a[148:151], a[28:31], v[148:151]
  ds_read_b64_tr_b16 a[178:179], v42 offset:4096
  v_mfma_f32_16x16x32_bf16 v[148:151], a[144:147], a[24:27], v[148:151]
  s_waitcnt lgkmcnt(12)
  ds_read_b64_tr_b16 a[180:181], v42 offset:8192
  v_mfma_f32_16x16x32_bf16 v[156:159], a[152:155], a[24:27], v[156:159]
  s_waitcnt lgkmcnt(11)
  buffer_load_dwordx4 a[124:127], v61, s[40:43], s34 offen offset:1024 sc1
  v_mfma_f32_16x16x32_bf16 v[156:159], a[156:159], a[28:31], v[156:159]
  s_xor_b32 s32, s100, 0x100000
  ds_read_b64_tr_b16 a[182:183], v42 offset:12288
  v_mfma_f32_16x16x32_bf16 v[152:155], a[156:159], a[20:23], v[152:155]
  s_add_u32 m0, s37, 0
  v_mfma_f32_16x16x32_bf16 v[152:155], a[152:155], a[16:19], v[152:155]
  v_mfma_f32_16x16x32_bf16 v[92:95], a[152:155], a[8:11], v[92:95]
  buffer_load_dwordx4 v24, s[44:47], s32 offen offset:0  lds
  v_mfma_f32_16x16x32_bf16 v[92:95], a[156:159], a[12:15], v[92:95]
  ds_read_b64_tr_b16 a[184:185], v43 offset:0
  v_mfma_f32_16x16x32_bf16 v[88:91], a[156:159], a[4:7], v[88:91]
  ds_read_b64_tr_b16 a[186:187], v43 offset:4096
  v_mfma_f32_16x16x32_bf16 v[88:91], a[152:155], a[0:3], v[88:91]
  s_waitcnt lgkmcnt(12)
  ds_read_b64_tr_b16 a[188:189], v43 offset:8192
  v_mfma_f32_16x16x32_bf16 v[96:99], a[160:163], a[0:3], v[96:99]
  s_waitcnt lgkmcnt(11)
  ds_read_b64_tr_b16 a[190:191], v43 offset:12288
  v_mfma_f32_16x16x32_bf16 v[96:99], a[164:167], a[4:7], v[96:99]
  buffer_load_dwordx4 v25, s[44:47], s32 offen offset:1024  lds
  v_mfma_f32_16x16x32_bf16 v[100:103], a[164:167], a[12:15], v[100:103]
  s_waitcnt vmcnt(35)
  v_mfma_f32_16x16x32_bf16 v[100:103], a[160:163], a[8:11], v[100:103]
  s_barrier
  v_mfma_f32_16x16x32_bf16 v[160:163], a[160:163], a[16:19], v[160:163]
  ds_read_b64_tr_b16 a[128:129], v36 offset:16384
  v_mfma_f32_16x16x32_bf16 v[160:163], a[164:167], a[20:23], v[160:163]
  buffer_load_dwordx4 v26, s[44:47], s32 offen offset:2048  lds
  v_mfma_f32_16x16x32_bf16 v[164:167], a[164:167], a[28:31], v[164:167]
  ds_read_b64_tr_b16 a[130:131], v36 offset:20480
  v_mfma_f32_16x16x32_bf16 v[164:167], a[160:163], a[24:27], v[164:167]
  s_waitcnt lgkmcnt(12)
  ds_read_b64_tr_b16 a[132:133], v36 offset:24576
  v_mfma_f32_16x16x32_bf16 v[172:175], a[168:171], a[24:27], v[172:175]
  s_waitcnt lgkmcnt(11)
  ds_read_b64_tr_b16 a[134:135], v36 offset:28672
  v_mfma_f32_16x16x32_bf16 v[172:175], a[172:175], a[28:31], v[172:175]
  buffer_load_dwordx4 v27, s[44:47], s32 offen offset:3072  lds
  v_mfma_f32_16x16x32_bf16 v[168:171], a[172:175], a[20:23], v[168:171]
  v_mfma_f32_16x16x32_bf16 v[168:171], a[168:171], a[16:19], v[168:171]
  s_xor_b32 s34, s101, 0x20000
  v_mfma_f32_16x16x32_bf16 v[108:111], a[168:171], a[8:11], v[108:111]
  ds_read_b64_tr_b16 a[136:137], v37 offset:16384
  v_mfma_f32_16x16x32_bf16 v[108:111], a[172:175], a[12:15], v[108:111]
  ds_read_b64_tr_b16 a[138:139], v37 offset:20480
  v_mfma_f32_16x16x32_bf16 v[104:107], a[172:175], a[4:7], v[104:107]
  buffer_load_dwordx4 v[192:195], v60, s[40:43], s34 offen offset:0 sc1
  v_mfma_f32_16x16x32_bf16 v[104:107], a[168:171], a[0:3], v[104:107]
  s_waitcnt lgkmcnt(12)
  ds_read_b64_tr_b16 a[140:141], v37 offset:24576
  v_mfma_f32_16x16x32_bf16 v[112:115], a[176:179], a[0:3], v[112:115]
  s_waitcnt lgkmcnt(11)
  ds_read_b64_tr_b16 a[142:143], v37 offset:28672
  v_mfma_f32_16x16x32_bf16 v[112:115], a[180:183], a[4:7], v[112:115]
  v_mfma_f32_16x16x32_bf16 v[116:119], a[180:183], a[12:15], v[116:119]
  buffer_load_dwordx4 v[200:203], v60, s[40:43], s34 offen offset:1024 sc1
  v_mfma_f32_16x16x32_bf16 v[116:119], a[176:179], a[8:11], v[116:119]
  v_mfma_f32_16x16x32_bf16 v[176:179], a[176:179], a[16:19], v[176:179]
  ds_read_b64_tr_b16 a[144:145], v38 offset:16384
  v_mfma_f32_16x16x32_bf16 v[176:179], a[180:183], a[20:23], v[176:179]
  ds_read_b64_tr_b16 a[146:147], v38 offset:20480
  v_mfma_f32_16x16x32_bf16 v[180:183], a[180:183], a[28:31], v[180:183]
  buffer_load_dwordx4 v[208:211], v61, s[40:43], s34 offen offset:0 sc1
  v_mfma_f32_16x16x32_bf16 v[180:183], a[176:179], a[24:27], v[180:183]
  s_waitcnt lgkmcnt(12)
  ds_read_b64_tr_b16 a[148:149], v38 offset:24576
  v_mfma_f32_16x16x32_bf16 v[188:191], a[184:187], a[24:27], v[188:191]
  s_waitcnt lgkmcnt(11)
  ds_read_b64_tr_b16 a[150:151], v38 offset:28672
  v_mfma_f32_16x16x32_bf16 v[188:191], a[188:191], a[28:31], v[188:191]
  v_mfma_f32_16x16x32_bf16 v[184:187], a[188:191], a[20:23], v[184:187]
  buffer_load_dwordx4 v[216:219], v61, s[40:43], s34 offen offset:1024 sc1
  v_mfma_f32_16x16x32_bf16 v[184:187], a[184:187], a[16:19], v[184:187]
  v_mfma_f32_16x16x32_bf16 v[124:127], a[184:187], a[8:11], v[124:127]
  s_xor_b32 s34, s101, 0x22000
  ds_read_b64_tr_b16 a[152:153], v39 offset:16384
  v_mfma_f32_16x16x32_bf16 v[124:127], a[188:191], a[12:15], v[124:127]
  ds_read_b64_tr_b16 a[154:155], v39 offset:20480
  v_mfma_f32_16x16x32_bf16 v[120:123], a[188:191], a[4:7], v[120:123]
  ds_read_b64_tr_b16 a[156:157], v39 offset:24576
  v_mfma_f32_16x16x32_bf16 v[120:123], a[184:187], a[0:3], v[120:123]
  s_waitcnt vmcnt(40) lgkmcnt(13)
  buffer_load_dwordx4 v[196:199], v60, s[40:43], s34 offen offset:0 sc1
  v_mfma_f32_16x16x32_bf16 v[64:67], a[128:131], a[32:35], v[64:67]
  s_waitcnt vmcnt(37) lgkmcnt(11)
  ds_read_b64_tr_b16 a[158:159], v39 offset:28672
  v_mfma_f32_16x16x32_bf16 v[64:67], a[132:135], a[36:39], v[64:67]
  s_waitcnt vmcnt(36)
  v_mfma_f32_16x16x32_bf16 v[68:71], a[132:135], a[44:47], v[68:71]
  v_mfma_f32_16x16x32_bf16 v[68:71], a[128:131], a[40:43], v[68:71]
  buffer_load_dwordx4 v[204:207], v60, s[40:43], s34 offen offset:1024 sc1
  v_mfma_f32_16x16x32_bf16 v[128:131], a[128:131], a[48:51], v[128:131]
  s_waitcnt vmcnt(36)
  ds_read_b64_tr_b16 a[160:161], v40 offset:16384
  v_mfma_f32_16x16x32_bf16 v[128:131], a[132:135], a[52:55], v[128:131]
  s_waitcnt vmcnt(35)
  ds_read_b64_tr_b16 a[162:163], v40 offset:20480
  v_mfma_f32_16x16x32_bf16 v[132:135], a[132:135], a[60:63], v[132:135]
  ds_read_b64_tr_b16 a[164:165], v40 offset:24576
  v_mfma_f32_16x16x32_bf16 v[132:135], a[128:131], a[56:59], v[132:135]
  s_waitcnt lgkmcnt(13)
  buffer_load_dwordx4 v[212:215], v61, s[40:43], s34 offen offset:0 sc1
  v_mfma_f32_16x16x32_bf16 v[140:143], a[136:139], a[56:59], v[140:143]
  s_waitcnt lgkmcnt(11)
  ds_read_b64_tr_b16 a[166:167], v40 offset:28672
  v_mfma_f32_16x16x32_bf16 v[140:143], a[140:143], a[60:63], v[140:143]
  v_mfma_f32_16x16x32_bf16 v[136:139], a[140:143], a[52:55], v[136:139]
  v_mfma_f32_16x16x32_bf16 v[136:139], a[136:139], a[48:51], v[136:139]
  v_mfma_f32_16x16x32_bf16 v[76:79], a[136:139], a[40:43], v[76:79]
  buffer_load_dwordx4 v[220:223], v61, s[40:43], s34 offen offset:1024 sc1
  v_mfma_f32_16x16x32_bf16 v[76:79], a[140:143], a[44:47], v[76:79]
  s_xor_b32 s32, s100, 0x120000
  ds_read_b64_tr_b16 a[168:169], v41 offset:16384
  v_mfma_f32_16x16x32_bf16 v[72:75], a[140:143], a[36:39], v[72:75]
  s_add_u32 m0, s37, 16384
  ds_read_b64_tr_b16 a[170:171], v41 offset:20480
  v_mfma_f32_16x16x32_bf16 v[72:75], a[136:139], a[32:35], v[72:75]
  s_waitcnt lgkmcnt(12)
  ds_read_b64_tr_b16 a[172:173], v41 offset:24576
  v_mfma_f32_16x16x32_bf16 v[80:83], a[144:147], a[32:35], v[80:83]
  s_waitcnt lgkmcnt(11)
  buffer_load_dwordx4 v24, s[44:47], s32 offen offset:0  lds
  v_mfma_f32_16x16x32_bf16 v[80:83], a[148:151], a[36:39], v[80:83]
  ds_read_b64_tr_b16 a[174:175], v41 offset:28672
  v_mfma_f32_16x16x32_bf16 v[84:87], a[148:151], a[44:47], v[84:87]
  v_mfma_f32_16x16x32_bf16 v[84:87], a[144:147], a[40:43], v[84:87]
  v_mfma_f32_16x16x32_bf16 v[144:147], a[144:147], a[48:51], v[144:147]
  buffer_load_dwordx4 v25, s[44:47], s32 offen offset:1024  lds
  v_mfma_f32_16x16x32_bf16 v[144:147], a[148:151], a[52:55], v[144:147]
  ds_read_b64_tr_b16 a[176:177], v42 offset:16384
  v_mfma_f32_16x16x32_bf16 v[148:151], a[148:151], a[60:63], v[148:151]
  ds_read_b64_tr_b16 a[178:179], v42 offset:20480
  v_mfma_f32_16x16x32_bf16 v[148:151], a[144:147], a[56:59], v[148:151]
  s_waitcnt lgkmcnt(12)
  ds_read_b64_tr_b16 a[180:181], v42 offset:24576
  v_mfma_f32_16x16x32_bf16 v[156:159], a[152:155], a[56:59], v[156:159]
  s_waitcnt lgkmcnt(11)
  ds_read_b64_tr_b16 a[182:183], v42 offset:28672
  v_mfma_f32_16x16x32_bf16 v[156:159], a[156:159], a[60:63], v[156:159]
  buffer_load_dwordx4 v26, s[44:47], s32 offen offset:2048  lds
  v_mfma_f32_16x16x32_bf16 v[152:155], a[156:159], a[52:55], v[152:155]
  v_mfma_f32_16x16x32_bf16 v[152:155], a[152:155], a[48:51], v[152:155]
  v_mfma_f32_16x16x32_bf16 v[92:95], a[152:155], a[40:43], v[92:95]
  ds_read_b64_tr_b16 a[184:185], v43 offset:16384
  v_mfma_f32_16x16x32_bf16 v[92:95], a[156:159], a[44:47], v[92:95]
  buffer_load_dwordx4 v27, s[44:47], s32 offen offset:3072  lds
  v_mfma_f32_16x16x32_bf16 v[88:91], a[156:159], a[36:39], v[88:91]
  s_xor_b32 s34, s101, 0x24000
  ds_read_b64_tr_b16 a[186:187], v43 offset:20480
  v_mfma_f32_16x16x32_bf16 v[88:91], a[152:155], a[32:35], v[88:91]
  s_waitcnt lgkmcnt(12)
  ds_read_b64_tr_b16 a[188:189], v43 offset:24576
  v_mfma_f32_16x16x32_bf16 v[96:99], a[160:163], a[32:35], v[96:99]
  s_waitcnt lgkmcnt(11)
  ds_read_b64_tr_b16 a[190:191], v43 offset:28672
  v_mfma_f32_16x16x32_bf16 v[96:99], a[164:167], a[36:39], v[96:99]
  buffer_load_dwordx4 v[224:227], v60, s[40:43], s34 offen offset:0 sc1
  v_mfma_f32_16x16x32_bf16 v[100:103], a[164:167], a[44:47], v[100:103]
  s_waitcnt vmcnt(38)
  v_mfma_f32_16x16x32_bf16 v[100:103], a[160:163], a[40:43], v[100:103]
  s_barrier
  v_mfma_f32_16x16x32_bf16 v[160:163], a[160:163], a[48:51], v[160:163]
  ds_read_b64_tr_b16 a[128:129], v36 offset:32768
  v_mfma_f32_16x16x32_bf16 v[160:163], a[164:167], a[52:55], v[160:163]
  buffer_load_dwordx4 v[232:235], v60, s[40:43], s34 offen offset:1024 sc1
  v_mfma_f32_16x16x32_bf16 v[164:167], a[164:167], a[60:63], v[164:167]
  ds_read_b64_tr_b16 a[130:131], v36 offset:36864
  v_mfma_f32_16x16x32_bf16 v[164:167], a[160:163], a[56:59], v[164:167]
  s_waitcnt lgkmcnt(12)
  ds_read_b64_tr_b16 a[132:133], v36 offset:40960
  v_mfma_f32_16x16x32_bf16 v[172:175], a[168:171], a[56:59], v[172:175]
  s_waitcnt lgkmcnt(11)
  ds_read_b64_tr_b16 a[134:135], v36 offset:45056
  v_mfma_f32_16x16x32_bf16 v[172:175], a[172:175], a[60:63], v[172:175]
  v_mfma_f32_16x16x32_bf16 v[168:171], a[172:175], a[52:55], v[168:171]
  buffer_load_dwordx4 v[240:243], v61, s[40:43], s34 offen offset:0 sc1
  v_mfma_f32_16x16x32_bf16 v[168:171], a[168:171], a[48:51], v[168:171]
  v_mfma_f32_16x16x32_bf16 v[108:111], a[168:171], a[40:43], v[108:111]
  ds_read_b64_tr_b16 a[136:137], v37 offset:32768
  v_mfma_f32_16x16x32_bf16 v[108:111], a[172:175], a[44:47], v[108:111]
  ds_read_b64_tr_b16 a[138:139], v37 offset:36864
  v_mfma_f32_16x16x32_bf16 v[104:107], a[172:175], a[36:39], v[104:107]
  buffer_load_dwordx4 v[248:251], v61, s[40:43], s34 offen offset:1024 sc1
  v_mfma_f32_16x16x32_bf16 v[104:107], a[168:171], a[32:35], v[104:107]
  s_waitcnt lgkmcnt(12)
  s_xor_b32 s34, s101, 0x26000
  ds_read_b64_tr_b16 a[140:141], v37 offset:40960
  v_mfma_f32_16x16x32_bf16 v[112:115], a[176:179], a[32:35], v[112:115]
  s_waitcnt lgkmcnt(11)
  ds_read_b64_tr_b16 a[142:143], v37 offset:45056
  v_mfma_f32_16x16x32_bf16 v[112:115], a[180:183], a[36:39], v[112:115]
  v_mfma_f32_16x16x32_bf16 v[116:119], a[180:183], a[44:47], v[116:119]
  buffer_load_dwordx4 v[228:231], v60, s[40:43], s34 offen offset:0 sc1
  v_mfma_f32_16x16x32_bf16 v[116:119], a[176:179], a[40:43], v[116:119]
  v_mfma_f32_16x16x32_bf16 v[176:179], a[176:179], a[48:51], v[176:179]
  ds_read_b64_tr_b16 a[144:145], v38 offset:32768
  v_mfma_f32_16x16x32_bf16 v[176:179], a[180:183], a[52:55], v[176:179]
  ds_read_b64_tr_b16 a[146:147], v38 offset:36864
  v_mfma_f32_16x16x32_bf16 v[180:183], a[180:183], a[60:63], v[180:183]
  ds_read_b64_tr_b16 a[148:149], v38 offset:40960
  v_mfma_f32_16x16x32_bf16 v[180:183], a[176:179], a[56:59], v[180:183]
  s_waitcnt lgkmcnt(13)
  buffer_load_dwordx4 v[236:239], v60, s[40:43], s34 offen offset:1024 sc1
  v_mfma_f32_16x16x32_bf16 v[188:191], a[184:187], a[56:59], v[188:191]
  s_waitcnt lgkmcnt(11)
  ds_read_b64_tr_b16 a[150:151], v38 offset:45056
  v_mfma_f32_16x16x32_bf16 v[188:191], a[188:191], a[60:63], v[188:191]
  v_mfma_f32_16x16x32_bf16 v[184:187], a[188:191], a[52:55], v[184:187]
  v_mfma_f32_16x16x32_bf16 v[184:187], a[184:187], a[48:51], v[184:187]
  buffer_load_dwordx4 v[244:247], v61, s[40:43], s34 offen offset:0 sc1
  v_mfma_f32_16x16x32_bf16 v[124:127], a[184:187], a[40:43], v[124:127]
  ds_read_b64_tr_b16 a[152:153], v39 offset:32768
  v_mfma_f32_16x16x32_bf16 v[124:127], a[188:191], a[44:47], v[124:127]
  ds_read_b64_tr_b16 a[154:155], v39 offset:36864
  v_mfma_f32_16x16x32_bf16 v[120:123], a[188:191], a[36:39], v[120:123]
  ds_read_b64_tr_b16 a[156:157], v39 offset:40960
  v_mfma_f32_16x16x32_bf16 v[120:123], a[184:187], a[32:35], v[120:123]
  s_waitcnt vmcnt(43) lgkmcnt(13)
  buffer_load_dwordx4 v[252:255], v61, s[40:43], s34 offen offset:1024 sc1
  v_mfma_f32_16x16x32_bf16 v[64:67], a[128:131], a[64:67], v[64:67]
  s_waitcnt vmcnt(39) lgkmcnt(11)
  s_xor_b32 s32, s100, 0x140000
  ds_read_b64_tr_b16 a[158:159], v39 offset:45056
  v_mfma_f32_16x16x32_bf16 v[64:67], a[132:135], a[68:71], v[64:67]
  s_waitcnt vmcnt(38)
  s_add_u32 m0, s37, 32768
  v_mfma_f32_16x16x32_bf16 v[68:71], a[132:135], a[76:79], v[68:71]
  v_mfma_f32_16x16x32_bf16 v[68:71], a[128:131], a[72:75], v[68:71]
  v_mfma_f32_16x16x32_bf16 v[128:131], a[128:131], a[80:83], v[128:131]
  s_waitcnt vmcnt(37)
  buffer_load_dwordx4 v24, s[44:47], s32 offen offset:0  lds
  v_mfma_f32_16x16x32_bf16 v[128:131], a[132:135], a[84:87], v[128:131]
  s_waitcnt vmcnt(37)
  ds_read_b64_tr_b16 a[160:161], v40 offset:32768
  v_mfma_f32_16x16x32_bf16 v[132:135], a[132:135], a[92:95], v[132:135]
  ds_read_b64_tr_b16 a[162:163], v40 offset:36864
  v_mfma_f32_16x16x32_bf16 v[132:135], a[128:131], a[88:91], v[132:135]
  s_waitcnt lgkmcnt(12)
  ds_read_b64_tr_b16 a[164:165], v40 offset:40960
  v_mfma_f32_16x16x32_bf16 v[140:143], a[136:139], a[88:91], v[140:143]
  s_waitcnt lgkmcnt(11)
  buffer_load_dwordx4 v25, s[44:47], s32 offen offset:1024  lds
  v_mfma_f32_16x16x32_bf16 v[140:143], a[140:143], a[92:95], v[140:143]
  ds_read_b64_tr_b16 a[166:167], v40 offset:45056
  v_mfma_f32_16x16x32_bf16 v[136:139], a[140:143], a[84:87], v[136:139]
  v_mfma_f32_16x16x32_bf16 v[136:139], a[136:139], a[80:83], v[136:139]
  v_mfma_f32_16x16x32_bf16 v[76:79], a[136:139], a[72:75], v[76:79]
  buffer_load_dwordx4 v26, s[44:47], s32 offen offset:2048  lds
  v_mfma_f32_16x16x32_bf16 v[76:79], a[140:143], a[76:79], v[76:79]
  ds_read_b64_tr_b16 a[168:169], v41 offset:32768
  v_mfma_f32_16x16x32_bf16 v[72:75], a[140:143], a[68:71], v[72:75]
  ds_read_b64_tr_b16 a[170:171], v41 offset:36864
  v_mfma_f32_16x16x32_bf16 v[72:75], a[136:139], a[64:67], v[72:75]
  s_waitcnt lgkmcnt(12)
  ds_read_b64_tr_b16 a[172:173], v41 offset:40960
  v_mfma_f32_16x16x32_bf16 v[80:83], a[144:147], a[64:67], v[80:83]
  s_waitcnt lgkmcnt(11)
  buffer_load_dwordx4 v27, s[44:47], s32 offen offset:3072  lds
  v_mfma_f32_16x16x32_bf16 v[80:83], a[148:151], a[68:71], v[80:83]
  ds_read_b64_tr_b16 a[174:175], v41 offset:45056
  v_mfma_f32_16x16x32_bf16 v[84:87], a[148:151], a[76:79], v[84:87]
  v_mfma_f32_16x16x32_bf16 v[84:87], a[144:147], a[72:75], v[84:87]
  v_mfma_f32_16x16x32_bf16 v[144:147], a[144:147], a[80:83], v[144:147]
  ds_read_b64_tr_b16 a[176:177], v42 offset:32768
  v_mfma_f32_16x16x32_bf16 v[144:147], a[148:151], a[84:87], v[144:147]
  buffer_load_dword v50, v48, s[56:59], 0 offen offset:0 sc1
  v_mfma_f32_16x16x32_bf16 v[148:151], a[148:151], a[92:95], v[148:151]
  ds_read_b64_tr_b16 a[178:179], v42 offset:36864
  v_mfma_f32_16x16x32_bf16 v[148:151], a[144:147], a[88:91], v[148:151]
  s_waitcnt lgkmcnt(12)
  ds_read_b64_tr_b16 a[180:181], v42 offset:40960
  v_mfma_f32_16x16x32_bf16 v[156:159], a[152:155], a[88:91], v[156:159]
  s_waitcnt lgkmcnt(11)
  ds_read_b64_tr_b16 a[182:183], v42 offset:45056
  v_mfma_f32_16x16x32_bf16 v[156:159], a[156:159], a[92:95], v[156:159]
  buffer_load_dword v51, v48, s[56:59], 0 offen offset:64 sc1
  v_mfma_f32_16x16x32_bf16 v[152:155], a[156:159], a[84:87], v[152:155]
  s_add_u32 m0, s37, 0x20000
  v_mfma_f32_16x16x32_bf16 v[152:155], a[152:155], a[80:83], v[152:155]
  s_mov_b32 s36, 0x0
  v_mfma_f32_16x16x32_bf16 v[92:95], a[152:155], a[72:75], v[92:95]
  ds_read_b64_tr_b16 a[184:185], v43 offset:32768
  v_mfma_f32_16x16x32_bf16 v[92:95], a[156:159], a[76:79], v[92:95]
  buffer_load_dwordx4 v46, s[48:51], s36 offen offset:0 lds
  v_mfma_f32_16x16x32_bf16 v[88:91], a[156:159], a[68:71], v[88:91]
  s_mov_b32 s36, 0x3c00
  ds_read_b64_tr_b16 a[186:187], v43 offset:36864
  v_mfma_f32_16x16x32_bf16 v[88:91], a[152:155], a[64:67], v[88:91]
  s_waitcnt lgkmcnt(12)
  ds_read_b64_tr_b16 a[188:189], v43 offset:40960
  v_mfma_f32_16x16x32_bf16 v[96:99], a[160:163], a[64:67], v[96:99]
  s_waitcnt lgkmcnt(11)
  ds_read_b64_tr_b16 a[190:191], v43 offset:45056
  v_mfma_f32_16x16x32_bf16 v[96:99], a[164:167], a[68:71], v[96:99]
  buffer_load_dwordx4 v46, s[48:51], s36 offen offset:1024 lds
  v_mfma_f32_16x16x32_bf16 v[100:103], a[164:167], a[76:79], v[100:103]
  s_mov_b32 s36, 0x7800
  v_mfma_f32_16x16x32_bf16 v[100:103], a[160:163], a[72:75], v[100:103]
  s_waitcnt vmcnt(40)
  s_barrier
  v_mfma_f32_16x16x32_bf16 v[160:163], a[160:163], a[80:83], v[160:163]
  ds_read_b64_tr_b16 a[128:129], v36 offset:49152
  v_mfma_f32_16x16x32_bf16 v[160:163], a[164:167], a[84:87], v[160:163]
  buffer_load_dwordx4 v46, s[48:51], s36 offen offset:2048 lds
  v_mfma_f32_16x16x32_bf16 v[164:167], a[164:167], a[92:95], v[164:167]
  s_mov_b32 s36, 0xb400
  ds_read_b64_tr_b16 a[130:131], v36 offset:53248
  v_mfma_f32_16x16x32_bf16 v[164:167], a[160:163], a[88:91], v[164:167]
  s_waitcnt lgkmcnt(12)
  ds_read_b64_tr_b16 a[132:133], v36 offset:57344
  v_mfma_f32_16x16x32_bf16 v[172:175], a[168:171], a[88:91], v[172:175]
  s_waitcnt lgkmcnt(11)
  ds_read_b64_tr_b16 a[134:135], v36 offset:61440
  v_mfma_f32_16x16x32_bf16 v[172:175], a[172:175], a[92:95], v[172:175]
  buffer_load_dwordx4 v46, s[48:51], s36 offen offset:3072 lds
  v_mfma_f32_16x16x32_bf16 v[168:171], a[172:175], a[84:87], v[168:171]
  s_xor_b32 s34, s101, 0x28000
  v_mfma_f32_16x16x32_bf16 v[168:171], a[168:171], a[80:83], v[168:171]
  v_mfma_f32_16x16x32_bf16 v[108:111], a[168:171], a[72:75], v[108:111]
  ds_read_b64_tr_b16 a[136:137], v37 offset:49152
  v_mfma_f32_16x16x32_bf16 v[108:111], a[172:175], a[76:79], v[108:111]
  buffer_load_dwordx4 a[192:195], v60, s[40:43], s34 offen offset:0 sc1
  v_mfma_f32_16x16x32_bf16 v[104:107], a[172:175], a[68:71], v[104:107]
  ds_read_b64_tr_b16 a[138:139], v37 offset:53248
  v_mfma_f32_16x16x32_bf16 v[104:107], a[168:171], a[64:67], v[104:107]
  s_waitcnt lgkmcnt(12)
  ds_read_b64_tr_b16 a[140:141], v37 offset:57344
  v_mfma_f32_16x16x32_bf16 v[112:115], a[176:179], a[64:67], v[112:115]
  s_waitcnt lgkmcnt(11)
  ds_read_b64_tr_b16 a[142:143], v37 offset:61440
  v_mfma_f32_16x16x32_bf16 v[112:115], a[180:183], a[68:71], v[112:115]
  buffer_load_dwordx4 a[200:203], v60, s[40:43], s34 offen offset:1024 sc1
  v_mfma_f32_16x16x32_bf16 v[116:119], a[180:183], a[76:79], v[116:119]
  v_mfma_f32_16x16x32_bf16 v[116:119], a[176:179], a[72:75], v[116:119]
  v_mfma_f32_16x16x32_bf16 v[176:179], a[176:179], a[80:83], v[176:179]
  ds_read_b64_tr_b16 a[144:145], v38 offset:49152
  v_mfma_f32_16x16x32_bf16 v[176:179], a[180:183], a[84:87], v[176:179]
  buffer_load_dwordx4 a[208:211], v61, s[40:43], s34 offen offset:0 sc1
  v_mfma_f32_16x16x32_bf16 v[180:183], a[180:183], a[92:95], v[180:183]
  ds_read_b64_tr_b16 a[146:147], v38 offset:53248
  v_mfma_f32_16x16x32_bf16 v[180:183], a[176:179], a[88:91], v[180:183]
  s_waitcnt lgkmcnt(12)
  ds_read_b64_tr_b16 a[148:149], v38 offset:57344
  v_mfma_f32_16x16x32_bf16 v[188:191], a[184:187], a[88:91], v[188:191]
  s_waitcnt lgkmcnt(11)
  ds_read_b64_tr_b16 a[150:151], v38 offset:61440
  v_mfma_f32_16x16x32_bf16 v[188:191], a[188:191], a[92:95], v[188:191]
  v_mfma_f32_16x16x32_bf16 v[184:187], a[188:191], a[84:87], v[184:187]
  buffer_load_dwordx4 a[216:219], v61, s[40:43], s34 offen offset:1024 sc1
  v_mfma_f32_16x16x32_bf16 v[184:187], a[184:187], a[80:83], v[184:187]
  s_xor_b32 s34, s101, 0x2a000
  v_mfma_f32_16x16x32_bf16 v[124:127], a[184:187], a[72:75], v[124:127]
  ds_read_b64_tr_b16 a[152:153], v39 offset:49152
  v_mfma_f32_16x16x32_bf16 v[124:127], a[188:191], a[76:79], v[124:127]
  ds_read_b64_tr_b16 a[154:155], v39 offset:53248
  v_mfma_f32_16x16x32_bf16 v[120:123], a[188:191], a[68:71], v[120:123]
  buffer_load_dwordx4 a[196:199], v60, s[40:43], s34 offen offset:0 sc1
  v_mfma_f32_16x16x32_bf16 v[120:123], a[184:187], a[64:67], v[120:123]
  s_waitcnt vmcnt(46) lgkmcnt(12)
  ds_read_b64_tr_b16 a[156:157], v39 offset:57344
  v_mfma_f32_16x16x32_bf16 v[64:67], a[128:131], a[96:99], v[64:67]
  s_waitcnt vmcnt(42) lgkmcnt(11)
  ds_read_b64_tr_b16 a[158:159], v39 offset:61440
  v_mfma_f32_16x16x32_bf16 v[64:67], a[132:135], a[100:103], v[64:67]
  s_waitcnt vmcnt(41)
  v_mfma_f32_16x16x32_bf16 v[68:71], a[132:135], a[108:111], v[68:71]
  buffer_load_dwordx4 a[204:207], v60, s[40:43], s34 offen offset:1024 sc1
  v_mfma_f32_16x16x32_bf16 v[68:71], a[128:131], a[104:107], v[68:71]
  v_mfma_f32_16x16x32_bf16 v[128:131], a[128:131], a[112:115], v[128:131]
  s_waitcnt vmcnt(41)
  ds_read_b64_tr_b16 a[160:161], v40 offset:49152
  v_mfma_f32_16x16x32_bf16 v[128:131], a[132:135], a[116:119], v[128:131]
  s_waitcnt vmcnt(40)
  ds_read_b64_tr_b16 a[162:163], v40 offset:53248
  v_mfma_f32_16x16x32_bf16 v[132:135], a[132:135], a[124:127], v[132:135]
  ds_read_b64_tr_b16 a[164:165], v40 offset:57344
  v_mfma_f32_16x16x32_bf16 v[132:135], a[128:131], a[120:123], v[132:135]
  s_waitcnt lgkmcnt(13)
  buffer_load_dwordx4 a[212:215], v61, s[40:43], s34 offen offset:0 sc1
  v_mfma_f32_16x16x32_bf16 v[140:143], a[136:139], a[120:123], v[140:143]
  s_waitcnt lgkmcnt(11)
  ds_read_b64_tr_b16 a[166:167], v40 offset:61440
  v_mfma_f32_16x16x32_bf16 v[140:143], a[140:143], a[124:127], v[140:143]
  v_mfma_f32_16x16x32_bf16 v[136:139], a[140:143], a[116:119], v[136:139]
  v_mfma_f32_16x16x32_bf16 v[136:139], a[136:139], a[112:115], v[136:139]
  buffer_load_dwordx4 a[220:223], v61, s[40:43], s34 offen offset:1024 sc1
  v_mfma_f32_16x16x32_bf16 v[76:79], a[136:139], a[104:107], v[76:79]
  s_xor_b32 s32, s100, 0x160000
  ds_read_b64_tr_b16 a[168:169], v41 offset:49152
  v_mfma_f32_16x16x32_bf16 v[76:79], a[140:143], a[108:111], v[76:79]
  s_add_u32 m0, s37, 49152
  ds_read_b64_tr_b16 a[170:171], v41 offset:53248
  v_mfma_f32_16x16x32_bf16 v[72:75], a[140:143], a[100:103], v[72:75]
  ds_read_b64_tr_b16 a[172:173], v41 offset:57344
  v_mfma_f32_16x16x32_bf16 v[72:75], a[136:139], a[96:99], v[72:75]
  s_waitcnt lgkmcnt(13)
  buffer_load_dwordx4 v24, s[44:47], s32 offen offset:0  lds
  v_mfma_f32_16x16x32_bf16 v[80:83], a[144:147], a[96:99], v[80:83]
  s_waitcnt lgkmcnt(11)
  ds_read_b64_tr_b16 a[174:175], v41 offset:61440
  v_mfma_f32_16x16x32_bf16 v[80:83], a[148:151], a[100:103], v[80:83]
  v_mfma_f32_16x16x32_bf16 v[84:87], a[148:151], a[108:111], v[84:87]
  v_mfma_f32_16x16x32_bf16 v[84:87], a[144:147], a[104:107], v[84:87]
  buffer_load_dwordx4 v25, s[44:47], s32 offen offset:1024  lds
  v_mfma_f32_16x16x32_bf16 v[144:147], a[144:147], a[112:115], v[144:147]
  ds_read_b64_tr_b16 a[176:177], v42 offset:49152
  v_mfma_f32_16x16x32_bf16 v[144:147], a[148:151], a[116:119], v[144:147]
  ds_read_b64_tr_b16 a[178:179], v42 offset:53248
  v_mfma_f32_16x16x32_bf16 v[148:151], a[148:151], a[124:127], v[148:151]
  ds_read_b64_tr_b16 a[180:181], v42 offset:57344
  v_mfma_f32_16x16x32_bf16 v[148:151], a[144:147], a[120:123], v[148:151]
  s_waitcnt lgkmcnt(13)
  ds_read_b64_tr_b16 a[182:183], v42 offset:61440
  v_mfma_f32_16x16x32_bf16 v[156:159], a[152:155], a[120:123], v[156:159]
  s_waitcnt lgkmcnt(12)
  buffer_load_dwordx4 v26, s[44:47], s32 offen offset:2048  lds
  v_mfma_f32_16x16x32_bf16 v[156:159], a[156:159], a[124:127], v[156:159]
  v_mfma_f32_16x16x32_bf16 v[152:155], a[156:159], a[116:119], v[152:155]
  v_mfma_f32_16x16x32_bf16 v[152:155], a[152:155], a[112:115], v[152:155]
  v_mfma_f32_16x16x32_bf16 v[92:95], a[152:155], a[104:107], v[92:95]
  buffer_load_dwordx4 v27, s[44:47], s32 offen offset:3072  lds
  v_mfma_f32_16x16x32_bf16 v[92:95], a[156:159], a[108:111], v[92:95]
  ds_read_b64_tr_b16 a[184:185], v43 offset:49152
  v_mfma_f32_16x16x32_bf16 v[88:91], a[156:159], a[100:103], v[88:91]
  ds_read_b64_tr_b16 a[186:187], v43 offset:53248
  v_mfma_f32_16x16x32_bf16 v[88:91], a[152:155], a[96:99], v[88:91]
  s_waitcnt lgkmcnt(12)
  ds_read_b64_tr_b16 a[188:189], v43 offset:57344
  v_mfma_f32_16x16x32_bf16 v[96:99], a[160:163], a[96:99], v[96:99]
  s_waitcnt lgkmcnt(11)
  buffer_load_dword v10, v7, s[20:23], 0 offen offset:0 sc1
  v_mfma_f32_16x16x32_bf16 v[96:99], a[164:167], a[100:103], v[96:99]
  s_xor_b32 s34, s101, 0x2c000
  ds_read_b64_tr_b16 a[190:191], v43 offset:61440
  v_mfma_f32_16x16x32_bf16 v[100:103], a[164:167], a[108:111], v[100:103]
  s_waitcnt vmcnt(43)
  buffer_load_dwordx4 a[224:227], v60, s[40:43], s34 offen offset:0 sc1
  v_mfma_f32_16x16x32_bf16 v[100:103], a[160:163], a[104:107], v[100:103]
  s_barrier
  v_mfma_f32_16x16x32_bf16 v[160:163], a[160:163], a[112:115], v[160:163]
  ds_read_b64_tr_b16 a[128:129], v32 offset:0
  v_mfma_f32_16x16x32_bf16 v[160:163], a[164:167], a[116:119], v[160:163]
  ds_read_b64_tr_b16 a[130:131], v32 offset:4096
  v_mfma_f32_16x16x32_bf16 v[164:167], a[164:167], a[124:127], v[164:167]
  ds_read_b64_tr_b16 a[132:133], v32 offset:8192
  v_mfma_f32_16x16x32_bf16 v[164:167], a[160:163], a[120:123], v[164:167]
  s_waitcnt lgkmcnt(13)
  buffer_load_dwordx4 a[232:235], v60, s[40:43], s34 offen offset:1024 sc1
  v_mfma_f32_16x16x32_bf16 v[172:175], a[168:171], a[120:123], v[172:175]
  s_waitcnt lgkmcnt(11)
  ds_read_b64_tr_b16 a[134:135], v32 offset:12288
  v_mfma_f32_16x16x32_bf16 v[172:175], a[172:175], a[124:127], v[172:175]
  v_mfma_f32_16x16x32_bf16 v[168:171], a[172:175], a[116:119], v[168:171]
  v_mfma_f32_16x16x32_bf16 v[168:171], a[168:171], a[112:115], v[168:171]
  buffer_load_dwordx4 a[240:243], v61, s[40:43], s34 offen offset:0 sc1
  v_mfma_f32_16x16x32_bf16 v[108:111], a[168:171], a[104:107], v[108:111]
  ds_read_b64_tr_b16 a[136:137], v33 offset:0
  v_mfma_f32_16x16x32_bf16 v[108:111], a[172:175], a[108:111], v[108:111]
  ds_read_b64_tr_b16 a[138:139], v33 offset:4096
  v_mfma_f32_16x16x32_bf16 v[104:107], a[172:175], a[100:103], v[104:107]
  ds_read_b64_tr_b16 a[140:141], v33 offset:8192
  v_mfma_f32_16x16x32_bf16 v[104:107], a[168:171], a[96:99], v[104:107]
  s_waitcnt lgkmcnt(13)
  buffer_load_dwordx4 a[248:251], v61, s[40:43], s34 offen offset:1024 sc1
  v_mfma_f32_16x16x32_bf16 v[112:115], a[176:179], a[96:99], v[112:115]
  s_waitcnt lgkmcnt(11)
  ds_read_b64_tr_b16 a[142:143], v33 offset:12288
  v_mfma_f32_16x16x32_bf16 v[112:115], a[180:183], a[100:103], v[112:115]
  s_xor_b32 s34, s101, 0x2e000
  v_mfma_f32_16x16x32_bf16 v[116:119], a[180:183], a[108:111], v[116:119]
  v_mfma_f32_16x16x32_bf16 v[116:119], a[176:179], a[104:107], v[116:119]
  v_mfma_f32_16x16x32_bf16 v[176:179], a[176:179], a[112:115], v[176:179]
  buffer_load_dwordx4 a[228:231], v60, s[40:43], s34 offen offset:0 sc1
  v_mfma_f32_16x16x32_bf16 v[176:179], a[180:183], a[116:119], v[176:179]
  ds_read_b64_tr_b16 a[144:145], v34 offset:0
  v_mfma_f32_16x16x32_bf16 v[180:183], a[180:183], a[124:127], v[180:183]
  ds_read_b64_tr_b16 a[146:147], v34 offset:4096
  v_mfma_f32_16x16x32_bf16 v[180:183], a[176:179], a[120:123], v[180:183]
  s_waitcnt lgkmcnt(12)
  ds_read_b64_tr_b16 a[148:149], v34 offset:8192
  v_mfma_f32_16x16x32_bf16 v[188:191], a[184:187], a[120:123], v[188:191]
  s_waitcnt lgkmcnt(11)
  buffer_load_dwordx4 a[236:239], v60, s[40:43], s34 offen offset:1024 sc1
  v_mfma_f32_16x16x32_bf16 v[188:191], a[188:191], a[124:127], v[188:191]
  ds_read_b64_tr_b16 a[150:151], v34 offset:12288
  v_mfma_f32_16x16x32_bf16 v[184:187], a[188:191], a[116:119], v[184:187]
  v_mfma_f32_16x16x32_bf16 v[184:187], a[184:187], a[112:115], v[184:187]
  v_mfma_f32_16x16x32_bf16 v[124:127], a[184:187], a[104:107], v[124:127]
  buffer_load_dwordx4 a[244:247], v61, s[40:43], s34 offen offset:0 sc1
  v_mfma_f32_16x16x32_bf16 v[124:127], a[188:191], a[108:111], v[124:127]
  ds_read_b64_tr_b16 a[152:153], v35 offset:0
  v_mfma_f32_16x16x32_bf16 v[120:123], a[188:191], a[100:103], v[120:123]
  ds_read_b64_tr_b16 a[154:155], v35 offset:4096
  v_mfma_f32_16x16x32_bf16 v[120:123], a[184:187], a[96:99], v[120:123]
  s_waitcnt vmcnt(49) lgkmcnt(12)
  ds_read_b64_tr_b16 a[156:157], v35 offset:8192
  v_mfma_f32_16x16x32_bf16 v[96:99], a[128:131], v[192:195], v[96:99]
  s_waitcnt vmcnt(45) lgkmcnt(11)
  ds_read_b64_tr_b16 a[158:159], v35 offset:12288
  buffer_load_dwordx4 a[252:255], v61, s[40:43], s34 offen offset:1024 sc1
  v_mfma_f32_16x16x32_bf16 v[96:99], a[132:135], v[196:199], v[96:99]
L_pad17:
  s_cbranch_execz L_hr2
  s_waitcnt vmcnt(45)
  s_xor_b32 s32, s100, 0x180000
  v_mfma_f32_16x16x32_bf16 v[100:103], a[132:135], v[204:207], v[100:103]
  s_add_u32 m0, s37, 65536
  v_mfma_f32_16x16x32_bf16 v[100:103], a[128:131], v[200:203], v[100:103]
  v_mfma_f32_16x16x32_bf16 v[160:163], a[128:131], v[208:211], v[160:163]
  s_waitcnt vmcnt(44)
  ds_read_b64_tr_b16 a[160:161], v28 offset:0
  v_mfma_f32_16x16x32_bf16 v[160:163], a[132:135], v[212:215], v[160:163]
  s_waitcnt vmcnt(43)
  ds_read_b64_tr_b16 a[162:163], v28 offset:4096
  buffer_load_dwordx4 v24, s[44:47], s32 offen offset:0  lds
  v_mfma_f32_16x16x32_bf16 v[164:167], a[132:135], v[220:223], v[164:167]
  ds_read_b64_tr_b16 a[164:165], v28 offset:8192
  v_mfma_f32_16x16x32_bf16 v[164:167], a[128:131], v[216:219], v[164:167]
  s_waitcnt lgkmcnt(13)
  ds_read_b64_tr_b16 a[166:167], v28 offset:12288
  v_mfma_f32_16x16x32_bf16 v[172:175], a[136:139], v[216:219], v[172:175]
  s_waitcnt lgkmcnt(12)
  ds_read_b64_tr_b16 a[168:169], v29 offset:0
  v_mfma_f32_16x16x32_bf16 v[172:175], a[140:143], v[220:223], v[172:175]
  ds_read_b64_tr_b16 a[170:171], v29 offset:4096
  buffer_load_dwordx4 v25, s[44:47], s32 offen offset:1024  lds
  v_mfma_f32_16x16x32_bf16 v[168:171], a[140:143], v[212:215], v[168:171]
  ds_read_b64_tr_b16 a[172:173], v29 offset:8192
  v_mfma_f32_16x16x32_bf16 v[168:171], a[136:139], v[208:211], v[168:171]
  ds_read_b64_tr_b16 a[174:175], v29 offset:12288
  v_mfma_f32_16x16x32_bf16 v[108:111], a[136:139], v[200:203], v[108:111]
  ds_read_b64_tr_b16 a[176:177], v30 offset:0
  v_mfma_f32_16x16x32_bf16 v[108:111], a[140:143], v[204:207], v[108:111]
  ds_read_b64_tr_b16 a[178:179], v30 offset:4096
  buffer_load_dwordx4 v26, s[44:47], s32 offen offset:2048  lds
  v_mfma_f32_16x16x32_bf16 v[104:107], a[140:143], v[196:199], v[104:107]
  ds_read_b64_tr_b16 a[180:181], v30 offset:8192
  v_mfma_f32_16x16x32_bf16 v[104:107], a[136:139], v[192:195], v[104:107]
  ds_read_b64_tr_b16 a[182:183], v30 offset:12288
  s_waitcnt lgkmcnt(15)
  v_mfma_f32_16x16x32_bf16 v[112:115], a[144:147], v[192:195], v[112:115]
  ds_read_b64_tr_b16 a[184:185], v31 offset:0
  v_mfma_f32_16x16x32_bf16 v[112:115], a[148:151], v[196:199], v[112:115]
  ds_read_b64_tr_b16 a[186:187], v31 offset:4096
  v_mfma_f32_16x16x32_bf16 v[116:119], a[148:151], v[204:207], v[116:119]
  ds_read_b64_tr_b16 a[188:189], v31 offset:8192
  buffer_load_dwordx4 v27, s[44:47], s32 offen offset:3072  lds
  v_mfma_f32_16x16x32_bf16 v[116:119], a[144:147], v[200:203], v[116:119]
  s_waitcnt vmcnt(43)
  s_xor_b32 s34, s101, 0x30000
  s_barrier
  v_mfma_f32_16x16x32_bf16 v[176:179], a[144:147], v[208:211], v[176:179]
  ds_read_b64_tr_b16 a[190:191], v31 offset:12288
  v_mfma_f32_16x16x32_bf16 v[176:179], a[148:151], v[212:215], v[176:179]
  ds_read_b64_tr_b16 a[128:129], v32 offset:16384
  v_mfma_f32_16x16x32_bf16 v[180:183], a[148:151], v[220:223], v[180:183]
  ds_read_b64_tr_b16 a[130:131], v32 offset:20480
  buffer_load_dwordx4 a[0:3], v60, s[40:43], s34 offen offset:0 sc1
  v_mfma_f32_16x16x32_bf16 v[180:183], a[144:147], v[216:219], v[180:183]
  ds_read_b64_tr_b16 a[132:133], v32 offset:24576
  s_waitcnt lgkmcnt(15)
  v_mfma_f32_16x16x32_bf16 v[188:191], a[152:155], v[216:219], v[188:191]
  ds_read_b64_tr_b16 a[134:135], v32 offset:28672
  v_mfma_f32_16x16x32_bf16 v[188:191], a[156:159], v[220:223], v[188:191]
  v_mfma_f32_16x16x32_bf16 v[184:187], a[156:159], v[212:215], v[184:187]
  buffer_load_dwordx4 a[8:11], v60, s[40:43], s34 offen offset:1024 sc1
  v_mfma_f32_16x16x32_bf16 v[184:187], a[152:155], v[208:211], v[184:187]
  v_mfma_f32_16x16x32_bf16 v[124:127], a[152:155], v[200:203], v[124:127]
  ds_read_b64_tr_b16 a[136:137], v33 offset:16384
  v_mfma_f32_16x16x32_bf16 v[124:127], a[156:159], v[204:207], v[124:127]
  ds_read_b64_tr_b16 a[138:139], v33 offset:20480
  v_mfma_f32_16x16x32_bf16 v[120:123], a[156:159], v[196:199], v[120:123]
  ds_read_b64_tr_b16 a[140:141], v33 offset:24576
  v_mfma_f32_16x16x32_bf16 v[120:123], a[152:155], v[192:195], v[120:123]
  ds_read_b64_tr_b16 a[142:143], v33 offset:28672
  buffer_load_dwordx4 a[16:19], v61, s[40:43], s34 offen offset:0 sc1
  v_mfma_f32_16x16x32_bf16 v[128:131], a[160:163], v[208:211], v[128:131]
  v_mfma_f32_16x16x32_bf16 v[128:131], a[164:167], v[212:215], v[128:131]
  v_mfma_f32_16x16x32_bf16 v[132:135], a[164:167], v[220:223], v[132:135]
  v_mfma_f32_16x16x32_bf16 v[132:135], a[160:163], v[216:219], v[132:135]
  s_waitcnt lgkmcnt(15)
  buffer_load_dwordx4 a[24:27], v61, s[40:43], s34 offen offset:1024 sc1
  v_mfma_f32_16x16x32_bf16 v[140:143], a[168:171], v[216:219], v[140:143]
  s_xor_b32 s34, s101, 0x32000
  ds_read_b64_tr_b16 a[144:145], v34 offset:16384
  v_mfma_f32_16x16x32_bf16 v[140:143], a[172:175], v[220:223], v[140:143]
  ds_read_b64_tr_b16 a[146:147], v34 offset:20480
  v_mfma_f32_16x16x32_bf16 v[136:139], a[172:175], v[212:215], v[136:139]
  ds_read_b64_tr_b16 a[148:149], v34 offset:24576
  v_mfma_f32_16x16x32_bf16 v[136:139], a[168:171], v[208:211], v[136:139]
  ds_read_b64_tr_b16 a[150:151], v34 offset:28672
  buffer_load_dwordx4 a[4:7], v60, s[40:43], s34 offen offset:0 sc1
  s_waitcnt lgkmcnt(15)
  v_mfma_f32_16x16x32_bf16 v[144:147], a[176:179], v[208:211], v[144:147]
  v_mfma_f32_16x16x32_bf16 v[144:147], a[180:183], v[212:215], v[144:147]
  v_mfma_f32_16x16x32_bf16 v[148:151], a[180:183], v[220:223], v[148:151]
  v_mfma_f32_16x16x32_bf16 v[148:151], a[176:179], v[216:219], v[148:151]
  s_waitcnt lgkmcnt(14)
  buffer_load_dwordx4 a[12:15], v60, s[40:43], s34 offen offset:1024 sc1
  v_mfma_f32_16x16x32_bf16 v[156:159], a[184:187], v[216:219], v[156:159]
  s_waitcnt lgkmcnt(12)
  ds_read_b64_tr_b16 a[152:153], v35 offset:16384
  v_mfma_f32_16x16x32_bf16 v[156:159], a[188:191], v[220:223], v[156:159]
  ds_read_b64_tr_b16 a[154:155], v35 offset:20480
  v_mfma_f32_16x16x32_bf16 v[152:155], a[188:191], v[212:215], v[152:155]
  ds_read_b64_tr_b16 a[156:157], v35 offset:24576
  v_mfma_f32_16x16x32_bf16 v[152:155], a[184:187], v[208:211], v[152:155]
  s_waitcnt vmcnt(48) lgkmcnt(13)
  ds_read_b64_tr_b16 a[158:159], v35 offset:28672
  v_mfma_f32_16x16x32_bf16 v[96:99], a[128:131], v[224:227], v[96:99]
  s_waitcnt vmcnt(31)
  s_waitcnt lgkmcnt(12)
  ds_read_b64 v[208:209], v56 offset:0
  buffer_load_dwordx4 a[20:23], v61, s[40:43], s34 offen offset:0 sc1
  v_mfma_f32_16x16x32_bf16 v[96:99], a[132:135], v[228:231], v[96:99]
  ds_read_b64 v[210:211], v57 offset:0
  v_mfma_f32_16x16x32_bf16 v[100:103], a[132:135], v[236:239], v[100:103]
  ds_read_b64 v[212:213], v58 offset:0
  v_mfma_f32_16x16x32_bf16 v[100:103], a[128:131], v[232:235], v[100:103]
  s_barrier
  v_mfma_f32_16x16x32_bf16 v[160:163], a[128:131], v[240:243], v[160:163]
  ds_read_b64_tr_b16 a[160:161], v32 offset:32768
  buffer_load_dwordx4 a[28:31], v61, s[40:43], s34 offen offset:1024 sc1
  v_mfma_f32_16x16x32_bf16 v[160:163], a[132:135], v[244:247], v[160:163]
  s_xor_b32 s32, s100, 0x1a0000
  ds_read_b64_tr_b16 a[162:163], v32 offset:36864
  v_mfma_f32_16x16x32_bf16 v[164:167], a[132:135], v[252:255], v[164:167]
  s_add_u32 m0, s37, 81920
  ds_read_b64_tr_b16 a[164:165], v32 offset:40960
  v_mfma_f32_16x16x32_bf16 v[164:167], a[128:131], v[248:251], v[164:167]
  ds_read_b64_tr_b16 a[166:167], v32 offset:45056
  s_waitcnt lgkmcnt(15)
  v_mfma_f32_16x16x32_bf16 v[172:175], a[136:139], v[248:251], v[172:175]
  ds_read_b64 v[214:215], v59 offset:0
  buffer_load_dwordx4 v24, s[44:47], s32 offen offset:0  lds
  v_mfma_f32_16x16x32_bf16 v[172:175], a[140:143], v[252:255], v[172:175]
  ds_read_b64 v[216:217], v56 offset:2048
  v_mfma_f32_16x16x32_bf16 v[168:171], a[140:143], v[244:247], v[168:171]
  ds_read_b64 v[218:219], v57 offset:2048
  v_mfma_f32_16x16x32_bf16 v[168:171], a[136:139], v[240:243], v[168:171]
  ds_read_b64 v[220:221], v58 offset:2048
  v_mfma_f32_16x16x32_bf16 v[108:111], a[136:139], v[232:235], v[108:111]
  ds_read_b64_tr_b16 a[168:169], v33 offset:32768
  v_mfma_f32_16x16x32_bf16 v[108:111], a[140:143], v[236:239], v[108:111]
  ds_read_b64_tr_b16 a[170:171], v33 offset:36864
  buffer_load_dwordx4 v25, s[44:47], s32 offen offset:1024  lds
  v_mfma_f32_16x16x32_bf16 v[104:107], a[140:143], v[228:231], v[104:107]
  ds_read_b64_tr_b16 a[172:173], v33 offset:40960
  v_mfma_f32_16x16x32_bf16 v[104:107], a[136:139], v[224:227], v[104:107]
  ds_read_b64_tr_b16 a[174:175], v33 offset:45056
  s_waitcnt lgkmcnt(15)
  v_mfma_f32_16x16x32_bf16 v[112:115], a[144:147], v[224:227], v[112:115]
  ds_read_b64 v[222:223], v59 offset:2048
  v_mfma_f32_16x16x32_bf16 v[112:115], a[148:151], v[228:231], v[112:115]
  s_waitcnt vmcnt(22)
  v_cmp_ne_u32 vcc, 1, v10
  s_nop 2
  s_cbranch_vccnz L_conv_wait
L_conv_ok:
  v_mfma_f32_16x16x32_bf16 v[116:119], a[148:151], v[236:239], v[116:119]
  buffer_load_dwordx4 v26, s[44:47], s32 offen offset:2048  lds
  v_mfma_f32_16x16x32_bf16 v[116:119], a[144:147], v[232:235], v[116:119]
  v_mfma_f32_16x16x32_bf16 v[176:179], a[144:147], v[240:243], v[176:179]
  ds_read_b64_tr_b16 a[176:177], v34 offset:32768
  v_mfma_f32_16x16x32_bf16 v[176:179], a[148:151], v[244:247], v[176:179]
  ds_read_b64_tr_b16 a[178:179], v34 offset:36864
  buffer_load_dwordx4 v27, s[44:47], s32 offen offset:3072  lds
  v_mfma_f32_16x16x32_bf16 v[180:183], a[148:151], v[252:255], v[180:183]
  ds_read_b64_tr_b16 a[180:181], v34 offset:40960
  v_mfma_f32_16x16x32_bf16 v[180:183], a[144:147], v[248:251], v[180:183]
  s_xor_b32 s34, s101, 0x34000
  ds_read_b64_tr_b16 a[182:183], v34 offset:45056
  v_mfma_f32_16x16x32_bf16 v[188:191], a[152:155], v[248:251], v[188:191]
  v_mfma_f32_16x16x32_bf16 v[188:191], a[156:159], v[252:255], v[188:191]
  v_mfma_f32_16x16x32_bf16 v[184:187], a[156:159], v[244:247], v[184:187]
  buffer_load_dwordx4 a[32:35], v60, s[40:43], s34 offen offset:0 sc1
  v_mfma_f32_16x16x32_bf16 v[184:187], a[152:155], v[240:243], v[184:187]
  v_mfma_f32_16x16x32_bf16 v[124:127], a[152:155], v[232:235], v[124:127]
  ds_read_b64_tr_b16 a[184:185], v35 offset:32768
  v_mfma_f32_16x16x32_bf16 v[124:127], a[156:159], v[236:239], v[124:127]
  ds_read_b64_tr_b16 a[186:187], v35 offset:36864
  v_mfma_f32_16x16x32_bf16 v[120:123], a[156:159], v[228:231], v[120:123]
  ds_read_b64_tr_b16 a[188:189], v35 offset:40960
  buffer_load_dwordx4 a[40:43], v60, s[40:43], s34 offen offset:1024 sc1
  v_mfma_f32_16x16x32_bf16 v[120:123], a[152:155], v[224:227], v[120:123]
  ds_read_b64_tr_b16 a[190:191], v35 offset:45056
  s_waitcnt lgkmcnt(15)
  v_mfma_f32_16x16x32_bf16 v[96:99], a[160:163], a[192:195], v[96:99]
  v_mfma_f32_16x16x32_bf16 v[96:99], a[164:167], a[196:199], v[96:99]
  v_mfma_f32_16x16x32_bf16 v[100:103], a[164:167], a[204:207], v[100:103]
  buffer_load_dwordx4 a[48:51], v61, s[40:43], s34 offen offset:0 sc1
  v_mfma_f32_16x16x32_bf16 v[100:103], a[160:163], a[200:203], v[100:103]
  s_barrier
  v_mfma_f32_16x16x32_bf16 v[160:163], a[160:163], a[208:211], v[160:163]
  ds_read_b64_tr_b16 a[128:129], v32 offset:49152
  v_mfma_f32_16x16x32_bf16 v[160:163], a[164:167], a[212:215], v[160:163]
  ds_read_b64_tr_b16 a[130:131], v32 offset:53248
  v_mfma_f32_16x16x32_bf16 v[164:167], a[164:167], a[220:223], v[164:167]
  ds_read_b64_tr_b16 a[132:133], v32 offset:57344
  buffer_load_dwordx4 a[56:59], v61, s[40:43], s34 offen offset:1024 sc1
  v_mfma_f32_16x16x32_bf16 v[164:167], a[160:163], a[216:219], v[164:167]
  ds_read_b64_tr_b16 a[134:135], v32 offset:61440
  s_waitcnt lgkmcnt(15)
  v_mfma_f32_16x16x32_bf16 v[172:175], a[168:171], a[216:219], v[172:175]
  s_waitcnt lgkmcnt(13)
  s_xor_b32 s34, s101, 0x36000
  v_mfma_f32_16x16x32_bf16 v[172:175], a[172:175], a[220:223], v[172:175]
  v_mfma_f32_16x16x32_bf16 v[168:171], a[172:175], a[212:215], v[168:171]
  v_mfma_f32_16x16x32_bf16 v[168:171], a[168:171], a[208:211], v[168:171]
  buffer_load_dwordx4 a[36:39], v60, s[40:43], s34 offen offset:0 sc1
  v_mfma_f32_16x16x32_bf16 v[108:111], a[168:171], a[200:203], v[108:111]
  ds_read_b64_tr_b16 a[136:137], v33 offset:49152
  v_mfma_f32_16x16x32_bf16 v[108:111], a[172:175], a[204:207], v[108:111]
  ds_read_b64_tr_b16 a[138:139], v33 offset:53248
  v_mfma_f32_16x16x32_bf16 v[104:107], a[172:175], a[196:199], v[104:107]
  ds_read_b64_tr_b16 a[140:141], v33 offset:57344
  v_mfma_f32_16x16x32_bf16 v[104:107], a[168:171], a[192:195], v[104:107]
  s_waitcnt lgkmcnt(13)
  ds_read_b64_tr_b16 a[142:143], v33 offset:61440
  buffer_load_dwordx4 a[44:47], v60, s[40:43], s34 offen offset:1024 sc1
  v_mfma_f32_16x16x32_bf16 v[112:115], a[176:179], a[192:195], v[112:115]
  s_waitcnt lgkmcnt(12)
  v_mfma_f32_16x16x32_bf16 v[112:115], a[180:183], a[196:199], v[112:115]
  v_mfma_f32_16x16x32_bf16 v[116:119], a[180:183], a[204:207], v[116:119]
  v_mfma_f32_16x16x32_bf16 v[116:119], a[176:179], a[200:203], v[116:119]
  buffer_load_dwordx4 a[52:55], v61, s[40:43], s34 offen offset:0 sc1
  v_mfma_f32_16x16x32_bf16 v[176:179], a[176:179], a[208:211], v[176:179]
  ds_read_b64_tr_b16 a[144:145], v34 offset:49152
  v_mfma_f32_16x16x32_bf16 v[176:179], a[180:183], a[212:215], v[176:179]
  ds_read_b64_tr_b16 a[146:147], v34 offset:53248
  v_mfma_f32_16x16x32_bf16 v[180:183], a[180:183], a[220:223], v[180:183]
  ds_read_b64_tr_b16 a[148:149], v34 offset:57344
  v_mfma_f32_16x16x32_bf16 v[180:183], a[176:179], a[216:219], v[180:183]
  s_waitcnt lgkmcnt(13)
  ds_read_b64_tr_b16 a[150:151], v34 offset:61440
  v_mfma_f32_16x16x32_bf16 v[188:191], a[184:187], a[216:219], v[188:191]
  s_waitcnt lgkmcnt(12)
  buffer_load_dwordx4 a[60:63], v61, s[40:43], s34 offen offset:1024 sc1
  v_mfma_f32_16x16x32_bf16 v[188:191], a[188:191], a[220:223], v[188:191]
  s_xor_b32 s32, s100, 0x1c0000
  v_mfma_f32_16x16x32_bf16 v[184:187], a[188:191], a[212:215], v[184:187]
  s_add_u32 m0, s37, 98304
  v_mfma_f32_16x16x32_bf16 v[184:187], a[184:187], a[208:211], v[184:187]
  v_mfma_f32_16x16x32_bf16 v[124:127], a[184:187], a[200:203], v[124:127]
  ds_read_b64_tr_b16 a[152:153], v35 offset:49152
  buffer_load_dwordx4 v24, s[44:47], s32 offen offset:0  lds
  v_mfma_f32_16x16x32_bf16 v[124:127], a[188:191], a[204:207], v[124:127]
  ds_read_b64_tr_b16 a[154:155], v35 offset:53248
  v_mfma_f32_16x16x32_bf16 v[120:123], a[188:191], a[196:199], v[120:123]
  ds_read_b64_tr_b16 a[156:157], v35 offset:57344
  v_mfma_f32_16x16x32_bf16 v[120:123], a[184:187], a[192:195], v[120:123]
  s_waitcnt vmcnt(32) lgkmcnt(13)
  ds_read_b64_tr_b16 a[158:159], v35 offset:61440
  v_mfma_f32_16x16x32_bf16 v[96:99], a[128:131], a[224:227], v[96:99]
  s_waitcnt vmcnt(28) lgkmcnt(12)
  buffer_load_dwordx4 v25, s[44:47], s32 offen offset:1024  lds
  v_mfma_f32_16x16x32_bf16 v[96:99], a[132:135], a[228:231], v[96:99]
  s_waitcnt vmcnt(28)
  v_mfma_f32_16x16x32_bf16 v[100:103], a[132:135], a[236:239], v[100:103]
  s_waitcnt vmcnt(22)
  v_mfma_f32_16x16x32_bf16 v[100:103], a[128:131], a[232:235], v[100:103]
  s_barrier
  v_mfma_f32_16x16x32_bf16 v[160:163], a[128:131], a[240:243], v[160:163]
  ds_read_b64_tr_b16 a[160:161], v40 offset:0
  buffer_load_dwordx4 v26, s[44:47], s32 offen offset:2048  lds
  v_mfma_f32_16x16x32_bf16 v[160:163], a[132:135], a[244:247], v[160:163]
  ds_read_b64_tr_b16 a[162:163], v40 offset:4096
  v_mfma_f32_16x16x32_bf16 v[164:167], a[132:135], a[252:255], v[164:167]
  ds_read_b64_tr_b16 a[164:165], v40 offset:8192
  v_mfma_f32_16x16x32_bf16 v[164:167], a[128:131], a[248:251], v[164:167]
  s_waitcnt lgkmcnt(13)
  ds_read_b64_tr_b16 a[166:167], v40 offset:12288
  v_mfma_f32_16x16x32_bf16 v[172:175], a[136:139], a[248:251], v[172:175]
  s_waitcnt lgkmcnt(12)
  v_mfma_f32_16x16x32_bf16 v[172:175], a[140:143], a[252:255], v[172:175]
  buffer_load_dwordx4 v27, s[44:47], s32 offen offset:3072  lds
  v_mfma_f32_16x16x32_bf16 v[168:171], a[140:143], a[244:247], v[168:171]
  s_xor_b32 s34, s101, 0x38000
  v_mfma_f32_16x16x32_bf16 v[168:171], a[136:139], a[240:243], v[168:171]
  v_mfma_f32_16x16x32_bf16 v[108:111], a[136:139], a[232:235], v[108:111]
  ds_read_b64_tr_b16 a[168:169], v41 offset:0
  v_mfma_f32_16x16x32_bf16 v[108:111], a[140:143], a[236:239], v[108:111]
  ds_read_b64_tr_b16 a[170:171], v41 offset:4096
  buffer_load_dwordx4 a[64:67], v60, s[40:43], s34 offen offset:0 sc1
  v_mfma_f32_16x16x32_bf16 v[104:107], a[140:143], a[228:231], v[104:107]
  ds_read_b64_tr_b16 a[172:173], v41 offset:8192
  v_mfma_f32_16x16x32_bf16 v[104:107], a[136:139], a[224:227], v[104:107]
  s_waitcnt lgkmcnt(13)
  ds_read_b64_tr_b16 a[174:175], v41 offset:12288
  v_mfma_f32_16x16x32_bf16 v[112:115], a[144:147], a[224:227], v[112:115]
  s_waitcnt lgkmcnt(12)
  v_mfma_f32_16x16x32_bf16 v[112:115], a[148:151], a[228:231], v[112:115]
  buffer_load_dwordx4 a[72:75], v60, s[40:43], s34 offen offset:1024 sc1
  v_mfma_f32_16x16x32_bf16 v[116:119], a[148:151], a[236:239], v[116:119]
  v_mfma_f32_16x16x32_bf16 v[116:119], a[144:147], a[232:235], v[116:119]
  v_mfma_f32_16x16x32_bf16 v[176:179], a[144:147], a[240:243], v[176:179]
  ds_read_b64_tr_b16 a[176:177], v42 offset:0
  v_mfma_f32_16x16x32_bf16 v[176:179], a[148:151], a[244:247], v[176:179]
  ds_read_b64_tr_b16 a[178:179], v42 offset:4096
  v_mfma_f32_16x16x32_bf16 v[180:183], a[148:151], a[252:255], v[180:183]
  ds_read_b64_tr_b16 a[180:181], v42 offset:8192
  buffer_load_dwordx4 a[80:83], v61, s[40:43], s34 offen offset:0 sc1
  v_mfma_f32_16x16x32_bf16 v[180:183], a[144:147], a[248:251], v[180:183]
  s_waitcnt lgkmcnt(13)
  ds_read_b64_tr_b16 a[182:183], v42 offset:12288
  v_mfma_f32_16x16x32_bf16 v[188:191], a[152:155], a[248:251], v[188:191]
  s_waitcnt lgkmcnt(12)
  v_mfma_f32_16x16x32_bf16 v[188:191], a[156:159], a[252:255], v[188:191]
  v_mfma_f32_16x16x32_bf16 v[184:187], a[156:159], a[244:247], v[184:187]
  buffer_load_dwordx4 a[88:91], v61, s[40:43], s34 offen offset:1024 sc1
  v_mfma_f32_16x16x32_bf16 v[184:187], a[152:155], a[240:243], v[184:187]
  s_xor_b32 s34, s101, 0x3a000
  v_mfma_f32_16x16x32_bf16 v[124:127], a[152:155], a[232:235], v[124:127]
  ds_read_b64_tr_b16 a[184:185], v43 offset:0
  v_mfma_f32_16x16x32_bf16 v[124:127], a[156:159], a[236:239], v[124:127]
  ds_read_b64_tr_b16 a[186:187], v43 offset:4096
  v_mfma_f32_16x16x32_bf16 v[120:123], a[156:159], a[228:231], v[120:123]
  ds_read_b64_tr_b16 a[188:189], v43 offset:8192
  buffer_load_dwordx4 a[68:71], v60, s[40:43], s34 offen offset:0 sc1
  v_mfma_f32_16x16x32_bf16 v[120:123], a[152:155], a[224:227], v[120:123]
  s_waitcnt vmcnt(28) lgkmcnt(13)
  ds_read_b64_tr_b16 a[190:191], v43 offset:12288
  v_mfma_f32_16x16x32_bf16 v[96:99], a[160:163], a[0:3], v[96:99]
  s_waitcnt vmcnt(24) lgkmcnt(12)
  v_mfma_f32_16x16x32_bf16 v[96:99], a[164:167], a[4:7], v[96:99]
  s_waitcnt vmcnt(23)
  v_mfma_f32_16x16x32_bf16 v[100:103], a[164:167], a[12:15], v[100:103]
  s_waitcnt vmcnt(17)
  v_mfma_f32_16x16x32_bf16 v[100:103], a[160:163], a[8:11], v[100:103]
  s_barrier
  v_mfma_f32_16x16x32_bf16 v[160:163], a[160:163], a[16:19], v[160:163]
  ds_read_b64_tr_b16 a[128:129], v40 offset:16384
  buffer_load_dwordx4 a[76:79], v60, s[40:43], s34 offen offset:1024 sc1
  v_mfma_f32_16x16x32_bf16 v[160:163], a[164:167], a[20:23], v[160:163]
  ds_read_b64_tr_b16 a[130:131], v40 offset:20480
  v_mfma_f32_16x16x32_bf16 v[164:167], a[164:167], a[28:31], v[164:167]
  ds_read_b64_tr_b16 a[132:133], v40 offset:24576
  v_mfma_f32_16x16x32_bf16 v[164:167], a[160:163], a[24:27], v[164:167]
  s_waitcnt lgkmcnt(13)
  ds_read_b64_tr_b16 a[134:135], v40 offset:28672
  buffer_load_dwordx4 a[84:87], v61, s[40:43], s34 offen offset:0 sc1
  v_mfma_f32_16x16x32_bf16 v[172:175], a[168:171], a[24:27], v[172:175]
  s_waitcnt lgkmcnt(12)
  v_mfma_f32_16x16x32_bf16 v[172:175], a[172:175], a[28:31], v[172:175]
  v_mfma_f32_16x16x32_bf16 v[168:171], a[172:175], a[20:23], v[168:171]
  v_mfma_f32_16x16x32_bf16 v[168:171], a[168:171], a[16:19], v[168:171]
  buffer_load_dwordx4 a[92:95], v61, s[40:43], s34 offen offset:1024 sc1
  v_mfma_f32_16x16x32_bf16 v[108:111], a[168:171], a[8:11], v[108:111]
  s_xor_b32 s32, s100, 0x1e0000
  ds_read_b64_tr_b16 a[136:137], v41 offset:16384
  v_mfma_f32_16x16x32_bf16 v[108:111], a[172:175], a[12:15], v[108:111]
  s_add_u32 m0, s37, 114688
  ds_read_b64_tr_b16 a[138:139], v41 offset:20480
  v_mfma_f32_16x16x32_bf16 v[104:107], a[172:175], a[4:7], v[104:107]
  ds_read_b64_tr_b16 a[140:141], v41 offset:24576
  v_mfma_f32_16x16x32_bf16 v[104:107], a[168:171], a[0:3], v[104:107]
  s_waitcnt lgkmcnt(13)
  ds_read_b64_tr_b16 a[142:143], v41 offset:28672
  buffer_load_dwordx4 v24, s[44:47], s32 offen offset:0  lds
  v_mfma_f32_16x16x32_bf16 v[112:115], a[176:179], a[0:3], v[112:115]
  s_waitcnt lgkmcnt(12)
  v_mfma_f32_16x16x32_bf16 v[112:115], a[180:183], a[4:7], v[112:115]
  v_mfma_f32_16x16x32_bf16 v[116:119], a[180:183], a[12:15], v[116:119]
  v_mfma_f32_16x16x32_bf16 v[116:119], a[176:179], a[8:11], v[116:119]
  buffer_load_dwordx4 v25, s[44:47], s32 offen offset:1024  lds
  v_mfma_f32_16x16x32_bf16 v[176:179], a[176:179], a[16:19], v[176:179]
  ds_read_b64_tr_b16 a[144:145], v42 offset:16384
  v_mfma_f32_16x16x32_bf16 v[176:179], a[180:183], a[20:23], v[176:179]
  ds_read_b64_tr_b16 a[146:147], v42 offset:20480
  buffer_load_dwordx4 v26, s[44:47], s32 offen offset:2048  lds
  v_mfma_f32_16x16x32_bf16 v[180:183], a[180:183], a[28:31], v[180:183]
  ds_read_b64_tr_b16 a[148:149], v42 offset:24576
  v_mfma_f32_16x16x32_bf16 v[180:183], a[176:179], a[24:27], v[180:183]
  s_waitcnt lgkmcnt(13)
  ds_read_b64_tr_b16 a[150:151], v42 offset:28672
  buffer_load_dwordx4 v27, s[44:47], s32 offen offset:3072  lds
  v_mfma_f32_16x16x32_bf16 v[188:191], a[184:187], a[24:27], v[188:191]
  s_waitcnt lgkmcnt(12)
  v_mfma_f32_16x16x32_bf16 v[188:191], a[188:191], a[28:31], v[188:191]
  v_mfma_f32_16x16x32_bf16 v[184:187], a[188:191], a[20:23], v[184:187]
  v_mfma_f32_16x16x32_bf16 v[184:187], a[184:187], a[16:19], v[184:187]
  v_mfma_f32_16x16x32_bf16 v[124:127], a[184:187], a[8:11], v[124:127]
  ds_read_b64_tr_b16 a[152:153], v43 offset:16384
  v_mfma_f32_16x16x32_bf16 v[124:127], a[188:191], a[12:15], v[124:127]
  s_xor_b32 s34, s101, 0x3c000
  ds_read_b64_tr_b16 a[154:155], v43 offset:20480
  v_mfma_f32_16x16x32_bf16 v[120:123], a[188:191], a[4:7], v[120:123]
  ds_read_b64_tr_b16 a[156:157], v43 offset:24576
  v_mfma_f32_16x16x32_bf16 v[120:123], a[184:187], a[0:3], v[120:123]
  s_waitcnt vmcnt(23) lgkmcnt(13)
  ds_read_b64_tr_b16 a[158:159], v43 offset:28672
  v_mfma_f32_16x16x32_bf16 v[96:99], a[128:131], a[32:35], v[96:99]
  s_waitcnt vmcnt(19) lgkmcnt(12)
  buffer_load_dwordx4 a[96:99], v60, s[40:43], s34 offen offset:0 sc1
  v_mfma_f32_16x16x32_bf16 v[96:99], a[132:135], a[36:39], v[96:99]
  s_waitcnt vmcnt(19)
  v_mfma_f32_16x16x32_bf16 v[100:103], a[132:135], a[44:47], v[100:103]
  s_waitcnt vmcnt(13)
  v_mfma_f32_16x16x32_bf16 v[100:103], a[128:131], a[40:43], v[100:103]
  s_barrier
  v_mfma_f32_16x16x32_bf16 v[160:163], a[128:131], a[48:51], v[160:163]
  ds_read_b64_tr_b16 a[160:161], v40 offset:32768
  buffer_load_dwordx4 a[104:107], v60, s[40:43], s34 offen offset:1024 sc1
  v_mfma_f32_16x16x32_bf16 v[160:163], a[132:135], a[52:55], v[160:163]
  ds_read_b64_tr_b16 a[162:163], v40 offset:36864
  v_mfma_f32_16x16x32_bf16 v[164:167], a[132:135], a[60:63], v[164:167]
  ds_read_b64_tr_b16 a[164:165], v40 offset:40960
  v_mfma_f32_16x16x32_bf16 v[164:167], a[128:131], a[56:59], v[164:167]
  s_waitcnt lgkmcnt(13)
  ds_read_b64_tr_b16 a[166:167], v40 offset:45056
  v_mfma_f32_16x16x32_bf16 v[172:175], a[136:139], a[56:59], v[172:175]
  s_waitcnt lgkmcnt(12)
  buffer_load_dwordx4 a[112:115], v61, s[40:43], s34 offen offset:0 sc1
  v_mfma_f32_16x16x32_bf16 v[172:175], a[140:143], a[60:63], v[172:175]
  v_mfma_f32_16x16x32_bf16 v[168:171], a[140:143], a[52:55], v[168:171]
  v_mfma_f32_16x16x32_bf16 v[168:171], a[136:139], a[48:51], v[168:171]
  v_mfma_f32_16x16x32_bf16 v[108:111], a[136:139], a[40:43], v[108:111]
  ds_read_b64_tr_b16 a[168:169], v41 offset:32768
  buffer_load_dwordx4 a[120:123], v61, s[40:43], s34 offen offset:1024 sc1
  v_mfma_f32_16x16x32_bf16 v[108:111], a[140:143], a[44:47], v[108:111]
  s_xor_b32 s34, s101, 0x3e000
  ds_read_b64_tr_b16 a[170:171], v41 offset:36864
  v_mfma_f32_16x16x32_bf16 v[104:107], a[140:143], a[36:39], v[104:107]
  ds_read_b64_tr_b16 a[172:173], v41 offset:40960
  buffer_load_dwordx4 a[100:103], v60, s[40:43], s34 offen offset:0 sc1
  v_mfma_f32_16x16x32_bf16 v[104:107], a[136:139], a[32:35], v[104:107]
  s_waitcnt lgkmcnt(13)
  ds_read_b64_tr_b16 a[174:175], v41 offset:45056
  v_mfma_f32_16x16x32_bf16 v[112:115], a[144:147], a[32:35], v[112:115]
  s_waitcnt lgkmcnt(12)
  buffer_load_dwordx4 a[108:111], v60, s[40:43], s34 offen offset:1024 sc1
  v_mfma_f32_16x16x32_bf16 v[112:115], a[148:151], a[36:39], v[112:115]
  v_mfma_f32_16x16x32_bf16 v[116:119], a[148:151], a[44:47], v[116:119]
  buffer_load_dwordx4 a[116:119], v61, s[40:43], s34 offen offset:0 sc1
  v_mfma_f32_16x16x32_bf16 v[116:119], a[144:147], a[40:43], v[116:119]
  v_mfma_f32_16x16x32_bf16 v[176:179], a[144:147], a[48:51], v[176:179]
  ds_read_b64_tr_b16 a[176:177], v42 offset:32768
  buffer_load_dwordx4 a[124:127], v61, s[40:43], s34 offen offset:1024 sc1
  v_mfma_f32_16x16x32_bf16 v[176:179], a[148:151], a[52:55], v[176:179]
  ds_read_b64_tr_b16 a[178:179], v42 offset:36864
  v_mfma_f32_16x16x32_bf16 v[180:183], a[148:151], a[60:63], v[180:183]
  ds_read_b64_tr_b16 a[180:181], v42 offset:40960
  v_mfma_f32_16x16x32_bf16 v[180:183], a[144:147], a[56:59], v[180:183]
  s_waitcnt lgkmcnt(13)
  ds_read_b64_tr_b16 a[182:183], v42 offset:45056
  v_mfma_f32_16x16x32_bf16 v[188:191], a[152:155], a[56:59], v[188:191]
  s_waitcnt lgkmcnt(12)
  v_mfma_f32_16x16x32_bf16 v[188:191], a[156:159], a[60:63], v[188:191]
  v_mfma_f32_16x16x32_bf16 v[184:187], a[156:159], a[52:55], v[184:187]
  v_mfma_f32_16x16x32_bf16 v[184:187], a[152:155], a[48:51], v[184:187]
  v_mfma_f32_16x16x32_bf16 v[124:127], a[152:155], a[40:43], v[124:127]
  ds_read_b64_tr_b16 a[184:185], v43 offset:32768
  v_mfma_f32_16x16x32_bf16 v[124:127], a[156:159], a[44:47], v[124:127]
  ds_read_b64_tr_b16 a[186:187], v43 offset:36864
  v_mfma_f32_16x16x32_bf16 v[120:123], a[156:159], a[36:39], v[120:123]
  ds_read_b64_tr_b16 a[188:189], v43 offset:40960
  v_mfma_f32_16x16x32_bf16 v[120:123], a[152:155], a[32:35], v[120:123]
  s_waitcnt vmcnt(19) lgkmcnt(13)
  ds_read_b64_tr_b16 a[190:191], v43 offset:45056
  v_mfma_f32_16x16x32_bf16 v[96:99], a[160:163], a[64:67], v[96:99]
  s_waitcnt vmcnt(15) lgkmcnt(12)
  v_mfma_f32_16x16x32_bf16 v[96:99], a[164:167], a[68:71], v[96:99]
  s_waitcnt vmcnt(14)
  v_mfma_f32_16x16x32_bf16 v[100:103], a[164:167], a[76:79], v[100:103]
  s_waitcnt vmcnt(8)
  v_mfma_f32_16x16x32_bf16 v[100:103], a[160:163], a[72:75], v[100:103]
  s_barrier
  v_mfma_f32_16x16x32_bf16 v[160:163], a[160:163], a[80:83], v[160:163]
  ds_read_b64_tr_b16 a[128:129], v40 offset:49152
  v_mfma_f32_16x16x32_bf16 v[160:163], a[164:167], a[84:87], v[160:163]
  ds_read_b64_tr_b16 a[130:131], v40 offset:53248
  v_mfma_f32_16x16x32_bf16 v[164:167], a[164:167], a[92:95], v[164:167]
  ds_read_b64_tr_b16 a[132:133], v40 offset:57344
  v_mfma_f32_16x16x32_bf16 v[164:167], a[160:163], a[88:91], v[164:167]
  s_waitcnt lgkmcnt(13)
  ds_read_b64_tr_b16 a[134:135], v40 offset:61440
  v_mfma_f32_16x16x32_bf16 v[172:175], a[168:171], a[88:91], v[172:175]
  s_waitcnt lgkmcnt(12)
  v_mfma_f32_16x16x32_bf16 v[172:175], a[172:175], a[92:95], v[172:175]
  v_mfma_f32_16x16x32_bf16 v[168:171], a[172:175], a[84:87], v[168:171]
  v_mfma_f32_16x16x32_bf16 v[168:171], a[168:171], a[80:83], v[168:171]
  v_mfma_f32_16x16x32_bf16 v[108:111], a[168:171], a[72:75], v[108:111]
  ds_read_b64_tr_b16 a[136:137], v41 offset:49152
  v_mfma_f32_16x16x32_bf16 v[108:111], a[172:175], a[76:79], v[108:111]
  ds_read_b64_tr_b16 a[138:139], v41 offset:53248
  v_mfma_f32_16x16x32_bf16 v[104:107], a[172:175], a[68:71], v[104:107]
  ds_read_b64_tr_b16 a[140:141], v41 offset:57344
  v_mfma_f32_16x16x32_bf16 v[104:107], a[168:171], a[64:67], v[104:107]
  s_waitcnt lgkmcnt(13)
  ds_read_b64_tr_b16 a[142:143], v41 offset:61440
  v_mfma_f32_16x16x32_bf16 v[112:115], a[176:179], a[64:67], v[112:115]
  s_waitcnt lgkmcnt(12)
  v_mfma_f32_16x16x32_bf16 v[112:115], a[180:183], a[68:71], v[112:115]
  v_mfma_f32_16x16x32_bf16 v[116:119], a[180:183], a[76:79], v[116:119]
  v_mfma_f32_16x16x32_bf16 v[116:119], a[176:179], a[72:75], v[116:119]
  v_mfma_f32_16x16x32_bf16 v[176:179], a[176:179], a[80:83], v[176:179]
  ds_read_b64_tr_b16 a[144:145], v42 offset:49152
  v_mfma_f32_16x16x32_bf16 v[176:179], a[180:183], a[84:87], v[176:179]
  ds_read_b64_tr_b16 a[146:147], v42 offset:53248
  v_mfma_f32_16x16x32_bf16 v[180:183], a[180:183], a[92:95], v[180:183]
  ds_read_b64_tr_b16 a[148:149], v42 offset:57344
  v_mfma_f32_16x16x32_bf16 v[180:183], a[176:179], a[88:91], v[180:183]
  s_waitcnt lgkmcnt(13)
  ds_read_b64_tr_b16 a[150:151], v42 offset:61440
  v_mfma_f32_16x16x32_bf16 v[188:191], a[184:187], a[88:91], v[188:191]
  s_waitcnt lgkmcnt(12)
  v_mfma_f32_16x16x32_bf16 v[188:191], a[188:191], a[92:95], v[188:191]
  v_mfma_f32_16x16x32_bf16 v[184:187], a[188:191], a[84:87], v[184:187]
  v_mfma_f32_16x16x32_bf16 v[184:187], a[184:187], a[80:83], v[184:187]
  v_mfma_f32_16x16x32_bf16 v[124:127], a[184:187], a[72:75], v[124:127]
  ds_read_b64_tr_b16 a[152:153], v43 offset:49152
  v_mfma_f32_16x16x32_bf16 v[124:127], a[188:191], a[76:79], v[124:127]
  ds_read_b64_tr_b16 a[154:155], v43 offset:53248
  v_mfma_f32_16x16x32_bf16 v[120:123], a[188:191], a[68:71], v[120:123]
  ds_read_b64_tr_b16 a[156:157], v43 offset:57344
  v_mfma_f32_16x16x32_bf16 v[120:123], a[184:187], a[64:67], v[120:123]
  s_waitcnt vmcnt(7) lgkmcnt(13)
  ds_read_b64_tr_b16 a[158:159], v43 offset:61440
  v_mfma_f32_16x16x32_bf16 v[96:99], a[128:131], a[96:99], v[96:99]
  s_waitcnt vmcnt(3) lgkmcnt(12)
  v_mfma_f32_16x16x32_bf16 v[96:99], a[132:135], a[100:103], v[96:99]
  s_waitcnt vmcnt(2)
  v_mfma_f32_16x16x32_bf16 v[100:103], a[132:135], a[108:111], v[100:103]
  v_mfma_f32_16x16x32_bf16 v[100:103], a[128:131], a[104:107], v[100:103]
  v_mfma_f32_16x16x32_bf16 v[160:163], a[128:131], a[112:115], v[160:163]
  s_waitcnt vmcnt(1)
  ds_read_b64_tr_b16 a[160:161], v28 offset:16384
  v_mfma_f32_16x16x32_bf16 v[160:163], a[132:135], a[116:119], v[160:163]
  s_waitcnt vmcnt(0)
  ds_read_b64_tr_b16 a[162:163], v28 offset:20480
  v_mfma_f32_16x16x32_bf16 v[164:167], a[132:135], a[124:127], v[164:167]
  ds_read_b64_tr_b16 a[164:165], v28 offset:24576
  v_mfma_f32_16x16x32_bf16 v[164:167], a[128:131], a[120:123], v[164:167]
  s_waitcnt lgkmcnt(13)
  ds_read_b64_tr_b16 a[166:167], v28 offset:28672
  v_mfma_f32_16x16x32_bf16 v[172:175], a[136:139], a[120:123], v[172:175]
  s_waitcnt lgkmcnt(12)
  v_cvt_pk_bf16_f32 v96, v96, v97
  v_cvt_pk_bf16_f32 v97, v98, v99
  v_mfma_f32_16x16x32_bf16 v[172:175], a[140:143], a[124:127], v[172:175]
  v_cvt_pk_bf16_f32 v98, v100, v101
  v_cvt_pk_bf16_f32 v99, v102, v103
  v_mfma_f32_16x16x32_bf16 v[168:171], a[140:143], a[116:119], v[168:171]
  ds_read_b64_tr_b16 a[168:169], v29 offset:16384
  v_mfma_f32_16x16x32_bf16 v[168:171], a[136:139], a[112:115], v[168:171]
  ds_read_b64_tr_b16 a[170:171], v29 offset:20480
  v_mfma_f32_16x16x32_bf16 v[108:111], a[136:139], a[104:107], v[108:111]
  v_cvt_pk_bf16_f32 v160, v160, v161
  v_cvt_pk_bf16_f32 v161, v162, v163
  v_mfma_f32_16x16x32_bf16 v[108:111], a[140:143], a[108:111], v[108:111]
  v_cvt_pk_bf16_f32 v162, v164, v165
  v_cvt_pk_bf16_f32 v163, v166, v167
  v_mfma_f32_16x16x32_bf16 v[104:107], a[140:143], a[100:103], v[104:107]
  s_xor_b32 s36, s8, 0x33000
  ds_read_b64_tr_b16 a[172:173], v29 offset:24576
  v_mfma_f32_16x16x32_bf16 v[104:107], a[136:139], a[96:99], v[104:107]
L_pad18:
  s_cbranch_execz L_hr2
  s_waitcnt lgkmcnt(13)
  ds_read_b64_tr_b16 a[174:175], v29 offset:28672
  buffer_store_dwordx4 v[160:163], v3, s[4:7], s36 offen offset:0 sc1
  v_mfma_f32_16x16x32_bf16 v[112:115], a[144:147], a[96:99], v[112:115]
  s_waitcnt lgkmcnt(12)
  v_cvt_pk_bf16_f32 v168, v168, v169
  v_cvt_pk_bf16_f32 v169, v170, v171
  v_mfma_f32_16x16x32_bf16 v[112:115], a[148:151], a[100:103], v[112:115]
  v_cvt_pk_bf16_f32 v170, v172, v173
  v_cvt_pk_bf16_f32 v171, v174, v175
  v_mfma_f32_16x16x32_bf16 v[116:119], a[148:151], a[108:111], v[116:119]
  ds_read_b64_tr_b16 a[176:177], v30 offset:16384
  buffer_store_dwordx4 v[168:171], v3, s[4:7], s36 offen offset:1024 sc1
  v_mfma_f32_16x16x32_bf16 v[116:119], a[144:147], a[104:107], v[116:119]
  ds_read_b64_tr_b16 a[178:179], v30 offset:20480
  v_mfma_f32_16x16x32_bf16 v[176:179], a[144:147], a[112:115], v[176:179]
  v_cvt_pk_bf16_f32 v104, v104, v105
  v_cvt_pk_bf16_f32 v105, v106, v107
  v_mfma_f32_16x16x32_bf16 v[176:179], a[148:151], a[116:119], v[176:179]
  v_cvt_pk_bf16_f32 v106, v108, v109
  v_cvt_pk_bf16_f32 v107, v110, v111
  v_mfma_f32_16x16x32_bf16 v[180:183], a[148:151], a[124:127], v[180:183]
  ds_read_b64_tr_b16 a[180:181], v30 offset:24576
  v_mfma_f32_16x16x32_bf16 v[180:183], a[144:147], a[120:123], v[180:183]
  s_waitcnt lgkmcnt(13)
  ds_read_b64_tr_b16 a[182:183], v30 offset:28672
  v_mfma_f32_16x16x32_bf16 v[188:191], a[152:155], a[120:123], v[188:191]
  s_waitcnt lgkmcnt(12)
  v_cvt_pk_bf16_f32 v112, v112, v113
  v_cvt_pk_bf16_f32 v113, v114, v115
  v_mfma_f32_16x16x32_bf16 v[188:191], a[156:159], a[124:127], v[188:191]
  v_cvt_pk_bf16_f32 v114, v116, v117
  v_cvt_pk_bf16_f32 v115, v118, v119
  v_mfma_f32_16x16x32_bf16 v[184:187], a[156:159], a[116:119], v[184:187]
  ds_read_b64_tr_b16 a[184:185], v31 offset:16384
  v_mfma_f32_16x16x32_bf16 v[184:187], a[152:155], a[112:115], v[184:187]
  ds_read_b64_tr_b16 a[186:187], v31 offset:20480
  v_mfma_f32_16x16x32_bf16 v[124:127], a[152:155], a[104:107], v[124:127]
  v_cvt_pk_bf16_f32 v176, v176, v177
  v_cvt_pk_bf16_f32 v177, v178, v179
  v_mfma_f32_16x16x32_bf16 v[124:127], a[156:159], a[108:111], v[124:127]
  v_cvt_pk_bf16_f32 v178, v180, v181
  v_cvt_pk_bf16_f32 v179, v182, v183
  v_mfma_f32_16x16x32_bf16 v[120:123], a[156:159], a[100:103], v[120:123]
  ds_read_b64_tr_b16 a[188:189], v31 offset:24576
  buffer_store_dwordx4 v[176:179], v3, s[4:7], s36 offen offset:2048 sc1
  v_mfma_f32_16x16x32_bf16 v[120:123], a[152:155], a[96:99], v[120:123]
  s_waitcnt lgkmcnt(13)
  ds_read_b64_tr_b16 a[190:191], v31 offset:28672
  v_mfma_f32_16x16x32_bf16 v[128:131], a[160:163], v[240:243], v[128:131]
  s_waitcnt lgkmcnt(12)
  v_cvt_pk_bf16_f32 v184, v184, v185
  v_cvt_pk_bf16_f32 v185, v186, v187
  v_mfma_f32_16x16x32_bf16 v[128:131], a[164:167], v[244:247], v[128:131]
  v_cvt_pk_bf16_f32 v186, v188, v189
  v_cvt_pk_bf16_f32 v187, v190, v191
  v_mfma_f32_16x16x32_bf16 v[132:135], a[164:167], v[252:255], v[132:135]
  ds_read_b64_tr_b16 a[128:129], v28 offset:32768
  buffer_store_dwordx4 v[184:187], v3, s[4:7], s36 offen offset:3072 sc1
  v_mfma_f32_16x16x32_bf16 v[132:135], a[160:163], v[248:251], v[132:135]
  s_waitcnt lgkmcnt(11)
  s_xor_b32 s36, s8, 0x11000
  ds_read_b64_tr_b16 a[130:131], v28 offset:36864
  v_mfma_f32_16x16x32_bf16 v[140:143], a[168:171], v[248:251], v[140:143]
  s_waitcnt lgkmcnt(10)
  v_cvt_pk_bf16_f32 v120, v120, v121
  v_cvt_pk_bf16_f32 v121, v122, v123
  v_mfma_f32_16x16x32_bf16 v[140:143], a[172:175], v[252:255], v[140:143]
  v_cvt_pk_bf16_f32 v122, v124, v125
  v_cvt_pk_bf16_f32 v123, v126, v127
  v_mfma_f32_16x16x32_bf16 v[136:139], a[172:175], v[244:247], v[136:139]
  ds_read_b64_tr_b16 a[132:133], v28 offset:40960
  buffer_store_dwordx4 v[96:99], v3, s[4:7], s36 offen offset:0 sc1
  v_mfma_f32_16x16x32_bf16 v[136:139], a[168:171], v[240:243], v[136:139]
  s_waitcnt lgkmcnt(9)
  ds_read_b64_tr_b16 a[134:135], v28 offset:45056
  v_mfma_f32_16x16x32_bf16 v[144:147], a[176:179], v[240:243], v[144:147]
  s_waitcnt lgkmcnt(8)
  ds_read_b64_tr_b16 a[136:137], v29 offset:32768
  buffer_store_dwordx4 v[104:107], v3, s[4:7], s36 offen offset:1024 sc1
  v_mfma_f32_16x16x32_bf16 v[144:147], a[180:183], v[244:247], v[144:147]
  ds_read_b64_tr_b16 a[138:139], v29 offset:36864
  v_mfma_f32_16x16x32_bf16 v[148:151], a[180:183], v[252:255], v[148:151]
  ds_read_b64_tr_b16 a[140:141], v29 offset:40960
  v_mfma_f32_16x16x32_bf16 v[148:151], a[176:179], v[248:251], v[148:151]
  s_waitcnt lgkmcnt(9)
  ds_read_b64_tr_b16 a[142:143], v29 offset:45056
  buffer_store_dwordx4 v[112:115], v3, s[4:7], s36 offen offset:2048 sc1
  v_mfma_f32_16x16x32_bf16 v[156:159], a[184:187], v[248:251], v[156:159]
  s_waitcnt lgkmcnt(8)
  ds_read_b64_tr_b16 a[144:145], v30 offset:32768
  v_mfma_f32_16x16x32_bf16 v[156:159], a[188:191], v[252:255], v[156:159]
  ds_read_b64_tr_b16 a[146:147], v30 offset:36864
  v_mfma_f32_16x16x32_bf16 v[152:155], a[188:191], v[244:247], v[152:155]
  ds_read_b64_tr_b16 a[148:149], v30 offset:40960
  buffer_store_dwordx4 v[120:123], v3, s[4:7], s36 offen offset:3072 sc1
  v_mfma_f32_16x16x32_bf16 v[152:155], a[184:187], v[240:243], v[152:155]
  s_waitcnt lgkmcnt(9)
  ds_read_b64_tr_b16 a[150:151], v30 offset:45056
  v_mfma_f32_16x16x32_bf16 v[128:131], a[128:131], a[208:211], v[128:131]
  s_waitcnt lgkmcnt(8)
  s_mov_b32 s13, 0x0
  ds_read_b64_tr_b16 a[152:153], v31 offset:32768
  v_mfma_f32_16x16x32_bf16 v[128:131], a[132:135], a[212:215], v[128:131]
  ds_read_b64_tr_b16 a[154:155], v31 offset:36864
  buffer_load_dwordx4 v[240:243], v47, s[52:55], s13 offen sc1
  v_mfma_f32_16x16x32_bf16 v[132:135], a[132:135], a[220:223], v[132:135]
  s_mov_b32 s13, 0x10000
  ds_read_b64_tr_b16 a[156:157], v31 offset:40960
  v_mfma_f32_16x16x32_bf16 v[132:135], a[128:131], a[216:219], v[132:135]
  s_waitcnt lgkmcnt(9)
  ds_read_b64_tr_b16 a[158:159], v31 offset:45056
  v_mfma_f32_16x16x32_bf16 v[140:143], a[136:139], a[216:219], v[140:143]
  s_waitcnt lgkmcnt(8)
  ds_read_b64_tr_b16 a[160:161], v28 offset:49152
  buffer_load_dwordx4 v[244:247], v47, s[52:55], s13 offen sc1
  v_mfma_f32_16x16x32_bf16 v[140:143], a[140:143], a[220:223], v[140:143]
  s_mov_b32 s13, 0x20000
  ds_read_b64_tr_b16 a[162:163], v28 offset:53248
  v_mfma_f32_16x16x32_bf16 v[136:139], a[140:143], a[212:215], v[136:139]
  ds_read_b64_tr_b16 a[164:165], v28 offset:57344
  v_mfma_f32_16x16x32_bf16 v[136:139], a[136:139], a[208:211], v[136:139]
  s_waitcnt lgkmcnt(9)
  ds_read_b64_tr_b16 a[166:167], v28 offset:61440
  buffer_load_dwordx4 v[248:251], v47, s[52:55], s13 offen sc1
  v_mfma_f32_16x16x32_bf16 v[144:147], a[144:147], a[208:211], v[144:147]
  s_waitcnt lgkmcnt(8)
  s_mov_b32 s13, 0x30000
  ds_read_b64_tr_b16 a[168:169], v29 offset:49152
  v_mfma_f32_16x16x32_bf16 v[144:147], a[148:151], a[212:215], v[144:147]
  ds_read_b64_tr_b16 a[170:171], v29 offset:53248
  v_mfma_f32_16x16x32_bf16 v[148:151], a[148:151], a[220:223], v[148:151]
  ds_read_b64_tr_b16 a[172:173], v29 offset:57344
  buffer_load_dwordx4 v[252:255], v47, s[52:55], s13 offen sc1
  v_mfma_f32_16x16x32_bf16 v[148:151], a[144:147], a[216:219], v[148:151]
  s_waitcnt lgkmcnt(9)
  ds_read_b64_tr_b16 a[174:175], v29 offset:61440
  v_mfma_f32_16x16x32_bf16 v[156:159], a[152:155], a[216:219], v[156:159]
  s_waitcnt lgkmcnt(8)
  ds_read_b64_tr_b16 a[176:177], v30 offset:49152
  v_mfma_f32_16x16x32_bf16 v[156:159], a[156:159], a[220:223], v[156:159]
  ds_read_b64_tr_b16 a[178:179], v30 offset:53248
  v_mfma_f32_16x16x32_bf16 v[152:155], a[156:159], a[212:215], v[152:155]
  ds_read_b64_tr_b16 a[180:181], v30 offset:57344
  v_mfma_f32_16x16x32_bf16 v[152:155], a[152:155], a[208:211], v[152:155]
  s_waitcnt lgkmcnt(9)
  ds_read_b64_tr_b16 a[182:183], v30 offset:61440
  v_mfma_f32_16x16x32_bf16 v[128:131], a[160:163], a[240:243], v[128:131]
  s_waitcnt lgkmcnt(8)
  ds_read_b64_tr_b16 a[184:185], v31 offset:49152
  v_mfma_f32_16x16x32_bf16 v[128:131], a[164:167], a[244:247], v[128:131]
  ds_read_b64_tr_b16 a[186:187], v31 offset:53248
  v_mfma_f32_16x16x32_bf16 v[132:135], a[164:167], a[252:255], v[132:135]
  ds_read_b64_tr_b16 a[188:189], v31 offset:57344
  v_mfma_f32_16x16x32_bf16 v[132:135], a[160:163], a[248:251], v[132:135]
  s_waitcnt lgkmcnt(9)
  ds_read_b64_tr_b16 a[190:191], v31 offset:61440
  v_mfma_f32_16x16x32_bf16 v[140:143], a[168:171], a[248:251], v[140:143]
  s_waitcnt lgkmcnt(8)
  ds_read_b64_tr_b16 a[128:129], v36 offset:0
  v_mfma_f32_16x16x32_bf16 v[140:143], a[172:175], a[252:255], v[140:143]
  ds_read_b64_tr_b16 a[130:131], v36 offset:4096
  v_mfma_f32_16x16x32_bf16 v[136:139], a[172:175], a[244:247], v[136:139]
  ds_read_b64_tr_b16 a[132:133], v36 offset:8192
  v_mfma_f32_16x16x32_bf16 v[136:139], a[168:171], a[240:243], v[136:139]
  s_waitcnt lgkmcnt(9)
  ds_read_b64_tr_b16 a[134:135], v36 offset:12288
  v_mfma_f32_16x16x32_bf16 v[144:147], a[176:179], a[240:243], v[144:147]
  s_waitcnt lgkmcnt(8)
  ds_read_b64_tr_b16 a[136:137], v37 offset:0
  v_mfma_f32_16x16x32_bf16 v[144:147], a[180:183], a[244:247], v[144:147]
  ds_read_b64_tr_b16 a[138:139], v37 offset:4096
  v_mfma_f32_16x16x32_bf16 v[148:151], a[180:183], a[252:255], v[148:151]
  ds_read_b64_tr_b16 a[140:141], v37 offset:8192
  v_mfma_f32_16x16x32_bf16 v[148:151], a[176:179], a[248:251], v[148:151]
  s_waitcnt lgkmcnt(9)
  ds_read_b64_tr_b16 a[142:143], v37 offset:12288
  v_mfma_f32_16x16x32_bf16 v[156:159], a[184:187], a[248:251], v[156:159]
  s_waitcnt lgkmcnt(8)
  ds_read_b64_tr_b16 a[144:145], v38 offset:0
  v_mfma_f32_16x16x32_bf16 v[156:159], a[188:191], a[252:255], v[156:159]
  ds_read_b64_tr_b16 a[146:147], v38 offset:4096
  v_mfma_f32_16x16x32_bf16 v[152:155], a[188:191], a[244:247], v[152:155]
  ds_read_b64_tr_b16 a[148:149], v38 offset:8192
  v_mfma_f32_16x16x32_bf16 v[152:155], a[184:187], a[240:243], v[152:155]
  s_waitcnt lgkmcnt(9)
  ds_read_b64_tr_b16 a[150:151], v38 offset:12288
  v_mfma_f32_16x16x32_bf16 v[128:131], a[128:131], a[16:19], v[128:131]
  s_waitcnt lgkmcnt(8)
  s_xor_b32 s3, s35, 0x1980
  ds_read_b64_tr_b16 a[152:153], v39 offset:0
  v_mfma_f32_16x16x32_bf16 v[128:131], a[132:135], a[20:23], v[128:131]
  s_waitcnt vmcnt(8)
  ds_read_b64_tr_b16 a[154:155], v39 offset:4096
  buffer_store_dword v9, v49, s[20:23], s3 offen sc1
  v_mfma_f32_16x16x32_bf16 v[132:135], a[132:135], a[28:31], v[132:135]
  ds_read_b64_tr_b16 a[156:157], v39 offset:8192
  v_mfma_f32_16x16x32_bf16 v[132:135], a[128:131], a[24:27], v[132:135]
  s_waitcnt lgkmcnt(9)
  ds_read_b64_tr_b16 a[158:159], v39 offset:12288
  v_mfma_f32_16x16x32_bf16 v[140:143], a[136:139], a[24:27], v[140:143]
  s_waitcnt lgkmcnt(8)
  ds_read_b64_tr_b16 a[160:161], v36 offset:16384
  v_mfma_f32_16x16x32_bf16 v[140:143], a[140:143], a[28:31], v[140:143]
  ds_read_b64_tr_b16 a[162:163], v36 offset:20480
  v_mfma_f32_16x16x32_bf16 v[136:139], a[140:143], a[20:23], v[136:139]
  ds_read_b64_tr_b16 a[164:165], v36 offset:24576
  v_mfma_f32_16x16x32_bf16 v[136:139], a[136:139], a[16:19], v[136:139]
  s_waitcnt lgkmcnt(9)
  ds_read_b64_tr_b16 a[166:167], v36 offset:28672
  v_mfma_f32_16x16x32_bf16 v[144:147], a[144:147], a[16:19], v[144:147]
  s_waitcnt lgkmcnt(8)
  ds_read_b64_tr_b16 a[168:169], v37 offset:16384
  v_mfma_f32_16x16x32_bf16 v[144:147], a[148:151], a[20:23], v[144:147]
  ds_read_b64_tr_b16 a[170:171], v37 offset:20480
  v_mfma_f32_16x16x32_bf16 v[148:151], a[148:151], a[28:31], v[148:151]
  ds_read_b64_tr_b16 a[172:173], v37 offset:24576
  v_mfma_f32_16x16x32_bf16 v[148:151], a[144:147], a[24:27], v[148:151]
  s_waitcnt lgkmcnt(9)
  ds_read_b64_tr_b16 a[174:175], v37 offset:28672
  v_mfma_f32_16x16x32_bf16 v[156:159], a[152:155], a[24:27], v[156:159]
  s_waitcnt lgkmcnt(8)
  ds_read_b64_tr_b16 a[176:177], v38 offset:16384
  v_mfma_f32_16x16x32_bf16 v[156:159], a[156:159], a[28:31], v[156:159]
  ds_read_b64_tr_b16 a[178:179], v38 offset:20480
  v_mfma_f32_16x16x32_bf16 v[152:155], a[156:159], a[20:23], v[152:155]
  ds_read_b64_tr_b16 a[180:181], v38 offset:24576
  v_mfma_f32_16x16x32_bf16 v[152:155], a[152:155], a[16:19], v[152:155]
  s_waitcnt lgkmcnt(9)
  ds_read_b64_tr_b16 a[182:183], v38 offset:28672
  v_mfma_f32_16x16x32_bf16 v[128:131], a[160:163], a[48:51], v[128:131]
  s_waitcnt lgkmcnt(8)
  ds_read_b64_tr_b16 a[184:185], v39 offset:16384
  v_mfma_f32_16x16x32_bf16 v[128:131], a[164:167], a[52:55], v[128:131]
  ds_read_b64_tr_b16 a[186:187], v39 offset:20480
  v_mfma_f32_16x16x32_bf16 v[132:135], a[164:167], a[60:63], v[132:135]
  ds_read_b64_tr_b16 a[188:189], v39 offset:24576
  v_sub_f32 v54, 1.0, v50
  v_mfma_f32_16x16x32_bf16 v[132:135], a[160:163], a[56:59], v[132:135]
  s_waitcnt lgkmcnt(9)
  ds_read_b64_tr_b16 a[190:191], v39 offset:28672
  v_lshlrev_b32 v14, 16, v208
  v_mfma_f32_16x16x32_bf16 v[140:143], a[168:171], a[56:59], v[140:143]
  s_waitcnt vmcnt(4) lgkmcnt(8)
  ds_read_b64_tr_b16 a[128:129], v36 offset:32768
  v_lshlrev_b32 v15, 16, v240
  v_mfma_f32_16x16x32_bf16 v[140:143], a[172:175], a[60:63], v[140:143]
  ds_read_b64_tr_b16 a[130:131], v36 offset:36864
  v_mul_f32 v160, v14, v15
  v_mfma_f32_16x16x32_bf16 v[136:139], a[172:175], a[52:55], v[136:139]
  ds_read_b64_tr_b16 a[132:133], v36 offset:40960
  v_mul_f32 v160, v160, v54
  v_mfma_f32_16x16x32_bf16 v[136:139], a[168:171], a[48:51], v[136:139]
  s_waitcnt lgkmcnt(9)
  ds_read_b64_tr_b16 a[134:135], v36 offset:45056
  v_and_b32 v14, s96, v208
  v_mfma_f32_16x16x32_bf16 v[144:147], a[176:179], a[48:51], v[144:147]
  s_waitcnt lgkmcnt(8)
  ds_read_b64_tr_b16 a[136:137], v37 offset:32768
  v_and_b32 v15, s96, v240
  v_mfma_f32_16x16x32_bf16 v[144:147], a[180:183], a[52:55], v[144:147]
  ds_read_b64_tr_b16 a[138:139], v37 offset:36864
  v_mul_f32 v161, v14, v15
  v_mfma_f32_16x16x32_bf16 v[148:151], a[180:183], a[60:63], v[148:151]
  ds_read_b64_tr_b16 a[140:141], v37 offset:40960
  v_mul_f32 v161, v161, v54
  v_mfma_f32_16x16x32_bf16 v[148:151], a[176:179], a[56:59], v[148:151]
  s_waitcnt lgkmcnt(9)
  ds_read_b64_tr_b16 a[142:143], v37 offset:45056
  v_lshlrev_b32 v14, 16, v209
  v_mfma_f32_16x16x32_bf16 v[156:159], a[184:187], a[56:59], v[156:159]
  s_waitcnt lgkmcnt(8)
  ds_read_b64_tr_b16 a[144:145], v38 offset:32768
  v_lshlrev_b32 v15, 16, v241
  v_mfma_f32_16x16x32_bf16 v[156:159], a[188:191], a[60:63], v[156:159]
  ds_read_b64_tr_b16 a[146:147], v38 offset:36864
  v_mul_f32 v162, v14, v15
  v_mfma_f32_16x16x32_bf16 v[152:155], a[188:191], a[52:55], v[152:155]
  ds_read_b64_tr_b16 a[148:149], v38 offset:40960
  v_mul_f32 v162, v162, v54
  v_mfma_f32_16x16x32_bf16 v[152:155], a[184:187], a[48:51], v[152:155]
  s_waitcnt lgkmcnt(9)
  ds_read_b64_tr_b16 a[150:151], v38 offset:45056
  v_and_b32 v14, s96, v209
  v_mfma_f32_16x16x32_bf16 v[128:131], a[128:131], a[80:83], v[128:131]
  s_waitcnt lgkmcnt(8)
  ds_read_b64_tr_b16 a[152:153], v39 offset:32768
  v_and_b32 v15, s96, v241
  v_mfma_f32_16x16x32_bf16 v[128:131], a[132:135], a[84:87], v[128:131]
  ds_read_b64_tr_b16 a[154:155], v39 offset:36864
  v_mul_f32 v163, v14, v15
  v_mfma_f32_16x16x32_bf16 v[132:135], a[132:135], a[92:95], v[132:135]
  ds_read_b64_tr_b16 a[156:157], v39 offset:40960
  v_mul_f32 v163, v163, v54
  v_mfma_f32_16x16x32_bf16 v[132:135], a[128:131], a[88:91], v[132:135]
  s_waitcnt lgkmcnt(9)
  ds_read_b64_tr_b16 a[158:159], v39 offset:45056
  v_lshlrev_b32 v14, 16, v210
  v_mfma_f32_16x16x32_bf16 v[140:143], a[136:139], a[88:91], v[140:143]
  s_waitcnt vmcnt(3) lgkmcnt(8)
  ds_read_b64_tr_b16 a[160:161], v36 offset:49152
  v_lshlrev_b32 v15, 16, v244
  v_mfma_f32_16x16x32_bf16 v[140:143], a[140:143], a[92:95], v[140:143]
  ds_read_b64_tr_b16 a[162:163], v36 offset:53248
  v_mul_f32 v168, v14, v15
  v_mfma_f32_16x16x32_bf16 v[136:139], a[140:143], a[84:87], v[136:139]
  ds_read_b64_tr_b16 a[164:165], v36 offset:57344
  v_mul_f32 v168, v168, v54
  v_mfma_f32_16x16x32_bf16 v[136:139], a[136:139], a[80:83], v[136:139]
  s_waitcnt lgkmcnt(9)
  ds_read_b64_tr_b16 a[166:167], v36 offset:61440
  v_and_b32 v14, s96, v210
  v_mfma_f32_16x16x32_bf16 v[144:147], a[144:147], a[80:83], v[144:147]
  s_waitcnt lgkmcnt(8)
  ds_read_b64_tr_b16 a[168:169], v37 offset:49152
  v_and_b32 v15, s96, v244
  v_mfma_f32_16x16x32_bf16 v[144:147], a[148:151], a[84:87], v[144:147]
  ds_read_b64_tr_b16 a[170:171], v37 offset:53248
  v_mul_f32 v169, v14, v15
  v_mfma_f32_16x16x32_bf16 v[148:151], a[148:151], a[92:95], v[148:151]
  ds_read_b64_tr_b16 a[172:173], v37 offset:57344
  v_mul_f32 v169, v169, v54
  v_mfma_f32_16x16x32_bf16 v[148:151], a[144:147], a[88:91], v[148:151]
  s_waitcnt lgkmcnt(9)
  ds_read_b64_tr_b16 a[174:175], v37 offset:61440
  v_lshlrev_b32 v14, 16, v211
  v_mfma_f32_16x16x32_bf16 v[156:159], a[152:155], a[88:91], v[156:159]
  s_waitcnt lgkmcnt(8)
  ds_read_b64_tr_b16 a[176:177], v38 offset:49152
  v_lshlrev_b32 v15, 16, v245
  v_mfma_f32_16x16x32_bf16 v[156:159], a[156:159], a[92:95], v[156:159]
  ds_read_b64_tr_b16 a[178:179], v38 offset:53248
  v_mul_f32 v170, v14, v15
  v_mfma_f32_16x16x32_bf16 v[152:155], a[156:159], a[84:87], v[152:155]
  ds_read_b64_tr_b16 a[180:181], v38 offset:57344
  v_mul_f32 v170, v170, v54
  v_mfma_f32_16x16x32_bf16 v[152:155], a[152:155], a[80:83], v[152:155]
  s_waitcnt lgkmcnt(9)
  ds_read_b64_tr_b16 a[182:183], v38 offset:61440
  v_and_b32 v14, s96, v211
  v_mfma_f32_16x16x32_bf16 v[128:131], a[160:163], a[112:115], v[128:131]
  s_waitcnt lgkmcnt(8)
  ds_read_b64_tr_b16 a[184:185], v39 offset:49152
  buffer_load_dword v10, v45, s[20:23], s35 offen offset:128 sc1
  v_mfma_f32_16x16x32_bf16 v[128:131], a[164:167], a[116:119], v[128:131]
  ds_read_b64_tr_b16 a[186:187], v39 offset:53248
  v_and_b32 v15, s96, v245
  v_mfma_f32_16x16x32_bf16 v[132:135], a[164:167], a[124:127], v[132:135]
  ds_read_b64_tr_b16 a[188:189], v39 offset:57344
  v_mul_f32 v171, v14, v15
  v_mfma_f32_16x16x32_bf16 v[132:135], a[160:163], a[120:123], v[132:135]
  s_waitcnt lgkmcnt(9)
  ds_read_b64_tr_b16 a[190:191], v39 offset:61440
  v_mul_f32 v171, v171, v54
  v_mfma_f32_16x16x32_bf16 v[140:143], a[168:171], a[120:123], v[140:143]
  s_waitcnt lgkmcnt(8)
  ds_read_b64_tr_b16 a[128:129], v28 offset:0
  v_lshlrev_b32 v14, 16, v212
  v_mfma_f32_16x16x32_bf16 v[140:143], a[172:175], a[124:127], v[140:143]
  s_waitcnt vmcnt(3)
  ds_read_b64_tr_b16 a[130:131], v28 offset:4096
  v_lshlrev_b32 v15, 16, v248
  v_mfma_f32_16x16x32_bf16 v[136:139], a[172:175], a[116:119], v[136:139]
  s_xor_b32 s3, s35, 0x880
  ds_read_b64_tr_b16 a[132:133], v28 offset:8192
  v_mul_f32 v176, v14, v15
  v_mfma_f32_16x16x32_bf16 v[136:139], a[168:171], a[112:115], v[136:139]
  s_waitcnt lgkmcnt(9)
  ds_read_b64_tr_b16 a[134:135], v28 offset:12288
  buffer_store_dword v9, v49, s[20:23], s3 offen sc1
  v_mfma_f32_16x16x32_bf16 v[144:147], a[176:179], a[112:115], v[144:147]
  s_waitcnt lgkmcnt(8)
  v_cvt_pk_bf16_f32 v128, v128, v129
  v_cvt_pk_bf16_f32 v129, v130, v131
  v_mfma_f32_16x16x32_bf16 v[144:147], a[180:183], a[116:119], v[144:147]
  v_cvt_pk_bf16_f32 v130, v132, v133
  v_cvt_pk_bf16_f32 v131, v134, v135
  v_mfma_f32_16x16x32_bf16 v[148:151], a[180:183], a[124:127], v[148:151]
  s_xor_b32 s36, s8, 0x22000
  ds_read_b64_tr_b16 a[136:137], v29 offset:0
  v_mul_f32 v176, v176, v54
  v_mfma_f32_16x16x32_bf16 v[148:151], a[176:179], a[120:123], v[148:151]
  s_waitcnt lgkmcnt(7)
  ds_read_b64_tr_b16 a[138:139], v29 offset:4096
  buffer_store_dwordx4 v[128:131], v3, s[4:7], s36 offen offset:0 sc1
  v_mfma_f32_16x16x32_bf16 v[156:159], a[184:187], a[120:123], v[156:159]
  s_waitcnt lgkmcnt(6)
  ds_read_b64_tr_b16 a[140:141], v29 offset:8192
  v_cvt_pk_bf16_f32 v136, v136, v137
  v_mfma_f32_16x16x32_bf16 v[156:159], a[188:191], a[124:127], v[156:159]
  ds_read_b64_tr_b16 a[142:143], v29 offset:12288
  v_cvt_pk_bf16_f32 v137, v138, v139
  v_mfma_f32_16x16x32_bf16 v[152:155], a[188:191], a[116:119], v[152:155]
  ds_read_b64_tr_b16 a[144:145], v30 offset:0
  v_cvt_pk_bf16_f32 v138, v140, v141
  v_mfma_f32_16x16x32_bf16 v[152:155], a[184:187], a[112:115], v[152:155]
  s_waitcnt lgkmcnt(7)
  ds_read_b64_tr_b16 a[146:147], v30 offset:4096
  v_cvt_pk_bf16_f32 v139, v142, v143
  v_mfma_f32_16x16x32_bf16 v[64:67], a[128:131], v[192:195], v[64:67]
  s_waitcnt lgkmcnt(6)
  ds_read_b64_tr_b16 a[148:149], v30 offset:8192
  v_cvt_pk_bf16_f32 v144, v144, v145
  v_mfma_f32_16x16x32_bf16 v[64:67], a[132:135], v[196:199], v[64:67]
  ds_read_b64_tr_b16 a[150:151], v30 offset:12288
  v_cvt_pk_bf16_f32 v145, v146, v147
  v_mfma_f32_16x16x32_bf16 v[68:71], a[132:135], v[204:207], v[68:71]
  ds_read_b64_tr_b16 a[152:153], v31 offset:0
  v_cvt_pk_bf16_f32 v146, v148, v149
  v_mfma_f32_16x16x32_bf16 v[68:71], a[128:131], v[200:203], v[68:71]
  s_waitcnt lgkmcnt(7)
  ds_read_b64_tr_b16 a[154:155], v31 offset:4096
  v_cvt_pk_bf16_f32 v147, v150, v151
  v_mfma_f32_16x16x32_bf16 v[76:79], a[136:139], v[200:203], v[76:79]
  s_waitcnt lgkmcnt(6)
  ds_read_b64_tr_b16 a[156:157], v31 offset:8192
  v_cvt_pk_bf16_f32 v152, v152, v153
  v_mfma_f32_16x16x32_bf16 v[76:79], a[140:143], v[204:207], v[76:79]
  ds_read_b64_tr_b16 a[158:159], v31 offset:12288
  v_cvt_pk_bf16_f32 v153, v154, v155
  v_mfma_f32_16x16x32_bf16 v[72:75], a[140:143], v[196:199], v[72:75]
  ds_read_b64_tr_b16 a[160:161], v28 offset:16384
  v_cvt_pk_bf16_f32 v154, v156, v157
  v_mfma_f32_16x16x32_bf16 v[72:75], a[136:139], v[192:195], v[72:75]
  s_waitcnt lgkmcnt(7)
  ds_read_b64_tr_b16 a[162:163], v28 offset:20480
  v_cvt_pk_bf16_f32 v155, v158, v159
  v_mfma_f32_16x16x32_bf16 v[80:83], a[144:147], v[192:195], v[80:83]
  s_waitcnt lgkmcnt(6)
  ds_read_b64_tr_b16 a[164:165], v28 offset:24576
  buffer_store_dwordx4 v[136:139], v3, s[4:7], s36 offen offset:1024 sc1
  v_mfma_f32_16x16x32_bf16 v[80:83], a[148:151], v[196:199], v[80:83]
  ds_read_b64_tr_b16 a[166:167], v28 offset:28672
  v_and_b32 v14, s96, v212
  v_mfma_f32_16x16x32_bf16 v[84:87], a[148:151], v[204:207], v[84:87]
  ds_read_b64_tr_b16 a[168:169], v29 offset:16384
  buffer_store_dwordx4 v[144:147], v3, s[4:7], s36 offen offset:2048 sc1
  v_mfma_f32_16x16x32_bf16 v[84:87], a[144:147], v[200:203], v[84:87]
  s_waitcnt lgkmcnt(7)
  ds_read_b64_tr_b16 a[170:171], v29 offset:20480
  v_and_b32 v15, s96, v248
  v_mfma_f32_16x16x32_bf16 v[92:95], a[152:155], v[200:203], v[92:95]
  s_waitcnt lgkmcnt(6)
  ds_read_b64_tr_b16 a[172:173], v29 offset:24576
  buffer_store_dwordx4 v[152:155], v3, s[4:7], s36 offen offset:3072 sc1
  v_mfma_f32_16x16x32_bf16 v[92:95], a[156:159], v[204:207], v[92:95]
  ds_read_b64_tr_b16 a[174:175], v29 offset:28672
  v_mul_f32 v177, v14, v15
  v_mfma_f32_16x16x32_bf16 v[88:91], a[156:159], v[196:199], v[88:91]
  ds_read_b64_tr_b16 a[176:177], v30 offset:16384
  v_mul_f32 v177, v177, v54
  v_mfma_f32_16x16x32_bf16 v[88:91], a[152:155], v[192:195], v[88:91]
  s_waitcnt lgkmcnt(7)
  ds_read_b64_tr_b16 a[178:179], v30 offset:20480
  v_lshlrev_b32 v14, 16, v213
  v_mfma_f32_16x16x32_bf16 v[64:67], a[160:163], v[224:227], v[64:67]
  s_waitcnt lgkmcnt(6)
  ds_read_b64_tr_b16 a[180:181], v30 offset:24576
  v_lshlrev_b32 v15, 16, v249
  v_mfma_f32_16x16x32_bf16 v[64:67], a[164:167], v[228:231], v[64:67]
  ds_read_b64_tr_b16 a[182:183], v30 offset:28672
  v_mul_f32 v178, v14, v15
  v_mfma_f32_16x16x32_bf16 v[68:71], a[164:167], v[236:239], v[68:71]
  ds_read_b64_tr_b16 a[184:185], v31 offset:16384
  v_mul_f32 v178, v178, v54
  v_mfma_f32_16x16x32_bf16 v[68:71], a[160:163], v[232:235], v[68:71]
  s_waitcnt lgkmcnt(7)
  ds_read_b64_tr_b16 a[186:187], v31 offset:20480
  v_and_b32 v14, s96, v213
  v_mfma_f32_16x16x32_bf16 v[76:79], a[168:171], v[232:235], v[76:79]
  s_waitcnt lgkmcnt(6)
  ds_read_b64_tr_b16 a[188:189], v31 offset:24576
  v_and_b32 v15, s96, v249
  v_mfma_f32_16x16x32_bf16 v[76:79], a[172:175], v[236:239], v[76:79]
  ds_read_b64_tr_b16 a[190:191], v31 offset:28672
  v_mul_f32 v179, v14, v15
  v_mfma_f32_16x16x32_bf16 v[72:75], a[172:175], v[228:231], v[72:75]
  ds_read_b64_tr_b16 a[128:129], v28 offset:32768
  v_mul_f32 v179, v179, v54
  v_mfma_f32_16x16x32_bf16 v[72:75], a[168:171], v[224:227], v[72:75]
  s_waitcnt lgkmcnt(7)
  ds_read_b64_tr_b16 a[130:131], v28 offset:36864
  v_lshlrev_b32 v14, 16, v214
  v_mfma_f32_16x16x32_bf16 v[80:83], a[176:179], v[224:227], v[80:83]
  s_waitcnt vmcnt(7) lgkmcnt(6)
  ds_read_b64_tr_b16 a[132:133], v28 offset:40960
  v_lshlrev_b32 v15, 16, v252
  v_mfma_f32_16x16x32_bf16 v[80:83], a[180:183], v[228:231], v[80:83]
  ds_read_b64_tr_b16 a[134:135], v28 offset:45056
  v_mul_f32 v184, v14, v15
  v_mfma_f32_16x16x32_bf16 v[84:87], a[180:183], v[236:239], v[84:87]
  ds_read_b64_tr_b16 a[136:137], v29 offset:32768
  v_mul_f32 v184, v184, v54
  v_mfma_f32_16x16x32_bf16 v[84:87], a[176:179], v[232:235], v[84:87]
  s_waitcnt lgkmcnt(7)
  ds_read_b64_tr_b16 a[138:139], v29 offset:36864
  v_and_b32 v14, s96, v214
  v_mfma_f32_16x16x32_bf16 v[92:95], a[184:187], v[232:235], v[92:95]
  s_waitcnt vmcnt(5) lgkmcnt(6)
  s_add_u32 s10, s8, 12288
  ds_read_b64_tr_b16 a[140:141], v29 offset:40960
  v_cmp_eq_u32 vcc, 1, v10
  v_mfma_f32_16x16x32_bf16 v[92:95], a[188:191], v[236:239], v[92:95]
  ds_read_b64_tr_b16 a[142:143], v29 offset:45056
  v_and_b32 v15, s96, v252
  v_mfma_f32_16x16x32_bf16 v[88:91], a[188:191], v[228:231], v[88:91]
  s_and_b32 s11, vcc_lo, 4
  s_cselect_b32 s10, s10, 0x1000000
  ds_read_b64_tr_b16 a[144:145], v30 offset:32768
  v_mfma_f32_16x16x32_bf16 v[88:91], a[184:187], v[224:227], v[88:91]
  s_waitcnt lgkmcnt(7)
  s_andn2_b32 s9, s9, s11
  ds_read_b64_tr_b16 a[146:147], v30 offset:36864
  v_mul_f32 v185, v14, v15
  v_mfma_f32_16x16x32_bf16 v[64:67], a[128:131], a[192:195], v[64:67]
  s_waitcnt lgkmcnt(6)
  ds_read_b64_tr_b16 a[148:149], v30 offset:40960
  buffer_load_dword v10, v45, s[20:23], s35 offen offset:128 sc1
  v_mfma_f32_16x16x32_bf16 v[64:67], a[132:135], a[196:199], v[64:67]
  ds_read_b64_tr_b16 a[150:151], v30 offset:45056
  v_mul_f32 v185, v185, v54
  v_mfma_f32_16x16x32_bf16 v[68:71], a[132:135], a[204:207], v[68:71]
  ds_read_b64_tr_b16 a[152:153], v31 offset:32768
  buffer_load_dwordx4 v[96:99], v3, s[4:7], s10 offen offset:0 sc1
  v_mfma_f32_16x16x32_bf16 v[68:71], a[128:131], a[200:203], v[68:71]
  s_waitcnt lgkmcnt(7)
  ds_read_b64_tr_b16 a[154:155], v31 offset:36864
  v_lshlrev_b32 v14, 16, v215
  v_mfma_f32_16x16x32_bf16 v[76:79], a[136:139], a[200:203], v[76:79]
  s_waitcnt lgkmcnt(6)
  ds_read_b64_tr_b16 a[156:157], v31 offset:40960
  buffer_load_dwordx4 v[100:103], v3, s[4:7], s10 offen offset:1024 sc1
  v_mfma_f32_16x16x32_bf16 v[76:79], a[140:143], a[204:207], v[76:79]
  ds_read_b64_tr_b16 a[158:159], v31 offset:45056
  v_lshlrev_b32 v15, 16, v253
  v_mfma_f32_16x16x32_bf16 v[72:75], a[140:143], a[196:199], v[72:75]
  ds_read_b64_tr_b16 a[160:161], v28 offset:49152
  v_mul_f32 v186, v14, v15
  v_mfma_f32_16x16x32_bf16 v[72:75], a[136:139], a[192:195], v[72:75]
  s_waitcnt lgkmcnt(7)
  ds_read_b64_tr_b16 a[162:163], v28 offset:53248
  buffer_load_dwordx4 v[104:107], v3, s[4:7], s10 offen offset:2048 sc1
  v_mfma_f32_16x16x32_bf16 v[80:83], a[144:147], a[192:195], v[80:83]
  s_waitcnt lgkmcnt(6)
  ds_read_b64_tr_b16 a[164:165], v28 offset:57344
  v_mul_f32 v186, v186, v54
  v_mfma_f32_16x16x32_bf16 v[80:83], a[148:151], a[196:199], v[80:83]
  ds_read_b64_tr_b16 a[166:167], v28 offset:61440
  v_and_b32 v14, s96, v215
  v_mfma_f32_16x16x32_bf16 v[84:87], a[148:151], a[204:207], v[84:87]
  ds_read_b64_tr_b16 a[168:169], v29 offset:49152
  buffer_load_dwordx4 v[108:111], v3, s[4:7], s10 offen offset:3072 sc1
  v_mfma_f32_16x16x32_bf16 v[84:87], a[144:147], a[200:203], v[84:87]
  s_waitcnt lgkmcnt(7)
  ds_read_b64_tr_b16 a[170:171], v29 offset:53248
  v_and_b32 v15, s96, v253
  v_mfma_f32_16x16x32_bf16 v[92:95], a[152:155], a[200:203], v[92:95]
  s_waitcnt lgkmcnt(6)
  ds_read_b64_tr_b16 a[172:173], v29 offset:57344
  v_mul_f32 v187, v14, v15
  v_mfma_f32_16x16x32_bf16 v[92:95], a[156:159], a[204:207], v[92:95]
  ds_read_b64_tr_b16 a[174:175], v29 offset:61440
  v_mul_f32 v187, v187, v54
  v_mfma_f32_16x16x32_bf16 v[88:91], a[156:159], a[196:199], v[88:91]
  ds_read_b64_tr_b16 a[176:177], v30 offset:49152
  v_sub_f32 v55, 1.0, v51
  v_mfma_f32_16x16x32_bf16 v[88:91], a[152:155], a[192:195], v[88:91]
  s_waitcnt lgkmcnt(7)
  ds_read_b64_tr_b16 a[178:179], v30 offset:53248
  v_lshlrev_b32 v14, 16, v216
  v_mfma_f32_16x16x32_bf16 v[64:67], a[160:163], a[224:227], v[64:67]
  s_waitcnt lgkmcnt(6)
  ds_read_b64_tr_b16 a[180:181], v30 offset:57344
  v_lshlrev_b32 v15, 16, v242
  v_mfma_f32_16x16x32_bf16 v[64:67], a[164:167], a[228:231], v[64:67]
  ds_read_b64_tr_b16 a[182:183], v30 offset:61440
  v_mul_f32 v164, v14, v15
  v_mfma_f32_16x16x32_bf16 v[68:71], a[164:167], a[236:239], v[68:71]
  ds_read_b64_tr_b16 a[184:185], v31 offset:49152
  v_mul_f32 v164, v164, v55
  v_mfma_f32_16x16x32_bf16 v[68:71], a[160:163], a[232:235], v[68:71]
  s_waitcnt lgkmcnt(7)
  ds_read_b64_tr_b16 a[186:187], v31 offset:53248
  v_and_b32 v14, s96, v216
  v_mfma_f32_16x16x32_bf16 v[76:79], a[168:171], a[232:235], v[76:79]
  s_waitcnt lgkmcnt(6)
  s_xor_b32 s3, s35, 0x1100
  ds_read_b64_tr_b16 a[188:189], v31 offset:57344
  v_and_b32 v15, s96, v242
  v_mfma_f32_16x16x32_bf16 v[76:79], a[172:175], a[236:239], v[76:79]
  s_waitcnt vmcnt(5)
  ds_read_b64_tr_b16 a[190:191], v31 offset:61440
  buffer_store_dword v9, v49, s[20:23], s3 offen sc1
  v_mfma_f32_16x16x32_bf16 v[72:75], a[172:175], a[228:231], v[72:75]
L_pad19:
  s_cbranch_execz L_hr2
  ds_read_b64_tr_b16 a[128:129], v36 offset:0
  v_mul_f32 v165, v14, v15
  v_mfma_f32_16x16x32_bf16 v[72:75], a[168:171], a[224:227], v[72:75]
  s_waitcnt lgkmcnt(7)
  ds_read_b64_tr_b16 a[130:131], v36 offset:4096
  v_mul_f32 v165, v165, v55
  v_mfma_f32_16x16x32_bf16 v[80:83], a[176:179], a[224:227], v[80:83]
  s_waitcnt lgkmcnt(6)
  ds_read_b64_tr_b16 a[132:133], v36 offset:8192
  v_lshlrev_b32 v14, 16, v217
  v_mfma_f32_16x16x32_bf16 v[80:83], a[180:183], a[228:231], v[80:83]
  ds_read_b64_tr_b16 a[134:135], v36 offset:12288
  v_lshlrev_b32 v15, 16, v243
  v_mfma_f32_16x16x32_bf16 v[84:87], a[180:183], a[236:239], v[84:87]
  ds_read_b64_tr_b16 a[136:137], v37 offset:0
  v_mul_f32 v166, v14, v15
  v_mfma_f32_16x16x32_bf16 v[84:87], a[176:179], a[232:235], v[84:87]
  s_waitcnt lgkmcnt(7)
  ds_read_b64_tr_b16 a[138:139], v37 offset:4096
  v_mul_f32 v166, v166, v55
  v_mfma_f32_16x16x32_bf16 v[92:95], a[184:187], a[232:235], v[92:95]
  s_waitcnt lgkmcnt(6)
  ds_read_b64_tr_b16 a[140:141], v37 offset:8192
  v_and_b32 v14, s96, v217
  v_mfma_f32_16x16x32_bf16 v[92:95], a[188:191], a[236:239], v[92:95]
  ds_read_b64_tr_b16 a[142:143], v37 offset:12288
  v_and_b32 v15, s96, v243
  v_mfma_f32_16x16x32_bf16 v[88:91], a[188:191], a[228:231], v[88:91]
  ds_read_b64_tr_b16 a[144:145], v38 offset:0
  v_mul_f32 v167, v14, v15
  v_mfma_f32_16x16x32_bf16 v[88:91], a[184:187], a[224:227], v[88:91]
  s_waitcnt lgkmcnt(7)
  ds_read_b64_tr_b16 a[146:147], v38 offset:4096
  v_mul_f32 v167, v167, v55
  v_mfma_f32_16x16x32_bf16 v[64:67], a[128:131], a[0:3], v[64:67]
  s_waitcnt lgkmcnt(6)
  ds_read_b64_tr_b16 a[148:149], v38 offset:8192
  v_lshlrev_b32 v14, 16, v218
  v_mfma_f32_16x16x32_bf16 v[64:67], a[132:135], a[4:7], v[64:67]
  ds_read_b64_tr_b16 a[150:151], v38 offset:12288
  v_lshlrev_b32 v15, 16, v246
  v_mfma_f32_16x16x32_bf16 v[68:71], a[132:135], a[12:15], v[68:71]
  ds_read_b64_tr_b16 a[152:153], v39 offset:0
  v_mul_f32 v172, v14, v15
  v_mfma_f32_16x16x32_bf16 v[68:71], a[128:131], a[8:11], v[68:71]
  s_waitcnt lgkmcnt(7)
  ds_read_b64_tr_b16 a[154:155], v39 offset:4096
  v_mul_f32 v172, v172, v55
  v_mfma_f32_16x16x32_bf16 v[76:79], a[136:139], a[8:11], v[76:79]
  s_waitcnt vmcnt(5) lgkmcnt(6)
  s_add_u32 s10, s8, 4096
  ds_read_b64_tr_b16 a[156:157], v39 offset:8192
  v_cmp_eq_u32 vcc, 1, v10
  v_mfma_f32_16x16x32_bf16 v[76:79], a[140:143], a[12:15], v[76:79]
  ds_read_b64_tr_b16 a[158:159], v39 offset:12288
  v_and_b32 v14, s96, v218
  v_mfma_f32_16x16x32_bf16 v[72:75], a[140:143], a[4:7], v[72:75]
  s_and_b32 s11, vcc_lo, 1
  s_cselect_b32 s10, s10, 0x1000000
  ds_read_b64_tr_b16 a[160:161], v36 offset:16384
  v_mfma_f32_16x16x32_bf16 v[72:75], a[136:139], a[0:3], v[72:75]
  s_waitcnt lgkmcnt(7)
  s_andn2_b32 s9, s9, s11
  ds_read_b64_tr_b16 a[162:163], v36 offset:20480
  v_and_b32 v15, s96, v246
  v_mfma_f32_16x16x32_bf16 v[80:83], a[144:147], a[0:3], v[80:83]
  s_waitcnt lgkmcnt(6)
  ds_read_b64_tr_b16 a[164:165], v36 offset:24576
  v_mul_f32 v173, v14, v15
  v_mfma_f32_16x16x32_bf16 v[80:83], a[148:151], a[4:7], v[80:83]
  ds_read_b64_tr_b16 a[166:167], v36 offset:28672
  buffer_load_dwordx4 v[112:115], v3, s[4:7], s10 offen offset:0 sc1
  v_mfma_f32_16x16x32_bf16 v[84:87], a[148:151], a[12:15], v[84:87]
  ds_read_b64_tr_b16 a[168:169], v37 offset:16384
  v_mul_f32 v173, v173, v55
  v_mfma_f32_16x16x32_bf16 v[84:87], a[144:147], a[8:11], v[84:87]
  s_waitcnt lgkmcnt(7)
  ds_read_b64_tr_b16 a[170:171], v37 offset:20480
  v_lshlrev_b32 v14, 16, v219
  v_mfma_f32_16x16x32_bf16 v[92:95], a[152:155], a[8:11], v[92:95]
  s_waitcnt lgkmcnt(6)
  ds_read_b64_tr_b16 a[172:173], v37 offset:24576
  buffer_load_dwordx4 v[116:119], v3, s[4:7], s10 offen offset:1024 sc1
  v_mfma_f32_16x16x32_bf16 v[92:95], a[156:159], a[12:15], v[92:95]
  ds_read_b64_tr_b16 a[174:175], v37 offset:28672
  v_lshlrev_b32 v15, 16, v247
  v_mfma_f32_16x16x32_bf16 v[88:91], a[156:159], a[4:7], v[88:91]
  ds_read_b64_tr_b16 a[176:177], v38 offset:16384
  v_mul_f32 v174, v14, v15
  v_mfma_f32_16x16x32_bf16 v[88:91], a[152:155], a[0:3], v[88:91]
  s_waitcnt lgkmcnt(7)
  ds_read_b64_tr_b16 a[178:179], v38 offset:20480
  buffer_load_dwordx4 v[120:123], v3, s[4:7], s10 offen offset:2048 sc1
  v_mfma_f32_16x16x32_bf16 v[64:67], a[160:163], a[32:35], v[64:67]
  s_waitcnt lgkmcnt(6)
  ds_read_b64_tr_b16 a[180:181], v38 offset:24576
  v_mul_f32 v174, v174, v55
  v_mfma_f32_16x16x32_bf16 v[64:67], a[164:167], a[36:39], v[64:67]
  ds_read_b64_tr_b16 a[182:183], v38 offset:28672
  v_and_b32 v14, s96, v219
  v_mfma_f32_16x16x32_bf16 v[68:71], a[164:167], a[44:47], v[68:71]
  ds_read_b64_tr_b16 a[184:185], v39 offset:16384
  buffer_load_dwordx4 v[124:127], v3, s[4:7], s10 offen offset:3072 sc1
  v_mfma_f32_16x16x32_bf16 v[68:71], a[160:163], a[40:43], v[68:71]
  s_waitcnt lgkmcnt(7)
  ds_read_b64_tr_b16 a[186:187], v39 offset:20480
  v_and_b32 v15, s96, v247
  v_mfma_f32_16x16x32_bf16 v[76:79], a[168:171], a[40:43], v[76:79]
  s_waitcnt lgkmcnt(6)
  ds_read_b64_tr_b16 a[188:189], v39 offset:24576
  v_mul_f32 v175, v14, v15
  v_mfma_f32_16x16x32_bf16 v[76:79], a[172:175], a[44:47], v[76:79]
  ds_read_b64_tr_b16 a[190:191], v39 offset:28672
  buffer_load_dword v10, v45, s[20:23], s35 offen offset:128 sc1
  v_mfma_f32_16x16x32_bf16 v[72:75], a[172:175], a[36:39], v[72:75]
  ds_read_b64_tr_b16 a[128:129], v36 offset:32768
  v_mul_f32 v175, v175, v55
  v_mfma_f32_16x16x32_bf16 v[72:75], a[168:171], a[32:35], v[72:75]
  s_waitcnt lgkmcnt(7)
  ds_read_b64_tr_b16 a[130:131], v36 offset:36864
  v_lshlrev_b32 v14, 16, v220
  v_mfma_f32_16x16x32_bf16 v[80:83], a[176:179], a[32:35], v[80:83]
  s_waitcnt lgkmcnt(6)
  ds_read_b64_tr_b16 a[132:133], v36 offset:40960
  v_lshlrev_b32 v15, 16, v250
  v_mfma_f32_16x16x32_bf16 v[80:83], a[180:183], a[36:39], v[80:83]
  ds_read_b64_tr_b16 a[134:135], v36 offset:45056
  v_mul_f32 v180, v14, v15
  v_mfma_f32_16x16x32_bf16 v[84:87], a[180:183], a[44:47], v[84:87]
  ds_read_b64_tr_b16 a[136:137], v37 offset:32768
  v_mul_f32 v180, v180, v55
  v_mfma_f32_16x16x32_bf16 v[84:87], a[176:179], a[40:43], v[84:87]
  s_waitcnt lgkmcnt(7)
  ds_read_b64_tr_b16 a[138:139], v37 offset:36864
  v_and_b32 v14, s96, v220
  v_mfma_f32_16x16x32_bf16 v[92:95], a[184:187], a[40:43], v[92:95]
  s_waitcnt lgkmcnt(6)
  ds_read_b64_tr_b16 a[140:141], v37 offset:40960
  v_and_b32 v15, s96, v250
  v_mfma_f32_16x16x32_bf16 v[92:95], a[188:191], a[44:47], v[92:95]
  ds_read_b64_tr_b16 a[142:143], v37 offset:45056
  v_mul_f32 v181, v14, v15
  v_mfma_f32_16x16x32_bf16 v[88:91], a[188:191], a[36:39], v[88:91]
  ds_read_b64_tr_b16 a[144:145], v38 offset:32768
  v_mul_f32 v181, v181, v55
  v_mfma_f32_16x16x32_bf16 v[88:91], a[184:187], a[32:35], v[88:91]
  s_waitcnt lgkmcnt(7)
  ds_read_b64_tr_b16 a[146:147], v38 offset:36864
  v_lshlrev_b32 v14, 16, v221
  v_mfma_f32_16x16x32_bf16 v[64:67], a[128:131], a[64:67], v[64:67]
  s_waitcnt lgkmcnt(6)
  ds_read_b64_tr_b16 a[148:149], v38 offset:40960
  v_lshlrev_b32 v15, 16, v251
  v_mfma_f32_16x16x32_bf16 v[64:67], a[132:135], a[68:71], v[64:67]
  ds_read_b64_tr_b16 a[150:151], v38 offset:45056
  v_mul_f32 v182, v14, v15
  v_mfma_f32_16x16x32_bf16 v[68:71], a[132:135], a[76:79], v[68:71]
  ds_read_b64_tr_b16 a[152:153], v39 offset:32768
  v_mul_f32 v182, v182, v55
  v_mfma_f32_16x16x32_bf16 v[68:71], a[128:131], a[72:75], v[68:71]
  s_waitcnt lgkmcnt(7)
  ds_read_b64_tr_b16 a[154:155], v39 offset:36864
  v_and_b32 v14, s96, v221
  v_mfma_f32_16x16x32_bf16 v[76:79], a[136:139], a[72:75], v[76:79]
  s_waitcnt lgkmcnt(6)
  ds_read_b64_tr_b16 a[156:157], v39 offset:40960
  v_and_b32 v15, s96, v251
  v_mfma_f32_16x16x32_bf16 v[76:79], a[140:143], a[76:79], v[76:79]
  ds_read_b64_tr_b16 a[158:159], v39 offset:45056
  v_mul_f32 v183, v14, v15
  v_mfma_f32_16x16x32_bf16 v[72:75], a[140:143], a[68:71], v[72:75]
  ds_read_b64_tr_b16 a[160:161], v36 offset:49152
  v_mul_f32 v183, v183, v55
  v_mfma_f32_16x16x32_bf16 v[72:75], a[136:139], a[64:67], v[72:75]
  s_waitcnt lgkmcnt(7)
  ds_read_b64_tr_b16 a[162:163], v36 offset:53248
  v_lshlrev_b32 v14, 16, v222
  v_mfma_f32_16x16x32_bf16 v[80:83], a[144:147], a[64:67], v[80:83]
  s_waitcnt lgkmcnt(6)
  ds_read_b64_tr_b16 a[164:165], v36 offset:57344
  v_lshlrev_b32 v15, 16, v254
  v_mfma_f32_16x16x32_bf16 v[80:83], a[148:151], a[68:71], v[80:83]
  ds_read_b64_tr_b16 a[166:167], v36 offset:61440
  v_mul_f32 v188, v14, v15
  v_mfma_f32_16x16x32_bf16 v[84:87], a[148:151], a[76:79], v[84:87]
  ds_read_b64_tr_b16 a[168:169], v37 offset:49152
  v_mul_f32 v188, v188, v55
  v_mfma_f32_16x16x32_bf16 v[84:87], a[144:147], a[72:75], v[84:87]
  s_waitcnt lgkmcnt(7)
  ds_read_b64_tr_b16 a[170:171], v37 offset:53248
  v_and_b32 v14, s96, v222
  v_mfma_f32_16x16x32_bf16 v[92:95], a[152:155], a[72:75], v[92:95]
  s_waitcnt lgkmcnt(6)
  ds_read_b64_tr_b16 a[172:173], v37 offset:57344
  v_and_b32 v15, s96, v254
  v_mfma_f32_16x16x32_bf16 v[92:95], a[156:159], a[76:79], v[92:95]
  ds_read_b64_tr_b16 a[174:175], v37 offset:61440
  v_mul_f32 v189, v14, v15
  v_mfma_f32_16x16x32_bf16 v[88:91], a[156:159], a[68:71], v[88:91]
  ds_read_b64_tr_b16 a[176:177], v38 offset:49152
  v_mul_f32 v189, v189, v55
  v_mfma_f32_16x16x32_bf16 v[88:91], a[152:155], a[64:67], v[88:91]
  s_waitcnt lgkmcnt(7)
  ds_read_b64_tr_b16 a[178:179], v38 offset:53248
  v_lshlrev_b32 v14, 16, v223
  v_mfma_f32_16x16x32_bf16 v[64:67], a[160:163], a[96:99], v[64:67]
  s_waitcnt lgkmcnt(6)
  ds_read_b64_tr_b16 a[180:181], v38 offset:57344
  v_lshlrev_b32 v15, 16, v255
  v_mfma_f32_16x16x32_bf16 v[64:67], a[164:167], a[100:103], v[64:67]
  ds_read_b64_tr_b16 a[182:183], v38 offset:61440
  v_mul_f32 v190, v14, v15
  v_mfma_f32_16x16x32_bf16 v[68:71], a[164:167], a[108:111], v[68:71]
  ds_read_b64_tr_b16 a[184:185], v39 offset:49152
  v_mul_f32 v190, v190, v55
  v_mfma_f32_16x16x32_bf16 v[68:71], a[160:163], a[104:107], v[68:71]
  s_waitcnt lgkmcnt(7)
  ds_read_b64_tr_b16 a[186:187], v39 offset:53248
  v_and_b32 v14, s96, v223
  v_mfma_f32_16x16x32_bf16 v[76:79], a[168:171], a[104:107], v[76:79]
  s_waitcnt lgkmcnt(6)
  ds_read_b64_tr_b16 a[188:189], v39 offset:57344
  v_and_b32 v15, s96, v255
  v_mfma_f32_16x16x32_bf16 v[76:79], a[172:175], a[108:111], v[76:79]
  ds_read_b64_tr_b16 a[190:191], v39 offset:61440
  v_mul_f32 v191, v14, v15
  v_mfma_f32_16x16x32_bf16 v[72:75], a[172:175], a[100:103], v[72:75]
  v_mul_f32 v191, v191, v55
  v_mfma_f32_16x16x32_bf16 v[72:75], a[168:171], a[96:99], v[72:75]
  s_waitcnt lgkmcnt(6)
  v_mfma_f32_16x16x32_bf16 v[80:83], a[176:179], a[96:99], v[80:83]
  s_waitcnt lgkmcnt(4)
  v_mfma_f32_16x16x32_bf16 v[80:83], a[180:183], a[100:103], v[80:83]
  v_mfma_f32_16x16x32_bf16 v[84:87], a[180:183], a[108:111], v[84:87]
  s_waitcnt vmcnt(0)
  s_add_u32 s10, s8, 8192
  v_cmp_eq_u32 vcc, 1, v10
  v_mfma_f32_16x16x32_bf16 v[84:87], a[176:179], a[104:107], v[84:87]
  s_waitcnt lgkmcnt(2)
  v_mfma_f32_16x16x32_bf16 v[92:95], a[184:187], a[104:107], v[92:95]
  s_waitcnt lgkmcnt(0)
  s_and_b32 s11, vcc_lo, 2
  s_cselect_b32 s10, s10, 0x1000000
  v_mfma_f32_16x16x32_bf16 v[92:95], a[188:191], a[108:111], v[92:95]
  s_andn2_b32 s9, s9, s11
  v_mfma_f32_16x16x32_bf16 v[88:91], a[188:191], a[100:103], v[88:91]
  v_mfma_f32_16x16x32_bf16 v[88:91], a[184:187], a[96:99], v[88:91]
  buffer_load_dwordx4 v[128:131], v3, s[4:7], s10 offen offset:0 sc1
  buffer_load_dwordx4 v[132:135], v3, s[4:7], s10 offen offset:1024 sc1
  buffer_load_dwordx4 v[136:139], v3, s[4:7], s10 offen offset:2048 sc1
  buffer_load_dwordx4 v[140:143], v3, s[4:7], s10 offen offset:3072 sc1
  s_mov_b32 s0, 0
  s_mov_b32 s1, s9
  s_cmp_eq_u32 s9, 0
  s_cbranch_scc1 L_ex_done
  buffer_load_dword v10, v45, s[20:23], s35 offen offset:128 sc1
  s_waitcnt vmcnt(0)
L_ex_loop:
  v_cmp_eq_u32 vcc, 1, v10
  s_nop 2
  s_and_b32 s3, vcc_lo, s1
  s_cmp_ge_u32 s0, 0x200000
  s_cselect_b32 s3, s1, s3
  s_andn2_b32 s1, s1, s3
  s_bitcmp0_b32 s3, 2
  s_cbranch_scc1 L_ex_skip3
  s_add_u32 s36, s8, 12288
  buffer_load_dwordx4 v[96:99], v3, s[4:7], s36 offen offset:0 sc1
  buffer_load_dwordx4 v[100:103], v3, s[4:7], s36 offen offset:1024 sc1
  buffer_load_dwordx4 v[104:107], v3, s[4:7], s36 offen offset:2048 sc1
  buffer_load_dwordx4 v[108:111], v3, s[4:7], s36 offen offset:3072 sc1
L_ex_skip3:
  s_bitcmp0_b32 s3, 0
  s_cbranch_scc1 L_ex_skip1
  s_add_u32 s36, s8, 4096
  buffer_load_dwordx4 v[112:115], v3, s[4:7], s36 offen offset:0 sc1
  buffer_load_dwordx4 v[116:119], v3, s[4:7], s36 offen offset:1024 sc1
  buffer_load_dwordx4 v[120:123], v3, s[4:7], s36 offen offset:2048 sc1
  buffer_load_dwordx4 v[124:127], v3, s[4:7], s36 offen offset:3072 sc1
L_ex_skip1:
  s_bitcmp0_b32 s3, 1
  s_cbranch_scc1 L_ex_skip2
  s_add_u32 s36, s8, 8192
  buffer_load_dwordx4 v[128:131], v3, s[4:7], s36 offen offset:0 sc1
  buffer_load_dwordx4 v[132:135], v3, s[4:7], s36 offen offset:1024 sc1
  buffer_load_dwordx4 v[136:139], v3, s[4:7], s36 offen offset:2048 sc1
  buffer_load_dwordx4 v[140:143], v3, s[4:7], s36 offen offset:3072 sc1
L_ex_skip2:
  s_cmp_eq_u32 s1, 0
  s_cbranch_scc1 L_ex_done
  buffer_load_dword v10, v45, s[20:23], s35 offen offset:128 sc1
  s_add_u32 s0, s0, 1
  s_waitcnt vmcnt(0)
  s_branch L_ex_loop
L_ex_done:
  s_waitcnt vmcnt(0)
  v_mfma_f32_16x16x32_bf16 v[64:67], v[18:21], v[96:99], v[64:67]
  s_mov_b32 s36, 0x0
  v_mfma_f32_16x16x32_bf16 v[64:67], v[18:21], v[112:115], v[64:67]
  v_mfma_f32_16x16x32_bf16 v[64:67], v[18:21], v[128:131], v[64:67]
  v_mfma_f32_16x16x32_bf16 v[72:75], v[18:21], v[100:103], v[72:75]
  v_mfma_f32_16x16x32_bf16 v[72:75], v[18:21], v[116:119], v[72:75]
  v_mfma_f32_16x16x32_bf16 v[72:75], v[18:21], v[132:135], v[72:75]
  s_nop 4
  v_fma_f32 v64, v64, v50, v160
  v_fma_f32 v65, v65, v50, v161
  v_mfma_f32_16x16x32_bf16 v[80:83], v[18:21], v[104:107], v[80:83]
  v_fma_f32 v66, v66, v50, v162
  v_fma_f32 v67, v67, v50, v163
  v_mfma_f32_16x16x32_bf16 v[80:83], v[18:21], v[120:123], v[80:83]
  v_cvt_pk_bf16_f32 v144, v64, v65
  v_cvt_pk_bf16_f32 v145, v66, v67
  v_mfma_f32_16x16x32_bf16 v[80:83], v[18:21], v[136:139], v[80:83]
  ds_write_b64 v56, v[144:145] offset:0
  v_fma_f32 v72, v72, v50, v168
  v_mfma_f32_16x16x32_bf16 v[88:91], v[18:21], v[108:111], v[88:91]
  v_fma_f32 v73, v73, v50, v169
  v_fma_f32 v74, v74, v50, v170
  v_mfma_f32_16x16x32_bf16 v[88:91], v[18:21], v[124:127], v[88:91]
  v_fma_f32 v75, v75, v50, v171
  v_cvt_pk_bf16_f32 v148, v72, v73
  v_mfma_f32_16x16x32_bf16 v[88:91], v[18:21], v[140:143], v[88:91]
  v_cvt_pk_bf16_f32 v149, v74, v75
  ds_write_b64 v57, v[148:149] offset:0
  v_mfma_f32_16x16x32_bf16 v[68:71], v[16:19], v[96:99], v[68:71]
  v_fma_f32 v80, v80, v50, v176
  v_fma_f32 v81, v81, v50, v177
  v_mfma_f32_16x16x32_bf16 v[68:71], v[16:19], v[112:115], v[68:71]
  v_fma_f32 v82, v82, v50, v178
  v_fma_f32 v83, v83, v50, v179
  v_mfma_f32_16x16x32_bf16 v[68:71], v[16:19], v[128:131], v[68:71]
  v_cvt_pk_bf16_f32 v152, v80, v81
  v_cvt_pk_bf16_f32 v153, v82, v83
  v_mfma_f32_16x16x32_bf16 v[76:79], v[16:19], v[100:103], v[76:79]
  ds_write_b64 v58, v[152:153] offset:0
  v_fma_f32 v88, v88, v50, v184
  v_mfma_f32_16x16x32_bf16 v[76:79], v[16:19], v[116:119], v[76:79]
  v_fma_f32 v89, v89, v50, v185
  v_fma_f32 v90, v90, v50, v186
  v_mfma_f32_16x16x32_bf16 v[76:79], v[16:19], v[132:135], v[76:79]
  v_fma_f32 v91, v91, v50, v187
  v_cvt_pk_bf16_f32 v156, v88, v89
  v_mfma_f32_16x16x32_bf16 v[84:87], v[16:19], v[104:107], v[84:87]
  v_cvt_pk_bf16_f32 v157, v90, v91
  ds_write_b64 v59, v[156:157] offset:0
  v_mfma_f32_16x16x32_bf16 v[84:87], v[16:19], v[120:123], v[84:87]
  ds_read_b128 v[192:195], v63 offset:0
  ds_read_b128 v[196:199], v63 offset:1024
  v_mfma_f32_16x16x32_bf16 v[84:87], v[16:19], v[136:139], v[84:87]
  v_fma_f32 v68, v68, v51, v164
  v_fma_f32 v69, v69, v51, v165
  v_mfma_f32_16x16x32_bf16 v[92:95], v[16:19], v[108:111], v[92:95]
  v_fma_f32 v70, v70, v51, v166
  v_fma_f32 v71, v71, v51, v167
  v_mfma_f32_16x16x32_bf16 v[92:95], v[16:19], v[124:127], v[92:95]
  v_cvt_pk_bf16_f32 v146, v68, v69
  v_cvt_pk_bf16_f32 v147, v70, v71
  v_mfma_f32_16x16x32_bf16 v[92:95], v[16:19], v[140:143], v[92:95]
  ds_write_b64 v56, v[146:147] offset:2048
  v_fma_f32 v76, v76, v51, v172
  v_fma_f32 v77, v77, v51, v173
  v_fma_f32 v78, v78, v51, v174
  v_fma_f32 v79, v79, v51, v175
  v_cvt_pk_bf16_f32 v150, v76, v77
  v_cvt_pk_bf16_f32 v151, v78, v79
  ds_write_b64 v57, v[150:151] offset:2048
  v_fma_f32 v84, v84, v51, v180
  v_fma_f32 v85, v85, v51, v181
  v_fma_f32 v86, v86, v51, v182
  v_fma_f32 v87, v87, v51, v183
  v_cvt_pk_bf16_f32 v154, v84, v85
  v_cvt_pk_bf16_f32 v155, v86, v87
  ds_write_b64 v58, v[154:155] offset:2048
  v_fma_f32 v92, v92, v51, v188
  v_fma_f32 v93, v93, v51, v189
  v_fma_f32 v94, v94, v51, v190
  v_fma_f32 v95, v95, v51, v191
  v_cvt_pk_bf16_f32 v158, v92, v93
  v_cvt_pk_bf16_f32 v159, v94, v95
  ds_write_b64 v59, v[158:159] offset:2048
  ds_read_b128 v[200:203], v63 offset:2048
  ds_read_b128 v[204:207], v63 offset:3072
  s_waitcnt lgkmcnt(7)
  buffer_store_dwordx4 v[192:195], v62, s[60:63], s36 offen sc1
  s_mov_b32 s36, 0x4000
  s_waitcnt lgkmcnt(6)
  buffer_store_dwordx4 v[196:199], v62, s[60:63], s36 offen sc1
  s_mov_b32 s36, 0x8000
  s_waitcnt lgkmcnt(1)
  buffer_store_dwordx4 v[200:203], v62, s[60:63], s36 offen sc1
  s_mov_b32 s36, 0xc000
  s_waitcnt lgkmcnt(0)
  buffer_store_dwordx4 v[204:207], v62, s[60:63], s36 offen sc1
L_end:
  s_endpgm
L_clr_wait:
  s_mov_b32 s0, 0
L_clr_loop:
  v_cmp_eq_u32 vcc, 0, v10
  s_nop 2
  s_cbranch_vccz L_clr_ok
  buffer_load_dword v10, off, s[4:7], s100 offset:0 sc1
  s_add_u32 s0, s0, 1
  s_cmp_lt_u32 s0, 0x200000
  s_waitcnt vmcnt(0)
  s_cbranch_scc1 L_clr_loop
  s_branch L_clr_ok
L_kv_wait:
  s_mov_b32 s0, 0
L_kv_loop:
  v_cmp_ne_u32 vcc, 1, v10
  s_nop 2
  s_cbranch_vccz L_kv_ok
  buffer_load_dword v10, v7, s[20:23], 0 offen offset:0 sc1
  s_add_u32 s0, s0, 1
  s_cmp_lt_u32 s0, 0x200000
  s_waitcnt vmcnt(0)
  s_cbranch_scc1 L_kv_loop
  s_branch L_kv_ok
L_prep_wait:
  s_mov_b32 s0, 0
L_prep_loop:
  v_cmp_eq_u32 vcc, 0, v10
  s_nop 2
  s_cbranch_vccz L_prep_ok
  buffer_load_dword v10, v6, s[4:7], 0 offen offset:128 sc1
  s_add_u32 s0, s0, 1
  s_cmp_lt_u32 s0, 0x200000
  s_waitcnt vmcnt(0)
  s_cbranch_scc1 L_prep_loop
  s_branch L_prep_ok
L_conv_wait:
  s_mov_b32 s0, 0
L_conv_loop:
  v_cmp_ne_u32 vcc, 1, v10
  s_nop 2
  s_cbranch_vccz L_conv_ok
  buffer_load_dword v10, v7, s[20:23], 0 offen offset:0 sc1
  s_add_u32 s0, s0, 1
  s_cmp_lt_u32 s0, 0x200000
  s_waitcnt vmcnt(0)
  s_cbranch_scc1 L_conv_loop
  s_branch L_conv_ok
L_codeend:
L_slow:
  s_waitcnt vmcnt(0) lgkmcnt(0)
  s_mov_b32 s72, 0
L_slow_qt:
  s_lshl_b32 s3, s30, 1
  s_xor_b32 s31, s3, 30
  s_cmp_lt_u32 s72, 2
  s_cselect_b32 s73, s3, s31
  s_and_b32 s3, s72, 1
  s_add_u32 s73, s73, s3
  s_mov_b32 s69, 0
  v_mov_b32 v14, v13
  v_mov_b32 v15, 0
  v_accvgpr_write_b32 a0, 0
  v_accvgpr_write_b32 a1, 0
  v_accvgpr_write_b32 a2, 0
  v_accvgpr_write_b32 a3, 0
  v_accvgpr_write_b32 a4, 0
  v_accvgpr_write_b32 a5, 0
  v_accvgpr_write_b32 a6, 0
  v_accvgpr_write_b32 a7, 0
  v_accvgpr_write_b32 a8, 0
  v_accvgpr_write_b32 a9, 0
  v_accvgpr_write_b32 a10, 0
  v_accvgpr_write_b32 a11, 0
  v_accvgpr_write_b32 a12, 0
  v_accvgpr_write_b32 a13, 0
  v_accvgpr_write_b32 a14, 0
  v_accvgpr_write_b32 a15, 0
  v_accvgpr_write_b32 a16, 0
  v_accvgpr_write_b32 a17, 0
  v_accvgpr_write_b32 a18, 0
  v_accvgpr_write_b32 a19, 0
  v_accvgpr_write_b32 a20, 0
  v_accvgpr_write_b32 a21, 0
  v_accvgpr_write_b32 a22, 0
  v_accvgpr_write_b32 a23, 0
  v_accvgpr_write_b32 a24, 0
  v_accvgpr_write_b32 a25, 0
  v_accvgpr_write_b32 a26, 0
  v_accvgpr_write_b32 a27, 0
  v_accvgpr_write_b32 a28, 0
  v_accvgpr_write_b32 a29, 0
  v_accvgpr_write_b32 a30, 0
  v_accvgpr_write_b32 a31, 0
  v_accvgpr_write_b32 a128, 0
  v_accvgpr_write_b32 a129, 0
  v_accvgpr_write_b32 a130, 0
  v_accvgpr_write_b32 a131, 0
L_slow_pass:
  v_mov_b32 v24, v15
  v_mov_b32 v25, v15
  v_mov_b32 v26, v15
  v_mov_b32 v27, v15
  v_mov_b32 v28, v15
  v_mov_b32 v29, v15
  v_mov_b32 v30, v15
  v_mov_b32 v31, v15
  v_mov_b32 v32, v15
  v_mov_b32 v33, v15
  v_mov_b32 v34, v15
  v_mov_b32 v35, v15
  v_mov_b32 v36, v15
  v_mov_b32 v37, v15
  v_mov_b32 v38, v15
  v_mov_b32 v39, v15
  s_mov_b32 s68, 0
L_slow_tile:
  s_lshl_b32 s3, s68, 15
  buffer_load_dwordx4 a[160:163], v3, s[24:27], s3 offen offset:0 sc1
  buffer_load_dwordx4 a[164:167], v3, s[24:27], s3 offen offset:1024 sc1
  buffer_load_dwordx4 a[168:171], v3, s[24:27], s3 offen offset:2048 sc1
  buffer_load_dwordx4 a[172:175], v3, s[24:27], s3 offen offset:3072 sc1
  s_add_u32 s3, s3, 4096
  buffer_load_dwordx4 a[176:179], v3, s[24:27], s3 offen offset:0 sc1
  buffer_load_dwordx4 a[180:183], v3, s[24:27], s3 offen offset:1024 sc1
  buffer_load_dwordx4 a[184:187], v3, s[24:27], s3 offen offset:2048 sc1
  buffer_load_dwordx4 a[188:191], v3, s[24:27], s3 offen offset:3072 sc1
  s_add_u32 s3, s3, 4096
  buffer_load_dwordx4 a[192:195], v3, s[24:27], s3 offen offset:0 sc1
  buffer_load_dwordx4 a[196:199], v3, s[24:27], s3 offen offset:1024 sc1
  buffer_load_dwordx4 a[200:203], v3, s[24:27], s3 offen offset:2048 sc1
  buffer_load_dwordx4 a[204:207], v3, s[24:27], s3 offen offset:3072 sc1
  s_add_u32 s3, s3, 4096
  buffer_load_dwordx4 a[208:211], v3, s[24:27], s3 offen offset:0 sc1
  buffer_load_dwordx4 a[212:215], v3, s[24:27], s3 offen offset:1024 sc1
  buffer_load_dwordx4 a[216:219], v3, s[24:27], s3 offen offset:2048 sc1
  buffer_load_dwordx4 a[220:223], v3, s[24:27], s3 offen offset:3072 sc1
  s_add_u32 s3, s3, 4096
  buffer_load_dwordx4 a[32:35], v3, s[24:27], s3 offen offset:0 sc1
  buffer_load_dwordx4 a[36:39], v3, s[24:27], s3 offen offset:1024 sc1
  buffer_load_dwordx4 a[40:43], v3, s[24:27], s3 offen offset:2048 sc1
  buffer_load_dwordx4 a[44:47], v3, s[24:27], s3 offen offset:3072 sc1
  s_add_u32 s3, s3, 4096
  buffer_load_dwordx4 a[48:51], v3, s[24:27], s3 offen offset:0 sc1
  buffer_load_dwordx4 a[52:55], v3, s[24:27], s3 offen offset:1024 sc1
  buffer_load_dwordx4 a[56:59], v3, s[24:27], s3 offen offset:2048 sc1
  buffer_load_dwordx4 a[60:63], v3, s[24:27], s3 offen offset:3072 sc1
  s_add_u32 s3, s3, 4096
  buffer_load_dwordx4 a[64:67], v3, s[24:27], s3 offen offset:0 sc1
  buffer_load_dwordx4 a[68:71], v3, s[24:27], s3 offen offset:1024 sc1
  buffer_load_dwordx4 a[72:75], v3, s[24:27], s3 offen offset:2048 sc1
  buffer_load_dwordx4 a[76:79], v3, s[24:27], s3 offen offset:3072 sc1
  s_add_u32 s3, s3, 4096
  buffer_load_dwordx4 a[80:83], v3, s[24:27], s3 offen offset:0 sc1
  buffer_load_dwordx4 a[84:87], v3, s[24:27], s3 offen offset:1024 sc1
  buffer_load_dwordx4 a[88:91], v3, s[24:27], s3 offen offset:2048 sc1
  buffer_load_dwordx4 a[92:95], v3, s[24:27], s3 offen offset:3072 sc1
  s_add_u32 s3, s3, 4096
  s_cmp_lg_u32 s68, s73
  s_cbranch_scc1 L_slow_nomask
  v_cndmask_b32 v24, v13, v24, s[32:33]
  v_cndmask_b32 v25, v13, v25, s[34:35]
  v_cndmask_b32 v26, v13, v26, s[36:37]
  v_cndmask_b32 v27, v13, v27, s[38:39]
  v_cndmask_b32 v28, v13, v28, s[40:41]
  v_cndmask_b32 v29, v13, v29, s[42:43]
  v_cndmask_b32 v30, v13, v30, s[44:45]
  v_cndmask_b32 v31, v13, v31, s[46:47]
  v_cndmask_b32 v32, v13, v32, s[48:49]
  v_cndmask_b32 v33, v13, v33, s[50:51]
  v_cndmask_b32 v34, v13, v34, s[52:53]
  v_cndmask_b32 v35, v13, v35, s[54:55]
  v_cndmask_b32 v36, v13, v36, s[56:57]
  v_cndmask_b32 v37, v13, v37, s[58:59]
  v_cndmask_b32 v38, v13, v38, s[60:61]
  v_cndmask_b32 v39, v13, v39, s[62:63]
L_slow_nomask:
  s_waitcnt vmcnt(0)
  v_mfma_f32_16x16x32_bf16 v[96:99], a[160:163], v[128:131], v[24:27]
  v_mfma_f32_16x16x32_bf16 v[96:99], a[164:167], v[132:135], v[96:99]
  v_mfma_f32_16x16x32_bf16 v[96:99], a[168:171], v[136:139], v[96:99]
  v_mfma_f32_16x16x32_bf16 v[96:99], a[172:175], v[140:143], v[96:99]
  v_mfma_f32_16x16x32_bf16 v[100:103], a[176:179], v[128:131], v[28:31]
  v_mfma_f32_16x16x32_bf16 v[100:103], a[180:183], v[132:135], v[100:103]
  v_mfma_f32_16x16x32_bf16 v[100:103], a[184:187], v[136:139], v[100:103]
  v_mfma_f32_16x16x32_bf16 v[100:103], a[188:191], v[140:143], v[100:103]
  v_mfma_f32_16x16x32_bf16 v[104:107], a[192:195], v[128:131], v[32:35]
  v_mfma_f32_16x16x32_bf16 v[104:107], a[196:199], v[132:135], v[104:107]
  v_mfma_f32_16x16x32_bf16 v[104:107], a[200:203], v[136:139], v[104:107]
  v_mfma_f32_16x16x32_bf16 v[104:107], a[204:207], v[140:143], v[104:107]
  v_mfma_f32_16x16x32_bf16 v[108:111], a[208:211], v[128:131], v[36:39]
  v_mfma_f32_16x16x32_bf16 v[108:111], a[212:215], v[132:135], v[108:111]
  v_mfma_f32_16x16x32_bf16 v[108:111], a[216:219], v[136:139], v[108:111]
  v_mfma_f32_16x16x32_bf16 v[108:111], a[220:223], v[140:143], v[108:111]
  s_cmp_lg_u32 s69, 0
  s_cbranch_scc1 L_slow_p2
  v_max3_f32 v14, v14, v96, v97
  v_max3_f32 v14, v14, v98, v99
  v_max3_f32 v14, v14, v100, v101
  v_max3_f32 v14, v14, v102, v103
  v_max3_f32 v14, v14, v104, v105
  v_max3_f32 v14, v14, v106, v107
  v_max3_f32 v14, v14, v108, v109
  v_max3_f32 v14, v14, v110, v111
  s_branch L_slow_next
L_slow_p2:
  v_exp_f32 v96, v96
  v_exp_f32 v97, v97
  v_exp_f32 v98, v98
  v_exp_f32 v99, v99
  v_exp_f32 v100, v100
  v_exp_f32 v101, v101
  v_exp_f32 v102, v102
  v_exp_f32 v103, v103
  v_exp_f32 v104, v104
  v_exp_f32 v105, v105
  v_exp_f32 v106, v106
  v_exp_f32 v107, v107
  v_exp_f32 v108, v108
  v_exp_f32 v109, v109
  v_exp_f32 v110, v110
  v_exp_f32 v111, v111
  v_cvt_pk_bf16_f32 v112, v96, v97
  v_cvt_pk_bf16_f32 v113, v98, v99
  v_cvt_pk_bf16_f32 v114, v100, v101
  v_cvt_pk_bf16_f32 v115, v102, v103
  v_cvt_pk_bf16_f32 v116, v104, v105
  v_cvt_pk_bf16_f32 v117, v106, v107
  v_cvt_pk_bf16_f32 v118, v108, v109
  v_cvt_pk_bf16_f32 v119, v110, v111
  v_mfma_f32_16x16x32_bf16 a[128:131], a[144:147], v[112:115], a[128:131]
  s_nop 0
  v_mfma_f32_16x16x32_bf16 a[128:131], a[144:147], v[116:119], a[128:131]
  v_mfma_f32_16x16x32_bf16 a[0:3], a[32:35], v[112:115], a[0:3]
  v_mfma_f32_16x16x32_bf16 a[0:3], a[36:39], v[116:119], a[0:3]
  v_mfma_f32_16x16x32_bf16 a[4:7], a[40:43], v[112:115], a[4:7]
  v_mfma_f32_16x16x32_bf16 a[4:7], a[44:47], v[116:119], a[4:7]
  v_mfma_f32_16x16x32_bf16 a[8:11], a[48:51], v[112:115], a[8:11]
  v_mfma_f32_16x16x32_bf16 a[8:11], a[52:55], v[116:119], a[8:11]
  v_mfma_f32_16x16x32_bf16 a[12:15], a[56:59], v[112:115], a[12:15]
  v_mfma_f32_16x16x32_bf16 a[12:15], a[60:63], v[116:119], a[12:15]
  v_mfma_f32_16x16x32_bf16 a[16:19], a[64:67], v[112:115], a[16:19]
  v_mfma_f32_16x16x32_bf16 a[16:19], a[68:71], v[116:119], a[16:19]
  v_mfma_f32_16x16x32_bf16 a[20:23], a[72:75], v[112:115], a[20:23]
  v_mfma_f32_16x16x32_bf16 a[20:23], a[76:79], v[116:119], a[20:23]
  v_mfma_f32_16x16x32_bf16 a[24:27], a[80:83], v[112:115], a[24:27]
  v_mfma_f32_16x16x32_bf16 a[24:27], a[84:87], v[116:119], a[24:27]
  v_mfma_f32_16x16x32_bf16 a[28:31], a[88:91], v[112:115], a[28:31]
  v_mfma_f32_16x16x32_bf16 a[28:31], a[92:95], v[116:119], a[28:31]
L_slow_next:
  s_add_u32 s68, s68, 1
  s_cmp_le_u32 s68, s73
  s_cbranch_scc1 L_slow_tile
  s_cmp_lg_u32 s69, 0
  s_cbranch_scc1 L_slow_store
  v_mov_b32 v16, v14
  s_nop 1
  v_permlane32_swap_b32 v16, v14
  v_max_f32 v14, v14, v16
  v_mov_b32 v16, v14
  s_nop 1
  v_permlane16_swap_b32 v16, v14
  v_max_f32 v14, v14, v16
  v_sub_f32 v15, 0, v14
  s_mov_b32 s69, 1
  s_branch L_slow_pass
L_slow_store:
  s_lshl_b32 s3, s30, 20
  s_xor_b32 s31, s3, 0xf00000
  s_cmp_lt_u32 s72, 2
  s_cselect_b32 s66, s3, s31
  s_and_b32 s3, s72, 1
  s_lshl_b32 s3, s3, 12
  s_add_u32 s66, s66, s3
  v_accvgpr_read_b32 v16, a128
  v_rcp_f32 v16, v16
  v_accvgpr_read_b32 v192, a0
  v_accvgpr_read_b32 v193, a1
  v_accvgpr_read_b32 v194, a2
  v_accvgpr_read_b32 v195, a3
  v_accvgpr_read_b32 v196, a4
  v_accvgpr_read_b32 v197, a5
  v_accvgpr_read_b32 v198, a6
  v_accvgpr_read_b32 v199, a7
  v_mul_f32 v192, v192, v16
  v_mul_f32 v193, v193, v16
  v_mul_f32 v194, v194, v16
  v_mul_f32 v195, v195, v16
  v_mul_f32 v196, v196, v16
  v_mul_f32 v197, v197, v16
  v_mul_f32 v198, v198, v16
  v_mul_f32 v199, v199, v16
  v_cvt_pk_bf16_f32 v200, v192, v193
  v_cvt_pk_bf16_f32 v201, v194, v195
  v_cvt_pk_bf16_f32 v202, v196, v197
  v_cvt_pk_bf16_f32 v203, v198, v199
  buffer_store_dwordx4 v[200:203], v3, s[4:7], s66 offen sc1
  s_add_u32 s66, s66, 8192
  v_accvgpr_read_b32 v192, a8
  v_accvgpr_read_b32 v193, a9
  v_accvgpr_read_b32 v194, a10
  v_accvgpr_read_b32 v195, a11
  v_accvgpr_read_b32 v196, a12
  v_accvgpr_read_b32 v197, a13
  v_accvgpr_read_b32 v198, a14
  v_accvgpr_read_b32 v199, a15
  v_mul_f32 v192, v192, v16
  v_mul_f32 v193, v193, v16
  v_mul_f32 v194, v194, v16
  v_mul_f32 v195, v195, v16
  v_mul_f32 v196, v196, v16
  v_mul_f32 v197, v197, v16
  v_mul_f32 v198, v198, v16
  v_mul_f32 v199, v199, v16
  v_cvt_pk_bf16_f32 v200, v192, v193
  v_cvt_pk_bf16_f32 v201, v194, v195
  v_cvt_pk_bf16_f32 v202, v196, v197
  v_cvt_pk_bf16_f32 v203, v198, v199
  buffer_store_dwordx4 v[200:203], v3, s[4:7], s66 offen sc1
  s_add_u32 s66, s66, 8192
  v_accvgpr_read_b32 v192, a16
  v_accvgpr_read_b32 v193, a17
  v_accvgpr_read_b32 v194, a18
  v_accvgpr_read_b32 v195, a19
  v_accvgpr_read_b32 v196, a20
  v_accvgpr_read_b32 v197, a21
  v_accvgpr_read_b32 v198, a22
  v_accvgpr_read_b32 v199, a23
  v_mul_f32 v192, v192, v16
  v_mul_f32 v193, v193, v16
  v_mul_f32 v194, v194, v16
  v_mul_f32 v195, v195, v16
  v_mul_f32 v196, v196, v16
  v_mul_f32 v197, v197, v16
  v_mul_f32 v198, v198, v16
  v_mul_f32 v199, v199, v16
  v_cvt_pk_bf16_f32 v200, v192, v193
  v_cvt_pk_bf16_f32 v201, v194, v195
  v_cvt_pk_bf16_f32 v202, v196, v197
  v_cvt_pk_bf16_f32 v203, v198, v199
  buffer_store_dwordx4 v[200:203], v3, s[4:7], s66 offen sc1
  s_add_u32 s66, s66, 8192
  v_accvgpr_read_b32 v192, a24
  v_accvgpr_read_b32 v193, a25
  v_accvgpr_read_b32 v194, a26
  v_accvgpr_read_b32 v195, a27
  v_accvgpr_read_b32 v196, a28
  v_accvgpr_read_b32 v197, a29
  v_accvgpr_read_b32 v198, a30
  v_accvgpr_read_b32 v199, a31
  v_mul_f32 v192, v192, v16
  v_mul_f32 v193, v193, v16
  v_mul_f32 v194, v194, v16
  v_mul_f32 v195, v195, v16
  v_mul_f32 v196, v196, v16
  v_mul_f32 v197, v197, v16
  v_mul_f32 v198, v198, v16
  v_mul_f32 v199, v199, v16
  v_cvt_pk_bf16_f32 v200, v192, v193
  v_cvt_pk_bf16_f32 v201, v194, v195
  v_cvt_pk_bf16_f32 v202, v196, v197
  v_cvt_pk_bf16_f32 v203, v198, v199
  buffer_store_dwordx4 v[200:203], v3, s[4:7], s66 offen sc1
  s_add_u32 s66, s66, 8192
  v_mov_b32 v128, v144
  v_mov_b32 v129, v145
  v_mov_b32 v130, v146
  v_mov_b32 v131, v147
  v_mov_b32 v132, v148
  v_mov_b32 v133, v149
  v_mov_b32 v134, v150
  v_mov_b32 v135, v151
  v_mov_b32 v136, v152
  v_mov_b32 v137, v153
  v_mov_b32 v138, v154
  v_mov_b32 v139, v155
  v_mov_b32 v140, v156
  v_mov_b32 v141, v157
  v_mov_b32 v142, v158
  v_mov_b32 v143, v159
  v_mov_b32 v144, v160
  v_mov_b32 v145, v161
  v_mov_b32 v146, v162
  v_mov_b32 v147, v163
  v_mov_b32 v148, v164
  v_mov_b32 v149, v165
  v_mov_b32 v150, v166
  v_mov_b32 v151, v167
  v_mov_b32 v152, v168
  v_mov_b32 v153, v169
  v_mov_b32 v154, v170
  v_mov_b32 v155, v171
  v_mov_b32 v156, v172
  v_mov_b32 v157, v173
  v_mov_b32 v158, v174
  v_mov_b32 v159, v175
  v_mov_b32 v160, v176
  v_mov_b32 v161, v177
  v_mov_b32 v162, v178
  v_mov_b32 v163, v179
  v_mov_b32 v164, v180
  v_mov_b32 v165, v181
  v_mov_b32 v166, v182
  v_mov_b32 v167, v183
  v_mov_b32 v168, v184
  v_mov_b32 v169, v185
  v_mov_b32 v170, v186
  v_mov_b32 v171, v187
  v_mov_b32 v172, v188
  v_mov_b32 v173, v189
  v_mov_b32 v174, v190
  v_mov_b32 v175, v191
  s_add_u32 s72, s72, 1
  s_cmp_lt_u32 s72, 4
  s_cbranch_scc1 L_slow_qt
  s_waitcnt vmcnt(0)
  ds_read_b128 a[32:35], v68 offset:448
  ds_read_b128 a[0:3], v72
  ds_read_b128 a[36:39], v68 offset:960
  ds_read2_b32 a[4:5], v64 offset0:128 offset1:129
  ds_read2_b32 a[6:7], v64 offset0:130 offset1:131
  ds_read_b128 a[40:43], v68 offset:1472
  ds_read2_b32 a[8:9], v65 offset0:0 offset1:1
  ds_read2_b32 a[10:11], v65 offset0:2 offset1:3
  ds_read_b128 a[44:47], v68 offset:1984
  ds_read2_b32 a[12:13], v65 offset0:128 offset1:129
  ds_read2_b32 a[14:15], v65 offset0:130 offset1:131
  ds_read_b128 a[48:51], v68 offset:2496
  ds_read2_b32 a[16:17], v66 offset0:0 offset1:1
  ds_read2_b32 a[18:19], v66 offset0:2 offset1:3
  ds_read_b128 a[52:55], v68 offset:3008
  ds_read2_b32 a[20:21], v66 offset0:128 offset1:129
  ds_read2_b32 a[22:23], v66 offset0:130 offset1:131
  ds_read_b128 a[56:59], v68 offset:3520
  ds_read2_b32 a[24:25], v67 offset0:0 offset1:1
  ds_read2_b32 a[26:27], v67 offset0:2 offset1:3
  ds_read_b128 a[60:63], v68 offset:4032
  ds_read2_b32 a[28:29], v67 offset0:128 offset1:129
  ds_read2_b32 a[30:31], v67 offset0:130 offset1:131
  s_mov_b32 s6, 0
  s_branch L_slow_ret
.section .rodata,"a"
.p2align 6
.amdhsa_kernel gated_mix__compressed_kv_cla__ssm_conv_h3__prompt_kernel
  .amdhsa_next_free_vgpr 512
  .amdhsa_next_free_sgpr 102
  .amdhsa_accum_offset 256
  .amdhsa_group_segment_fixed_size 0
  .amdhsa_kernarg_size 128
  .amdhsa_user_sgpr_count 2
  .amdhsa_user_sgpr_kernarg_segment_ptr 1
  .amdhsa_system_sgpr_workgroup_id_x 1
  .amdhsa_float_denorm_mode_32 3
.end_amdhsa_kernel
```
